```python
import torch

def _softmax(x, axis=-1):
    return torch.softmax(x, dim=axis)
def _gelu(x):
    return torch.nn.functional.gelu(x, approximate="tanh")
def _silu(x):
    return torch.nn.functional.silu(x)
def _sigmoid(x):
    return torch.sigmoid(x)
def _layernorm(x, axis=-1, eps=1e-5):
    m = x.mean(dim=axis, keepdim=True)
    v = x.var(dim=axis, keepdim=True, unbiased=False)
    return (x - m) / torch.sqrt(v + eps)
def _scatter_add(tgt, idx, src, axis=0):
    return tgt.clone().index_add_(axis, idx, src)
def _segment_sum(src, seg, n):
    out = torch.zeros((n,) + src.shape[1:], dtype=src.dtype)
    return out.index_add_(0, seg, src)
def _pad(x, pw):
    flat = tuple(v for pair in reversed(pw) for v in pair)
    return torch.nn.functional.pad(x, flat)

kernel_name = 'interleave_layers__sliding_local_dilated__dense_activation_squared_relu__prompt'

def setup_inputs():

    _w = (lambda a: (lambda t: t.to(torch.bfloat16) if t.is_floating_point() else t)(torch.as_tensor(a)))
    def _A_setup():
        B, S, D = 1, 2048, 1024
        return {
            "x": _w((lambda *s: torch.randn(*s, dtype=torch.bfloat16) * 0.05)(B, S, D)),
            "wqkv": _w((lambda *s: torch.randn(*s, dtype=torch.bfloat16) * 0.05)(D, 3 * D)),
            "wo": _w((lambda *s: torch.randn(*s, dtype=torch.bfloat16) * 0.05)(D, D)),
        }
    _A_in = _A_setup()

    def _B_setup():
        B, S, D, F = 1, 2048, 1024, 3584
        return {
            "x": _w((lambda *s: torch.randn(*s, dtype=torch.bfloat16) * 0.05)(B, S, D)),
            "w1": _w((lambda *s: torch.randn(*s, dtype=torch.bfloat16) * 0.05)(D, F)),
            "b1": _w((lambda *s: torch.randn(*s, dtype=torch.bfloat16) * 0.2)(F)),
            "w2": _w((lambda *s: torch.randn(*s, dtype=torch.bfloat16) * 0.05)(F, D)),
            "b2": _w((lambda *s: torch.randn(*s, dtype=torch.bfloat16) * 1.6)(D)),
        }
    _B_in = _B_setup()

    return {
        "A_x": _A_in["x"],
        "A_wqkv": _A_in["wqkv"],
        "A_wo": _A_in["wo"],
        "B_x": _B_in["x"],
        "B_w1": _B_in["w1"],
        "B_b1": _B_in["b1"],
        "B_w2": _B_in["w2"],
        "B_b2": _B_in["b2"],
    }

def reference(A_x, A_wqkv, A_wo, B_x, B_w1, B_b1, B_w2, B_b2):
    def _A_ref(x, wqkv, wo):
        B, S, D = x.shape
        H = 32; Dh = D // H
        W, dil = 8, 2
        qkv = (lambda x, *d: x.permute(*d))((x @ wqkv).reshape(B, S, 3, H, Dh), 2, 0, 3, 1, 4)
        q, k, v = qkv[0], qkv[1], qkv[2]
        scale = Dh ** -0.5
        pos = torch.arange(S)
        off = torch.arange(W) * dil
        idx = pos[:, None] - off[None, :]
        mask = idx >= 0
        idx_c = torch.where(mask, idx, 0).reshape(-1)
        kg = k[:, :, idx_c, :].reshape(B, H, S, W, Dh)
        vg = v[:, :, idx_c, :].reshape(B, H, S, W, Dh)
        logits = torch.einsum("bhsd,bhswd->bhsw", q, kg) * scale
        logits = torch.where(mask[None, None, :, :], logits, -1e9)
        attn = _softmax(logits, axis=-1)
        o = torch.einsum("bhsw,bhswd->bhsd", attn, vg)
        return (lambda x, *d: x.permute(*d))(o, 0, 2, 1, 3).reshape(B, S, D) @ wo

    def _B_ref(x, w1, b1, w2, b2):
        h = torch.einsum("bsd,df->bsf", x, w1) + b1
        zero = torch.zeros_like(h)
        r = torch.where(h > zero, h, zero)
        h = r * r
        out = torch.einsum("bsf,fd->bsd", h, w2) + b2
        return out

    x = A_x
    x = x + _A_ref(_layernorm(x, axis=-1), A_wqkv, A_wo)
    x = x + _B_ref(_layernorm(x, axis=-1), B_w1, B_b1, B_w2, B_b2)
    x = x + _A_ref(_layernorm(x, axis=-1), A_wqkv, A_wo)
    x = x + _B_ref(_layernorm(x, axis=-1), B_w1, B_b1, B_w2, B_b2)
    return x
```

```asm
; @launch grid=(256,1,1) block=(256,1,1) lds=163840
.amdgcn_target "amdgcn-amd-amdhsa--gfx950"
.text
.globl interleave_layers__sliding_local_dilated__dense_activation_squared_relu__prompt_kernel
.p2align 8
.type interleave_layers__sliding_local_dilated__dense_activation_squared_relu__prompt_kernel,@function
interleave_layers__sliding_local_dilated__dense_activation_squared_relu__prompt_kernel:
    s_load_dwordx16 s[64:79], s[0:1], 0x0
    s_load_dwordx4 s[80:83], s[0:1], 0x40
    s_load_dwordx2 s[84:85], s[0:1], 0x50
    s_cmp_ge_u32 s2, 256
    s_cbranch_scc1 L_end
    v_lshrrev_b32 v1, 6, v0
    s_nop 0
    v_readfirstlane_b32 s30, v1
    v_and_b32 v0, 63, v0
    v_lshlrev_b32 v1, 4, v0
    s_lshr_b32 s53, s2, 4
    s_cmp_lt_u32 s53, 8
    s_mov_b32 s38, 0x2c281b1a
    s_mov_b32 s39, 0x3c31302d
    s_cselect_b32 s38, 0x3020100, s38
    s_cselect_b32 s39, 0x19181110, s39
    s_lshl_b32 s37, s53, 3
    s_lshr_b64 s[38:39], s[38:39], s37
    s_and_b32 s29, s38, 63
    s_mov_b32 s38, 0x11221111
    s_mov_b32 s39, 0x43333011
    s_lshl_b32 s37, s53, 2
    s_lshr_b64 s[38:39], s[38:39], s37
    s_and_b32 s53, s38, 7
    s_mov_b32 s38, 0xc8403210
    s_mov_b32 s39, 0xa8206420
    s_cmp_eq_u32 s53, 4
    s_cselect_b32 s38, 0x1302, s38
    s_and_b32 s37, s2, 3
    s_lshl_b32 s28, s53, 2
    s_add_u32 s37, s37, s28
    s_lshl_b32 s37, s37, 2
    s_lshr_b64 s[38:39], s[38:39], s37
    s_and_b32 s38, s38, 15
    s_add_u32 s29, s29, s38
    s_bfe_u32 s28, s2, 0x20002
    s_cmp_ge_u32 s53, 2
    s_cselect_b32 s37, 1, 0
    s_xor_b32 s28, s28, s37
    s_mov_b32 s43, 0x40000
    s_mov_b32 s55, 0
    s_waitcnt lgkmcnt(0)
    s_mov_b32 s4, s84
    s_mov_b32 s5, s85
    s_mov_b32 s6, 0x6200000
    s_mov_b32 s7, 0x00020000
    s_mov_b32 s8, s84
    s_mov_b32 s9, s85
    s_mov_b32 s10, 0x6200000
    s_mov_b32 s11, 0x00020000
    s_cmp_lt_u32 s29, 16
    s_cbranch_scc1 Lqkv_start
    s_cmp_ge_u32 s2, 128
    s_cbranch_scc1 L_prep
    s_lshr_b32 s38, s2, 3
    s_mov_b32 s24, s66
    s_mov_b32 s25, s67
    s_mov_b32 s26, 0x600000
    s_mov_b32 s27, 0x00020000
    v_lshrrev_b32 v12, 2, v0
    v_mul_u32_u24 v12, 6144, v12
    v_and_b32 v14, 3, v0
    v_lshl_add_u32 v12, v14, 7, v12
    s_and_b32 s41, s2, 3
    s_mul_i32 s37, s38, 0x60000
    s_mul_i32 s53, s30, 0x18000
    s_add_u32 s37, s37, s53
    s_mul_i32 s53, s41, 0x200
    s_add_u32 s37, s37, s53
    s_add_u32 s37, s37, 0xffd00000
    buffer_load_dword v13, v12, s[24:27], s37 offen
    s_add_u32 s37, s37, 2048
    buffer_load_dword v14, v12, s[24:27], s37 offen
    s_add_u32 s37, s37, 2048
    buffer_load_dword v15, v12, s[24:27], s37 offen
    s_getpc_b64 s[24:25]
L_pc76:
    s_sub_u32 s24, s24, L_pc76-interleave_layers__sliding_local_dilated__dense_activation_squared_relu__prompt_kernel
    s_subb_u32 s25, s25, 0
    s_mov_b32 s26, L_end-interleave_layers__sliding_local_dilated__dense_activation_squared_relu__prompt_kernel
    s_mov_b32 s27, 0x00020000
    s_mul_i32 s37, s38, 0x200
    s_mul_i32 s53, s30, 0x80
    s_add_u32 s37, s37, s53
    s_add_u32 s37, s37, 0xfffff000
    v_min_u32 v12, 11, v0
    v_mul_u32_u24 v12, 12288, v12
    buffer_load_dword v55, v12, s[24:27], s37 offen
    s_waitcnt vmcnt(1)
    s_branch L_noprep
L_prep:
    s_and_b32 s33, s2, 3
    s_bfe_u32 s34, s2, 0x50002
    s_mov_b32 s20, s64
    s_mov_b32 s21, s65
    s_mov_b32 s22, 0x400000
    s_mov_b32 s23, 0x00020000
    v_bfe_u32 v8, v0, 4, 1
    v_lshlrev_b32 v8, 5, v8
    v_lshrrev_b32 v10, 5, v0
    v_lshl_add_u32 v8, v10, 4, v8
    v_and_b32 v10, 15, v0
    v_lshl_add_u32 v8, v10, 11, v8
    s_mul_i32 s37, s33, 0x100000
    s_mul_i32 s53, s34, 0xffff8000
    s_add_u32 s37, s37, s53
    s_mul_i32 s53, s30, 0x200
    s_add_u32 s37, s37, s53
    s_add_u32 s37, s37, 0xf8000
    buffer_load_dwordx4 v[16:19], v8, s[20:23], s37 offen offset:0
    buffer_load_dwordx4 v[20:23], v8, s[20:23], s37 offen offset:64
    buffer_load_dwordx4 v[24:27], v8, s[20:23], s37 offen offset:128
    buffer_load_dwordx4 v[28:31], v8, s[20:23], s37 offen offset:192
    buffer_load_dwordx4 v[32:35], v8, s[20:23], s37 offen offset:256
    buffer_load_dwordx4 v[36:39], v8, s[20:23], s37 offen offset:320
    buffer_load_dwordx4 v[40:43], v8, s[20:23], s37 offen offset:384
    buffer_load_dwordx4 v[44:47], v8, s[20:23], s37 offen offset:448
    s_mul_i32 s37, s2, 0x4000
    s_mul_i32 s53, s30, 0x1000
    s_add_u32 s37, s37, s53
    s_add_u32 s37, s37, 0x5e00000
    v_mov_b32 v60, 0
    v_mov_b32 v61, 0
    v_mov_b32 v62, 0
    v_mov_b32 v63, 0
    buffer_store_dwordx4 v[60:63], v1, s[4:7], s37 offen offset:0 sc1
    buffer_store_dwordx4 v[60:63], v1, s[4:7], s37 offen offset:1024 sc1
    buffer_store_dwordx4 v[60:63], v1, s[4:7], s37 offen offset:2048 sc1
    buffer_store_dwordx4 v[60:63], v1, s[4:7], s37 offen offset:3072 sc1
    v_mov_b32 v56, 0x3f803f80
    v_mov_b32 v57, 0x3f803f80
    v_mov_b32 v58, 0x3f803f80
    v_mov_b32 v59, 0x3f803f80
    s_mov_b32 s44, 0xaaaaaaaa
    s_mov_b32 s45, 0xaaaaaaaa
    s_mov_b32 s46, 0xcccccccc
    s_mov_b32 s47, 0xcccccccc
    s_mov_b32 s38, 0xf0000f
    s_mov_b32 s39, 0xf0000f00
    v_and_b32 v10, 15, v0
    v_lshlrev_b32 v10, 3, v10
    v_mov_b32 v9, 0x40000000
    v_cndmask_b32 v9, v9, v10, s[38:39]
    s_mul_i32 s36, s33, 0x220000
    s_mul_i32 s53, s34, 0x8800
    s_add_u32 s36, s36, s53
    s_mul_i32 s53, s30, 0x2000
    s_add_u32 s36, s36, s53
    s_add_u32 s42, s36, 4096
    s_mul_i32 s40, s33, 0x220000
    s_mul_i32 s53, s34, 0x8800
    s_add_u32 s40, s40, s53
    s_mul_i32 s53, s30, 0x200
    s_add_u32 s40, s40, s53
    s_add_u32 s40, s40, 0x8000
    s_waitcnt vmcnt(4)
    v_permlane16_swap_b32 v16, v18
    v_permlane16_swap_b32 v17, v19
    buffer_store_dwordx4 v[16:19], v1, s[4:7], s36 offen offset:0 sc1
    v_permlane16_swap_b32 v20, v22
    v_permlane16_swap_b32 v21, v23
    buffer_store_dwordx4 v[20:23], v1, s[4:7], s36 offen offset:1024 sc1
    v_permlane16_swap_b32 v24, v26
    v_permlane16_swap_b32 v25, v27
    buffer_store_dwordx4 v[24:27], v1, s[4:7], s36 offen offset:2048 sc1
    v_permlane16_swap_b32 v28, v30
    v_permlane16_swap_b32 v29, v31
    buffer_store_dwordx4 v[28:31], v1, s[4:7], s36 offen offset:3072 sc1
    v_permlane16_swap_b32 v32, v34
    v_permlane16_swap_b32 v33, v35
    buffer_store_dwordx4 v[32:35], v1, s[4:7], s42 offen offset:0 sc1
    v_permlane16_swap_b32 v36, v38
    v_permlane16_swap_b32 v37, v39
    buffer_store_dwordx4 v[36:39], v1, s[4:7], s42 offen offset:1024 sc1
    v_permlane16_swap_b32 v40, v42
    v_permlane16_swap_b32 v41, v43
    buffer_store_dwordx4 v[40:43], v1, s[4:7], s42 offen offset:2048 sc1
    v_permlane16_swap_b32 v44, v46
    v_permlane16_swap_b32 v45, v47
    buffer_store_dwordx4 v[44:47], v1, s[4:7], s42 offen offset:3072 sc1
    v_mfma_f32_16x16x32_bf16 v[68:71], v[16:19], v[16:19], 0
    v_mfma_f32_16x16x32_bf16 v[76:79], v[24:27], v[24:27], 0
    v_mfma_f32_16x16x32_bf16 v[84:87], v[32:35], v[32:35], 0
    v_mfma_f32_16x16x32_bf16 v[92:95], v[40:43], v[40:43], 0
    v_mfma_f32_16x16x32_bf16 v[64:67], v[56:59], v[16:19], 0
    v_mfma_f32_16x16x32_bf16 v[72:75], v[56:59], v[24:27], 0
    v_mfma_f32_16x16x32_bf16 v[80:83], v[56:59], v[32:35], 0
    v_mfma_f32_16x16x32_bf16 v[88:91], v[56:59], v[40:43], 0
    v_mfma_f32_16x16x32_bf16 v[68:71], v[20:23], v[20:23], v[68:71]
    v_mfma_f32_16x16x32_bf16 v[76:79], v[28:31], v[28:31], v[76:79]
    v_mfma_f32_16x16x32_bf16 v[84:87], v[36:39], v[36:39], v[84:87]
    v_mfma_f32_16x16x32_bf16 v[92:95], v[44:47], v[44:47], v[92:95]
    v_mfma_f32_16x16x32_bf16 v[64:67], v[56:59], v[20:23], v[64:67]
    v_mfma_f32_16x16x32_bf16 v[72:75], v[56:59], v[28:31], v[72:75]
    v_mfma_f32_16x16x32_bf16 v[80:83], v[56:59], v[36:39], v[80:83]
    v_mfma_f32_16x16x32_bf16 v[88:91], v[56:59], v[44:47], v[88:91]
    s_nop 0
    v_cndmask_b32 v68, v68, v69, s[44:45]
    v_cndmask_b32 v76, v76, v77, s[44:45]
    v_cndmask_b32 v84, v84, v85, s[44:45]
    v_cndmask_b32 v92, v92, v93, s[44:45]
    v_cndmask_b32 v70, v70, v71, s[44:45]
    v_cndmask_b32 v78, v78, v79, s[44:45]
    v_cndmask_b32 v86, v86, v87, s[44:45]
    v_cndmask_b32 v94, v94, v95, s[44:45]
    v_cndmask_b32 v65, v68, v70, s[46:47]
    v_cndmask_b32 v73, v76, v78, s[46:47]
    v_cndmask_b32 v81, v84, v86, s[46:47]
    v_cndmask_b32 v89, v92, v94, s[46:47]
    buffer_store_dwordx2 v[64:65], v9, s[4:7], s40 offen offset:0 sc1
    buffer_store_dwordx2 v[72:73], v9, s[4:7], s40 offen offset:128 sc1
    buffer_store_dwordx2 v[80:81], v9, s[4:7], s40 offen offset:256 sc1
    buffer_store_dwordx2 v[88:89], v9, s[4:7], s40 offen offset:384 sc1
    s_lshr_b32 s38, s2, 3
    s_mov_b32 s24, s66
    s_mov_b32 s25, s67
    s_mov_b32 s26, 0x600000
    s_mov_b32 s27, 0x00020000
    v_lshrrev_b32 v12, 2, v0
    v_mul_u32_u24 v12, 6144, v12
    v_and_b32 v14, 3, v0
    v_lshl_add_u32 v12, v14, 7, v12
    s_and_b32 s41, s2, 3
    s_lshr_b32 s39, s30, 1
    s_mul_i32 s37, s38, 0x30000
    s_mul_i32 s53, s39, 0x18000
    s_add_u32 s37, s37, s53
    s_mul_i32 s53, s41, 0x200
    s_add_u32 s37, s37, s53
    s_and_b32 s39, s30, 1
    s_lshl_b32 s39, s39, 11
    s_add_u32 s37, s37, s39
    buffer_load_dword v13, v12, s[24:27], s37 offen
    s_add_u32 s37, s37, 2048
    buffer_load_dword v14, v12, s[24:27], s37 offen
    s_getpc_b64 s[24:25]
L_pc236:
    s_sub_u32 s24, s24, L_pc236-interleave_layers__sliding_local_dilated__dense_activation_squared_relu__prompt_kernel
    s_subb_u32 s25, s25, 0
    s_mov_b32 s26, L_end-interleave_layers__sliding_local_dilated__dense_activation_squared_relu__prompt_kernel
    s_mov_b32 s27, 0x00020000
    s_mul_i32 s37, s38, 0x200
    s_mul_i32 s53, s30, 0x80
    s_add_u32 s37, s37, s53
    s_add_u32 s37, s37, 0xfffff000
    v_min_u32 v12, 11, v0
    v_mul_u32_u24 v12, 12288, v12
    buffer_load_dword v55, v12, s[24:27], s37 offen
    s_waitcnt vmcnt(3)
    s_barrier
    s_mov_b32 s20, s82
    s_mov_b32 s21, s83
    s_mov_b32 s22, 0x100
    s_mov_b32 s23, 0x00020000
    s_cmp_eq_u32 s30, 0
    s_cselect_b32 s22, 256, 0
    s_and_b32 s37, s2, 15
    s_lshl_b32 s37, s37, 4
    v_mov_b32 v6, 1
    v_lshlrev_b32 v5, 8, v0
    buffer_atomic_add v6, v5, s[20:23], s37 offen
    s_waitcnt vmcnt(2)
L_noprep:
    s_cmp_lt_u32 s29, 24
    s_cbranch_scc1 Lwo_start
    s_cmp_lt_u32 s29, 43
    s_cbranch_scc1 Lffa_start
    s_cmp_lt_u32 s29, 44
    s_cbranch_scc1 L_end
    s_cmp_lt_u32 s29, 60
    s_cbranch_scc1 Lffb_start
Lred_start:
    s_mov_b32 s12, s76
    s_mov_b32 s13, s77
    s_mov_b32 s14, 0x700000
    s_mov_b32 s15, 0x00020000
    v_lshrrev_b32 v24, 3, v0
    v_mul_u32_u24 v24, 2048, v24
    v_bfe_u32 v25, v0, 4, 2
    v_lshlrev_b32 v25, 1, v25
    v_and_b32 v26, 7, v0
    v_xor_b32 v25, v25, v26
    v_lshl_add_u32 v40, v25, 4, v24
    v_add_u32 v41, 15360, v40
    s_sub_u32 s38, s29, 44
    s_and_b32 s39, s38, 3
    s_lshr_b32 s38, s38, 2
    s_mul_i32 s86, s38, 0x180000
    s_mul_i32 s53, s39, 0x200
    s_add_u32 s86, s86, s53
    s_mul_i32 s37, s30, 32768
    s_add_u32 s86, s86, s37
    s_lshl_b32 s87, s30, 11
    s_add_u32 m0, s87, 0
    s_add_u32 s37, s86, 0
    buffer_load_dwordx4 v40, s[12:15], s37 offen lds
    buffer_load_dwordx4 v41, s[12:15], s37 offen offset:1024 lds
    s_add_u32 m0, s87, 8192
    s_add_u32 s37, s86, 128
    buffer_load_dwordx4 v40, s[12:15], s37 offen lds
    buffer_load_dwordx4 v41, s[12:15], s37 offen offset:1024 lds
    s_add_u32 m0, s87, 16384
    s_add_u32 s37, s86, 256
    buffer_load_dwordx4 v40, s[12:15], s37 offen lds
    buffer_load_dwordx4 v41, s[12:15], s37 offen offset:1024 lds
    s_add_u32 m0, s87, 24576
    s_add_u32 s37, s86, 384
    buffer_load_dwordx4 v40, s[12:15], s37 offen lds
    buffer_load_dwordx4 v41, s[12:15], s37 offen offset:1024 lds
    s_add_u32 m0, s87, 32768
    s_add_u32 s37, s86, 131072
    buffer_load_dwordx4 v40, s[12:15], s37 offen lds
    buffer_load_dwordx4 v41, s[12:15], s37 offen offset:1024 lds
    s_add_u32 m0, s87, 40960
    s_add_u32 s37, s86, 131200
    buffer_load_dwordx4 v40, s[12:15], s37 offen lds
    buffer_load_dwordx4 v41, s[12:15], s37 offen offset:1024 lds
    s_add_u32 m0, s87, 49152
    s_add_u32 s37, s86, 131328
    buffer_load_dwordx4 v40, s[12:15], s37 offen lds
    buffer_load_dwordx4 v41, s[12:15], s37 offen offset:1024 lds
    s_add_u32 m0, s87, 57344
    s_add_u32 s37, s86, 131456
    buffer_load_dwordx4 v40, s[12:15], s37 offen lds
    buffer_load_dwordx4 v41, s[12:15], s37 offen offset:1024 lds
    s_add_u32 m0, s87, 65536
    s_add_u32 s37, s86, 262144
    buffer_load_dwordx4 v40, s[12:15], s37 offen lds
    buffer_load_dwordx4 v41, s[12:15], s37 offen offset:1024 lds
    s_add_u32 m0, s87, 73728
    s_add_u32 s37, s86, 262272
    buffer_load_dwordx4 v40, s[12:15], s37 offen lds
    buffer_load_dwordx4 v41, s[12:15], s37 offen offset:1024 lds
    s_add_u32 m0, s87, 81920
    s_add_u32 s37, s86, 262400
    buffer_load_dwordx4 v40, s[12:15], s37 offen lds
    buffer_load_dwordx4 v41, s[12:15], s37 offen offset:1024 lds
    s_add_u32 m0, s87, 90112
    s_add_u32 s37, s86, 262528
    buffer_load_dwordx4 v40, s[12:15], s37 offen lds
    buffer_load_dwordx4 v41, s[12:15], s37 offen offset:1024 lds
    s_add_u32 m0, s87, 98304
    s_add_u32 s37, s86, 393216
    buffer_load_dwordx4 v40, s[12:15], s37 offen lds
    buffer_load_dwordx4 v41, s[12:15], s37 offen offset:1024 lds
    s_add_u32 m0, s87, 106496
    s_add_u32 s37, s86, 393344
    buffer_load_dwordx4 v40, s[12:15], s37 offen lds
    buffer_load_dwordx4 v41, s[12:15], s37 offen offset:1024 lds
    s_add_u32 m0, s87, 114688
    s_add_u32 s37, s86, 393472
    buffer_load_dwordx4 v40, s[12:15], s37 offen lds
    buffer_load_dwordx4 v41, s[12:15], s37 offen offset:1024 lds
    s_add_u32 m0, s87, 122880
    s_add_u32 s37, s86, 393600
    buffer_load_dwordx4 v40, s[12:15], s37 offen lds
    buffer_load_dwordx4 v41, s[12:15], s37 offen offset:1024 lds
    v_bfe_u32 v24, v0, 3, 2
    v_and_b32 v25, 3, v0
    v_lshlrev_b32 v25, 3, v25
    v_lshrrev_b32 v26, 2, v0
    v_lshl_add_u32 v26, v26, 7, v25
    v_lshrrev_b32 v27, 5, v0
    v_lshl_add_u32 v27, v27, 10, v26
    s_mov_b32 s37, s30
    s_mov_b32 s38, 0
    s_lshl_b32 s37, s37, 13
    v_xor_b32 v28, s38, v24
    v_lshl_add_u32 v28, v28, 5, s37
    v_add_u32 v42, v28, v26
    v_add_u32 v46, v28, v27
    s_mov_b32 s37, s30
    s_mov_b32 s38, 1
    s_lshl_b32 s37, s37, 13
    v_xor_b32 v28, s38, v24
    v_lshl_add_u32 v28, v28, 5, s37
    v_add_u32 v43, v28, v26
    v_add_u32 v47, v28, v27
    s_mov_b32 s37, s30
    s_mov_b32 s38, 2
    s_lshl_b32 s37, s37, 13
    v_xor_b32 v28, s38, v24
    v_lshl_add_u32 v28, v28, 5, s37
    v_add_u32 v44, v28, v26
    v_add_u32 v48, v28, v27
    s_mov_b32 s37, s30
    s_mov_b32 s38, 3
    s_lshl_b32 s37, s37, 13
    v_xor_b32 v28, s38, v24
    v_lshl_add_u32 v28, v28, 5, s37
    v_add_u32 v45, v28, v26
    v_add_u32 v49, v28, v27
    s_mov_b32 s20, s78
    s_mov_b32 s21, s79
    s_mov_b32 s22, 0x800
    s_mov_b32 s23, 0x00020000
    v_lshrrev_b32 v8, 4, v0
    v_lshlrev_b32 v8, 3, v8
    s_mul_i32 s37, s29, 0x200
    s_mul_i32 s53, s30, 0x80
    s_add_u32 s37, s37, s53
    s_add_u32 s37, s37, 0xffff8800
    buffer_load_dwordx2 v[10:11], v8, s[20:23], s37 offen
    s_mul_i32 s37, s29, 0x200
    s_mul_i32 s53, s30, 0x80
    s_add_u32 s37, s37, s53
    s_add_u32 s37, s37, 0xffff8820
    buffer_load_dwordx2 v[12:13], v8, s[20:23], s37 offen
    s_mul_i32 s37, s29, 0x200
    s_mul_i32 s53, s30, 0x80
    s_add_u32 s37, s37, s53
    s_add_u32 s37, s37, 0xffff8840
    buffer_load_dwordx2 v[14:15], v8, s[20:23], s37 offen
    s_mul_i32 s37, s29, 0x200
    s_mul_i32 s53, s30, 0x80
    s_add_u32 s37, s37, s53
    s_add_u32 s37, s37, 0xffff8860
    buffer_load_dwordx2 v[16:17], v8, s[20:23], s37 offen
    s_waitcnt vmcnt(0)
    v_lshlrev_b32 v84, 16, v10
    v_and_b32 v85, 0xffff0000, v10
    v_lshlrev_b32 v86, 16, v11
    v_and_b32 v87, 0xffff0000, v11
    v_lshlrev_b32 v88, 16, v12
    v_and_b32 v89, 0xffff0000, v12
    v_lshlrev_b32 v90, 16, v13
    v_and_b32 v91, 0xffff0000, v13
    v_lshlrev_b32 v92, 16, v14
    v_and_b32 v93, 0xffff0000, v14
    v_lshlrev_b32 v94, 16, v15
    v_and_b32 v95, 0xffff0000, v15
    v_lshlrev_b32 v96, 16, v16
    v_and_b32 v97, 0xffff0000, v16
    v_lshlrev_b32 v98, 16, v17
    v_and_b32 v99, 0xffff0000, v17
    v_mov_b32 v74, 0x3f803f80
    v_mov_b32 v75, 0x3f803f80
    v_mov_b32 v76, 0x3f803f80
    v_mov_b32 v77, 0x3f803f80
    s_mov_b32 s44, 0xaaaaaaaa
    s_mov_b32 s45, 0xaaaaaaaa
    s_mov_b32 s46, 0xcccccccc
    s_mov_b32 s47, 0xcccccccc
    s_mov_b32 s38, 0xf0000f
    s_mov_b32 s39, 0xf0000f00
    v_and_b32 v8, 15, v0
    v_lshlrev_b32 v8, 3, v8
    v_mov_b32 v7, 0x40000000
    v_cndmask_b32 v7, v7, v8, s[38:39]
    s_mul_i32 s37, s29, 0xffffe200
    s_mul_i32 s53, s30, 0xfffff880
    s_add_u32 s37, s37, s53
    s_add_u32 s37, s37, 0x78800
    v_add_u32 v7, s37, v7
    v_mov_b32 v78, 0
    v_mov_b32 v79, 0
    v_mov_b32 v82, 0
    v_mov_b32 v83, 0
    v_mov_b32 v8, 0x3f80
    v_mov_b32 v9, 0x3f800000
    s_mov_b32 s38, 0x100001
    s_mov_b32 s39, 0x10000100
    v_cndmask_b32 v80, v78, v8, s[38:39]
    s_mov_b32 s38, 0x200002
    s_mov_b32 s39, 0x20000200
    v_cndmask_b32 v80, v80, v9, s[38:39]
    s_mov_b32 s38, 0x400004
    s_mov_b32 s39, 0x40000400
    v_cndmask_b32 v81, v78, v8, s[38:39]
    s_mov_b32 s38, 0x800008
    s_mov_b32 s39, 0x80000800
    v_cndmask_b32 v81, v81, v9, s[38:39]
    v_bfe_u32 v100, v0, 4, 1
    v_lshlrev_b32 v100, 5, v100
    v_lshrrev_b32 v8, 5, v0
    v_lshl_add_u32 v100, v8, 4, v100
    v_and_b32 v8, 15, v0
    v_lshl_add_u32 v100, v8, 11, v100
    s_mul_i32 s37, s28, 0x80000
    s_add_u32 s37, s37, 0x6001200
    v_min_u32 v4, 27, v0
    v_lshl_add_u32 v4, v4, 5, s37
    s_mul_i32 s37, s28, 0x80000
    s_mul_i32 s53, s29, 0x80
    s_add_u32 s37, s37, s53
    s_add_u32 s37, s37, 0x5fff800
    v_lshrrev_b32 v8, 2, v0
    v_lshl_add_u32 v8, v8, 9, s37
    v_and_b32 v9, 3, v0
    v_lshl_add_u32 v8, v9, 5, v8
    v_cmp_gt_u32 vcc, 16, v0
    s_nop 1
    v_cndmask_b32 v4, v4, v8, vcc
    s_mov_b32 s32, 1
    s_mul_i32 s33, s28, 0x720000
    s_add_u32 s33, s33, 0x2018000
    s_mul_i32 s40, s28, 0x800000
    s_mul_i32 s53, s29, 0x2000
    s_add_u32 s40, s40, s53
    s_mul_i32 s53, s30, 0x800
    s_add_u32 s40, s40, s53
    s_add_u32 s40, s40, 0x3f88000
    s_mul_i32 s41, s28, 0x240000
    s_mul_i32 s53, s29, 0x2000
    s_add_u32 s41, s41, s53
    s_mul_i32 s53, s30, 0x800
    s_add_u32 s41, s41, s53
    s_add_u32 s41, s41, 0x1188000
    s_mul_i32 s36, s28, 0x220000
    s_mul_i32 s53, s29, 0x2000
    s_add_u32 s36, s36, s53
    s_mul_i32 s53, s30, 0x800
    s_add_u32 s36, s36, s53
    s_add_u32 s36, s36, 0x8f800
    s_mul_i32 s42, s28, 0x100000
    s_mul_i32 s53, s29, 0x200
    s_add_u32 s42, s42, s53
    s_mul_i32 s53, s30, 0x80
    s_add_u32 s42, s42, s53
    s_add_u32 s42, s42, 0x1f8800
    s_mov_b32 s24, s80
    s_mov_b32 s25, s81
    s_mov_b32 s26, 0x400000
    s_mov_b32 s27, 0x00020000
    s_mov_b32 s31, -1
    s_mov_b32 s35, 0
    s_mov_b32 s16, 0
    v_mov_b32 v5, 0
    s_mul_i32 s17, s28, 0x80000
    s_mul_i32 s53, s29, 0x80
    s_add_u32 s17, s17, s53
    s_mul_i32 s53, s30, 0x20
    s_add_u32 s17, s17, s53
    s_add_u32 s17, s17, 0x5ffe000
    v_cmp_eq_u32 vcc, 0, v0
    v_mov_b32 v64, 0x40000000
    s_nop 0
    v_cndmask_b32 v64, v64, v0, vcc
    v_mov_b32 v2, v1
    s_mul_i32 s34, s30, 4096
    s_add_u32 s33, s33, s34
    s_mov_b64 s[18:19], 0xfffffff
    v_mov_b32 v8, 0x40000000
    v_cndmask_b32 v4, v8, v4, s[18:19]
    v_add_u32 v50, 0, v42
    v_add_u32 v51, 0, v43
    v_add_u32 v52, 0, v44
    v_add_u32 v53, 0, v45
    s_waitcnt vmcnt(24)
    s_barrier
    ds_read_b64_tr_b16 a[0:1], v50 offset:0
    ds_read_b64_tr_b16 a[2:3], v50 offset:2048
    ds_read_b64_tr_b16 a[4:5], v51 offset:0
    ds_read_b64_tr_b16 a[6:7], v51 offset:2048
    ds_read_b64_tr_b16 a[8:9], v52 offset:0
    ds_read_b64_tr_b16 a[10:11], v52 offset:2048
    ds_read_b64_tr_b16 a[12:13], v53 offset:0
    ds_read_b64_tr_b16 a[14:15], v53 offset:2048
    ds_read_b64_tr_b16 a[16:17], v50 offset:4096
    ds_read_b64_tr_b16 a[18:19], v50 offset:6144
    ds_read_b64_tr_b16 a[20:21], v51 offset:4096
    ds_read_b64_tr_b16 a[22:23], v51 offset:6144
    ds_read_b64_tr_b16 a[24:25], v52 offset:4096
    ds_read_b64_tr_b16 a[26:27], v52 offset:6144
    ds_read_b64_tr_b16 a[28:29], v53 offset:4096
    ds_read_b64_tr_b16 a[30:31], v53 offset:6144
    s_add_u32 m0, s87, 131072
    s_add_u32 s37, s86, 524288
    buffer_load_dwordx4 v40, s[12:15], s37 offen lds
    buffer_load_dwordx4 v41, s[12:15], s37 offen offset:1024 lds
    s_add_u32 m0, s87, 139264
    s_add_u32 s37, s86, 524416
    buffer_load_dwordx4 v40, s[12:15], s37 offen lds
    buffer_load_dwordx4 v41, s[12:15], s37 offen offset:1024 lds
    s_add_u32 m0, s87, 147456
    s_add_u32 s37, s86, 524544
    buffer_load_dwordx4 v40, s[12:15], s37 offen lds
    buffer_load_dwordx4 v41, s[12:15], s37 offen offset:1024 lds
    s_add_u32 m0, s87, 155648
    s_add_u32 s37, s86, 524672
    buffer_load_dwordx4 v40, s[12:15], s37 offen lds
    buffer_load_dwordx4 v41, s[12:15], s37 offen offset:1024 lds
    s_waitcnt lgkmcnt(0)
    v_add_u32 v50, 32768, v42
    v_add_u32 v51, 32768, v43
    v_add_u32 v52, 32768, v44
    v_add_u32 v53, 32768, v45
    s_waitcnt vmcnt(24)
    s_barrier
    ds_read_b64_tr_b16 a[32:33], v50 offset:0
    ds_read_b64_tr_b16 a[34:35], v50 offset:2048
    ds_read_b64_tr_b16 a[36:37], v51 offset:0
    ds_read_b64_tr_b16 a[38:39], v51 offset:2048
    ds_read_b64_tr_b16 a[40:41], v52 offset:0
    ds_read_b64_tr_b16 a[42:43], v52 offset:2048
    ds_read_b64_tr_b16 a[44:45], v53 offset:0
    ds_read_b64_tr_b16 a[46:47], v53 offset:2048
    ds_read_b64_tr_b16 a[48:49], v50 offset:4096
    ds_read_b64_tr_b16 a[50:51], v50 offset:6144
    ds_read_b64_tr_b16 a[52:53], v51 offset:4096
    ds_read_b64_tr_b16 a[54:55], v51 offset:6144
    ds_read_b64_tr_b16 a[56:57], v52 offset:4096
    ds_read_b64_tr_b16 a[58:59], v52 offset:6144
    ds_read_b64_tr_b16 a[60:61], v53 offset:4096
    ds_read_b64_tr_b16 a[62:63], v53 offset:6144
    s_add_u32 m0, s87, 0
    s_add_u32 s37, s86, 655360
    buffer_load_dwordx4 v40, s[12:15], s37 offen lds
    buffer_load_dwordx4 v41, s[12:15], s37 offen offset:1024 lds
    s_add_u32 m0, s87, 8192
    s_add_u32 s37, s86, 655488
    buffer_load_dwordx4 v40, s[12:15], s37 offen lds
    buffer_load_dwordx4 v41, s[12:15], s37 offen offset:1024 lds
    s_add_u32 m0, s87, 16384
    s_add_u32 s37, s86, 655616
    buffer_load_dwordx4 v40, s[12:15], s37 offen lds
    buffer_load_dwordx4 v41, s[12:15], s37 offen offset:1024 lds
    s_add_u32 m0, s87, 24576
    s_add_u32 s37, s86, 655744
    buffer_load_dwordx4 v40, s[12:15], s37 offen lds
    buffer_load_dwordx4 v41, s[12:15], s37 offen offset:1024 lds
    s_waitcnt lgkmcnt(0)
    v_add_u32 v50, 65536, v46
    v_add_u32 v51, 65536, v47
    v_add_u32 v52, 65536, v48
    v_add_u32 v53, 65536, v49
    s_waitcnt vmcnt(24)
    s_barrier
    ds_read_b64_tr_b16 a[64:65], v50 offset:0
    ds_read_b64_tr_b16 a[66:67], v50 offset:1024
    ds_read_b64_tr_b16 a[68:69], v51 offset:0
    ds_read_b64_tr_b16 a[70:71], v51 offset:1024
    ds_read_b64_tr_b16 a[72:73], v52 offset:0
    ds_read_b64_tr_b16 a[74:75], v52 offset:1024
    ds_read_b64_tr_b16 a[76:77], v53 offset:0
    ds_read_b64_tr_b16 a[78:79], v53 offset:1024
    ds_read_b64_tr_b16 a[80:81], v50 offset:4096
    ds_read_b64_tr_b16 a[82:83], v50 offset:5120
    ds_read_b64_tr_b16 a[84:85], v51 offset:4096
    ds_read_b64_tr_b16 a[86:87], v51 offset:5120
    ds_read_b64_tr_b16 a[88:89], v52 offset:4096
    ds_read_b64_tr_b16 a[90:91], v52 offset:5120
    ds_read_b64_tr_b16 a[92:93], v53 offset:4096
    ds_read_b64_tr_b16 a[94:95], v53 offset:5120
    s_add_u32 m0, s87, 32768
    s_add_u32 s37, s86, 786432
    buffer_load_dwordx4 v40, s[12:15], s37 offen lds
    buffer_load_dwordx4 v41, s[12:15], s37 offen offset:1024 lds
    s_add_u32 m0, s87, 40960
    s_add_u32 s37, s86, 786560
    buffer_load_dwordx4 v40, s[12:15], s37 offen lds
    buffer_load_dwordx4 v41, s[12:15], s37 offen offset:1024 lds
    s_add_u32 m0, s87, 49152
    s_add_u32 s37, s86, 786688
    buffer_load_dwordx4 v40, s[12:15], s37 offen lds
    buffer_load_dwordx4 v41, s[12:15], s37 offen offset:1024 lds
    s_add_u32 m0, s87, 57344
    s_add_u32 s37, s86, 786816
    buffer_load_dwordx4 v40, s[12:15], s37 offen lds
    buffer_load_dwordx4 v41, s[12:15], s37 offen offset:1024 lds
    s_waitcnt lgkmcnt(0)
    v_add_u32 v50, 98304, v42
    v_add_u32 v51, 98304, v43
    v_add_u32 v52, 98304, v44
    v_add_u32 v53, 98304, v45
    s_waitcnt vmcnt(24)
    s_barrier
    ds_read_b64_tr_b16 a[96:97], v50 offset:0
    ds_read_b64_tr_b16 a[98:99], v50 offset:2048
    ds_read_b64_tr_b16 a[100:101], v51 offset:0
    ds_read_b64_tr_b16 a[102:103], v51 offset:2048
    ds_read_b64_tr_b16 a[104:105], v52 offset:0
    ds_read_b64_tr_b16 a[106:107], v52 offset:2048
    ds_read_b64_tr_b16 a[108:109], v53 offset:0
    ds_read_b64_tr_b16 a[110:111], v53 offset:2048
    ds_read_b64_tr_b16 a[112:113], v50 offset:4096
    ds_read_b64_tr_b16 a[114:115], v50 offset:6144
    ds_read_b64_tr_b16 a[116:117], v51 offset:4096
    ds_read_b64_tr_b16 a[118:119], v51 offset:6144
    ds_read_b64_tr_b16 a[120:121], v52 offset:4096
    ds_read_b64_tr_b16 a[122:123], v52 offset:6144
    ds_read_b64_tr_b16 a[124:125], v53 offset:4096
    ds_read_b64_tr_b16 a[126:127], v53 offset:6144
    s_add_u32 m0, s87, 65536
    s_add_u32 s37, s86, 917504
    buffer_load_dwordx4 v40, s[12:15], s37 offen lds
    buffer_load_dwordx4 v41, s[12:15], s37 offen offset:1024 lds
    s_add_u32 m0, s87, 73728
    s_add_u32 s37, s86, 917632
    buffer_load_dwordx4 v40, s[12:15], s37 offen lds
    buffer_load_dwordx4 v41, s[12:15], s37 offen offset:1024 lds
    s_add_u32 m0, s87, 81920
    s_add_u32 s37, s86, 917760
    buffer_load_dwordx4 v40, s[12:15], s37 offen lds
    buffer_load_dwordx4 v41, s[12:15], s37 offen offset:1024 lds
    s_add_u32 m0, s87, 90112
    s_add_u32 s37, s86, 917888
    buffer_load_dwordx4 v40, s[12:15], s37 offen lds
    buffer_load_dwordx4 v41, s[12:15], s37 offen offset:1024 lds
    s_waitcnt lgkmcnt(0)
    v_add_u32 v50, 131072, v42
    v_add_u32 v51, 131072, v43
    v_add_u32 v52, 131072, v44
    v_add_u32 v53, 131072, v45
    s_waitcnt vmcnt(24)
    s_barrier
    ds_read_b64_tr_b16 a[128:129], v50 offset:0
    ds_read_b64_tr_b16 a[130:131], v50 offset:2048
    ds_read_b64_tr_b16 a[132:133], v51 offset:0
    ds_read_b64_tr_b16 a[134:135], v51 offset:2048
    ds_read_b64_tr_b16 a[136:137], v52 offset:0
    ds_read_b64_tr_b16 a[138:139], v52 offset:2048
    ds_read_b64_tr_b16 a[140:141], v53 offset:0
    ds_read_b64_tr_b16 a[142:143], v53 offset:2048
    ds_read_b64_tr_b16 a[144:145], v50 offset:4096
    ds_read_b64_tr_b16 a[146:147], v50 offset:6144
    ds_read_b64_tr_b16 a[148:149], v51 offset:4096
    ds_read_b64_tr_b16 a[150:151], v51 offset:6144
    ds_read_b64_tr_b16 a[152:153], v52 offset:4096
    ds_read_b64_tr_b16 a[154:155], v52 offset:6144
    ds_read_b64_tr_b16 a[156:157], v53 offset:4096
    ds_read_b64_tr_b16 a[158:159], v53 offset:6144
    s_waitcnt lgkmcnt(0)
    v_add_u32 v50, 0, v46
    v_add_u32 v51, 0, v47
    v_add_u32 v52, 0, v48
    v_add_u32 v53, 0, v49
    s_waitcnt vmcnt(16)
    s_barrier
    ds_read_b64_tr_b16 a[160:161], v50 offset:0
    ds_read_b64_tr_b16 a[162:163], v50 offset:1024
    ds_read_b64_tr_b16 a[164:165], v51 offset:0
    ds_read_b64_tr_b16 a[166:167], v51 offset:1024
    ds_read_b64_tr_b16 a[168:169], v52 offset:0
    ds_read_b64_tr_b16 a[170:171], v52 offset:1024
    ds_read_b64_tr_b16 a[172:173], v53 offset:0
    ds_read_b64_tr_b16 a[174:175], v53 offset:1024
    ds_read_b64_tr_b16 a[176:177], v50 offset:4096
    ds_read_b64_tr_b16 a[178:179], v50 offset:5120
    ds_read_b64_tr_b16 a[180:181], v51 offset:4096
    ds_read_b64_tr_b16 a[182:183], v51 offset:5120
    ds_read_b64_tr_b16 a[184:185], v52 offset:4096
    ds_read_b64_tr_b16 a[186:187], v52 offset:5120
    ds_read_b64_tr_b16 a[188:189], v53 offset:4096
    ds_read_b64_tr_b16 a[190:191], v53 offset:5120
    s_waitcnt lgkmcnt(0)
    v_add_u32 v50, 32768, v42
    v_add_u32 v51, 32768, v43
    v_add_u32 v52, 32768, v44
    v_add_u32 v53, 32768, v45
    s_waitcnt vmcnt(8)
    s_barrier
    ds_read_b64_tr_b16 a[192:193], v50 offset:0
    ds_read_b64_tr_b16 a[194:195], v50 offset:2048
    ds_read_b64_tr_b16 a[196:197], v51 offset:0
    ds_read_b64_tr_b16 a[198:199], v51 offset:2048
    ds_read_b64_tr_b16 a[200:201], v52 offset:0
    ds_read_b64_tr_b16 a[202:203], v52 offset:2048
    ds_read_b64_tr_b16 a[204:205], v53 offset:0
    ds_read_b64_tr_b16 a[206:207], v53 offset:2048
    ds_read_b64_tr_b16 a[208:209], v50 offset:4096
    ds_read_b64_tr_b16 a[210:211], v50 offset:6144
    ds_read_b64_tr_b16 a[212:213], v51 offset:4096
    ds_read_b64_tr_b16 a[214:215], v51 offset:6144
    ds_read_b64_tr_b16 a[216:217], v52 offset:4096
    ds_read_b64_tr_b16 a[218:219], v52 offset:6144
    ds_read_b64_tr_b16 a[220:221], v53 offset:4096
    ds_read_b64_tr_b16 a[222:223], v53 offset:6144
    s_waitcnt lgkmcnt(0)
    v_add_u32 v50, 65536, v42
    v_add_u32 v51, 65536, v43
    v_add_u32 v52, 65536, v44
    v_add_u32 v53, 65536, v45
    s_waitcnt vmcnt(0)
    s_barrier
    ds_read_b64_tr_b16 a[224:225], v50 offset:0
    ds_read_b64_tr_b16 a[226:227], v50 offset:2048
    ds_read_b64_tr_b16 a[228:229], v51 offset:0
    ds_read_b64_tr_b16 a[230:231], v51 offset:2048
    ds_read_b64_tr_b16 a[232:233], v52 offset:0
    ds_read_b64_tr_b16 a[234:235], v52 offset:2048
    ds_read_b64_tr_b16 a[236:237], v53 offset:0
    ds_read_b64_tr_b16 a[238:239], v53 offset:2048
    ds_read_b64_tr_b16 a[240:241], v50 offset:4096
    ds_read_b64_tr_b16 a[242:243], v50 offset:6144
    ds_read_b64_tr_b16 a[244:245], v51 offset:4096
    ds_read_b64_tr_b16 a[246:247], v51 offset:6144
    ds_read_b64_tr_b16 a[248:249], v52 offset:4096
    ds_read_b64_tr_b16 a[250:251], v52 offset:6144
    ds_read_b64_tr_b16 a[252:253], v53 offset:4096
    ds_read_b64_tr_b16 a[254:255], v53 offset:6144
    s_waitcnt lgkmcnt(0)
    s_mov_b32 s12, s84
    s_mov_b32 s13, s85
    s_mov_b32 s14, 0x6200000
    s_mov_b32 s15, 0x00020000
    s_barrier
    s_mov_b32 s20, s82
    s_mov_b32 s21, s83
    s_mov_b32 s22, 0x100
    s_mov_b32 s23, 0x00020000
    v_and_b32 v8, 15, v0
    v_lshlrev_b32 v8, 4, v8
    buffer_load_dword v9, v8, s[20:23], 0 offen sc1
    s_waitcnt vmcnt(0)
Lred_wa:
    v_cmp_gt_u32 vcc, 8, v9
    s_sub_u32 s43, s43, 1
    s_cmp_lt_i32 s43, 0
    s_cbranch_scc1 Lred_all
    s_cbranch_vccz Lred_all
    s_sleep 2
    buffer_load_dword v9, v8, s[20:23], 0 offen sc1
    s_waitcnt vmcnt(0)
    s_branch Lred_wa
Lred_all:
    s_branch Lred_spin1
    .p2align 6
Lred_body0:
    s_waitcnt lgkmcnt(2)
    v_mfma_f32_16x16x32_bf16 v[8:11], a[0:3], v[40:43], v[84:87]
    ds_read_b128 v[52:55], v2 offset:3072
    s_add_u32 s16, s16, 8192
    v_mfma_f32_16x16x32_bf16 v[12:15], a[4:7], v[40:43], v[88:91]
    s_cmp_eq_u32 s10, 0
    s_cbranch_scc1 Lred_slow0
    v_mfma_f32_16x16x32_bf16 v[16:19], a[8:11], v[40:43], v[92:95]
    buffer_load_dword v5, v4, s[4:7], s16 offen sc1
    v_mfma_f32_16x16x32_bf16 v[20:23], a[12:15], v[40:43], v[96:99]
    s_waitcnt lgkmcnt(2)
    v_cvt_pk_bf16_f32 v56, v24, v25
    v_cvt_pk_bf16_f32 v57, v26, v27
    v_mfma_f32_16x16x32_bf16 v[8:11], a[16:19], v[44:47], v[8:11]
    ds_read_b128 v[40:43], v2 offset:4096
    v_cvt_pk_bf16_f32 v58, v28, v29
    v_mfma_f32_16x16x32_bf16 v[12:15], a[20:23], v[44:47], v[12:15]
    s_add_u32 s31, s31, 1
    v_mov_b32 v6, s31
    v_cvt_pk_bf16_f32 v59, v30, v31
    v_mfma_f32_16x16x32_bf16 v[16:19], a[24:27], v[44:47], v[16:19]
    buffer_store_dwordx4 v[56:59], v1, s[12:15], s36 offen offset:0 sc1
    v_cvt_pk_bf16_f32 v60, v32, v33
    v_mfma_f32_16x16x32_bf16 v[20:23], a[28:31], v[44:47], v[20:23]
    s_waitcnt lgkmcnt(2)
    v_cvt_pk_bf16_f32 v61, v34, v35
    v_cvt_pk_bf16_f32 v62, v36, v37
    v_mfma_f32_16x16x32_bf16 v[8:11], a[32:35], v[48:51], v[8:11]
    ds_read_b128 v[44:47], v2 offset:5120
    v_cvt_pk_bf16_f32 v63, v38, v39
    v_mfma_f32_16x16x32_bf16 v[12:15], a[36:39], v[48:51], v[12:15]
    s_add_u32 s35, s35, 36864
    s_cmp_eq_u32 s35, 147456
    s_cselect_b32 s35, 0, s35
    v_mfma_f32_16x16x32_bf16 v[16:19], a[40:43], v[48:51], v[16:19]
    buffer_store_dwordx4 v[60:63], v1, s[12:15], s36 offen offset:1024 sc1
    v_add_u32 v3, s35, v1
    v_mfma_f32_16x16x32_bf16 v[70:73], v[56:59], v[56:59], 0
    v_mfma_f32_16x16x32_bf16 v[66:69], v[74:77], v[56:59], 0
    v_mfma_f32_16x16x32_bf16 v[70:73], v[60:63], v[60:63], v[70:73]
    v_mfma_f32_16x16x32_bf16 v[66:69], v[74:77], v[60:63], v[66:69]
    buffer_load_dwordx4 v[142:145], v1, s[8:11], s40 offen offset:0 sc1
    v_mfma_f32_16x16x32_bf16 v[20:23], a[44:47], v[48:51], v[20:23]
    s_waitcnt lgkmcnt(2)
    v_permlane16_swap_b32 v56, v58
    v_mfma_f32_16x16x32_bf16 v[8:11], a[48:51], v[52:55], v[8:11]
    ds_read_b128 v[48:51], v2 offset:6144
    v_mfma_f32_16x16x32_bf16 v[12:15], a[52:55], v[52:55], v[12:15]
    v_permlane16_swap_b32 v57, v59
    v_mfma_f32_16x16x32_bf16 v[16:19], a[56:59], v[52:55], v[16:19]
    buffer_store_dwordx4 v[56:59], v100, s[24:27], s42 offen offset:0
    v_mfma_f32_16x16x32_bf16 v[20:23], a[60:63], v[52:55], v[20:23]
    s_waitcnt lgkmcnt(2)
    v_permlane16_swap_b32 v60, v62
    v_mfma_f32_16x16x32_bf16 v[8:11], a[64:67], v[40:43], v[8:11]
    ds_read_b128 v[52:55], v2 offset:7168
    v_mfma_f32_16x16x32_bf16 v[12:15], a[68:71], v[40:43], v[12:15]
    v_permlane16_swap_b32 v61, v63
    v_mfma_f32_16x16x32_bf16 v[16:19], a[72:75], v[40:43], v[16:19]
    buffer_store_dwordx4 v[60:63], v100, s[24:27], s42 offen offset:64
    v_cndmask_b32 v70, v70, v71, s[44:45]
    v_mfma_f32_16x16x32_bf16 v[20:23], a[76:79], v[40:43], v[20:23]
    s_waitcnt lgkmcnt(2)
    v_cndmask_b32 v72, v72, v73, s[44:45]
    v_cndmask_b32 v67, v70, v72, s[46:47]
    v_mfma_f32_16x16x32_bf16 v[8:11], a[80:83], v[44:47], v[8:11]
    ds_read_b128 v[40:43], v2 offset:8192
    v_mfma_f32_16x16x32_bf16 v[12:15], a[84:87], v[44:47], v[12:15]
    v_mfma_f32_16x16x32_bf16 v[16:19], a[88:91], v[44:47], v[16:19]
    buffer_store_dwordx2 v[66:67], v7, s[12:15], s36 offen offset:0 sc1
    s_add_u32 s36, s36, 34816
    v_mfma_f32_16x16x32_bf16 v[20:23], a[92:95], v[44:47], v[20:23]
    s_waitcnt lgkmcnt(2)
    s_sub_u32 s42, s42, 32768
    v_mfma_f32_16x16x32_bf16 v[8:11], a[96:99], v[48:51], v[8:11]
    ds_read_b128 v[44:47], v2 offset:9216
    v_mfma_f32_16x16x32_bf16 v[12:15], a[100:103], v[48:51], v[12:15]
    v_mfma_f32_16x16x32_bf16 v[16:19], a[104:107], v[48:51], v[16:19]
    buffer_load_dwordx4 v[146:149], v1, s[8:11], s40 offen offset:1024 sc1
    v_mfma_f32_16x16x32_bf16 v[20:23], a[108:111], v[48:51], v[20:23]
    s_waitcnt lgkmcnt(2)
    s_add_u32 s37, s40, 32768
    v_mfma_f32_16x16x32_bf16 v[8:11], a[112:115], v[52:55], v[8:11]
    ds_read_b128 v[48:51], v2 offset:10240
    v_mfma_f32_16x16x32_bf16 v[12:15], a[116:119], v[52:55], v[12:15]
    v_mfma_f32_16x16x32_bf16 v[16:19], a[120:123], v[52:55], v[16:19]
    buffer_load_dwordx4 v[150:153], v1, s[8:11], s37 offen offset:0 sc1
    v_mfma_f32_16x16x32_bf16 v[20:23], a[124:127], v[52:55], v[20:23]
    s_waitcnt lgkmcnt(2)
    v_mfma_f32_16x16x32_bf16 v[8:11], a[128:131], v[40:43], v[8:11]
    ds_read_b128 v[52:55], v2 offset:11264
    v_mfma_f32_16x16x32_bf16 v[12:15], a[132:135], v[40:43], v[12:15]
    v_mfma_f32_16x16x32_bf16 v[16:19], a[136:139], v[40:43], v[16:19]
    buffer_load_dwordx4 v[154:157], v1, s[8:11], s37 offen offset:1024 sc1
    v_mfma_f32_16x16x32_bf16 v[20:23], a[140:143], v[40:43], v[20:23]
    s_waitcnt lgkmcnt(2)
    s_add_u32 s37, s40, 65536
    v_mfma_f32_16x16x32_bf16 v[8:11], a[144:147], v[44:47], v[8:11]
    ds_read_b128 v[40:43], v2 offset:12288
    v_mfma_f32_16x16x32_bf16 v[12:15], a[148:151], v[44:47], v[12:15]
    v_mfma_f32_16x16x32_bf16 v[16:19], a[152:155], v[44:47], v[16:19]
    buffer_load_dwordx4 v[158:161], v1, s[8:11], s37 offen offset:0 sc1
    v_mfma_f32_16x16x32_bf16 v[20:23], a[156:159], v[44:47], v[20:23]
    s_waitcnt lgkmcnt(2)
    v_mfma_f32_16x16x32_bf16 v[8:11], a[160:163], v[48:51], v[8:11]
    ds_read_b128 v[44:47], v2 offset:13312
    v_mfma_f32_16x16x32_bf16 v[12:15], a[164:167], v[48:51], v[12:15]
    v_mfma_f32_16x16x32_bf16 v[16:19], a[168:171], v[48:51], v[16:19]
    buffer_load_dwordx4 v[162:165], v1, s[8:11], s37 offen offset:1024 sc1
    v_mfma_f32_16x16x32_bf16 v[20:23], a[172:175], v[48:51], v[20:23]
    s_waitcnt lgkmcnt(2)
    s_add_u32 s37, s40, 98304
    v_mfma_f32_16x16x32_bf16 v[8:11], a[176:179], v[52:55], v[8:11]
    ds_read_b128 v[48:51], v2 offset:14336
    v_mfma_f32_16x16x32_bf16 v[12:15], a[180:183], v[52:55], v[12:15]
    v_mfma_f32_16x16x32_bf16 v[16:19], a[184:187], v[52:55], v[16:19]
    buffer_load_dwordx4 v[166:169], v1, s[8:11], s37 offen offset:0 sc1
    v_mfma_f32_16x16x32_bf16 v[20:23], a[188:191], v[52:55], v[20:23]
    s_waitcnt lgkmcnt(2)
    v_mfma_f32_16x16x32_bf16 v[8:11], a[192:195], v[40:43], v[8:11]
    ds_read_b128 v[52:55], v2 offset:15360
    v_mfma_f32_16x16x32_bf16 v[12:15], a[196:199], v[40:43], v[12:15]
    v_mfma_f32_16x16x32_bf16 v[16:19], a[200:203], v[40:43], v[16:19]
    buffer_load_dwordx4 v[170:173], v1, s[8:11], s37 offen offset:1024 sc1
    v_mfma_f32_16x16x32_bf16 v[20:23], a[204:207], v[40:43], v[20:23]
    s_waitcnt lgkmcnt(2)
    v_mfma_f32_16x16x32_bf16 v[8:11], a[208:211], v[44:47], v[8:11]
    v_mfma_f32_16x16x32_bf16 v[12:15], a[212:215], v[44:47], v[12:15]
    v_mfma_f32_16x16x32_bf16 v[16:19], a[216:219], v[44:47], v[16:19]
    buffer_load_dwordx4 v[174:177], v1, s[8:11], s41 offen offset:0 sc1
    v_mfma_f32_16x16x32_bf16 v[20:23], a[220:223], v[44:47], v[20:23]
    s_waitcnt lgkmcnt(1)
    v_mfma_f32_16x16x32_bf16 v[8:11], a[224:227], v[48:51], v[8:11]
    v_mfma_f32_16x16x32_bf16 v[12:15], a[228:231], v[48:51], v[12:15]
    v_mfma_f32_16x16x32_bf16 v[16:19], a[232:235], v[48:51], v[16:19]
    buffer_load_dwordx4 v[178:181], v1, s[8:11], s41 offen offset:1024 sc1
    v_mfma_f32_16x16x32_bf16 v[20:23], a[236:239], v[48:51], v[20:23]
    s_waitcnt lgkmcnt(0)
    s_add_u32 s32, s32, 1
    s_add_u32 s33, s33, 116736
    v_mfma_f32_16x16x32_bf16 v[8:11], a[240:243], v[52:55], v[8:11]
    s_add_u32 s34, s34, 36864
    s_cmp_ge_u32 s34, 147456
    s_cselect_b32 s38, 147456, 0
    v_mfma_f32_16x16x32_bf16 v[12:15], a[244:247], v[52:55], v[12:15]
    s_sub_u32 s34, s34, s38
    s_add_u32 s40, s40, 131072
    s_add_u32 s41, s41, 36864
    v_mfma_f32_16x16x32_bf16 v[16:19], a[248:251], v[52:55], v[16:19]
    s_waitcnt vmcnt(15)
    v_cmp_gt_i32 vcc, s32, v5
    v_mfma_f32_16x16x32_bf16 v[20:23], a[252:255], v[52:55], v[20:23]
    v_mfma_f32_16x16x32_bf16 v[8:11], v[80:83], v[102:105], v[8:11]
    s_and_b64 vcc, vcc, s[18:19]
    s_cselect_b32 s10, 0, s6
    s_add_u32 m0, s34, 0
    v_mfma_f32_16x16x32_bf16 v[12:15], v[78:81], v[102:105], v[12:15]
    buffer_load_dwordx4 v1, s[8:11], s33 offen offset:0 sc1 lds
    v_mfma_f32_16x16x32_bf16 v[16:19], v[80:83], v[106:109], v[16:19]
    v_mfma_f32_16x16x32_bf16 v[20:23], v[78:81], v[106:109], v[20:23]
    v_mfma_f32_16x16x32_bf16 v[8:11], v[80:83], v[110:113], v[8:11]
    v_mfma_f32_16x16x32_bf16 v[12:15], v[78:81], v[110:113], v[12:15]
    s_barrier
    v_mfma_f32_16x16x32_bf16 v[16:19], v[80:83], v[114:117], v[16:19]
    buffer_load_dwordx4 v1, s[8:11], s33 offen offset:1024 sc1 lds
    v_mfma_f32_16x16x32_bf16 v[20:23], v[78:81], v[114:117], v[20:23]
    v_mfma_f32_16x16x32_bf16 v[8:11], v[80:83], v[118:121], v[8:11]
    ds_read_b128 v[40:43], v3 offset:0
    s_waitcnt vmcnt(11)
    v_mfma_f32_16x16x32_bf16 v[12:15], v[78:81], v[118:121], v[12:15]
    buffer_store_dword v6, v64, s[12:15], s17 offen sc1
    v_mfma_f32_16x16x32_bf16 v[16:19], v[80:83], v[122:125], v[16:19]
    buffer_load_dwordx4 v1, s[8:11], s33 offen offset:2048 sc1 lds
    v_mfma_f32_16x16x32_bf16 v[20:23], v[78:81], v[122:125], v[20:23]
    s_cmp_lt_i32 s31, 32
    s_cselect_b32 s14, s6, 0
    s_cselect_b32 s26, 0, 0x400000
    v_mfma_f32_16x16x32_bf16 v[8:11], v[80:83], v[126:129], v[8:11]
    ds_read_b128 v[44:47], v3 offset:1024
    s_add_u32 s17, s17, 8192
    v_mfma_f32_16x16x32_bf16 v[12:15], v[78:81], v[126:129], v[12:15]
    v_mfma_f32_16x16x32_bf16 v[16:19], v[80:83], v[130:133], v[16:19]
    buffer_load_dwordx4 v1, s[8:11], s33 offen offset:3072 sc1 lds
    v_mfma_f32_16x16x32_bf16 v[20:23], v[78:81], v[130:133], v[20:23]
    v_mfma_f32_16x16x32_bf16 v[8:11], v[80:83], v[134:137], v[8:11]
    ds_read_b128 v[48:51], v3 offset:2048
    v_mfma_f32_16x16x32_bf16 v[12:15], v[78:81], v[134:137], v[12:15]
    v_mfma_f32_16x16x32_bf16 v[16:19], v[80:83], v[138:141], v[16:19]
    v_mfma_f32_16x16x32_bf16 v[20:23], v[78:81], v[138:141], v[20:23]
Lred_body1:
    s_waitcnt lgkmcnt(2)
    v_mfma_f32_16x16x32_bf16 v[24:27], a[0:3], v[40:43], v[84:87]
    ds_read_b128 v[52:55], v3 offset:3072
    s_add_u32 s16, s16, 8192
    v_mfma_f32_16x16x32_bf16 v[28:31], a[4:7], v[40:43], v[88:91]
    s_cmp_eq_u32 s10, 0
    s_cbranch_scc1 Lred_slow1
    v_mfma_f32_16x16x32_bf16 v[32:35], a[8:11], v[40:43], v[92:95]
    buffer_load_dword v5, v4, s[4:7], s16 offen sc1
    v_mfma_f32_16x16x32_bf16 v[36:39], a[12:15], v[40:43], v[96:99]
    s_waitcnt lgkmcnt(2)
    v_cvt_pk_bf16_f32 v56, v8, v9
    v_cvt_pk_bf16_f32 v57, v10, v11
    v_mfma_f32_16x16x32_bf16 v[24:27], a[16:19], v[44:47], v[24:27]
    ds_read_b128 v[40:43], v3 offset:4096
    v_cvt_pk_bf16_f32 v58, v12, v13
    v_mfma_f32_16x16x32_bf16 v[28:31], a[20:23], v[44:47], v[28:31]
    s_add_u32 s31, s31, 1
    v_mov_b32 v6, s31
    v_cvt_pk_bf16_f32 v59, v14, v15
    v_mfma_f32_16x16x32_bf16 v[32:35], a[24:27], v[44:47], v[32:35]
    buffer_store_dwordx4 v[56:59], v1, s[12:15], s36 offen offset:0 sc1
    v_cvt_pk_bf16_f32 v60, v16, v17
    v_mfma_f32_16x16x32_bf16 v[36:39], a[28:31], v[44:47], v[36:39]
    s_waitcnt lgkmcnt(2)
    v_cvt_pk_bf16_f32 v61, v18, v19
    v_cvt_pk_bf16_f32 v62, v20, v21
    v_mfma_f32_16x16x32_bf16 v[24:27], a[32:35], v[48:51], v[24:27]
    ds_read_b128 v[44:47], v3 offset:5120
    v_cvt_pk_bf16_f32 v63, v22, v23
    v_mfma_f32_16x16x32_bf16 v[28:31], a[36:39], v[48:51], v[28:31]
    s_add_u32 s35, s35, 36864
    s_cmp_eq_u32 s35, 147456
    s_cselect_b32 s35, 0, s35
    v_mfma_f32_16x16x32_bf16 v[32:35], a[40:43], v[48:51], v[32:35]
    buffer_store_dwordx4 v[60:63], v1, s[12:15], s36 offen offset:1024 sc1
    v_add_u32 v2, s35, v1
    v_mfma_f32_16x16x32_bf16 v[70:73], v[56:59], v[56:59], 0
    v_mfma_f32_16x16x32_bf16 v[66:69], v[74:77], v[56:59], 0
    v_mfma_f32_16x16x32_bf16 v[70:73], v[60:63], v[60:63], v[70:73]
    v_mfma_f32_16x16x32_bf16 v[66:69], v[74:77], v[60:63], v[66:69]
    buffer_load_dwordx4 v[102:105], v1, s[8:11], s40 offen offset:0 sc1
    v_mfma_f32_16x16x32_bf16 v[36:39], a[44:47], v[48:51], v[36:39]
    s_waitcnt lgkmcnt(2)
    v_permlane16_swap_b32 v56, v58
    v_mfma_f32_16x16x32_bf16 v[24:27], a[48:51], v[52:55], v[24:27]
    ds_read_b128 v[48:51], v3 offset:6144
    v_mfma_f32_16x16x32_bf16 v[28:31], a[52:55], v[52:55], v[28:31]
    v_permlane16_swap_b32 v57, v59
    v_mfma_f32_16x16x32_bf16 v[32:35], a[56:59], v[52:55], v[32:35]
    buffer_store_dwordx4 v[56:59], v100, s[24:27], s42 offen offset:0
    v_mfma_f32_16x16x32_bf16 v[36:39], a[60:63], v[52:55], v[36:39]
    s_waitcnt lgkmcnt(2)
    v_permlane16_swap_b32 v60, v62
    v_mfma_f32_16x16x32_bf16 v[24:27], a[64:67], v[40:43], v[24:27]
    ds_read_b128 v[52:55], v3 offset:7168
    v_mfma_f32_16x16x32_bf16 v[28:31], a[68:71], v[40:43], v[28:31]
    v_permlane16_swap_b32 v61, v63
    v_mfma_f32_16x16x32_bf16 v[32:35], a[72:75], v[40:43], v[32:35]
    buffer_store_dwordx4 v[60:63], v100, s[24:27], s42 offen offset:64
    v_cndmask_b32 v70, v70, v71, s[44:45]
    v_mfma_f32_16x16x32_bf16 v[36:39], a[76:79], v[40:43], v[36:39]
    s_waitcnt lgkmcnt(2)
    v_cndmask_b32 v72, v72, v73, s[44:45]
    v_cndmask_b32 v67, v70, v72, s[46:47]
    v_mfma_f32_16x16x32_bf16 v[24:27], a[80:83], v[44:47], v[24:27]
    ds_read_b128 v[40:43], v3 offset:8192
    v_mfma_f32_16x16x32_bf16 v[28:31], a[84:87], v[44:47], v[28:31]
    v_mfma_f32_16x16x32_bf16 v[32:35], a[88:91], v[44:47], v[32:35]
    buffer_store_dwordx2 v[66:67], v7, s[12:15], s36 offen offset:0 sc1
    s_add_u32 s36, s36, 34816
    v_mfma_f32_16x16x32_bf16 v[36:39], a[92:95], v[44:47], v[36:39]
    s_waitcnt lgkmcnt(2)
    s_sub_u32 s42, s42, 32768
    v_mfma_f32_16x16x32_bf16 v[24:27], a[96:99], v[48:51], v[24:27]
    ds_read_b128 v[44:47], v3 offset:9216
    v_mfma_f32_16x16x32_bf16 v[28:31], a[100:103], v[48:51], v[28:31]
    v_mfma_f32_16x16x32_bf16 v[32:35], a[104:107], v[48:51], v[32:35]
    buffer_load_dwordx4 v[106:109], v1, s[8:11], s40 offen offset:1024 sc1
    v_mfma_f32_16x16x32_bf16 v[36:39], a[108:111], v[48:51], v[36:39]
    s_waitcnt lgkmcnt(2)
    s_add_u32 s37, s40, 32768
    v_mfma_f32_16x16x32_bf16 v[24:27], a[112:115], v[52:55], v[24:27]
    ds_read_b128 v[48:51], v3 offset:10240
    v_mfma_f32_16x16x32_bf16 v[28:31], a[116:119], v[52:55], v[28:31]
    v_mfma_f32_16x16x32_bf16 v[32:35], a[120:123], v[52:55], v[32:35]
    buffer_load_dwordx4 v[110:113], v1, s[8:11], s37 offen offset:0 sc1
    v_mfma_f32_16x16x32_bf16 v[36:39], a[124:127], v[52:55], v[36:39]
    s_waitcnt lgkmcnt(2)
    v_mfma_f32_16x16x32_bf16 v[24:27], a[128:131], v[40:43], v[24:27]
    ds_read_b128 v[52:55], v3 offset:11264
    v_mfma_f32_16x16x32_bf16 v[28:31], a[132:135], v[40:43], v[28:31]
    v_mfma_f32_16x16x32_bf16 v[32:35], a[136:139], v[40:43], v[32:35]
    buffer_load_dwordx4 v[114:117], v1, s[8:11], s37 offen offset:1024 sc1
    v_mfma_f32_16x16x32_bf16 v[36:39], a[140:143], v[40:43], v[36:39]
    s_waitcnt lgkmcnt(2)
    s_add_u32 s37, s40, 65536
    v_mfma_f32_16x16x32_bf16 v[24:27], a[144:147], v[44:47], v[24:27]
    ds_read_b128 v[40:43], v3 offset:12288
    v_mfma_f32_16x16x32_bf16 v[28:31], a[148:151], v[44:47], v[28:31]
    v_mfma_f32_16x16x32_bf16 v[32:35], a[152:155], v[44:47], v[32:35]
    buffer_load_dwordx4 v[118:121], v1, s[8:11], s37 offen offset:0 sc1
    v_mfma_f32_16x16x32_bf16 v[36:39], a[156:159], v[44:47], v[36:39]
    s_waitcnt lgkmcnt(2)
    v_mfma_f32_16x16x32_bf16 v[24:27], a[160:163], v[48:51], v[24:27]
    ds_read_b128 v[44:47], v3 offset:13312
    v_mfma_f32_16x16x32_bf16 v[28:31], a[164:167], v[48:51], v[28:31]
    v_mfma_f32_16x16x32_bf16 v[32:35], a[168:171], v[48:51], v[32:35]
    buffer_load_dwordx4 v[122:125], v1, s[8:11], s37 offen offset:1024 sc1
    v_mfma_f32_16x16x32_bf16 v[36:39], a[172:175], v[48:51], v[36:39]
    s_waitcnt lgkmcnt(2)
    s_add_u32 s37, s40, 98304
    v_mfma_f32_16x16x32_bf16 v[24:27], a[176:179], v[52:55], v[24:27]
    ds_read_b128 v[48:51], v3 offset:14336
    v_mfma_f32_16x16x32_bf16 v[28:31], a[180:183], v[52:55], v[28:31]
    v_mfma_f32_16x16x32_bf16 v[32:35], a[184:187], v[52:55], v[32:35]
    buffer_load_dwordx4 v[126:129], v1, s[8:11], s37 offen offset:0 sc1
    v_mfma_f32_16x16x32_bf16 v[36:39], a[188:191], v[52:55], v[36:39]
    s_waitcnt lgkmcnt(2)
    v_mfma_f32_16x16x32_bf16 v[24:27], a[192:195], v[40:43], v[24:27]
    ds_read_b128 v[52:55], v3 offset:15360
    v_mfma_f32_16x16x32_bf16 v[28:31], a[196:199], v[40:43], v[28:31]
    v_mfma_f32_16x16x32_bf16 v[32:35], a[200:203], v[40:43], v[32:35]
    buffer_load_dwordx4 v[130:133], v1, s[8:11], s37 offen offset:1024 sc1
    v_mfma_f32_16x16x32_bf16 v[36:39], a[204:207], v[40:43], v[36:39]
    s_waitcnt lgkmcnt(2)
    v_mfma_f32_16x16x32_bf16 v[24:27], a[208:211], v[44:47], v[24:27]
    v_mfma_f32_16x16x32_bf16 v[28:31], a[212:215], v[44:47], v[28:31]
    v_mfma_f32_16x16x32_bf16 v[32:35], a[216:219], v[44:47], v[32:35]
    buffer_load_dwordx4 v[134:137], v1, s[8:11], s41 offen offset:0 sc1
    v_mfma_f32_16x16x32_bf16 v[36:39], a[220:223], v[44:47], v[36:39]
    s_waitcnt lgkmcnt(1)
    v_mfma_f32_16x16x32_bf16 v[24:27], a[224:227], v[48:51], v[24:27]
    v_mfma_f32_16x16x32_bf16 v[28:31], a[228:231], v[48:51], v[28:31]
    v_mfma_f32_16x16x32_bf16 v[32:35], a[232:235], v[48:51], v[32:35]
    buffer_load_dwordx4 v[138:141], v1, s[8:11], s41 offen offset:1024 sc1
    v_mfma_f32_16x16x32_bf16 v[36:39], a[236:239], v[48:51], v[36:39]
    s_waitcnt lgkmcnt(0)
    s_add_u32 s32, s32, 1
    s_add_u32 s33, s33, 116736
    v_mfma_f32_16x16x32_bf16 v[24:27], a[240:243], v[52:55], v[24:27]
    s_add_u32 s34, s34, 36864
    s_cmp_ge_u32 s34, 147456
    s_cselect_b32 s38, 147456, 0
    v_mfma_f32_16x16x32_bf16 v[28:31], a[244:247], v[52:55], v[28:31]
    s_sub_u32 s34, s34, s38
    s_add_u32 s40, s40, 131072
    s_add_u32 s41, s41, 36864
    v_mfma_f32_16x16x32_bf16 v[32:35], a[248:251], v[52:55], v[32:35]
    s_waitcnt vmcnt(15)
    v_cmp_gt_i32 vcc, s32, v5
    v_mfma_f32_16x16x32_bf16 v[36:39], a[252:255], v[52:55], v[36:39]
    v_mfma_f32_16x16x32_bf16 v[24:27], v[80:83], v[142:145], v[24:27]
    s_and_b64 vcc, vcc, s[18:19]
    s_cselect_b32 s10, 0, s6
    s_add_u32 m0, s34, 0
    v_mfma_f32_16x16x32_bf16 v[28:31], v[78:81], v[142:145], v[28:31]
    buffer_load_dwordx4 v1, s[8:11], s33 offen offset:0 sc1 lds
    v_mfma_f32_16x16x32_bf16 v[32:35], v[80:83], v[146:149], v[32:35]
    v_mfma_f32_16x16x32_bf16 v[36:39], v[78:81], v[146:149], v[36:39]
    v_mfma_f32_16x16x32_bf16 v[24:27], v[80:83], v[150:153], v[24:27]
    v_mfma_f32_16x16x32_bf16 v[28:31], v[78:81], v[150:153], v[28:31]
    s_barrier
    v_mfma_f32_16x16x32_bf16 v[32:35], v[80:83], v[154:157], v[32:35]
    buffer_load_dwordx4 v1, s[8:11], s33 offen offset:1024 sc1 lds
    v_mfma_f32_16x16x32_bf16 v[36:39], v[78:81], v[154:157], v[36:39]
    v_mfma_f32_16x16x32_bf16 v[24:27], v[80:83], v[158:161], v[24:27]
    ds_read_b128 v[40:43], v2 offset:0
    s_waitcnt vmcnt(11)
    v_mfma_f32_16x16x32_bf16 v[28:31], v[78:81], v[158:161], v[28:31]
    buffer_store_dword v6, v64, s[12:15], s17 offen sc1
    v_mfma_f32_16x16x32_bf16 v[32:35], v[80:83], v[162:165], v[32:35]
    buffer_load_dwordx4 v1, s[8:11], s33 offen offset:2048 sc1 lds
    v_mfma_f32_16x16x32_bf16 v[36:39], v[78:81], v[162:165], v[36:39]
    s_cmp_lt_i32 s31, 32
    s_cselect_b32 s14, s6, 0
    s_cselect_b32 s26, 0, 0x400000
    v_mfma_f32_16x16x32_bf16 v[24:27], v[80:83], v[166:169], v[24:27]
    ds_read_b128 v[44:47], v2 offset:1024
    s_add_u32 s17, s17, 8192
    v_mfma_f32_16x16x32_bf16 v[28:31], v[78:81], v[166:169], v[28:31]
    v_mfma_f32_16x16x32_bf16 v[32:35], v[80:83], v[170:173], v[32:35]
    buffer_load_dwordx4 v1, s[8:11], s33 offen offset:3072 sc1 lds
    v_mfma_f32_16x16x32_bf16 v[36:39], v[78:81], v[170:173], v[36:39]
    v_mfma_f32_16x16x32_bf16 v[24:27], v[80:83], v[174:177], v[24:27]
    ds_read_b128 v[48:51], v2 offset:2048
    v_mfma_f32_16x16x32_bf16 v[28:31], v[78:81], v[174:177], v[28:31]
    v_mfma_f32_16x16x32_bf16 v[32:35], v[80:83], v[178:181], v[32:35]
    v_mfma_f32_16x16x32_bf16 v[36:39], v[78:81], v[178:181], v[36:39]
Lred_back:
    s_cmp_lt_i32 s31, 63
    s_cbranch_scc1 Lred_body0
    s_branch L_exit
Lred_slow0:
    s_sub_u32 s39, s16, 8192
    v_mfma_f32_16x16x32_bf16 v[16:19], a[8:11], v[40:43], v[92:95]
    buffer_load_dword v65, v4, s[4:7], s39 offen sc1
    v_mfma_f32_16x16x32_bf16 v[20:23], a[12:15], v[40:43], v[96:99]
    s_waitcnt lgkmcnt(2)
    v_cvt_pk_bf16_f32 v56, v24, v25
    v_cvt_pk_bf16_f32 v57, v26, v27
    v_mfma_f32_16x16x32_bf16 v[8:11], a[16:19], v[44:47], v[8:11]
    ds_read_b128 v[40:43], v2 offset:4096
    v_cvt_pk_bf16_f32 v58, v28, v29
    v_mfma_f32_16x16x32_bf16 v[12:15], a[20:23], v[44:47], v[12:15]
    s_add_u32 s31, s31, 1
    v_mov_b32 v6, s31
    v_cvt_pk_bf16_f32 v59, v30, v31
    v_mfma_f32_16x16x32_bf16 v[16:19], a[24:27], v[44:47], v[16:19]
    buffer_store_dwordx4 v[56:59], v1, s[12:15], s36 offen offset:0 sc1
    v_cvt_pk_bf16_f32 v60, v32, v33
    v_mfma_f32_16x16x32_bf16 v[20:23], a[28:31], v[44:47], v[20:23]
    s_waitcnt lgkmcnt(2)
    v_cvt_pk_bf16_f32 v61, v34, v35
    v_cvt_pk_bf16_f32 v62, v36, v37
    v_mfma_f32_16x16x32_bf16 v[8:11], a[32:35], v[48:51], v[8:11]
    ds_read_b128 v[44:47], v2 offset:5120
    v_cvt_pk_bf16_f32 v63, v38, v39
    v_mfma_f32_16x16x32_bf16 v[12:15], a[36:39], v[48:51], v[12:15]
    s_add_u32 s35, s35, 36864
    s_cmp_eq_u32 s35, 147456
    s_cselect_b32 s35, 0, s35
    v_mfma_f32_16x16x32_bf16 v[16:19], a[40:43], v[48:51], v[16:19]
    buffer_store_dwordx4 v[60:63], v1, s[12:15], s36 offen offset:1024 sc1
    v_add_u32 v3, s35, v1
    v_mfma_f32_16x16x32_bf16 v[70:73], v[56:59], v[56:59], 0
    v_mfma_f32_16x16x32_bf16 v[66:69], v[74:77], v[56:59], 0
    v_mfma_f32_16x16x32_bf16 v[70:73], v[60:63], v[60:63], v[70:73]
    v_mfma_f32_16x16x32_bf16 v[66:69], v[74:77], v[60:63], v[66:69]
    v_permlane16_swap_b32 v56, v58
    v_mfma_f32_16x16x32_bf16 v[20:23], a[44:47], v[48:51], v[20:23]
    s_waitcnt lgkmcnt(2)
    v_permlane16_swap_b32 v57, v59
    v_mfma_f32_16x16x32_bf16 v[8:11], a[48:51], v[52:55], v[8:11]
    ds_read_b128 v[48:51], v2 offset:6144
    v_mfma_f32_16x16x32_bf16 v[12:15], a[52:55], v[52:55], v[12:15]
    buffer_store_dwordx4 v[56:59], v100, s[24:27], s42 offen offset:0
    v_mfma_f32_16x16x32_bf16 v[16:19], a[56:59], v[52:55], v[16:19]
    v_permlane16_swap_b32 v60, v62
    v_mfma_f32_16x16x32_bf16 v[20:23], a[60:63], v[52:55], v[20:23]
    s_waitcnt lgkmcnt(2)
    v_permlane16_swap_b32 v61, v63
    v_mfma_f32_16x16x32_bf16 v[8:11], a[64:67], v[40:43], v[8:11]
    ds_read_b128 v[52:55], v2 offset:7168
    v_mfma_f32_16x16x32_bf16 v[12:15], a[68:71], v[40:43], v[12:15]
    buffer_store_dwordx4 v[60:63], v100, s[24:27], s42 offen offset:64
    v_cndmask_b32 v70, v70, v71, s[44:45]
    v_mfma_f32_16x16x32_bf16 v[16:19], a[72:75], v[40:43], v[16:19]
    v_cndmask_b32 v72, v72, v73, s[44:45]
    v_cndmask_b32 v67, v70, v72, s[46:47]
    v_mfma_f32_16x16x32_bf16 v[20:23], a[76:79], v[40:43], v[20:23]
    s_waitcnt lgkmcnt(2)
    v_mfma_f32_16x16x32_bf16 v[8:11], a[80:83], v[44:47], v[8:11]
    ds_read_b128 v[40:43], v2 offset:8192
    v_mfma_f32_16x16x32_bf16 v[12:15], a[84:87], v[44:47], v[12:15]
    buffer_store_dwordx2 v[66:67], v7, s[12:15], s36 offen offset:0 sc1
    s_add_u32 s36, s36, 34816
    v_mfma_f32_16x16x32_bf16 v[16:19], a[88:91], v[44:47], v[16:19]
    s_sub_u32 s42, s42, 32768
    v_mfma_f32_16x16x32_bf16 v[20:23], a[92:95], v[44:47], v[20:23]
    s_waitcnt lgkmcnt(2)
    v_mfma_f32_16x16x32_bf16 v[8:11], a[96:99], v[48:51], v[8:11]
    ds_read_b128 v[44:47], v2 offset:9216
    v_mfma_f32_16x16x32_bf16 v[12:15], a[100:103], v[48:51], v[12:15]
    v_mfma_f32_16x16x32_bf16 v[16:19], a[104:107], v[48:51], v[16:19]
    v_mfma_f32_16x16x32_bf16 v[20:23], a[108:111], v[48:51], v[20:23]
    s_waitcnt lgkmcnt(2)
    v_mfma_f32_16x16x32_bf16 v[8:11], a[112:115], v[52:55], v[8:11]
    ds_read_b128 v[48:51], v2 offset:10240
    s_waitcnt vmcnt(5)
    v_mfma_f32_16x16x32_bf16 v[12:15], a[116:119], v[52:55], v[12:15]
    v_cmp_gt_i32 vcc, s32, v65
    v_mfma_f32_16x16x32_bf16 v[16:19], a[120:123], v[52:55], v[16:19]
    v_mfma_f32_16x16x32_bf16 v[20:23], a[124:127], v[52:55], v[20:23]
    s_waitcnt lgkmcnt(2)
    s_and_b64 vcc, vcc, s[18:19]
    s_cselect_b32 s10, 0, s6
    v_mfma_f32_16x16x32_bf16 v[8:11], a[128:131], v[40:43], v[8:11]
    ds_read_b128 v[52:55], v2 offset:11264
    v_mfma_f32_16x16x32_bf16 v[12:15], a[132:135], v[40:43], v[12:15]
    s_cmp_eq_u32 s10, 0
    s_cbranch_scc1 Lred_slowc0
    v_mfma_f32_16x16x32_bf16 v[16:19], a[136:139], v[40:43], v[16:19]
    buffer_load_dword v5, v4, s[4:7], s16 offen sc1
    v_mfma_f32_16x16x32_bf16 v[20:23], a[140:143], v[40:43], v[20:23]
    s_waitcnt lgkmcnt(2)
    s_add_u32 m0, s34, 0
    v_mfma_f32_16x16x32_bf16 v[8:11], a[144:147], v[44:47], v[8:11]
    ds_read_b128 v[40:43], v2 offset:12288
    v_mfma_f32_16x16x32_bf16 v[12:15], a[148:151], v[44:47], v[12:15]
    v_mfma_f32_16x16x32_bf16 v[16:19], a[152:155], v[44:47], v[16:19]
    buffer_load_dwordx4 v1, s[8:11], s33 offen offset:0 sc1 lds
    v_mfma_f32_16x16x32_bf16 v[20:23], a[156:159], v[44:47], v[20:23]
    s_waitcnt lgkmcnt(2)
    v_mfma_f32_16x16x32_bf16 v[8:11], a[160:163], v[48:51], v[8:11]
    ds_read_b128 v[44:47], v2 offset:13312
    v_mfma_f32_16x16x32_bf16 v[12:15], a[164:167], v[48:51], v[12:15]
    v_mfma_f32_16x16x32_bf16 v[16:19], a[168:171], v[48:51], v[16:19]
    buffer_load_dwordx4 v1, s[8:11], s33 offen offset:1024 sc1 lds
    v_mfma_f32_16x16x32_bf16 v[20:23], a[172:175], v[48:51], v[20:23]
    s_waitcnt lgkmcnt(2)
    v_mfma_f32_16x16x32_bf16 v[8:11], a[176:179], v[52:55], v[8:11]
    ds_read_b128 v[48:51], v2 offset:14336
    v_mfma_f32_16x16x32_bf16 v[12:15], a[180:183], v[52:55], v[12:15]
    v_mfma_f32_16x16x32_bf16 v[16:19], a[184:187], v[52:55], v[16:19]
    buffer_load_dwordx4 v1, s[8:11], s33 offen offset:2048 sc1 lds
    v_mfma_f32_16x16x32_bf16 v[20:23], a[188:191], v[52:55], v[20:23]
    s_waitcnt lgkmcnt(2)
    v_mfma_f32_16x16x32_bf16 v[8:11], a[192:195], v[40:43], v[8:11]
    ds_read_b128 v[52:55], v2 offset:15360
    v_mfma_f32_16x16x32_bf16 v[12:15], a[196:199], v[40:43], v[12:15]
    v_mfma_f32_16x16x32_bf16 v[16:19], a[200:203], v[40:43], v[16:19]
    buffer_load_dwordx4 v1, s[8:11], s33 offen offset:3072 sc1 lds
    v_mfma_f32_16x16x32_bf16 v[20:23], a[204:207], v[40:43], v[20:23]
    s_waitcnt lgkmcnt(2)
    v_mfma_f32_16x16x32_bf16 v[8:11], a[208:211], v[44:47], v[8:11]
    v_mfma_f32_16x16x32_bf16 v[12:15], a[212:215], v[44:47], v[12:15]
    v_mfma_f32_16x16x32_bf16 v[16:19], a[216:219], v[44:47], v[16:19]
    buffer_load_dwordx4 v[142:145], v1, s[8:11], s40 offen offset:0 sc1
    v_mfma_f32_16x16x32_bf16 v[20:23], a[220:223], v[44:47], v[20:23]
    s_waitcnt lgkmcnt(1)
    v_mfma_f32_16x16x32_bf16 v[8:11], a[224:227], v[48:51], v[8:11]
    v_mfma_f32_16x16x32_bf16 v[12:15], a[228:231], v[48:51], v[12:15]
    v_mfma_f32_16x16x32_bf16 v[16:19], a[232:235], v[48:51], v[16:19]
    buffer_load_dwordx4 v[146:149], v1, s[8:11], s40 offen offset:1024 sc1
    v_mfma_f32_16x16x32_bf16 v[20:23], a[236:239], v[48:51], v[20:23]
    s_waitcnt lgkmcnt(0)
    s_add_u32 s37, s40, 32768
    v_mfma_f32_16x16x32_bf16 v[8:11], a[240:243], v[52:55], v[8:11]
    v_mfma_f32_16x16x32_bf16 v[12:15], a[244:247], v[52:55], v[12:15]
    v_mfma_f32_16x16x32_bf16 v[16:19], a[248:251], v[52:55], v[16:19]
    buffer_load_dwordx4 v[150:153], v1, s[8:11], s37 offen offset:0 sc1
    v_mfma_f32_16x16x32_bf16 v[20:23], a[252:255], v[52:55], v[20:23]
    v_mfma_f32_16x16x32_bf16 v[8:11], v[80:83], v[102:105], v[8:11]
    v_mfma_f32_16x16x32_bf16 v[12:15], v[78:81], v[102:105], v[12:15]
    v_mfma_f32_16x16x32_bf16 v[16:19], v[80:83], v[106:109], v[16:19]
    buffer_load_dwordx4 v[154:157], v1, s[8:11], s37 offen offset:1024 sc1
    v_mfma_f32_16x16x32_bf16 v[20:23], v[78:81], v[106:109], v[20:23]
    s_add_u32 s37, s40, 65536
    v_mfma_f32_16x16x32_bf16 v[8:11], v[80:83], v[110:113], v[8:11]
    v_mfma_f32_16x16x32_bf16 v[12:15], v[78:81], v[110:113], v[12:15]
    s_waitcnt vmcnt(4)
    s_barrier
    v_mfma_f32_16x16x32_bf16 v[16:19], v[80:83], v[114:117], v[16:19]
    buffer_load_dwordx4 v[158:161], v1, s[8:11], s37 offen offset:0 sc1
    v_mfma_f32_16x16x32_bf16 v[20:23], v[78:81], v[114:117], v[20:23]
    v_mfma_f32_16x16x32_bf16 v[8:11], v[80:83], v[118:121], v[8:11]
    ds_read_b128 v[40:43], v3 offset:0
    v_mfma_f32_16x16x32_bf16 v[12:15], v[78:81], v[118:121], v[12:15]
    buffer_store_dword v6, v64, s[12:15], s17 offen sc1
    v_mfma_f32_16x16x32_bf16 v[16:19], v[80:83], v[122:125], v[16:19]
    buffer_load_dwordx4 v[162:165], v1, s[8:11], s37 offen offset:1024 sc1
    v_mfma_f32_16x16x32_bf16 v[20:23], v[78:81], v[122:125], v[20:23]
    s_add_u32 s37, s40, 98304
    v_mfma_f32_16x16x32_bf16 v[8:11], v[80:83], v[126:129], v[8:11]
    ds_read_b128 v[44:47], v3 offset:1024
    v_mfma_f32_16x16x32_bf16 v[12:15], v[78:81], v[126:129], v[12:15]
    s_cmp_lt_i32 s31, 32
    s_cselect_b32 s14, s6, 0
    s_cselect_b32 s26, 0, 0x400000
    v_mfma_f32_16x16x32_bf16 v[16:19], v[80:83], v[130:133], v[16:19]
    buffer_load_dwordx4 v[166:169], v1, s[8:11], s37 offen offset:0 sc1
    v_mfma_f32_16x16x32_bf16 v[20:23], v[78:81], v[130:133], v[20:23]
    s_add_u32 s17, s17, 8192
    v_mfma_f32_16x16x32_bf16 v[8:11], v[80:83], v[134:137], v[8:11]
    ds_read_b128 v[48:51], v3 offset:2048
    v_mfma_f32_16x16x32_bf16 v[12:15], v[78:81], v[134:137], v[12:15]
    v_mfma_f32_16x16x32_bf16 v[16:19], v[80:83], v[138:141], v[16:19]
    buffer_load_dwordx4 v[170:173], v1, s[8:11], s37 offen offset:1024 sc1
    v_mfma_f32_16x16x32_bf16 v[20:23], v[78:81], v[138:141], v[20:23]
    buffer_load_dwordx4 v[174:177], v1, s[8:11], s41 offen offset:0 sc1
    buffer_load_dwordx4 v[178:181], v1, s[8:11], s41 offen offset:1024 sc1
    s_add_u32 s32, s32, 1
    s_add_u32 s33, s33, 116736
    s_add_u32 s34, s34, 36864
    s_cmp_ge_u32 s34, 147456
    s_cselect_b32 s38, 147456, 0
    s_sub_u32 s34, s34, s38
    s_add_u32 s40, s40, 131072
    s_add_u32 s41, s41, 36864
    v_cmp_gt_i32 vcc, s32, v5
    s_nop 0
    s_and_b64 vcc, vcc, s[18:19]
    s_cselect_b32 s10, 0, s6
    s_add_u32 m0, s34, 0
    s_nop 0
    buffer_load_dwordx4 v1, s[8:11], s33 offen offset:0 sc1 lds
    buffer_load_dwordx4 v1, s[8:11], s33 offen offset:1024 sc1 lds
    buffer_load_dwordx4 v1, s[8:11], s33 offen offset:2048 sc1 lds
    buffer_load_dwordx4 v1, s[8:11], s33 offen offset:3072 sc1 lds
    s_nop 1
    s_branch Lred_body1
Lred_slowc0:
    v_mfma_f32_16x16x32_bf16 v[16:19], a[136:139], v[40:43], v[16:19]
    v_mfma_f32_16x16x32_bf16 v[20:23], a[140:143], v[40:43], v[20:23]
    s_waitcnt lgkmcnt(2)
    v_mfma_f32_16x16x32_bf16 v[8:11], a[144:147], v[44:47], v[8:11]
    ds_read_b128 v[40:43], v2 offset:12288
    v_mfma_f32_16x16x32_bf16 v[12:15], a[148:151], v[44:47], v[12:15]
    v_mfma_f32_16x16x32_bf16 v[16:19], a[152:155], v[44:47], v[16:19]
    v_mfma_f32_16x16x32_bf16 v[20:23], a[156:159], v[44:47], v[20:23]
    s_waitcnt lgkmcnt(2)
    v_mfma_f32_16x16x32_bf16 v[8:11], a[160:163], v[48:51], v[8:11]
    ds_read_b128 v[44:47], v2 offset:13312
    v_mfma_f32_16x16x32_bf16 v[12:15], a[164:167], v[48:51], v[12:15]
    v_mfma_f32_16x16x32_bf16 v[16:19], a[168:171], v[48:51], v[16:19]
    v_mfma_f32_16x16x32_bf16 v[20:23], a[172:175], v[48:51], v[20:23]
    s_waitcnt lgkmcnt(2)
    v_mfma_f32_16x16x32_bf16 v[8:11], a[176:179], v[52:55], v[8:11]
    ds_read_b128 v[48:51], v2 offset:14336
    v_mfma_f32_16x16x32_bf16 v[12:15], a[180:183], v[52:55], v[12:15]
    v_mfma_f32_16x16x32_bf16 v[16:19], a[184:187], v[52:55], v[16:19]
    v_mfma_f32_16x16x32_bf16 v[20:23], a[188:191], v[52:55], v[20:23]
    s_waitcnt lgkmcnt(2)
    v_mfma_f32_16x16x32_bf16 v[8:11], a[192:195], v[40:43], v[8:11]
    ds_read_b128 v[52:55], v2 offset:15360
    v_mfma_f32_16x16x32_bf16 v[12:15], a[196:199], v[40:43], v[12:15]
    v_mfma_f32_16x16x32_bf16 v[16:19], a[200:203], v[40:43], v[16:19]
    v_mfma_f32_16x16x32_bf16 v[20:23], a[204:207], v[40:43], v[20:23]
    s_waitcnt lgkmcnt(2)
    v_mfma_f32_16x16x32_bf16 v[8:11], a[208:211], v[44:47], v[8:11]
    v_mfma_f32_16x16x32_bf16 v[12:15], a[212:215], v[44:47], v[12:15]
    v_mfma_f32_16x16x32_bf16 v[16:19], a[216:219], v[44:47], v[16:19]
    v_mfma_f32_16x16x32_bf16 v[20:23], a[220:223], v[44:47], v[20:23]
    s_waitcnt lgkmcnt(1)
    v_mfma_f32_16x16x32_bf16 v[8:11], a[224:227], v[48:51], v[8:11]
    v_mfma_f32_16x16x32_bf16 v[12:15], a[228:231], v[48:51], v[12:15]
    v_mfma_f32_16x16x32_bf16 v[16:19], a[232:235], v[48:51], v[16:19]
    v_mfma_f32_16x16x32_bf16 v[20:23], a[236:239], v[48:51], v[20:23]
    s_waitcnt lgkmcnt(0)
    v_mfma_f32_16x16x32_bf16 v[8:11], a[240:243], v[52:55], v[8:11]
    v_mfma_f32_16x16x32_bf16 v[12:15], a[244:247], v[52:55], v[12:15]
    v_mfma_f32_16x16x32_bf16 v[16:19], a[248:251], v[52:55], v[16:19]
    v_mfma_f32_16x16x32_bf16 v[20:23], a[252:255], v[52:55], v[20:23]
    v_mfma_f32_16x16x32_bf16 v[8:11], v[80:83], v[102:105], v[8:11]
    v_mfma_f32_16x16x32_bf16 v[12:15], v[78:81], v[102:105], v[12:15]
    v_mfma_f32_16x16x32_bf16 v[16:19], v[80:83], v[106:109], v[16:19]
    v_mfma_f32_16x16x32_bf16 v[20:23], v[78:81], v[106:109], v[20:23]
    v_mfma_f32_16x16x32_bf16 v[8:11], v[80:83], v[110:113], v[8:11]
    v_mfma_f32_16x16x32_bf16 v[12:15], v[78:81], v[110:113], v[12:15]
    v_mfma_f32_16x16x32_bf16 v[16:19], v[80:83], v[114:117], v[16:19]
    v_mfma_f32_16x16x32_bf16 v[20:23], v[78:81], v[114:117], v[20:23]
    v_mfma_f32_16x16x32_bf16 v[8:11], v[80:83], v[118:121], v[8:11]
    s_waitcnt vmcnt(0)
    buffer_store_dword v6, v64, s[12:15], s17 offen sc1
    v_mfma_f32_16x16x32_bf16 v[12:15], v[78:81], v[118:121], v[12:15]
    s_cmp_lt_i32 s31, 32
    s_cselect_b32 s14, s6, 0
    s_cselect_b32 s26, 0, 0x400000
    v_mfma_f32_16x16x32_bf16 v[16:19], v[80:83], v[122:125], v[16:19]
    s_add_u32 s17, s17, 8192
    v_mfma_f32_16x16x32_bf16 v[20:23], v[78:81], v[122:125], v[20:23]
    v_mfma_f32_16x16x32_bf16 v[8:11], v[80:83], v[126:129], v[8:11]
    v_mfma_f32_16x16x32_bf16 v[12:15], v[78:81], v[126:129], v[12:15]
    v_mfma_f32_16x16x32_bf16 v[16:19], v[80:83], v[130:133], v[16:19]
    v_mfma_f32_16x16x32_bf16 v[20:23], v[78:81], v[130:133], v[20:23]
    v_mfma_f32_16x16x32_bf16 v[8:11], v[80:83], v[134:137], v[8:11]
    v_mfma_f32_16x16x32_bf16 v[12:15], v[78:81], v[134:137], v[12:15]
    v_mfma_f32_16x16x32_bf16 v[16:19], v[80:83], v[138:141], v[16:19]
    v_mfma_f32_16x16x32_bf16 v[20:23], v[78:81], v[138:141], v[20:23]
    s_nop 4
    v_cvt_pk_bf16_f32 v56, v8, v9
    v_cvt_pk_bf16_f32 v57, v10, v11
    v_cvt_pk_bf16_f32 v58, v12, v13
    v_cvt_pk_bf16_f32 v59, v14, v15
    buffer_store_dwordx4 v[56:59], v1, s[12:15], s36 offen offset:0 sc1
    v_cvt_pk_bf16_f32 v60, v16, v17
    v_cvt_pk_bf16_f32 v61, v18, v19
    v_cvt_pk_bf16_f32 v62, v20, v21
    v_cvt_pk_bf16_f32 v63, v22, v23
    buffer_store_dwordx4 v[60:63], v1, s[12:15], s36 offen offset:1024 sc1
    v_mfma_f32_16x16x32_bf16 v[70:73], v[56:59], v[56:59], 0
    v_mfma_f32_16x16x32_bf16 v[66:69], v[74:77], v[56:59], 0
    v_mfma_f32_16x16x32_bf16 v[70:73], v[60:63], v[60:63], v[70:73]
    v_mfma_f32_16x16x32_bf16 v[66:69], v[74:77], v[60:63], v[66:69]
    v_permlane16_swap_b32 v56, v58
    v_permlane16_swap_b32 v57, v59
    buffer_store_dwordx4 v[56:59], v100, s[24:27], s42 offen offset:0
    v_permlane16_swap_b32 v60, v62
    v_permlane16_swap_b32 v61, v63
    buffer_store_dwordx4 v[60:63], v100, s[24:27], s42 offen offset:64
    s_nop 0
    v_cndmask_b32 v70, v70, v71, s[44:45]
    v_cndmask_b32 v72, v72, v73, s[44:45]
    v_cndmask_b32 v67, v70, v72, s[46:47]
    buffer_store_dwordx2 v[66:67], v7, s[12:15], s36 offen offset:0 sc1
    s_add_u32 s54, s31, 1
    v_mov_b32 v6, s54
Lred_late0:
    s_mov_b32 s16, s39
    buffer_load_dword v5, v4, s[4:7], s16 offen sc1
    s_waitcnt vmcnt(1)
    buffer_store_dword v6, v64, s[12:15], s17 offen sc1
    s_cmp_ge_i32 s31, 63
    s_cbranch_scc1 L_exit
    s_waitcnt vmcnt(1)
    v_cmp_gt_i32 vcc, s32, v5
    s_sub_u32 s43, s43, 1
    s_cmp_lt_i32 s43, 0
    s_cbranch_scc1 Lred_rdy0
    s_and_b64 vcc, vcc, s[18:19]
    s_cbranch_scc0 Lred_rdy0
Lred_spin0:
    buffer_load_dword v5, v4, s[4:7], s16 offen sc1
    s_waitcnt vmcnt(0)
    v_cmp_gt_i32 vcc, s32, v5
    s_sub_u32 s43, s43, 1
    s_cmp_lt_i32 s43, 0
    s_cbranch_scc1 Lred_rdy0
    s_and_b64 vcc, vcc, s[18:19]
    s_cbranch_scc0 Lred_rdy0
    s_sleep 8
    s_branch Lred_spin0
Lred_rdy0:
    s_add_u32 s16, s16, 8192
    buffer_load_dword v5, v4, s[4:7], s16 offen sc1
    s_mov_b32 s10, s6
    s_add_u32 m0, s34, 0
    s_nop 0
    buffer_load_dwordx4 v1, s[8:11], s33 offen offset:0 sc1 lds
    buffer_load_dwordx4 v1, s[8:11], s33 offen offset:1024 sc1 lds
    buffer_load_dwordx4 v1, s[8:11], s33 offen offset:2048 sc1 lds
    buffer_load_dwordx4 v1, s[8:11], s33 offen offset:3072 sc1 lds
    buffer_load_dwordx4 v[142:145], v1, s[8:11], s40 offen offset:0 sc1
    buffer_load_dwordx4 v[146:149], v1, s[8:11], s40 offen offset:1024 sc1
    s_add_u32 s37, s40, 32768
    buffer_load_dwordx4 v[150:153], v1, s[8:11], s37 offen offset:0 sc1
    buffer_load_dwordx4 v[154:157], v1, s[8:11], s37 offen offset:1024 sc1
    s_add_u32 s37, s40, 65536
    buffer_load_dwordx4 v[158:161], v1, s[8:11], s37 offen offset:0 sc1
    buffer_load_dwordx4 v[162:165], v1, s[8:11], s37 offen offset:1024 sc1
    s_add_u32 s37, s40, 98304
    buffer_load_dwordx4 v[166:169], v1, s[8:11], s37 offen offset:0 sc1
    buffer_load_dwordx4 v[170:173], v1, s[8:11], s37 offen offset:1024 sc1
    buffer_load_dwordx4 v[174:177], v1, s[8:11], s41 offen offset:0 sc1
    buffer_load_dwordx4 v[178:181], v1, s[8:11], s41 offen offset:1024 sc1
    s_waitcnt vmcnt(14)
    s_add_u32 s32, s32, 1
    s_add_u32 s33, s33, 116736
    s_add_u32 s34, s34, 36864
    s_cmp_ge_u32 s34, 147456
    s_cselect_b32 s38, 147456, 0
    s_sub_u32 s34, s34, s38
    s_add_u32 s40, s40, 131072
    s_add_u32 s41, s41, 36864
    v_cmp_gt_i32 vcc, s32, v5
    s_nop 0
    s_and_b64 vcc, vcc, s[18:19]
    s_cselect_b32 s10, 0, s6
    s_add_u32 m0, s34, 0
    s_nop 0
    buffer_load_dwordx4 v1, s[8:11], s33 offen offset:0 sc1 lds
    buffer_load_dwordx4 v1, s[8:11], s33 offen offset:1024 sc1 lds
    buffer_load_dwordx4 v1, s[8:11], s33 offen offset:2048 sc1 lds
    buffer_load_dwordx4 v1, s[8:11], s33 offen offset:3072 sc1 lds
    s_waitcnt vmcnt(4)
Lred_go0:
    s_mov_b32 s14, 0
    s_mov_b32 s26, 0
    s_barrier
    ds_read_b128 v[40:43], v3 offset:0
    ds_read_b128 v[44:47], v3 offset:1024
    ds_read_b128 v[48:51], v3 offset:2048
    s_branch Lred_body1
Lred_slow1:
    s_sub_u32 s39, s16, 8192
    v_mfma_f32_16x16x32_bf16 v[32:35], a[8:11], v[40:43], v[92:95]
    buffer_load_dword v65, v4, s[4:7], s39 offen sc1
    v_mfma_f32_16x16x32_bf16 v[36:39], a[12:15], v[40:43], v[96:99]
    s_waitcnt lgkmcnt(2)
    v_cvt_pk_bf16_f32 v56, v8, v9
    v_cvt_pk_bf16_f32 v57, v10, v11
    v_mfma_f32_16x16x32_bf16 v[24:27], a[16:19], v[44:47], v[24:27]
    ds_read_b128 v[40:43], v3 offset:4096
    v_cvt_pk_bf16_f32 v58, v12, v13
    v_mfma_f32_16x16x32_bf16 v[28:31], a[20:23], v[44:47], v[28:31]
    s_add_u32 s31, s31, 1
    v_mov_b32 v6, s31
    v_cvt_pk_bf16_f32 v59, v14, v15
    v_mfma_f32_16x16x32_bf16 v[32:35], a[24:27], v[44:47], v[32:35]
    buffer_store_dwordx4 v[56:59], v1, s[12:15], s36 offen offset:0 sc1
    v_cvt_pk_bf16_f32 v60, v16, v17
    v_mfma_f32_16x16x32_bf16 v[36:39], a[28:31], v[44:47], v[36:39]
    s_waitcnt lgkmcnt(2)
    v_cvt_pk_bf16_f32 v61, v18, v19
    v_cvt_pk_bf16_f32 v62, v20, v21
    v_mfma_f32_16x16x32_bf16 v[24:27], a[32:35], v[48:51], v[24:27]
    ds_read_b128 v[44:47], v3 offset:5120
    v_cvt_pk_bf16_f32 v63, v22, v23
    v_mfma_f32_16x16x32_bf16 v[28:31], a[36:39], v[48:51], v[28:31]
    s_add_u32 s35, s35, 36864
    s_cmp_eq_u32 s35, 147456
    s_cselect_b32 s35, 0, s35
    v_mfma_f32_16x16x32_bf16 v[32:35], a[40:43], v[48:51], v[32:35]
    buffer_store_dwordx4 v[60:63], v1, s[12:15], s36 offen offset:1024 sc1
    v_add_u32 v2, s35, v1
    v_mfma_f32_16x16x32_bf16 v[70:73], v[56:59], v[56:59], 0
    v_mfma_f32_16x16x32_bf16 v[66:69], v[74:77], v[56:59], 0
    v_mfma_f32_16x16x32_bf16 v[70:73], v[60:63], v[60:63], v[70:73]
    v_mfma_f32_16x16x32_bf16 v[66:69], v[74:77], v[60:63], v[66:69]
    v_permlane16_swap_b32 v56, v58
    v_mfma_f32_16x16x32_bf16 v[36:39], a[44:47], v[48:51], v[36:39]
    s_waitcnt lgkmcnt(2)
    v_permlane16_swap_b32 v57, v59
    v_mfma_f32_16x16x32_bf16 v[24:27], a[48:51], v[52:55], v[24:27]
    ds_read_b128 v[48:51], v3 offset:6144
    v_mfma_f32_16x16x32_bf16 v[28:31], a[52:55], v[52:55], v[28:31]
    buffer_store_dwordx4 v[56:59], v100, s[24:27], s42 offen offset:0
    v_mfma_f32_16x16x32_bf16 v[32:35], a[56:59], v[52:55], v[32:35]
    v_permlane16_swap_b32 v60, v62
    v_mfma_f32_16x16x32_bf16 v[36:39], a[60:63], v[52:55], v[36:39]
    s_waitcnt lgkmcnt(2)
    v_permlane16_swap_b32 v61, v63
    v_mfma_f32_16x16x32_bf16 v[24:27], a[64:67], v[40:43], v[24:27]
    ds_read_b128 v[52:55], v3 offset:7168
    v_mfma_f32_16x16x32_bf16 v[28:31], a[68:71], v[40:43], v[28:31]
    buffer_store_dwordx4 v[60:63], v100, s[24:27], s42 offen offset:64
    v_cndmask_b32 v70, v70, v71, s[44:45]
    v_mfma_f32_16x16x32_bf16 v[32:35], a[72:75], v[40:43], v[32:35]
    v_cndmask_b32 v72, v72, v73, s[44:45]
    v_cndmask_b32 v67, v70, v72, s[46:47]
    v_mfma_f32_16x16x32_bf16 v[36:39], a[76:79], v[40:43], v[36:39]
    s_waitcnt lgkmcnt(2)
    v_mfma_f32_16x16x32_bf16 v[24:27], a[80:83], v[44:47], v[24:27]
    ds_read_b128 v[40:43], v3 offset:8192
    v_mfma_f32_16x16x32_bf16 v[28:31], a[84:87], v[44:47], v[28:31]
    buffer_store_dwordx2 v[66:67], v7, s[12:15], s36 offen offset:0 sc1
    s_add_u32 s36, s36, 34816
    v_mfma_f32_16x16x32_bf16 v[32:35], a[88:91], v[44:47], v[32:35]
    s_sub_u32 s42, s42, 32768
    v_mfma_f32_16x16x32_bf16 v[36:39], a[92:95], v[44:47], v[36:39]
    s_waitcnt lgkmcnt(2)
    v_mfma_f32_16x16x32_bf16 v[24:27], a[96:99], v[48:51], v[24:27]
    ds_read_b128 v[44:47], v3 offset:9216
    v_mfma_f32_16x16x32_bf16 v[28:31], a[100:103], v[48:51], v[28:31]
    v_mfma_f32_16x16x32_bf16 v[32:35], a[104:107], v[48:51], v[32:35]
    v_mfma_f32_16x16x32_bf16 v[36:39], a[108:111], v[48:51], v[36:39]
    s_waitcnt lgkmcnt(2)
    v_mfma_f32_16x16x32_bf16 v[24:27], a[112:115], v[52:55], v[24:27]
    ds_read_b128 v[48:51], v3 offset:10240
    s_waitcnt vmcnt(5)
    v_mfma_f32_16x16x32_bf16 v[28:31], a[116:119], v[52:55], v[28:31]
    v_cmp_gt_i32 vcc, s32, v65
    v_mfma_f32_16x16x32_bf16 v[32:35], a[120:123], v[52:55], v[32:35]
    v_mfma_f32_16x16x32_bf16 v[36:39], a[124:127], v[52:55], v[36:39]
    s_waitcnt lgkmcnt(2)
    s_and_b64 vcc, vcc, s[18:19]
    s_cselect_b32 s10, 0, s6
    v_mfma_f32_16x16x32_bf16 v[24:27], a[128:131], v[40:43], v[24:27]
    ds_read_b128 v[52:55], v3 offset:11264
    v_mfma_f32_16x16x32_bf16 v[28:31], a[132:135], v[40:43], v[28:31]
    s_cmp_eq_u32 s10, 0
    s_cbranch_scc1 Lred_slowc1
    v_mfma_f32_16x16x32_bf16 v[32:35], a[136:139], v[40:43], v[32:35]
    buffer_load_dword v5, v4, s[4:7], s16 offen sc1
    v_mfma_f32_16x16x32_bf16 v[36:39], a[140:143], v[40:43], v[36:39]
    s_waitcnt lgkmcnt(2)
    s_add_u32 m0, s34, 0
    v_mfma_f32_16x16x32_bf16 v[24:27], a[144:147], v[44:47], v[24:27]
    ds_read_b128 v[40:43], v3 offset:12288
    v_mfma_f32_16x16x32_bf16 v[28:31], a[148:151], v[44:47], v[28:31]
    v_mfma_f32_16x16x32_bf16 v[32:35], a[152:155], v[44:47], v[32:35]
    buffer_load_dwordx4 v1, s[8:11], s33 offen offset:0 sc1 lds
    v_mfma_f32_16x16x32_bf16 v[36:39], a[156:159], v[44:47], v[36:39]
    s_waitcnt lgkmcnt(2)
    v_mfma_f32_16x16x32_bf16 v[24:27], a[160:163], v[48:51], v[24:27]
    ds_read_b128 v[44:47], v3 offset:13312
    v_mfma_f32_16x16x32_bf16 v[28:31], a[164:167], v[48:51], v[28:31]
    v_mfma_f32_16x16x32_bf16 v[32:35], a[168:171], v[48:51], v[32:35]
    buffer_load_dwordx4 v1, s[8:11], s33 offen offset:1024 sc1 lds
    v_mfma_f32_16x16x32_bf16 v[36:39], a[172:175], v[48:51], v[36:39]
    s_waitcnt lgkmcnt(2)
    v_mfma_f32_16x16x32_bf16 v[24:27], a[176:179], v[52:55], v[24:27]
    ds_read_b128 v[48:51], v3 offset:14336
    v_mfma_f32_16x16x32_bf16 v[28:31], a[180:183], v[52:55], v[28:31]
    v_mfma_f32_16x16x32_bf16 v[32:35], a[184:187], v[52:55], v[32:35]
    buffer_load_dwordx4 v1, s[8:11], s33 offen offset:2048 sc1 lds
    v_mfma_f32_16x16x32_bf16 v[36:39], a[188:191], v[52:55], v[36:39]
    s_waitcnt lgkmcnt(2)
    v_mfma_f32_16x16x32_bf16 v[24:27], a[192:195], v[40:43], v[24:27]
    ds_read_b128 v[52:55], v3 offset:15360
    v_mfma_f32_16x16x32_bf16 v[28:31], a[196:199], v[40:43], v[28:31]
    v_mfma_f32_16x16x32_bf16 v[32:35], a[200:203], v[40:43], v[32:35]
    buffer_load_dwordx4 v1, s[8:11], s33 offen offset:3072 sc1 lds
    v_mfma_f32_16x16x32_bf16 v[36:39], a[204:207], v[40:43], v[36:39]
    s_waitcnt lgkmcnt(2)
    v_mfma_f32_16x16x32_bf16 v[24:27], a[208:211], v[44:47], v[24:27]
    v_mfma_f32_16x16x32_bf16 v[28:31], a[212:215], v[44:47], v[28:31]
    v_mfma_f32_16x16x32_bf16 v[32:35], a[216:219], v[44:47], v[32:35]
    buffer_load_dwordx4 v[102:105], v1, s[8:11], s40 offen offset:0 sc1
    v_mfma_f32_16x16x32_bf16 v[36:39], a[220:223], v[44:47], v[36:39]
    s_waitcnt lgkmcnt(1)
    v_mfma_f32_16x16x32_bf16 v[24:27], a[224:227], v[48:51], v[24:27]
    v_mfma_f32_16x16x32_bf16 v[28:31], a[228:231], v[48:51], v[28:31]
    v_mfma_f32_16x16x32_bf16 v[32:35], a[232:235], v[48:51], v[32:35]
    buffer_load_dwordx4 v[106:109], v1, s[8:11], s40 offen offset:1024 sc1
    v_mfma_f32_16x16x32_bf16 v[36:39], a[236:239], v[48:51], v[36:39]
    s_waitcnt lgkmcnt(0)
    s_add_u32 s37, s40, 32768
    v_mfma_f32_16x16x32_bf16 v[24:27], a[240:243], v[52:55], v[24:27]
    v_mfma_f32_16x16x32_bf16 v[28:31], a[244:247], v[52:55], v[28:31]
    v_mfma_f32_16x16x32_bf16 v[32:35], a[248:251], v[52:55], v[32:35]
    buffer_load_dwordx4 v[110:113], v1, s[8:11], s37 offen offset:0 sc1
    v_mfma_f32_16x16x32_bf16 v[36:39], a[252:255], v[52:55], v[36:39]
    v_mfma_f32_16x16x32_bf16 v[24:27], v[80:83], v[142:145], v[24:27]
    v_mfma_f32_16x16x32_bf16 v[28:31], v[78:81], v[142:145], v[28:31]
    v_mfma_f32_16x16x32_bf16 v[32:35], v[80:83], v[146:149], v[32:35]
    buffer_load_dwordx4 v[114:117], v1, s[8:11], s37 offen offset:1024 sc1
    v_mfma_f32_16x16x32_bf16 v[36:39], v[78:81], v[146:149], v[36:39]
    s_add_u32 s37, s40, 65536
    v_mfma_f32_16x16x32_bf16 v[24:27], v[80:83], v[150:153], v[24:27]
    v_mfma_f32_16x16x32_bf16 v[28:31], v[78:81], v[150:153], v[28:31]
    s_waitcnt vmcnt(4)
    s_barrier
    v_mfma_f32_16x16x32_bf16 v[32:35], v[80:83], v[154:157], v[32:35]
    buffer_load_dwordx4 v[118:121], v1, s[8:11], s37 offen offset:0 sc1
    v_mfma_f32_16x16x32_bf16 v[36:39], v[78:81], v[154:157], v[36:39]
    v_mfma_f32_16x16x32_bf16 v[24:27], v[80:83], v[158:161], v[24:27]
    ds_read_b128 v[40:43], v2 offset:0
    v_mfma_f32_16x16x32_bf16 v[28:31], v[78:81], v[158:161], v[28:31]
    buffer_store_dword v6, v64, s[12:15], s17 offen sc1
    v_mfma_f32_16x16x32_bf16 v[32:35], v[80:83], v[162:165], v[32:35]
    buffer_load_dwordx4 v[122:125], v1, s[8:11], s37 offen offset:1024 sc1
    v_mfma_f32_16x16x32_bf16 v[36:39], v[78:81], v[162:165], v[36:39]
    s_add_u32 s37, s40, 98304
    v_mfma_f32_16x16x32_bf16 v[24:27], v[80:83], v[166:169], v[24:27]
    ds_read_b128 v[44:47], v2 offset:1024
    v_mfma_f32_16x16x32_bf16 v[28:31], v[78:81], v[166:169], v[28:31]
    s_cmp_lt_i32 s31, 32
    s_cselect_b32 s14, s6, 0
    s_cselect_b32 s26, 0, 0x400000
    v_mfma_f32_16x16x32_bf16 v[32:35], v[80:83], v[170:173], v[32:35]
    buffer_load_dwordx4 v[126:129], v1, s[8:11], s37 offen offset:0 sc1
    v_mfma_f32_16x16x32_bf16 v[36:39], v[78:81], v[170:173], v[36:39]
    s_add_u32 s17, s17, 8192
    v_mfma_f32_16x16x32_bf16 v[24:27], v[80:83], v[174:177], v[24:27]
    ds_read_b128 v[48:51], v2 offset:2048
    v_mfma_f32_16x16x32_bf16 v[28:31], v[78:81], v[174:177], v[28:31]
    v_mfma_f32_16x16x32_bf16 v[32:35], v[80:83], v[178:181], v[32:35]
    buffer_load_dwordx4 v[130:133], v1, s[8:11], s37 offen offset:1024 sc1
    v_mfma_f32_16x16x32_bf16 v[36:39], v[78:81], v[178:181], v[36:39]
    buffer_load_dwordx4 v[134:137], v1, s[8:11], s41 offen offset:0 sc1
    buffer_load_dwordx4 v[138:141], v1, s[8:11], s41 offen offset:1024 sc1
    s_add_u32 s32, s32, 1
    s_add_u32 s33, s33, 116736
    s_add_u32 s34, s34, 36864
    s_cmp_ge_u32 s34, 147456
    s_cselect_b32 s38, 147456, 0
    s_sub_u32 s34, s34, s38
    s_add_u32 s40, s40, 131072
    s_add_u32 s41, s41, 36864
    v_cmp_gt_i32 vcc, s32, v5
    s_nop 0
    s_and_b64 vcc, vcc, s[18:19]
    s_cselect_b32 s10, 0, s6
    s_add_u32 m0, s34, 0
    s_nop 0
    buffer_load_dwordx4 v1, s[8:11], s33 offen offset:0 sc1 lds
    buffer_load_dwordx4 v1, s[8:11], s33 offen offset:1024 sc1 lds
    buffer_load_dwordx4 v1, s[8:11], s33 offen offset:2048 sc1 lds
    buffer_load_dwordx4 v1, s[8:11], s33 offen offset:3072 sc1 lds
    s_cmp_lt_i32 s31, 63
    s_cbranch_scc1 Lred_body0
    s_branch L_exit
Lred_slowc1:
    v_mfma_f32_16x16x32_bf16 v[32:35], a[136:139], v[40:43], v[32:35]
    v_mfma_f32_16x16x32_bf16 v[36:39], a[140:143], v[40:43], v[36:39]
    s_waitcnt lgkmcnt(2)
    v_mfma_f32_16x16x32_bf16 v[24:27], a[144:147], v[44:47], v[24:27]
    ds_read_b128 v[40:43], v3 offset:12288
    v_mfma_f32_16x16x32_bf16 v[28:31], a[148:151], v[44:47], v[28:31]
    v_mfma_f32_16x16x32_bf16 v[32:35], a[152:155], v[44:47], v[32:35]
    v_mfma_f32_16x16x32_bf16 v[36:39], a[156:159], v[44:47], v[36:39]
    s_waitcnt lgkmcnt(2)
    v_mfma_f32_16x16x32_bf16 v[24:27], a[160:163], v[48:51], v[24:27]
    ds_read_b128 v[44:47], v3 offset:13312
    v_mfma_f32_16x16x32_bf16 v[28:31], a[164:167], v[48:51], v[28:31]
    v_mfma_f32_16x16x32_bf16 v[32:35], a[168:171], v[48:51], v[32:35]
    v_mfma_f32_16x16x32_bf16 v[36:39], a[172:175], v[48:51], v[36:39]
    s_waitcnt lgkmcnt(2)
    v_mfma_f32_16x16x32_bf16 v[24:27], a[176:179], v[52:55], v[24:27]
    ds_read_b128 v[48:51], v3 offset:14336
    v_mfma_f32_16x16x32_bf16 v[28:31], a[180:183], v[52:55], v[28:31]
    v_mfma_f32_16x16x32_bf16 v[32:35], a[184:187], v[52:55], v[32:35]
    v_mfma_f32_16x16x32_bf16 v[36:39], a[188:191], v[52:55], v[36:39]
    s_waitcnt lgkmcnt(2)
    v_mfma_f32_16x16x32_bf16 v[24:27], a[192:195], v[40:43], v[24:27]
    ds_read_b128 v[52:55], v3 offset:15360
    v_mfma_f32_16x16x32_bf16 v[28:31], a[196:199], v[40:43], v[28:31]
    v_mfma_f32_16x16x32_bf16 v[32:35], a[200:203], v[40:43], v[32:35]
    v_mfma_f32_16x16x32_bf16 v[36:39], a[204:207], v[40:43], v[36:39]
    s_waitcnt lgkmcnt(2)
    v_mfma_f32_16x16x32_bf16 v[24:27], a[208:211], v[44:47], v[24:27]
    v_mfma_f32_16x16x32_bf16 v[28:31], a[212:215], v[44:47], v[28:31]
    v_mfma_f32_16x16x32_bf16 v[32:35], a[216:219], v[44:47], v[32:35]
    v_mfma_f32_16x16x32_bf16 v[36:39], a[220:223], v[44:47], v[36:39]
    s_waitcnt lgkmcnt(1)
    v_mfma_f32_16x16x32_bf16 v[24:27], a[224:227], v[48:51], v[24:27]
    v_mfma_f32_16x16x32_bf16 v[28:31], a[228:231], v[48:51], v[28:31]
    v_mfma_f32_16x16x32_bf16 v[32:35], a[232:235], v[48:51], v[32:35]
    v_mfma_f32_16x16x32_bf16 v[36:39], a[236:239], v[48:51], v[36:39]
    s_waitcnt lgkmcnt(0)
    v_mfma_f32_16x16x32_bf16 v[24:27], a[240:243], v[52:55], v[24:27]
    v_mfma_f32_16x16x32_bf16 v[28:31], a[244:247], v[52:55], v[28:31]
    v_mfma_f32_16x16x32_bf16 v[32:35], a[248:251], v[52:55], v[32:35]
    v_mfma_f32_16x16x32_bf16 v[36:39], a[252:255], v[52:55], v[36:39]
    v_mfma_f32_16x16x32_bf16 v[24:27], v[80:83], v[142:145], v[24:27]
    v_mfma_f32_16x16x32_bf16 v[28:31], v[78:81], v[142:145], v[28:31]
    v_mfma_f32_16x16x32_bf16 v[32:35], v[80:83], v[146:149], v[32:35]
    v_mfma_f32_16x16x32_bf16 v[36:39], v[78:81], v[146:149], v[36:39]
    v_mfma_f32_16x16x32_bf16 v[24:27], v[80:83], v[150:153], v[24:27]
    v_mfma_f32_16x16x32_bf16 v[28:31], v[78:81], v[150:153], v[28:31]
    v_mfma_f32_16x16x32_bf16 v[32:35], v[80:83], v[154:157], v[32:35]
    v_mfma_f32_16x16x32_bf16 v[36:39], v[78:81], v[154:157], v[36:39]
    v_mfma_f32_16x16x32_bf16 v[24:27], v[80:83], v[158:161], v[24:27]
    s_waitcnt vmcnt(0)
    buffer_store_dword v6, v64, s[12:15], s17 offen sc1
    v_mfma_f32_16x16x32_bf16 v[28:31], v[78:81], v[158:161], v[28:31]
    s_cmp_lt_i32 s31, 32
    s_cselect_b32 s14, s6, 0
    s_cselect_b32 s26, 0, 0x400000
    v_mfma_f32_16x16x32_bf16 v[32:35], v[80:83], v[162:165], v[32:35]
    s_add_u32 s17, s17, 8192
    v_mfma_f32_16x16x32_bf16 v[36:39], v[78:81], v[162:165], v[36:39]
    v_mfma_f32_16x16x32_bf16 v[24:27], v[80:83], v[166:169], v[24:27]
    v_mfma_f32_16x16x32_bf16 v[28:31], v[78:81], v[166:169], v[28:31]
    v_mfma_f32_16x16x32_bf16 v[32:35], v[80:83], v[170:173], v[32:35]
    v_mfma_f32_16x16x32_bf16 v[36:39], v[78:81], v[170:173], v[36:39]
    v_mfma_f32_16x16x32_bf16 v[24:27], v[80:83], v[174:177], v[24:27]
    v_mfma_f32_16x16x32_bf16 v[28:31], v[78:81], v[174:177], v[28:31]
    v_mfma_f32_16x16x32_bf16 v[32:35], v[80:83], v[178:181], v[32:35]
    v_mfma_f32_16x16x32_bf16 v[36:39], v[78:81], v[178:181], v[36:39]
    s_nop 4
    v_cvt_pk_bf16_f32 v56, v24, v25
    v_cvt_pk_bf16_f32 v57, v26, v27
    v_cvt_pk_bf16_f32 v58, v28, v29
    v_cvt_pk_bf16_f32 v59, v30, v31
    buffer_store_dwordx4 v[56:59], v1, s[12:15], s36 offen offset:0 sc1
    v_cvt_pk_bf16_f32 v60, v32, v33
    v_cvt_pk_bf16_f32 v61, v34, v35
    v_cvt_pk_bf16_f32 v62, v36, v37
    v_cvt_pk_bf16_f32 v63, v38, v39
    buffer_store_dwordx4 v[60:63], v1, s[12:15], s36 offen offset:1024 sc1
    v_mfma_f32_16x16x32_bf16 v[70:73], v[56:59], v[56:59], 0
    v_mfma_f32_16x16x32_bf16 v[66:69], v[74:77], v[56:59], 0
    v_mfma_f32_16x16x32_bf16 v[70:73], v[60:63], v[60:63], v[70:73]
    v_mfma_f32_16x16x32_bf16 v[66:69], v[74:77], v[60:63], v[66:69]
    v_permlane16_swap_b32 v56, v58
    v_permlane16_swap_b32 v57, v59
    buffer_store_dwordx4 v[56:59], v100, s[24:27], s42 offen offset:0
    v_permlane16_swap_b32 v60, v62
    v_permlane16_swap_b32 v61, v63
    buffer_store_dwordx4 v[60:63], v100, s[24:27], s42 offen offset:64
    s_nop 0
    v_cndmask_b32 v70, v70, v71, s[44:45]
    v_cndmask_b32 v72, v72, v73, s[44:45]
    v_cndmask_b32 v67, v70, v72, s[46:47]
    buffer_store_dwordx2 v[66:67], v7, s[12:15], s36 offen offset:0 sc1
    s_add_u32 s54, s31, 1
    v_mov_b32 v6, s54
Lred_late1:
    s_mov_b32 s16, s39
    buffer_load_dword v5, v4, s[4:7], s16 offen sc1
    s_waitcnt vmcnt(1)
    buffer_store_dword v6, v64, s[12:15], s17 offen sc1
    s_cmp_ge_i32 s31, 63
    s_cbranch_scc1 L_exit
    s_waitcnt vmcnt(1)
    v_cmp_gt_i32 vcc, s32, v5
    s_sub_u32 s43, s43, 1
    s_cmp_lt_i32 s43, 0
    s_cbranch_scc1 Lred_rdy1
    s_and_b64 vcc, vcc, s[18:19]
    s_cbranch_scc0 Lred_rdy1
Lred_spin1:
    buffer_load_dword v5, v4, s[4:7], s16 offen sc1
    s_waitcnt vmcnt(0)
    v_cmp_gt_i32 vcc, s32, v5
    s_sub_u32 s43, s43, 1
    s_cmp_lt_i32 s43, 0
    s_cbranch_scc1 Lred_rdy1
    s_and_b64 vcc, vcc, s[18:19]
    s_cbranch_scc0 Lred_rdy1
    s_sleep 8
    s_branch Lred_spin1
Lred_rdy1:
    s_add_u32 s16, s16, 8192
    buffer_load_dword v5, v4, s[4:7], s16 offen sc1
    s_mov_b32 s10, s6
    s_add_u32 m0, s34, 0
    s_nop 0
    buffer_load_dwordx4 v1, s[8:11], s33 offen offset:0 sc1 lds
    buffer_load_dwordx4 v1, s[8:11], s33 offen offset:1024 sc1 lds
    buffer_load_dwordx4 v1, s[8:11], s33 offen offset:2048 sc1 lds
    buffer_load_dwordx4 v1, s[8:11], s33 offen offset:3072 sc1 lds
    buffer_load_dwordx4 v[102:105], v1, s[8:11], s40 offen offset:0 sc1
    buffer_load_dwordx4 v[106:109], v1, s[8:11], s40 offen offset:1024 sc1
    s_add_u32 s37, s40, 32768
    buffer_load_dwordx4 v[110:113], v1, s[8:11], s37 offen offset:0 sc1
    buffer_load_dwordx4 v[114:117], v1, s[8:11], s37 offen offset:1024 sc1
    s_add_u32 s37, s40, 65536
    buffer_load_dwordx4 v[118:121], v1, s[8:11], s37 offen offset:0 sc1
    buffer_load_dwordx4 v[122:125], v1, s[8:11], s37 offen offset:1024 sc1
    s_add_u32 s37, s40, 98304
    buffer_load_dwordx4 v[126:129], v1, s[8:11], s37 offen offset:0 sc1
    buffer_load_dwordx4 v[130:133], v1, s[8:11], s37 offen offset:1024 sc1
    buffer_load_dwordx4 v[134:137], v1, s[8:11], s41 offen offset:0 sc1
    buffer_load_dwordx4 v[138:141], v1, s[8:11], s41 offen offset:1024 sc1
    s_waitcnt vmcnt(14)
    s_add_u32 s32, s32, 1
    s_add_u32 s33, s33, 116736
    s_add_u32 s34, s34, 36864
    s_cmp_ge_u32 s34, 147456
    s_cselect_b32 s38, 147456, 0
    s_sub_u32 s34, s34, s38
    s_add_u32 s40, s40, 131072
    s_add_u32 s41, s41, 36864
    v_cmp_gt_i32 vcc, s32, v5
    s_nop 0
    s_and_b64 vcc, vcc, s[18:19]
    s_cselect_b32 s10, 0, s6
    s_add_u32 m0, s34, 0
    s_nop 0
    buffer_load_dwordx4 v1, s[8:11], s33 offen offset:0 sc1 lds
    buffer_load_dwordx4 v1, s[8:11], s33 offen offset:1024 sc1 lds
    buffer_load_dwordx4 v1, s[8:11], s33 offen offset:2048 sc1 lds
    buffer_load_dwordx4 v1, s[8:11], s33 offen offset:3072 sc1 lds
    s_waitcnt vmcnt(4)
Lred_go1:
    s_mov_b32 s14, 0
    s_mov_b32 s26, 0
    s_barrier
    ds_read_b128 v[40:43], v2 offset:0
    ds_read_b128 v[44:47], v2 offset:1024
    ds_read_b128 v[48:51], v2 offset:2048
    s_branch Lred_body0
Lqkv_start:
    s_mov_b32 s12, s66
    s_mov_b32 s13, s67
    s_mov_b32 s14, 0x600000
    s_mov_b32 s15, 0x00020000
    v_lshrrev_b32 v24, 3, v0
    v_mul_u32_u24 v24, 6144, v24
    v_bfe_u32 v25, v0, 4, 2
    v_lshlrev_b32 v25, 1, v25
    v_and_b32 v26, 7, v0
    v_xor_b32 v25, v25, v26
    v_lshl_add_u32 v40, v25, 4, v24
    v_add_u32 v41, 48128, v40
    s_mul_i32 s86, s29, 0x80
    s_mul_i32 s37, s30, 98304
    s_add_u32 s86, s86, s37
    s_lshl_b32 s87, s30, 11
    s_add_u32 m0, s87, 40960
    s_add_u32 s37, s86, 0
    buffer_load_dwordx4 v40, s[12:15], s37 offen lds
    buffer_load_dwordx4 v41, s[12:15], s37 offen offset:1024 lds
    s_add_u32 m0, s87, 49152
    s_add_u32 s37, s86, 2048
    buffer_load_dwordx4 v40, s[12:15], s37 offen lds
    buffer_load_dwordx4 v41, s[12:15], s37 offen offset:1024 lds
    s_add_u32 m0, s87, 57344
    s_add_u32 s37, s86, 4096
    buffer_load_dwordx4 v40, s[12:15], s37 offen lds
    buffer_load_dwordx4 v41, s[12:15], s37 offen offset:1024 lds
    s_add_u32 m0, s87, 65536
    s_add_u32 s37, s86, 393216
    buffer_load_dwordx4 v40, s[12:15], s37 offen lds
    buffer_load_dwordx4 v41, s[12:15], s37 offen offset:1024 lds
    s_add_u32 m0, s87, 73728
    s_add_u32 s37, s86, 395264
    buffer_load_dwordx4 v40, s[12:15], s37 offen lds
    buffer_load_dwordx4 v41, s[12:15], s37 offen offset:1024 lds
    s_add_u32 m0, s87, 81920
    s_add_u32 s37, s86, 397312
    buffer_load_dwordx4 v40, s[12:15], s37 offen lds
    buffer_load_dwordx4 v41, s[12:15], s37 offen offset:1024 lds
    s_add_u32 m0, s87, 90112
    s_add_u32 s37, s86, 786432
    buffer_load_dwordx4 v40, s[12:15], s37 offen lds
    buffer_load_dwordx4 v41, s[12:15], s37 offen offset:1024 lds
    s_add_u32 m0, s87, 98304
    s_add_u32 s37, s86, 788480
    buffer_load_dwordx4 v40, s[12:15], s37 offen lds
    buffer_load_dwordx4 v41, s[12:15], s37 offen offset:1024 lds
    s_add_u32 m0, s87, 106496
    s_add_u32 s37, s86, 790528
    buffer_load_dwordx4 v40, s[12:15], s37 offen lds
    buffer_load_dwordx4 v41, s[12:15], s37 offen offset:1024 lds
    s_add_u32 m0, s87, 114688
    s_add_u32 s37, s86, 1179648
    buffer_load_dwordx4 v40, s[12:15], s37 offen lds
    buffer_load_dwordx4 v41, s[12:15], s37 offen offset:1024 lds
    s_add_u32 m0, s87, 122880
    s_add_u32 s37, s86, 1181696
    buffer_load_dwordx4 v40, s[12:15], s37 offen lds
    buffer_load_dwordx4 v41, s[12:15], s37 offen offset:1024 lds
    s_add_u32 m0, s87, 131072
    s_add_u32 s37, s86, 1183744
    buffer_load_dwordx4 v40, s[12:15], s37 offen lds
    buffer_load_dwordx4 v41, s[12:15], s37 offen offset:1024 lds
    v_bfe_u32 v24, v0, 3, 2
    v_and_b32 v25, 3, v0
    v_lshlrev_b32 v25, 3, v25
    v_lshrrev_b32 v26, 2, v0
    v_lshl_add_u32 v26, v26, 7, v25
    v_lshrrev_b32 v27, 5, v0
    v_lshl_add_u32 v27, v27, 10, v26
    s_mov_b32 s37, 0
    s_mov_b32 s38, s30
    s_lshl_b32 s37, s37, 13
    v_xor_b32 v28, s38, v24
    v_lshl_add_u32 v28, v28, 5, s37
    v_add_u32 v42, v28, v26
    v_add_u32 v46, v28, v27
    s_mov_b32 s37, 1
    s_mov_b32 s38, s30
    s_lshl_b32 s37, s37, 13
    v_xor_b32 v28, s38, v24
    v_lshl_add_u32 v28, v28, 5, s37
    v_add_u32 v43, v28, v26
    v_add_u32 v47, v28, v27
    s_mov_b32 s37, 2
    s_mov_b32 s38, s30
    s_lshl_b32 s37, s37, 13
    v_xor_b32 v28, s38, v24
    v_lshl_add_u32 v28, v28, 5, s37
    v_add_u32 v44, v28, v26
    v_add_u32 v48, v28, v27
    v_mov_b32 v28, 0x3f803f80
    v_mov_b32 v29, 0x3f803f80
    v_mov_b32 v30, 0x3f803f80
    v_mov_b32 v31, 0x3f803f80
    s_mul_i32 s37, s28, 0x80000
    s_add_u32 s37, s37, 0x6001e00
    v_min_u32 v4, 15, v0
    v_lshl_add_u32 v4, v4, 5, s37
    s_mul_i32 s37, s28, 0x80000
    s_mul_i32 s53, s29, 0x80
    s_add_u32 s37, s37, s53
    s_mul_i32 s53, s30, 0x20
    s_add_u32 s37, s37, s53
    s_add_u32 s37, s37, 0x5f80000
    v_mov_b32 v8, s37
    s_cmp_eq_u32 s28, 0
    s_cselect_b32 s37, 64, 16
    v_cmp_le_u32 vcc, s37, v0
    s_nop 1
    v_cndmask_b32 v4, v4, v8, vcc
    s_mul_i32 s33, s28, 0x220000
    s_lshr_b32 s38, s30, 1
    s_mul_i32 s36, s28, 0x200000
    s_mul_i32 s53, s29, 0x800
    s_add_u32 s36, s36, s53
    s_mul_i32 s53, s38, 0x400
    s_add_u32 s36, s36, s53
    s_add_u32 s36, s36, 0x9e8000
    s_and_b32 s38, s30, 1
    v_lshrrev_b32 v8, 5, v0
    v_cmp_eq_u32 vcc, s38, v8
    v_add_u32 v8, 0, v1
    v_mov_b32 v7, 0x40000000
    v_cndmask_b32 v7, v7, v8, vcc
    s_mul_i32 s40, s28, 0x10000
    s_mul_i32 s53, s29, 0x1000
    s_add_u32 s40, s40, s53
    s_mul_i32 s53, s30, 0x400
    s_add_u32 s40, s40, s53
    s_add_u32 s40, s40, 0x1c00000
    s_sub_u32 s41, s40, 327680
    s_mov_b32 s24, s84
    s_mov_b32 s25, s85
    s_mov_b32 s26, 0x6200000
    s_mov_b32 s27, 0x00020000
    s_cmp_eq_u32 s28, 0
    s_cselect_b32 s26, 0, s26
    s_cselect_b32 s42, 0xf149f2ca, 0
    v_mov_b32 v86, 0
    v_mov_b32 v87, 0
    v_mov_b32 v90, 0
    v_mov_b32 v91, 0
    s_lshl_b32 s37, s30, 9
    s_add_u32 s38, s37, 147456
    v_lshl_add_u32 v36, v0, 3, s38
    v_xor_b32 v37, 512, v36
    v_add_u32 v39, 4096, v36
    s_add_u32 s38, s37, 151552
    v_and_b32 v8, 15, v0
    v_lshl_add_u32 v8, v8, 5, s38
    v_lshrrev_b32 v9, 4, v0
    v_lshl_add_u32 v38, v9, 3, v8
    s_mov_b32 s44, 0xaaaaaaaa
    s_mov_b32 s45, 0xaaaaaaaa
    s_mov_b32 s48, 0xfff0ffff
    s_mov_b32 s49, 0xf000ff00
    s_mov_b32 s50, 0xffc0fffc
    s_mov_b32 s51, 0xc000fc00
    s_mov_b32 s52, 0x3e8293ee
    v_mov_b32 v10, 0x0c0c0c0c
    v_mov_b32 v8, 0xc0c0100
    v_mov_b32 v9, 0x1000c0c
    v_cndmask_b32 v8, v8, v9, s[44:45]
    v_cndmask_b32 v102, v8, v10, s[48:49]
    v_cndmask_b32 v104, v10, v8, s[48:49]
    v_mov_b32 v8, 0xc0c0302
    v_mov_b32 v9, 0x3020c0c
    v_cndmask_b32 v8, v8, v9, s[44:45]
    v_cndmask_b32 v103, v8, v10, s[50:51]
    v_cndmask_b32 v105, v10, v8, s[50:51]
    s_mov_b32 s31, -1
    s_mov_b32 s35, 0
    s_mov_b32 s16, 0
    v_mov_b32 v5, 0
    s_mul_i32 s17, s28, 0x80000
    s_mul_i32 s53, s29, 0x80
    s_add_u32 s17, s17, s53
    s_mul_i32 s53, s30, 0x20
    s_add_u32 s17, s17, s53
    s_add_u32 s17, s17, 0x5ff8000
    v_cmp_eq_u32 vcc, 0, v0
    v_mov_b32 v21, 0x40000000
    s_nop 0
    v_cndmask_b32 v21, v21, v0, vcc
    v_mov_b32 v2, v1
    s_mul_i32 s34, s30, 9216
    s_min_u32 s34, s34, 25600
    s_add_u32 s33, s33, s34
    v_lshlrev_b32 v20, 3, v0
    s_mov_b64 s[18:19], 0x1ffff
    v_mov_b32 v8, 0x40000000
    v_cndmask_b32 v4, v8, v4, s[18:19]
    v_add_u32 v50, 40960, v42
    v_add_u32 v51, 40960, v43
    v_add_u32 v52, 40960, v44
    s_waitcnt vmcnt(18)
    s_barrier
    ds_read_b64_tr_b16 a[0:1], v50 offset:0
    ds_read_b64_tr_b16 a[2:3], v50 offset:2048
    ds_read_b64_tr_b16 a[4:5], v51 offset:0
    ds_read_b64_tr_b16 a[6:7], v51 offset:2048
    ds_read_b64_tr_b16 a[8:9], v52 offset:0
    ds_read_b64_tr_b16 a[10:11], v52 offset:2048
    ds_read_b64_tr_b16 a[12:13], v50 offset:4096
    ds_read_b64_tr_b16 a[14:15], v50 offset:6144
    ds_read_b64_tr_b16 a[16:17], v51 offset:4096
    ds_read_b64_tr_b16 a[18:19], v51 offset:6144
    ds_read_b64_tr_b16 a[20:21], v52 offset:4096
    ds_read_b64_tr_b16 a[22:23], v52 offset:6144
    s_add_u32 m0, s87, 139264
    s_add_u32 s37, s86, 1572864
    buffer_load_dwordx4 v40, s[12:15], s37 offen lds
    buffer_load_dwordx4 v41, s[12:15], s37 offen offset:1024 lds
    s_add_u32 m0, s87, 147456
    s_add_u32 s37, s86, 1574912
    buffer_load_dwordx4 v40, s[12:15], s37 offen lds
    buffer_load_dwordx4 v41, s[12:15], s37 offen offset:1024 lds
    s_add_u32 m0, s87, 155648
    s_add_u32 s37, s86, 1576960
    buffer_load_dwordx4 v40, s[12:15], s37 offen lds
    buffer_load_dwordx4 v41, s[12:15], s37 offen offset:1024 lds
    s_waitcnt lgkmcnt(0)
    v_mfma_f32_16x16x32_bf16 v[56:59], a[0:3], v[28:31], 0
    v_mfma_f32_16x16x32_bf16 v[60:63], a[4:7], v[28:31], 0
    v_mfma_f32_16x16x32_bf16 v[64:67], a[8:11], v[28:31], 0
    v_mfma_f32_16x16x32_bf16 v[56:59], a[12:15], v[28:31], v[56:59]
    v_mfma_f32_16x16x32_bf16 v[60:63], a[16:19], v[28:31], v[60:63]
    v_mfma_f32_16x16x32_bf16 v[64:67], a[20:23], v[28:31], v[64:67]
    v_add_u32 v50, 65536, v42
    v_add_u32 v51, 65536, v43
    v_add_u32 v52, 65536, v44
    s_waitcnt vmcnt(18)
    s_barrier
    ds_read_b64_tr_b16 a[24:25], v50 offset:0
    ds_read_b64_tr_b16 a[26:27], v50 offset:2048
    ds_read_b64_tr_b16 a[28:29], v51 offset:0
    ds_read_b64_tr_b16 a[30:31], v51 offset:2048
    ds_read_b64_tr_b16 a[32:33], v52 offset:0
    ds_read_b64_tr_b16 a[34:35], v52 offset:2048
    ds_read_b64_tr_b16 a[36:37], v50 offset:4096
    ds_read_b64_tr_b16 a[38:39], v50 offset:6144
    ds_read_b64_tr_b16 a[40:41], v51 offset:4096
    ds_read_b64_tr_b16 a[42:43], v51 offset:6144
    ds_read_b64_tr_b16 a[44:45], v52 offset:4096
    ds_read_b64_tr_b16 a[46:47], v52 offset:6144
    s_add_u32 m0, s87, 40960
    s_add_u32 s37, s86, 1966080
    buffer_load_dwordx4 v40, s[12:15], s37 offen lds
    buffer_load_dwordx4 v41, s[12:15], s37 offen offset:1024 lds
    s_add_u32 m0, s87, 49152
    s_add_u32 s37, s86, 1968128
    buffer_load_dwordx4 v40, s[12:15], s37 offen lds
    buffer_load_dwordx4 v41, s[12:15], s37 offen offset:1024 lds
    s_add_u32 m0, s87, 57344
    s_add_u32 s37, s86, 1970176
    buffer_load_dwordx4 v40, s[12:15], s37 offen lds
    buffer_load_dwordx4 v41, s[12:15], s37 offen offset:1024 lds
    s_waitcnt lgkmcnt(0)
    v_mfma_f32_16x16x32_bf16 v[56:59], a[24:27], v[28:31], v[56:59]
    v_mfma_f32_16x16x32_bf16 v[60:63], a[28:31], v[28:31], v[60:63]
    v_mfma_f32_16x16x32_bf16 v[64:67], a[32:35], v[28:31], v[64:67]
    v_mfma_f32_16x16x32_bf16 v[56:59], a[36:39], v[28:31], v[56:59]
    v_mfma_f32_16x16x32_bf16 v[60:63], a[40:43], v[28:31], v[60:63]
    v_mfma_f32_16x16x32_bf16 v[64:67], a[44:47], v[28:31], v[64:67]
    v_add_u32 v50, 90112, v42
    v_add_u32 v51, 90112, v43
    v_add_u32 v52, 90112, v44
    s_waitcnt vmcnt(18)
    s_barrier
    ds_read_b64_tr_b16 a[48:49], v50 offset:0
    ds_read_b64_tr_b16 a[50:51], v50 offset:2048
    ds_read_b64_tr_b16 a[52:53], v51 offset:0
    ds_read_b64_tr_b16 a[54:55], v51 offset:2048
    ds_read_b64_tr_b16 a[56:57], v52 offset:0
    ds_read_b64_tr_b16 a[58:59], v52 offset:2048
    ds_read_b64_tr_b16 a[60:61], v50 offset:4096
    ds_read_b64_tr_b16 a[62:63], v50 offset:6144
    ds_read_b64_tr_b16 a[64:65], v51 offset:4096
    ds_read_b64_tr_b16 a[66:67], v51 offset:6144
    ds_read_b64_tr_b16 a[68:69], v52 offset:4096
    ds_read_b64_tr_b16 a[70:71], v52 offset:6144
    s_add_u32 m0, s87, 65536
    s_add_u32 s37, s86, 2359296
    buffer_load_dwordx4 v40, s[12:15], s37 offen lds
    buffer_load_dwordx4 v41, s[12:15], s37 offen offset:1024 lds
    s_add_u32 m0, s87, 73728
    s_add_u32 s37, s86, 2361344
    buffer_load_dwordx4 v40, s[12:15], s37 offen lds
    buffer_load_dwordx4 v41, s[12:15], s37 offen offset:1024 lds
    s_add_u32 m0, s87, 81920
    s_add_u32 s37, s86, 2363392
    buffer_load_dwordx4 v40, s[12:15], s37 offen lds
    buffer_load_dwordx4 v41, s[12:15], s37 offen offset:1024 lds
    s_waitcnt lgkmcnt(0)
    v_mfma_f32_16x16x32_bf16 v[56:59], a[48:51], v[28:31], v[56:59]
    v_mfma_f32_16x16x32_bf16 v[60:63], a[52:55], v[28:31], v[60:63]
    v_mfma_f32_16x16x32_bf16 v[64:67], a[56:59], v[28:31], v[64:67]
    v_mfma_f32_16x16x32_bf16 v[56:59], a[60:63], v[28:31], v[56:59]
    v_mfma_f32_16x16x32_bf16 v[60:63], a[64:67], v[28:31], v[60:63]
    v_mfma_f32_16x16x32_bf16 v[64:67], a[68:71], v[28:31], v[64:67]
    v_add_u32 v50, 114688, v42
    v_add_u32 v51, 114688, v43
    v_add_u32 v52, 114688, v44
    s_waitcnt vmcnt(18)
    s_barrier
    ds_read_b64_tr_b16 a[72:73], v50 offset:0
    ds_read_b64_tr_b16 a[74:75], v50 offset:2048
    ds_read_b64_tr_b16 a[76:77], v51 offset:0
    ds_read_b64_tr_b16 a[78:79], v51 offset:2048
    ds_read_b64_tr_b16 a[80:81], v52 offset:0
    ds_read_b64_tr_b16 a[82:83], v52 offset:2048
    ds_read_b64_tr_b16 a[84:85], v50 offset:4096
    ds_read_b64_tr_b16 a[86:87], v50 offset:6144
    ds_read_b64_tr_b16 a[88:89], v51 offset:4096
    ds_read_b64_tr_b16 a[90:91], v51 offset:6144
    ds_read_b64_tr_b16 a[92:93], v52 offset:4096
    ds_read_b64_tr_b16 a[94:95], v52 offset:6144
    s_add_u32 m0, s87, 90112
    s_add_u32 s37, s86, 2752512
    buffer_load_dwordx4 v40, s[12:15], s37 offen lds
    buffer_load_dwordx4 v41, s[12:15], s37 offen offset:1024 lds
    s_add_u32 m0, s87, 98304
    s_add_u32 s37, s86, 2754560
    buffer_load_dwordx4 v40, s[12:15], s37 offen lds
    buffer_load_dwordx4 v41, s[12:15], s37 offen offset:1024 lds
    s_add_u32 m0, s87, 106496
    s_add_u32 s37, s86, 2756608
    buffer_load_dwordx4 v40, s[12:15], s37 offen lds
    buffer_load_dwordx4 v41, s[12:15], s37 offen offset:1024 lds
    s_waitcnt lgkmcnt(0)
    v_mfma_f32_16x16x32_bf16 v[56:59], a[72:75], v[28:31], v[56:59]
    v_mfma_f32_16x16x32_bf16 v[60:63], a[76:79], v[28:31], v[60:63]
    v_mfma_f32_16x16x32_bf16 v[64:67], a[80:83], v[28:31], v[64:67]
    v_mfma_f32_16x16x32_bf16 v[56:59], a[84:87], v[28:31], v[56:59]
    v_mfma_f32_16x16x32_bf16 v[60:63], a[88:91], v[28:31], v[60:63]
    v_mfma_f32_16x16x32_bf16 v[64:67], a[92:95], v[28:31], v[64:67]
    v_add_u32 v50, 139264, v42
    v_add_u32 v51, 139264, v43
    v_add_u32 v52, 139264, v44
    s_waitcnt vmcnt(18)
    s_barrier
    ds_read_b64_tr_b16 a[96:97], v50 offset:0
    ds_read_b64_tr_b16 a[98:99], v50 offset:2048
    ds_read_b64_tr_b16 a[100:101], v51 offset:0
    ds_read_b64_tr_b16 a[102:103], v51 offset:2048
    ds_read_b64_tr_b16 a[104:105], v52 offset:0
    ds_read_b64_tr_b16 a[106:107], v52 offset:2048
    ds_read_b64_tr_b16 a[108:109], v50 offset:4096
    ds_read_b64_tr_b16 a[110:111], v50 offset:6144
    ds_read_b64_tr_b16 a[112:113], v51 offset:4096
    ds_read_b64_tr_b16 a[114:115], v51 offset:6144
    ds_read_b64_tr_b16 a[116:117], v52 offset:4096
    ds_read_b64_tr_b16 a[118:119], v52 offset:6144
    s_add_u32 m0, s87, 114688
    s_add_u32 s37, s86, 3145728
    buffer_load_dwordx4 v40, s[12:15], s37 offen lds
    buffer_load_dwordx4 v41, s[12:15], s37 offen offset:1024 lds
    s_add_u32 m0, s87, 122880
    s_add_u32 s37, s86, 3147776
    buffer_load_dwordx4 v40, s[12:15], s37 offen lds
    buffer_load_dwordx4 v41, s[12:15], s37 offen offset:1024 lds
    s_add_u32 m0, s87, 131072
    s_add_u32 s37, s86, 3149824
    buffer_load_dwordx4 v40, s[12:15], s37 offen lds
    buffer_load_dwordx4 v41, s[12:15], s37 offen offset:1024 lds
    s_waitcnt lgkmcnt(0)
    v_mfma_f32_16x16x32_bf16 v[56:59], a[96:99], v[28:31], v[56:59]
    v_mfma_f32_16x16x32_bf16 v[60:63], a[100:103], v[28:31], v[60:63]
    v_mfma_f32_16x16x32_bf16 v[64:67], a[104:107], v[28:31], v[64:67]
    v_mfma_f32_16x16x32_bf16 v[56:59], a[108:111], v[28:31], v[56:59]
    v_mfma_f32_16x16x32_bf16 v[60:63], a[112:115], v[28:31], v[60:63]
    v_mfma_f32_16x16x32_bf16 v[64:67], a[116:119], v[28:31], v[64:67]
    v_add_u32 v50, 40960, v42
    v_add_u32 v51, 40960, v43
    v_add_u32 v52, 40960, v44
    s_waitcnt vmcnt(18)
    s_barrier
    ds_read_b64_tr_b16 a[120:121], v50 offset:0
    ds_read_b64_tr_b16 a[122:123], v50 offset:2048
    ds_read_b64_tr_b16 a[124:125], v51 offset:0
    ds_read_b64_tr_b16 a[126:127], v51 offset:2048
    ds_read_b64_tr_b16 a[128:129], v52 offset:0
    ds_read_b64_tr_b16 a[130:131], v52 offset:2048
    ds_read_b64_tr_b16 a[132:133], v50 offset:4096
    ds_read_b64_tr_b16 a[134:135], v50 offset:6144
    ds_read_b64_tr_b16 a[136:137], v51 offset:4096
    ds_read_b64_tr_b16 a[138:139], v51 offset:6144
    ds_read_b64_tr_b16 a[140:141], v52 offset:4096
    ds_read_b64_tr_b16 a[142:143], v52 offset:6144
    s_add_u32 m0, s87, 139264
    s_add_u32 s37, s86, 3538944
    buffer_load_dwordx4 v40, s[12:15], s37 offen lds
    buffer_load_dwordx4 v41, s[12:15], s37 offen offset:1024 lds
    s_add_u32 m0, s87, 147456
    s_add_u32 s37, s86, 3540992
    buffer_load_dwordx4 v40, s[12:15], s37 offen lds
    buffer_load_dwordx4 v41, s[12:15], s37 offen offset:1024 lds
    s_add_u32 m0, s87, 155648
    s_add_u32 s37, s86, 3543040
    buffer_load_dwordx4 v40, s[12:15], s37 offen lds
    buffer_load_dwordx4 v41, s[12:15], s37 offen offset:1024 lds
    s_waitcnt lgkmcnt(0)
    v_mfma_f32_16x16x32_bf16 v[56:59], a[120:123], v[28:31], v[56:59]
    v_mfma_f32_16x16x32_bf16 v[60:63], a[124:127], v[28:31], v[60:63]
    v_mfma_f32_16x16x32_bf16 v[64:67], a[128:131], v[28:31], v[64:67]
    v_mfma_f32_16x16x32_bf16 v[56:59], a[132:135], v[28:31], v[56:59]
    v_mfma_f32_16x16x32_bf16 v[60:63], a[136:139], v[28:31], v[60:63]
    v_mfma_f32_16x16x32_bf16 v[64:67], a[140:143], v[28:31], v[64:67]
    v_add_u32 v50, 65536, v42
    v_add_u32 v51, 65536, v43
    v_add_u32 v52, 65536, v44
    s_waitcnt vmcnt(18)
    s_barrier
    ds_read_b64_tr_b16 a[144:145], v50 offset:0
    ds_read_b64_tr_b16 a[146:147], v50 offset:2048
    ds_read_b64_tr_b16 a[148:149], v51 offset:0
    ds_read_b64_tr_b16 a[150:151], v51 offset:2048
    ds_read_b64_tr_b16 a[152:153], v52 offset:0
    ds_read_b64_tr_b16 a[154:155], v52 offset:2048
    ds_read_b64_tr_b16 a[156:157], v50 offset:4096
    ds_read_b64_tr_b16 a[158:159], v50 offset:6144
    ds_read_b64_tr_b16 a[160:161], v51 offset:4096
    ds_read_b64_tr_b16 a[162:163], v51 offset:6144
    ds_read_b64_tr_b16 a[164:165], v52 offset:4096
    ds_read_b64_tr_b16 a[166:167], v52 offset:6144
    s_add_u32 m0, s87, 40960
    s_add_u32 s37, s86, 3932160
    buffer_load_dwordx4 v40, s[12:15], s37 offen lds
    buffer_load_dwordx4 v41, s[12:15], s37 offen offset:1024 lds
    s_add_u32 m0, s87, 49152
    s_add_u32 s37, s86, 3934208
    buffer_load_dwordx4 v40, s[12:15], s37 offen lds
    buffer_load_dwordx4 v41, s[12:15], s37 offen offset:1024 lds
    s_add_u32 m0, s87, 57344
    s_add_u32 s37, s86, 3936256
    buffer_load_dwordx4 v40, s[12:15], s37 offen lds
    buffer_load_dwordx4 v41, s[12:15], s37 offen offset:1024 lds
    s_waitcnt lgkmcnt(0)
    v_mfma_f32_16x16x32_bf16 v[56:59], a[144:147], v[28:31], v[56:59]
    v_mfma_f32_16x16x32_bf16 v[60:63], a[148:151], v[28:31], v[60:63]
    v_mfma_f32_16x16x32_bf16 v[64:67], a[152:155], v[28:31], v[64:67]
    v_mfma_f32_16x16x32_bf16 v[56:59], a[156:159], v[28:31], v[56:59]
    v_mfma_f32_16x16x32_bf16 v[60:63], a[160:163], v[28:31], v[60:63]
    v_mfma_f32_16x16x32_bf16 v[64:67], a[164:167], v[28:31], v[64:67]
    v_add_u32 v50, 90112, v42
    v_add_u32 v51, 90112, v43
    v_add_u32 v52, 90112, v44
    s_waitcnt vmcnt(18)
    s_barrier
    ds_read_b64_tr_b16 a[168:169], v50 offset:0
    ds_read_b64_tr_b16 a[170:171], v50 offset:2048
    ds_read_b64_tr_b16 a[172:173], v51 offset:0
    ds_read_b64_tr_b16 a[174:175], v51 offset:2048
    ds_read_b64_tr_b16 a[176:177], v52 offset:0
    ds_read_b64_tr_b16 a[178:179], v52 offset:2048
    ds_read_b64_tr_b16 a[180:181], v50 offset:4096
    ds_read_b64_tr_b16 a[182:183], v50 offset:6144
    ds_read_b64_tr_b16 a[184:185], v51 offset:4096
    ds_read_b64_tr_b16 a[186:187], v51 offset:6144
    ds_read_b64_tr_b16 a[188:189], v52 offset:4096
    ds_read_b64_tr_b16 a[190:191], v52 offset:6144
    s_add_u32 m0, s87, 65536
    s_add_u32 s37, s86, 4325376
    buffer_load_dwordx4 v40, s[12:15], s37 offen lds
    buffer_load_dwordx4 v41, s[12:15], s37 offen offset:1024 lds
    s_add_u32 m0, s87, 73728
    s_add_u32 s37, s86, 4327424
    buffer_load_dwordx4 v40, s[12:15], s37 offen lds
    buffer_load_dwordx4 v41, s[12:15], s37 offen offset:1024 lds
    s_add_u32 m0, s87, 81920
    s_add_u32 s37, s86, 4329472
    buffer_load_dwordx4 v40, s[12:15], s37 offen lds
    buffer_load_dwordx4 v41, s[12:15], s37 offen offset:1024 lds
    s_waitcnt lgkmcnt(0)
    v_mfma_f32_16x16x32_bf16 v[56:59], a[168:171], v[28:31], v[56:59]
    v_mfma_f32_16x16x32_bf16 v[60:63], a[172:175], v[28:31], v[60:63]
    v_mfma_f32_16x16x32_bf16 v[64:67], a[176:179], v[28:31], v[64:67]
    v_mfma_f32_16x16x32_bf16 v[56:59], a[180:183], v[28:31], v[56:59]
    v_mfma_f32_16x16x32_bf16 v[60:63], a[184:187], v[28:31], v[60:63]
    v_mfma_f32_16x16x32_bf16 v[64:67], a[188:191], v[28:31], v[64:67]
    v_add_u32 v50, 114688, v42
    v_add_u32 v51, 114688, v43
    v_add_u32 v52, 114688, v44
    s_waitcnt vmcnt(18)
    s_barrier
    ds_read_b64_tr_b16 a[192:193], v50 offset:0
    ds_read_b64_tr_b16 a[194:195], v50 offset:2048
    ds_read_b64_tr_b16 a[196:197], v51 offset:0
    ds_read_b64_tr_b16 a[198:199], v51 offset:2048
    ds_read_b64_tr_b16 a[200:201], v52 offset:0
    ds_read_b64_tr_b16 a[202:203], v52 offset:2048
    ds_read_b64_tr_b16 a[204:205], v50 offset:4096
    ds_read_b64_tr_b16 a[206:207], v50 offset:6144
    ds_read_b64_tr_b16 a[208:209], v51 offset:4096
    ds_read_b64_tr_b16 a[210:211], v51 offset:6144
    ds_read_b64_tr_b16 a[212:213], v52 offset:4096
    ds_read_b64_tr_b16 a[214:215], v52 offset:6144
    s_mov_b32 s20, s82
    s_mov_b32 s21, s83
    s_mov_b32 s22, 0x100
    s_mov_b32 s23, 0x00020000
    v_and_b32 v8, 15, v0
    v_lshlrev_b32 v8, 4, v8
    buffer_load_dword v9, v8, s[20:23], 0 offen sc1
    s_add_u32 m0, s87, 90112
    s_add_u32 s37, s86, 4718592
    buffer_load_dwordx4 v40, s[12:15], s37 offen lds
    buffer_load_dwordx4 v41, s[12:15], s37 offen offset:1024 lds
    s_add_u32 m0, s87, 98304
    s_add_u32 s37, s86, 4720640
    buffer_load_dwordx4 v40, s[12:15], s37 offen lds
    buffer_load_dwordx4 v41, s[12:15], s37 offen offset:1024 lds
    s_add_u32 m0, s87, 106496
    s_add_u32 s37, s86, 4722688
    buffer_load_dwordx4 v40, s[12:15], s37 offen lds
    buffer_load_dwordx4 v41, s[12:15], s37 offen offset:1024 lds
    s_waitcnt lgkmcnt(0)
    v_mfma_f32_16x16x32_bf16 v[56:59], a[192:195], v[28:31], v[56:59]
    v_mfma_f32_16x16x32_bf16 v[60:63], a[196:199], v[28:31], v[60:63]
    v_mfma_f32_16x16x32_bf16 v[64:67], a[200:203], v[28:31], v[64:67]
    v_mfma_f32_16x16x32_bf16 v[56:59], a[204:207], v[28:31], v[56:59]
    v_mfma_f32_16x16x32_bf16 v[60:63], a[208:211], v[28:31], v[60:63]
    v_mfma_f32_16x16x32_bf16 v[64:67], a[212:215], v[28:31], v[64:67]
    v_add_u32 v50, 139264, v42
    v_add_u32 v51, 139264, v43
    v_add_u32 v52, 139264, v44
    s_waitcnt vmcnt(19)
    s_barrier
    ds_read_b64_tr_b16 a[216:217], v50 offset:0
    ds_read_b64_tr_b16 a[218:219], v50 offset:2048
    ds_read_b64_tr_b16 a[220:221], v51 offset:0
    ds_read_b64_tr_b16 a[222:223], v51 offset:2048
    ds_read_b64_tr_b16 a[224:225], v52 offset:0
    ds_read_b64_tr_b16 a[226:227], v52 offset:2048
    ds_read_b64_tr_b16 a[228:229], v50 offset:4096
    ds_read_b64_tr_b16 a[230:231], v50 offset:6144
    ds_read_b64_tr_b16 a[232:233], v51 offset:4096
    ds_read_b64_tr_b16 a[234:235], v51 offset:6144
    ds_read_b64_tr_b16 a[236:237], v52 offset:4096
    ds_read_b64_tr_b16 a[238:239], v52 offset:6144
    s_add_u32 m0, s87, 114688
    s_add_u32 s37, s86, 5111808
    buffer_load_dwordx4 v40, s[12:15], s37 offen lds
    buffer_load_dwordx4 v41, s[12:15], s37 offen offset:1024 lds
    s_add_u32 m0, s87, 122880
    s_add_u32 s37, s86, 5113856
    buffer_load_dwordx4 v40, s[12:15], s37 offen lds
    buffer_load_dwordx4 v41, s[12:15], s37 offen offset:1024 lds
    s_add_u32 m0, s87, 131072
    s_add_u32 s37, s86, 5115904
    buffer_load_dwordx4 v40, s[12:15], s37 offen lds
    buffer_load_dwordx4 v41, s[12:15], s37 offen offset:1024 lds
    s_waitcnt lgkmcnt(0)
    v_mfma_f32_16x16x32_bf16 v[56:59], a[216:219], v[28:31], v[56:59]
    v_mfma_f32_16x16x32_bf16 v[60:63], a[220:223], v[28:31], v[60:63]
    v_mfma_f32_16x16x32_bf16 v[64:67], a[224:227], v[28:31], v[64:67]
    v_mfma_f32_16x16x32_bf16 v[56:59], a[228:231], v[28:31], v[56:59]
    v_mfma_f32_16x16x32_bf16 v[60:63], a[232:235], v[28:31], v[60:63]
    v_mfma_f32_16x16x32_bf16 v[64:67], a[236:239], v[28:31], v[64:67]
    v_add_u32 v50, 40960, v42
    v_add_u32 v51, 40960, v43
    v_add_u32 v52, 40960, v44
    s_waitcnt vmcnt(19)
    s_barrier
    ds_read_b64_tr_b16 a[240:241], v50 offset:0
    ds_read_b64_tr_b16 a[242:243], v50 offset:2048
    ds_read_b64_tr_b16 a[244:245], v51 offset:0
    ds_read_b64_tr_b16 a[246:247], v51 offset:2048
    ds_read_b64_tr_b16 a[248:249], v52 offset:0
    ds_read_b64_tr_b16 a[250:251], v52 offset:2048
    ds_read_b64_tr_b16 a[252:253], v50 offset:4096
    ds_read_b64_tr_b16 a[254:255], v50 offset:6144
    ds_read_b64_tr_b16 v[128:129], v51 offset:4096
    ds_read_b64_tr_b16 v[130:131], v51 offset:6144
    ds_read_b64_tr_b16 v[132:133], v52 offset:4096
    ds_read_b64_tr_b16 v[134:135], v52 offset:6144
    s_add_u32 m0, s87, 139264
    s_add_u32 s37, s86, 5505024
    buffer_load_dwordx4 v40, s[12:15], s37 offen lds
    buffer_load_dwordx4 v41, s[12:15], s37 offen offset:1024 lds
    s_add_u32 m0, s87, 147456
    s_add_u32 s37, s86, 5507072
    buffer_load_dwordx4 v40, s[12:15], s37 offen lds
    buffer_load_dwordx4 v41, s[12:15], s37 offen offset:1024 lds
    s_add_u32 m0, s87, 155648
    s_add_u32 s37, s86, 5509120
    buffer_load_dwordx4 v40, s[12:15], s37 offen lds
    buffer_load_dwordx4 v41, s[12:15], s37 offen offset:1024 lds
    s_waitcnt lgkmcnt(0)
    v_mfma_f32_16x16x32_bf16 v[56:59], a[240:243], v[28:31], v[56:59]
    v_mfma_f32_16x16x32_bf16 v[60:63], a[244:247], v[28:31], v[60:63]
    v_mfma_f32_16x16x32_bf16 v[64:67], a[248:251], v[28:31], v[64:67]
    v_mfma_f32_16x16x32_bf16 v[56:59], a[252:255], v[28:31], v[56:59]
    v_mfma_f32_16x16x32_bf16 v[60:63], v[128:131], v[28:31], v[60:63]
    v_mfma_f32_16x16x32_bf16 v[64:67], v[132:135], v[28:31], v[64:67]
    v_add_u32 v50, 65536, v42
    v_add_u32 v51, 65536, v43
    v_add_u32 v52, 65536, v44
    s_waitcnt vmcnt(19)
    s_barrier
    ds_read_b64_tr_b16 v[136:137], v50 offset:0
    ds_read_b64_tr_b16 v[138:139], v50 offset:2048
    ds_read_b64_tr_b16 v[140:141], v51 offset:0
    ds_read_b64_tr_b16 v[142:143], v51 offset:2048
    ds_read_b64_tr_b16 v[144:145], v52 offset:0
    ds_read_b64_tr_b16 v[146:147], v52 offset:2048
    ds_read_b64_tr_b16 v[148:149], v50 offset:4096
    ds_read_b64_tr_b16 v[150:151], v50 offset:6144
    ds_read_b64_tr_b16 v[152:153], v51 offset:4096
    ds_read_b64_tr_b16 v[154:155], v51 offset:6144
    ds_read_b64_tr_b16 v[156:157], v52 offset:4096
    ds_read_b64_tr_b16 v[158:159], v52 offset:6144
    s_add_u32 m0, s87, 40960
    s_add_u32 s37, s86, 5898240
    buffer_load_dwordx4 v40, s[12:15], s37 offen lds
    buffer_load_dwordx4 v41, s[12:15], s37 offen offset:1024 lds
    s_add_u32 m0, s87, 49152
    s_add_u32 s37, s86, 5900288
    buffer_load_dwordx4 v40, s[12:15], s37 offen lds
    buffer_load_dwordx4 v41, s[12:15], s37 offen offset:1024 lds
    s_add_u32 m0, s87, 57344
    s_add_u32 s37, s86, 5902336
    buffer_load_dwordx4 v40, s[12:15], s37 offen lds
    buffer_load_dwordx4 v41, s[12:15], s37 offen offset:1024 lds
    s_waitcnt lgkmcnt(0)
    v_mfma_f32_16x16x32_bf16 v[56:59], v[136:139], v[28:31], v[56:59]
    v_mfma_f32_16x16x32_bf16 v[60:63], v[140:143], v[28:31], v[60:63]
    v_mfma_f32_16x16x32_bf16 v[64:67], v[144:147], v[28:31], v[64:67]
    v_mfma_f32_16x16x32_bf16 v[56:59], v[148:151], v[28:31], v[56:59]
    v_mfma_f32_16x16x32_bf16 v[60:63], v[152:155], v[28:31], v[60:63]
    v_mfma_f32_16x16x32_bf16 v[64:67], v[156:159], v[28:31], v[64:67]
    v_add_u32 v50, 90112, v42
    v_add_u32 v51, 90112, v43
    v_add_u32 v52, 90112, v44
    s_waitcnt vmcnt(18)
    s_barrier
    ds_read_b64_tr_b16 v[160:161], v50 offset:0
    ds_read_b64_tr_b16 v[162:163], v50 offset:2048
    ds_read_b64_tr_b16 v[164:165], v51 offset:0
    ds_read_b64_tr_b16 v[166:167], v51 offset:2048
    ds_read_b64_tr_b16 v[168:169], v52 offset:0
    ds_read_b64_tr_b16 v[170:171], v52 offset:2048
    ds_read_b64_tr_b16 v[172:173], v50 offset:4096
    ds_read_b64_tr_b16 v[174:175], v50 offset:6144
    ds_read_b64_tr_b16 v[176:177], v51 offset:4096
    ds_read_b64_tr_b16 v[178:179], v51 offset:6144
    ds_read_b64_tr_b16 v[180:181], v52 offset:4096
    ds_read_b64_tr_b16 v[182:183], v52 offset:6144
Lqkv_wa:
    v_cmp_gt_u32 vcc, 8, v9
    s_sub_u32 s43, s43, 1
    s_cmp_lt_i32 s43, 0
    s_cbranch_scc1 Lqkv_all
    s_cbranch_vccz Lqkv_all
    s_sleep 2
    buffer_load_dword v9, v8, s[20:23], 0 offen sc1
    s_waitcnt vmcnt(0)
    s_branch Lqkv_wa
Lqkv_all:
    s_mov_b32 s10, s6
    s_add_u32 m0, s34, 0
    s_nop 0
    buffer_load_dwordx4 v1, s[8:11], s33 offen offset:0 sc1 lds
    buffer_load_dwordx4 v1, s[8:11], s33 offen offset:1024 sc1 lds
    buffer_load_dwordx4 v1, s[8:11], s33 offen offset:2048 sc1 lds
    buffer_load_dwordx4 v1, s[8:11], s33 offen offset:3072 sc1 lds
    s_add_u32 m0, s34, 4096
    s_add_u32 s37, s33, 4096
    buffer_load_dwordx4 v1, s[8:11], s37 offen offset:0 sc1 lds
    buffer_load_dwordx4 v1, s[8:11], s37 offen offset:1024 sc1 lds
    buffer_load_dwordx4 v1, s[8:11], s37 offen offset:2048 sc1 lds
    buffer_load_dwordx4 v1, s[8:11], s37 offen offset:3072 sc1 lds
    s_add_u32 m0, s34, 8192
    s_add_u32 s37, s33, 8192
    buffer_load_dwordx4 v1, s[8:11], s37 offen offset:0 sc1 lds
    s_waitcnt lgkmcnt(0)
    v_mfma_f32_16x16x32_bf16 v[56:59], v[160:163], v[28:31], v[56:59]
    v_mfma_f32_16x16x32_bf16 v[60:63], v[164:167], v[28:31], v[60:63]
    v_mfma_f32_16x16x32_bf16 v[64:67], v[168:171], v[28:31], v[64:67]
    v_mfma_f32_16x16x32_bf16 v[56:59], v[172:175], v[28:31], v[56:59]
    v_mfma_f32_16x16x32_bf16 v[60:63], v[176:179], v[28:31], v[60:63]
    v_mfma_f32_16x16x32_bf16 v[64:67], v[180:183], v[28:31], v[64:67]
    v_add_u32 v50, 114688, v42
    v_add_u32 v51, 114688, v43
    v_add_u32 v52, 114688, v44
    s_waitcnt vmcnt(21)
    s_barrier
    ds_read_b64_tr_b16 v[184:185], v50 offset:0
    ds_read_b64_tr_b16 v[186:187], v50 offset:2048
    ds_read_b64_tr_b16 v[188:189], v51 offset:0
    ds_read_b64_tr_b16 v[190:191], v51 offset:2048
    ds_read_b64_tr_b16 v[192:193], v52 offset:0
    ds_read_b64_tr_b16 v[194:195], v52 offset:2048
    ds_read_b64_tr_b16 v[196:197], v50 offset:4096
    ds_read_b64_tr_b16 v[198:199], v50 offset:6144
    ds_read_b64_tr_b16 v[200:201], v51 offset:4096
    ds_read_b64_tr_b16 v[202:203], v51 offset:6144
    ds_read_b64_tr_b16 v[204:205], v52 offset:4096
    ds_read_b64_tr_b16 v[206:207], v52 offset:6144
    s_waitcnt lgkmcnt(0)
    v_mfma_f32_16x16x32_bf16 v[56:59], v[184:187], v[28:31], v[56:59]
    v_mfma_f32_16x16x32_bf16 v[60:63], v[188:191], v[28:31], v[60:63]
    v_mfma_f32_16x16x32_bf16 v[64:67], v[192:195], v[28:31], v[64:67]
    v_mfma_f32_16x16x32_bf16 v[56:59], v[196:199], v[28:31], v[56:59]
    v_mfma_f32_16x16x32_bf16 v[60:63], v[200:203], v[28:31], v[60:63]
    v_mfma_f32_16x16x32_bf16 v[64:67], v[204:207], v[28:31], v[64:67]
    v_add_u32 v50, 139264, v42
    v_add_u32 v51, 139264, v43
    v_add_u32 v52, 139264, v44
    s_waitcnt vmcnt(15)
    s_barrier
    ds_read_b64_tr_b16 v[208:209], v50 offset:0
    ds_read_b64_tr_b16 v[210:211], v50 offset:2048
    ds_read_b64_tr_b16 v[212:213], v51 offset:0
    ds_read_b64_tr_b16 v[214:215], v51 offset:2048
    ds_read_b64_tr_b16 v[216:217], v52 offset:0
    ds_read_b64_tr_b16 v[218:219], v52 offset:2048
    ds_read_b64_tr_b16 v[220:221], v50 offset:4096
    ds_read_b64_tr_b16 v[222:223], v50 offset:6144
    ds_read_b64_tr_b16 v[224:225], v51 offset:4096
    ds_read_b64_tr_b16 v[226:227], v51 offset:6144
    ds_read_b64_tr_b16 v[228:229], v52 offset:4096
    ds_read_b64_tr_b16 v[230:231], v52 offset:6144
    s_waitcnt lgkmcnt(0)
    v_mfma_f32_16x16x32_bf16 v[56:59], v[208:211], v[28:31], v[56:59]
    v_mfma_f32_16x16x32_bf16 v[60:63], v[212:215], v[28:31], v[60:63]
    v_mfma_f32_16x16x32_bf16 v[64:67], v[216:219], v[28:31], v[64:67]
    v_mfma_f32_16x16x32_bf16 v[56:59], v[220:223], v[28:31], v[56:59]
    v_mfma_f32_16x16x32_bf16 v[60:63], v[224:227], v[28:31], v[60:63]
    v_mfma_f32_16x16x32_bf16 v[64:67], v[228:231], v[28:31], v[64:67]
    v_add_u32 v50, 40960, v42
    v_add_u32 v51, 40960, v43
    v_add_u32 v52, 40960, v44
    s_waitcnt vmcnt(9)
    s_barrier
    ds_read_b64_tr_b16 v[232:233], v50 offset:0
    ds_read_b64_tr_b16 v[234:235], v50 offset:2048
    ds_read_b64_tr_b16 v[236:237], v51 offset:0
    ds_read_b64_tr_b16 v[238:239], v51 offset:2048
    ds_read_b64_tr_b16 v[240:241], v52 offset:0
    ds_read_b64_tr_b16 v[242:243], v52 offset:2048
    ds_read_b64_tr_b16 v[244:245], v50 offset:4096
    ds_read_b64_tr_b16 v[246:247], v50 offset:6144
    ds_read_b64_tr_b16 v[248:249], v51 offset:4096
    ds_read_b64_tr_b16 v[250:251], v51 offset:6144
    ds_read_b64_tr_b16 v[252:253], v52 offset:4096
    ds_read_b64_tr_b16 v[254:255], v52 offset:6144
    s_waitcnt lgkmcnt(0)
    v_mfma_f32_16x16x32_bf16 v[56:59], v[232:235], v[28:31], v[56:59]
    v_mfma_f32_16x16x32_bf16 v[60:63], v[236:239], v[28:31], v[60:63]
    v_mfma_f32_16x16x32_bf16 v[64:67], v[240:243], v[28:31], v[64:67]
    v_mfma_f32_16x16x32_bf16 v[56:59], v[244:247], v[28:31], v[56:59]
    v_mfma_f32_16x16x32_bf16 v[60:63], v[248:251], v[28:31], v[60:63]
    v_mfma_f32_16x16x32_bf16 v[64:67], v[252:255], v[28:31], v[64:67]
    s_mov_b32 s12, s84
    s_mov_b32 s13, s85
    s_mov_b32 s14, 0x6200000
    s_mov_b32 s15, 0x00020000
    s_waitcnt vmcnt(0)
    s_barrier
    ds_read_b128 v[40:43], v2 offset:0
    ds_read_b128 v[44:47], v2 offset:1024
    ds_read_b128 v[48:51], v2 offset:2048
    s_add_u32 s33, s33, 34816
    s_add_u32 s34, s34, 36864
    s_cmp_ge_u32 s34, 147456
    s_cselect_b32 s38, 147456, 0
    s_sub_u32 s34, s34, s38
    s_mov_b32 s10, s6
    s_add_u32 m0, s34, 0
    s_nop 0
    buffer_load_dwordx4 v1, s[8:11], s33 offen offset:0 sc1 lds
    buffer_load_dwordx4 v1, s[8:11], s33 offen offset:1024 sc1 lds
    buffer_load_dwordx4 v1, s[8:11], s33 offen offset:2048 sc1 lds
    buffer_load_dwordx4 v1, s[8:11], s33 offen offset:3072 sc1 lds
    s_add_u32 m0, s34, 4096
    s_add_u32 s37, s33, 4096
    buffer_load_dwordx4 v1, s[8:11], s37 offen offset:0 sc1 lds
    buffer_load_dwordx4 v1, s[8:11], s37 offen offset:1024 sc1 lds
    buffer_load_dwordx4 v1, s[8:11], s37 offen offset:2048 sc1 lds
    buffer_load_dwordx4 v1, s[8:11], s37 offen offset:3072 sc1 lds
    s_add_u32 m0, s34, 8192
    s_add_u32 s37, s33, 8192
    buffer_load_dwordx4 v1, s[8:11], s37 offen offset:0 sc1 lds
    s_mov_b32 s14, 0
    s_add_u32 s31, s31, 1
    s_sub_u32 s32, s31, 29
    s_min_i32 s32, s32, 32
    s_sub_u32 s54, s31, 3
    v_mov_b32 v6, s54
    s_min_i32 s39, s32, 31
    s_min_u32 s39, s39, 0x1000
    s_lshl_b32 s39, s39, 13
    s_branch Lqkv_g0
    .p2align 6
Lqkv_s1:
    s_waitcnt lgkmcnt(2)
    v_mfma_f32_16x16x32_bf16 v[24:27], a[0:3], v[40:43], 0
    ds_read_b128 v[52:55], v3 offset:3072
    s_add_u32 s35, s35, 36864
    v_mfma_f32_16x16x32_bf16 v[28:31], a[4:7], v[40:43], 0
    ds_read_b64 v[122:123], v37 offset:0
    v_mfma_f32_16x16x32_bf16 v[32:35], a[8:11], v[40:43], 0
    s_waitcnt lgkmcnt(3)
    s_waitcnt vmcnt(10)
    v_cmp_gt_i32 vcc, s32, v5
    v_mfma_f32_16x16x32_bf16 v[24:27], a[12:15], v[44:47], v[24:27]
    ds_read_b128 v[40:43], v3 offset:4096
    v_fma_f32 v16, -v68, v64, v16
    v_mfma_f32_16x16x32_bf16 v[28:31], a[16:19], v[44:47], v[28:31]
    s_and_b64 vcc, vcc, s[18:19]
    s_cbranch_scc1 Lqkv_slows1
Lqkv_backs1:
    v_mfma_f32_16x16x32_bf16 v[32:35], a[20:23], v[44:47], v[32:35]
    s_waitcnt lgkmcnt(3)
    buffer_load_dwordx4 v[96:99], v1, s[24:27], s41 offen sc1
    v_mfma_f32_16x16x32_bf16 v[24:27], a[24:27], v[48:51], v[24:27]
    ds_read_b128 v[44:47], v3 offset:5120
    s_waitcnt vmcnt(10)
    v_mfma_f32_16x16x32_bf16 v[28:31], a[28:31], v[48:51], v[28:31]
    s_mov_b32 s16, s39
    buffer_store_dword v6, v21, s[12:15], s17 offen sc1
    v_mfma_f32_16x16x32_bf16 v[32:35], a[32:35], v[48:51], v[32:35]
    s_waitcnt lgkmcnt(3)
    v_fma_f32 v17, -v68, v65, v17
    v_fma_f32 v18, -v68, v66, v18
    v_mfma_f32_16x16x32_bf16 v[24:27], a[36:39], v[52:55], v[24:27]
    ds_read_b128 v[48:51], v3 offset:6144
    s_waitcnt lgkmcnt(3)
    v_mfma_f32_16x16x32_bf16 v[28:31], a[40:43], v[52:55], v[28:31]
    s_cmp_ge_i32 s54, 0
    s_cselect_b32 s14, s6, 0
    v_add_f32 v122, v122, v120
    v_mfma_f32_16x16x32_bf16 v[32:35], a[44:47], v[52:55], v[32:35]
    s_waitcnt lgkmcnt(2)
    buffer_load_dword v5, v4, s[4:7], s16 offen sc1
    v_mfma_f32_16x16x32_bf16 v[24:27], a[48:51], v[40:43], v[24:27]
    ds_read_b128 v[52:55], v3 offset:7168
    v_add_f32 v123, v123, v121
    v_mfma_f32_16x16x32_bf16 v[28:31], a[52:55], v[40:43], v[28:31]
    s_add_u32 s33, s33, 34816
    v_max_f32 v22, v122, v123
    v_mov_b32 v23, v22
    v_mfma_f32_16x16x32_bf16 v[32:35], a[56:59], v[40:43], v[32:35]
    s_waitcnt lgkmcnt(2)
    v_permlane16_swap_b32 v22, v23
    v_mfma_f32_16x16x32_bf16 v[24:27], a[60:63], v[44:47], v[24:27]
    ds_read_b128 v[40:43], v3 offset:8192
    v_max_f32 v22, v22, v23
    v_mfma_f32_16x16x32_bf16 v[28:31], a[64:67], v[44:47], v[28:31]
    s_add_u32 s34, s34, 36864
    v_mov_b32 v23, v22
    v_fma_f32 v19, -v68, v67, v19
    v_mfma_f32_16x16x32_bf16 v[32:35], a[68:71], v[44:47], v[32:35]
    s_waitcnt lgkmcnt(2)
    v_permlane32_swap_b32 v22, v23
    v_mfma_f32_16x16x32_bf16 v[24:27], a[72:75], v[48:51], v[24:27]
    ds_read_b128 v[44:47], v3 offset:9216
    v_max_f32 v22, v22, v23
    v_mfma_f32_16x16x32_bf16 v[28:31], a[76:79], v[48:51], v[28:31]
    s_cmp_ge_u32 s34, 147456
    s_cselect_b32 s38, 147456, 0
    v_mul_f32 v22, s52, v22
    v_mfma_f32_16x16x32_bf16 v[32:35], a[80:83], v[48:51], v[32:35]
    s_waitcnt lgkmcnt(2)
    v_fma_f32 v122, v122, s52, -v22
    v_fma_f32 v123, v123, s52, -v22
    v_mfma_f32_16x16x32_bf16 v[24:27], a[84:87], v[52:55], v[24:27]
    ds_read_b128 v[48:51], v3 offset:10240
    v_mul_f32 v16, v16, v69
    v_mfma_f32_16x16x32_bf16 v[28:31], a[88:91], v[52:55], v[28:31]
    s_sub_u32 s34, s34, s38
    v_exp_f32 v122, v122
    v_mfma_f32_16x16x32_bf16 v[32:35], a[92:95], v[52:55], v[32:35]
    s_waitcnt lgkmcnt(2)
    v_exp_f32 v123, v123
    v_mfma_f32_16x16x32_bf16 v[24:27], a[96:99], v[40:43], v[24:27]
    ds_read_b128 v[52:55], v3 offset:11264
    v_add_f32 v22, v122, v123
    v_mfma_f32_16x16x32_bf16 v[28:31], a[100:103], v[40:43], v[28:31]
    s_add_u32 m0, s34, 0
    v_mov_b32 v23, v22
    v_mul_f32 v17, v17, v69
    v_mfma_f32_16x16x32_bf16 v[32:35], a[104:107], v[40:43], v[32:35]
    s_waitcnt lgkmcnt(2)
    v_permlane16_swap_b32 v22, v23
    v_mfma_f32_16x16x32_bf16 v[24:27], a[108:111], v[44:47], v[24:27]
    ds_read_b128 v[40:43], v3 offset:12288
    v_add_f32 v22, v22, v23
    v_mfma_f32_16x16x32_bf16 v[28:31], a[112:115], v[44:47], v[28:31]
    s_add_u32 s17, s17, 8192
    v_mov_b32 v23, v22
    v_mul_f32 v18, v18, v69
    v_mfma_f32_16x16x32_bf16 v[32:35], a[116:119], v[44:47], v[32:35]
    s_waitcnt lgkmcnt(2)
    v_permlane32_swap_b32 v22, v23
    v_mfma_f32_16x16x32_bf16 v[24:27], a[120:123], v[48:51], v[24:27]
    ds_read_b128 v[44:47], v3 offset:13312
    v_add_f32 v22, v22, v23
    v_mfma_f32_16x16x32_bf16 v[28:31], a[124:127], v[48:51], v[28:31]
    s_add_u32 s41, s41, 262144
    v_rcp_f32 v22, v22
    v_mfma_f32_16x16x32_bf16 v[32:35], a[128:131], v[48:51], v[32:35]
    s_waitcnt lgkmcnt(2)
    v_mul_f32 v122, v122, v22
    v_mul_f32 v123, v123, v22
    v_mfma_f32_16x16x32_bf16 v[24:27], a[132:135], v[52:55], v[24:27]
    ds_read_b128 v[48:51], v3 offset:14336
    v_cvt_pk_bf16_f32 v23, v122, v123
    v_mfma_f32_16x16x32_bf16 v[28:31], a[136:139], v[52:55], v[28:31]
    s_cmp_eq_u32 s35, 147456
    s_cselect_b32 s35, 0, s35
    v_perm_b32 v116, v23, v23, v102
    v_mfma_f32_16x16x32_bf16 v[32:35], a[140:143], v[52:55], v[32:35]
    s_waitcnt lgkmcnt(2)
    v_perm_b32 v117, v23, v23, v103
    v_perm_b32 v114, v23, v23, v104
    v_mfma_f32_16x16x32_bf16 v[24:27], a[144:147], v[40:43], v[24:27]
    ds_read_b128 v[52:55], v3 offset:15360
    v_perm_b32 v115, v23, v23, v105
    v_mfma_f32_16x16x32_bf16 v[28:31], a[148:151], v[40:43], v[28:31]
    s_add_u32 s31, s31, 1
    v_mov_b32 v106, s42
    v_mov_b32 v107, s42
    v_mfma_f32_16x16x32_bf16 v[72:75], v[92:95], v[114:117], 0
    s_sub_u32 s32, s31, 29
    v_mov_b32 v108, s42
    v_mov_b32 v109, s42
    v_mfma_f32_16x16x32_bf16 v[32:35], a[152:155], v[40:43], v[32:35]
    s_waitcnt lgkmcnt(2)
    v_fma_f32 v12, -v68, v60, v12
    v_fma_f32 v13, -v68, v61, v13
    v_mfma_f32_16x16x32_bf16 v[24:27], a[156:159], v[44:47], v[24:27]
    ds_read_b128 v[40:43], v3 offset:16384
    v_cvt_pk_bf16_f32 v114, v72, v73
    v_mfma_f32_16x16x32_bf16 v[28:31], a[160:163], v[44:47], v[28:31]
    s_min_i32 s32, s32, 32
    v_cvt_pk_bf16_f32 v115, v74, v75
    v_cvt_pk_bf16_f32 v116, v72, v73
    v_mfma_f32_16x16x32_bf16 v[32:35], a[164:167], v[44:47], v[32:35]
    s_waitcnt lgkmcnt(2)
    v_cvt_pk_bf16_f32 v117, v74, v75
    v_fma_f32 v14, -v68, v62, v14
    v_mfma_f32_16x16x32_bf16 v[24:27], a[168:171], v[48:51], v[24:27]
    ds_read_b128 v[44:47], v3 offset:17408
    v_fma_f32 v15, -v68, v63, v15
    v_mfma_f32_16x16x32_bf16 v[28:31], a[172:175], v[48:51], v[28:31]
    s_sub_u32 s54, s31, 3
    v_permlane32_swap_b32 v114, v116
    v_mfma_f32_16x16x32_bf16 v[32:35], a[176:179], v[48:51], v[32:35]
    s_waitcnt lgkmcnt(2)
    v_permlane32_swap_b32 v115, v117
    v_mfma_f32_16x16x32_bf16 v[24:27], a[180:183], v[52:55], v[24:27]
    ds_read_b128 v[48:51], v3 offset:18432
    v_mul_f32 v12, v12, v69
    v_mfma_f32_16x16x32_bf16 v[28:31], a[184:187], v[52:55], v[28:31]
    buffer_store_dwordx4 v[114:117], v7, s[12:15], s36 offen sc1
    v_mul_f32 v13, v13, v69
    v_mfma_f32_16x16x32_bf16 v[32:35], a[188:191], v[52:55], v[32:35]
    s_waitcnt lgkmcnt(2)
    v_mul_f32 v14, v14, v69
    v_mul_f32 v15, v15, v69
    v_mfma_f32_16x16x32_bf16 v[24:27], a[192:195], v[40:43], v[24:27]
    ds_read_b128 v[52:55], v3 offset:19456
    v_cvt_pk_bf16_f32 v84, v12, v13
    v_mfma_f32_16x16x32_bf16 v[28:31], a[196:199], v[40:43], v[28:31]
    s_add_u32 s36, s36, 32768
    v_cvt_pk_bf16_f32 v85, v14, v15
    s_waitcnt vmcnt(3)
    v_mfma_f32_16x16x32_bf16 v[106:109], v[96:99], v[88:91], v[106:109]
    v_fma_f32 v8, -v68, v56, v8
    v_fma_f32 v9, -v68, v57, v9
    v_mfma_f32_16x16x32_bf16 v[32:35], a[200:203], v[40:43], v[32:35]
    s_waitcnt lgkmcnt(2)
    v_fma_f32 v10, -v68, v58, v10
    v_fma_f32 v11, -v68, v59, v11
    v_mfma_f32_16x16x32_bf16 v[24:27], a[204:207], v[44:47], v[24:27]
    ds_read_b128 v[40:43], v3 offset:20480
    v_mul_f32 v8, v8, v69
    v_mfma_f32_16x16x32_bf16 v[28:31], a[208:211], v[44:47], v[28:31]
    v_mul_f32 v9, v9, v69
    v_mul_f32 v10, v10, v69
    v_mfma_f32_16x16x32_bf16 v[32:35], a[212:215], v[44:47], v[32:35]
    s_waitcnt lgkmcnt(2)
    v_mul_f32 v11, v11, v69
    v_cvt_pk_bf16_f32 v88, v8, v9
    v_mfma_f32_16x16x32_bf16 v[24:27], a[216:219], v[48:51], v[24:27]
    ds_read_b128 v[44:47], v3 offset:21504
    v_cvt_pk_bf16_f32 v89, v10, v11
    v_mfma_f32_16x16x32_bf16 v[28:31], a[220:223], v[48:51], v[28:31]
    v_mul_f32 v19, v19, v69
    v_cvt_pk_bf16_f32 v16, v16, v17
    v_mfma_f32_16x16x32_bf16 v[110:113], v[84:87], v[88:91], 0
    v_cndmask_b32 v106, v106, v107, s[44:45]
    v_cndmask_b32 v108, v108, v109, s[44:45]
    v_mfma_f32_16x16x32_bf16 v[32:35], a[224:227], v[48:51], v[32:35]
    s_waitcnt lgkmcnt(2)
    v_cndmask_b32 v120, v106, v118, s[48:49]
    v_cndmask_b32 v121, v108, v119, s[50:51]
    v_mfma_f32_16x16x32_bf16 v[24:27], a[228:231], v[52:55], v[24:27]
    ds_read_b128 v[48:51], v3 offset:22528
    v_cvt_pk_bf16_f32 v17, v18, v19
    v_mfma_f32_16x16x32_bf16 v[28:31], a[232:235], v[52:55], v[28:31]
    ds_write_b64 v36, v[120:121] offset:2048
    v_mfma_f32_16x16x32_bf16 v[32:35], a[236:239], v[52:55], v[32:35]
    s_waitcnt lgkmcnt(3)
    v_cndmask_b32 v118, v110, v111, s[44:45]
    v_cndmask_b32 v119, v112, v113, s[44:45]
    v_mfma_f32_16x16x32_bf16 v[24:27], a[240:243], v[40:43], v[24:27]
    ds_read_b128 v[52:55], v3 offset:23552
    v_sub_u32 v76, v3, v20
    v_mfma_f32_16x16x32_bf16 v[28:31], a[244:247], v[40:43], v[28:31]
    ds_write_b64 v38, v[16:17]
    v_mfma_f32_16x16x32_bf16 v[32:35], a[248:251], v[40:43], v[32:35]
    s_waitcnt lgkmcnt(4)
    buffer_load_dwordx4 v1, s[8:11], s33 offen offset:0 sc1 lds
    v_mfma_f32_16x16x32_bf16 v[24:27], a[252:255], v[44:47], v[24:27]
    ds_read_b128 v[40:43], v3 offset:24576
    v_add_u32 v2, s35, v1
    v_mfma_f32_16x16x32_bf16 v[28:31], v[128:131], v[44:47], v[28:31]
    ds_read_b64_tr_b16 v[92:93], v39
    v_mov_b32 v8, v84
    v_mfma_f32_16x16x32_bf16 v[32:35], v[132:135], v[44:47], v[32:35]
    s_waitcnt lgkmcnt(5)
    v_mov_b32 v9, v85
    v_mov_b32 v6, s54
    v_mfma_f32_16x16x32_bf16 v[24:27], v[136:139], v[48:51], v[24:27]
    ds_read_b128 v[44:47], v3 offset:25600
    s_min_i32 s39, s32, 31
    v_mfma_f32_16x16x32_bf16 v[28:31], v[140:143], v[48:51], v[28:31]
    ds_read2st64_b64 v[80:83], v76 offset0:66 offset1:67
    s_min_u32 s39, s39, 0x1000
    v_mfma_f32_16x16x32_bf16 v[32:35], v[144:147], v[48:51], v[32:35]
    s_waitcnt lgkmcnt(5)
    buffer_load_dwordx4 v1, s[8:11], s33 offen offset:1024 sc1 lds
    v_mfma_f32_16x16x32_bf16 v[24:27], v[148:151], v[52:55], v[24:27]
    ds_read_b128 v[48:51], v3 offset:26624
    s_waitcnt lgkmcnt(3)
    v_mfma_f32_16x16x32_bf16 v[28:31], v[152:155], v[52:55], v[28:31]
    ds_read2st64_b64 v[76:79], v76 offset0:64 offset1:65
    v_mov_b32 v10, v92
    v_mfma_f32_16x16x32_bf16 v[32:35], v[156:159], v[52:55], v[32:35]
    s_lshl_b32 s39, s39, 13
    v_mov_b32 v11, v93
    v_mfma_f32_16x16x32_bf16 v[24:27], v[160:163], v[40:43], v[24:27]
    ds_read_b128 v[52:55], v3 offset:27648
    v_mfma_f32_16x16x32_bf16 v[28:31], v[164:167], v[40:43], v[28:31]
    buffer_store_dwordx4 v[8:11], v1, s[4:7], s40 offen sc1
    s_add_u32 s40, s40, 262144
    v_mfma_f32_16x16x32_bf16 v[32:35], v[168:171], v[40:43], v[32:35]
    s_waitcnt lgkmcnt(4)
    v_mfma_f32_16x16x32_bf16 v[24:27], v[172:175], v[44:47], v[24:27]
    ds_read_b128 v[40:43], v3 offset:28672
    v_mfma_f32_16x16x32_bf16 v[28:31], v[176:179], v[44:47], v[28:31]
    v_mfma_f32_16x16x32_bf16 v[32:35], v[180:183], v[44:47], v[32:35]
    s_waitcnt lgkmcnt(3)
    buffer_load_dwordx4 v1, s[8:11], s33 offen offset:2048 sc1 lds
    v_mfma_f32_16x16x32_bf16 v[24:27], v[184:187], v[48:51], v[24:27]
    ds_read_b128 v[44:47], v3 offset:29696
    v_mfma_f32_16x16x32_bf16 v[28:31], v[188:191], v[48:51], v[28:31]
    v_mfma_f32_16x16x32_bf16 v[32:35], v[192:195], v[48:51], v[32:35]
    s_waitcnt lgkmcnt(2)
    v_add_f32 v76, v76, v80
    v_add_f32 v77, v77, v81
    v_mfma_f32_16x16x32_bf16 v[24:27], v[196:199], v[52:55], v[24:27]
    ds_read_b128 v[48:51], v3 offset:30720
    v_add_f32 v78, v78, v82
    v_mfma_f32_16x16x32_bf16 v[28:31], v[200:203], v[52:55], v[28:31]
    s_barrier
    v_mfma_f32_16x16x32_bf16 v[32:35], v[204:207], v[52:55], v[32:35]
    s_waitcnt lgkmcnt(2)
    buffer_load_dwordx4 v1, s[8:11], s33 offen offset:3072 sc1 lds
    v_mfma_f32_16x16x32_bf16 v[24:27], v[208:211], v[40:43], v[24:27]
    ds_read_b128 v[52:55], v3 offset:31744
    v_add_f32 v79, v79, v83
    v_mfma_f32_16x16x32_bf16 v[28:31], v[212:215], v[40:43], v[28:31]
    s_add_u32 m0, s34, 4096
    v_add_f32 v70, v76, v78
    v_add_f32 v71, v77, v79
    v_mfma_f32_16x16x32_bf16 v[32:35], v[216:219], v[40:43], v[32:35]
    s_waitcnt lgkmcnt(2)
    v_permlane16_swap_b32 v70, v71
    v_mfma_f32_16x16x32_bf16 v[24:27], v[220:223], v[44:47], v[24:27]
    ds_read_b128 v[40:43], v2 offset:0
    v_add_f32 v70, v70, v71
    v_mfma_f32_16x16x32_bf16 v[28:31], v[224:227], v[44:47], v[28:31]
    s_add_u32 s37, s33, 4096
    v_mov_b32 v71, v70
    v_mfma_f32_16x16x32_bf16 v[32:35], v[228:231], v[44:47], v[32:35]
    s_waitcnt lgkmcnt(2)
    buffer_load_dwordx4 v1, s[8:11], s37 offen offset:0 sc1 lds
    v_mfma_f32_16x16x32_bf16 v[24:27], v[232:235], v[48:51], v[24:27]
    ds_read_b128 v[44:47], v2 offset:1024
    v_mfma_f32_16x16x32_bf16 v[28:31], v[236:239], v[48:51], v[28:31]
    v_permlane32_swap_b32 v70, v71
    v_mfma_f32_16x16x32_bf16 v[32:35], v[240:243], v[48:51], v[32:35]
    s_waitcnt lgkmcnt(2)
    v_add_f32 v70, v70, v71
    v_mul_f32 v70, 0x3a800000, v70
    v_mfma_f32_16x16x32_bf16 v[24:27], v[244:247], v[52:55], v[24:27]
    ds_read_b128 v[48:51], v2 offset:2048
    v_mov_b32 v71, v70
    v_mfma_f32_16x16x32_bf16 v[28:31], v[248:251], v[52:55], v[28:31]
    buffer_load_dwordx4 v1, s[8:11], s37 offen offset:1024 sc1 lds
    v_mfma_f32_16x16x32_bf16 v[32:35], v[252:255], v[52:55], v[32:35]
    buffer_load_dwordx4 v1, s[8:11], s37 offen offset:2048 sc1 lds
    v_permlane16_swap_b32 v70, v71
    v_fma_f32 v71, -v70, v70, v71
    v_max_f32 v71, 0, v71
    v_add_f32 v71, 0x3727c5ac, v71
    v_rsq_f32 v71, v71
    buffer_load_dwordx4 v1, s[8:11], s37 offen offset:3072 sc1 lds
    s_add_u32 m0, s34, 8192
    s_add_u32 s37, s33, 8192
    buffer_load_dwordx4 v1, s[8:11], s37 offen offset:0 sc1 lds
Lqkv_s0:
    s_waitcnt lgkmcnt(2)
    v_mfma_f32_16x16x32_bf16 v[8:11], a[0:3], v[40:43], 0
    ds_read_b128 v[52:55], v2 offset:3072
    s_add_u32 s35, s35, 36864
    v_mfma_f32_16x16x32_bf16 v[12:15], a[4:7], v[40:43], 0
    ds_read_b64 v[122:123], v37 offset:2048
    v_mfma_f32_16x16x32_bf16 v[16:19], a[8:11], v[40:43], 0
    s_waitcnt lgkmcnt(3)
    s_waitcnt vmcnt(11)
    v_cmp_gt_i32 vcc, s32, v5
    v_mfma_f32_16x16x32_bf16 v[8:11], a[12:15], v[44:47], v[8:11]
    ds_read_b128 v[40:43], v2 offset:4096
    v_fma_f32 v28, -v70, v60, v28
    v_mfma_f32_16x16x32_bf16 v[12:15], a[16:19], v[44:47], v[12:15]
    s_and_b64 vcc, vcc, s[18:19]
    s_cbranch_scc1 Lqkv_slows0
Lqkv_backs0:
    v_mfma_f32_16x16x32_bf16 v[16:19], a[20:23], v[44:47], v[16:19]
    s_waitcnt lgkmcnt(3)
    v_fma_f32 v29, -v70, v61, v29
    v_fma_f32 v30, -v70, v62, v30
    v_mfma_f32_16x16x32_bf16 v[8:11], a[24:27], v[48:51], v[8:11]
    ds_read_b128 v[44:47], v2 offset:5120
    s_waitcnt vmcnt(10)
    v_mfma_f32_16x16x32_bf16 v[12:15], a[28:31], v[48:51], v[12:15]
    s_mov_b32 s16, s39
    buffer_store_dword v6, v21, s[12:15], s17 offen sc1
    v_mfma_f32_16x16x32_bf16 v[16:19], a[32:35], v[48:51], v[16:19]
    s_waitcnt lgkmcnt(3)
    buffer_load_dword v5, v4, s[4:7], s16 offen sc1
    v_mfma_f32_16x16x32_bf16 v[8:11], a[36:39], v[52:55], v[8:11]
    ds_read_b128 v[48:51], v2 offset:6144
    s_waitcnt lgkmcnt(3)
    v_mfma_f32_16x16x32_bf16 v[12:15], a[40:43], v[52:55], v[12:15]
    s_add_u32 s33, s33, 34816
    v_add_f32 v122, v122, v120
    v_add_f32 v123, v123, v121
    v_mfma_f32_16x16x32_bf16 v[16:19], a[44:47], v[52:55], v[16:19]
    s_waitcnt lgkmcnt(2)
    v_max_f32 v22, v122, v123
    v_mov_b32 v23, v22
    v_mfma_f32_16x16x32_bf16 v[8:11], a[48:51], v[40:43], v[8:11]
    ds_read_b128 v[52:55], v2 offset:7168
    v_fma_f32 v31, -v70, v63, v31
    v_mfma_f32_16x16x32_bf16 v[12:15], a[52:55], v[40:43], v[12:15]
    s_add_u32 s34, s34, 36864
    v_permlane16_swap_b32 v22, v23
    v_mfma_f32_16x16x32_bf16 v[16:19], a[56:59], v[40:43], v[16:19]
    s_waitcnt lgkmcnt(2)
    v_max_f32 v22, v22, v23
    v_mov_b32 v23, v22
    v_mfma_f32_16x16x32_bf16 v[8:11], a[60:63], v[44:47], v[8:11]
    ds_read_b128 v[40:43], v2 offset:8192
    v_mul_f32 v28, v28, v71
    v_mfma_f32_16x16x32_bf16 v[12:15], a[64:67], v[44:47], v[12:15]
    s_cmp_ge_u32 s34, 147456
    s_cselect_b32 s38, 147456, 0
    v_mul_f32 v29, v29, v71
    v_mfma_f32_16x16x32_bf16 v[16:19], a[68:71], v[44:47], v[16:19]
    s_waitcnt lgkmcnt(2)
    v_permlane32_swap_b32 v22, v23
    v_mfma_f32_16x16x32_bf16 v[8:11], a[72:75], v[48:51], v[8:11]
    ds_read_b128 v[44:47], v2 offset:9216
    v_max_f32 v22, v22, v23
    v_mfma_f32_16x16x32_bf16 v[12:15], a[76:79], v[48:51], v[12:15]
    s_sub_u32 s34, s34, s38
    v_mul_f32 v22, s52, v22
    v_fma_f32 v122, v122, s52, -v22
    v_mfma_f32_16x16x32_bf16 v[16:19], a[80:83], v[48:51], v[16:19]
    s_waitcnt lgkmcnt(2)
    v_fma_f32 v123, v123, s52, -v22
    v_mul_f32 v30, v30, v71
    v_mfma_f32_16x16x32_bf16 v[8:11], a[84:87], v[52:55], v[8:11]
    ds_read_b128 v[48:51], v2 offset:10240
    v_mul_f32 v31, v31, v71
    v_mfma_f32_16x16x32_bf16 v[12:15], a[88:91], v[52:55], v[12:15]
    s_add_u32 m0, s34, 0
    v_exp_f32 v122, v122
    v_mfma_f32_16x16x32_bf16 v[16:19], a[92:95], v[52:55], v[16:19]
    s_waitcnt lgkmcnt(2)
    v_exp_f32 v123, v123
    v_mfma_f32_16x16x32_bf16 v[8:11], a[96:99], v[40:43], v[8:11]
    ds_read_b128 v[52:55], v2 offset:11264
    v_add_f32 v22, v122, v123
    v_mfma_f32_16x16x32_bf16 v[12:15], a[100:103], v[40:43], v[12:15]
    s_cmp_ge_i32 s54, 0
    s_cselect_b32 s14, s6, 0
    v_mov_b32 v23, v22
    v_mfma_f32_16x16x32_bf16 v[16:19], a[104:107], v[40:43], v[16:19]
    s_waitcnt lgkmcnt(2)
    v_permlane16_swap_b32 v22, v23
    v_mfma_f32_16x16x32_bf16 v[8:11], a[108:111], v[44:47], v[8:11]
    ds_read_b128 v[40:43], v2 offset:12288
    v_add_f32 v22, v22, v23
    v_mfma_f32_16x16x32_bf16 v[12:15], a[112:115], v[44:47], v[12:15]
    s_add_u32 s17, s17, 8192
    v_mov_b32 v23, v22
    v_cvt_pk_bf16_f32 v84, v28, v29
    v_mfma_f32_16x16x32_bf16 v[16:19], a[116:119], v[44:47], v[16:19]
    s_waitcnt lgkmcnt(2)
    v_permlane32_swap_b32 v22, v23
    v_mfma_f32_16x16x32_bf16 v[8:11], a[120:123], v[48:51], v[8:11]
    ds_read_b128 v[44:47], v2 offset:13312
    v_add_f32 v22, v22, v23
    v_mfma_f32_16x16x32_bf16 v[12:15], a[124:127], v[48:51], v[12:15]
    s_cmp_eq_u32 s35, 147456
    s_cselect_b32 s35, 0, s35
    v_cvt_pk_bf16_f32 v85, v30, v31
    v_mfma_f32_16x16x32_bf16 v[16:19], a[128:131], v[48:51], v[16:19]
    s_waitcnt lgkmcnt(2)
    v_rcp_f32 v22, v22
    v_mfma_f32_16x16x32_bf16 v[106:109], v[84:87], v[88:91], 0
    s_add_u32 s31, s31, 1
    v_mul_f32 v122, v122, v22
    v_mul_f32 v123, v123, v22
    v_mfma_f32_16x16x32_bf16 v[8:11], a[132:135], v[52:55], v[8:11]
    ds_read_b128 v[48:51], v2 offset:14336
    v_cvt_pk_bf16_f32 v23, v122, v123
    v_mfma_f32_16x16x32_bf16 v[12:15], a[136:139], v[52:55], v[12:15]
    s_sub_u32 s32, s31, 29
    v_perm_b32 v114, v23, v23, v102
    v_perm_b32 v115, v23, v23, v103
    v_mfma_f32_16x16x32_bf16 v[16:19], a[140:143], v[52:55], v[16:19]
    s_waitcnt lgkmcnt(2)
    v_perm_b32 v116, v23, v23, v104
    v_perm_b32 v117, v23, v23, v105
    v_mfma_f32_16x16x32_bf16 v[8:11], a[144:147], v[40:43], v[8:11]
    ds_read_b128 v[52:55], v2 offset:15360
    v_mov_b32 v100, v94
    v_mfma_f32_16x16x32_bf16 v[12:15], a[148:151], v[40:43], v[12:15]
    s_min_i32 s32, s32, 32
    v_mov_b32 v101, v95
    v_fma_f32 v24, -v70, v56, v24
    v_mfma_f32_16x16x32_bf16 v[16:19], a[152:155], v[40:43], v[16:19]
    s_waitcnt lgkmcnt(2)
    v_fma_f32 v25, -v70, v57, v25
    v_fma_f32 v26, -v70, v58, v26
    v_mfma_f32_16x16x32_bf16 v[72:75], v[98:101], v[114:117], 0
    s_sub_u32 s54, s31, 3
    v_fma_f32 v27, -v70, v59, v27
    v_mul_f32 v24, v24, v71
    v_mfma_f32_16x16x32_bf16 v[8:11], a[156:159], v[44:47], v[8:11]
    ds_read_b128 v[40:43], v2 offset:16384
    v_mul_f32 v25, v25, v71
    v_mfma_f32_16x16x32_bf16 v[12:15], a[160:163], v[44:47], v[12:15]
    v_mul_f32 v26, v26, v71
    v_cvt_pk_bf16_f32 v114, v72, v73
    v_mfma_f32_16x16x32_bf16 v[16:19], a[164:167], v[44:47], v[16:19]
    s_waitcnt lgkmcnt(2)
    v_cvt_pk_bf16_f32 v115, v74, v75
    v_cvt_pk_bf16_f32 v116, v72, v73
    v_mfma_f32_16x16x32_bf16 v[8:11], a[168:171], v[48:51], v[8:11]
    ds_read_b128 v[44:47], v2 offset:17408
    v_cvt_pk_bf16_f32 v117, v74, v75
    v_mfma_f32_16x16x32_bf16 v[12:15], a[172:175], v[48:51], v[12:15]
    v_permlane32_swap_b32 v114, v116
    v_mfma_f32_16x16x32_bf16 v[16:19], a[176:179], v[48:51], v[16:19]
    s_waitcnt lgkmcnt(2)
    v_permlane32_swap_b32 v115, v117
    v_mfma_f32_16x16x32_bf16 v[8:11], a[180:183], v[52:55], v[8:11]
    ds_read_b128 v[48:51], v2 offset:18432
    v_mul_f32 v27, v27, v71
    v_mfma_f32_16x16x32_bf16 v[12:15], a[184:187], v[52:55], v[12:15]
    buffer_store_dwordx4 v[114:117], v7, s[12:15], s36 offen sc1
    v_cvt_pk_bf16_f32 v88, v24, v25
    v_mfma_f32_16x16x32_bf16 v[16:19], a[188:191], v[52:55], v[16:19]
    s_waitcnt lgkmcnt(2)
    v_cvt_pk_bf16_f32 v89, v26, v27
    v_fma_f32 v32, -v70, v64, v32
    v_mfma_f32_16x16x32_bf16 v[8:11], a[192:195], v[40:43], v[8:11]
    ds_read_b128 v[52:55], v2 offset:19456
    v_fma_f32 v33, -v70, v65, v33
    v_mfma_f32_16x16x32_bf16 v[110:113], v[84:87], v[88:91], 0
    s_add_u32 s36, s36, 32768
    v_cndmask_b32 v106, v106, v107, s[44:45]
    v_cndmask_b32 v108, v108, v109, s[44:45]
    v_mfma_f32_16x16x32_bf16 v[12:15], a[196:199], v[40:43], v[12:15]
    v_cndmask_b32 v120, v106, v118, s[48:49]
    v_cndmask_b32 v121, v108, v119, s[50:51]
    v_mfma_f32_16x16x32_bf16 v[16:19], a[200:203], v[40:43], v[16:19]
    s_waitcnt lgkmcnt(2)
    ds_write_b64 v36, v[120:121] offset:0
    v_mfma_f32_16x16x32_bf16 v[8:11], a[204:207], v[44:47], v[8:11]
    ds_read_b128 v[40:43], v2 offset:20480
    v_cndmask_b32 v118, v110, v111, s[44:45]
    v_mfma_f32_16x16x32_bf16 v[12:15], a[208:211], v[44:47], v[12:15]
    v_cndmask_b32 v119, v112, v113, s[44:45]
    v_fma_f32 v34, -v70, v66, v34
    v_mfma_f32_16x16x32_bf16 v[16:19], a[212:215], v[44:47], v[16:19]
    s_waitcnt lgkmcnt(3)
    v_fma_f32 v35, -v70, v67, v35
    v_mul_f32 v32, v32, v71
    v_mfma_f32_16x16x32_bf16 v[8:11], a[216:219], v[48:51], v[8:11]
    ds_read_b128 v[44:47], v2 offset:21504
    v_mul_f32 v33, v33, v71
    v_mfma_f32_16x16x32_bf16 v[12:15], a[220:223], v[48:51], v[12:15]
    v_mul_f32 v34, v34, v71
    v_mul_f32 v35, v35, v71
    v_mfma_f32_16x16x32_bf16 v[16:19], a[224:227], v[48:51], v[16:19]
    s_waitcnt lgkmcnt(3)
    v_cvt_pk_bf16_f32 v32, v32, v33
    v_cvt_pk_bf16_f32 v33, v34, v35
    v_mfma_f32_16x16x32_bf16 v[8:11], a[228:231], v[52:55], v[8:11]
    ds_read_b128 v[48:51], v2 offset:22528
    v_sub_u32 v76, v2, v20
    v_mfma_f32_16x16x32_bf16 v[12:15], a[232:235], v[52:55], v[12:15]
    ds_write_b64 v38, v[32:33]
    v_mfma_f32_16x16x32_bf16 v[16:19], a[236:239], v[52:55], v[16:19]
    s_waitcnt lgkmcnt(3)
    buffer_load_dwordx4 v1, s[8:11], s33 offen offset:0 sc1 lds
    v_mfma_f32_16x16x32_bf16 v[8:11], a[240:243], v[40:43], v[8:11]
    ds_read_b128 v[52:55], v2 offset:23552
    v_add_u32 v3, s35, v1
    v_mfma_f32_16x16x32_bf16 v[12:15], a[244:247], v[40:43], v[12:15]
    ds_read_b64_tr_b16 v[94:95], v39
    v_mov_b32 v6, s54
    v_mfma_f32_16x16x32_bf16 v[16:19], a[248:251], v[40:43], v[16:19]
    s_waitcnt lgkmcnt(4)
    ds_read2st64_b64 v[80:83], v76 offset0:66 offset1:67
    v_mfma_f32_16x16x32_bf16 v[8:11], a[252:255], v[44:47], v[8:11]
    ds_read_b128 v[40:43], v2 offset:24576
    s_min_i32 s39, s32, 31
    v_mfma_f32_16x16x32_bf16 v[12:15], v[128:131], v[44:47], v[12:15]
    ds_read2st64_b64 v[76:79], v76 offset0:64 offset1:65
    s_min_u32 s39, s39, 0x1000
    v_mfma_f32_16x16x32_bf16 v[16:19], v[132:135], v[44:47], v[16:19]
    s_waitcnt lgkmcnt(6)
    buffer_load_dwordx4 v1, s[8:11], s33 offen offset:1024 sc1 lds
    v_mfma_f32_16x16x32_bf16 v[8:11], v[136:139], v[48:51], v[8:11]
    ds_read_b128 v[44:47], v2 offset:25600
    s_lshl_b32 s39, s39, 13
    v_mfma_f32_16x16x32_bf16 v[12:15], v[140:143], v[48:51], v[12:15]
    v_mfma_f32_16x16x32_bf16 v[16:19], v[144:147], v[48:51], v[16:19]
    s_waitcnt lgkmcnt(5)
    v_mfma_f32_16x16x32_bf16 v[8:11], v[148:151], v[52:55], v[8:11]
    ds_read_b128 v[48:51], v2 offset:26624
    v_mfma_f32_16x16x32_bf16 v[12:15], v[152:155], v[52:55], v[12:15]
    buffer_load_dwordx4 v1, s[8:11], s33 offen offset:2048 sc1 lds
    v_mfma_f32_16x16x32_bf16 v[16:19], v[156:159], v[52:55], v[16:19]
    s_waitcnt lgkmcnt(3)
    v_mfma_f32_16x16x32_bf16 v[8:11], v[160:163], v[40:43], v[8:11]
    ds_read_b128 v[52:55], v2 offset:27648
    v_mfma_f32_16x16x32_bf16 v[12:15], v[164:167], v[40:43], v[12:15]
    v_mfma_f32_16x16x32_bf16 v[16:19], v[168:171], v[40:43], v[16:19]
    s_waitcnt lgkmcnt(2)
    buffer_load_dwordx4 v1, s[8:11], s33 offen offset:3072 sc1 lds
    v_mfma_f32_16x16x32_bf16 v[8:11], v[172:175], v[44:47], v[8:11]
    ds_read_b128 v[40:43], v2 offset:28672
    v_add_f32 v76, v76, v80
    v_mfma_f32_16x16x32_bf16 v[12:15], v[176:179], v[44:47], v[12:15]
    s_add_u32 m0, s34, 4096
    v_add_f32 v77, v77, v81
    v_add_f32 v78, v78, v82
    v_mfma_f32_16x16x32_bf16 v[16:19], v[180:183], v[44:47], v[16:19]
    s_waitcnt lgkmcnt(2)
    v_add_f32 v79, v79, v83
    v_add_f32 v68, v76, v78
    v_mfma_f32_16x16x32_bf16 v[8:11], v[184:187], v[48:51], v[8:11]
    ds_read_b128 v[44:47], v2 offset:29696
    v_add_f32 v69, v77, v79
    v_mfma_f32_16x16x32_bf16 v[12:15], v[188:191], v[48:51], v[12:15]
    s_add_u32 s37, s33, 4096
    v_permlane16_swap_b32 v68, v69
    v_mfma_f32_16x16x32_bf16 v[16:19], v[192:195], v[48:51], v[16:19]
    s_waitcnt lgkmcnt(2)
    buffer_load_dwordx4 v1, s[8:11], s37 offen offset:0 sc1 lds
    v_mfma_f32_16x16x32_bf16 v[8:11], v[196:199], v[52:55], v[8:11]
    ds_read_b128 v[48:51], v2 offset:30720
    v_add_f32 v68, v68, v69
    v_mfma_f32_16x16x32_bf16 v[12:15], v[200:203], v[52:55], v[12:15]
    s_waitcnt vmcnt(8)
    s_barrier
    v_mfma_f32_16x16x32_bf16 v[16:19], v[204:207], v[52:55], v[16:19]
    s_waitcnt lgkmcnt(2)
    v_mov_b32 v69, v68
    v_mfma_f32_16x16x32_bf16 v[8:11], v[208:211], v[40:43], v[8:11]
    ds_read_b128 v[52:55], v2 offset:31744
    v_mfma_f32_16x16x32_bf16 v[12:15], v[212:215], v[40:43], v[12:15]
    buffer_load_dwordx4 v1, s[8:11], s37 offen offset:1024 sc1 lds
    v_mfma_f32_16x16x32_bf16 v[16:19], v[216:219], v[40:43], v[16:19]
    s_waitcnt lgkmcnt(2)
    v_permlane32_swap_b32 v68, v69
    v_mfma_f32_16x16x32_bf16 v[8:11], v[220:223], v[44:47], v[8:11]
    ds_read_b128 v[40:43], v3 offset:0
    v_add_f32 v68, v68, v69
    v_mfma_f32_16x16x32_bf16 v[12:15], v[224:227], v[44:47], v[12:15]
    v_mul_f32 v68, 0x3a800000, v68
    v_mov_b32 v69, v68
    v_mfma_f32_16x16x32_bf16 v[16:19], v[228:231], v[44:47], v[16:19]
    s_waitcnt lgkmcnt(2)
    buffer_load_dwordx4 v1, s[8:11], s37 offen offset:2048 sc1 lds
    v_mfma_f32_16x16x32_bf16 v[8:11], v[232:235], v[48:51], v[8:11]
    ds_read_b128 v[44:47], v3 offset:1024
    v_mfma_f32_16x16x32_bf16 v[12:15], v[236:239], v[48:51], v[12:15]
    v_permlane16_swap_b32 v68, v69
    v_mfma_f32_16x16x32_bf16 v[16:19], v[240:243], v[48:51], v[16:19]
    s_waitcnt lgkmcnt(2)
    v_fma_f32 v69, -v68, v68, v69
    v_max_f32 v69, 0, v69
    v_mfma_f32_16x16x32_bf16 v[8:11], v[244:247], v[52:55], v[8:11]
    ds_read_b128 v[48:51], v3 offset:2048
    v_add_f32 v69, 0x3727c5ac, v69
    v_mfma_f32_16x16x32_bf16 v[12:15], v[248:251], v[52:55], v[12:15]
    buffer_load_dwordx4 v1, s[8:11], s37 offen offset:3072 sc1 lds
    v_mfma_f32_16x16x32_bf16 v[16:19], v[252:255], v[52:55], v[16:19]
    s_add_u32 m0, s34, 8192
    s_add_u32 s37, s33, 8192
    buffer_load_dwordx4 v1, s[8:11], s37 offen offset:0 sc1 lds
    v_rsq_f32 v69, v69
    s_nop 1
Lqkv_g1:
    s_waitcnt lgkmcnt(2)
    v_mfma_f32_16x16x32_bf16 v[24:27], a[0:3], v[40:43], 0
    ds_read_b128 v[52:55], v3 offset:3072
    s_add_u32 s35, s35, 36864
    v_mfma_f32_16x16x32_bf16 v[28:31], a[4:7], v[40:43], 0
    ds_read_b64 v[122:123], v37 offset:0
    v_mfma_f32_16x16x32_bf16 v[32:35], a[8:11], v[40:43], 0
    s_waitcnt lgkmcnt(3)
    s_waitcnt vmcnt(10)
    v_cmp_gt_i32 vcc, s32, v5
    v_mfma_f32_16x16x32_bf16 v[24:27], a[12:15], v[44:47], v[24:27]
    ds_read_b128 v[40:43], v3 offset:4096
    v_fma_f32 v12, -v68, v60, v12
    v_mfma_f32_16x16x32_bf16 v[28:31], a[16:19], v[44:47], v[28:31]
    s_and_b64 vcc, vcc, s[18:19]
    s_cbranch_scc1 Lqkv_slowg1
Lqkv_backg1:
    v_mfma_f32_16x16x32_bf16 v[32:35], a[20:23], v[44:47], v[32:35]
    s_waitcnt lgkmcnt(3)
    v_fma_f32 v13, -v68, v61, v13
    v_fma_f32 v14, -v68, v62, v14
    v_mfma_f32_16x16x32_bf16 v[24:27], a[24:27], v[48:51], v[24:27]
    ds_read_b128 v[44:47], v3 offset:5120
    s_waitcnt vmcnt(9)
    v_mfma_f32_16x16x32_bf16 v[28:31], a[28:31], v[48:51], v[28:31]
    s_mov_b32 s16, s39
    buffer_store_dword v6, v21, s[12:15], s17 offen sc1
    v_mfma_f32_16x16x32_bf16 v[32:35], a[32:35], v[48:51], v[32:35]
    s_waitcnt lgkmcnt(3)
    buffer_load_dword v5, v4, s[4:7], s16 offen sc1
    v_mfma_f32_16x16x32_bf16 v[24:27], a[36:39], v[52:55], v[24:27]
    ds_read_b128 v[48:51], v3 offset:6144
    s_waitcnt lgkmcnt(3)
    v_mfma_f32_16x16x32_bf16 v[28:31], a[40:43], v[52:55], v[28:31]
    s_add_u32 s33, s33, 34816
    v_add_f32 v122, v122, v120
    v_add_f32 v123, v123, v121
    v_mfma_f32_16x16x32_bf16 v[32:35], a[44:47], v[52:55], v[32:35]
    s_waitcnt lgkmcnt(2)
    v_max_f32 v22, v122, v123
    v_mov_b32 v23, v22
    v_mfma_f32_16x16x32_bf16 v[24:27], a[48:51], v[40:43], v[24:27]
    ds_read_b128 v[52:55], v3 offset:7168
    v_fma_f32 v15, -v68, v63, v15
    v_mfma_f32_16x16x32_bf16 v[28:31], a[52:55], v[40:43], v[28:31]
    s_add_u32 s34, s34, 36864
    v_permlane16_swap_b32 v22, v23
    v_mfma_f32_16x16x32_bf16 v[32:35], a[56:59], v[40:43], v[32:35]
    s_waitcnt lgkmcnt(2)
    v_max_f32 v22, v22, v23
    v_mov_b32 v23, v22
    v_mfma_f32_16x16x32_bf16 v[24:27], a[60:63], v[44:47], v[24:27]
    ds_read_b128 v[40:43], v3 offset:8192
    v_mul_f32 v12, v12, v69
    v_mfma_f32_16x16x32_bf16 v[28:31], a[64:67], v[44:47], v[28:31]
    s_cmp_ge_u32 s34, 147456
    s_cselect_b32 s38, 147456, 0
    v_mul_f32 v13, v13, v69
    v_mfma_f32_16x16x32_bf16 v[32:35], a[68:71], v[44:47], v[32:35]
    s_waitcnt lgkmcnt(2)
    v_permlane32_swap_b32 v22, v23
    v_mfma_f32_16x16x32_bf16 v[24:27], a[72:75], v[48:51], v[24:27]
    ds_read_b128 v[44:47], v3 offset:9216
    v_max_f32 v22, v22, v23
    v_mfma_f32_16x16x32_bf16 v[28:31], a[76:79], v[48:51], v[28:31]
    s_sub_u32 s34, s34, s38
    v_mul_f32 v22, s52, v22
    v_fma_f32 v122, v122, s52, -v22
    v_mfma_f32_16x16x32_bf16 v[32:35], a[80:83], v[48:51], v[32:35]
    s_waitcnt lgkmcnt(2)
    v_fma_f32 v123, v123, s52, -v22
    v_mul_f32 v14, v14, v69
    v_mfma_f32_16x16x32_bf16 v[24:27], a[84:87], v[52:55], v[24:27]
    ds_read_b128 v[48:51], v3 offset:10240
    v_mul_f32 v15, v15, v69
    v_mfma_f32_16x16x32_bf16 v[28:31], a[88:91], v[52:55], v[28:31]
    s_add_u32 m0, s34, 0
    v_exp_f32 v122, v122
    v_mfma_f32_16x16x32_bf16 v[32:35], a[92:95], v[52:55], v[32:35]
    s_waitcnt lgkmcnt(2)
    v_exp_f32 v123, v123
    v_mfma_f32_16x16x32_bf16 v[24:27], a[96:99], v[40:43], v[24:27]
    ds_read_b128 v[52:55], v3 offset:11264
    v_add_f32 v22, v122, v123
    v_mfma_f32_16x16x32_bf16 v[28:31], a[100:103], v[40:43], v[28:31]
    s_cmp_ge_i32 s54, 0
    s_cselect_b32 s14, s6, 0
    v_mov_b32 v23, v22
    v_mfma_f32_16x16x32_bf16 v[32:35], a[104:107], v[40:43], v[32:35]
    s_waitcnt lgkmcnt(2)
    v_permlane16_swap_b32 v22, v23
    v_mfma_f32_16x16x32_bf16 v[24:27], a[108:111], v[44:47], v[24:27]
    ds_read_b128 v[40:43], v3 offset:12288
    v_add_f32 v22, v22, v23
    v_mfma_f32_16x16x32_bf16 v[28:31], a[112:115], v[44:47], v[28:31]
    s_add_u32 s17, s17, 8192
    v_mov_b32 v23, v22
    v_cvt_pk_bf16_f32 v84, v12, v13
    v_mfma_f32_16x16x32_bf16 v[32:35], a[116:119], v[44:47], v[32:35]
    s_waitcnt lgkmcnt(2)
    v_permlane32_swap_b32 v22, v23
    v_mfma_f32_16x16x32_bf16 v[24:27], a[120:123], v[48:51], v[24:27]
    ds_read_b128 v[44:47], v3 offset:13312
    v_add_f32 v22, v22, v23
    v_mfma_f32_16x16x32_bf16 v[28:31], a[124:127], v[48:51], v[28:31]
    s_cmp_eq_u32 s35, 147456
    s_cselect_b32 s35, 0, s35
    v_cvt_pk_bf16_f32 v85, v14, v15
    v_mfma_f32_16x16x32_bf16 v[32:35], a[128:131], v[48:51], v[32:35]
    s_waitcnt lgkmcnt(2)
    v_rcp_f32 v22, v22
    v_mfma_f32_16x16x32_bf16 v[106:109], v[84:87], v[88:91], 0
    s_add_u32 s31, s31, 1
    v_mul_f32 v122, v122, v22
    v_mul_f32 v123, v123, v22
    v_mfma_f32_16x16x32_bf16 v[24:27], a[132:135], v[52:55], v[24:27]
    ds_read_b128 v[48:51], v3 offset:14336
    v_cvt_pk_bf16_f32 v23, v122, v123
    v_mfma_f32_16x16x32_bf16 v[28:31], a[136:139], v[52:55], v[28:31]
    s_sub_u32 s32, s31, 29
    v_perm_b32 v116, v23, v23, v102
    v_perm_b32 v117, v23, v23, v103
    v_mfma_f32_16x16x32_bf16 v[32:35], a[140:143], v[52:55], v[32:35]
    s_waitcnt lgkmcnt(2)
    v_perm_b32 v114, v23, v23, v104
    v_perm_b32 v115, v23, v23, v105
    v_mfma_f32_16x16x32_bf16 v[24:27], a[144:147], v[40:43], v[24:27]
    ds_read_b128 v[52:55], v3 offset:15360
    v_fma_f32 v8, -v68, v56, v8
    v_mfma_f32_16x16x32_bf16 v[72:75], v[92:95], v[114:117], 0
    s_min_i32 s32, s32, 32
    v_fma_f32 v9, -v68, v57, v9
    v_fma_f32 v10, -v68, v58, v10
    v_mfma_f32_16x16x32_bf16 v[28:31], a[148:151], v[40:43], v[28:31]
    s_sub_u32 s54, s31, 3
    v_fma_f32 v11, -v68, v59, v11
    v_mul_f32 v8, v8, v69
    v_mfma_f32_16x16x32_bf16 v[32:35], a[152:155], v[40:43], v[32:35]
    s_waitcnt lgkmcnt(2)
    v_cvt_pk_bf16_f32 v114, v72, v73
    v_cvt_pk_bf16_f32 v115, v74, v75
    v_mfma_f32_16x16x32_bf16 v[24:27], a[156:159], v[44:47], v[24:27]
    ds_read_b128 v[40:43], v3 offset:16384
    v_cvt_pk_bf16_f32 v116, v72, v73
    v_mfma_f32_16x16x32_bf16 v[28:31], a[160:163], v[44:47], v[28:31]
    v_cvt_pk_bf16_f32 v117, v74, v75
    v_mul_f32 v9, v9, v69
    v_mfma_f32_16x16x32_bf16 v[32:35], a[164:167], v[44:47], v[32:35]
    s_waitcnt lgkmcnt(2)
    v_permlane32_swap_b32 v114, v116
    v_mfma_f32_16x16x32_bf16 v[24:27], a[168:171], v[48:51], v[24:27]
    ds_read_b128 v[44:47], v3 offset:17408
    v_mul_f32 v10, v10, v69
    v_mfma_f32_16x16x32_bf16 v[28:31], a[172:175], v[48:51], v[28:31]
    v_permlane32_swap_b32 v115, v117
    v_mfma_f32_16x16x32_bf16 v[32:35], a[176:179], v[48:51], v[32:35]
    s_waitcnt lgkmcnt(2)
    buffer_store_dwordx4 v[114:117], v7, s[12:15], s36 offen sc1
    v_mul_f32 v11, v11, v69
    v_mfma_f32_16x16x32_bf16 v[24:27], a[180:183], v[52:55], v[24:27]
    ds_read_b128 v[48:51], v3 offset:18432
    v_cvt_pk_bf16_f32 v88, v8, v9
    v_mfma_f32_16x16x32_bf16 v[28:31], a[184:187], v[52:55], v[28:31]
    s_add_u32 s36, s36, 32768
    v_cvt_pk_bf16_f32 v89, v10, v11
    v_fma_f32 v16, -v68, v64, v16
    v_mfma_f32_16x16x32_bf16 v[32:35], a[188:191], v[52:55], v[32:35]
    s_waitcnt lgkmcnt(2)
    v_fma_f32 v17, -v68, v65, v17
    v_fma_f32 v18, -v68, v66, v18
    v_mfma_f32_16x16x32_bf16 v[110:113], v[84:87], v[88:91], 0
    v_cndmask_b32 v106, v106, v107, s[44:45]
    v_cndmask_b32 v108, v108, v109, s[44:45]
    v_mfma_f32_16x16x32_bf16 v[24:27], a[192:195], v[40:43], v[24:27]
    ds_read_b128 v[52:55], v3 offset:19456
    v_cndmask_b32 v120, v106, v118, s[48:49]
    v_mfma_f32_16x16x32_bf16 v[28:31], a[196:199], v[40:43], v[28:31]
    v_cndmask_b32 v121, v108, v119, s[50:51]
    v_fma_f32 v19, -v68, v67, v19
    v_mfma_f32_16x16x32_bf16 v[32:35], a[200:203], v[40:43], v[32:35]
    s_waitcnt lgkmcnt(2)
    ds_write_b64 v36, v[120:121] offset:2048
    v_mfma_f32_16x16x32_bf16 v[24:27], a[204:207], v[44:47], v[24:27]
    ds_read_b128 v[40:43], v3 offset:20480
    v_cndmask_b32 v118, v110, v111, s[44:45]
    v_mfma_f32_16x16x32_bf16 v[28:31], a[208:211], v[44:47], v[28:31]
    v_cndmask_b32 v119, v112, v113, s[44:45]
    v_mul_f32 v16, v16, v69
    v_mfma_f32_16x16x32_bf16 v[32:35], a[212:215], v[44:47], v[32:35]
    s_waitcnt lgkmcnt(3)
    v_mul_f32 v17, v17, v69
    v_mul_f32 v18, v18, v69
    v_mfma_f32_16x16x32_bf16 v[24:27], a[216:219], v[48:51], v[24:27]
    ds_read_b128 v[44:47], v3 offset:21504
    v_mul_f32 v19, v19, v69
    v_mfma_f32_16x16x32_bf16 v[28:31], a[220:223], v[48:51], v[28:31]
    v_cvt_pk_bf16_f32 v16, v16, v17
    v_cvt_pk_bf16_f32 v17, v18, v19
    v_mfma_f32_16x16x32_bf16 v[32:35], a[224:227], v[48:51], v[32:35]
    s_waitcnt lgkmcnt(3)
    ds_write_b64 v38, v[16:17]
    v_mfma_f32_16x16x32_bf16 v[24:27], a[228:231], v[52:55], v[24:27]
    ds_read_b128 v[48:51], v3 offset:22528
    v_sub_u32 v76, v3, v20
    v_mfma_f32_16x16x32_bf16 v[28:31], a[232:235], v[52:55], v[28:31]
    buffer_load_dwordx4 v1, s[8:11], s33 offen offset:0 sc1 lds
    v_mfma_f32_16x16x32_bf16 v[32:35], a[236:239], v[52:55], v[32:35]
    s_waitcnt lgkmcnt(3)
    ds_read_b64_tr_b16 v[92:93], v39
    v_mfma_f32_16x16x32_bf16 v[24:27], a[240:243], v[40:43], v[24:27]
    ds_read_b128 v[52:55], v3 offset:23552
    v_add_u32 v2, s35, v1
    v_mfma_f32_16x16x32_bf16 v[28:31], a[244:247], v[40:43], v[28:31]
    ds_read2st64_b64 v[80:83], v76 offset0:66 offset1:67
    v_mov_b32 v6, s54
    v_mfma_f32_16x16x32_bf16 v[32:35], a[248:251], v[40:43], v[32:35]
    s_waitcnt lgkmcnt(5)
    buffer_load_dwordx4 v1, s[8:11], s33 offen offset:1024 sc1 lds
    v_mfma_f32_16x16x32_bf16 v[24:27], a[252:255], v[44:47], v[24:27]
    ds_read_b128 v[40:43], v3 offset:24576
    s_min_i32 s39, s32, 31
    v_mfma_f32_16x16x32_bf16 v[28:31], v[128:131], v[44:47], v[28:31]
    ds_read2st64_b64 v[76:79], v76 offset0:64 offset1:65
    s_min_u32 s39, s39, 0x1000
    v_mfma_f32_16x16x32_bf16 v[32:35], v[132:135], v[44:47], v[32:35]
    s_waitcnt lgkmcnt(5)
    s_lshl_b32 s39, s39, 13
    v_mfma_f32_16x16x32_bf16 v[24:27], v[136:139], v[48:51], v[24:27]
    ds_read_b128 v[44:47], v3 offset:25600
    v_mfma_f32_16x16x32_bf16 v[28:31], v[140:143], v[48:51], v[28:31]
    buffer_load_dwordx4 v1, s[8:11], s33 offen offset:2048 sc1 lds
    v_mfma_f32_16x16x32_bf16 v[32:35], v[144:147], v[48:51], v[32:35]
    s_waitcnt lgkmcnt(4)
    v_mfma_f32_16x16x32_bf16 v[24:27], v[148:151], v[52:55], v[24:27]
    ds_read_b128 v[48:51], v3 offset:26624
    v_mfma_f32_16x16x32_bf16 v[28:31], v[152:155], v[52:55], v[28:31]
    v_mfma_f32_16x16x32_bf16 v[32:35], v[156:159], v[52:55], v[32:35]
    s_waitcnt lgkmcnt(3)
    buffer_load_dwordx4 v1, s[8:11], s33 offen offset:3072 sc1 lds
    v_mfma_f32_16x16x32_bf16 v[24:27], v[160:163], v[40:43], v[24:27]
    ds_read_b128 v[52:55], v3 offset:27648
    s_add_u32 m0, s34, 4096
    v_mfma_f32_16x16x32_bf16 v[28:31], v[164:167], v[40:43], v[28:31]
    s_add_u32 s37, s33, 4096
    v_mfma_f32_16x16x32_bf16 v[32:35], v[168:171], v[40:43], v[32:35]
    s_waitcnt lgkmcnt(2)
    v_add_f32 v76, v76, v80
    v_add_f32 v77, v77, v81
    v_mfma_f32_16x16x32_bf16 v[24:27], v[172:175], v[44:47], v[24:27]
    ds_read_b128 v[40:43], v3 offset:28672
    v_add_f32 v78, v78, v82
    v_mfma_f32_16x16x32_bf16 v[28:31], v[176:179], v[44:47], v[28:31]
    buffer_load_dwordx4 v1, s[8:11], s37 offen offset:0 sc1 lds
    v_mfma_f32_16x16x32_bf16 v[32:35], v[180:183], v[44:47], v[32:35]
    s_waitcnt lgkmcnt(2)
    v_add_f32 v79, v79, v83
    v_add_f32 v70, v76, v78
    v_mfma_f32_16x16x32_bf16 v[24:27], v[184:187], v[48:51], v[24:27]
    ds_read_b128 v[44:47], v3 offset:29696
    v_add_f32 v71, v77, v79
    v_mfma_f32_16x16x32_bf16 v[28:31], v[188:191], v[48:51], v[28:31]
    v_mfma_f32_16x16x32_bf16 v[32:35], v[192:195], v[48:51], v[32:35]
    s_waitcnt lgkmcnt(2)
    buffer_load_dwordx4 v1, s[8:11], s37 offen offset:1024 sc1 lds
    v_mfma_f32_16x16x32_bf16 v[24:27], v[196:199], v[52:55], v[24:27]
    ds_read_b128 v[48:51], v3 offset:30720
    v_mfma_f32_16x16x32_bf16 v[28:31], v[200:203], v[52:55], v[28:31]
    s_waitcnt vmcnt(9)
    s_barrier
    v_mfma_f32_16x16x32_bf16 v[32:35], v[204:207], v[52:55], v[32:35]
    s_waitcnt lgkmcnt(2)
    v_permlane16_swap_b32 v70, v71
    v_mfma_f32_16x16x32_bf16 v[24:27], v[208:211], v[40:43], v[24:27]
    ds_read_b128 v[52:55], v3 offset:31744
    v_add_f32 v70, v70, v71
    v_mfma_f32_16x16x32_bf16 v[28:31], v[212:215], v[40:43], v[28:31]
    buffer_load_dwordx4 v1, s[8:11], s37 offen offset:2048 sc1 lds
    v_mfma_f32_16x16x32_bf16 v[32:35], v[216:219], v[40:43], v[32:35]
    s_waitcnt lgkmcnt(2)
    v_mov_b32 v71, v70
    v_mfma_f32_16x16x32_bf16 v[24:27], v[220:223], v[44:47], v[24:27]
    ds_read_b128 v[40:43], v2 offset:0
    v_mfma_f32_16x16x32_bf16 v[28:31], v[224:227], v[44:47], v[28:31]
    v_permlane32_swap_b32 v70, v71
    v_mfma_f32_16x16x32_bf16 v[32:35], v[228:231], v[44:47], v[32:35]
    s_waitcnt lgkmcnt(2)
    buffer_load_dwordx4 v1, s[8:11], s37 offen offset:3072 sc1 lds
    v_mfma_f32_16x16x32_bf16 v[24:27], v[232:235], v[48:51], v[24:27]
    ds_read_b128 v[44:47], v2 offset:1024
    v_add_f32 v70, v70, v71
    v_mfma_f32_16x16x32_bf16 v[28:31], v[236:239], v[48:51], v[28:31]
    s_add_u32 m0, s34, 8192
    v_mul_f32 v70, 0x3a800000, v70
    v_mov_b32 v71, v70
    v_mfma_f32_16x16x32_bf16 v[32:35], v[240:243], v[48:51], v[32:35]
    s_waitcnt lgkmcnt(2)
    v_permlane16_swap_b32 v70, v71
    v_mfma_f32_16x16x32_bf16 v[24:27], v[244:247], v[52:55], v[24:27]
    ds_read_b128 v[48:51], v2 offset:2048
    v_fma_f32 v71, -v70, v70, v71
    v_mfma_f32_16x16x32_bf16 v[28:31], v[248:251], v[52:55], v[28:31]
    s_add_u32 s37, s33, 8192
    v_max_f32 v71, 0, v71
    v_add_f32 v71, 0x3727c5ac, v71
    v_mfma_f32_16x16x32_bf16 v[32:35], v[252:255], v[52:55], v[32:35]
    buffer_load_dwordx4 v1, s[8:11], s37 offen offset:0 sc1 lds
    v_rsq_f32 v71, v71
    s_nop 1
    s_cmp_eq_u32 s31, 64
    s_cbranch_scc1 Lqkv_tail
Lqkv_g0:
    s_waitcnt lgkmcnt(2)
    v_mfma_f32_16x16x32_bf16 v[8:11], a[0:3], v[40:43], 0
    ds_read_b128 v[52:55], v2 offset:3072
    s_add_u32 s35, s35, 36864
    v_mfma_f32_16x16x32_bf16 v[12:15], a[4:7], v[40:43], 0
    ds_read_b64 v[122:123], v37 offset:2048
    v_mfma_f32_16x16x32_bf16 v[16:19], a[8:11], v[40:43], 0
    s_waitcnt lgkmcnt(3)
    s_waitcnt vmcnt(10)
    v_cmp_gt_i32 vcc, s32, v5
    v_mfma_f32_16x16x32_bf16 v[8:11], a[12:15], v[44:47], v[8:11]
    ds_read_b128 v[40:43], v2 offset:4096
    v_fma_f32 v28, -v70, v60, v28
    v_mfma_f32_16x16x32_bf16 v[12:15], a[16:19], v[44:47], v[12:15]
    s_and_b64 vcc, vcc, s[18:19]
    s_cbranch_scc1 Lqkv_slowg0
Lqkv_backg0:
    v_mfma_f32_16x16x32_bf16 v[16:19], a[20:23], v[44:47], v[16:19]
    s_waitcnt lgkmcnt(3)
    v_fma_f32 v29, -v70, v61, v29
    v_fma_f32 v30, -v70, v62, v30
    v_mfma_f32_16x16x32_bf16 v[8:11], a[24:27], v[48:51], v[8:11]
    ds_read_b128 v[44:47], v2 offset:5120
    s_waitcnt vmcnt(9)
    v_mfma_f32_16x16x32_bf16 v[12:15], a[28:31], v[48:51], v[12:15]
    s_mov_b32 s16, s39
    buffer_store_dword v6, v21, s[12:15], s17 offen sc1
    v_mfma_f32_16x16x32_bf16 v[16:19], a[32:35], v[48:51], v[16:19]
    s_waitcnt lgkmcnt(3)
    buffer_load_dword v5, v4, s[4:7], s16 offen sc1
    v_mfma_f32_16x16x32_bf16 v[8:11], a[36:39], v[52:55], v[8:11]
    ds_read_b128 v[48:51], v2 offset:6144
    s_waitcnt lgkmcnt(3)
    v_mfma_f32_16x16x32_bf16 v[12:15], a[40:43], v[52:55], v[12:15]
    s_add_u32 s33, s33, 34816
    v_add_f32 v122, v122, v120
    v_add_f32 v123, v123, v121
    v_mfma_f32_16x16x32_bf16 v[16:19], a[44:47], v[52:55], v[16:19]
    s_waitcnt lgkmcnt(2)
    v_max_f32 v22, v122, v123
    v_mov_b32 v23, v22
    v_mfma_f32_16x16x32_bf16 v[8:11], a[48:51], v[40:43], v[8:11]
    ds_read_b128 v[52:55], v2 offset:7168
    v_fma_f32 v31, -v70, v63, v31
    v_mfma_f32_16x16x32_bf16 v[12:15], a[52:55], v[40:43], v[12:15]
    s_add_u32 s34, s34, 36864
    v_permlane16_swap_b32 v22, v23
    v_mfma_f32_16x16x32_bf16 v[16:19], a[56:59], v[40:43], v[16:19]
    s_waitcnt lgkmcnt(2)
    v_max_f32 v22, v22, v23
    v_mov_b32 v23, v22
    v_mfma_f32_16x16x32_bf16 v[8:11], a[60:63], v[44:47], v[8:11]
    ds_read_b128 v[40:43], v2 offset:8192
    v_mul_f32 v28, v28, v71
    v_mfma_f32_16x16x32_bf16 v[12:15], a[64:67], v[44:47], v[12:15]
    s_cmp_ge_u32 s34, 147456
    s_cselect_b32 s38, 147456, 0
    v_mul_f32 v29, v29, v71
    v_mfma_f32_16x16x32_bf16 v[16:19], a[68:71], v[44:47], v[16:19]
    s_waitcnt lgkmcnt(2)
    v_permlane32_swap_b32 v22, v23
    v_mfma_f32_16x16x32_bf16 v[8:11], a[72:75], v[48:51], v[8:11]
    ds_read_b128 v[44:47], v2 offset:9216
    v_max_f32 v22, v22, v23
    v_mfma_f32_16x16x32_bf16 v[12:15], a[76:79], v[48:51], v[12:15]
    s_sub_u32 s34, s34, s38
    v_mul_f32 v22, s52, v22
    v_fma_f32 v122, v122, s52, -v22
    v_mfma_f32_16x16x32_bf16 v[16:19], a[80:83], v[48:51], v[16:19]
    s_waitcnt lgkmcnt(2)
    v_fma_f32 v123, v123, s52, -v22
    v_mul_f32 v30, v30, v71
    v_mfma_f32_16x16x32_bf16 v[8:11], a[84:87], v[52:55], v[8:11]
    ds_read_b128 v[48:51], v2 offset:10240
    v_mul_f32 v31, v31, v71
    v_mfma_f32_16x16x32_bf16 v[12:15], a[88:91], v[52:55], v[12:15]
    s_add_u32 m0, s34, 0
    v_exp_f32 v122, v122
    v_mfma_f32_16x16x32_bf16 v[16:19], a[92:95], v[52:55], v[16:19]
    s_waitcnt lgkmcnt(2)
    v_exp_f32 v123, v123
    v_mfma_f32_16x16x32_bf16 v[8:11], a[96:99], v[40:43], v[8:11]
    ds_read_b128 v[52:55], v2 offset:11264
    v_add_f32 v22, v122, v123
    v_mfma_f32_16x16x32_bf16 v[12:15], a[100:103], v[40:43], v[12:15]
    s_cmp_ge_i32 s54, 0
    s_cselect_b32 s14, s6, 0
    v_mov_b32 v23, v22
    v_mfma_f32_16x16x32_bf16 v[16:19], a[104:107], v[40:43], v[16:19]
    s_waitcnt lgkmcnt(2)
    v_permlane16_swap_b32 v22, v23
    v_mfma_f32_16x16x32_bf16 v[8:11], a[108:111], v[44:47], v[8:11]
    ds_read_b128 v[40:43], v2 offset:12288
    v_add_f32 v22, v22, v23
    v_mfma_f32_16x16x32_bf16 v[12:15], a[112:115], v[44:47], v[12:15]
    s_add_u32 s17, s17, 8192
    v_mov_b32 v23, v22
    v_cvt_pk_bf16_f32 v84, v28, v29
    v_mfma_f32_16x16x32_bf16 v[16:19], a[116:119], v[44:47], v[16:19]
    s_waitcnt lgkmcnt(2)
    v_permlane32_swap_b32 v22, v23
    v_mfma_f32_16x16x32_bf16 v[8:11], a[120:123], v[48:51], v[8:11]
    ds_read_b128 v[44:47], v2 offset:13312
    v_add_f32 v22, v22, v23
    v_mfma_f32_16x16x32_bf16 v[12:15], a[124:127], v[48:51], v[12:15]
    s_cmp_eq_u32 s35, 147456
    s_cselect_b32 s35, 0, s35
    v_cvt_pk_bf16_f32 v85, v30, v31
    v_mfma_f32_16x16x32_bf16 v[16:19], a[128:131], v[48:51], v[16:19]
    s_waitcnt lgkmcnt(2)
    v_rcp_f32 v22, v22
    v_mfma_f32_16x16x32_bf16 v[106:109], v[84:87], v[88:91], 0
    s_add_u32 s31, s31, 1
    v_mul_f32 v122, v122, v22
    v_mul_f32 v123, v123, v22
    v_mfma_f32_16x16x32_bf16 v[8:11], a[132:135], v[52:55], v[8:11]
    ds_read_b128 v[48:51], v2 offset:14336
    v_cvt_pk_bf16_f32 v23, v122, v123
    v_mfma_f32_16x16x32_bf16 v[12:15], a[136:139], v[52:55], v[12:15]
    s_sub_u32 s32, s31, 29
    v_perm_b32 v114, v23, v23, v102
    v_perm_b32 v115, v23, v23, v103
    v_mfma_f32_16x16x32_bf16 v[16:19], a[140:143], v[52:55], v[16:19]
    s_waitcnt lgkmcnt(2)
    v_perm_b32 v116, v23, v23, v104
    v_perm_b32 v117, v23, v23, v105
    v_mfma_f32_16x16x32_bf16 v[8:11], a[144:147], v[40:43], v[8:11]
    ds_read_b128 v[52:55], v2 offset:15360
    v_fma_f32 v24, -v70, v56, v24
    v_mfma_f32_16x16x32_bf16 v[72:75], v[92:95], v[114:117], 0
    s_min_i32 s32, s32, 32
    v_fma_f32 v25, -v70, v57, v25
    v_fma_f32 v26, -v70, v58, v26
    v_mfma_f32_16x16x32_bf16 v[12:15], a[148:151], v[40:43], v[12:15]
    s_sub_u32 s54, s31, 3
    v_fma_f32 v27, -v70, v59, v27
    v_mul_f32 v24, v24, v71
    v_mfma_f32_16x16x32_bf16 v[16:19], a[152:155], v[40:43], v[16:19]
    s_waitcnt lgkmcnt(2)
    v_cvt_pk_bf16_f32 v114, v72, v73
    v_cvt_pk_bf16_f32 v115, v74, v75
    v_mfma_f32_16x16x32_bf16 v[8:11], a[156:159], v[44:47], v[8:11]
    ds_read_b128 v[40:43], v2 offset:16384
    v_cvt_pk_bf16_f32 v116, v72, v73
    v_mfma_f32_16x16x32_bf16 v[12:15], a[160:163], v[44:47], v[12:15]
    v_cvt_pk_bf16_f32 v117, v74, v75
    v_mul_f32 v25, v25, v71
    v_mfma_f32_16x16x32_bf16 v[16:19], a[164:167], v[44:47], v[16:19]
    s_waitcnt lgkmcnt(2)
    v_permlane32_swap_b32 v114, v116
    v_mfma_f32_16x16x32_bf16 v[8:11], a[168:171], v[48:51], v[8:11]
    ds_read_b128 v[44:47], v2 offset:17408
    v_mul_f32 v26, v26, v71
    v_mfma_f32_16x16x32_bf16 v[12:15], a[172:175], v[48:51], v[12:15]
    v_permlane32_swap_b32 v115, v117
    v_mfma_f32_16x16x32_bf16 v[16:19], a[176:179], v[48:51], v[16:19]
    s_waitcnt lgkmcnt(2)
    buffer_store_dwordx4 v[114:117], v7, s[12:15], s36 offen sc1
    v_mul_f32 v27, v27, v71
    v_mfma_f32_16x16x32_bf16 v[8:11], a[180:183], v[52:55], v[8:11]
    ds_read_b128 v[48:51], v2 offset:18432
    v_cvt_pk_bf16_f32 v88, v24, v25
    v_mfma_f32_16x16x32_bf16 v[12:15], a[184:187], v[52:55], v[12:15]
    s_add_u32 s36, s36, 32768
    v_cvt_pk_bf16_f32 v89, v26, v27
    v_fma_f32 v32, -v70, v64, v32
    v_mfma_f32_16x16x32_bf16 v[16:19], a[188:191], v[52:55], v[16:19]
    s_waitcnt lgkmcnt(2)
    v_fma_f32 v33, -v70, v65, v33
    v_fma_f32 v34, -v70, v66, v34
    v_mfma_f32_16x16x32_bf16 v[110:113], v[84:87], v[88:91], 0
    v_cndmask_b32 v106, v106, v107, s[44:45]
    v_cndmask_b32 v108, v108, v109, s[44:45]
    v_mfma_f32_16x16x32_bf16 v[8:11], a[192:195], v[40:43], v[8:11]
    ds_read_b128 v[52:55], v2 offset:19456
    v_cndmask_b32 v120, v106, v118, s[48:49]
    v_mfma_f32_16x16x32_bf16 v[12:15], a[196:199], v[40:43], v[12:15]
    v_cndmask_b32 v121, v108, v119, s[50:51]
    v_fma_f32 v35, -v70, v67, v35
    v_mfma_f32_16x16x32_bf16 v[16:19], a[200:203], v[40:43], v[16:19]
    s_waitcnt lgkmcnt(2)
    ds_write_b64 v36, v[120:121] offset:0
    v_mfma_f32_16x16x32_bf16 v[8:11], a[204:207], v[44:47], v[8:11]
    ds_read_b128 v[40:43], v2 offset:20480
    v_cndmask_b32 v118, v110, v111, s[44:45]
    v_mfma_f32_16x16x32_bf16 v[12:15], a[208:211], v[44:47], v[12:15]
    v_cndmask_b32 v119, v112, v113, s[44:45]
    v_mul_f32 v32, v32, v71
    v_mfma_f32_16x16x32_bf16 v[16:19], a[212:215], v[44:47], v[16:19]
    s_waitcnt lgkmcnt(3)
    v_mul_f32 v33, v33, v71
    v_mul_f32 v34, v34, v71
    v_mfma_f32_16x16x32_bf16 v[8:11], a[216:219], v[48:51], v[8:11]
    ds_read_b128 v[44:47], v2 offset:21504
    v_mul_f32 v35, v35, v71
    v_mfma_f32_16x16x32_bf16 v[12:15], a[220:223], v[48:51], v[12:15]
    v_cvt_pk_bf16_f32 v32, v32, v33
    v_cvt_pk_bf16_f32 v33, v34, v35
    v_mfma_f32_16x16x32_bf16 v[16:19], a[224:227], v[48:51], v[16:19]
    s_waitcnt lgkmcnt(3)
    ds_write_b64 v38, v[32:33]
    v_mfma_f32_16x16x32_bf16 v[8:11], a[228:231], v[52:55], v[8:11]
    ds_read_b128 v[48:51], v2 offset:22528
    v_sub_u32 v76, v2, v20
    v_mfma_f32_16x16x32_bf16 v[12:15], a[232:235], v[52:55], v[12:15]
    buffer_load_dwordx4 v1, s[8:11], s33 offen offset:0 sc1 lds
    v_mfma_f32_16x16x32_bf16 v[16:19], a[236:239], v[52:55], v[16:19]
    s_waitcnt lgkmcnt(3)
    ds_read_b64_tr_b16 v[94:95], v39
    v_mfma_f32_16x16x32_bf16 v[8:11], a[240:243], v[40:43], v[8:11]
    ds_read_b128 v[52:55], v2 offset:23552
    v_add_u32 v3, s35, v1
    v_mfma_f32_16x16x32_bf16 v[12:15], a[244:247], v[40:43], v[12:15]
    ds_read2st64_b64 v[80:83], v76 offset0:66 offset1:67
    v_mov_b32 v6, s54
    v_mfma_f32_16x16x32_bf16 v[16:19], a[248:251], v[40:43], v[16:19]
    s_waitcnt lgkmcnt(5)
    buffer_load_dwordx4 v1, s[8:11], s33 offen offset:1024 sc1 lds
    v_mfma_f32_16x16x32_bf16 v[8:11], a[252:255], v[44:47], v[8:11]
    ds_read_b128 v[40:43], v2 offset:24576
    s_min_i32 s39, s32, 31
    v_mfma_f32_16x16x32_bf16 v[12:15], v[128:131], v[44:47], v[12:15]
    ds_read2st64_b64 v[76:79], v76 offset0:64 offset1:65
    s_min_u32 s39, s39, 0x1000
    v_mfma_f32_16x16x32_bf16 v[16:19], v[132:135], v[44:47], v[16:19]
    s_waitcnt lgkmcnt(5)
    s_lshl_b32 s39, s39, 13
    v_mfma_f32_16x16x32_bf16 v[8:11], v[136:139], v[48:51], v[8:11]
    ds_read_b128 v[44:47], v2 offset:25600
    v_mfma_f32_16x16x32_bf16 v[12:15], v[140:143], v[48:51], v[12:15]
    buffer_load_dwordx4 v1, s[8:11], s33 offen offset:2048 sc1 lds
    v_mfma_f32_16x16x32_bf16 v[16:19], v[144:147], v[48:51], v[16:19]
    s_waitcnt lgkmcnt(4)
    v_mfma_f32_16x16x32_bf16 v[8:11], v[148:151], v[52:55], v[8:11]
    ds_read_b128 v[48:51], v2 offset:26624
    v_mfma_f32_16x16x32_bf16 v[12:15], v[152:155], v[52:55], v[12:15]
    v_mfma_f32_16x16x32_bf16 v[16:19], v[156:159], v[52:55], v[16:19]
    s_waitcnt lgkmcnt(3)
    buffer_load_dwordx4 v1, s[8:11], s33 offen offset:3072 sc1 lds
    v_mfma_f32_16x16x32_bf16 v[8:11], v[160:163], v[40:43], v[8:11]
    ds_read_b128 v[52:55], v2 offset:27648
    s_add_u32 m0, s34, 4096
    v_mfma_f32_16x16x32_bf16 v[12:15], v[164:167], v[40:43], v[12:15]
    s_add_u32 s37, s33, 4096
    v_mfma_f32_16x16x32_bf16 v[16:19], v[168:171], v[40:43], v[16:19]
    s_waitcnt lgkmcnt(2)
    v_add_f32 v76, v76, v80
    v_add_f32 v77, v77, v81
    v_mfma_f32_16x16x32_bf16 v[8:11], v[172:175], v[44:47], v[8:11]
    ds_read_b128 v[40:43], v2 offset:28672
    v_add_f32 v78, v78, v82
    v_mfma_f32_16x16x32_bf16 v[12:15], v[176:179], v[44:47], v[12:15]
    buffer_load_dwordx4 v1, s[8:11], s37 offen offset:0 sc1 lds
    v_mfma_f32_16x16x32_bf16 v[16:19], v[180:183], v[44:47], v[16:19]
    s_waitcnt lgkmcnt(2)
    v_add_f32 v79, v79, v83
    v_add_f32 v68, v76, v78
    v_mfma_f32_16x16x32_bf16 v[8:11], v[184:187], v[48:51], v[8:11]
    ds_read_b128 v[44:47], v2 offset:29696
    v_add_f32 v69, v77, v79
    v_mfma_f32_16x16x32_bf16 v[12:15], v[188:191], v[48:51], v[12:15]
    v_mfma_f32_16x16x32_bf16 v[16:19], v[192:195], v[48:51], v[16:19]
    s_waitcnt lgkmcnt(2)
    buffer_load_dwordx4 v1, s[8:11], s37 offen offset:1024 sc1 lds
    v_mfma_f32_16x16x32_bf16 v[8:11], v[196:199], v[52:55], v[8:11]
    ds_read_b128 v[48:51], v2 offset:30720
    v_mfma_f32_16x16x32_bf16 v[12:15], v[200:203], v[52:55], v[12:15]
    s_waitcnt vmcnt(9)
    s_barrier
    v_mfma_f32_16x16x32_bf16 v[16:19], v[204:207], v[52:55], v[16:19]
    s_waitcnt lgkmcnt(2)
    v_permlane16_swap_b32 v68, v69
    v_mfma_f32_16x16x32_bf16 v[8:11], v[208:211], v[40:43], v[8:11]
    ds_read_b128 v[52:55], v2 offset:31744
    v_add_f32 v68, v68, v69
    v_mfma_f32_16x16x32_bf16 v[12:15], v[212:215], v[40:43], v[12:15]
    buffer_load_dwordx4 v1, s[8:11], s37 offen offset:2048 sc1 lds
    v_mfma_f32_16x16x32_bf16 v[16:19], v[216:219], v[40:43], v[16:19]
    s_waitcnt lgkmcnt(2)
    v_mov_b32 v69, v68
    v_mfma_f32_16x16x32_bf16 v[8:11], v[220:223], v[44:47], v[8:11]
    ds_read_b128 v[40:43], v3 offset:0
    v_mfma_f32_16x16x32_bf16 v[12:15], v[224:227], v[44:47], v[12:15]
    v_permlane32_swap_b32 v68, v69
    v_mfma_f32_16x16x32_bf16 v[16:19], v[228:231], v[44:47], v[16:19]
    s_waitcnt lgkmcnt(2)
    buffer_load_dwordx4 v1, s[8:11], s37 offen offset:3072 sc1 lds
    v_mfma_f32_16x16x32_bf16 v[8:11], v[232:235], v[48:51], v[8:11]
    ds_read_b128 v[44:47], v3 offset:1024
    v_add_f32 v68, v68, v69
    v_mfma_f32_16x16x32_bf16 v[12:15], v[236:239], v[48:51], v[12:15]
    s_add_u32 m0, s34, 8192
    v_mul_f32 v68, 0x3a800000, v68
    v_mov_b32 v69, v68
    v_mfma_f32_16x16x32_bf16 v[16:19], v[240:243], v[48:51], v[16:19]
    s_waitcnt lgkmcnt(2)
    v_permlane16_swap_b32 v68, v69
    v_mfma_f32_16x16x32_bf16 v[8:11], v[244:247], v[52:55], v[8:11]
    ds_read_b128 v[48:51], v3 offset:2048
    v_fma_f32 v69, -v68, v68, v69
    v_mfma_f32_16x16x32_bf16 v[12:15], v[248:251], v[52:55], v[12:15]
    s_add_u32 s37, s33, 8192
    v_max_f32 v69, 0, v69
    v_add_f32 v69, 0x3727c5ac, v69
    v_mfma_f32_16x16x32_bf16 v[16:19], v[252:255], v[52:55], v[16:19]
    buffer_load_dwordx4 v1, s[8:11], s37 offen offset:0 sc1 lds
    v_rsq_f32 v69, v69
    s_nop 1
    s_and_b32 s37, s31, 30
    s_cbranch_scc1 Lqkv_g1
    s_branch Lqkv_s1
Lqkv_slows1:
Lqkv_spins1:
    buffer_load_dword v5, v4, s[4:7], s16 offen sc1
    s_waitcnt vmcnt(0)
    v_cmp_gt_i32 vcc, s32, v5
    s_sub_u32 s43, s43, 1
    s_cmp_lt_i32 s43, 0
    s_cbranch_scc1 Lqkv_backs1
    s_and_b64 vcc, vcc, s[18:19]
    s_cbranch_scc0 Lqkv_backs1
    s_sleep 8
    s_branch Lqkv_spins1
Lqkv_slows0:
Lqkv_spins0:
    buffer_load_dword v5, v4, s[4:7], s16 offen sc1
    s_waitcnt vmcnt(0)
    v_cmp_gt_i32 vcc, s32, v5
    s_sub_u32 s43, s43, 1
    s_cmp_lt_i32 s43, 0
    s_cbranch_scc1 Lqkv_backs0
    s_and_b64 vcc, vcc, s[18:19]
    s_cbranch_scc0 Lqkv_backs0
    s_sleep 8
    s_branch Lqkv_spins0
Lqkv_slowg1:
Lqkv_sping1:
    buffer_load_dword v5, v4, s[4:7], s16 offen sc1
    s_waitcnt vmcnt(0)
    v_cmp_gt_i32 vcc, s32, v5
    s_sub_u32 s43, s43, 1
    s_cmp_lt_i32 s43, 0
    s_cbranch_scc1 Lqkv_backg1
    s_and_b64 vcc, vcc, s[18:19]
    s_cbranch_scc0 Lqkv_backg1
    s_sleep 8
    s_branch Lqkv_sping1
Lqkv_slowg0:
Lqkv_sping0:
    buffer_load_dword v5, v4, s[4:7], s16 offen sc1
    s_waitcnt vmcnt(0)
    v_cmp_gt_i32 vcc, s32, v5
    s_sub_u32 s43, s43, 1
    s_cmp_lt_i32 s43, 0
    s_cbranch_scc1 Lqkv_backg0
    s_and_b64 vcc, vcc, s[18:19]
    s_cbranch_scc0 Lqkv_backg0
    s_sleep 8
    s_branch Lqkv_sping0
Lqkv_tail:
    ds_read_b64 v[122:123], v37 offset:2048
    v_fma_f32 v28, -v70, v60, v28
    v_fma_f32 v29, -v70, v61, v29
    v_fma_f32 v30, -v70, v62, v30
    v_fma_f32 v31, -v70, v63, v31
    v_mul_f32 v28, v28, v71
    v_mul_f32 v29, v29, v71
    v_mul_f32 v30, v30, v71
    v_mul_f32 v31, v31, v71
    v_cvt_pk_bf16_f32 v84, v28, v29
    v_cvt_pk_bf16_f32 v85, v30, v31
    v_fma_f32 v32, -v70, v64, v32
    v_fma_f32 v33, -v70, v65, v33
    v_mfma_f32_16x16x32_bf16 v[106:109], v[84:87], v[88:91], 0
    v_fma_f32 v24, -v70, v56, v24
    v_fma_f32 v25, -v70, v57, v25
    v_fma_f32 v26, -v70, v58, v26
    v_fma_f32 v27, -v70, v59, v27
    v_mul_f32 v24, v24, v71
    v_mul_f32 v25, v25, v71
    v_mul_f32 v26, v26, v71
    v_mul_f32 v27, v27, v71
    v_cvt_pk_bf16_f32 v88, v24, v25
    v_cvt_pk_bf16_f32 v89, v26, v27
    v_fma_f32 v34, -v70, v66, v34
    v_fma_f32 v35, -v70, v67, v35
    v_mfma_f32_16x16x32_bf16 v[110:113], v[84:87], v[88:91], 0
    v_cndmask_b32 v106, v106, v107, s[44:45]
    v_cndmask_b32 v108, v108, v109, s[44:45]
    v_mul_f32 v32, v32, v71
    v_mul_f32 v33, v33, v71
    v_mul_f32 v34, v34, v71
    v_mul_f32 v35, v35, v71
    v_cvt_pk_bf16_f32 v32, v32, v33
    v_cvt_pk_bf16_f32 v33, v34, v35
    ds_write_b64 v38, v[32:33]
    v_mov_b32 v6, s54
    s_waitcnt lgkmcnt(1)
    v_add_f32 v122, v122, v120
    v_add_f32 v123, v123, v121
    v_max_f32 v22, v122, v123
    v_mov_b32 v23, v22
    v_cndmask_b32 v120, v106, v118, s[48:49]
    v_cndmask_b32 v121, v108, v119, s[50:51]
    v_permlane16_swap_b32 v22, v23
    v_max_f32 v22, v22, v23
    v_mov_b32 v23, v22
    ds_write_b64 v36, v[120:121] offset:0
    v_cndmask_b32 v118, v110, v111, s[44:45]
    v_permlane32_swap_b32 v22, v23
    v_max_f32 v22, v22, v23
    v_mul_f32 v22, s52, v22
    v_fma_f32 v122, v122, s52, -v22
    v_fma_f32 v123, v123, s52, -v22
    v_exp_f32 v122, v122
    v_exp_f32 v123, v123
    v_cndmask_b32 v119, v112, v113, s[44:45]
    v_add_f32 v22, v122, v123
    v_mov_b32 v23, v22
    s_nop 1
    v_permlane16_swap_b32 v22, v23
    v_add_f32 v22, v22, v23
    v_mov_b32 v23, v22
    s_nop 1
    v_permlane32_swap_b32 v22, v23
    v_add_f32 v22, v22, v23
    v_rcp_f32 v22, v22
    s_nop 0
    v_mul_f32 v122, v122, v22
    v_mul_f32 v123, v123, v22
    v_cvt_pk_bf16_f32 v23, v122, v123
    v_perm_b32 v114, v23, v23, v102
    v_perm_b32 v115, v23, v23, v103
    v_perm_b32 v116, v23, v23, v104
    v_perm_b32 v117, v23, v23, v105
    s_nop 1
    v_mfma_f32_16x16x32_bf16 v[72:75], v[92:95], v[114:117], 0
    ds_read_b64_tr_b16 v[94:95], v39
    s_nop 6
    v_cvt_pk_bf16_f32 v114, v72, v73
    v_cvt_pk_bf16_f32 v115, v74, v75
    v_cvt_pk_bf16_f32 v116, v72, v73
    v_cvt_pk_bf16_f32 v117, v74, v75
    s_nop 0
    v_permlane32_swap_b32 v114, v116
    v_permlane32_swap_b32 v115, v117
    s_waitcnt vmcnt(9)
    buffer_store_dword v6, v21, s[12:15], s17 offen sc1
    buffer_store_dwordx4 v[114:117], v7, s[12:15], s36 offen sc1
    s_add_u32 s36, s36, 32768
    s_waitcnt lgkmcnt(0)
    s_barrier
    ds_read_b64 v[122:123], v37 offset:0
    buffer_load_dwordx4 v[96:99], v1, s[24:27], s41 offen sc1
    s_add_u32 s41, s41, 262144
    v_mov_b32 v106, s42
    v_mov_b32 v107, s42
    v_mov_b32 v108, s42
    v_mov_b32 v109, s42
    s_waitcnt lgkmcnt(0)
    v_add_f32 v122, v122, v120
    v_add_f32 v123, v123, v121
    v_max_f32 v22, v122, v123
    v_mov_b32 v23, v22
    s_nop 1
    v_permlane16_swap_b32 v22, v23
    v_max_f32 v22, v22, v23
    v_mov_b32 v23, v22
    s_nop 1
    v_permlane32_swap_b32 v22, v23
    v_max_f32 v22, v22, v23
    v_mul_f32 v22, s52, v22
    v_fma_f32 v122, v122, s52, -v22
    v_fma_f32 v123, v123, s52, -v22
    v_exp_f32 v122, v122
    v_exp_f32 v123, v123
    s_nop 0
    v_add_f32 v22, v122, v123
    v_mov_b32 v23, v22
    s_nop 1
    v_permlane16_swap_b32 v22, v23
    v_add_f32 v22, v22, v23
    v_mov_b32 v23, v22
    s_nop 1
    v_permlane32_swap_b32 v22, v23
    v_add_f32 v22, v22, v23
    v_rcp_f32 v22, v22
    s_nop 0
    v_mul_f32 v122, v122, v22
    v_mul_f32 v123, v123, v22
    v_cvt_pk_bf16_f32 v23, v122, v123
    v_perm_b32 v116, v23, v23, v102
    v_perm_b32 v117, v23, v23, v103
    v_perm_b32 v114, v23, v23, v104
    v_perm_b32 v115, v23, v23, v105
    s_nop 1
    v_mfma_f32_16x16x32_bf16 v[72:75], v[92:95], v[114:117], 0
    s_nop 7
    v_cvt_pk_bf16_f32 v114, v72, v73
    v_cvt_pk_bf16_f32 v115, v74, v75
    v_cvt_pk_bf16_f32 v116, v72, v73
    v_cvt_pk_bf16_f32 v117, v74, v75
    s_nop 0
    v_permlane32_swap_b32 v114, v116
    v_permlane32_swap_b32 v115, v117
    buffer_store_dwordx4 v[114:117], v7, s[12:15], s36 offen sc1
    s_add_u32 s36, s36, 32768
    s_waitcnt vmcnt(1)
    v_mfma_f32_16x16x32_bf16 v[106:109], v[96:99], v[88:91], v[106:109]
    s_nop 7
    v_cndmask_b32 v106, v106, v107, s[44:45]
    v_cndmask_b32 v108, v108, v109, s[44:45]
    v_cndmask_b32 v120, v106, v118, s[48:49]
    v_cndmask_b32 v121, v108, v119, s[50:51]
    ds_write_b64 v36, v[120:121] offset:2048
    s_waitcnt lgkmcnt(0)
    s_barrier
    ds_read_b64 v[122:123], v37 offset:2048
    s_waitcnt lgkmcnt(0)
    v_add_f32 v122, v122, v120
    v_add_f32 v123, v123, v121
    v_max_f32 v22, v122, v123
    v_mov_b32 v23, v22
    s_nop 1
    v_permlane16_swap_b32 v22, v23
    v_max_f32 v22, v22, v23
    v_mov_b32 v23, v22
    s_nop 1
    v_permlane32_swap_b32 v22, v23
    v_max_f32 v22, v22, v23
    v_mul_f32 v22, s52, v22
    v_fma_f32 v122, v122, s52, -v22
    v_fma_f32 v123, v123, s52, -v22
    v_exp_f32 v122, v122
    v_exp_f32 v123, v123
    s_nop 0
    v_add_f32 v22, v122, v123
    v_mov_b32 v23, v22
    s_nop 1
    v_permlane16_swap_b32 v22, v23
    v_add_f32 v22, v22, v23
    v_mov_b32 v23, v22
    s_nop 1
    v_permlane32_swap_b32 v22, v23
    v_add_f32 v22, v22, v23
    v_rcp_f32 v22, v22
    s_nop 0
    v_mul_f32 v122, v122, v22
    v_mul_f32 v123, v123, v22
    v_cvt_pk_bf16_f32 v23, v122, v123
    v_perm_b32 v114, v23, v23, v102
    v_perm_b32 v115, v23, v23, v103
    v_perm_b32 v116, v23, v23, v104
    v_perm_b32 v117, v23, v23, v105
    v_mov_b32 v100, v94
    v_mov_b32 v101, v95
    s_nop 1
    v_mfma_f32_16x16x32_bf16 v[72:75], v[98:101], v[114:117], 0
    s_nop 7
    v_cvt_pk_bf16_f32 v114, v72, v73
    v_cvt_pk_bf16_f32 v115, v74, v75
    v_cvt_pk_bf16_f32 v116, v72, v73
    v_cvt_pk_bf16_f32 v117, v74, v75
    s_nop 0
    v_permlane32_swap_b32 v114, v116
    v_permlane32_swap_b32 v115, v117
    buffer_store_dwordx4 v[114:117], v7, s[12:15], s36 offen sc1
    s_add_u32 s36, s36, 32768
    v_mov_b32 v8, 62
    s_add_u32 s17, s17, 8192
    buffer_store_dword v8, v21, s[12:15], s17 offen sc1
    v_mov_b32 v9, 63
    s_waitcnt vmcnt(2)
    s_add_u32 s17, s17, 8192
    buffer_store_dword v9, v21, s[12:15], s17 offen sc1
    v_mov_b32 v10, 64
    s_waitcnt vmcnt(2)
    s_add_u32 s17, s17, 8192
    buffer_store_dword v10, v21, s[12:15], s17 offen sc1
    s_branch L_exit
Lwo_start:
    s_mov_b32 s12, s68
    s_mov_b32 s13, s69
    s_mov_b32 s14, 0x200000
    s_mov_b32 s15, 0x00020000
    v_lshrrev_b32 v24, 3, v0
    v_mul_u32_u24 v24, 2048, v24
    v_bfe_u32 v25, v0, 4, 2
    v_lshlrev_b32 v25, 1, v25
    v_and_b32 v26, 7, v0
    v_xor_b32 v25, v25, v26
    v_lshl_add_u32 v40, v25, 4, v24
    v_add_u32 v41, 15360, v40
    s_mul_i32 s86, s29, 0x100
    s_add_u32 s86, s86, 0xfffff000
    s_mul_i32 s37, s30, 32768
    s_add_u32 s86, s86, s37
    s_lshl_b32 s87, s30, 11
    s_add_u32 m0, s87, 0
    s_add_u32 s37, s86, 0
    buffer_load_dwordx4 v40, s[12:15], s37 offen lds
    buffer_load_dwordx4 v41, s[12:15], s37 offen offset:1024 lds
    s_add_u32 m0, s87, 8192
    s_add_u32 s37, s86, 128
    buffer_load_dwordx4 v40, s[12:15], s37 offen lds
    buffer_load_dwordx4 v41, s[12:15], s37 offen offset:1024 lds
    s_add_u32 m0, s87, 16384
    s_add_u32 s37, s86, 131072
    buffer_load_dwordx4 v40, s[12:15], s37 offen lds
    buffer_load_dwordx4 v41, s[12:15], s37 offen offset:1024 lds
    s_add_u32 m0, s87, 24576
    s_add_u32 s37, s86, 131200
    buffer_load_dwordx4 v40, s[12:15], s37 offen lds
    buffer_load_dwordx4 v41, s[12:15], s37 offen offset:1024 lds
    s_add_u32 m0, s87, 32768
    s_add_u32 s37, s86, 262144
    buffer_load_dwordx4 v40, s[12:15], s37 offen lds
    buffer_load_dwordx4 v41, s[12:15], s37 offen offset:1024 lds
    s_add_u32 m0, s87, 40960
    s_add_u32 s37, s86, 262272
    buffer_load_dwordx4 v40, s[12:15], s37 offen lds
    buffer_load_dwordx4 v41, s[12:15], s37 offen offset:1024 lds
    s_add_u32 m0, s87, 49152
    s_add_u32 s37, s86, 393216
    buffer_load_dwordx4 v40, s[12:15], s37 offen lds
    buffer_load_dwordx4 v41, s[12:15], s37 offen offset:1024 lds
    s_add_u32 m0, s87, 57344
    s_add_u32 s37, s86, 393344
    buffer_load_dwordx4 v40, s[12:15], s37 offen lds
    buffer_load_dwordx4 v41, s[12:15], s37 offen offset:1024 lds
    s_add_u32 m0, s87, 65536
    s_add_u32 s37, s86, 524288
    buffer_load_dwordx4 v40, s[12:15], s37 offen lds
    buffer_load_dwordx4 v41, s[12:15], s37 offen offset:1024 lds
    s_add_u32 m0, s87, 73728
    s_add_u32 s37, s86, 524416
    buffer_load_dwordx4 v40, s[12:15], s37 offen lds
    buffer_load_dwordx4 v41, s[12:15], s37 offen offset:1024 lds
    s_add_u32 m0, s87, 81920
    s_add_u32 s37, s86, 655360
    buffer_load_dwordx4 v40, s[12:15], s37 offen lds
    buffer_load_dwordx4 v41, s[12:15], s37 offen offset:1024 lds
    s_add_u32 m0, s87, 90112
    s_add_u32 s37, s86, 655488
    buffer_load_dwordx4 v40, s[12:15], s37 offen lds
    buffer_load_dwordx4 v41, s[12:15], s37 offen offset:1024 lds
    s_add_u32 m0, s87, 98304
    s_add_u32 s37, s86, 786432
    buffer_load_dwordx4 v40, s[12:15], s37 offen lds
    buffer_load_dwordx4 v41, s[12:15], s37 offen offset:1024 lds
    s_add_u32 m0, s87, 106496
    s_add_u32 s37, s86, 786560
    buffer_load_dwordx4 v40, s[12:15], s37 offen lds
    buffer_load_dwordx4 v41, s[12:15], s37 offen offset:1024 lds
    s_add_u32 m0, s87, 114688
    s_add_u32 s37, s86, 917504
    buffer_load_dwordx4 v40, s[12:15], s37 offen lds
    buffer_load_dwordx4 v41, s[12:15], s37 offen offset:1024 lds
    s_add_u32 m0, s87, 122880
    s_add_u32 s37, s86, 917632
    buffer_load_dwordx4 v40, s[12:15], s37 offen lds
    buffer_load_dwordx4 v41, s[12:15], s37 offen offset:1024 lds
    s_add_u32 m0, s87, 131072
    s_add_u32 s37, s86, 1048576
    buffer_load_dwordx4 v40, s[12:15], s37 offen lds
    buffer_load_dwordx4 v41, s[12:15], s37 offen offset:1024 lds
    s_add_u32 m0, s87, 139264
    s_add_u32 s37, s86, 1048704
    buffer_load_dwordx4 v40, s[12:15], s37 offen lds
    buffer_load_dwordx4 v41, s[12:15], s37 offen offset:1024 lds
    v_bfe_u32 v24, v0, 3, 2
    v_and_b32 v25, 3, v0
    v_lshlrev_b32 v25, 3, v25
    v_lshrrev_b32 v26, 2, v0
    v_lshl_add_u32 v26, v26, 7, v25
    v_lshrrev_b32 v27, 5, v0
    v_lshl_add_u32 v27, v27, 10, v26
    s_lshr_b32 s37, s30, 1
    s_and_b32 s38, s30, 1
    s_lshl_b32 s38, s38, 1
    s_add_u32 s38, s38, 0
    s_lshl_b32 s37, s37, 13
    v_xor_b32 v28, s38, v24
    v_lshl_add_u32 v28, v28, 5, s37
    v_add_u32 v42, v28, v26
    v_add_u32 v46, v28, v27
    s_lshr_b32 s37, s30, 1
    s_and_b32 s38, s30, 1
    s_lshl_b32 s38, s38, 1
    s_add_u32 s38, s38, 1
    s_lshl_b32 s37, s37, 13
    v_xor_b32 v28, s38, v24
    v_lshl_add_u32 v28, v28, 5, s37
    v_add_u32 v43, v28, v26
    v_add_u32 v47, v28, v27
    v_mov_b32 v84, 0x3f803f80
    v_mov_b32 v85, 0x3f803f80
    v_mov_b32 v86, 0x3f803f80
    v_mov_b32 v87, 0x3f803f80
    s_mov_b32 s44, 0xaaaaaaaa
    s_mov_b32 s45, 0xaaaaaaaa
    s_mov_b32 s46, 0xcccccccc
    s_mov_b32 s47, 0xcccccccc
    s_mov_b32 s38, 0xf0000f
    s_mov_b32 s39, 0xf0000f00
    v_and_b32 v8, 15, v0
    v_lshlrev_b32 v8, 3, v8
    v_mov_b32 v7, 0x40000000
    v_cndmask_b32 v7, v7, v8, s[38:39]
    s_mul_i32 s37, s29, 0xfffff200
    s_mul_i32 s53, s30, 0xfffffc80
    s_add_u32 s37, s37, s53
    s_add_u32 s37, s37, 0x16000
    v_add_u32 v7, s37, v7
    v_mov_b32 v88, 0
    v_mov_b32 v89, 0
    v_mov_b32 v92, 0
    v_mov_b32 v93, 0
    v_mov_b32 v8, 0x3f80
    v_mov_b32 v9, 0x3f800000
    s_mov_b32 s38, 0x100001
    s_mov_b32 s39, 0x10000100
    v_cndmask_b32 v90, v88, v8, s[38:39]
    s_mov_b32 s38, 0x200002
    s_mov_b32 s39, 0x20000200
    v_cndmask_b32 v90, v90, v9, s[38:39]
    s_mov_b32 s38, 0x400004
    s_mov_b32 s39, 0x40000400
    v_cndmask_b32 v91, v88, v8, s[38:39]
    s_mov_b32 s38, 0x800008
    s_mov_b32 s39, 0x80000800
    v_cndmask_b32 v91, v91, v9, s[38:39]
    s_mul_i32 s37, s28, 0x80000
    s_add_u32 s37, s37, 0x6000000
    v_min_u32 v4, 63, v0
    v_lshl_add_u32 v4, v4, 5, s37
    s_mov_b32 s32, 1
    s_mul_i32 s33, s28, 0x200000
    s_add_u32 s33, s33, 0xa00000
    s_mul_i32 s40, s28, 0x220000
    s_mul_i32 s53, s29, 0x1000
    s_add_u32 s40, s40, s53
    s_mul_i32 s53, s30, 0x400
    s_add_u32 s40, s40, s53
    s_add_u32 s40, s40, 0xffff0000
    s_mul_i32 s36, s28, 0x240000
    s_mul_i32 s53, s29, 0x1000
    s_add_u32 s36, s36, s53
    s_mul_i32 s53, s30, 0x400
    s_add_u32 s36, s36, s53
    s_add_u32 s36, s36, 0x11e7000
    s_mov_b32 s31, -1
    s_mov_b32 s35, 0
    s_mov_b32 s16, 0
    v_mov_b32 v5, 0
    s_mul_i32 s17, s28, 0x80000
    s_mul_i32 s53, s29, 0x80
    s_add_u32 s17, s17, s53
    s_mul_i32 s53, s30, 0x20
    s_add_u32 s17, s17, s53
    s_add_u32 s17, s17, 0x5ffe000
    v_cmp_eq_u32 vcc, 0, v0
    v_mov_b32 v102, 0x40000000
    s_nop 0
    v_cndmask_b32 v102, v102, v0, vcc
    v_mov_b32 v2, v1
    s_mul_i32 s34, s30, 8192
    s_add_u32 s33, s33, s34
    s_mov_b64 s[18:19], -1
    v_mov_b32 v8, 0x40000000
    v_cndmask_b32 v4, v8, v4, s[18:19]
    v_add_u32 v50, 0, v46
    v_add_u32 v51, 0, v47
    s_waitcnt vmcnt(32)
    s_barrier
    ds_read_b64_tr_b16 a[0:1], v50 offset:0
    ds_read_b64_tr_b16 a[2:3], v50 offset:1024
    ds_read_b64_tr_b16 a[4:5], v51 offset:0
    ds_read_b64_tr_b16 a[6:7], v51 offset:1024
    ds_read_b64_tr_b16 a[8:9], v50 offset:4096
    ds_read_b64_tr_b16 a[10:11], v50 offset:5120
    ds_read_b64_tr_b16 a[12:13], v51 offset:4096
    ds_read_b64_tr_b16 a[14:15], v51 offset:5120
    s_add_u32 m0, s87, 147456
    s_add_u32 s37, s86, 1179648
    buffer_load_dwordx4 v40, s[12:15], s37 offen lds
    buffer_load_dwordx4 v41, s[12:15], s37 offen offset:1024 lds
    s_add_u32 m0, s87, 155648
    s_add_u32 s37, s86, 1179776
    buffer_load_dwordx4 v40, s[12:15], s37 offen lds
    buffer_load_dwordx4 v41, s[12:15], s37 offen offset:1024 lds
    s_waitcnt lgkmcnt(0)
    v_add_u32 v50, 16384, v46
    v_add_u32 v51, 16384, v47
    s_waitcnt vmcnt(32)
    s_barrier
    ds_read_b64_tr_b16 a[16:17], v50 offset:0
    ds_read_b64_tr_b16 a[18:19], v50 offset:1024
    ds_read_b64_tr_b16 a[20:21], v51 offset:0
    ds_read_b64_tr_b16 a[22:23], v51 offset:1024
    ds_read_b64_tr_b16 a[24:25], v50 offset:4096
    ds_read_b64_tr_b16 a[26:27], v50 offset:5120
    ds_read_b64_tr_b16 a[28:29], v51 offset:4096
    ds_read_b64_tr_b16 a[30:31], v51 offset:5120
    s_add_u32 m0, s87, 0
    s_add_u32 s37, s86, 1310720
    buffer_load_dwordx4 v40, s[12:15], s37 offen lds
    buffer_load_dwordx4 v41, s[12:15], s37 offen offset:1024 lds
    s_add_u32 m0, s87, 8192
    s_add_u32 s37, s86, 1310848
    buffer_load_dwordx4 v40, s[12:15], s37 offen lds
    buffer_load_dwordx4 v41, s[12:15], s37 offen offset:1024 lds
    s_waitcnt lgkmcnt(0)
    v_add_u32 v50, 32768, v46
    v_add_u32 v51, 32768, v47
    s_waitcnt vmcnt(32)
    s_barrier
    ds_read_b64_tr_b16 a[32:33], v50 offset:0
    ds_read_b64_tr_b16 a[34:35], v50 offset:1024
    ds_read_b64_tr_b16 a[36:37], v51 offset:0
    ds_read_b64_tr_b16 a[38:39], v51 offset:1024
    ds_read_b64_tr_b16 a[40:41], v50 offset:4096
    ds_read_b64_tr_b16 a[42:43], v50 offset:5120
    ds_read_b64_tr_b16 a[44:45], v51 offset:4096
    ds_read_b64_tr_b16 a[46:47], v51 offset:5120
    s_add_u32 m0, s87, 16384
    s_add_u32 s37, s86, 1441792
    buffer_load_dwordx4 v40, s[12:15], s37 offen lds
    buffer_load_dwordx4 v41, s[12:15], s37 offen offset:1024 lds
    s_add_u32 m0, s87, 24576
    s_add_u32 s37, s86, 1441920
    buffer_load_dwordx4 v40, s[12:15], s37 offen lds
    buffer_load_dwordx4 v41, s[12:15], s37 offen offset:1024 lds
    s_waitcnt lgkmcnt(0)
    v_add_u32 v50, 49152, v46
    v_add_u32 v51, 49152, v47
    s_waitcnt vmcnt(32)
    s_barrier
    ds_read_b64_tr_b16 a[48:49], v50 offset:0
    ds_read_b64_tr_b16 a[50:51], v50 offset:1024
    ds_read_b64_tr_b16 a[52:53], v51 offset:0
    ds_read_b64_tr_b16 a[54:55], v51 offset:1024
    ds_read_b64_tr_b16 a[56:57], v50 offset:4096
    ds_read_b64_tr_b16 a[58:59], v50 offset:5120
    ds_read_b64_tr_b16 a[60:61], v51 offset:4096
    ds_read_b64_tr_b16 a[62:63], v51 offset:5120
    s_add_u32 m0, s87, 32768
    s_add_u32 s37, s86, 1572864
    buffer_load_dwordx4 v40, s[12:15], s37 offen lds
    buffer_load_dwordx4 v41, s[12:15], s37 offen offset:1024 lds
    s_add_u32 m0, s87, 40960
    s_add_u32 s37, s86, 1572992
    buffer_load_dwordx4 v40, s[12:15], s37 offen lds
    buffer_load_dwordx4 v41, s[12:15], s37 offen offset:1024 lds
    s_waitcnt lgkmcnt(0)
    v_add_u32 v50, 65536, v46
    v_add_u32 v51, 65536, v47
    s_waitcnt vmcnt(32)
    s_barrier
    ds_read_b64_tr_b16 a[64:65], v50 offset:0
    ds_read_b64_tr_b16 a[66:67], v50 offset:1024
    ds_read_b64_tr_b16 a[68:69], v51 offset:0
    ds_read_b64_tr_b16 a[70:71], v51 offset:1024
    ds_read_b64_tr_b16 a[72:73], v50 offset:4096
    ds_read_b64_tr_b16 a[74:75], v50 offset:5120
    ds_read_b64_tr_b16 a[76:77], v51 offset:4096
    ds_read_b64_tr_b16 a[78:79], v51 offset:5120
    s_add_u32 m0, s87, 49152
    s_add_u32 s37, s86, 1703936
    buffer_load_dwordx4 v40, s[12:15], s37 offen lds
    buffer_load_dwordx4 v41, s[12:15], s37 offen offset:1024 lds
    s_add_u32 m0, s87, 57344
    s_add_u32 s37, s86, 1704064
    buffer_load_dwordx4 v40, s[12:15], s37 offen lds
    buffer_load_dwordx4 v41, s[12:15], s37 offen offset:1024 lds
    s_waitcnt lgkmcnt(0)
    v_add_u32 v50, 81920, v46
    v_add_u32 v51, 81920, v47
    s_waitcnt vmcnt(32)
    s_barrier
    ds_read_b64_tr_b16 a[80:81], v50 offset:0
    ds_read_b64_tr_b16 a[82:83], v50 offset:1024
    ds_read_b64_tr_b16 a[84:85], v51 offset:0
    ds_read_b64_tr_b16 a[86:87], v51 offset:1024
    ds_read_b64_tr_b16 a[88:89], v50 offset:4096
    ds_read_b64_tr_b16 a[90:91], v50 offset:5120
    ds_read_b64_tr_b16 a[92:93], v51 offset:4096
    ds_read_b64_tr_b16 a[94:95], v51 offset:5120
    s_add_u32 m0, s87, 65536
    s_add_u32 s37, s86, 1835008
    buffer_load_dwordx4 v40, s[12:15], s37 offen lds
    buffer_load_dwordx4 v41, s[12:15], s37 offen offset:1024 lds
    s_add_u32 m0, s87, 73728
    s_add_u32 s37, s86, 1835136
    buffer_load_dwordx4 v40, s[12:15], s37 offen lds
    buffer_load_dwordx4 v41, s[12:15], s37 offen offset:1024 lds
    s_waitcnt lgkmcnt(0)
    v_add_u32 v50, 98304, v46
    v_add_u32 v51, 98304, v47
    s_waitcnt vmcnt(32)
    s_barrier
    ds_read_b64_tr_b16 a[96:97], v50 offset:0
    ds_read_b64_tr_b16 a[98:99], v50 offset:1024
    ds_read_b64_tr_b16 a[100:101], v51 offset:0
    ds_read_b64_tr_b16 a[102:103], v51 offset:1024
    ds_read_b64_tr_b16 a[104:105], v50 offset:4096
    ds_read_b64_tr_b16 a[106:107], v50 offset:5120
    ds_read_b64_tr_b16 a[108:109], v51 offset:4096
    ds_read_b64_tr_b16 a[110:111], v51 offset:5120
    s_add_u32 m0, s87, 81920
    s_add_u32 s37, s86, 1966080
    buffer_load_dwordx4 v40, s[12:15], s37 offen lds
    buffer_load_dwordx4 v41, s[12:15], s37 offen offset:1024 lds
    s_add_u32 m0, s87, 90112
    s_add_u32 s37, s86, 1966208
    buffer_load_dwordx4 v40, s[12:15], s37 offen lds
    buffer_load_dwordx4 v41, s[12:15], s37 offen offset:1024 lds
    s_waitcnt lgkmcnt(0)
    v_add_u32 v50, 114688, v46
    v_add_u32 v51, 114688, v47
    s_waitcnt vmcnt(32)
    s_barrier
    ds_read_b64_tr_b16 a[112:113], v50 offset:0
    ds_read_b64_tr_b16 a[114:115], v50 offset:1024
    ds_read_b64_tr_b16 a[116:117], v51 offset:0
    ds_read_b64_tr_b16 a[118:119], v51 offset:1024
    ds_read_b64_tr_b16 a[120:121], v50 offset:4096
    ds_read_b64_tr_b16 a[122:123], v50 offset:5120
    ds_read_b64_tr_b16 a[124:125], v51 offset:4096
    ds_read_b64_tr_b16 a[126:127], v51 offset:5120
    s_waitcnt lgkmcnt(0)
    v_add_u32 v50, 131072, v46
    v_add_u32 v51, 131072, v47
    s_waitcnt vmcnt(28)
    s_barrier
    ds_read_b64_tr_b16 a[128:129], v50 offset:0
    ds_read_b64_tr_b16 a[130:131], v50 offset:1024
    ds_read_b64_tr_b16 a[132:133], v51 offset:0
    ds_read_b64_tr_b16 a[134:135], v51 offset:1024
    ds_read_b64_tr_b16 a[136:137], v50 offset:4096
    ds_read_b64_tr_b16 a[138:139], v50 offset:5120
    ds_read_b64_tr_b16 a[140:141], v51 offset:4096
    ds_read_b64_tr_b16 a[142:143], v51 offset:5120
    s_waitcnt lgkmcnt(0)
    v_add_u32 v50, 147456, v46
    v_add_u32 v51, 147456, v47
    s_waitcnt vmcnt(24)
    s_barrier
    ds_read_b64_tr_b16 a[144:145], v50 offset:0
    ds_read_b64_tr_b16 a[146:147], v50 offset:1024
    ds_read_b64_tr_b16 a[148:149], v51 offset:0
    ds_read_b64_tr_b16 a[150:151], v51 offset:1024
    ds_read_b64_tr_b16 a[152:153], v50 offset:4096
    ds_read_b64_tr_b16 a[154:155], v50 offset:5120
    ds_read_b64_tr_b16 a[156:157], v51 offset:4096
    ds_read_b64_tr_b16 a[158:159], v51 offset:5120
    s_waitcnt lgkmcnt(0)
    v_add_u32 v50, 0, v46
    v_add_u32 v51, 0, v47
    s_waitcnt vmcnt(20)
    s_barrier
    ds_read_b64_tr_b16 a[160:161], v50 offset:0
    ds_read_b64_tr_b16 a[162:163], v50 offset:1024
    ds_read_b64_tr_b16 a[164:165], v51 offset:0
    ds_read_b64_tr_b16 a[166:167], v51 offset:1024
    ds_read_b64_tr_b16 a[168:169], v50 offset:4096
    ds_read_b64_tr_b16 a[170:171], v50 offset:5120
    ds_read_b64_tr_b16 a[172:173], v51 offset:4096
    ds_read_b64_tr_b16 a[174:175], v51 offset:5120
    s_waitcnt lgkmcnt(0)
    v_add_u32 v50, 16384, v46
    v_add_u32 v51, 16384, v47
    s_waitcnt vmcnt(16)
    s_barrier
    ds_read_b64_tr_b16 a[176:177], v50 offset:0
    ds_read_b64_tr_b16 a[178:179], v50 offset:1024
    ds_read_b64_tr_b16 a[180:181], v51 offset:0
    ds_read_b64_tr_b16 a[182:183], v51 offset:1024
    ds_read_b64_tr_b16 a[184:185], v50 offset:4096
    ds_read_b64_tr_b16 a[186:187], v50 offset:5120
    ds_read_b64_tr_b16 a[188:189], v51 offset:4096
    ds_read_b64_tr_b16 a[190:191], v51 offset:5120
    s_waitcnt lgkmcnt(0)
    v_add_u32 v50, 32768, v46
    v_add_u32 v51, 32768, v47
    s_waitcnt vmcnt(12)
    s_barrier
    ds_read_b64_tr_b16 a[192:193], v50 offset:0
    ds_read_b64_tr_b16 a[194:195], v50 offset:1024
    ds_read_b64_tr_b16 a[196:197], v51 offset:0
    ds_read_b64_tr_b16 a[198:199], v51 offset:1024
    ds_read_b64_tr_b16 a[200:201], v50 offset:4096
    ds_read_b64_tr_b16 a[202:203], v50 offset:5120
    ds_read_b64_tr_b16 a[204:205], v51 offset:4096
    ds_read_b64_tr_b16 a[206:207], v51 offset:5120
    s_waitcnt lgkmcnt(0)
    v_add_u32 v50, 49152, v46
    v_add_u32 v51, 49152, v47
    s_waitcnt vmcnt(8)
    s_barrier
    ds_read_b64_tr_b16 a[208:209], v50 offset:0
    ds_read_b64_tr_b16 a[210:211], v50 offset:1024
    ds_read_b64_tr_b16 a[212:213], v51 offset:0
    ds_read_b64_tr_b16 a[214:215], v51 offset:1024
    ds_read_b64_tr_b16 a[216:217], v50 offset:4096
    ds_read_b64_tr_b16 a[218:219], v50 offset:5120
    ds_read_b64_tr_b16 a[220:221], v51 offset:4096
    ds_read_b64_tr_b16 a[222:223], v51 offset:5120
    s_waitcnt lgkmcnt(0)
    v_add_u32 v50, 65536, v46
    v_add_u32 v51, 65536, v47
    s_waitcnt vmcnt(4)
    s_barrier
    ds_read_b64_tr_b16 a[224:225], v50 offset:0
    ds_read_b64_tr_b16 a[226:227], v50 offset:1024
    ds_read_b64_tr_b16 a[228:229], v51 offset:0
    ds_read_b64_tr_b16 a[230:231], v51 offset:1024
    ds_read_b64_tr_b16 a[232:233], v50 offset:4096
    ds_read_b64_tr_b16 a[234:235], v50 offset:5120
    ds_read_b64_tr_b16 a[236:237], v51 offset:4096
    ds_read_b64_tr_b16 a[238:239], v51 offset:5120
    s_waitcnt lgkmcnt(0)
    v_add_u32 v50, 81920, v46
    v_add_u32 v51, 81920, v47
    s_waitcnt vmcnt(0)
    s_barrier
    ds_read_b64_tr_b16 a[240:241], v50 offset:0
    ds_read_b64_tr_b16 a[242:243], v50 offset:1024
    ds_read_b64_tr_b16 a[244:245], v51 offset:0
    ds_read_b64_tr_b16 a[246:247], v51 offset:1024
    ds_read_b64_tr_b16 a[248:249], v50 offset:4096
    ds_read_b64_tr_b16 a[250:251], v50 offset:5120
    ds_read_b64_tr_b16 a[252:253], v51 offset:4096
    ds_read_b64_tr_b16 a[254:255], v51 offset:5120
    s_waitcnt lgkmcnt(0)
    s_mov_b32 s12, s84
    s_mov_b32 s13, s85
    s_mov_b32 s14, 0x6200000
    s_mov_b32 s15, 0x00020000
    s_barrier
    s_mov_b32 s20, s82
    s_mov_b32 s21, s83
    s_mov_b32 s22, 0x100
    s_mov_b32 s23, 0x00020000
    v_and_b32 v8, 15, v0
    v_lshlrev_b32 v8, 4, v8
    buffer_load_dword v9, v8, s[20:23], 0 offen sc1
    s_waitcnt vmcnt(0)
Lwo_wa:
    v_cmp_gt_u32 vcc, 8, v9
    s_sub_u32 s43, s43, 1
    s_cmp_lt_i32 s43, 0
    s_cbranch_scc1 Lwo_all
    s_cbranch_vccz Lwo_all
    s_sleep 2
    buffer_load_dword v9, v8, s[20:23], 0 offen sc1
    s_waitcnt vmcnt(0)
    s_branch Lwo_wa
Lwo_all:
    s_branch Lwo_spin1
    .p2align 6
Lwo_body0:
    s_waitcnt lgkmcnt(5)
    v_mfma_f32_16x16x32_bf16 v[8:11], a[0:3], v[40:43], 0
    ds_read_b128 v[64:67], v2 offset:6144
    s_add_u32 s31, s31, 1
    v_mfma_f32_16x16x32_bf16 v[12:15], a[4:7], v[40:43], 0
    s_waitcnt lgkmcnt(5)
    s_cmp_eq_u32 s10, 0
    s_cbranch_scc1 Lwo_slow0
    v_mfma_f32_16x16x32_bf16 v[8:11], a[8:11], v[44:47], v[8:11]
    ds_read_b128 v[68:71], v2 offset:7168
    v_mov_b32 v6, s31
    v_mfma_f32_16x16x32_bf16 v[12:15], a[12:15], v[44:47], v[12:15]
    s_waitcnt lgkmcnt(5)
    buffer_load_dwordx4 v[98:101], v1, s[8:11], s40 offen sc1
    v_mfma_f32_16x16x32_bf16 v[8:11], a[16:19], v[48:51], v[8:11]
    ds_read_b128 v[40:43], v2 offset:8192
    v_cvt_pk_bf16_f32 v72, v24, v25
    v_mfma_f32_16x16x32_bf16 v[12:15], a[20:23], v[48:51], v[12:15]
    s_waitcnt lgkmcnt(5)
    v_cvt_pk_bf16_f32 v73, v26, v27
    v_cvt_pk_bf16_f32 v74, v28, v29
    v_mfma_f32_16x16x32_bf16 v[8:11], a[24:27], v[52:55], v[8:11]
    ds_read_b128 v[44:47], v2 offset:9216
    v_cvt_pk_bf16_f32 v75, v30, v31
    v_mfma_f32_16x16x32_bf16 v[12:15], a[28:31], v[52:55], v[12:15]
    s_waitcnt lgkmcnt(5)
    buffer_store_dwordx4 v[72:75], v1, s[12:15], s36 offen sc1
    s_add_u32 s35, s35, 36864
    v_mfma_f32_16x16x32_bf16 v[80:83], v[72:75], v[72:75], 0
    s_cmp_eq_u32 s35, 147456
    s_cselect_b32 s35, 0, s35
    v_add_u32 v3, s35, v1
    v_mfma_f32_16x16x32_bf16 v[76:79], v[84:87], v[72:75], 0
    v_mfma_f32_16x16x32_bf16 v[8:11], a[32:35], v[56:59], v[8:11]
    ds_read_b128 v[48:51], v2 offset:10240
    v_mfma_f32_16x16x32_bf16 v[12:15], a[36:39], v[56:59], v[12:15]
    s_waitcnt lgkmcnt(5)
    v_cndmask_b32 v80, v80, v81, s[44:45]
    v_cndmask_b32 v82, v82, v83, s[44:45]
    v_mfma_f32_16x16x32_bf16 v[8:11], a[40:43], v[60:63], v[8:11]
    ds_read_b128 v[52:55], v2 offset:11264
    v_cndmask_b32 v77, v80, v82, s[46:47]
    v_mfma_f32_16x16x32_bf16 v[12:15], a[44:47], v[60:63], v[12:15]
    s_waitcnt lgkmcnt(5)
    buffer_store_dwordx2 v[76:77], v7, s[12:15], s36 offen offset:0 sc1
    s_add_u32 s36, s36, 36864
    v_mfma_f32_16x16x32_bf16 v[8:11], a[48:51], v[64:67], v[8:11]
    ds_read_b128 v[56:59], v2 offset:12288
    v_mfma_f32_16x16x32_bf16 v[12:15], a[52:55], v[64:67], v[12:15]
    s_waitcnt lgkmcnt(5)
    v_mfma_f32_16x16x32_bf16 v[8:11], a[56:59], v[68:71], v[8:11]
    ds_read_b128 v[60:63], v2 offset:13312
    v_mfma_f32_16x16x32_bf16 v[12:15], a[60:63], v[68:71], v[12:15]
    s_waitcnt lgkmcnt(5)
    v_mfma_f32_16x16x32_bf16 v[8:11], a[64:67], v[40:43], v[8:11]
    ds_read_b128 v[64:67], v2 offset:14336
    s_add_u32 s32, s32, 1
    v_mfma_f32_16x16x32_bf16 v[12:15], a[68:71], v[40:43], v[12:15]
    s_waitcnt lgkmcnt(5)
    s_add_u32 s33, s33, 32768
    s_add_u32 s34, s34, 36864
    v_mfma_f32_16x16x32_bf16 v[8:11], a[72:75], v[44:47], v[8:11]
    ds_read_b128 v[68:71], v2 offset:15360
    v_mfma_f32_16x16x32_bf16 v[12:15], a[76:79], v[44:47], v[12:15]
    s_waitcnt lgkmcnt(5)
    s_cmp_ge_u32 s34, 147456
    s_cselect_b32 s38, 147456, 0
    v_mfma_f32_16x16x32_bf16 v[8:11], a[80:83], v[48:51], v[8:11]
    ds_read_b128 v[40:43], v2 offset:16384
    s_sub_u32 s34, s34, s38
    v_mfma_f32_16x16x32_bf16 v[12:15], a[84:87], v[48:51], v[12:15]
    s_waitcnt lgkmcnt(5)
    s_add_u32 s40, s40, 34816
    v_mfma_f32_16x16x32_bf16 v[8:11], a[88:91], v[52:55], v[8:11]
    ds_read_b128 v[44:47], v2 offset:17408
    v_mfma_f32_16x16x32_bf16 v[12:15], a[92:95], v[52:55], v[12:15]
    s_waitcnt lgkmcnt(5)
    v_mfma_f32_16x16x32_bf16 v[8:11], a[96:99], v[56:59], v[8:11]
    ds_read_b128 v[48:51], v2 offset:18432
    s_waitcnt vmcnt(8)
    v_mfma_f32_16x16x32_bf16 v[12:15], a[100:103], v[56:59], v[12:15]
    s_waitcnt lgkmcnt(5)
    v_cmp_gt_i32 vcc, s32, v5
    v_mfma_f32_16x16x32_bf16 v[8:11], a[104:107], v[60:63], v[8:11]
    ds_read_b128 v[52:55], v2 offset:19456
    v_mfma_f32_16x16x32_bf16 v[12:15], a[108:111], v[60:63], v[12:15]
    s_waitcnt lgkmcnt(5)
    s_and_b64 vcc, vcc, s[18:19]
    s_cselect_b32 s10, 0, s6
    v_mfma_f32_16x16x32_bf16 v[8:11], a[112:115], v[64:67], v[8:11]
    ds_read_b128 v[56:59], v2 offset:20480
    s_add_u32 m0, s34, 0
    v_mfma_f32_16x16x32_bf16 v[12:15], a[116:119], v[64:67], v[12:15]
    s_waitcnt lgkmcnt(5)
    buffer_load_dwordx4 v1, s[8:11], s33 offen offset:0 sc1 lds
    v_mfma_f32_16x16x32_bf16 v[8:11], a[120:123], v[68:71], v[8:11]
    ds_read_b128 v[60:63], v2 offset:21504
    v_mfma_f32_16x16x32_bf16 v[12:15], a[124:127], v[68:71], v[12:15]
    s_waitcnt lgkmcnt(5)
    v_mfma_f32_16x16x32_bf16 v[8:11], a[128:131], v[40:43], v[8:11]
    ds_read_b128 v[64:67], v2 offset:22528
    v_mfma_f32_16x16x32_bf16 v[12:15], a[132:135], v[40:43], v[12:15]
    s_waitcnt lgkmcnt(5)
    buffer_load_dwordx4 v1, s[8:11], s33 offen offset:1024 sc1 lds
    v_mfma_f32_16x16x32_bf16 v[8:11], a[136:139], v[44:47], v[8:11]
    ds_read_b128 v[68:71], v2 offset:23552
    v_mfma_f32_16x16x32_bf16 v[12:15], a[140:143], v[44:47], v[12:15]
    s_waitcnt lgkmcnt(5)
    v_mfma_f32_16x16x32_bf16 v[8:11], a[144:147], v[48:51], v[8:11]
    ds_read_b128 v[40:43], v2 offset:24576
    v_mfma_f32_16x16x32_bf16 v[12:15], a[148:151], v[48:51], v[12:15]
    s_waitcnt lgkmcnt(5)
    buffer_load_dwordx4 v1, s[8:11], s33 offen offset:2048 sc1 lds
    v_mfma_f32_16x16x32_bf16 v[8:11], a[152:155], v[52:55], v[8:11]
    ds_read_b128 v[44:47], v2 offset:25600
    s_add_u32 s16, s16, 8192
    v_mfma_f32_16x16x32_bf16 v[12:15], a[156:159], v[52:55], v[12:15]
    s_waitcnt lgkmcnt(5)
    v_mfma_f32_16x16x32_bf16 v[8:11], a[160:163], v[56:59], v[8:11]
    ds_read_b128 v[48:51], v2 offset:26624
    v_mfma_f32_16x16x32_bf16 v[12:15], a[164:167], v[56:59], v[12:15]
    s_waitcnt lgkmcnt(5)
    buffer_load_dword v5, v4, s[4:7], s16 offen sc1
    v_mfma_f32_16x16x32_bf16 v[8:11], a[168:171], v[60:63], v[8:11]
    ds_read_b128 v[52:55], v2 offset:27648
    v_mfma_f32_16x16x32_bf16 v[12:15], a[172:175], v[60:63], v[12:15]
    s_waitcnt lgkmcnt(5)
    v_mfma_f32_16x16x32_bf16 v[8:11], a[176:179], v[64:67], v[8:11]
    ds_read_b128 v[56:59], v2 offset:28672
    v_mfma_f32_16x16x32_bf16 v[12:15], a[180:183], v[64:67], v[12:15]
    s_waitcnt lgkmcnt(5)
    buffer_load_dwordx4 v1, s[8:11], s33 offen offset:3072 sc1 lds
    v_mfma_f32_16x16x32_bf16 v[8:11], a[184:187], v[68:71], v[8:11]
    ds_read_b128 v[60:63], v2 offset:29696
    s_add_u32 m0, s34, 4096
    v_mfma_f32_16x16x32_bf16 v[12:15], a[188:191], v[68:71], v[12:15]
    s_waitcnt lgkmcnt(5)
    s_add_u32 s37, s33, 4096
    v_mfma_f32_16x16x32_bf16 v[8:11], a[192:195], v[40:43], v[8:11]
    ds_read_b128 v[64:67], v2 offset:30720
    v_mfma_f32_16x16x32_bf16 v[12:15], a[196:199], v[40:43], v[12:15]
    s_waitcnt lgkmcnt(5)
    buffer_load_dwordx4 v1, s[8:11], s37 offen offset:0 sc1 lds
    v_mfma_f32_16x16x32_bf16 v[8:11], a[200:203], v[44:47], v[8:11]
    ds_read_b128 v[68:71], v2 offset:31744
    s_waitcnt vmcnt(9)
    v_mfma_f32_16x16x32_bf16 v[12:15], a[204:207], v[44:47], v[12:15]
    s_waitcnt lgkmcnt(5)
    s_barrier
    v_mfma_f32_16x16x32_bf16 v[8:11], a[208:211], v[48:51], v[8:11]
    s_waitcnt vmcnt(6)
    buffer_store_dword v6, v102, s[12:15], s17 offen sc1
    v_mfma_f32_16x16x32_bf16 v[12:15], a[212:215], v[48:51], v[12:15]
    s_waitcnt lgkmcnt(4)
    buffer_load_dwordx4 v1, s[8:11], s37 offen offset:1024 sc1 lds
    v_mfma_f32_16x16x32_bf16 v[8:11], a[216:219], v[52:55], v[8:11]
    ds_read_b128 v[40:43], v3 offset:0
    s_mov_b32 s14, s6
    v_mfma_f32_16x16x32_bf16 v[12:15], a[220:223], v[52:55], v[12:15]
    s_waitcnt lgkmcnt(4)
    s_add_u32 s17, s17, 8192
    v_mfma_f32_16x16x32_bf16 v[8:11], a[224:227], v[56:59], v[8:11]
    ds_read_b128 v[44:47], v3 offset:1024
    v_mfma_f32_16x16x32_bf16 v[12:15], a[228:231], v[56:59], v[12:15]
    s_waitcnt lgkmcnt(4)
    buffer_load_dwordx4 v1, s[8:11], s37 offen offset:2048 sc1 lds
    v_mfma_f32_16x16x32_bf16 v[8:11], a[232:235], v[60:63], v[8:11]
    ds_read_b128 v[48:51], v3 offset:2048
    v_mfma_f32_16x16x32_bf16 v[12:15], a[236:239], v[60:63], v[12:15]
    s_waitcnt lgkmcnt(4)
    v_mfma_f32_16x16x32_bf16 v[8:11], a[240:243], v[64:67], v[8:11]
    ds_read_b128 v[52:55], v3 offset:3072
    v_mfma_f32_16x16x32_bf16 v[12:15], a[244:247], v[64:67], v[12:15]
    s_waitcnt lgkmcnt(4)
    buffer_load_dwordx4 v1, s[8:11], s37 offen offset:3072 sc1 lds
    v_mfma_f32_16x16x32_bf16 v[8:11], a[248:251], v[68:71], v[8:11]
    ds_read_b128 v[56:59], v3 offset:4096
    v_mfma_f32_16x16x32_bf16 v[12:15], a[252:255], v[68:71], v[12:15]
    v_mfma_f32_16x16x32_bf16 v[8:11], v[90:93], v[94:97], v[8:11]
    ds_read_b128 v[60:63], v3 offset:5120
    v_mfma_f32_16x16x32_bf16 v[12:15], v[88:91], v[94:97], v[12:15]
Lwo_body1:
    s_waitcnt lgkmcnt(5)
    v_mfma_f32_16x16x32_bf16 v[24:27], a[0:3], v[40:43], 0
    ds_read_b128 v[64:67], v3 offset:6144
    s_add_u32 s31, s31, 1
    v_mfma_f32_16x16x32_bf16 v[28:31], a[4:7], v[40:43], 0
    s_waitcnt lgkmcnt(5)
    s_cmp_eq_u32 s10, 0
    s_cbranch_scc1 Lwo_slow1
    v_mfma_f32_16x16x32_bf16 v[24:27], a[8:11], v[44:47], v[24:27]
    ds_read_b128 v[68:71], v3 offset:7168
    v_mov_b32 v6, s31
    v_mfma_f32_16x16x32_bf16 v[28:31], a[12:15], v[44:47], v[28:31]
    s_waitcnt lgkmcnt(5)
    buffer_load_dwordx4 v[94:97], v1, s[8:11], s40 offen sc1
    v_mfma_f32_16x16x32_bf16 v[24:27], a[16:19], v[48:51], v[24:27]
    ds_read_b128 v[40:43], v3 offset:8192
    v_cvt_pk_bf16_f32 v72, v8, v9
    v_mfma_f32_16x16x32_bf16 v[28:31], a[20:23], v[48:51], v[28:31]
    s_waitcnt lgkmcnt(5)
    v_cvt_pk_bf16_f32 v73, v10, v11
    v_cvt_pk_bf16_f32 v74, v12, v13
    v_mfma_f32_16x16x32_bf16 v[24:27], a[24:27], v[52:55], v[24:27]
    ds_read_b128 v[44:47], v3 offset:9216
    v_cvt_pk_bf16_f32 v75, v14, v15
    v_mfma_f32_16x16x32_bf16 v[28:31], a[28:31], v[52:55], v[28:31]
    s_waitcnt lgkmcnt(5)
    buffer_store_dwordx4 v[72:75], v1, s[12:15], s36 offen sc1
    s_add_u32 s35, s35, 36864
    v_mfma_f32_16x16x32_bf16 v[80:83], v[72:75], v[72:75], 0
    s_cmp_eq_u32 s35, 147456
    s_cselect_b32 s35, 0, s35
    v_add_u32 v2, s35, v1
    v_mfma_f32_16x16x32_bf16 v[76:79], v[84:87], v[72:75], 0
    v_mfma_f32_16x16x32_bf16 v[24:27], a[32:35], v[56:59], v[24:27]
    ds_read_b128 v[48:51], v3 offset:10240
    v_mfma_f32_16x16x32_bf16 v[28:31], a[36:39], v[56:59], v[28:31]
    s_waitcnt lgkmcnt(5)
    v_cndmask_b32 v80, v80, v81, s[44:45]
    v_cndmask_b32 v82, v82, v83, s[44:45]
    v_mfma_f32_16x16x32_bf16 v[24:27], a[40:43], v[60:63], v[24:27]
    ds_read_b128 v[52:55], v3 offset:11264
    v_cndmask_b32 v77, v80, v82, s[46:47]
    v_mfma_f32_16x16x32_bf16 v[28:31], a[44:47], v[60:63], v[28:31]
    s_waitcnt lgkmcnt(5)
    buffer_store_dwordx2 v[76:77], v7, s[12:15], s36 offen offset:0 sc1
    s_add_u32 s36, s36, 36864
    v_mfma_f32_16x16x32_bf16 v[24:27], a[48:51], v[64:67], v[24:27]
    ds_read_b128 v[56:59], v3 offset:12288
    v_mfma_f32_16x16x32_bf16 v[28:31], a[52:55], v[64:67], v[28:31]
    s_waitcnt lgkmcnt(5)
    v_mfma_f32_16x16x32_bf16 v[24:27], a[56:59], v[68:71], v[24:27]
    ds_read_b128 v[60:63], v3 offset:13312
    v_mfma_f32_16x16x32_bf16 v[28:31], a[60:63], v[68:71], v[28:31]
    s_waitcnt lgkmcnt(5)
    v_mfma_f32_16x16x32_bf16 v[24:27], a[64:67], v[40:43], v[24:27]
    ds_read_b128 v[64:67], v3 offset:14336
    s_add_u32 s32, s32, 1
    v_mfma_f32_16x16x32_bf16 v[28:31], a[68:71], v[40:43], v[28:31]
    s_waitcnt lgkmcnt(5)
    s_add_u32 s33, s33, 32768
    s_add_u32 s34, s34, 36864
    v_mfma_f32_16x16x32_bf16 v[24:27], a[72:75], v[44:47], v[24:27]
    ds_read_b128 v[68:71], v3 offset:15360
    v_mfma_f32_16x16x32_bf16 v[28:31], a[76:79], v[44:47], v[28:31]
    s_waitcnt lgkmcnt(5)
    s_cmp_ge_u32 s34, 147456
    s_cselect_b32 s38, 147456, 0
    v_mfma_f32_16x16x32_bf16 v[24:27], a[80:83], v[48:51], v[24:27]
    ds_read_b128 v[40:43], v3 offset:16384
    s_sub_u32 s34, s34, s38
    v_mfma_f32_16x16x32_bf16 v[28:31], a[84:87], v[48:51], v[28:31]
    s_waitcnt lgkmcnt(5)
    s_add_u32 s40, s40, 34816
    v_mfma_f32_16x16x32_bf16 v[24:27], a[88:91], v[52:55], v[24:27]
    ds_read_b128 v[44:47], v3 offset:17408
    v_mfma_f32_16x16x32_bf16 v[28:31], a[92:95], v[52:55], v[28:31]
    s_waitcnt lgkmcnt(5)
    v_mfma_f32_16x16x32_bf16 v[24:27], a[96:99], v[56:59], v[24:27]
    ds_read_b128 v[48:51], v3 offset:18432
    s_waitcnt vmcnt(8)
    v_mfma_f32_16x16x32_bf16 v[28:31], a[100:103], v[56:59], v[28:31]
    s_waitcnt lgkmcnt(5)
    v_cmp_gt_i32 vcc, s32, v5
    v_mfma_f32_16x16x32_bf16 v[24:27], a[104:107], v[60:63], v[24:27]
    ds_read_b128 v[52:55], v3 offset:19456
    v_mfma_f32_16x16x32_bf16 v[28:31], a[108:111], v[60:63], v[28:31]
    s_waitcnt lgkmcnt(5)
    s_and_b64 vcc, vcc, s[18:19]
    s_cselect_b32 s10, 0, s6
    v_mfma_f32_16x16x32_bf16 v[24:27], a[112:115], v[64:67], v[24:27]
    ds_read_b128 v[56:59], v3 offset:20480
    s_add_u32 m0, s34, 0
    v_mfma_f32_16x16x32_bf16 v[28:31], a[116:119], v[64:67], v[28:31]
    s_waitcnt lgkmcnt(5)
    buffer_load_dwordx4 v1, s[8:11], s33 offen offset:0 sc1 lds
    v_mfma_f32_16x16x32_bf16 v[24:27], a[120:123], v[68:71], v[24:27]
    ds_read_b128 v[60:63], v3 offset:21504
    v_mfma_f32_16x16x32_bf16 v[28:31], a[124:127], v[68:71], v[28:31]
    s_waitcnt lgkmcnt(5)
    v_mfma_f32_16x16x32_bf16 v[24:27], a[128:131], v[40:43], v[24:27]
    ds_read_b128 v[64:67], v3 offset:22528
    v_mfma_f32_16x16x32_bf16 v[28:31], a[132:135], v[40:43], v[28:31]
    s_waitcnt lgkmcnt(5)
    buffer_load_dwordx4 v1, s[8:11], s33 offen offset:1024 sc1 lds
    v_mfma_f32_16x16x32_bf16 v[24:27], a[136:139], v[44:47], v[24:27]
    ds_read_b128 v[68:71], v3 offset:23552
    v_mfma_f32_16x16x32_bf16 v[28:31], a[140:143], v[44:47], v[28:31]
    s_waitcnt lgkmcnt(5)
    v_mfma_f32_16x16x32_bf16 v[24:27], a[144:147], v[48:51], v[24:27]
    ds_read_b128 v[40:43], v3 offset:24576
    v_mfma_f32_16x16x32_bf16 v[28:31], a[148:151], v[48:51], v[28:31]
    s_waitcnt lgkmcnt(5)
    buffer_load_dwordx4 v1, s[8:11], s33 offen offset:2048 sc1 lds
    v_mfma_f32_16x16x32_bf16 v[24:27], a[152:155], v[52:55], v[24:27]
    ds_read_b128 v[44:47], v3 offset:25600
    s_add_u32 s16, s16, 8192
    v_mfma_f32_16x16x32_bf16 v[28:31], a[156:159], v[52:55], v[28:31]
    s_waitcnt lgkmcnt(5)
    v_mfma_f32_16x16x32_bf16 v[24:27], a[160:163], v[56:59], v[24:27]
    ds_read_b128 v[48:51], v3 offset:26624
    v_mfma_f32_16x16x32_bf16 v[28:31], a[164:167], v[56:59], v[28:31]
    s_waitcnt lgkmcnt(5)
    buffer_load_dword v5, v4, s[4:7], s16 offen sc1
    v_mfma_f32_16x16x32_bf16 v[24:27], a[168:171], v[60:63], v[24:27]
    ds_read_b128 v[52:55], v3 offset:27648
    v_mfma_f32_16x16x32_bf16 v[28:31], a[172:175], v[60:63], v[28:31]
    s_waitcnt lgkmcnt(5)
    v_mfma_f32_16x16x32_bf16 v[24:27], a[176:179], v[64:67], v[24:27]
    ds_read_b128 v[56:59], v3 offset:28672
    v_mfma_f32_16x16x32_bf16 v[28:31], a[180:183], v[64:67], v[28:31]
    s_waitcnt lgkmcnt(5)
    buffer_load_dwordx4 v1, s[8:11], s33 offen offset:3072 sc1 lds
    v_mfma_f32_16x16x32_bf16 v[24:27], a[184:187], v[68:71], v[24:27]
    ds_read_b128 v[60:63], v3 offset:29696
    s_add_u32 m0, s34, 4096
    v_mfma_f32_16x16x32_bf16 v[28:31], a[188:191], v[68:71], v[28:31]
    s_waitcnt lgkmcnt(5)
    s_add_u32 s37, s33, 4096
    v_mfma_f32_16x16x32_bf16 v[24:27], a[192:195], v[40:43], v[24:27]
    ds_read_b128 v[64:67], v3 offset:30720
    v_mfma_f32_16x16x32_bf16 v[28:31], a[196:199], v[40:43], v[28:31]
    s_waitcnt lgkmcnt(5)
    buffer_load_dwordx4 v1, s[8:11], s37 offen offset:0 sc1 lds
    v_mfma_f32_16x16x32_bf16 v[24:27], a[200:203], v[44:47], v[24:27]
    ds_read_b128 v[68:71], v3 offset:31744
    s_waitcnt vmcnt(9)
    v_mfma_f32_16x16x32_bf16 v[28:31], a[204:207], v[44:47], v[28:31]
    s_waitcnt lgkmcnt(5)
    s_barrier
    v_mfma_f32_16x16x32_bf16 v[24:27], a[208:211], v[48:51], v[24:27]
    s_waitcnt vmcnt(6)
    buffer_store_dword v6, v102, s[12:15], s17 offen sc1
    v_mfma_f32_16x16x32_bf16 v[28:31], a[212:215], v[48:51], v[28:31]
    s_waitcnt lgkmcnt(4)
    buffer_load_dwordx4 v1, s[8:11], s37 offen offset:1024 sc1 lds
    v_mfma_f32_16x16x32_bf16 v[24:27], a[216:219], v[52:55], v[24:27]
    ds_read_b128 v[40:43], v2 offset:0
    s_mov_b32 s14, s6
    v_mfma_f32_16x16x32_bf16 v[28:31], a[220:223], v[52:55], v[28:31]
    s_waitcnt lgkmcnt(4)
    s_add_u32 s17, s17, 8192
    v_mfma_f32_16x16x32_bf16 v[24:27], a[224:227], v[56:59], v[24:27]
    ds_read_b128 v[44:47], v2 offset:1024
    v_mfma_f32_16x16x32_bf16 v[28:31], a[228:231], v[56:59], v[28:31]
    s_waitcnt lgkmcnt(4)
    buffer_load_dwordx4 v1, s[8:11], s37 offen offset:2048 sc1 lds
    v_mfma_f32_16x16x32_bf16 v[24:27], a[232:235], v[60:63], v[24:27]
    ds_read_b128 v[48:51], v2 offset:2048
    v_mfma_f32_16x16x32_bf16 v[28:31], a[236:239], v[60:63], v[28:31]
    s_waitcnt lgkmcnt(4)
    v_mfma_f32_16x16x32_bf16 v[24:27], a[240:243], v[64:67], v[24:27]
    ds_read_b128 v[52:55], v2 offset:3072
    v_mfma_f32_16x16x32_bf16 v[28:31], a[244:247], v[64:67], v[28:31]
    s_waitcnt lgkmcnt(4)
    buffer_load_dwordx4 v1, s[8:11], s37 offen offset:3072 sc1 lds
    v_mfma_f32_16x16x32_bf16 v[24:27], a[248:251], v[68:71], v[24:27]
    ds_read_b128 v[56:59], v2 offset:4096
    v_mfma_f32_16x16x32_bf16 v[28:31], a[252:255], v[68:71], v[28:31]
    v_mfma_f32_16x16x32_bf16 v[24:27], v[90:93], v[98:101], v[24:27]
    ds_read_b128 v[60:63], v2 offset:5120
    v_mfma_f32_16x16x32_bf16 v[28:31], v[88:91], v[98:101], v[28:31]
Lwo_back:
    s_cmp_lt_i32 s31, 63
    s_cbranch_scc1 Lwo_body0
    s_branch L_exit
Lwo_slow0:
    s_sub_u32 s39, s16, 8192
    v_mfma_f32_16x16x32_bf16 v[8:11], a[8:11], v[44:47], v[8:11]
    ds_read_b128 v[68:71], v2 offset:7168
    v_mov_b32 v6, s31
    v_mfma_f32_16x16x32_bf16 v[12:15], a[12:15], v[44:47], v[12:15]
    s_waitcnt lgkmcnt(5)
    buffer_load_dword v103, v4, s[4:7], s39 offen sc1
    v_mfma_f32_16x16x32_bf16 v[8:11], a[16:19], v[48:51], v[8:11]
    ds_read_b128 v[40:43], v2 offset:8192
    v_cvt_pk_bf16_f32 v72, v24, v25
    v_mfma_f32_16x16x32_bf16 v[12:15], a[20:23], v[48:51], v[12:15]
    s_waitcnt lgkmcnt(5)
    v_cvt_pk_bf16_f32 v73, v26, v27
    v_cvt_pk_bf16_f32 v74, v28, v29
    v_mfma_f32_16x16x32_bf16 v[8:11], a[24:27], v[52:55], v[8:11]
    ds_read_b128 v[44:47], v2 offset:9216
    v_cvt_pk_bf16_f32 v75, v30, v31
    v_mfma_f32_16x16x32_bf16 v[12:15], a[28:31], v[52:55], v[12:15]
    s_waitcnt lgkmcnt(5)
    buffer_store_dwordx4 v[72:75], v1, s[12:15], s36 offen sc1
    s_add_u32 s35, s35, 36864
    v_mfma_f32_16x16x32_bf16 v[80:83], v[72:75], v[72:75], 0
    s_cmp_eq_u32 s35, 147456
    s_cselect_b32 s35, 0, s35
    v_add_u32 v3, s35, v1
    v_mfma_f32_16x16x32_bf16 v[76:79], v[84:87], v[72:75], 0
    v_mfma_f32_16x16x32_bf16 v[8:11], a[32:35], v[56:59], v[8:11]
    ds_read_b128 v[48:51], v2 offset:10240
    v_mfma_f32_16x16x32_bf16 v[12:15], a[36:39], v[56:59], v[12:15]
    s_waitcnt lgkmcnt(5)
    v_cndmask_b32 v80, v80, v81, s[44:45]
    v_cndmask_b32 v82, v82, v83, s[44:45]
    v_mfma_f32_16x16x32_bf16 v[8:11], a[40:43], v[60:63], v[8:11]
    ds_read_b128 v[52:55], v2 offset:11264
    v_cndmask_b32 v77, v80, v82, s[46:47]
    v_mfma_f32_16x16x32_bf16 v[12:15], a[44:47], v[60:63], v[12:15]
    s_waitcnt lgkmcnt(5)
    buffer_store_dwordx2 v[76:77], v7, s[12:15], s36 offen offset:0 sc1
    s_add_u32 s36, s36, 36864
    v_mfma_f32_16x16x32_bf16 v[8:11], a[48:51], v[64:67], v[8:11]
    ds_read_b128 v[56:59], v2 offset:12288
    v_mfma_f32_16x16x32_bf16 v[12:15], a[52:55], v[64:67], v[12:15]
    s_waitcnt lgkmcnt(5)
    v_mfma_f32_16x16x32_bf16 v[8:11], a[56:59], v[68:71], v[8:11]
    ds_read_b128 v[60:63], v2 offset:13312
    v_mfma_f32_16x16x32_bf16 v[12:15], a[60:63], v[68:71], v[12:15]
    s_waitcnt lgkmcnt(5)
    v_mfma_f32_16x16x32_bf16 v[8:11], a[64:67], v[40:43], v[8:11]
    ds_read_b128 v[64:67], v2 offset:14336
    v_mfma_f32_16x16x32_bf16 v[12:15], a[68:71], v[40:43], v[12:15]
    s_waitcnt lgkmcnt(5)
    v_mfma_f32_16x16x32_bf16 v[8:11], a[72:75], v[44:47], v[8:11]
    ds_read_b128 v[68:71], v2 offset:15360
    v_mfma_f32_16x16x32_bf16 v[12:15], a[76:79], v[44:47], v[12:15]
    s_waitcnt lgkmcnt(5)
    v_mfma_f32_16x16x32_bf16 v[8:11], a[80:83], v[48:51], v[8:11]
    ds_read_b128 v[40:43], v2 offset:16384
    v_mfma_f32_16x16x32_bf16 v[12:15], a[84:87], v[48:51], v[12:15]
    s_waitcnt lgkmcnt(5)
    v_mfma_f32_16x16x32_bf16 v[8:11], a[88:91], v[52:55], v[8:11]
    ds_read_b128 v[44:47], v2 offset:17408
    v_mfma_f32_16x16x32_bf16 v[12:15], a[92:95], v[52:55], v[12:15]
    s_waitcnt lgkmcnt(5)
    v_mfma_f32_16x16x32_bf16 v[8:11], a[96:99], v[56:59], v[8:11]
    ds_read_b128 v[48:51], v2 offset:18432
    v_mfma_f32_16x16x32_bf16 v[12:15], a[100:103], v[56:59], v[12:15]
    s_waitcnt lgkmcnt(5)
    v_mfma_f32_16x16x32_bf16 v[8:11], a[104:107], v[60:63], v[8:11]
    ds_read_b128 v[52:55], v2 offset:19456
    v_mfma_f32_16x16x32_bf16 v[12:15], a[108:111], v[60:63], v[12:15]
    s_waitcnt lgkmcnt(5)
    v_mfma_f32_16x16x32_bf16 v[8:11], a[112:115], v[64:67], v[8:11]
    ds_read_b128 v[56:59], v2 offset:20480
    v_mfma_f32_16x16x32_bf16 v[12:15], a[116:119], v[64:67], v[12:15]
    s_waitcnt lgkmcnt(5)
    v_mfma_f32_16x16x32_bf16 v[8:11], a[120:123], v[68:71], v[8:11]
    ds_read_b128 v[60:63], v2 offset:21504
    v_mfma_f32_16x16x32_bf16 v[12:15], a[124:127], v[68:71], v[12:15]
    s_waitcnt lgkmcnt(5)
    s_waitcnt vmcnt(2)
    v_cmp_gt_i32 vcc, s32, v103
    v_mfma_f32_16x16x32_bf16 v[8:11], a[128:131], v[40:43], v[8:11]
    ds_read_b128 v[64:67], v2 offset:22528
    v_mfma_f32_16x16x32_bf16 v[12:15], a[132:135], v[40:43], v[12:15]
    s_waitcnt lgkmcnt(5)
    s_and_b64 vcc, vcc, s[18:19]
    s_cselect_b32 s10, 0, s6
    v_mfma_f32_16x16x32_bf16 v[8:11], a[136:139], v[44:47], v[8:11]
    ds_read_b128 v[68:71], v2 offset:23552
    s_add_u32 m0, s34, 0
    v_mfma_f32_16x16x32_bf16 v[12:15], a[140:143], v[44:47], v[12:15]
    s_waitcnt lgkmcnt(5)
    buffer_load_dwordx4 v1, s[8:11], s33 offen offset:0 sc1 lds
    v_mfma_f32_16x16x32_bf16 v[8:11], a[144:147], v[48:51], v[8:11]
    ds_read_b128 v[40:43], v2 offset:24576
    v_mfma_f32_16x16x32_bf16 v[12:15], a[148:151], v[48:51], v[12:15]
    s_waitcnt lgkmcnt(5)
    v_mfma_f32_16x16x32_bf16 v[8:11], a[152:155], v[52:55], v[8:11]
    ds_read_b128 v[44:47], v2 offset:25600
    v_mfma_f32_16x16x32_bf16 v[12:15], a[156:159], v[52:55], v[12:15]
    s_waitcnt lgkmcnt(5)
    buffer_load_dwordx4 v1, s[8:11], s33 offen offset:1024 sc1 lds
    v_mfma_f32_16x16x32_bf16 v[8:11], a[160:163], v[56:59], v[8:11]
    ds_read_b128 v[48:51], v2 offset:26624
    v_mfma_f32_16x16x32_bf16 v[12:15], a[164:167], v[56:59], v[12:15]
    s_waitcnt lgkmcnt(5)
    v_mfma_f32_16x16x32_bf16 v[8:11], a[168:171], v[60:63], v[8:11]
    ds_read_b128 v[52:55], v2 offset:27648
    v_mfma_f32_16x16x32_bf16 v[12:15], a[172:175], v[60:63], v[12:15]
    s_waitcnt lgkmcnt(5)
    buffer_load_dword v5, v4, s[4:7], s16 offen sc1
    v_mfma_f32_16x16x32_bf16 v[8:11], a[176:179], v[64:67], v[8:11]
    ds_read_b128 v[56:59], v2 offset:28672
    v_mfma_f32_16x16x32_bf16 v[12:15], a[180:183], v[64:67], v[12:15]
    s_waitcnt lgkmcnt(5)
    v_mfma_f32_16x16x32_bf16 v[8:11], a[184:187], v[68:71], v[8:11]
    ds_read_b128 v[60:63], v2 offset:29696
    v_mfma_f32_16x16x32_bf16 v[12:15], a[188:191], v[68:71], v[12:15]
    s_waitcnt lgkmcnt(5)
    buffer_load_dwordx4 v1, s[8:11], s33 offen offset:2048 sc1 lds
    v_mfma_f32_16x16x32_bf16 v[8:11], a[192:195], v[40:43], v[8:11]
    ds_read_b128 v[64:67], v2 offset:30720
    v_mfma_f32_16x16x32_bf16 v[12:15], a[196:199], v[40:43], v[12:15]
    s_waitcnt lgkmcnt(5)
    v_mfma_f32_16x16x32_bf16 v[8:11], a[200:203], v[44:47], v[8:11]
    ds_read_b128 v[68:71], v2 offset:31744
    s_waitcnt vmcnt(4)
    v_mfma_f32_16x16x32_bf16 v[12:15], a[204:207], v[44:47], v[12:15]
    s_waitcnt lgkmcnt(5)
    buffer_load_dwordx4 v1, s[8:11], s33 offen offset:3072 sc1 lds
    v_mfma_f32_16x16x32_bf16 v[8:11], a[208:211], v[48:51], v[8:11]
    s_add_u32 m0, s34, 4096
    s_add_u32 s37, s33, 4096
    v_mfma_f32_16x16x32_bf16 v[12:15], a[212:215], v[48:51], v[12:15]
    s_waitcnt lgkmcnt(4)
    buffer_store_dword v6, v102, s[12:15], s17 offen sc1
    v_mfma_f32_16x16x32_bf16 v[8:11], a[216:219], v[52:55], v[8:11]
    s_mov_b32 s14, s6
    s_add_u32 s17, s17, 8192
    v_mfma_f32_16x16x32_bf16 v[12:15], a[220:223], v[52:55], v[12:15]
    s_waitcnt lgkmcnt(3)
    buffer_load_dwordx4 v1, s[8:11], s37 offen offset:0 sc1 lds
    v_mfma_f32_16x16x32_bf16 v[8:11], a[224:227], v[56:59], v[8:11]
    v_mfma_f32_16x16x32_bf16 v[12:15], a[228:231], v[56:59], v[12:15]
    s_waitcnt lgkmcnt(2)
    v_mfma_f32_16x16x32_bf16 v[8:11], a[232:235], v[60:63], v[8:11]
    v_mfma_f32_16x16x32_bf16 v[12:15], a[236:239], v[60:63], v[12:15]
    s_waitcnt lgkmcnt(1)
    buffer_load_dwordx4 v1, s[8:11], s37 offen offset:1024 sc1 lds
    v_mfma_f32_16x16x32_bf16 v[8:11], a[240:243], v[64:67], v[8:11]
    v_mfma_f32_16x16x32_bf16 v[12:15], a[244:247], v[64:67], v[12:15]
    s_waitcnt lgkmcnt(0)
    v_mfma_f32_16x16x32_bf16 v[8:11], a[248:251], v[68:71], v[8:11]
    v_mfma_f32_16x16x32_bf16 v[12:15], a[252:255], v[68:71], v[12:15]
    buffer_load_dwordx4 v1, s[8:11], s37 offen offset:2048 sc1 lds
    v_mfma_f32_16x16x32_bf16 v[8:11], v[90:93], v[94:97], v[8:11]
    v_mfma_f32_16x16x32_bf16 v[12:15], v[88:91], v[94:97], v[12:15]
    buffer_load_dwordx4 v1, s[8:11], s37 offen offset:3072 sc1 lds
    buffer_load_dwordx4 v[98:101], v1, s[8:11], s40 offen sc1
    s_nop 4
    v_cvt_pk_bf16_f32 v72, v8, v9
    v_cvt_pk_bf16_f32 v73, v10, v11
    v_cvt_pk_bf16_f32 v74, v12, v13
    v_cvt_pk_bf16_f32 v75, v14, v15
    buffer_store_dwordx4 v[72:75], v1, s[12:15], s36 offen sc1
    s_nop 0
    v_mfma_f32_16x16x32_bf16 v[80:83], v[72:75], v[72:75], 0
    v_mfma_f32_16x16x32_bf16 v[76:79], v[84:87], v[72:75], 0
    s_nop 6
    v_cndmask_b32 v80, v80, v81, s[44:45]
    v_cndmask_b32 v82, v82, v83, s[44:45]
    v_cndmask_b32 v77, v80, v82, s[46:47]
    buffer_store_dwordx2 v[76:77], v7, s[12:15], s36 offen offset:0 sc1
    s_add_u32 s54, s31, 1
    v_mov_b32 v6, s54
    s_cmp_ge_i32 s31, 63
    s_cbranch_scc1 Lwo_late0
    s_cmp_eq_u32 s10, 0
    s_cbranch_scc1 Lwo_late0
    s_add_u32 s32, s32, 1
    s_add_u32 s33, s33, 32768
    s_add_u32 s34, s34, 36864
    s_cmp_ge_u32 s34, 147456
    s_cselect_b32 s38, 147456, 0
    s_sub_u32 s34, s34, s38
    s_add_u32 s40, s40, 34816
    s_waitcnt vmcnt(10)
    v_cmp_gt_i32 vcc, s32, v5
    s_nop 0
    s_and_b64 vcc, vcc, s[18:19]
    s_cselect_b32 s10, 0, s6
    s_add_u32 m0, s34, 0
    s_nop 0
    buffer_load_dwordx4 v1, s[8:11], s33 offen offset:0 sc1 lds
    buffer_load_dwordx4 v1, s[8:11], s33 offen offset:1024 sc1 lds
    buffer_load_dwordx4 v1, s[8:11], s33 offen offset:2048 sc1 lds
    s_add_u32 s16, s16, 8192
    buffer_load_dword v5, v4, s[4:7], s16 offen sc1
    buffer_load_dwordx4 v1, s[8:11], s33 offen offset:3072 sc1 lds
    s_add_u32 m0, s34, 4096
    s_add_u32 s37, s33, 4096
    buffer_load_dwordx4 v1, s[8:11], s37 offen offset:0 sc1 lds
    buffer_load_dwordx4 v1, s[8:11], s37 offen offset:1024 sc1 lds
    buffer_load_dwordx4 v1, s[8:11], s37 offen offset:2048 sc1 lds
    buffer_load_dwordx4 v1, s[8:11], s37 offen offset:3072 sc1 lds
    s_waitcnt vmcnt(9)
    buffer_store_dword v6, v102, s[12:15], s17 offen sc1
    s_branch Lwo_go0
Lwo_late0:
    s_mov_b32 s16, s39
    buffer_load_dword v5, v4, s[4:7], s16 offen sc1
    s_waitcnt vmcnt(1)
    buffer_store_dword v6, v102, s[12:15], s17 offen sc1
    s_cmp_ge_i32 s31, 63
    s_cbranch_scc1 L_exit
    s_waitcnt vmcnt(1)
    v_cmp_gt_i32 vcc, s32, v5
    s_sub_u32 s43, s43, 1
    s_cmp_lt_i32 s43, 0
    s_cbranch_scc1 Lwo_rdy0
    s_and_b64 vcc, vcc, s[18:19]
    s_cbranch_scc0 Lwo_rdy0
Lwo_spin0:
    buffer_load_dword v5, v4, s[4:7], s16 offen sc1
    s_waitcnt vmcnt(0)
    v_cmp_gt_i32 vcc, s32, v5
    s_sub_u32 s43, s43, 1
    s_cmp_lt_i32 s43, 0
    s_cbranch_scc1 Lwo_rdy0
    s_and_b64 vcc, vcc, s[18:19]
    s_cbranch_scc0 Lwo_rdy0
    s_sleep 8
    s_branch Lwo_spin0
Lwo_rdy0:
    s_add_u32 s16, s16, 8192
    buffer_load_dword v5, v4, s[4:7], s16 offen sc1
    s_mov_b32 s10, s6
    s_add_u32 m0, s34, 0
    s_nop 0
    buffer_load_dwordx4 v1, s[8:11], s33 offen offset:0 sc1 lds
    buffer_load_dwordx4 v1, s[8:11], s33 offen offset:1024 sc1 lds
    buffer_load_dwordx4 v1, s[8:11], s33 offen offset:2048 sc1 lds
    buffer_load_dwordx4 v1, s[8:11], s33 offen offset:3072 sc1 lds
    s_add_u32 m0, s34, 4096
    s_add_u32 s37, s33, 4096
    buffer_load_dwordx4 v1, s[8:11], s37 offen offset:0 sc1 lds
    buffer_load_dwordx4 v1, s[8:11], s37 offen offset:1024 sc1 lds
    buffer_load_dwordx4 v1, s[8:11], s37 offen offset:2048 sc1 lds
    buffer_load_dwordx4 v1, s[8:11], s37 offen offset:3072 sc1 lds
    buffer_load_dwordx4 v[98:101], v1, s[8:11], s40 offen sc1
    s_waitcnt vmcnt(9)
    s_add_u32 s32, s32, 1
    s_add_u32 s33, s33, 32768
    s_add_u32 s34, s34, 36864
    s_cmp_ge_u32 s34, 147456
    s_cselect_b32 s38, 147456, 0
    s_sub_u32 s34, s34, s38
    s_add_u32 s40, s40, 34816
    v_cmp_gt_i32 vcc, s32, v5
    s_nop 0
    s_and_b64 vcc, vcc, s[18:19]
    s_cselect_b32 s10, 0, s6
    s_add_u32 m0, s34, 0
    s_nop 0
    buffer_load_dwordx4 v1, s[8:11], s33 offen offset:0 sc1 lds
    buffer_load_dwordx4 v1, s[8:11], s33 offen offset:1024 sc1 lds
    buffer_load_dwordx4 v1, s[8:11], s33 offen offset:2048 sc1 lds
    s_add_u32 s16, s16, 8192
    buffer_load_dword v5, v4, s[4:7], s16 offen sc1
    buffer_load_dwordx4 v1, s[8:11], s33 offen offset:3072 sc1 lds
    s_add_u32 m0, s34, 4096
    s_add_u32 s37, s33, 4096
    buffer_load_dwordx4 v1, s[8:11], s37 offen offset:0 sc1 lds
    buffer_load_dwordx4 v1, s[8:11], s37 offen offset:1024 sc1 lds
    buffer_load_dwordx4 v1, s[8:11], s37 offen offset:2048 sc1 lds
    buffer_load_dwordx4 v1, s[8:11], s37 offen offset:3072 sc1 lds
    s_waitcnt vmcnt(9)
Lwo_go0:
    s_mov_b32 s14, 0
    s_barrier
    ds_read_b128 v[40:43], v3 offset:0
    ds_read_b128 v[44:47], v3 offset:1024
    ds_read_b128 v[48:51], v3 offset:2048
    ds_read_b128 v[52:55], v3 offset:3072
    ds_read_b128 v[56:59], v3 offset:4096
    ds_read_b128 v[60:63], v3 offset:5120
    s_branch Lwo_body1
Lwo_slow1:
    s_sub_u32 s39, s16, 8192
    v_mfma_f32_16x16x32_bf16 v[24:27], a[8:11], v[44:47], v[24:27]
    ds_read_b128 v[68:71], v3 offset:7168
    v_mov_b32 v6, s31
    v_mfma_f32_16x16x32_bf16 v[28:31], a[12:15], v[44:47], v[28:31]
    s_waitcnt lgkmcnt(5)
    buffer_load_dword v103, v4, s[4:7], s39 offen sc1
    v_mfma_f32_16x16x32_bf16 v[24:27], a[16:19], v[48:51], v[24:27]
    ds_read_b128 v[40:43], v3 offset:8192
    v_cvt_pk_bf16_f32 v72, v8, v9
    v_mfma_f32_16x16x32_bf16 v[28:31], a[20:23], v[48:51], v[28:31]
    s_waitcnt lgkmcnt(5)
    v_cvt_pk_bf16_f32 v73, v10, v11
    v_cvt_pk_bf16_f32 v74, v12, v13
    v_mfma_f32_16x16x32_bf16 v[24:27], a[24:27], v[52:55], v[24:27]
    ds_read_b128 v[44:47], v3 offset:9216
    v_cvt_pk_bf16_f32 v75, v14, v15
    v_mfma_f32_16x16x32_bf16 v[28:31], a[28:31], v[52:55], v[28:31]
    s_waitcnt lgkmcnt(5)
    buffer_store_dwordx4 v[72:75], v1, s[12:15], s36 offen sc1
    s_add_u32 s35, s35, 36864
    v_mfma_f32_16x16x32_bf16 v[80:83], v[72:75], v[72:75], 0
    s_cmp_eq_u32 s35, 147456
    s_cselect_b32 s35, 0, s35
    v_add_u32 v2, s35, v1
    v_mfma_f32_16x16x32_bf16 v[76:79], v[84:87], v[72:75], 0
    v_mfma_f32_16x16x32_bf16 v[24:27], a[32:35], v[56:59], v[24:27]
    ds_read_b128 v[48:51], v3 offset:10240
    v_mfma_f32_16x16x32_bf16 v[28:31], a[36:39], v[56:59], v[28:31]
    s_waitcnt lgkmcnt(5)
    v_cndmask_b32 v80, v80, v81, s[44:45]
    v_cndmask_b32 v82, v82, v83, s[44:45]
    v_mfma_f32_16x16x32_bf16 v[24:27], a[40:43], v[60:63], v[24:27]
    ds_read_b128 v[52:55], v3 offset:11264
    v_cndmask_b32 v77, v80, v82, s[46:47]
    v_mfma_f32_16x16x32_bf16 v[28:31], a[44:47], v[60:63], v[28:31]
    s_waitcnt lgkmcnt(5)
    buffer_store_dwordx2 v[76:77], v7, s[12:15], s36 offen offset:0 sc1
    s_add_u32 s36, s36, 36864
    v_mfma_f32_16x16x32_bf16 v[24:27], a[48:51], v[64:67], v[24:27]
    ds_read_b128 v[56:59], v3 offset:12288
    v_mfma_f32_16x16x32_bf16 v[28:31], a[52:55], v[64:67], v[28:31]
    s_waitcnt lgkmcnt(5)
    v_mfma_f32_16x16x32_bf16 v[24:27], a[56:59], v[68:71], v[24:27]
    ds_read_b128 v[60:63], v3 offset:13312
    v_mfma_f32_16x16x32_bf16 v[28:31], a[60:63], v[68:71], v[28:31]
    s_waitcnt lgkmcnt(5)
    v_mfma_f32_16x16x32_bf16 v[24:27], a[64:67], v[40:43], v[24:27]
    ds_read_b128 v[64:67], v3 offset:14336
    v_mfma_f32_16x16x32_bf16 v[28:31], a[68:71], v[40:43], v[28:31]
    s_waitcnt lgkmcnt(5)
    v_mfma_f32_16x16x32_bf16 v[24:27], a[72:75], v[44:47], v[24:27]
    ds_read_b128 v[68:71], v3 offset:15360
    v_mfma_f32_16x16x32_bf16 v[28:31], a[76:79], v[44:47], v[28:31]
    s_waitcnt lgkmcnt(5)
    v_mfma_f32_16x16x32_bf16 v[24:27], a[80:83], v[48:51], v[24:27]
    ds_read_b128 v[40:43], v3 offset:16384
    v_mfma_f32_16x16x32_bf16 v[28:31], a[84:87], v[48:51], v[28:31]
    s_waitcnt lgkmcnt(5)
    v_mfma_f32_16x16x32_bf16 v[24:27], a[88:91], v[52:55], v[24:27]
    ds_read_b128 v[44:47], v3 offset:17408
    v_mfma_f32_16x16x32_bf16 v[28:31], a[92:95], v[52:55], v[28:31]
    s_waitcnt lgkmcnt(5)
    v_mfma_f32_16x16x32_bf16 v[24:27], a[96:99], v[56:59], v[24:27]
    ds_read_b128 v[48:51], v3 offset:18432
    v_mfma_f32_16x16x32_bf16 v[28:31], a[100:103], v[56:59], v[28:31]
    s_waitcnt lgkmcnt(5)
    v_mfma_f32_16x16x32_bf16 v[24:27], a[104:107], v[60:63], v[24:27]
    ds_read_b128 v[52:55], v3 offset:19456
    v_mfma_f32_16x16x32_bf16 v[28:31], a[108:111], v[60:63], v[28:31]
    s_waitcnt lgkmcnt(5)
    v_mfma_f32_16x16x32_bf16 v[24:27], a[112:115], v[64:67], v[24:27]
    ds_read_b128 v[56:59], v3 offset:20480
    v_mfma_f32_16x16x32_bf16 v[28:31], a[116:119], v[64:67], v[28:31]
    s_waitcnt lgkmcnt(5)
    v_mfma_f32_16x16x32_bf16 v[24:27], a[120:123], v[68:71], v[24:27]
    ds_read_b128 v[60:63], v3 offset:21504
    v_mfma_f32_16x16x32_bf16 v[28:31], a[124:127], v[68:71], v[28:31]
    s_waitcnt lgkmcnt(5)
    s_waitcnt vmcnt(2)
    v_cmp_gt_i32 vcc, s32, v103
    v_mfma_f32_16x16x32_bf16 v[24:27], a[128:131], v[40:43], v[24:27]
    ds_read_b128 v[64:67], v3 offset:22528
    v_mfma_f32_16x16x32_bf16 v[28:31], a[132:135], v[40:43], v[28:31]
    s_waitcnt lgkmcnt(5)
    s_and_b64 vcc, vcc, s[18:19]
    s_cselect_b32 s10, 0, s6
    v_mfma_f32_16x16x32_bf16 v[24:27], a[136:139], v[44:47], v[24:27]
    ds_read_b128 v[68:71], v3 offset:23552
    s_add_u32 m0, s34, 0
    v_mfma_f32_16x16x32_bf16 v[28:31], a[140:143], v[44:47], v[28:31]
    s_waitcnt lgkmcnt(5)
    buffer_load_dwordx4 v1, s[8:11], s33 offen offset:0 sc1 lds
    v_mfma_f32_16x16x32_bf16 v[24:27], a[144:147], v[48:51], v[24:27]
    ds_read_b128 v[40:43], v3 offset:24576
    v_mfma_f32_16x16x32_bf16 v[28:31], a[148:151], v[48:51], v[28:31]
    s_waitcnt lgkmcnt(5)
    v_mfma_f32_16x16x32_bf16 v[24:27], a[152:155], v[52:55], v[24:27]
    ds_read_b128 v[44:47], v3 offset:25600
    v_mfma_f32_16x16x32_bf16 v[28:31], a[156:159], v[52:55], v[28:31]
    s_waitcnt lgkmcnt(5)
    buffer_load_dwordx4 v1, s[8:11], s33 offen offset:1024 sc1 lds
    v_mfma_f32_16x16x32_bf16 v[24:27], a[160:163], v[56:59], v[24:27]
    ds_read_b128 v[48:51], v3 offset:26624
    v_mfma_f32_16x16x32_bf16 v[28:31], a[164:167], v[56:59], v[28:31]
    s_waitcnt lgkmcnt(5)
    v_mfma_f32_16x16x32_bf16 v[24:27], a[168:171], v[60:63], v[24:27]
    ds_read_b128 v[52:55], v3 offset:27648
    v_mfma_f32_16x16x32_bf16 v[28:31], a[172:175], v[60:63], v[28:31]
    s_waitcnt lgkmcnt(5)
    buffer_load_dword v5, v4, s[4:7], s16 offen sc1
    v_mfma_f32_16x16x32_bf16 v[24:27], a[176:179], v[64:67], v[24:27]
    ds_read_b128 v[56:59], v3 offset:28672
    v_mfma_f32_16x16x32_bf16 v[28:31], a[180:183], v[64:67], v[28:31]
    s_waitcnt lgkmcnt(5)
    v_mfma_f32_16x16x32_bf16 v[24:27], a[184:187], v[68:71], v[24:27]
    ds_read_b128 v[60:63], v3 offset:29696
    v_mfma_f32_16x16x32_bf16 v[28:31], a[188:191], v[68:71], v[28:31]
    s_waitcnt lgkmcnt(5)
    buffer_load_dwordx4 v1, s[8:11], s33 offen offset:2048 sc1 lds
    v_mfma_f32_16x16x32_bf16 v[24:27], a[192:195], v[40:43], v[24:27]
    ds_read_b128 v[64:67], v3 offset:30720
    v_mfma_f32_16x16x32_bf16 v[28:31], a[196:199], v[40:43], v[28:31]
    s_waitcnt lgkmcnt(5)
    v_mfma_f32_16x16x32_bf16 v[24:27], a[200:203], v[44:47], v[24:27]
    ds_read_b128 v[68:71], v3 offset:31744
    s_waitcnt vmcnt(4)
    v_mfma_f32_16x16x32_bf16 v[28:31], a[204:207], v[44:47], v[28:31]
    s_waitcnt lgkmcnt(5)
    buffer_load_dwordx4 v1, s[8:11], s33 offen offset:3072 sc1 lds
    v_mfma_f32_16x16x32_bf16 v[24:27], a[208:211], v[48:51], v[24:27]
    s_add_u32 m0, s34, 4096
    s_add_u32 s37, s33, 4096
    v_mfma_f32_16x16x32_bf16 v[28:31], a[212:215], v[48:51], v[28:31]
    s_waitcnt lgkmcnt(4)
    buffer_store_dword v6, v102, s[12:15], s17 offen sc1
    v_mfma_f32_16x16x32_bf16 v[24:27], a[216:219], v[52:55], v[24:27]
    s_mov_b32 s14, s6
    s_add_u32 s17, s17, 8192
    v_mfma_f32_16x16x32_bf16 v[28:31], a[220:223], v[52:55], v[28:31]
    s_waitcnt lgkmcnt(3)
    buffer_load_dwordx4 v1, s[8:11], s37 offen offset:0 sc1 lds
    v_mfma_f32_16x16x32_bf16 v[24:27], a[224:227], v[56:59], v[24:27]
    v_mfma_f32_16x16x32_bf16 v[28:31], a[228:231], v[56:59], v[28:31]
    s_waitcnt lgkmcnt(2)
    v_mfma_f32_16x16x32_bf16 v[24:27], a[232:235], v[60:63], v[24:27]
    v_mfma_f32_16x16x32_bf16 v[28:31], a[236:239], v[60:63], v[28:31]
    s_waitcnt lgkmcnt(1)
    buffer_load_dwordx4 v1, s[8:11], s37 offen offset:1024 sc1 lds
    v_mfma_f32_16x16x32_bf16 v[24:27], a[240:243], v[64:67], v[24:27]
    v_mfma_f32_16x16x32_bf16 v[28:31], a[244:247], v[64:67], v[28:31]
    s_waitcnt lgkmcnt(0)
    v_mfma_f32_16x16x32_bf16 v[24:27], a[248:251], v[68:71], v[24:27]
    v_mfma_f32_16x16x32_bf16 v[28:31], a[252:255], v[68:71], v[28:31]
    buffer_load_dwordx4 v1, s[8:11], s37 offen offset:2048 sc1 lds
    v_mfma_f32_16x16x32_bf16 v[24:27], v[90:93], v[98:101], v[24:27]
    v_mfma_f32_16x16x32_bf16 v[28:31], v[88:91], v[98:101], v[28:31]
    buffer_load_dwordx4 v1, s[8:11], s37 offen offset:3072 sc1 lds
    buffer_load_dwordx4 v[94:97], v1, s[8:11], s40 offen sc1
    s_nop 4
    v_cvt_pk_bf16_f32 v72, v24, v25
    v_cvt_pk_bf16_f32 v73, v26, v27
    v_cvt_pk_bf16_f32 v74, v28, v29
    v_cvt_pk_bf16_f32 v75, v30, v31
    buffer_store_dwordx4 v[72:75], v1, s[12:15], s36 offen sc1
    s_nop 0
    v_mfma_f32_16x16x32_bf16 v[80:83], v[72:75], v[72:75], 0
    v_mfma_f32_16x16x32_bf16 v[76:79], v[84:87], v[72:75], 0
    s_nop 6
    v_cndmask_b32 v80, v80, v81, s[44:45]
    v_cndmask_b32 v82, v82, v83, s[44:45]
    v_cndmask_b32 v77, v80, v82, s[46:47]
    buffer_store_dwordx2 v[76:77], v7, s[12:15], s36 offen offset:0 sc1
    s_add_u32 s54, s31, 1
    v_mov_b32 v6, s54
    s_cmp_ge_i32 s31, 63
    s_cbranch_scc1 Lwo_late1
    s_cmp_eq_u32 s10, 0
    s_cbranch_scc1 Lwo_late1
    s_add_u32 s32, s32, 1
    s_add_u32 s33, s33, 32768
    s_add_u32 s34, s34, 36864
    s_cmp_ge_u32 s34, 147456
    s_cselect_b32 s38, 147456, 0
    s_sub_u32 s34, s34, s38
    s_add_u32 s40, s40, 34816
    s_waitcnt vmcnt(10)
    v_cmp_gt_i32 vcc, s32, v5
    s_nop 0
    s_and_b64 vcc, vcc, s[18:19]
    s_cselect_b32 s10, 0, s6
    s_add_u32 m0, s34, 0
    s_nop 0
    buffer_load_dwordx4 v1, s[8:11], s33 offen offset:0 sc1 lds
    buffer_load_dwordx4 v1, s[8:11], s33 offen offset:1024 sc1 lds
    buffer_load_dwordx4 v1, s[8:11], s33 offen offset:2048 sc1 lds
    s_add_u32 s16, s16, 8192
    buffer_load_dword v5, v4, s[4:7], s16 offen sc1
    buffer_load_dwordx4 v1, s[8:11], s33 offen offset:3072 sc1 lds
    s_add_u32 m0, s34, 4096
    s_add_u32 s37, s33, 4096
    buffer_load_dwordx4 v1, s[8:11], s37 offen offset:0 sc1 lds
    buffer_load_dwordx4 v1, s[8:11], s37 offen offset:1024 sc1 lds
    buffer_load_dwordx4 v1, s[8:11], s37 offen offset:2048 sc1 lds
    buffer_load_dwordx4 v1, s[8:11], s37 offen offset:3072 sc1 lds
    s_waitcnt vmcnt(9)
    buffer_store_dword v6, v102, s[12:15], s17 offen sc1
    s_branch Lwo_go1
Lwo_late1:
    s_mov_b32 s16, s39
    buffer_load_dword v5, v4, s[4:7], s16 offen sc1
    s_waitcnt vmcnt(1)
    buffer_store_dword v6, v102, s[12:15], s17 offen sc1
    s_cmp_ge_i32 s31, 63
    s_cbranch_scc1 L_exit
    s_waitcnt vmcnt(1)
    v_cmp_gt_i32 vcc, s32, v5
    s_sub_u32 s43, s43, 1
    s_cmp_lt_i32 s43, 0
    s_cbranch_scc1 Lwo_rdy1
    s_and_b64 vcc, vcc, s[18:19]
    s_cbranch_scc0 Lwo_rdy1
Lwo_spin1:
    buffer_load_dword v5, v4, s[4:7], s16 offen sc1
    s_waitcnt vmcnt(0)
    v_cmp_gt_i32 vcc, s32, v5
    s_sub_u32 s43, s43, 1
    s_cmp_lt_i32 s43, 0
    s_cbranch_scc1 Lwo_rdy1
    s_and_b64 vcc, vcc, s[18:19]
    s_cbranch_scc0 Lwo_rdy1
    s_sleep 8
    s_branch Lwo_spin1
Lwo_rdy1:
    s_add_u32 s16, s16, 8192
    buffer_load_dword v5, v4, s[4:7], s16 offen sc1
    s_mov_b32 s10, s6
    s_add_u32 m0, s34, 0
    s_nop 0
    buffer_load_dwordx4 v1, s[8:11], s33 offen offset:0 sc1 lds
    buffer_load_dwordx4 v1, s[8:11], s33 offen offset:1024 sc1 lds
    buffer_load_dwordx4 v1, s[8:11], s33 offen offset:2048 sc1 lds
    buffer_load_dwordx4 v1, s[8:11], s33 offen offset:3072 sc1 lds
    s_add_u32 m0, s34, 4096
    s_add_u32 s37, s33, 4096
    buffer_load_dwordx4 v1, s[8:11], s37 offen offset:0 sc1 lds
    buffer_load_dwordx4 v1, s[8:11], s37 offen offset:1024 sc1 lds
    buffer_load_dwordx4 v1, s[8:11], s37 offen offset:2048 sc1 lds
    buffer_load_dwordx4 v1, s[8:11], s37 offen offset:3072 sc1 lds
    buffer_load_dwordx4 v[94:97], v1, s[8:11], s40 offen sc1
    s_waitcnt vmcnt(9)
    s_add_u32 s32, s32, 1
    s_add_u32 s33, s33, 32768
    s_add_u32 s34, s34, 36864
    s_cmp_ge_u32 s34, 147456
    s_cselect_b32 s38, 147456, 0
    s_sub_u32 s34, s34, s38
    s_add_u32 s40, s40, 34816
    v_cmp_gt_i32 vcc, s32, v5
    s_nop 0
    s_and_b64 vcc, vcc, s[18:19]
    s_cselect_b32 s10, 0, s6
    s_add_u32 m0, s34, 0
    s_nop 0
    buffer_load_dwordx4 v1, s[8:11], s33 offen offset:0 sc1 lds
    buffer_load_dwordx4 v1, s[8:11], s33 offen offset:1024 sc1 lds
    buffer_load_dwordx4 v1, s[8:11], s33 offen offset:2048 sc1 lds
    s_add_u32 s16, s16, 8192
    buffer_load_dword v5, v4, s[4:7], s16 offen sc1
    buffer_load_dwordx4 v1, s[8:11], s33 offen offset:3072 sc1 lds
    s_add_u32 m0, s34, 4096
    s_add_u32 s37, s33, 4096
    buffer_load_dwordx4 v1, s[8:11], s37 offen offset:0 sc1 lds
    buffer_load_dwordx4 v1, s[8:11], s37 offen offset:1024 sc1 lds
    buffer_load_dwordx4 v1, s[8:11], s37 offen offset:2048 sc1 lds
    buffer_load_dwordx4 v1, s[8:11], s37 offen offset:3072 sc1 lds
    s_waitcnt vmcnt(9)
Lwo_go1:
    s_mov_b32 s14, 0
    s_barrier
    ds_read_b128 v[40:43], v2 offset:0
    ds_read_b128 v[44:47], v2 offset:1024
    ds_read_b128 v[48:51], v2 offset:2048
    ds_read_b128 v[52:55], v2 offset:3072
    ds_read_b128 v[56:59], v2 offset:4096
    ds_read_b128 v[60:63], v2 offset:5120
    s_branch Lwo_body0
Lffa_start:
    s_mov_b32 s12, s72
    s_mov_b32 s13, s73
    s_mov_b32 s14, 0x700000
    s_mov_b32 s15, 0x00020000
    v_lshrrev_b32 v24, 3, v0
    v_mul_u32_u24 v24, 7168, v24
    v_bfe_u32 v25, v0, 4, 2
    v_lshlrev_b32 v25, 1, v25
    v_and_b32 v26, 7, v0
    v_xor_b32 v25, v25, v26
    v_lshl_add_u32 v40, v25, 4, v24
    v_add_u32 v41, 56320, v40
    s_mul_i32 s86, s29, 0x180
    s_add_u32 s86, s86, 0xffffdc00
    s_mul_i32 s37, s30, 114688
    s_add_u32 s86, s86, s37
    s_lshl_b32 s87, s30, 11
    s_add_u32 m0, s87, 0
    s_add_u32 s37, s86, 0
    buffer_load_dwordx4 v40, s[12:15], s37 offen lds
    buffer_load_dwordx4 v41, s[12:15], s37 offen offset:1024 lds
    s_add_u32 m0, s87, 8192
    s_add_u32 s37, s86, 128
    buffer_load_dwordx4 v40, s[12:15], s37 offen lds
    buffer_load_dwordx4 v41, s[12:15], s37 offen offset:1024 lds
    s_add_u32 m0, s87, 16384
    s_add_u32 s37, s86, 256
    buffer_load_dwordx4 v40, s[12:15], s37 offen lds
    buffer_load_dwordx4 v41, s[12:15], s37 offen offset:1024 lds
    s_add_u32 m0, s87, 24576
    s_add_u32 s37, s86, 458752
    buffer_load_dwordx4 v40, s[12:15], s37 offen lds
    buffer_load_dwordx4 v41, s[12:15], s37 offen offset:1024 lds
    s_add_u32 m0, s87, 32768
    s_add_u32 s37, s86, 458880
    buffer_load_dwordx4 v40, s[12:15], s37 offen lds
    buffer_load_dwordx4 v41, s[12:15], s37 offen offset:1024 lds
    s_add_u32 m0, s87, 40960
    s_add_u32 s37, s86, 459008
    buffer_load_dwordx4 v40, s[12:15], s37 offen lds
    buffer_load_dwordx4 v41, s[12:15], s37 offen offset:1024 lds
    s_add_u32 m0, s87, 49152
    s_add_u32 s37, s86, 917504
    buffer_load_dwordx4 v40, s[12:15], s37 offen lds
    buffer_load_dwordx4 v41, s[12:15], s37 offen offset:1024 lds
    s_add_u32 m0, s87, 57344
    s_add_u32 s37, s86, 917632
    buffer_load_dwordx4 v40, s[12:15], s37 offen lds
    buffer_load_dwordx4 v41, s[12:15], s37 offen offset:1024 lds
    s_add_u32 m0, s87, 65536
    s_add_u32 s37, s86, 917760
    buffer_load_dwordx4 v40, s[12:15], s37 offen lds
    buffer_load_dwordx4 v41, s[12:15], s37 offen offset:1024 lds
    s_add_u32 m0, s87, 73728
    s_add_u32 s37, s86, 1376256
    buffer_load_dwordx4 v40, s[12:15], s37 offen lds
    buffer_load_dwordx4 v41, s[12:15], s37 offen offset:1024 lds
    s_add_u32 m0, s87, 81920
    s_add_u32 s37, s86, 1376384
    buffer_load_dwordx4 v40, s[12:15], s37 offen lds
    buffer_load_dwordx4 v41, s[12:15], s37 offen offset:1024 lds
    s_add_u32 m0, s87, 90112
    s_add_u32 s37, s86, 1376512
    buffer_load_dwordx4 v40, s[12:15], s37 offen lds
    buffer_load_dwordx4 v41, s[12:15], s37 offen offset:1024 lds
    s_add_u32 m0, s87, 98304
    s_add_u32 s37, s86, 1835008
    buffer_load_dwordx4 v40, s[12:15], s37 offen lds
    buffer_load_dwordx4 v41, s[12:15], s37 offen offset:1024 lds
    s_add_u32 m0, s87, 106496
    s_add_u32 s37, s86, 1835136
    buffer_load_dwordx4 v40, s[12:15], s37 offen lds
    buffer_load_dwordx4 v41, s[12:15], s37 offen offset:1024 lds
    s_add_u32 m0, s87, 114688
    s_add_u32 s37, s86, 1835264
    buffer_load_dwordx4 v40, s[12:15], s37 offen lds
    buffer_load_dwordx4 v41, s[12:15], s37 offen offset:1024 lds
    v_bfe_u32 v24, v0, 3, 2
    v_and_b32 v25, 3, v0
    v_lshlrev_b32 v25, 3, v25
    v_lshrrev_b32 v26, 2, v0
    v_lshl_add_u32 v26, v26, 7, v25
    v_lshrrev_b32 v27, 5, v0
    v_lshl_add_u32 v27, v27, 10, v26
    s_lshr_b32 s37, s30, 1
    s_and_b32 s38, s30, 1
    s_lshl_b32 s38, s38, 1
    s_add_u32 s38, s38, 0
    s_lshl_b32 s37, s37, 13
    v_xor_b32 v28, s38, v24
    v_lshl_add_u32 v28, v28, 5, s37
    v_add_u32 v42, v28, v26
    v_add_u32 v46, v28, v27
    s_lshr_b32 s37, s30, 1
    s_and_b32 s38, s30, 1
    s_lshl_b32 s38, s38, 1
    s_add_u32 s38, s38, 1
    s_lshl_b32 s37, s37, 13
    v_xor_b32 v28, s38, v24
    v_lshl_add_u32 v28, v28, 5, s37
    v_add_u32 v43, v28, v26
    v_add_u32 v47, v28, v27
    s_mov_b32 s37, 2
    s_mov_b32 s38, s30
    s_lshl_b32 s37, s37, 13
    v_xor_b32 v28, s38, v24
    v_lshl_add_u32 v28, v28, 5, s37
    v_add_u32 v44, v28, v26
    v_add_u32 v48, v28, v27
    v_mov_b32 v28, 0x3f803f80
    v_mov_b32 v29, 0x3f803f80
    v_mov_b32 v30, 0x3f803f80
    v_mov_b32 v31, 0x3f803f80
    s_mov_b32 s20, s74
    s_mov_b32 s21, s75
    s_mov_b32 s22, 0x1c00
    s_mov_b32 s23, 0x00020000
    v_lshrrev_b32 v8, 4, v0
    v_lshlrev_b32 v8, 3, v8
    s_mul_i32 s37, s29, 0x180
    s_mul_i32 s53, s30, 0x40
    s_add_u32 s37, s37, s53
    s_add_u32 s37, s37, 0xffffdc00
    buffer_load_dwordx2 v[10:11], v8, s[20:23], s37 offen
    s_mul_i32 s37, s29, 0x180
    s_mul_i32 s53, s30, 0x40
    s_add_u32 s37, s37, s53
    s_add_u32 s37, s37, 0xffffdc20
    buffer_load_dwordx2 v[12:13], v8, s[20:23], s37 offen
    s_mul_i32 s37, s29, 0x180
    s_mul_i32 s53, s30, 0x20
    s_add_u32 s37, s37, s53
    s_add_u32 s37, s37, 0xffffdd00
    buffer_load_dwordx2 v[14:15], v8, s[20:23], s37 offen
    s_waitcnt vmcnt(0)
    v_lshlrev_b32 v68, 16, v10
    v_and_b32 v69, 0xffff0000, v10
    v_lshlrev_b32 v70, 16, v11
    v_and_b32 v71, 0xffff0000, v11
    v_lshlrev_b32 v72, 16, v12
    v_and_b32 v73, 0xffff0000, v12
    v_lshlrev_b32 v74, 16, v13
    v_and_b32 v75, 0xffff0000, v13
    v_lshlrev_b32 v76, 16, v14
    v_and_b32 v77, 0xffff0000, v14
    v_lshlrev_b32 v78, 16, v15
    v_and_b32 v79, 0xffff0000, v15
    s_mul_i32 s37, s28, 0x80000
    s_add_u32 s37, s37, 0x6000800
    v_min_u32 v4, 31, v0
    v_lshl_add_u32 v4, v4, 5, s37
    s_mov_b32 s32, 1
    s_mul_i32 s33, s28, 0x240000
    s_add_u32 s33, s33, 0x1200000
    s_mul_i32 s36, s28, 0x720000
    s_mul_i32 s53, s29, 0x1800
    s_add_u32 s36, s36, s53
    s_mul_i32 s53, s30, 0x400
    s_add_u32 s36, s36, s53
    s_add_u32 s36, s36, 0x1fbf800
    s_lshr_b32 s37, s30, 1
    s_sub_u32 s37, s37, s30
    s_add_u32 s37, s37, 4
    s_lshl_b32 s37, s37, 10
    s_and_b32 s38, s30, 1
    v_lshrrev_b32 v8, 5, v0
    v_cmp_eq_u32 vcc, s38, v8
    v_add_u32 v8, s37, v1
    v_mov_b32 v7, 0x40000000
    v_cndmask_b32 v7, v7, v8, vcc
    s_mov_b32 s31, -1
    s_mov_b32 s35, 0
    s_mov_b32 s16, 0
    v_mov_b32 v5, 0
    s_mul_i32 s17, s28, 0x80000
    s_mul_i32 s53, s29, 0x80
    s_add_u32 s17, s17, s53
    s_mul_i32 s53, s30, 0x20
    s_add_u32 s17, s17, s53
    s_add_u32 s17, s17, 0x5ffe000
    v_cmp_eq_u32 vcc, 0, v0
    v_mov_b32 v22, 0x40000000
    s_nop 0
    v_cndmask_b32 v22, v22, v0, vcc
    v_mov_b32 v2, v1
    s_mul_i32 s34, s30, 9216
    s_add_u32 s33, s33, s34
    v_lshlrev_b32 v20, 3, v0
    s_mov_b64 s[18:19], 0xffffffff
    s_mov_b32 s19, 0
    v_mov_b32 v8, 0x40000000
    v_cndmask_b32 v4, v8, v4, s[18:19]
    v_add_u32 v50, 0, v42
    v_add_u32 v51, 0, v43
    v_add_u32 v52, 0, v44
    s_waitcnt vmcnt(24)
    s_barrier
    ds_read_b64_tr_b16 a[0:1], v50 offset:0
    ds_read_b64_tr_b16 a[2:3], v50 offset:2048
    ds_read_b64_tr_b16 a[4:5], v51 offset:0
    ds_read_b64_tr_b16 a[6:7], v51 offset:2048
    ds_read_b64_tr_b16 a[8:9], v52 offset:0
    ds_read_b64_tr_b16 a[10:11], v52 offset:2048
    ds_read_b64_tr_b16 a[12:13], v50 offset:4096
    ds_read_b64_tr_b16 a[14:15], v50 offset:6144
    ds_read_b64_tr_b16 a[16:17], v51 offset:4096
    ds_read_b64_tr_b16 a[18:19], v51 offset:6144
    ds_read_b64_tr_b16 a[20:21], v52 offset:4096
    ds_read_b64_tr_b16 a[22:23], v52 offset:6144
    s_add_u32 m0, s87, 122880
    s_add_u32 s37, s86, 2293760
    buffer_load_dwordx4 v40, s[12:15], s37 offen lds
    buffer_load_dwordx4 v41, s[12:15], s37 offen offset:1024 lds
    s_add_u32 m0, s87, 131072
    s_add_u32 s37, s86, 2293888
    buffer_load_dwordx4 v40, s[12:15], s37 offen lds
    buffer_load_dwordx4 v41, s[12:15], s37 offen offset:1024 lds
    s_add_u32 m0, s87, 139264
    s_add_u32 s37, s86, 2294016
    buffer_load_dwordx4 v40, s[12:15], s37 offen lds
    buffer_load_dwordx4 v41, s[12:15], s37 offen offset:1024 lds
    s_waitcnt lgkmcnt(0)
    v_mfma_f32_16x16x32_bf16 v[56:59], a[0:3], v[28:31], 0
    v_mfma_f32_16x16x32_bf16 v[60:63], a[4:7], v[28:31], 0
    v_mfma_f32_16x16x32_bf16 v[64:67], a[8:11], v[28:31], 0
    v_mfma_f32_16x16x32_bf16 v[56:59], a[12:15], v[28:31], v[56:59]
    v_mfma_f32_16x16x32_bf16 v[60:63], a[16:19], v[28:31], v[60:63]
    v_mfma_f32_16x16x32_bf16 v[64:67], a[20:23], v[28:31], v[64:67]
    v_add_u32 v50, 24576, v42
    v_add_u32 v51, 24576, v43
    v_add_u32 v52, 24576, v44
    s_waitcnt vmcnt(24)
    s_barrier
    ds_read_b64_tr_b16 a[24:25], v50 offset:0
    ds_read_b64_tr_b16 a[26:27], v50 offset:2048
    ds_read_b64_tr_b16 a[28:29], v51 offset:0
    ds_read_b64_tr_b16 a[30:31], v51 offset:2048
    ds_read_b64_tr_b16 a[32:33], v52 offset:0
    ds_read_b64_tr_b16 a[34:35], v52 offset:2048
    ds_read_b64_tr_b16 a[36:37], v50 offset:4096
    ds_read_b64_tr_b16 a[38:39], v50 offset:6144
    ds_read_b64_tr_b16 a[40:41], v51 offset:4096
    ds_read_b64_tr_b16 a[42:43], v51 offset:6144
    ds_read_b64_tr_b16 a[44:45], v52 offset:4096
    ds_read_b64_tr_b16 a[46:47], v52 offset:6144
    s_add_u32 m0, s87, 0
    s_add_u32 s37, s86, 2752512
    buffer_load_dwordx4 v40, s[12:15], s37 offen lds
    buffer_load_dwordx4 v41, s[12:15], s37 offen offset:1024 lds
    s_add_u32 m0, s87, 8192
    s_add_u32 s37, s86, 2752640
    buffer_load_dwordx4 v40, s[12:15], s37 offen lds
    buffer_load_dwordx4 v41, s[12:15], s37 offen offset:1024 lds
    s_add_u32 m0, s87, 16384
    s_add_u32 s37, s86, 2752768
    buffer_load_dwordx4 v40, s[12:15], s37 offen lds
    buffer_load_dwordx4 v41, s[12:15], s37 offen offset:1024 lds
    s_waitcnt lgkmcnt(0)
    v_mfma_f32_16x16x32_bf16 v[56:59], a[24:27], v[28:31], v[56:59]
    v_mfma_f32_16x16x32_bf16 v[60:63], a[28:31], v[28:31], v[60:63]
    v_mfma_f32_16x16x32_bf16 v[64:67], a[32:35], v[28:31], v[64:67]
    v_mfma_f32_16x16x32_bf16 v[56:59], a[36:39], v[28:31], v[56:59]
    v_mfma_f32_16x16x32_bf16 v[60:63], a[40:43], v[28:31], v[60:63]
    v_mfma_f32_16x16x32_bf16 v[64:67], a[44:47], v[28:31], v[64:67]
    v_add_u32 v50, 49152, v42
    v_add_u32 v51, 49152, v43
    v_add_u32 v52, 49152, v44
    s_waitcnt vmcnt(24)
    s_barrier
    ds_read_b64_tr_b16 a[48:49], v50 offset:0
    ds_read_b64_tr_b16 a[50:51], v50 offset:2048
    ds_read_b64_tr_b16 a[52:53], v51 offset:0
    ds_read_b64_tr_b16 a[54:55], v51 offset:2048
    ds_read_b64_tr_b16 a[56:57], v52 offset:0
    ds_read_b64_tr_b16 a[58:59], v52 offset:2048
    ds_read_b64_tr_b16 a[60:61], v50 offset:4096
    ds_read_b64_tr_b16 a[62:63], v50 offset:6144
    ds_read_b64_tr_b16 a[64:65], v51 offset:4096
    ds_read_b64_tr_b16 a[66:67], v51 offset:6144
    ds_read_b64_tr_b16 a[68:69], v52 offset:4096
    ds_read_b64_tr_b16 a[70:71], v52 offset:6144
    s_add_u32 m0, s87, 24576
    s_add_u32 s37, s86, 3211264
    buffer_load_dwordx4 v40, s[12:15], s37 offen lds
    buffer_load_dwordx4 v41, s[12:15], s37 offen offset:1024 lds
    s_add_u32 m0, s87, 32768
    s_add_u32 s37, s86, 3211392
    buffer_load_dwordx4 v40, s[12:15], s37 offen lds
    buffer_load_dwordx4 v41, s[12:15], s37 offen offset:1024 lds
    s_add_u32 m0, s87, 40960
    s_add_u32 s37, s86, 3211520
    buffer_load_dwordx4 v40, s[12:15], s37 offen lds
    buffer_load_dwordx4 v41, s[12:15], s37 offen offset:1024 lds
    s_waitcnt lgkmcnt(0)
    v_mfma_f32_16x16x32_bf16 v[56:59], a[48:51], v[28:31], v[56:59]
    v_mfma_f32_16x16x32_bf16 v[60:63], a[52:55], v[28:31], v[60:63]
    v_mfma_f32_16x16x32_bf16 v[64:67], a[56:59], v[28:31], v[64:67]
    v_mfma_f32_16x16x32_bf16 v[56:59], a[60:63], v[28:31], v[56:59]
    v_mfma_f32_16x16x32_bf16 v[60:63], a[64:67], v[28:31], v[60:63]
    v_mfma_f32_16x16x32_bf16 v[64:67], a[68:71], v[28:31], v[64:67]
    v_add_u32 v50, 73728, v42
    v_add_u32 v51, 73728, v43
    v_add_u32 v52, 73728, v44
    s_waitcnt vmcnt(24)
    s_barrier
    ds_read_b64_tr_b16 a[72:73], v50 offset:0
    ds_read_b64_tr_b16 a[74:75], v50 offset:2048
    ds_read_b64_tr_b16 a[76:77], v51 offset:0
    ds_read_b64_tr_b16 a[78:79], v51 offset:2048
    ds_read_b64_tr_b16 a[80:81], v52 offset:0
    ds_read_b64_tr_b16 a[82:83], v52 offset:2048
    ds_read_b64_tr_b16 a[84:85], v50 offset:4096
    ds_read_b64_tr_b16 a[86:87], v50 offset:6144
    ds_read_b64_tr_b16 a[88:89], v51 offset:4096
    ds_read_b64_tr_b16 a[90:91], v51 offset:6144
    ds_read_b64_tr_b16 a[92:93], v52 offset:4096
    ds_read_b64_tr_b16 a[94:95], v52 offset:6144
    s_add_u32 m0, s87, 49152
    s_add_u32 s37, s86, 3670016
    buffer_load_dwordx4 v40, s[12:15], s37 offen lds
    buffer_load_dwordx4 v41, s[12:15], s37 offen offset:1024 lds
    s_add_u32 m0, s87, 57344
    s_add_u32 s37, s86, 3670144
    buffer_load_dwordx4 v40, s[12:15], s37 offen lds
    buffer_load_dwordx4 v41, s[12:15], s37 offen offset:1024 lds
    s_add_u32 m0, s87, 65536
    s_add_u32 s37, s86, 3670272
    buffer_load_dwordx4 v40, s[12:15], s37 offen lds
    buffer_load_dwordx4 v41, s[12:15], s37 offen offset:1024 lds
    s_waitcnt lgkmcnt(0)
    v_mfma_f32_16x16x32_bf16 v[56:59], a[72:75], v[28:31], v[56:59]
    v_mfma_f32_16x16x32_bf16 v[60:63], a[76:79], v[28:31], v[60:63]
    v_mfma_f32_16x16x32_bf16 v[64:67], a[80:83], v[28:31], v[64:67]
    v_mfma_f32_16x16x32_bf16 v[56:59], a[84:87], v[28:31], v[56:59]
    v_mfma_f32_16x16x32_bf16 v[60:63], a[88:91], v[28:31], v[60:63]
    v_mfma_f32_16x16x32_bf16 v[64:67], a[92:95], v[28:31], v[64:67]
    v_add_u32 v50, 98304, v42
    v_add_u32 v51, 98304, v43
    v_add_u32 v52, 98304, v44
    s_waitcnt vmcnt(24)
    s_barrier
    ds_read_b64_tr_b16 a[96:97], v50 offset:0
    ds_read_b64_tr_b16 a[98:99], v50 offset:2048
    ds_read_b64_tr_b16 a[100:101], v51 offset:0
    ds_read_b64_tr_b16 a[102:103], v51 offset:2048
    ds_read_b64_tr_b16 a[104:105], v52 offset:0
    ds_read_b64_tr_b16 a[106:107], v52 offset:2048
    ds_read_b64_tr_b16 a[108:109], v50 offset:4096
    ds_read_b64_tr_b16 a[110:111], v50 offset:6144
    ds_read_b64_tr_b16 a[112:113], v51 offset:4096
    ds_read_b64_tr_b16 a[114:115], v51 offset:6144
    ds_read_b64_tr_b16 a[116:117], v52 offset:4096
    ds_read_b64_tr_b16 a[118:119], v52 offset:6144
    s_add_u32 m0, s87, 73728
    s_add_u32 s37, s86, 4128768
    buffer_load_dwordx4 v40, s[12:15], s37 offen lds
    buffer_load_dwordx4 v41, s[12:15], s37 offen offset:1024 lds
    s_add_u32 m0, s87, 81920
    s_add_u32 s37, s86, 4128896
    buffer_load_dwordx4 v40, s[12:15], s37 offen lds
    buffer_load_dwordx4 v41, s[12:15], s37 offen offset:1024 lds
    s_add_u32 m0, s87, 90112
    s_add_u32 s37, s86, 4129024
    buffer_load_dwordx4 v40, s[12:15], s37 offen lds
    buffer_load_dwordx4 v41, s[12:15], s37 offen offset:1024 lds
    s_waitcnt lgkmcnt(0)
    v_mfma_f32_16x16x32_bf16 v[56:59], a[96:99], v[28:31], v[56:59]
    v_mfma_f32_16x16x32_bf16 v[60:63], a[100:103], v[28:31], v[60:63]
    v_mfma_f32_16x16x32_bf16 v[64:67], a[104:107], v[28:31], v[64:67]
    v_mfma_f32_16x16x32_bf16 v[56:59], a[108:111], v[28:31], v[56:59]
    v_mfma_f32_16x16x32_bf16 v[60:63], a[112:115], v[28:31], v[60:63]
    v_mfma_f32_16x16x32_bf16 v[64:67], a[116:119], v[28:31], v[64:67]
    v_add_u32 v50, 122880, v42
    v_add_u32 v51, 122880, v43
    v_add_u32 v52, 122880, v44
    s_waitcnt vmcnt(24)
    s_barrier
    ds_read_b64_tr_b16 a[120:121], v50 offset:0
    ds_read_b64_tr_b16 a[122:123], v50 offset:2048
    ds_read_b64_tr_b16 a[124:125], v51 offset:0
    ds_read_b64_tr_b16 a[126:127], v51 offset:2048
    ds_read_b64_tr_b16 a[128:129], v52 offset:0
    ds_read_b64_tr_b16 a[130:131], v52 offset:2048
    ds_read_b64_tr_b16 a[132:133], v50 offset:4096
    ds_read_b64_tr_b16 a[134:135], v50 offset:6144
    ds_read_b64_tr_b16 a[136:137], v51 offset:4096
    ds_read_b64_tr_b16 a[138:139], v51 offset:6144
    ds_read_b64_tr_b16 a[140:141], v52 offset:4096
    ds_read_b64_tr_b16 a[142:143], v52 offset:6144
    s_add_u32 m0, s87, 98304
    s_add_u32 s37, s86, 4587520
    buffer_load_dwordx4 v40, s[12:15], s37 offen lds
    buffer_load_dwordx4 v41, s[12:15], s37 offen offset:1024 lds
    s_add_u32 m0, s87, 106496
    s_add_u32 s37, s86, 4587648
    buffer_load_dwordx4 v40, s[12:15], s37 offen lds
    buffer_load_dwordx4 v41, s[12:15], s37 offen offset:1024 lds
    s_add_u32 m0, s87, 114688
    s_add_u32 s37, s86, 4587776
    buffer_load_dwordx4 v40, s[12:15], s37 offen lds
    buffer_load_dwordx4 v41, s[12:15], s37 offen offset:1024 lds
    s_waitcnt lgkmcnt(0)
    v_mfma_f32_16x16x32_bf16 v[56:59], a[120:123], v[28:31], v[56:59]
    v_mfma_f32_16x16x32_bf16 v[60:63], a[124:127], v[28:31], v[60:63]
    v_mfma_f32_16x16x32_bf16 v[64:67], a[128:131], v[28:31], v[64:67]
    v_mfma_f32_16x16x32_bf16 v[56:59], a[132:135], v[28:31], v[56:59]
    v_mfma_f32_16x16x32_bf16 v[60:63], a[136:139], v[28:31], v[60:63]
    v_mfma_f32_16x16x32_bf16 v[64:67], a[140:143], v[28:31], v[64:67]
    v_add_u32 v50, 0, v42
    v_add_u32 v51, 0, v43
    v_add_u32 v52, 0, v44
    s_waitcnt vmcnt(24)
    s_barrier
    ds_read_b64_tr_b16 a[144:145], v50 offset:0
    ds_read_b64_tr_b16 a[146:147], v50 offset:2048
    ds_read_b64_tr_b16 a[148:149], v51 offset:0
    ds_read_b64_tr_b16 a[150:151], v51 offset:2048
    ds_read_b64_tr_b16 a[152:153], v52 offset:0
    ds_read_b64_tr_b16 a[154:155], v52 offset:2048
    ds_read_b64_tr_b16 a[156:157], v50 offset:4096
    ds_read_b64_tr_b16 a[158:159], v50 offset:6144
    ds_read_b64_tr_b16 a[160:161], v51 offset:4096
    ds_read_b64_tr_b16 a[162:163], v51 offset:6144
    ds_read_b64_tr_b16 a[164:165], v52 offset:4096
    ds_read_b64_tr_b16 a[166:167], v52 offset:6144
    s_add_u32 m0, s87, 122880
    s_add_u32 s37, s86, 5046272
    buffer_load_dwordx4 v40, s[12:15], s37 offen lds
    buffer_load_dwordx4 v41, s[12:15], s37 offen offset:1024 lds
    s_add_u32 m0, s87, 131072
    s_add_u32 s37, s86, 5046400
    buffer_load_dwordx4 v40, s[12:15], s37 offen lds
    buffer_load_dwordx4 v41, s[12:15], s37 offen offset:1024 lds
    s_add_u32 m0, s87, 139264
    s_add_u32 s37, s86, 5046528
    buffer_load_dwordx4 v40, s[12:15], s37 offen lds
    buffer_load_dwordx4 v41, s[12:15], s37 offen offset:1024 lds
    s_waitcnt lgkmcnt(0)
    v_mfma_f32_16x16x32_bf16 v[56:59], a[144:147], v[28:31], v[56:59]
    v_mfma_f32_16x16x32_bf16 v[60:63], a[148:151], v[28:31], v[60:63]
    v_mfma_f32_16x16x32_bf16 v[64:67], a[152:155], v[28:31], v[64:67]
    v_mfma_f32_16x16x32_bf16 v[56:59], a[156:159], v[28:31], v[56:59]
    v_mfma_f32_16x16x32_bf16 v[60:63], a[160:163], v[28:31], v[60:63]
    v_mfma_f32_16x16x32_bf16 v[64:67], a[164:167], v[28:31], v[64:67]
    v_add_u32 v50, 24576, v42
    v_add_u32 v51, 24576, v43
    v_add_u32 v52, 24576, v44
    s_waitcnt vmcnt(24)
    s_barrier
    ds_read_b64_tr_b16 a[168:169], v50 offset:0
    ds_read_b64_tr_b16 a[170:171], v50 offset:2048
    ds_read_b64_tr_b16 a[172:173], v51 offset:0
    ds_read_b64_tr_b16 a[174:175], v51 offset:2048
    ds_read_b64_tr_b16 a[176:177], v52 offset:0
    ds_read_b64_tr_b16 a[178:179], v52 offset:2048
    ds_read_b64_tr_b16 a[180:181], v50 offset:4096
    ds_read_b64_tr_b16 a[182:183], v50 offset:6144
    ds_read_b64_tr_b16 a[184:185], v51 offset:4096
    ds_read_b64_tr_b16 a[186:187], v51 offset:6144
    ds_read_b64_tr_b16 a[188:189], v52 offset:4096
    ds_read_b64_tr_b16 a[190:191], v52 offset:6144
    s_add_u32 m0, s87, 0
    s_add_u32 s37, s86, 5505024
    buffer_load_dwordx4 v40, s[12:15], s37 offen lds
    buffer_load_dwordx4 v41, s[12:15], s37 offen offset:1024 lds
    s_add_u32 m0, s87, 8192
    s_add_u32 s37, s86, 5505152
    buffer_load_dwordx4 v40, s[12:15], s37 offen lds
    buffer_load_dwordx4 v41, s[12:15], s37 offen offset:1024 lds
    s_add_u32 m0, s87, 16384
    s_add_u32 s37, s86, 5505280
    buffer_load_dwordx4 v40, s[12:15], s37 offen lds
    buffer_load_dwordx4 v41, s[12:15], s37 offen offset:1024 lds
    s_waitcnt lgkmcnt(0)
    v_mfma_f32_16x16x32_bf16 v[56:59], a[168:171], v[28:31], v[56:59]
    v_mfma_f32_16x16x32_bf16 v[60:63], a[172:175], v[28:31], v[60:63]
    v_mfma_f32_16x16x32_bf16 v[64:67], a[176:179], v[28:31], v[64:67]
    v_mfma_f32_16x16x32_bf16 v[56:59], a[180:183], v[28:31], v[56:59]
    v_mfma_f32_16x16x32_bf16 v[60:63], a[184:187], v[28:31], v[60:63]
    v_mfma_f32_16x16x32_bf16 v[64:67], a[188:191], v[28:31], v[64:67]
    v_add_u32 v50, 49152, v42
    v_add_u32 v51, 49152, v43
    v_add_u32 v52, 49152, v44
    s_waitcnt vmcnt(24)
    s_barrier
    ds_read_b64_tr_b16 a[192:193], v50 offset:0
    ds_read_b64_tr_b16 a[194:195], v50 offset:2048
    ds_read_b64_tr_b16 a[196:197], v51 offset:0
    ds_read_b64_tr_b16 a[198:199], v51 offset:2048
    ds_read_b64_tr_b16 a[200:201], v52 offset:0
    ds_read_b64_tr_b16 a[202:203], v52 offset:2048
    ds_read_b64_tr_b16 a[204:205], v50 offset:4096
    ds_read_b64_tr_b16 a[206:207], v50 offset:6144
    ds_read_b64_tr_b16 a[208:209], v51 offset:4096
    ds_read_b64_tr_b16 a[210:211], v51 offset:6144
    ds_read_b64_tr_b16 a[212:213], v52 offset:4096
    ds_read_b64_tr_b16 a[214:215], v52 offset:6144
    s_add_u32 m0, s87, 24576
    s_add_u32 s37, s86, 5963776
    buffer_load_dwordx4 v40, s[12:15], s37 offen lds
    buffer_load_dwordx4 v41, s[12:15], s37 offen offset:1024 lds
    s_add_u32 m0, s87, 32768
    s_add_u32 s37, s86, 5963904
    buffer_load_dwordx4 v40, s[12:15], s37 offen lds
    buffer_load_dwordx4 v41, s[12:15], s37 offen offset:1024 lds
    s_add_u32 m0, s87, 40960
    s_add_u32 s37, s86, 5964032
    buffer_load_dwordx4 v40, s[12:15], s37 offen lds
    buffer_load_dwordx4 v41, s[12:15], s37 offen offset:1024 lds
    s_waitcnt lgkmcnt(0)
    v_mfma_f32_16x16x32_bf16 v[56:59], a[192:195], v[28:31], v[56:59]
    v_mfma_f32_16x16x32_bf16 v[60:63], a[196:199], v[28:31], v[60:63]
    v_mfma_f32_16x16x32_bf16 v[64:67], a[200:203], v[28:31], v[64:67]
    v_mfma_f32_16x16x32_bf16 v[56:59], a[204:207], v[28:31], v[56:59]
    v_mfma_f32_16x16x32_bf16 v[60:63], a[208:211], v[28:31], v[60:63]
    v_mfma_f32_16x16x32_bf16 v[64:67], a[212:215], v[28:31], v[64:67]
    v_add_u32 v50, 73728, v42
    v_add_u32 v51, 73728, v43
    v_add_u32 v52, 73728, v44
    s_waitcnt vmcnt(24)
    s_barrier
    ds_read_b64_tr_b16 a[216:217], v50 offset:0
    ds_read_b64_tr_b16 a[218:219], v50 offset:2048
    ds_read_b64_tr_b16 a[220:221], v51 offset:0
    ds_read_b64_tr_b16 a[222:223], v51 offset:2048
    ds_read_b64_tr_b16 a[224:225], v52 offset:0
    ds_read_b64_tr_b16 a[226:227], v52 offset:2048
    ds_read_b64_tr_b16 a[228:229], v50 offset:4096
    ds_read_b64_tr_b16 a[230:231], v50 offset:6144
    ds_read_b64_tr_b16 a[232:233], v51 offset:4096
    ds_read_b64_tr_b16 a[234:235], v51 offset:6144
    ds_read_b64_tr_b16 a[236:237], v52 offset:4096
    ds_read_b64_tr_b16 a[238:239], v52 offset:6144
    s_add_u32 m0, s87, 49152
    s_add_u32 s37, s86, 6422528
    buffer_load_dwordx4 v40, s[12:15], s37 offen lds
    buffer_load_dwordx4 v41, s[12:15], s37 offen offset:1024 lds
    s_add_u32 m0, s87, 57344
    s_add_u32 s37, s86, 6422656
    buffer_load_dwordx4 v40, s[12:15], s37 offen lds
    buffer_load_dwordx4 v41, s[12:15], s37 offen offset:1024 lds
    s_add_u32 m0, s87, 65536
    s_add_u32 s37, s86, 6422784
    buffer_load_dwordx4 v40, s[12:15], s37 offen lds
    buffer_load_dwordx4 v41, s[12:15], s37 offen offset:1024 lds
    s_waitcnt lgkmcnt(0)
    v_mfma_f32_16x16x32_bf16 v[56:59], a[216:219], v[28:31], v[56:59]
    v_mfma_f32_16x16x32_bf16 v[60:63], a[220:223], v[28:31], v[60:63]
    v_mfma_f32_16x16x32_bf16 v[64:67], a[224:227], v[28:31], v[64:67]
    v_mfma_f32_16x16x32_bf16 v[56:59], a[228:231], v[28:31], v[56:59]
    v_mfma_f32_16x16x32_bf16 v[60:63], a[232:235], v[28:31], v[60:63]
    v_mfma_f32_16x16x32_bf16 v[64:67], a[236:239], v[28:31], v[64:67]
    v_add_u32 v50, 98304, v42
    v_add_u32 v51, 98304, v43
    v_add_u32 v52, 98304, v44
    s_waitcnt vmcnt(24)
    s_barrier
    ds_read_b64_tr_b16 a[240:241], v50 offset:0
    ds_read_b64_tr_b16 a[242:243], v50 offset:2048
    ds_read_b64_tr_b16 a[244:245], v51 offset:0
    ds_read_b64_tr_b16 a[246:247], v51 offset:2048
    ds_read_b64_tr_b16 a[248:249], v52 offset:0
    ds_read_b64_tr_b16 a[250:251], v52 offset:2048
    ds_read_b64_tr_b16 a[252:253], v50 offset:4096
    ds_read_b64_tr_b16 a[254:255], v50 offset:6144
    ds_read_b64_tr_b16 v[128:129], v51 offset:4096
    ds_read_b64_tr_b16 v[130:131], v51 offset:6144
    ds_read_b64_tr_b16 v[132:133], v52 offset:4096
    ds_read_b64_tr_b16 v[134:135], v52 offset:6144
    s_add_u32 m0, s87, 73728
    s_add_u32 s37, s86, 6881280
    buffer_load_dwordx4 v40, s[12:15], s37 offen lds
    buffer_load_dwordx4 v41, s[12:15], s37 offen offset:1024 lds
    s_add_u32 m0, s87, 81920
    s_add_u32 s37, s86, 6881408
    buffer_load_dwordx4 v40, s[12:15], s37 offen lds
    buffer_load_dwordx4 v41, s[12:15], s37 offen offset:1024 lds
    s_add_u32 m0, s87, 90112
    s_add_u32 s37, s86, 6881536
    buffer_load_dwordx4 v40, s[12:15], s37 offen lds
    buffer_load_dwordx4 v41, s[12:15], s37 offen offset:1024 lds
    s_waitcnt lgkmcnt(0)
    v_mfma_f32_16x16x32_bf16 v[56:59], a[240:243], v[28:31], v[56:59]
    v_mfma_f32_16x16x32_bf16 v[60:63], a[244:247], v[28:31], v[60:63]
    v_mfma_f32_16x16x32_bf16 v[64:67], a[248:251], v[28:31], v[64:67]
    v_mfma_f32_16x16x32_bf16 v[56:59], a[252:255], v[28:31], v[56:59]
    v_mfma_f32_16x16x32_bf16 v[60:63], v[128:131], v[28:31], v[60:63]
    v_mfma_f32_16x16x32_bf16 v[64:67], v[132:135], v[28:31], v[64:67]
    v_add_u32 v50, 122880, v42
    v_add_u32 v51, 122880, v43
    v_add_u32 v52, 122880, v44
    s_waitcnt vmcnt(24)
    s_barrier
    ds_read_b64_tr_b16 v[136:137], v50 offset:0
    ds_read_b64_tr_b16 v[138:139], v50 offset:2048
    ds_read_b64_tr_b16 v[140:141], v51 offset:0
    ds_read_b64_tr_b16 v[142:143], v51 offset:2048
    ds_read_b64_tr_b16 v[144:145], v52 offset:0
    ds_read_b64_tr_b16 v[146:147], v52 offset:2048
    ds_read_b64_tr_b16 v[148:149], v50 offset:4096
    ds_read_b64_tr_b16 v[150:151], v50 offset:6144
    ds_read_b64_tr_b16 v[152:153], v51 offset:4096
    ds_read_b64_tr_b16 v[154:155], v51 offset:6144
    ds_read_b64_tr_b16 v[156:157], v52 offset:4096
    ds_read_b64_tr_b16 v[158:159], v52 offset:6144
    s_waitcnt lgkmcnt(0)
    v_mfma_f32_16x16x32_bf16 v[56:59], v[136:139], v[28:31], v[56:59]
    v_mfma_f32_16x16x32_bf16 v[60:63], v[140:143], v[28:31], v[60:63]
    v_mfma_f32_16x16x32_bf16 v[64:67], v[144:147], v[28:31], v[64:67]
    v_mfma_f32_16x16x32_bf16 v[56:59], v[148:151], v[28:31], v[56:59]
    v_mfma_f32_16x16x32_bf16 v[60:63], v[152:155], v[28:31], v[60:63]
    v_mfma_f32_16x16x32_bf16 v[64:67], v[156:159], v[28:31], v[64:67]
    v_add_u32 v50, 0, v42
    v_add_u32 v51, 0, v43
    v_add_u32 v52, 0, v44
    s_waitcnt vmcnt(18)
    s_barrier
    ds_read_b64_tr_b16 v[160:161], v50 offset:0
    ds_read_b64_tr_b16 v[162:163], v50 offset:2048
    ds_read_b64_tr_b16 v[164:165], v51 offset:0
    ds_read_b64_tr_b16 v[166:167], v51 offset:2048
    ds_read_b64_tr_b16 v[168:169], v52 offset:0
    ds_read_b64_tr_b16 v[170:171], v52 offset:2048
    ds_read_b64_tr_b16 v[172:173], v50 offset:4096
    ds_read_b64_tr_b16 v[174:175], v50 offset:6144
    ds_read_b64_tr_b16 v[176:177], v51 offset:4096
    ds_read_b64_tr_b16 v[178:179], v51 offset:6144
    ds_read_b64_tr_b16 v[180:181], v52 offset:4096
    ds_read_b64_tr_b16 v[182:183], v52 offset:6144
    s_waitcnt lgkmcnt(0)
    v_mfma_f32_16x16x32_bf16 v[56:59], v[160:163], v[28:31], v[56:59]
    v_mfma_f32_16x16x32_bf16 v[60:63], v[164:167], v[28:31], v[60:63]
    v_mfma_f32_16x16x32_bf16 v[64:67], v[168:171], v[28:31], v[64:67]
    v_mfma_f32_16x16x32_bf16 v[56:59], v[172:175], v[28:31], v[56:59]
    v_mfma_f32_16x16x32_bf16 v[60:63], v[176:179], v[28:31], v[60:63]
    v_mfma_f32_16x16x32_bf16 v[64:67], v[180:183], v[28:31], v[64:67]
    v_add_u32 v50, 24576, v42
    v_add_u32 v51, 24576, v43
    v_add_u32 v52, 24576, v44
    s_waitcnt vmcnt(12)
    s_barrier
    ds_read_b64_tr_b16 v[184:185], v50 offset:0
    ds_read_b64_tr_b16 v[186:187], v50 offset:2048
    ds_read_b64_tr_b16 v[188:189], v51 offset:0
    ds_read_b64_tr_b16 v[190:191], v51 offset:2048
    ds_read_b64_tr_b16 v[192:193], v52 offset:0
    ds_read_b64_tr_b16 v[194:195], v52 offset:2048
    ds_read_b64_tr_b16 v[196:197], v50 offset:4096
    ds_read_b64_tr_b16 v[198:199], v50 offset:6144
    ds_read_b64_tr_b16 v[200:201], v51 offset:4096
    ds_read_b64_tr_b16 v[202:203], v51 offset:6144
    ds_read_b64_tr_b16 v[204:205], v52 offset:4096
    ds_read_b64_tr_b16 v[206:207], v52 offset:6144
    s_waitcnt lgkmcnt(0)
    v_mfma_f32_16x16x32_bf16 v[56:59], v[184:187], v[28:31], v[56:59]
    v_mfma_f32_16x16x32_bf16 v[60:63], v[188:191], v[28:31], v[60:63]
    v_mfma_f32_16x16x32_bf16 v[64:67], v[192:195], v[28:31], v[64:67]
    v_mfma_f32_16x16x32_bf16 v[56:59], v[196:199], v[28:31], v[56:59]
    v_mfma_f32_16x16x32_bf16 v[60:63], v[200:203], v[28:31], v[60:63]
    v_mfma_f32_16x16x32_bf16 v[64:67], v[204:207], v[28:31], v[64:67]
    v_add_u32 v50, 49152, v42
    v_add_u32 v51, 49152, v43
    v_add_u32 v52, 49152, v44
    s_waitcnt vmcnt(6)
    s_barrier
    ds_read_b64_tr_b16 v[208:209], v50 offset:0
    ds_read_b64_tr_b16 v[210:211], v50 offset:2048
    ds_read_b64_tr_b16 v[212:213], v51 offset:0
    ds_read_b64_tr_b16 v[214:215], v51 offset:2048
    ds_read_b64_tr_b16 v[216:217], v52 offset:0
    ds_read_b64_tr_b16 v[218:219], v52 offset:2048
    ds_read_b64_tr_b16 v[220:221], v50 offset:4096
    ds_read_b64_tr_b16 v[222:223], v50 offset:6144
    ds_read_b64_tr_b16 v[224:225], v51 offset:4096
    ds_read_b64_tr_b16 v[226:227], v51 offset:6144
    ds_read_b64_tr_b16 v[228:229], v52 offset:4096
    ds_read_b64_tr_b16 v[230:231], v52 offset:6144
    s_waitcnt lgkmcnt(0)
    v_mfma_f32_16x16x32_bf16 v[56:59], v[208:211], v[28:31], v[56:59]
    v_mfma_f32_16x16x32_bf16 v[60:63], v[212:215], v[28:31], v[60:63]
    v_mfma_f32_16x16x32_bf16 v[64:67], v[216:219], v[28:31], v[64:67]
    v_mfma_f32_16x16x32_bf16 v[56:59], v[220:223], v[28:31], v[56:59]
    v_mfma_f32_16x16x32_bf16 v[60:63], v[224:227], v[28:31], v[60:63]
    v_mfma_f32_16x16x32_bf16 v[64:67], v[228:231], v[28:31], v[64:67]
    v_add_u32 v50, 73728, v42
    v_add_u32 v51, 73728, v43
    v_add_u32 v52, 73728, v44
    s_waitcnt vmcnt(0)
    s_barrier
    ds_read_b64_tr_b16 v[232:233], v50 offset:0
    ds_read_b64_tr_b16 v[234:235], v50 offset:2048
    ds_read_b64_tr_b16 v[236:237], v51 offset:0
    ds_read_b64_tr_b16 v[238:239], v51 offset:2048
    ds_read_b64_tr_b16 v[240:241], v52 offset:0
    ds_read_b64_tr_b16 v[242:243], v52 offset:2048
    ds_read_b64_tr_b16 v[244:245], v50 offset:4096
    ds_read_b64_tr_b16 v[246:247], v50 offset:6144
    ds_read_b64_tr_b16 v[248:249], v51 offset:4096
    ds_read_b64_tr_b16 v[250:251], v51 offset:6144
    ds_read_b64_tr_b16 v[252:253], v52 offset:4096
    ds_read_b64_tr_b16 v[254:255], v52 offset:6144
    s_waitcnt lgkmcnt(0)
    v_mfma_f32_16x16x32_bf16 v[56:59], v[232:235], v[28:31], v[56:59]
    v_mfma_f32_16x16x32_bf16 v[60:63], v[236:239], v[28:31], v[60:63]
    v_mfma_f32_16x16x32_bf16 v[64:67], v[240:243], v[28:31], v[64:67]
    v_mfma_f32_16x16x32_bf16 v[56:59], v[244:247], v[28:31], v[56:59]
    v_mfma_f32_16x16x32_bf16 v[60:63], v[248:251], v[28:31], v[60:63]
    v_mfma_f32_16x16x32_bf16 v[64:67], v[252:255], v[28:31], v[64:67]
    s_mov_b32 s12, s84
    s_mov_b32 s13, s85
    s_mov_b32 s14, 0x6200000
    s_mov_b32 s15, 0x00020000
    s_barrier
    s_mov_b32 s20, s82
    s_mov_b32 s21, s83
    s_mov_b32 s22, 0x100
    s_mov_b32 s23, 0x00020000
    v_and_b32 v8, 15, v0
    v_lshlrev_b32 v8, 4, v8
    buffer_load_dword v9, v8, s[20:23], 0 offen sc1
    s_waitcnt vmcnt(0)
Lffa_wa:
    v_cmp_gt_u32 vcc, 8, v9
    s_sub_u32 s43, s43, 1
    s_cmp_lt_i32 s43, 0
    s_cbranch_scc1 Lffa_all
    s_cbranch_vccz Lffa_all
    s_sleep 2
    buffer_load_dword v9, v8, s[20:23], 0 offen sc1
    s_waitcnt vmcnt(0)
    s_branch Lffa_wa
Lffa_all:
    s_branch Lffa_spin1
    .p2align 6
Lffa_body0:
    s_waitcnt lgkmcnt(2)
    v_mfma_f32_16x16x32_bf16 v[8:11], a[0:3], v[40:43], 0
    ds_read_b128 v[52:55], v2 offset:3072
    s_add_u32 s16, s16, 8192
    v_mfma_f32_16x16x32_bf16 v[12:15], a[4:7], v[40:43], 0
    s_cmp_eq_u32 s10, 0
    s_cbranch_scc1 Lffa_slow0
    v_mfma_f32_16x16x32_bf16 v[16:19], a[8:11], v[40:43], 0
    s_waitcnt lgkmcnt(2)
    s_add_u32 m0, s34, 4096
    s_add_u32 s37, s33, 4096
    v_mfma_f32_16x16x32_bf16 v[8:11], a[12:15], v[44:47], v[8:11]
    ds_read_b128 v[40:43], v2 offset:4096
    v_fma_f32 v116, v24, v21, v80
    v_mfma_f32_16x16x32_bf16 v[12:15], a[16:19], v[44:47], v[12:15]
    buffer_load_dwordx4 v1, s[8:11], s37 offen offset:0 sc1 lds
    v_mfma_f32_16x16x32_bf16 v[16:19], a[20:23], v[44:47], v[16:19]
    s_waitcnt lgkmcnt(2)
    v_fma_f32 v117, v25, v21, v81
    v_fma_f32 v118, v26, v21, v82
    v_mfma_f32_16x16x32_bf16 v[8:11], a[24:27], v[48:51], v[8:11]
    ds_read_b128 v[44:47], v2 offset:5120
    v_fma_f32 v119, v27, v21, v83
    v_mfma_f32_16x16x32_bf16 v[12:15], a[28:31], v[48:51], v[12:15]
    s_add_u32 s31, s31, 1
    v_mov_b32 v6, s31
    v_fma_f32 v120, v28, v21, v84
    v_mfma_f32_16x16x32_bf16 v[16:19], a[32:35], v[48:51], v[16:19]
    s_waitcnt lgkmcnt(2)
    buffer_load_dwordx4 v1, s[8:11], s37 offen offset:1024 sc1 lds
    v_mfma_f32_16x16x32_bf16 v[8:11], a[36:39], v[52:55], v[8:11]
    ds_read_b128 v[48:51], v2 offset:6144
    v_fma_f32 v121, v29, v21, v85
    v_mfma_f32_16x16x32_bf16 v[12:15], a[40:43], v[52:55], v[12:15]
    s_add_u32 s35, s35, 36864
    v_fma_f32 v122, v30, v21, v86
    v_fma_f32 v123, v31, v21, v87
    v_mfma_f32_16x16x32_bf16 v[16:19], a[44:47], v[52:55], v[16:19]
    s_waitcnt lgkmcnt(2)
    v_mul_f32 v116, v116, |v116|
    v_mul_f32 v117, v117, |v117|
    v_mfma_f32_16x16x32_bf16 v[8:11], a[48:51], v[40:43], v[8:11]
    ds_read_b128 v[52:55], v2 offset:7168
    v_mul_f32 v118, v118, |v118|
    v_mfma_f32_16x16x32_bf16 v[12:15], a[52:55], v[40:43], v[12:15]
    buffer_load_dword v5, v4, s[4:7], s16 offen sc1
    v_mfma_f32_16x16x32_bf16 v[16:19], a[56:59], v[40:43], v[16:19]
    s_waitcnt lgkmcnt(2)
    v_mul_f32 v119, v119, |v119|
    v_mul_f32 v120, v120, |v120|
    v_mfma_f32_16x16x32_bf16 v[8:11], a[60:63], v[44:47], v[8:11]
    ds_read_b128 v[40:43], v2 offset:8192
    v_mul_f32 v121, v121, |v121|
    v_mfma_f32_16x16x32_bf16 v[12:15], a[64:67], v[44:47], v[12:15]
    s_cmp_eq_u32 s35, 147456
    s_cselect_b32 s35, 0, s35
    v_mul_f32 v122, v122, |v122|
    v_mfma_f32_16x16x32_bf16 v[16:19], a[68:71], v[44:47], v[16:19]
    s_waitcnt lgkmcnt(2)
    buffer_load_dwordx4 v1, s[8:11], s37 offen offset:2048 sc1 lds
    v_mfma_f32_16x16x32_bf16 v[8:11], a[72:75], v[48:51], v[8:11]
    ds_read_b128 v[44:47], v2 offset:9216
    v_mul_f32 v123, v123, |v123|
    v_mfma_f32_16x16x32_bf16 v[12:15], a[76:79], v[48:51], v[12:15]
    v_cvt_pk_bf16_f32 v116, v116, v117
    v_cvt_pk_bf16_f32 v118, v118, v119
    v_mfma_f32_16x16x32_bf16 v[16:19], a[80:83], v[48:51], v[16:19]
    s_waitcnt lgkmcnt(2)
    v_cvt_pk_bf16_f32 v120, v120, v121
    v_cvt_pk_bf16_f32 v122, v122, v123
    v_mfma_f32_16x16x32_bf16 v[8:11], a[84:87], v[52:55], v[8:11]
    ds_read_b128 v[48:51], v2 offset:10240
    v_pk_max_i16 v92, v116, 0
    v_mfma_f32_16x16x32_bf16 v[12:15], a[88:91], v[52:55], v[12:15]
    buffer_load_dwordx4 v1, s[8:11], s37 offen offset:3072 sc1 lds
    v_mfma_f32_16x16x32_bf16 v[16:19], a[92:95], v[52:55], v[16:19]
    s_waitcnt lgkmcnt(2)
    s_add_u32 m0, s34, 8192
    s_add_u32 s37, s33, 8192
    v_mfma_f32_16x16x32_bf16 v[8:11], a[96:99], v[40:43], v[8:11]
    ds_read_b128 v[52:55], v2 offset:11264
    v_pk_max_i16 v93, v118, 0
    v_mfma_f32_16x16x32_bf16 v[12:15], a[100:103], v[40:43], v[12:15]
    v_pk_max_i16 v94, v120, 0
    v_pk_max_i16 v95, v122, 0
    v_mfma_f32_16x16x32_bf16 v[16:19], a[104:107], v[40:43], v[16:19]
    s_waitcnt lgkmcnt(2)
    buffer_store_dwordx4 v[92:95], v1, s[12:15], s36 offen sc1
    v_fma_f32 v124, v32, v21, v88
    v_mfma_f32_16x16x32_bf16 v[8:11], a[108:111], v[44:47], v[8:11]
    ds_read_b128 v[40:43], v2 offset:12288
    v_fma_f32 v125, v33, v21, v89
    v_mfma_f32_16x16x32_bf16 v[12:15], a[112:115], v[44:47], v[12:15]
    v_sub_u32 v100, v2, v20
    v_fma_f32 v126, v34, v21, v90
    v_mfma_f32_16x16x32_bf16 v[16:19], a[116:119], v[44:47], v[16:19]
    s_waitcnt lgkmcnt(2)
    ds_read2st64_b64 v[112:115], v100 offset0:70 offset1:71
    v_mfma_f32_16x16x32_bf16 v[8:11], a[120:123], v[48:51], v[8:11]
    ds_read_b128 v[44:47], v2 offset:13312
    v_fma_f32 v127, v35, v21, v91
    v_mfma_f32_16x16x32_bf16 v[12:15], a[124:127], v[48:51], v[12:15]
    buffer_load_dwordx4 v1, s[8:11], s37 offen offset:0 sc1 lds
    v_mfma_f32_16x16x32_bf16 v[16:19], a[128:131], v[48:51], v[16:19]
    s_waitcnt lgkmcnt(3)
    ds_read2st64_b64 v[108:111], v100 offset0:68 offset1:69
    v_mfma_f32_16x16x32_bf16 v[8:11], a[132:135], v[52:55], v[8:11]
    ds_read_b128 v[48:51], v2 offset:14336
    v_mul_f32 v124, v124, |v124|
    v_mfma_f32_16x16x32_bf16 v[12:15], a[136:139], v[52:55], v[12:15]
    ds_read2st64_b64 v[104:107], v100 offset0:66 offset1:67
    v_mul_f32 v125, v125, |v125|
    v_mfma_f32_16x16x32_bf16 v[16:19], a[140:143], v[52:55], v[16:19]
    s_waitcnt lgkmcnt(5)
    ds_read2st64_b64 v[100:103], v100 offset0:64 offset1:65
    v_mfma_f32_16x16x32_bf16 v[8:11], a[144:147], v[40:43], v[8:11]
    ds_read_b128 v[52:55], v2 offset:15360
    v_mul_f32 v126, v126, |v126|
    v_mfma_f32_16x16x32_bf16 v[12:15], a[148:151], v[40:43], v[12:15]
    v_mul_f32 v127, v127, |v127|
    v_cvt_pk_bf16_f32 v124, v124, v125
    v_mfma_f32_16x16x32_bf16 v[16:19], a[152:155], v[40:43], v[16:19]
    s_waitcnt lgkmcnt(5)
    v_cvt_pk_bf16_f32 v126, v126, v127
    v_pk_max_i16 v96, v124, 0
    v_mfma_f32_16x16x32_bf16 v[8:11], a[156:159], v[44:47], v[8:11]
    ds_read_b128 v[40:43], v2 offset:16384
    v_pk_max_i16 v97, v126, 0
    v_mfma_f32_16x16x32_bf16 v[12:15], a[160:163], v[44:47], v[12:15]
    v_pk_max_i16 v98, v124, 0
    v_pk_max_i16 v99, v126, 0
    v_mfma_f32_16x16x32_bf16 v[16:19], a[164:167], v[44:47], v[16:19]
    s_waitcnt lgkmcnt(4)
    v_permlane32_swap_b32 v96, v98
    v_mfma_f32_16x16x32_bf16 v[8:11], a[168:171], v[48:51], v[8:11]
    ds_read_b128 v[44:47], v2 offset:17408
    v_add_u32 v3, s35, v1
    v_mfma_f32_16x16x32_bf16 v[12:15], a[172:175], v[48:51], v[12:15]
    v_permlane32_swap_b32 v97, v99
    v_mfma_f32_16x16x32_bf16 v[16:19], a[176:179], v[48:51], v[16:19]
    s_waitcnt lgkmcnt(2)
    buffer_store_dwordx4 v[96:99], v7, s[12:15], s36 offen sc1
    s_add_u32 s36, s36, 116736
    v_mfma_f32_16x16x32_bf16 v[8:11], a[180:183], v[52:55], v[8:11]
    ds_read_b128 v[48:51], v2 offset:18432
    v_add_f32 v100, v100, v108
    v_mfma_f32_16x16x32_bf16 v[12:15], a[184:187], v[52:55], v[12:15]
    v_add_f32 v101, v101, v109
    v_add_f32 v102, v102, v110
    v_mfma_f32_16x16x32_bf16 v[16:19], a[188:191], v[52:55], v[16:19]
    s_waitcnt lgkmcnt(2)
    v_add_f32 v103, v103, v111
    v_add_f32 v104, v104, v112
    v_mfma_f32_16x16x32_bf16 v[8:11], a[192:195], v[40:43], v[8:11]
    ds_read_b128 v[52:55], v2 offset:19456
    v_add_f32 v105, v105, v113
    v_mfma_f32_16x16x32_bf16 v[12:15], a[196:199], v[40:43], v[12:15]
    v_add_f32 v106, v106, v114
    v_add_f32 v107, v107, v115
    v_mfma_f32_16x16x32_bf16 v[16:19], a[200:203], v[40:43], v[16:19]
    s_waitcnt lgkmcnt(2)
    v_add_f32 v100, v100, v104
    v_add_f32 v101, v101, v105
    v_mfma_f32_16x16x32_bf16 v[8:11], a[204:207], v[44:47], v[8:11]
    ds_read_b128 v[40:43], v2 offset:20480
    v_add_f32 v102, v102, v106
    v_mfma_f32_16x16x32_bf16 v[12:15], a[208:211], v[44:47], v[12:15]
    v_add_f32 v103, v103, v107
    v_add_f32 v100, v100, v102
    v_mfma_f32_16x16x32_bf16 v[16:19], a[212:215], v[44:47], v[16:19]
    s_waitcnt lgkmcnt(2)
    v_add_f32 v101, v101, v103
    v_mfma_f32_16x16x32_bf16 v[8:11], a[216:219], v[48:51], v[8:11]
    ds_read_b128 v[44:47], v2 offset:21504
    v_mfma_f32_16x16x32_bf16 v[12:15], a[220:223], v[48:51], v[12:15]
    v_permlane16_swap_b32 v100, v101
    v_mfma_f32_16x16x32_bf16 v[16:19], a[224:227], v[48:51], v[16:19]
    s_waitcnt lgkmcnt(2)
    v_add_f32 v100, v100, v101
    v_mov_b32 v101, v100
    v_mfma_f32_16x16x32_bf16 v[8:11], a[228:231], v[52:55], v[8:11]
    ds_read_b128 v[48:51], v2 offset:22528
    v_mfma_f32_16x16x32_bf16 v[12:15], a[232:235], v[52:55], v[12:15]
    v_permlane32_swap_b32 v100, v101
    v_mfma_f32_16x16x32_bf16 v[16:19], a[236:239], v[52:55], v[16:19]
    s_waitcnt lgkmcnt(2)
    v_add_f32 v100, v100, v101
    v_mul_f32 v100, 0x3a800000, v100
    v_mfma_f32_16x16x32_bf16 v[8:11], a[240:243], v[40:43], v[8:11]
    ds_read_b128 v[52:55], v2 offset:23552
    v_mov_b32 v101, v100
    v_mfma_f32_16x16x32_bf16 v[12:15], a[244:247], v[40:43], v[12:15]
    v_mfma_f32_16x16x32_bf16 v[16:19], a[248:251], v[40:43], v[16:19]
    s_waitcnt lgkmcnt(2)
    v_permlane16_swap_b32 v100, v101
    v_mfma_f32_16x16x32_bf16 v[8:11], a[252:255], v[44:47], v[8:11]
    ds_read_b128 v[40:43], v2 offset:24576
    v_fma_f32 v101, -v100, v100, v101
    v_mfma_f32_16x16x32_bf16 v[12:15], v[128:131], v[44:47], v[12:15]
    s_add_u32 s32, s32, 1
    s_add_u32 s33, s33, 36864
    s_add_u32 s34, s34, 36864
    v_mfma_f32_16x16x32_bf16 v[16:19], v[132:135], v[44:47], v[16:19]
    s_waitcnt lgkmcnt(2)
    s_cmp_ge_u32 s34, 147456
    s_cselect_b32 s38, 147456, 0
    v_mfma_f32_16x16x32_bf16 v[8:11], v[136:139], v[48:51], v[8:11]
    ds_read_b128 v[44:47], v2 offset:25600
    s_sub_u32 s34, s34, s38
    v_mfma_f32_16x16x32_bf16 v[12:15], v[140:143], v[48:51], v[12:15]
    v_max_f32 v101, 0, v101
    v_add_f32 v101, 0x3727c5ac, v101
    v_mfma_f32_16x16x32_bf16 v[16:19], v[144:147], v[48:51], v[16:19]
    s_waitcnt lgkmcnt(2)
    v_rsq_f32 v21, v101
    v_mfma_f32_16x16x32_bf16 v[8:11], v[148:151], v[52:55], v[8:11]
    ds_read_b128 v[48:51], v2 offset:26624
    v_mul_f32 v100, v100, v21
    v_mfma_f32_16x16x32_bf16 v[12:15], v[152:155], v[52:55], v[12:15]
    v_fma_f32 v80, -v100, v56, v68
    v_fma_f32 v81, -v100, v57, v69
    v_mfma_f32_16x16x32_bf16 v[16:19], v[156:159], v[52:55], v[16:19]
    s_waitcnt lgkmcnt(2)
    v_fma_f32 v82, -v100, v58, v70
    v_fma_f32 v83, -v100, v59, v71
    v_mfma_f32_16x16x32_bf16 v[8:11], v[160:163], v[40:43], v[8:11]
    ds_read_b128 v[52:55], v2 offset:27648
    s_waitcnt vmcnt(5)
    v_mfma_f32_16x16x32_bf16 v[12:15], v[164:167], v[40:43], v[12:15]
    v_cmp_gt_i32 vcc, s32, v5
    v_fma_f32 v84, -v100, v60, v72
    v_mfma_f32_16x16x32_bf16 v[16:19], v[168:171], v[40:43], v[16:19]
    s_waitcnt lgkmcnt(2)
    v_fma_f32 v85, -v100, v61, v73
    v_fma_f32 v86, -v100, v62, v74
    v_mfma_f32_16x16x32_bf16 v[8:11], v[172:175], v[44:47], v[8:11]
    ds_read_b128 v[40:43], v2 offset:28672
    v_fma_f32 v87, -v100, v63, v75
    v_mfma_f32_16x16x32_bf16 v[12:15], v[176:179], v[44:47], v[12:15]
    s_and_b64 vcc, vcc, s[18:19]
    s_cselect_b32 s10, 0, s6
    s_add_u32 m0, s34, 0
    v_mfma_f32_16x16x32_bf16 v[16:19], v[180:183], v[44:47], v[16:19]
    s_waitcnt lgkmcnt(2)
    buffer_load_dwordx4 v1, s[8:11], s33 offen offset:0 sc1 lds
    v_mfma_f32_16x16x32_bf16 v[8:11], v[184:187], v[48:51], v[8:11]
    ds_read_b128 v[44:47], v2 offset:29696
    v_fma_f32 v88, -v100, v64, v76
    v_mfma_f32_16x16x32_bf16 v[12:15], v[188:191], v[48:51], v[12:15]
    v_fma_f32 v89, -v100, v65, v77
    v_fma_f32 v90, -v100, v66, v78
    v_mfma_f32_16x16x32_bf16 v[16:19], v[192:195], v[48:51], v[16:19]
    s_waitcnt lgkmcnt(2)
    v_fma_f32 v91, -v100, v67, v79
    v_mfma_f32_16x16x32_bf16 v[8:11], v[196:199], v[52:55], v[8:11]
    ds_read_b128 v[48:51], v2 offset:30720
    v_mfma_f32_16x16x32_bf16 v[12:15], v[200:203], v[52:55], v[12:15]
    buffer_load_dwordx4 v1, s[8:11], s33 offen offset:1024 sc1 lds
    v_mfma_f32_16x16x32_bf16 v[16:19], v[204:207], v[52:55], v[16:19]
    s_waitcnt lgkmcnt(2)
    s_waitcnt vmcnt(3)
    v_mfma_f32_16x16x32_bf16 v[8:11], v[208:211], v[40:43], v[8:11]
    ds_read_b128 v[52:55], v2 offset:31744
    v_mfma_f32_16x16x32_bf16 v[12:15], v[212:215], v[40:43], v[12:15]
    s_barrier
    v_mfma_f32_16x16x32_bf16 v[16:19], v[216:219], v[40:43], v[16:19]
    s_waitcnt lgkmcnt(2)
    buffer_load_dwordx4 v1, s[8:11], s33 offen offset:2048 sc1 lds
    v_mfma_f32_16x16x32_bf16 v[8:11], v[220:223], v[44:47], v[8:11]
    ds_read_b128 v[40:43], v3 offset:0
    v_mfma_f32_16x16x32_bf16 v[12:15], v[224:227], v[44:47], v[12:15]
    v_mfma_f32_16x16x32_bf16 v[16:19], v[228:231], v[44:47], v[16:19]
    s_waitcnt lgkmcnt(2)
    v_mfma_f32_16x16x32_bf16 v[8:11], v[232:235], v[48:51], v[8:11]
    ds_read_b128 v[44:47], v3 offset:1024
    s_waitcnt vmcnt(3)
    v_mfma_f32_16x16x32_bf16 v[12:15], v[236:239], v[48:51], v[12:15]
    buffer_load_dwordx4 v1, s[8:11], s33 offen offset:3072 sc1 lds
    v_mfma_f32_16x16x32_bf16 v[16:19], v[240:243], v[48:51], v[16:19]
    s_waitcnt lgkmcnt(2)
    buffer_store_dword v6, v22, s[12:15], s17 offen sc1
    v_mfma_f32_16x16x32_bf16 v[8:11], v[244:247], v[52:55], v[8:11]
    ds_read_b128 v[48:51], v3 offset:2048
    s_mov_b32 s14, s6
    v_mfma_f32_16x16x32_bf16 v[12:15], v[248:251], v[52:55], v[12:15]
    s_add_u32 s17, s17, 8192
    v_mfma_f32_16x16x32_bf16 v[16:19], v[252:255], v[52:55], v[16:19]
Lffa_body1:
    s_waitcnt lgkmcnt(2)
    v_mfma_f32_16x16x32_bf16 v[24:27], a[0:3], v[40:43], 0
    ds_read_b128 v[52:55], v3 offset:3072
    s_add_u32 s16, s16, 8192
    v_mfma_f32_16x16x32_bf16 v[28:31], a[4:7], v[40:43], 0
    s_cmp_eq_u32 s10, 0
    s_cbranch_scc1 Lffa_slow1
    v_mfma_f32_16x16x32_bf16 v[32:35], a[8:11], v[40:43], 0
    s_waitcnt lgkmcnt(2)
    s_add_u32 m0, s34, 4096
    s_add_u32 s37, s33, 4096
    v_mfma_f32_16x16x32_bf16 v[24:27], a[12:15], v[44:47], v[24:27]
    ds_read_b128 v[40:43], v3 offset:4096
    v_fma_f32 v116, v8, v21, v80
    v_mfma_f32_16x16x32_bf16 v[28:31], a[16:19], v[44:47], v[28:31]
    buffer_load_dwordx4 v1, s[8:11], s37 offen offset:0 sc1 lds
    v_mfma_f32_16x16x32_bf16 v[32:35], a[20:23], v[44:47], v[32:35]
    s_waitcnt lgkmcnt(2)
    v_fma_f32 v117, v9, v21, v81
    v_fma_f32 v118, v10, v21, v82
    v_mfma_f32_16x16x32_bf16 v[24:27], a[24:27], v[48:51], v[24:27]
    ds_read_b128 v[44:47], v3 offset:5120
    v_fma_f32 v119, v11, v21, v83
    v_mfma_f32_16x16x32_bf16 v[28:31], a[28:31], v[48:51], v[28:31]
    s_add_u32 s31, s31, 1
    v_mov_b32 v6, s31
    v_fma_f32 v120, v12, v21, v84
    v_mfma_f32_16x16x32_bf16 v[32:35], a[32:35], v[48:51], v[32:35]
    s_waitcnt lgkmcnt(2)
    buffer_load_dwordx4 v1, s[8:11], s37 offen offset:1024 sc1 lds
    v_mfma_f32_16x16x32_bf16 v[24:27], a[36:39], v[52:55], v[24:27]
    ds_read_b128 v[48:51], v3 offset:6144
    v_fma_f32 v121, v13, v21, v85
    v_mfma_f32_16x16x32_bf16 v[28:31], a[40:43], v[52:55], v[28:31]
    s_add_u32 s35, s35, 36864
    v_fma_f32 v122, v14, v21, v86
    v_fma_f32 v123, v15, v21, v87
    v_mfma_f32_16x16x32_bf16 v[32:35], a[44:47], v[52:55], v[32:35]
    s_waitcnt lgkmcnt(2)
    v_mul_f32 v116, v116, |v116|
    v_mul_f32 v117, v117, |v117|
    v_mfma_f32_16x16x32_bf16 v[24:27], a[48:51], v[40:43], v[24:27]
    ds_read_b128 v[52:55], v3 offset:7168
    v_mul_f32 v118, v118, |v118|
    v_mfma_f32_16x16x32_bf16 v[28:31], a[52:55], v[40:43], v[28:31]
    buffer_load_dword v5, v4, s[4:7], s16 offen sc1
    v_mfma_f32_16x16x32_bf16 v[32:35], a[56:59], v[40:43], v[32:35]
    s_waitcnt lgkmcnt(2)
    v_mul_f32 v119, v119, |v119|
    v_mul_f32 v120, v120, |v120|
    v_mfma_f32_16x16x32_bf16 v[24:27], a[60:63], v[44:47], v[24:27]
    ds_read_b128 v[40:43], v3 offset:8192
    v_mul_f32 v121, v121, |v121|
    v_mfma_f32_16x16x32_bf16 v[28:31], a[64:67], v[44:47], v[28:31]
    s_cmp_eq_u32 s35, 147456
    s_cselect_b32 s35, 0, s35
    v_mul_f32 v122, v122, |v122|
    v_mfma_f32_16x16x32_bf16 v[32:35], a[68:71], v[44:47], v[32:35]
    s_waitcnt lgkmcnt(2)
    buffer_load_dwordx4 v1, s[8:11], s37 offen offset:2048 sc1 lds
    v_mfma_f32_16x16x32_bf16 v[24:27], a[72:75], v[48:51], v[24:27]
    ds_read_b128 v[44:47], v3 offset:9216
    v_mul_f32 v123, v123, |v123|
    v_mfma_f32_16x16x32_bf16 v[28:31], a[76:79], v[48:51], v[28:31]
    v_cvt_pk_bf16_f32 v116, v116, v117
    v_cvt_pk_bf16_f32 v118, v118, v119
    v_mfma_f32_16x16x32_bf16 v[32:35], a[80:83], v[48:51], v[32:35]
    s_waitcnt lgkmcnt(2)
    v_cvt_pk_bf16_f32 v120, v120, v121
    v_cvt_pk_bf16_f32 v122, v122, v123
    v_mfma_f32_16x16x32_bf16 v[24:27], a[84:87], v[52:55], v[24:27]
    ds_read_b128 v[48:51], v3 offset:10240
    v_pk_max_i16 v92, v116, 0
    v_mfma_f32_16x16x32_bf16 v[28:31], a[88:91], v[52:55], v[28:31]
    buffer_load_dwordx4 v1, s[8:11], s37 offen offset:3072 sc1 lds
    v_mfma_f32_16x16x32_bf16 v[32:35], a[92:95], v[52:55], v[32:35]
    s_waitcnt lgkmcnt(2)
    s_add_u32 m0, s34, 8192
    s_add_u32 s37, s33, 8192
    v_mfma_f32_16x16x32_bf16 v[24:27], a[96:99], v[40:43], v[24:27]
    ds_read_b128 v[52:55], v3 offset:11264
    v_pk_max_i16 v93, v118, 0
    v_mfma_f32_16x16x32_bf16 v[28:31], a[100:103], v[40:43], v[28:31]
    v_pk_max_i16 v94, v120, 0
    v_pk_max_i16 v95, v122, 0
    v_mfma_f32_16x16x32_bf16 v[32:35], a[104:107], v[40:43], v[32:35]
    s_waitcnt lgkmcnt(2)
    buffer_store_dwordx4 v[92:95], v1, s[12:15], s36 offen sc1
    v_fma_f32 v124, v16, v21, v88
    v_mfma_f32_16x16x32_bf16 v[24:27], a[108:111], v[44:47], v[24:27]
    ds_read_b128 v[40:43], v3 offset:12288
    v_fma_f32 v125, v17, v21, v89
    v_mfma_f32_16x16x32_bf16 v[28:31], a[112:115], v[44:47], v[28:31]
    v_sub_u32 v100, v3, v20
    v_fma_f32 v126, v18, v21, v90
    v_mfma_f32_16x16x32_bf16 v[32:35], a[116:119], v[44:47], v[32:35]
    s_waitcnt lgkmcnt(2)
    ds_read2st64_b64 v[112:115], v100 offset0:70 offset1:71
    v_mfma_f32_16x16x32_bf16 v[24:27], a[120:123], v[48:51], v[24:27]
    ds_read_b128 v[44:47], v3 offset:13312
    v_fma_f32 v127, v19, v21, v91
    v_mfma_f32_16x16x32_bf16 v[28:31], a[124:127], v[48:51], v[28:31]
    buffer_load_dwordx4 v1, s[8:11], s37 offen offset:0 sc1 lds
    v_mfma_f32_16x16x32_bf16 v[32:35], a[128:131], v[48:51], v[32:35]
    s_waitcnt lgkmcnt(3)
    ds_read2st64_b64 v[108:111], v100 offset0:68 offset1:69
    v_mfma_f32_16x16x32_bf16 v[24:27], a[132:135], v[52:55], v[24:27]
    ds_read_b128 v[48:51], v3 offset:14336
    v_mul_f32 v124, v124, |v124|
    v_mfma_f32_16x16x32_bf16 v[28:31], a[136:139], v[52:55], v[28:31]
    ds_read2st64_b64 v[104:107], v100 offset0:66 offset1:67
    v_mul_f32 v125, v125, |v125|
    v_mfma_f32_16x16x32_bf16 v[32:35], a[140:143], v[52:55], v[32:35]
    s_waitcnt lgkmcnt(5)
    ds_read2st64_b64 v[100:103], v100 offset0:64 offset1:65
    v_mfma_f32_16x16x32_bf16 v[24:27], a[144:147], v[40:43], v[24:27]
    ds_read_b128 v[52:55], v3 offset:15360
    v_mul_f32 v126, v126, |v126|
    v_mfma_f32_16x16x32_bf16 v[28:31], a[148:151], v[40:43], v[28:31]
    v_mul_f32 v127, v127, |v127|
    v_cvt_pk_bf16_f32 v124, v124, v125
    v_mfma_f32_16x16x32_bf16 v[32:35], a[152:155], v[40:43], v[32:35]
    s_waitcnt lgkmcnt(5)
    v_cvt_pk_bf16_f32 v126, v126, v127
    v_pk_max_i16 v96, v124, 0
    v_mfma_f32_16x16x32_bf16 v[24:27], a[156:159], v[44:47], v[24:27]
    ds_read_b128 v[40:43], v3 offset:16384
    v_pk_max_i16 v97, v126, 0
    v_mfma_f32_16x16x32_bf16 v[28:31], a[160:163], v[44:47], v[28:31]
    v_pk_max_i16 v98, v124, 0
    v_pk_max_i16 v99, v126, 0
    v_mfma_f32_16x16x32_bf16 v[32:35], a[164:167], v[44:47], v[32:35]
    s_waitcnt lgkmcnt(4)
    v_permlane32_swap_b32 v96, v98
    v_mfma_f32_16x16x32_bf16 v[24:27], a[168:171], v[48:51], v[24:27]
    ds_read_b128 v[44:47], v3 offset:17408
    v_add_u32 v2, s35, v1
    v_mfma_f32_16x16x32_bf16 v[28:31], a[172:175], v[48:51], v[28:31]
    v_permlane32_swap_b32 v97, v99
    v_mfma_f32_16x16x32_bf16 v[32:35], a[176:179], v[48:51], v[32:35]
    s_waitcnt lgkmcnt(2)
    buffer_store_dwordx4 v[96:99], v7, s[12:15], s36 offen sc1
    s_add_u32 s36, s36, 116736
    v_mfma_f32_16x16x32_bf16 v[24:27], a[180:183], v[52:55], v[24:27]
    ds_read_b128 v[48:51], v3 offset:18432
    v_add_f32 v100, v100, v108
    v_mfma_f32_16x16x32_bf16 v[28:31], a[184:187], v[52:55], v[28:31]
    v_add_f32 v101, v101, v109
    v_add_f32 v102, v102, v110
    v_mfma_f32_16x16x32_bf16 v[32:35], a[188:191], v[52:55], v[32:35]
    s_waitcnt lgkmcnt(2)
    v_add_f32 v103, v103, v111
    v_add_f32 v104, v104, v112
    v_mfma_f32_16x16x32_bf16 v[24:27], a[192:195], v[40:43], v[24:27]
    ds_read_b128 v[52:55], v3 offset:19456
    v_add_f32 v105, v105, v113
    v_mfma_f32_16x16x32_bf16 v[28:31], a[196:199], v[40:43], v[28:31]
    v_add_f32 v106, v106, v114
    v_add_f32 v107, v107, v115
    v_mfma_f32_16x16x32_bf16 v[32:35], a[200:203], v[40:43], v[32:35]
    s_waitcnt lgkmcnt(2)
    v_add_f32 v100, v100, v104
    v_add_f32 v101, v101, v105
    v_mfma_f32_16x16x32_bf16 v[24:27], a[204:207], v[44:47], v[24:27]
    ds_read_b128 v[40:43], v3 offset:20480
    v_add_f32 v102, v102, v106
    v_mfma_f32_16x16x32_bf16 v[28:31], a[208:211], v[44:47], v[28:31]
    v_add_f32 v103, v103, v107
    v_add_f32 v100, v100, v102
    v_mfma_f32_16x16x32_bf16 v[32:35], a[212:215], v[44:47], v[32:35]
    s_waitcnt lgkmcnt(2)
    v_add_f32 v101, v101, v103
    v_mfma_f32_16x16x32_bf16 v[24:27], a[216:219], v[48:51], v[24:27]
    ds_read_b128 v[44:47], v3 offset:21504
    v_mfma_f32_16x16x32_bf16 v[28:31], a[220:223], v[48:51], v[28:31]
    v_permlane16_swap_b32 v100, v101
    v_mfma_f32_16x16x32_bf16 v[32:35], a[224:227], v[48:51], v[32:35]
    s_waitcnt lgkmcnt(2)
    v_add_f32 v100, v100, v101
    v_mov_b32 v101, v100
    v_mfma_f32_16x16x32_bf16 v[24:27], a[228:231], v[52:55], v[24:27]
    ds_read_b128 v[48:51], v3 offset:22528
    v_mfma_f32_16x16x32_bf16 v[28:31], a[232:235], v[52:55], v[28:31]
    v_permlane32_swap_b32 v100, v101
    v_mfma_f32_16x16x32_bf16 v[32:35], a[236:239], v[52:55], v[32:35]
    s_waitcnt lgkmcnt(2)
    v_add_f32 v100, v100, v101
    v_mul_f32 v100, 0x3a800000, v100
    v_mfma_f32_16x16x32_bf16 v[24:27], a[240:243], v[40:43], v[24:27]
    ds_read_b128 v[52:55], v3 offset:23552
    v_mov_b32 v101, v100
    v_mfma_f32_16x16x32_bf16 v[28:31], a[244:247], v[40:43], v[28:31]
    v_mfma_f32_16x16x32_bf16 v[32:35], a[248:251], v[40:43], v[32:35]
    s_waitcnt lgkmcnt(2)
    v_permlane16_swap_b32 v100, v101
    v_mfma_f32_16x16x32_bf16 v[24:27], a[252:255], v[44:47], v[24:27]
    ds_read_b128 v[40:43], v3 offset:24576
    v_fma_f32 v101, -v100, v100, v101
    v_mfma_f32_16x16x32_bf16 v[28:31], v[128:131], v[44:47], v[28:31]
    s_add_u32 s32, s32, 1
    s_add_u32 s33, s33, 36864
    s_add_u32 s34, s34, 36864
    v_mfma_f32_16x16x32_bf16 v[32:35], v[132:135], v[44:47], v[32:35]
    s_waitcnt lgkmcnt(2)
    s_cmp_ge_u32 s34, 147456
    s_cselect_b32 s38, 147456, 0
    v_mfma_f32_16x16x32_bf16 v[24:27], v[136:139], v[48:51], v[24:27]
    ds_read_b128 v[44:47], v3 offset:25600
    s_sub_u32 s34, s34, s38
    v_mfma_f32_16x16x32_bf16 v[28:31], v[140:143], v[48:51], v[28:31]
    v_max_f32 v101, 0, v101
    v_add_f32 v101, 0x3727c5ac, v101
    v_mfma_f32_16x16x32_bf16 v[32:35], v[144:147], v[48:51], v[32:35]
    s_waitcnt lgkmcnt(2)
    v_rsq_f32 v21, v101
    v_mfma_f32_16x16x32_bf16 v[24:27], v[148:151], v[52:55], v[24:27]
    ds_read_b128 v[48:51], v3 offset:26624
    v_mul_f32 v100, v100, v21
    v_mfma_f32_16x16x32_bf16 v[28:31], v[152:155], v[52:55], v[28:31]
    v_fma_f32 v80, -v100, v56, v68
    v_fma_f32 v81, -v100, v57, v69
    v_mfma_f32_16x16x32_bf16 v[32:35], v[156:159], v[52:55], v[32:35]
    s_waitcnt lgkmcnt(2)
    v_fma_f32 v82, -v100, v58, v70
    v_fma_f32 v83, -v100, v59, v71
    v_mfma_f32_16x16x32_bf16 v[24:27], v[160:163], v[40:43], v[24:27]
    ds_read_b128 v[52:55], v3 offset:27648
    s_waitcnt vmcnt(5)
    v_mfma_f32_16x16x32_bf16 v[28:31], v[164:167], v[40:43], v[28:31]
    v_cmp_gt_i32 vcc, s32, v5
    v_fma_f32 v84, -v100, v60, v72
    v_mfma_f32_16x16x32_bf16 v[32:35], v[168:171], v[40:43], v[32:35]
    s_waitcnt lgkmcnt(2)
    v_fma_f32 v85, -v100, v61, v73
    v_fma_f32 v86, -v100, v62, v74
    v_mfma_f32_16x16x32_bf16 v[24:27], v[172:175], v[44:47], v[24:27]
    ds_read_b128 v[40:43], v3 offset:28672
    v_fma_f32 v87, -v100, v63, v75
    v_mfma_f32_16x16x32_bf16 v[28:31], v[176:179], v[44:47], v[28:31]
    s_and_b64 vcc, vcc, s[18:19]
    s_cselect_b32 s10, 0, s6
    s_add_u32 m0, s34, 0
    v_mfma_f32_16x16x32_bf16 v[32:35], v[180:183], v[44:47], v[32:35]
    s_waitcnt lgkmcnt(2)
    buffer_load_dwordx4 v1, s[8:11], s33 offen offset:0 sc1 lds
    v_mfma_f32_16x16x32_bf16 v[24:27], v[184:187], v[48:51], v[24:27]
    ds_read_b128 v[44:47], v3 offset:29696
    v_fma_f32 v88, -v100, v64, v76
    v_mfma_f32_16x16x32_bf16 v[28:31], v[188:191], v[48:51], v[28:31]
    v_fma_f32 v89, -v100, v65, v77
    v_fma_f32 v90, -v100, v66, v78
    v_mfma_f32_16x16x32_bf16 v[32:35], v[192:195], v[48:51], v[32:35]
    s_waitcnt lgkmcnt(2)
    v_fma_f32 v91, -v100, v67, v79
    v_mfma_f32_16x16x32_bf16 v[24:27], v[196:199], v[52:55], v[24:27]
    ds_read_b128 v[48:51], v3 offset:30720
    v_mfma_f32_16x16x32_bf16 v[28:31], v[200:203], v[52:55], v[28:31]
    buffer_load_dwordx4 v1, s[8:11], s33 offen offset:1024 sc1 lds
    v_mfma_f32_16x16x32_bf16 v[32:35], v[204:207], v[52:55], v[32:35]
    s_waitcnt lgkmcnt(2)
    s_waitcnt vmcnt(3)
    v_mfma_f32_16x16x32_bf16 v[24:27], v[208:211], v[40:43], v[24:27]
    ds_read_b128 v[52:55], v3 offset:31744
    v_mfma_f32_16x16x32_bf16 v[28:31], v[212:215], v[40:43], v[28:31]
    s_barrier
    v_mfma_f32_16x16x32_bf16 v[32:35], v[216:219], v[40:43], v[32:35]
    s_waitcnt lgkmcnt(2)
    buffer_load_dwordx4 v1, s[8:11], s33 offen offset:2048 sc1 lds
    v_mfma_f32_16x16x32_bf16 v[24:27], v[220:223], v[44:47], v[24:27]
    ds_read_b128 v[40:43], v2 offset:0
    v_mfma_f32_16x16x32_bf16 v[28:31], v[224:227], v[44:47], v[28:31]
    v_mfma_f32_16x16x32_bf16 v[32:35], v[228:231], v[44:47], v[32:35]
    s_waitcnt lgkmcnt(2)
    v_mfma_f32_16x16x32_bf16 v[24:27], v[232:235], v[48:51], v[24:27]
    ds_read_b128 v[44:47], v2 offset:1024
    s_waitcnt vmcnt(3)
    v_mfma_f32_16x16x32_bf16 v[28:31], v[236:239], v[48:51], v[28:31]
    buffer_load_dwordx4 v1, s[8:11], s33 offen offset:3072 sc1 lds
    v_mfma_f32_16x16x32_bf16 v[32:35], v[240:243], v[48:51], v[32:35]
    s_waitcnt lgkmcnt(2)
    buffer_store_dword v6, v22, s[12:15], s17 offen sc1
    v_mfma_f32_16x16x32_bf16 v[24:27], v[244:247], v[52:55], v[24:27]
    ds_read_b128 v[48:51], v2 offset:2048
    s_mov_b32 s14, s6
    v_mfma_f32_16x16x32_bf16 v[28:31], v[248:251], v[52:55], v[28:31]
    s_add_u32 s17, s17, 8192
    v_mfma_f32_16x16x32_bf16 v[32:35], v[252:255], v[52:55], v[32:35]
Lffa_back:
    s_cmp_lt_i32 s31, 63
    s_cbranch_scc1 Lffa_body0
    s_branch L_exit
Lffa_slow0:
    s_sub_u32 s39, s16, 8192
    v_mfma_f32_16x16x32_bf16 v[16:19], a[8:11], v[40:43], 0
    s_waitcnt lgkmcnt(2)
    buffer_load_dword v23, v4, s[4:7], s39 offen sc1
    v_mfma_f32_16x16x32_bf16 v[8:11], a[12:15], v[44:47], v[8:11]
    ds_read_b128 v[40:43], v2 offset:4096
    v_fma_f32 v116, v24, v21, v80
    v_mfma_f32_16x16x32_bf16 v[12:15], a[16:19], v[44:47], v[12:15]
    s_add_u32 s31, s31, 1
    v_mov_b32 v6, s31
    v_fma_f32 v117, v25, v21, v81
    v_mfma_f32_16x16x32_bf16 v[16:19], a[20:23], v[44:47], v[16:19]
    s_waitcnt lgkmcnt(2)
    v_fma_f32 v118, v26, v21, v82
    v_fma_f32 v119, v27, v21, v83
    v_mfma_f32_16x16x32_bf16 v[8:11], a[24:27], v[48:51], v[8:11]
    ds_read_b128 v[44:47], v2 offset:5120
    v_fma_f32 v120, v28, v21, v84
    v_mfma_f32_16x16x32_bf16 v[12:15], a[28:31], v[48:51], v[12:15]
    s_add_u32 s35, s35, 36864
    v_fma_f32 v121, v29, v21, v85
    v_fma_f32 v122, v30, v21, v86
    v_mfma_f32_16x16x32_bf16 v[16:19], a[32:35], v[48:51], v[16:19]
    s_waitcnt lgkmcnt(2)
    v_fma_f32 v123, v31, v21, v87
    v_mul_f32 v116, v116, |v116|
    v_mfma_f32_16x16x32_bf16 v[8:11], a[36:39], v[52:55], v[8:11]
    ds_read_b128 v[48:51], v2 offset:6144
    v_mul_f32 v117, v117, |v117|
    v_mfma_f32_16x16x32_bf16 v[12:15], a[40:43], v[52:55], v[12:15]
    s_cmp_eq_u32 s35, 147456
    s_cselect_b32 s35, 0, s35
    v_mul_f32 v118, v118, |v118|
    v_mfma_f32_16x16x32_bf16 v[16:19], a[44:47], v[52:55], v[16:19]
    s_waitcnt lgkmcnt(2)
    v_mul_f32 v119, v119, |v119|
    v_mul_f32 v120, v120, |v120|
    v_mfma_f32_16x16x32_bf16 v[8:11], a[48:51], v[40:43], v[8:11]
    ds_read_b128 v[52:55], v2 offset:7168
    v_mul_f32 v121, v121, |v121|
    v_mfma_f32_16x16x32_bf16 v[12:15], a[52:55], v[40:43], v[12:15]
    v_mul_f32 v122, v122, |v122|
    v_mul_f32 v123, v123, |v123|
    v_mfma_f32_16x16x32_bf16 v[16:19], a[56:59], v[40:43], v[16:19]
    s_waitcnt lgkmcnt(2)
    v_cvt_pk_bf16_f32 v116, v116, v117
    v_cvt_pk_bf16_f32 v118, v118, v119
    v_mfma_f32_16x16x32_bf16 v[8:11], a[60:63], v[44:47], v[8:11]
    ds_read_b128 v[40:43], v2 offset:8192
    v_cvt_pk_bf16_f32 v120, v120, v121
    v_mfma_f32_16x16x32_bf16 v[12:15], a[64:67], v[44:47], v[12:15]
    v_cvt_pk_bf16_f32 v122, v122, v123
    v_pk_max_i16 v92, v116, 0
    v_mfma_f32_16x16x32_bf16 v[16:19], a[68:71], v[44:47], v[16:19]
    s_waitcnt lgkmcnt(2)
    v_pk_max_i16 v93, v118, 0
    v_pk_max_i16 v94, v120, 0
    v_mfma_f32_16x16x32_bf16 v[8:11], a[72:75], v[48:51], v[8:11]
    ds_read_b128 v[44:47], v2 offset:9216
    v_pk_max_i16 v95, v122, 0
    v_mfma_f32_16x16x32_bf16 v[12:15], a[76:79], v[48:51], v[12:15]
    buffer_store_dwordx4 v[92:95], v1, s[12:15], s36 offen sc1
    v_fma_f32 v124, v32, v21, v88
    v_mfma_f32_16x16x32_bf16 v[16:19], a[80:83], v[48:51], v[16:19]
    s_waitcnt lgkmcnt(2)
    v_fma_f32 v125, v33, v21, v89
    v_fma_f32 v126, v34, v21, v90
    v_mfma_f32_16x16x32_bf16 v[8:11], a[84:87], v[52:55], v[8:11]
    ds_read_b128 v[48:51], v2 offset:10240
    v_fma_f32 v127, v35, v21, v91
    v_mfma_f32_16x16x32_bf16 v[12:15], a[88:91], v[52:55], v[12:15]
    v_mul_f32 v124, v124, |v124|
    v_mul_f32 v125, v125, |v125|
    v_mfma_f32_16x16x32_bf16 v[16:19], a[92:95], v[52:55], v[16:19]
    s_waitcnt lgkmcnt(2)
    v_mul_f32 v126, v126, |v126|
    v_mul_f32 v127, v127, |v127|
    v_mfma_f32_16x16x32_bf16 v[8:11], a[96:99], v[40:43], v[8:11]
    ds_read_b128 v[52:55], v2 offset:11264
    v_cvt_pk_bf16_f32 v124, v124, v125
    v_mfma_f32_16x16x32_bf16 v[12:15], a[100:103], v[40:43], v[12:15]
    v_cvt_pk_bf16_f32 v126, v126, v127
    v_pk_max_i16 v96, v124, 0
    v_mfma_f32_16x16x32_bf16 v[16:19], a[104:107], v[40:43], v[16:19]
    s_waitcnt lgkmcnt(2)
    v_pk_max_i16 v97, v126, 0
    v_pk_max_i16 v98, v124, 0
    v_mfma_f32_16x16x32_bf16 v[8:11], a[108:111], v[44:47], v[8:11]
    ds_read_b128 v[40:43], v2 offset:12288
    v_pk_max_i16 v99, v126, 0
    v_mfma_f32_16x16x32_bf16 v[12:15], a[112:115], v[44:47], v[12:15]
    v_sub_u32 v100, v2, v20
    v_add_u32 v3, s35, v1
    v_mfma_f32_16x16x32_bf16 v[16:19], a[116:119], v[44:47], v[16:19]
    s_waitcnt lgkmcnt(2)
    ds_read2st64_b64 v[112:115], v100 offset0:70 offset1:71
    v_mfma_f32_16x16x32_bf16 v[8:11], a[120:123], v[48:51], v[8:11]
    ds_read_b128 v[44:47], v2 offset:13312
    v_mfma_f32_16x16x32_bf16 v[12:15], a[124:127], v[48:51], v[12:15]
    ds_read2st64_b64 v[108:111], v100 offset0:68 offset1:69
    v_mfma_f32_16x16x32_bf16 v[16:19], a[128:131], v[48:51], v[16:19]
    s_waitcnt lgkmcnt(4)
    s_waitcnt vmcnt(1)
    v_cmp_gt_i32 vcc, s32, v23
    v_mfma_f32_16x16x32_bf16 v[8:11], a[132:135], v[52:55], v[8:11]
    ds_read_b128 v[48:51], v2 offset:14336
    v_mfma_f32_16x16x32_bf16 v[12:15], a[136:139], v[52:55], v[12:15]
    s_and_b64 vcc, vcc, s[18:19]
    s_cselect_b32 s10, 0, s6
    v_mfma_f32_16x16x32_bf16 v[16:19], a[140:143], v[52:55], v[16:19]
    s_waitcnt lgkmcnt(4)
    s_cmp_eq_u32 s10, 0
    s_cbranch_scc1 Lffa_slowc0
    v_mfma_f32_16x16x32_bf16 v[8:11], a[144:147], v[40:43], v[8:11]
    ds_read_b128 v[52:55], v2 offset:15360
    s_add_u32 m0, s34, 0
    v_mfma_f32_16x16x32_bf16 v[12:15], a[148:151], v[40:43], v[12:15]
    buffer_load_dwordx4 v1, s[8:11], s33 offen offset:0 sc1 lds
    v_mfma_f32_16x16x32_bf16 v[16:19], a[152:155], v[40:43], v[16:19]
    s_waitcnt lgkmcnt(3)
    ds_read2st64_b64 v[104:107], v100 offset0:66 offset1:67
    v_mfma_f32_16x16x32_bf16 v[8:11], a[156:159], v[44:47], v[8:11]
    ds_read_b128 v[40:43], v2 offset:16384
    v_mfma_f32_16x16x32_bf16 v[12:15], a[160:163], v[44:47], v[12:15]
    ds_read2st64_b64 v[100:103], v100 offset0:64 offset1:65
    v_mfma_f32_16x16x32_bf16 v[16:19], a[164:167], v[44:47], v[16:19]
    s_waitcnt lgkmcnt(4)
    buffer_load_dwordx4 v1, s[8:11], s33 offen offset:1024 sc1 lds
    v_mfma_f32_16x16x32_bf16 v[8:11], a[168:171], v[48:51], v[8:11]
    ds_read_b128 v[44:47], v2 offset:17408
    v_mfma_f32_16x16x32_bf16 v[12:15], a[172:175], v[48:51], v[12:15]
    v_permlane32_swap_b32 v96, v98
    v_mfma_f32_16x16x32_bf16 v[16:19], a[176:179], v[48:51], v[16:19]
    s_waitcnt lgkmcnt(4)
    v_permlane32_swap_b32 v97, v99
    v_mfma_f32_16x16x32_bf16 v[8:11], a[180:183], v[52:55], v[8:11]
    ds_read_b128 v[48:51], v2 offset:18432
    v_mfma_f32_16x16x32_bf16 v[12:15], a[184:187], v[52:55], v[12:15]
    buffer_store_dwordx4 v[96:99], v7, s[12:15], s36 offen sc1
    s_add_u32 s36, s36, 116736
    v_mfma_f32_16x16x32_bf16 v[16:19], a[188:191], v[52:55], v[16:19]
    s_waitcnt lgkmcnt(3)
    v_mfma_f32_16x16x32_bf16 v[8:11], a[192:195], v[40:43], v[8:11]
    ds_read_b128 v[52:55], v2 offset:19456
    v_mfma_f32_16x16x32_bf16 v[12:15], a[196:199], v[40:43], v[12:15]
    v_mfma_f32_16x16x32_bf16 v[16:19], a[200:203], v[40:43], v[16:19]
    s_waitcnt lgkmcnt(2)
    buffer_load_dword v5, v4, s[4:7], s16 offen sc1
    v_mfma_f32_16x16x32_bf16 v[8:11], a[204:207], v[44:47], v[8:11]
    ds_read_b128 v[40:43], v2 offset:20480
    v_add_f32 v100, v100, v108
    v_mfma_f32_16x16x32_bf16 v[12:15], a[208:211], v[44:47], v[12:15]
    v_add_f32 v101, v101, v109
    v_add_f32 v102, v102, v110
    v_mfma_f32_16x16x32_bf16 v[16:19], a[212:215], v[44:47], v[16:19]
    s_waitcnt lgkmcnt(2)
    v_add_f32 v103, v103, v111
    v_add_f32 v104, v104, v112
    v_mfma_f32_16x16x32_bf16 v[8:11], a[216:219], v[48:51], v[8:11]
    ds_read_b128 v[44:47], v2 offset:21504
    v_add_f32 v105, v105, v113
    v_mfma_f32_16x16x32_bf16 v[12:15], a[220:223], v[48:51], v[12:15]
    buffer_load_dwordx4 v1, s[8:11], s33 offen offset:2048 sc1 lds
    v_mfma_f32_16x16x32_bf16 v[16:19], a[224:227], v[48:51], v[16:19]
    s_waitcnt lgkmcnt(2)
    v_add_f32 v106, v106, v114
    v_add_f32 v107, v107, v115
    v_mfma_f32_16x16x32_bf16 v[8:11], a[228:231], v[52:55], v[8:11]
    ds_read_b128 v[48:51], v2 offset:22528
    v_add_f32 v100, v100, v104
    v_mfma_f32_16x16x32_bf16 v[12:15], a[232:235], v[52:55], v[12:15]
    v_add_f32 v101, v101, v105
    v_add_f32 v102, v102, v106
    v_mfma_f32_16x16x32_bf16 v[16:19], a[236:239], v[52:55], v[16:19]
    s_waitcnt lgkmcnt(2)
    buffer_load_dwordx4 v1, s[8:11], s33 offen offset:3072 sc1 lds
    v_mfma_f32_16x16x32_bf16 v[8:11], a[240:243], v[40:43], v[8:11]
    ds_read_b128 v[52:55], v2 offset:23552
    s_add_u32 m0, s34, 4096
    v_mfma_f32_16x16x32_bf16 v[12:15], a[244:247], v[40:43], v[12:15]
    s_add_u32 s37, s33, 4096
    v_add_f32 v103, v103, v107
    v_add_f32 v100, v100, v102
    v_mfma_f32_16x16x32_bf16 v[16:19], a[248:251], v[40:43], v[16:19]
    s_waitcnt lgkmcnt(2)
    v_add_f32 v101, v101, v103
    v_mfma_f32_16x16x32_bf16 v[8:11], a[252:255], v[44:47], v[8:11]
    ds_read_b128 v[40:43], v2 offset:24576
    v_mfma_f32_16x16x32_bf16 v[12:15], v[128:131], v[44:47], v[12:15]
    buffer_load_dwordx4 v1, s[8:11], s37 offen offset:0 sc1 lds
    v_mfma_f32_16x16x32_bf16 v[16:19], v[132:135], v[44:47], v[16:19]
    s_waitcnt lgkmcnt(2)
    v_permlane16_swap_b32 v100, v101
    v_mfma_f32_16x16x32_bf16 v[8:11], v[136:139], v[48:51], v[8:11]
    ds_read_b128 v[44:47], v2 offset:25600
    v_add_f32 v100, v100, v101
    v_mfma_f32_16x16x32_bf16 v[12:15], v[140:143], v[48:51], v[12:15]
    v_mov_b32 v101, v100
    v_mfma_f32_16x16x32_bf16 v[16:19], v[144:147], v[48:51], v[16:19]
    s_waitcnt lgkmcnt(2)
    buffer_load_dwordx4 v1, s[8:11], s37 offen offset:1024 sc1 lds
    v_mfma_f32_16x16x32_bf16 v[8:11], v[148:151], v[52:55], v[8:11]
    ds_read_b128 v[48:51], v2 offset:26624
    v_mfma_f32_16x16x32_bf16 v[12:15], v[152:155], v[52:55], v[12:15]
    v_permlane32_swap_b32 v100, v101
    v_mfma_f32_16x16x32_bf16 v[16:19], v[156:159], v[52:55], v[16:19]
    s_waitcnt lgkmcnt(2)
    v_add_f32 v100, v100, v101
    v_mul_f32 v100, 0x3a800000, v100
    v_mfma_f32_16x16x32_bf16 v[8:11], v[160:163], v[40:43], v[8:11]
    ds_read_b128 v[52:55], v2 offset:27648
    v_mov_b32 v101, v100
    v_mfma_f32_16x16x32_bf16 v[12:15], v[164:167], v[40:43], v[12:15]
    buffer_load_dwordx4 v1, s[8:11], s37 offen offset:2048 sc1 lds
    v_mfma_f32_16x16x32_bf16 v[16:19], v[168:171], v[40:43], v[16:19]
    s_waitcnt lgkmcnt(2)
    v_permlane16_swap_b32 v100, v101
    v_mfma_f32_16x16x32_bf16 v[8:11], v[172:175], v[44:47], v[8:11]
    ds_read_b128 v[40:43], v2 offset:28672
    v_fma_f32 v101, -v100, v100, v101
    v_mfma_f32_16x16x32_bf16 v[12:15], v[176:179], v[44:47], v[12:15]
    v_max_f32 v101, 0, v101
    v_add_f32 v101, 0x3727c5ac, v101
    v_mfma_f32_16x16x32_bf16 v[16:19], v[180:183], v[44:47], v[16:19]
    s_waitcnt lgkmcnt(2)
    buffer_load_dwordx4 v1, s[8:11], s37 offen offset:3072 sc1 lds
    v_mfma_f32_16x16x32_bf16 v[8:11], v[184:187], v[48:51], v[8:11]
    ds_read_b128 v[44:47], v2 offset:29696
    s_add_u32 m0, s34, 8192
    v_mfma_f32_16x16x32_bf16 v[12:15], v[188:191], v[48:51], v[12:15]
    s_add_u32 s37, s33, 8192
    v_rsq_f32 v21, v101
    v_mfma_f32_16x16x32_bf16 v[16:19], v[192:195], v[48:51], v[16:19]
    s_waitcnt lgkmcnt(2)
    v_mul_f32 v100, v100, v21
    v_fma_f32 v80, -v100, v56, v68
    v_mfma_f32_16x16x32_bf16 v[8:11], v[196:199], v[52:55], v[8:11]
    ds_read_b128 v[48:51], v2 offset:30720
    v_fma_f32 v81, -v100, v57, v69
    v_mfma_f32_16x16x32_bf16 v[12:15], v[200:203], v[52:55], v[12:15]
    buffer_load_dwordx4 v1, s[8:11], s37 offen offset:0 sc1 lds
    v_mfma_f32_16x16x32_bf16 v[16:19], v[204:207], v[52:55], v[16:19]
    s_waitcnt lgkmcnt(2)
    s_waitcnt vmcnt(0)
    s_add_u32 s32, s32, 1
    v_mfma_f32_16x16x32_bf16 v[8:11], v[208:211], v[40:43], v[8:11]
    ds_read_b128 v[52:55], v2 offset:31744
    s_add_u32 s33, s33, 36864
    v_mfma_f32_16x16x32_bf16 v[12:15], v[212:215], v[40:43], v[12:15]
    s_barrier
    v_mfma_f32_16x16x32_bf16 v[16:19], v[216:219], v[40:43], v[16:19]
    s_waitcnt lgkmcnt(2)
    s_add_u32 s34, s34, 36864
    v_fma_f32 v82, -v100, v58, v70
    v_mfma_f32_16x16x32_bf16 v[8:11], v[220:223], v[44:47], v[8:11]
    ds_read_b128 v[40:43], v3 offset:0
    v_fma_f32 v83, -v100, v59, v71
    v_mfma_f32_16x16x32_bf16 v[12:15], v[224:227], v[44:47], v[12:15]
    s_cmp_ge_u32 s34, 147456
    s_cselect_b32 s38, 147456, 0
    s_sub_u32 s34, s34, s38
    v_mfma_f32_16x16x32_bf16 v[16:19], v[228:231], v[44:47], v[16:19]
    s_waitcnt lgkmcnt(2)
    v_cmp_gt_i32 vcc, s32, v5
    v_fma_f32 v84, -v100, v60, v72
    v_mfma_f32_16x16x32_bf16 v[8:11], v[232:235], v[48:51], v[8:11]
    ds_read_b128 v[44:47], v3 offset:1024
    v_fma_f32 v85, -v100, v61, v73
    v_mfma_f32_16x16x32_bf16 v[12:15], v[236:239], v[48:51], v[12:15]
    s_and_b64 vcc, vcc, s[18:19]
    s_cselect_b32 s10, 0, s6
    s_add_u32 m0, s34, 0
    v_mfma_f32_16x16x32_bf16 v[16:19], v[240:243], v[48:51], v[16:19]
    s_waitcnt lgkmcnt(2)
    buffer_load_dwordx4 v1, s[8:11], s33 offen offset:0 sc1 lds
    v_mfma_f32_16x16x32_bf16 v[8:11], v[244:247], v[52:55], v[8:11]
    ds_read_b128 v[48:51], v3 offset:2048
    v_fma_f32 v86, -v100, v62, v74
    v_mfma_f32_16x16x32_bf16 v[12:15], v[248:251], v[52:55], v[12:15]
    buffer_store_dword v6, v22, s[12:15], s17 offen sc1
    v_fma_f32 v87, -v100, v63, v75
    v_mfma_f32_16x16x32_bf16 v[16:19], v[252:255], v[52:55], v[16:19]
    buffer_load_dwordx4 v1, s[8:11], s33 offen offset:1024 sc1 lds
    s_mov_b32 s14, s6
    s_add_u32 s17, s17, 8192
    v_fma_f32 v88, -v100, v64, v76
    v_fma_f32 v89, -v100, v65, v77
    v_fma_f32 v90, -v100, v66, v78
    v_fma_f32 v91, -v100, v67, v79
    buffer_load_dwordx4 v1, s[8:11], s33 offen offset:2048 sc1 lds
    buffer_load_dwordx4 v1, s[8:11], s33 offen offset:3072 sc1 lds
    s_nop 1
    s_branch Lffa_body1
Lffa_slowc0:
    v_mfma_f32_16x16x32_bf16 v[8:11], a[144:147], v[40:43], v[8:11]
    ds_read_b128 v[52:55], v2 offset:15360
    v_mfma_f32_16x16x32_bf16 v[12:15], a[148:151], v[40:43], v[12:15]
    ds_read2st64_b64 v[104:107], v100 offset0:66 offset1:67
    v_mfma_f32_16x16x32_bf16 v[16:19], a[152:155], v[40:43], v[16:19]
    s_waitcnt lgkmcnt(4)
    ds_read2st64_b64 v[100:103], v100 offset0:64 offset1:65
    v_mfma_f32_16x16x32_bf16 v[8:11], a[156:159], v[44:47], v[8:11]
    ds_read_b128 v[40:43], v2 offset:16384
    v_mfma_f32_16x16x32_bf16 v[12:15], a[160:163], v[44:47], v[12:15]
    v_permlane32_swap_b32 v96, v98
    v_mfma_f32_16x16x32_bf16 v[16:19], a[164:167], v[44:47], v[16:19]
    s_waitcnt lgkmcnt(4)
    v_permlane32_swap_b32 v97, v99
    v_mfma_f32_16x16x32_bf16 v[8:11], a[168:171], v[48:51], v[8:11]
    ds_read_b128 v[44:47], v2 offset:17408
    v_mfma_f32_16x16x32_bf16 v[12:15], a[172:175], v[48:51], v[12:15]
    buffer_store_dwordx4 v[96:99], v7, s[12:15], s36 offen sc1
    s_add_u32 s36, s36, 116736
    v_mfma_f32_16x16x32_bf16 v[16:19], a[176:179], v[48:51], v[16:19]
    s_waitcnt lgkmcnt(4)
    v_mfma_f32_16x16x32_bf16 v[8:11], a[180:183], v[52:55], v[8:11]
    ds_read_b128 v[48:51], v2 offset:18432
    v_mfma_f32_16x16x32_bf16 v[12:15], a[184:187], v[52:55], v[12:15]
    v_mfma_f32_16x16x32_bf16 v[16:19], a[188:191], v[52:55], v[16:19]
    s_waitcnt lgkmcnt(2)
    v_mfma_f32_16x16x32_bf16 v[8:11], a[192:195], v[40:43], v[8:11]
    ds_read_b128 v[52:55], v2 offset:19456
    v_add_f32 v100, v100, v108
    v_mfma_f32_16x16x32_bf16 v[12:15], a[196:199], v[40:43], v[12:15]
    v_add_f32 v101, v101, v109
    v_add_f32 v102, v102, v110
    v_mfma_f32_16x16x32_bf16 v[16:19], a[200:203], v[40:43], v[16:19]
    s_waitcnt lgkmcnt(2)
    v_add_f32 v103, v103, v111
    v_add_f32 v104, v104, v112
    v_mfma_f32_16x16x32_bf16 v[8:11], a[204:207], v[44:47], v[8:11]
    ds_read_b128 v[40:43], v2 offset:20480
    v_add_f32 v105, v105, v113
    v_mfma_f32_16x16x32_bf16 v[12:15], a[208:211], v[44:47], v[12:15]
    v_add_f32 v106, v106, v114
    v_add_f32 v107, v107, v115
    v_mfma_f32_16x16x32_bf16 v[16:19], a[212:215], v[44:47], v[16:19]
    s_waitcnt lgkmcnt(2)
    v_add_f32 v100, v100, v104
    v_add_f32 v101, v101, v105
    v_mfma_f32_16x16x32_bf16 v[8:11], a[216:219], v[48:51], v[8:11]
    ds_read_b128 v[44:47], v2 offset:21504
    v_add_f32 v102, v102, v106
    v_mfma_f32_16x16x32_bf16 v[12:15], a[220:223], v[48:51], v[12:15]
    v_add_f32 v103, v103, v107
    v_add_f32 v100, v100, v102
    v_mfma_f32_16x16x32_bf16 v[16:19], a[224:227], v[48:51], v[16:19]
    s_waitcnt lgkmcnt(2)
    v_add_f32 v101, v101, v103
    v_mfma_f32_16x16x32_bf16 v[8:11], a[228:231], v[52:55], v[8:11]
    ds_read_b128 v[48:51], v2 offset:22528
    v_mfma_f32_16x16x32_bf16 v[12:15], a[232:235], v[52:55], v[12:15]
    v_permlane16_swap_b32 v100, v101
    v_mfma_f32_16x16x32_bf16 v[16:19], a[236:239], v[52:55], v[16:19]
    s_waitcnt lgkmcnt(2)
    v_add_f32 v100, v100, v101
    v_mov_b32 v101, v100
    v_mfma_f32_16x16x32_bf16 v[8:11], a[240:243], v[40:43], v[8:11]
    ds_read_b128 v[52:55], v2 offset:23552
    v_mfma_f32_16x16x32_bf16 v[12:15], a[244:247], v[40:43], v[12:15]
    v_permlane32_swap_b32 v100, v101
    v_mfma_f32_16x16x32_bf16 v[16:19], a[248:251], v[40:43], v[16:19]
    s_waitcnt lgkmcnt(2)
    v_add_f32 v100, v100, v101
    v_mul_f32 v100, 0x3a800000, v100
    v_mfma_f32_16x16x32_bf16 v[8:11], a[252:255], v[44:47], v[8:11]
    ds_read_b128 v[40:43], v2 offset:24576
    v_mov_b32 v101, v100
    v_mfma_f32_16x16x32_bf16 v[12:15], v[128:131], v[44:47], v[12:15]
    v_mfma_f32_16x16x32_bf16 v[16:19], v[132:135], v[44:47], v[16:19]
    s_waitcnt lgkmcnt(2)
    v_permlane16_swap_b32 v100, v101
    v_mfma_f32_16x16x32_bf16 v[8:11], v[136:139], v[48:51], v[8:11]
    ds_read_b128 v[44:47], v2 offset:25600
    v_fma_f32 v101, -v100, v100, v101
    v_mfma_f32_16x16x32_bf16 v[12:15], v[140:143], v[48:51], v[12:15]
    v_max_f32 v101, 0, v101
    v_add_f32 v101, 0x3727c5ac, v101
    v_mfma_f32_16x16x32_bf16 v[16:19], v[144:147], v[48:51], v[16:19]
    s_waitcnt lgkmcnt(2)
    v_rsq_f32 v21, v101
    v_mfma_f32_16x16x32_bf16 v[8:11], v[148:151], v[52:55], v[8:11]
    ds_read_b128 v[48:51], v2 offset:26624
    v_mul_f32 v100, v100, v21
    v_mfma_f32_16x16x32_bf16 v[12:15], v[152:155], v[52:55], v[12:15]
    v_fma_f32 v80, -v100, v56, v68
    v_fma_f32 v81, -v100, v57, v69
    v_mfma_f32_16x16x32_bf16 v[16:19], v[156:159], v[52:55], v[16:19]
    s_waitcnt lgkmcnt(2)
    v_fma_f32 v82, -v100, v58, v70
    v_fma_f32 v83, -v100, v59, v71
    v_mfma_f32_16x16x32_bf16 v[8:11], v[160:163], v[40:43], v[8:11]
    ds_read_b128 v[52:55], v2 offset:27648
    v_fma_f32 v84, -v100, v60, v72
    v_mfma_f32_16x16x32_bf16 v[12:15], v[164:167], v[40:43], v[12:15]
    v_fma_f32 v85, -v100, v61, v73
    v_fma_f32 v86, -v100, v62, v74
    v_mfma_f32_16x16x32_bf16 v[16:19], v[168:171], v[40:43], v[16:19]
    s_waitcnt lgkmcnt(2)
    v_fma_f32 v87, -v100, v63, v75
    v_fma_f32 v88, -v100, v64, v76
    v_mfma_f32_16x16x32_bf16 v[8:11], v[172:175], v[44:47], v[8:11]
    ds_read_b128 v[40:43], v2 offset:28672
    v_fma_f32 v89, -v100, v65, v77
    v_mfma_f32_16x16x32_bf16 v[12:15], v[176:179], v[44:47], v[12:15]
    v_fma_f32 v90, -v100, v66, v78
    v_fma_f32 v91, -v100, v67, v79
    v_mfma_f32_16x16x32_bf16 v[16:19], v[180:183], v[44:47], v[16:19]
    s_waitcnt lgkmcnt(2)
    v_mfma_f32_16x16x32_bf16 v[8:11], v[184:187], v[48:51], v[8:11]
    ds_read_b128 v[44:47], v2 offset:29696
    v_mfma_f32_16x16x32_bf16 v[12:15], v[188:191], v[48:51], v[12:15]
    v_mfma_f32_16x16x32_bf16 v[16:19], v[192:195], v[48:51], v[16:19]
    s_waitcnt lgkmcnt(2)
    v_mfma_f32_16x16x32_bf16 v[8:11], v[196:199], v[52:55], v[8:11]
    ds_read_b128 v[48:51], v2 offset:30720
    v_mfma_f32_16x16x32_bf16 v[12:15], v[200:203], v[52:55], v[12:15]
    v_mfma_f32_16x16x32_bf16 v[16:19], v[204:207], v[52:55], v[16:19]
    s_waitcnt lgkmcnt(2)
    v_mfma_f32_16x16x32_bf16 v[8:11], v[208:211], v[40:43], v[8:11]
    ds_read_b128 v[52:55], v2 offset:31744
    v_mfma_f32_16x16x32_bf16 v[12:15], v[212:215], v[40:43], v[12:15]
    v_mfma_f32_16x16x32_bf16 v[16:19], v[216:219], v[40:43], v[16:19]
    s_waitcnt lgkmcnt(2)
    v_mfma_f32_16x16x32_bf16 v[8:11], v[220:223], v[44:47], v[8:11]
    v_mfma_f32_16x16x32_bf16 v[12:15], v[224:227], v[44:47], v[12:15]
    v_mfma_f32_16x16x32_bf16 v[16:19], v[228:231], v[44:47], v[16:19]
    s_waitcnt lgkmcnt(1)
    v_mfma_f32_16x16x32_bf16 v[8:11], v[232:235], v[48:51], v[8:11]
    s_waitcnt vmcnt(0)
    buffer_store_dword v6, v22, s[12:15], s17 offen sc1
    v_mfma_f32_16x16x32_bf16 v[12:15], v[236:239], v[48:51], v[12:15]
    s_mov_b32 s14, s6
    s_add_u32 s17, s17, 8192
    v_mfma_f32_16x16x32_bf16 v[16:19], v[240:243], v[48:51], v[16:19]
    s_waitcnt lgkmcnt(0)
    v_mfma_f32_16x16x32_bf16 v[8:11], v[244:247], v[52:55], v[8:11]
    v_mfma_f32_16x16x32_bf16 v[12:15], v[248:251], v[52:55], v[12:15]
    v_mfma_f32_16x16x32_bf16 v[16:19], v[252:255], v[52:55], v[16:19]
    s_nop 5
    v_fma_f32 v116, v8, v21, v80
    v_fma_f32 v117, v9, v21, v81
    v_fma_f32 v118, v10, v21, v82
    v_fma_f32 v119, v11, v21, v83
    v_fma_f32 v120, v12, v21, v84
    v_fma_f32 v121, v13, v21, v85
    v_fma_f32 v122, v14, v21, v86
    v_fma_f32 v123, v15, v21, v87
    v_mul_f32 v116, v116, |v116|
    v_mul_f32 v117, v117, |v117|
    v_mul_f32 v118, v118, |v118|
    v_mul_f32 v119, v119, |v119|
    v_mul_f32 v120, v120, |v120|
    v_mul_f32 v121, v121, |v121|
    v_mul_f32 v122, v122, |v122|
    v_mul_f32 v123, v123, |v123|
    v_cvt_pk_bf16_f32 v116, v116, v117
    v_cvt_pk_bf16_f32 v118, v118, v119
    v_cvt_pk_bf16_f32 v120, v120, v121
    v_cvt_pk_bf16_f32 v122, v122, v123
    v_pk_max_i16 v92, v116, 0
    v_pk_max_i16 v93, v118, 0
    v_pk_max_i16 v94, v120, 0
    v_pk_max_i16 v95, v122, 0
    buffer_store_dwordx4 v[92:95], v1, s[12:15], s36 offen sc1
    v_fma_f32 v124, v16, v21, v88
    v_fma_f32 v125, v17, v21, v89
    v_fma_f32 v126, v18, v21, v90
    v_fma_f32 v127, v19, v21, v91
    v_mul_f32 v124, v124, |v124|
    v_mul_f32 v125, v125, |v125|
    v_mul_f32 v126, v126, |v126|
    v_mul_f32 v127, v127, |v127|
    v_cvt_pk_bf16_f32 v124, v124, v125
    v_cvt_pk_bf16_f32 v126, v126, v127
    v_pk_max_i16 v96, v124, 0
    v_pk_max_i16 v97, v126, 0
    v_pk_max_i16 v98, v124, 0
    v_pk_max_i16 v99, v126, 0
    s_nop 0
    v_permlane32_swap_b32 v96, v98
    v_permlane32_swap_b32 v97, v99
    buffer_store_dwordx4 v[96:99], v7, s[12:15], s36 offen sc1
    s_add_u32 s54, s31, 1
    v_mov_b32 v6, s54
Lffa_late0:
    s_mov_b32 s16, s39
    buffer_load_dword v5, v4, s[4:7], s16 offen sc1
    s_waitcnt vmcnt(1)
    buffer_store_dword v6, v22, s[12:15], s17 offen sc1
    s_cmp_ge_i32 s31, 63
    s_cbranch_scc1 L_exit
    s_waitcnt vmcnt(1)
    v_cmp_gt_i32 vcc, s32, v5
    s_sub_u32 s43, s43, 1
    s_cmp_lt_i32 s43, 0
    s_cbranch_scc1 Lffa_rdy0
    s_and_b64 vcc, vcc, s[18:19]
    s_cbranch_scc0 Lffa_rdy0
Lffa_spin0:
    buffer_load_dword v5, v4, s[4:7], s16 offen sc1
    s_waitcnt vmcnt(0)
    v_cmp_gt_i32 vcc, s32, v5
    s_sub_u32 s43, s43, 1
    s_cmp_lt_i32 s43, 0
    s_cbranch_scc1 Lffa_rdy0
    s_and_b64 vcc, vcc, s[18:19]
    s_cbranch_scc0 Lffa_rdy0
    s_sleep 8
    s_branch Lffa_spin0
Lffa_rdy0:
    s_add_u32 s16, s16, 8192
    buffer_load_dword v5, v4, s[4:7], s16 offen sc1
    s_mov_b32 s10, s6
    s_add_u32 m0, s34, 0
    s_nop 0
    buffer_load_dwordx4 v1, s[8:11], s33 offen offset:0 sc1 lds
    buffer_load_dwordx4 v1, s[8:11], s33 offen offset:1024 sc1 lds
    buffer_load_dwordx4 v1, s[8:11], s33 offen offset:2048 sc1 lds
    buffer_load_dwordx4 v1, s[8:11], s33 offen offset:3072 sc1 lds
    s_add_u32 m0, s34, 4096
    s_add_u32 s37, s33, 4096
    buffer_load_dwordx4 v1, s[8:11], s37 offen offset:0 sc1 lds
    buffer_load_dwordx4 v1, s[8:11], s37 offen offset:1024 sc1 lds
    buffer_load_dwordx4 v1, s[8:11], s37 offen offset:2048 sc1 lds
    buffer_load_dwordx4 v1, s[8:11], s37 offen offset:3072 sc1 lds
    s_add_u32 m0, s34, 8192
    s_add_u32 s37, s33, 8192
    buffer_load_dwordx4 v1, s[8:11], s37 offen offset:0 sc1 lds
    s_waitcnt vmcnt(9)
    s_add_u32 s32, s32, 1
    s_add_u32 s33, s33, 36864
    s_add_u32 s34, s34, 36864
    s_cmp_ge_u32 s34, 147456
    s_cselect_b32 s38, 147456, 0
    s_sub_u32 s34, s34, s38
    v_cmp_gt_i32 vcc, s32, v5
    s_nop 0
    s_and_b64 vcc, vcc, s[18:19]
    s_cselect_b32 s10, 0, s6
    s_add_u32 m0, s34, 0
    s_nop 0
    buffer_load_dwordx4 v1, s[8:11], s33 offen offset:0 sc1 lds
    buffer_load_dwordx4 v1, s[8:11], s33 offen offset:1024 sc1 lds
    buffer_load_dwordx4 v1, s[8:11], s33 offen offset:2048 sc1 lds
    buffer_load_dwordx4 v1, s[8:11], s33 offen offset:3072 sc1 lds
    s_waitcnt vmcnt(4)
Lffa_go0:
    s_mov_b32 s14, 0
    s_barrier
    ds_read_b128 v[40:43], v3 offset:0
    ds_read_b128 v[44:47], v3 offset:1024
    ds_read_b128 v[48:51], v3 offset:2048
    s_branch Lffa_body1
Lffa_slow1:
    s_sub_u32 s39, s16, 8192
    v_mfma_f32_16x16x32_bf16 v[32:35], a[8:11], v[40:43], 0
    s_waitcnt lgkmcnt(2)
    buffer_load_dword v23, v4, s[4:7], s39 offen sc1
    v_mfma_f32_16x16x32_bf16 v[24:27], a[12:15], v[44:47], v[24:27]
    ds_read_b128 v[40:43], v3 offset:4096
    v_fma_f32 v116, v8, v21, v80
    v_mfma_f32_16x16x32_bf16 v[28:31], a[16:19], v[44:47], v[28:31]
    s_add_u32 s31, s31, 1
    v_mov_b32 v6, s31
    v_fma_f32 v117, v9, v21, v81
    v_mfma_f32_16x16x32_bf16 v[32:35], a[20:23], v[44:47], v[32:35]
    s_waitcnt lgkmcnt(2)
    v_fma_f32 v118, v10, v21, v82
    v_fma_f32 v119, v11, v21, v83
    v_mfma_f32_16x16x32_bf16 v[24:27], a[24:27], v[48:51], v[24:27]
    ds_read_b128 v[44:47], v3 offset:5120
    v_fma_f32 v120, v12, v21, v84
    v_mfma_f32_16x16x32_bf16 v[28:31], a[28:31], v[48:51], v[28:31]
    s_add_u32 s35, s35, 36864
    v_fma_f32 v121, v13, v21, v85
    v_fma_f32 v122, v14, v21, v86
    v_mfma_f32_16x16x32_bf16 v[32:35], a[32:35], v[48:51], v[32:35]
    s_waitcnt lgkmcnt(2)
    v_fma_f32 v123, v15, v21, v87
    v_mul_f32 v116, v116, |v116|
    v_mfma_f32_16x16x32_bf16 v[24:27], a[36:39], v[52:55], v[24:27]
    ds_read_b128 v[48:51], v3 offset:6144
    v_mul_f32 v117, v117, |v117|
    v_mfma_f32_16x16x32_bf16 v[28:31], a[40:43], v[52:55], v[28:31]
    s_cmp_eq_u32 s35, 147456
    s_cselect_b32 s35, 0, s35
    v_mul_f32 v118, v118, |v118|
    v_mfma_f32_16x16x32_bf16 v[32:35], a[44:47], v[52:55], v[32:35]
    s_waitcnt lgkmcnt(2)
    v_mul_f32 v119, v119, |v119|
    v_mul_f32 v120, v120, |v120|
    v_mfma_f32_16x16x32_bf16 v[24:27], a[48:51], v[40:43], v[24:27]
    ds_read_b128 v[52:55], v3 offset:7168
    v_mul_f32 v121, v121, |v121|
    v_mfma_f32_16x16x32_bf16 v[28:31], a[52:55], v[40:43], v[28:31]
    v_mul_f32 v122, v122, |v122|
    v_mul_f32 v123, v123, |v123|
    v_mfma_f32_16x16x32_bf16 v[32:35], a[56:59], v[40:43], v[32:35]
    s_waitcnt lgkmcnt(2)
    v_cvt_pk_bf16_f32 v116, v116, v117
    v_cvt_pk_bf16_f32 v118, v118, v119
    v_mfma_f32_16x16x32_bf16 v[24:27], a[60:63], v[44:47], v[24:27]
    ds_read_b128 v[40:43], v3 offset:8192
    v_cvt_pk_bf16_f32 v120, v120, v121
    v_mfma_f32_16x16x32_bf16 v[28:31], a[64:67], v[44:47], v[28:31]
    v_cvt_pk_bf16_f32 v122, v122, v123
    v_pk_max_i16 v92, v116, 0
    v_mfma_f32_16x16x32_bf16 v[32:35], a[68:71], v[44:47], v[32:35]
    s_waitcnt lgkmcnt(2)
    v_pk_max_i16 v93, v118, 0
    v_pk_max_i16 v94, v120, 0
    v_mfma_f32_16x16x32_bf16 v[24:27], a[72:75], v[48:51], v[24:27]
    ds_read_b128 v[44:47], v3 offset:9216
    v_pk_max_i16 v95, v122, 0
    v_mfma_f32_16x16x32_bf16 v[28:31], a[76:79], v[48:51], v[28:31]
    buffer_store_dwordx4 v[92:95], v1, s[12:15], s36 offen sc1
    v_fma_f32 v124, v16, v21, v88
    v_mfma_f32_16x16x32_bf16 v[32:35], a[80:83], v[48:51], v[32:35]
    s_waitcnt lgkmcnt(2)
    v_fma_f32 v125, v17, v21, v89
    v_fma_f32 v126, v18, v21, v90
    v_mfma_f32_16x16x32_bf16 v[24:27], a[84:87], v[52:55], v[24:27]
    ds_read_b128 v[48:51], v3 offset:10240
    v_fma_f32 v127, v19, v21, v91
    v_mfma_f32_16x16x32_bf16 v[28:31], a[88:91], v[52:55], v[28:31]
    v_mul_f32 v124, v124, |v124|
    v_mul_f32 v125, v125, |v125|
    v_mfma_f32_16x16x32_bf16 v[32:35], a[92:95], v[52:55], v[32:35]
    s_waitcnt lgkmcnt(2)
    v_mul_f32 v126, v126, |v126|
    v_mul_f32 v127, v127, |v127|
    v_mfma_f32_16x16x32_bf16 v[24:27], a[96:99], v[40:43], v[24:27]
    ds_read_b128 v[52:55], v3 offset:11264
    v_cvt_pk_bf16_f32 v124, v124, v125
    v_mfma_f32_16x16x32_bf16 v[28:31], a[100:103], v[40:43], v[28:31]
    v_cvt_pk_bf16_f32 v126, v126, v127
    v_pk_max_i16 v96, v124, 0
    v_mfma_f32_16x16x32_bf16 v[32:35], a[104:107], v[40:43], v[32:35]
    s_waitcnt lgkmcnt(2)
    v_pk_max_i16 v97, v126, 0
    v_pk_max_i16 v98, v124, 0
    v_mfma_f32_16x16x32_bf16 v[24:27], a[108:111], v[44:47], v[24:27]
    ds_read_b128 v[40:43], v3 offset:12288
    v_pk_max_i16 v99, v126, 0
    v_mfma_f32_16x16x32_bf16 v[28:31], a[112:115], v[44:47], v[28:31]
    v_sub_u32 v100, v3, v20
    v_add_u32 v2, s35, v1
    v_mfma_f32_16x16x32_bf16 v[32:35], a[116:119], v[44:47], v[32:35]
    s_waitcnt lgkmcnt(2)
    ds_read2st64_b64 v[112:115], v100 offset0:70 offset1:71
    v_mfma_f32_16x16x32_bf16 v[24:27], a[120:123], v[48:51], v[24:27]
    ds_read_b128 v[44:47], v3 offset:13312
    v_mfma_f32_16x16x32_bf16 v[28:31], a[124:127], v[48:51], v[28:31]
    ds_read2st64_b64 v[108:111], v100 offset0:68 offset1:69
    v_mfma_f32_16x16x32_bf16 v[32:35], a[128:131], v[48:51], v[32:35]
    s_waitcnt lgkmcnt(4)
    s_waitcnt vmcnt(1)
    v_cmp_gt_i32 vcc, s32, v23
    v_mfma_f32_16x16x32_bf16 v[24:27], a[132:135], v[52:55], v[24:27]
    ds_read_b128 v[48:51], v3 offset:14336
    v_mfma_f32_16x16x32_bf16 v[28:31], a[136:139], v[52:55], v[28:31]
    s_and_b64 vcc, vcc, s[18:19]
    s_cselect_b32 s10, 0, s6
    v_mfma_f32_16x16x32_bf16 v[32:35], a[140:143], v[52:55], v[32:35]
    s_waitcnt lgkmcnt(4)
    s_cmp_eq_u32 s10, 0
    s_cbranch_scc1 Lffa_slowc1
    v_mfma_f32_16x16x32_bf16 v[24:27], a[144:147], v[40:43], v[24:27]
    ds_read_b128 v[52:55], v3 offset:15360
    s_add_u32 m0, s34, 0
    v_mfma_f32_16x16x32_bf16 v[28:31], a[148:151], v[40:43], v[28:31]
    buffer_load_dwordx4 v1, s[8:11], s33 offen offset:0 sc1 lds
    v_mfma_f32_16x16x32_bf16 v[32:35], a[152:155], v[40:43], v[32:35]
    s_waitcnt lgkmcnt(3)
    ds_read2st64_b64 v[104:107], v100 offset0:66 offset1:67
    v_mfma_f32_16x16x32_bf16 v[24:27], a[156:159], v[44:47], v[24:27]
    ds_read_b128 v[40:43], v3 offset:16384
    v_mfma_f32_16x16x32_bf16 v[28:31], a[160:163], v[44:47], v[28:31]
    ds_read2st64_b64 v[100:103], v100 offset0:64 offset1:65
    v_mfma_f32_16x16x32_bf16 v[32:35], a[164:167], v[44:47], v[32:35]
    s_waitcnt lgkmcnt(4)
    buffer_load_dwordx4 v1, s[8:11], s33 offen offset:1024 sc1 lds
    v_mfma_f32_16x16x32_bf16 v[24:27], a[168:171], v[48:51], v[24:27]
    ds_read_b128 v[44:47], v3 offset:17408
    v_mfma_f32_16x16x32_bf16 v[28:31], a[172:175], v[48:51], v[28:31]
    v_permlane32_swap_b32 v96, v98
    v_mfma_f32_16x16x32_bf16 v[32:35], a[176:179], v[48:51], v[32:35]
    s_waitcnt lgkmcnt(4)
    v_permlane32_swap_b32 v97, v99
    v_mfma_f32_16x16x32_bf16 v[24:27], a[180:183], v[52:55], v[24:27]
    ds_read_b128 v[48:51], v3 offset:18432
    v_mfma_f32_16x16x32_bf16 v[28:31], a[184:187], v[52:55], v[28:31]
    buffer_store_dwordx4 v[96:99], v7, s[12:15], s36 offen sc1
    s_add_u32 s36, s36, 116736
    v_mfma_f32_16x16x32_bf16 v[32:35], a[188:191], v[52:55], v[32:35]
    s_waitcnt lgkmcnt(3)
    v_mfma_f32_16x16x32_bf16 v[24:27], a[192:195], v[40:43], v[24:27]
    ds_read_b128 v[52:55], v3 offset:19456
    v_mfma_f32_16x16x32_bf16 v[28:31], a[196:199], v[40:43], v[28:31]
    v_mfma_f32_16x16x32_bf16 v[32:35], a[200:203], v[40:43], v[32:35]
    s_waitcnt lgkmcnt(2)
    buffer_load_dword v5, v4, s[4:7], s16 offen sc1
    v_mfma_f32_16x16x32_bf16 v[24:27], a[204:207], v[44:47], v[24:27]
    ds_read_b128 v[40:43], v3 offset:20480
    v_add_f32 v100, v100, v108
    v_mfma_f32_16x16x32_bf16 v[28:31], a[208:211], v[44:47], v[28:31]
    v_add_f32 v101, v101, v109
    v_add_f32 v102, v102, v110
    v_mfma_f32_16x16x32_bf16 v[32:35], a[212:215], v[44:47], v[32:35]
    s_waitcnt lgkmcnt(2)
    v_add_f32 v103, v103, v111
    v_add_f32 v104, v104, v112
    v_mfma_f32_16x16x32_bf16 v[24:27], a[216:219], v[48:51], v[24:27]
    ds_read_b128 v[44:47], v3 offset:21504
    v_add_f32 v105, v105, v113
    v_mfma_f32_16x16x32_bf16 v[28:31], a[220:223], v[48:51], v[28:31]
    buffer_load_dwordx4 v1, s[8:11], s33 offen offset:2048 sc1 lds
    v_mfma_f32_16x16x32_bf16 v[32:35], a[224:227], v[48:51], v[32:35]
    s_waitcnt lgkmcnt(2)
    v_add_f32 v106, v106, v114
    v_add_f32 v107, v107, v115
    v_mfma_f32_16x16x32_bf16 v[24:27], a[228:231], v[52:55], v[24:27]
    ds_read_b128 v[48:51], v3 offset:22528
    v_add_f32 v100, v100, v104
    v_mfma_f32_16x16x32_bf16 v[28:31], a[232:235], v[52:55], v[28:31]
    v_add_f32 v101, v101, v105
    v_add_f32 v102, v102, v106
    v_mfma_f32_16x16x32_bf16 v[32:35], a[236:239], v[52:55], v[32:35]
    s_waitcnt lgkmcnt(2)
    buffer_load_dwordx4 v1, s[8:11], s33 offen offset:3072 sc1 lds
    v_mfma_f32_16x16x32_bf16 v[24:27], a[240:243], v[40:43], v[24:27]
    ds_read_b128 v[52:55], v3 offset:23552
    s_add_u32 m0, s34, 4096
    v_mfma_f32_16x16x32_bf16 v[28:31], a[244:247], v[40:43], v[28:31]
    s_add_u32 s37, s33, 4096
    v_add_f32 v103, v103, v107
    v_add_f32 v100, v100, v102
    v_mfma_f32_16x16x32_bf16 v[32:35], a[248:251], v[40:43], v[32:35]
    s_waitcnt lgkmcnt(2)
    v_add_f32 v101, v101, v103
    v_mfma_f32_16x16x32_bf16 v[24:27], a[252:255], v[44:47], v[24:27]
    ds_read_b128 v[40:43], v3 offset:24576
    v_mfma_f32_16x16x32_bf16 v[28:31], v[128:131], v[44:47], v[28:31]
    buffer_load_dwordx4 v1, s[8:11], s37 offen offset:0 sc1 lds
    v_mfma_f32_16x16x32_bf16 v[32:35], v[132:135], v[44:47], v[32:35]
    s_waitcnt lgkmcnt(2)
    v_permlane16_swap_b32 v100, v101
    v_mfma_f32_16x16x32_bf16 v[24:27], v[136:139], v[48:51], v[24:27]
    ds_read_b128 v[44:47], v3 offset:25600
    v_add_f32 v100, v100, v101
    v_mfma_f32_16x16x32_bf16 v[28:31], v[140:143], v[48:51], v[28:31]
    v_mov_b32 v101, v100
    v_mfma_f32_16x16x32_bf16 v[32:35], v[144:147], v[48:51], v[32:35]
    s_waitcnt lgkmcnt(2)
    buffer_load_dwordx4 v1, s[8:11], s37 offen offset:1024 sc1 lds
    v_mfma_f32_16x16x32_bf16 v[24:27], v[148:151], v[52:55], v[24:27]
    ds_read_b128 v[48:51], v3 offset:26624
    v_mfma_f32_16x16x32_bf16 v[28:31], v[152:155], v[52:55], v[28:31]
    v_permlane32_swap_b32 v100, v101
    v_mfma_f32_16x16x32_bf16 v[32:35], v[156:159], v[52:55], v[32:35]
    s_waitcnt lgkmcnt(2)
    v_add_f32 v100, v100, v101
    v_mul_f32 v100, 0x3a800000, v100
    v_mfma_f32_16x16x32_bf16 v[24:27], v[160:163], v[40:43], v[24:27]
    ds_read_b128 v[52:55], v3 offset:27648
    v_mov_b32 v101, v100
    v_mfma_f32_16x16x32_bf16 v[28:31], v[164:167], v[40:43], v[28:31]
    buffer_load_dwordx4 v1, s[8:11], s37 offen offset:2048 sc1 lds
    v_mfma_f32_16x16x32_bf16 v[32:35], v[168:171], v[40:43], v[32:35]
    s_waitcnt lgkmcnt(2)
    v_permlane16_swap_b32 v100, v101
    v_mfma_f32_16x16x32_bf16 v[24:27], v[172:175], v[44:47], v[24:27]
    ds_read_b128 v[40:43], v3 offset:28672
    v_fma_f32 v101, -v100, v100, v101
    v_mfma_f32_16x16x32_bf16 v[28:31], v[176:179], v[44:47], v[28:31]
    v_max_f32 v101, 0, v101
    v_add_f32 v101, 0x3727c5ac, v101
    v_mfma_f32_16x16x32_bf16 v[32:35], v[180:183], v[44:47], v[32:35]
    s_waitcnt lgkmcnt(2)
    buffer_load_dwordx4 v1, s[8:11], s37 offen offset:3072 sc1 lds
    v_mfma_f32_16x16x32_bf16 v[24:27], v[184:187], v[48:51], v[24:27]
    ds_read_b128 v[44:47], v3 offset:29696
    s_add_u32 m0, s34, 8192
    v_mfma_f32_16x16x32_bf16 v[28:31], v[188:191], v[48:51], v[28:31]
    s_add_u32 s37, s33, 8192
    v_rsq_f32 v21, v101
    v_mfma_f32_16x16x32_bf16 v[32:35], v[192:195], v[48:51], v[32:35]
    s_waitcnt lgkmcnt(2)
    v_mul_f32 v100, v100, v21
    v_fma_f32 v80, -v100, v56, v68
    v_mfma_f32_16x16x32_bf16 v[24:27], v[196:199], v[52:55], v[24:27]
    ds_read_b128 v[48:51], v3 offset:30720
    v_fma_f32 v81, -v100, v57, v69
    v_mfma_f32_16x16x32_bf16 v[28:31], v[200:203], v[52:55], v[28:31]
    buffer_load_dwordx4 v1, s[8:11], s37 offen offset:0 sc1 lds
    v_mfma_f32_16x16x32_bf16 v[32:35], v[204:207], v[52:55], v[32:35]
    s_waitcnt lgkmcnt(2)
    s_waitcnt vmcnt(0)
    s_add_u32 s32, s32, 1
    v_mfma_f32_16x16x32_bf16 v[24:27], v[208:211], v[40:43], v[24:27]
    ds_read_b128 v[52:55], v3 offset:31744
    s_add_u32 s33, s33, 36864
    v_mfma_f32_16x16x32_bf16 v[28:31], v[212:215], v[40:43], v[28:31]
    s_barrier
    v_mfma_f32_16x16x32_bf16 v[32:35], v[216:219], v[40:43], v[32:35]
    s_waitcnt lgkmcnt(2)
    s_add_u32 s34, s34, 36864
    v_fma_f32 v82, -v100, v58, v70
    v_mfma_f32_16x16x32_bf16 v[24:27], v[220:223], v[44:47], v[24:27]
    ds_read_b128 v[40:43], v2 offset:0
    v_fma_f32 v83, -v100, v59, v71
    v_mfma_f32_16x16x32_bf16 v[28:31], v[224:227], v[44:47], v[28:31]
    s_cmp_ge_u32 s34, 147456
    s_cselect_b32 s38, 147456, 0
    s_sub_u32 s34, s34, s38
    v_mfma_f32_16x16x32_bf16 v[32:35], v[228:231], v[44:47], v[32:35]
    s_waitcnt lgkmcnt(2)
    v_cmp_gt_i32 vcc, s32, v5
    v_fma_f32 v84, -v100, v60, v72
    v_mfma_f32_16x16x32_bf16 v[24:27], v[232:235], v[48:51], v[24:27]
    ds_read_b128 v[44:47], v2 offset:1024
    v_fma_f32 v85, -v100, v61, v73
    v_mfma_f32_16x16x32_bf16 v[28:31], v[236:239], v[48:51], v[28:31]
    s_and_b64 vcc, vcc, s[18:19]
    s_cselect_b32 s10, 0, s6
    s_add_u32 m0, s34, 0
    v_mfma_f32_16x16x32_bf16 v[32:35], v[240:243], v[48:51], v[32:35]
    s_waitcnt lgkmcnt(2)
    buffer_load_dwordx4 v1, s[8:11], s33 offen offset:0 sc1 lds
    v_mfma_f32_16x16x32_bf16 v[24:27], v[244:247], v[52:55], v[24:27]
    ds_read_b128 v[48:51], v2 offset:2048
    v_fma_f32 v86, -v100, v62, v74
    v_mfma_f32_16x16x32_bf16 v[28:31], v[248:251], v[52:55], v[28:31]
    buffer_store_dword v6, v22, s[12:15], s17 offen sc1
    v_fma_f32 v87, -v100, v63, v75
    v_mfma_f32_16x16x32_bf16 v[32:35], v[252:255], v[52:55], v[32:35]
    buffer_load_dwordx4 v1, s[8:11], s33 offen offset:1024 sc1 lds
    s_mov_b32 s14, s6
    s_add_u32 s17, s17, 8192
    v_fma_f32 v88, -v100, v64, v76
    v_fma_f32 v89, -v100, v65, v77
    v_fma_f32 v90, -v100, v66, v78
    v_fma_f32 v91, -v100, v67, v79
    buffer_load_dwordx4 v1, s[8:11], s33 offen offset:2048 sc1 lds
    buffer_load_dwordx4 v1, s[8:11], s33 offen offset:3072 sc1 lds
    s_cmp_lt_i32 s31, 63
    s_cbranch_scc1 Lffa_body0
    s_branch L_exit
Lffa_slowc1:
    v_mfma_f32_16x16x32_bf16 v[24:27], a[144:147], v[40:43], v[24:27]
    ds_read_b128 v[52:55], v3 offset:15360
    v_mfma_f32_16x16x32_bf16 v[28:31], a[148:151], v[40:43], v[28:31]
    ds_read2st64_b64 v[104:107], v100 offset0:66 offset1:67
    v_mfma_f32_16x16x32_bf16 v[32:35], a[152:155], v[40:43], v[32:35]
    s_waitcnt lgkmcnt(4)
    ds_read2st64_b64 v[100:103], v100 offset0:64 offset1:65
    v_mfma_f32_16x16x32_bf16 v[24:27], a[156:159], v[44:47], v[24:27]
    ds_read_b128 v[40:43], v3 offset:16384
    v_mfma_f32_16x16x32_bf16 v[28:31], a[160:163], v[44:47], v[28:31]
    v_permlane32_swap_b32 v96, v98
    v_mfma_f32_16x16x32_bf16 v[32:35], a[164:167], v[44:47], v[32:35]
    s_waitcnt lgkmcnt(4)
    v_permlane32_swap_b32 v97, v99
    v_mfma_f32_16x16x32_bf16 v[24:27], a[168:171], v[48:51], v[24:27]
    ds_read_b128 v[44:47], v3 offset:17408
    v_mfma_f32_16x16x32_bf16 v[28:31], a[172:175], v[48:51], v[28:31]
    buffer_store_dwordx4 v[96:99], v7, s[12:15], s36 offen sc1
    s_add_u32 s36, s36, 116736
    v_mfma_f32_16x16x32_bf16 v[32:35], a[176:179], v[48:51], v[32:35]
    s_waitcnt lgkmcnt(4)
    v_mfma_f32_16x16x32_bf16 v[24:27], a[180:183], v[52:55], v[24:27]
    ds_read_b128 v[48:51], v3 offset:18432
    v_mfma_f32_16x16x32_bf16 v[28:31], a[184:187], v[52:55], v[28:31]
    v_mfma_f32_16x16x32_bf16 v[32:35], a[188:191], v[52:55], v[32:35]
    s_waitcnt lgkmcnt(2)
    v_mfma_f32_16x16x32_bf16 v[24:27], a[192:195], v[40:43], v[24:27]
    ds_read_b128 v[52:55], v3 offset:19456
    v_add_f32 v100, v100, v108
    v_mfma_f32_16x16x32_bf16 v[28:31], a[196:199], v[40:43], v[28:31]
    v_add_f32 v101, v101, v109
    v_add_f32 v102, v102, v110
    v_mfma_f32_16x16x32_bf16 v[32:35], a[200:203], v[40:43], v[32:35]
    s_waitcnt lgkmcnt(2)
    v_add_f32 v103, v103, v111
    v_add_f32 v104, v104, v112
    v_mfma_f32_16x16x32_bf16 v[24:27], a[204:207], v[44:47], v[24:27]
    ds_read_b128 v[40:43], v3 offset:20480
    v_add_f32 v105, v105, v113
    v_mfma_f32_16x16x32_bf16 v[28:31], a[208:211], v[44:47], v[28:31]
    v_add_f32 v106, v106, v114
    v_add_f32 v107, v107, v115
    v_mfma_f32_16x16x32_bf16 v[32:35], a[212:215], v[44:47], v[32:35]
    s_waitcnt lgkmcnt(2)
    v_add_f32 v100, v100, v104
    v_add_f32 v101, v101, v105
    v_mfma_f32_16x16x32_bf16 v[24:27], a[216:219], v[48:51], v[24:27]
    ds_read_b128 v[44:47], v3 offset:21504
    v_add_f32 v102, v102, v106
    v_mfma_f32_16x16x32_bf16 v[28:31], a[220:223], v[48:51], v[28:31]
    v_add_f32 v103, v103, v107
    v_add_f32 v100, v100, v102
    v_mfma_f32_16x16x32_bf16 v[32:35], a[224:227], v[48:51], v[32:35]
    s_waitcnt lgkmcnt(2)
    v_add_f32 v101, v101, v103
    v_mfma_f32_16x16x32_bf16 v[24:27], a[228:231], v[52:55], v[24:27]
    ds_read_b128 v[48:51], v3 offset:22528
    v_mfma_f32_16x16x32_bf16 v[28:31], a[232:235], v[52:55], v[28:31]
    v_permlane16_swap_b32 v100, v101
    v_mfma_f32_16x16x32_bf16 v[32:35], a[236:239], v[52:55], v[32:35]
    s_waitcnt lgkmcnt(2)
    v_add_f32 v100, v100, v101
    v_mov_b32 v101, v100
    v_mfma_f32_16x16x32_bf16 v[24:27], a[240:243], v[40:43], v[24:27]
    ds_read_b128 v[52:55], v3 offset:23552
    v_mfma_f32_16x16x32_bf16 v[28:31], a[244:247], v[40:43], v[28:31]
    v_permlane32_swap_b32 v100, v101
    v_mfma_f32_16x16x32_bf16 v[32:35], a[248:251], v[40:43], v[32:35]
    s_waitcnt lgkmcnt(2)
    v_add_f32 v100, v100, v101
    v_mul_f32 v100, 0x3a800000, v100
    v_mfma_f32_16x16x32_bf16 v[24:27], a[252:255], v[44:47], v[24:27]
    ds_read_b128 v[40:43], v3 offset:24576
    v_mov_b32 v101, v100
    v_mfma_f32_16x16x32_bf16 v[28:31], v[128:131], v[44:47], v[28:31]
    v_mfma_f32_16x16x32_bf16 v[32:35], v[132:135], v[44:47], v[32:35]
    s_waitcnt lgkmcnt(2)
    v_permlane16_swap_b32 v100, v101
    v_mfma_f32_16x16x32_bf16 v[24:27], v[136:139], v[48:51], v[24:27]
    ds_read_b128 v[44:47], v3 offset:25600
    v_fma_f32 v101, -v100, v100, v101
    v_mfma_f32_16x16x32_bf16 v[28:31], v[140:143], v[48:51], v[28:31]
    v_max_f32 v101, 0, v101
    v_add_f32 v101, 0x3727c5ac, v101
    v_mfma_f32_16x16x32_bf16 v[32:35], v[144:147], v[48:51], v[32:35]
    s_waitcnt lgkmcnt(2)
    v_rsq_f32 v21, v101
    v_mfma_f32_16x16x32_bf16 v[24:27], v[148:151], v[52:55], v[24:27]
    ds_read_b128 v[48:51], v3 offset:26624
    v_mul_f32 v100, v100, v21
    v_mfma_f32_16x16x32_bf16 v[28:31], v[152:155], v[52:55], v[28:31]
    v_fma_f32 v80, -v100, v56, v68
    v_fma_f32 v81, -v100, v57, v69
    v_mfma_f32_16x16x32_bf16 v[32:35], v[156:159], v[52:55], v[32:35]
    s_waitcnt lgkmcnt(2)
    v_fma_f32 v82, -v100, v58, v70
    v_fma_f32 v83, -v100, v59, v71
    v_mfma_f32_16x16x32_bf16 v[24:27], v[160:163], v[40:43], v[24:27]
    ds_read_b128 v[52:55], v3 offset:27648
    v_fma_f32 v84, -v100, v60, v72
    v_mfma_f32_16x16x32_bf16 v[28:31], v[164:167], v[40:43], v[28:31]
    v_fma_f32 v85, -v100, v61, v73
    v_fma_f32 v86, -v100, v62, v74
    v_mfma_f32_16x16x32_bf16 v[32:35], v[168:171], v[40:43], v[32:35]
    s_waitcnt lgkmcnt(2)
    v_fma_f32 v87, -v100, v63, v75
    v_fma_f32 v88, -v100, v64, v76
    v_mfma_f32_16x16x32_bf16 v[24:27], v[172:175], v[44:47], v[24:27]
    ds_read_b128 v[40:43], v3 offset:28672
    v_fma_f32 v89, -v100, v65, v77
    v_mfma_f32_16x16x32_bf16 v[28:31], v[176:179], v[44:47], v[28:31]
    v_fma_f32 v90, -v100, v66, v78
    v_fma_f32 v91, -v100, v67, v79
    v_mfma_f32_16x16x32_bf16 v[32:35], v[180:183], v[44:47], v[32:35]
    s_waitcnt lgkmcnt(2)
    v_mfma_f32_16x16x32_bf16 v[24:27], v[184:187], v[48:51], v[24:27]
    ds_read_b128 v[44:47], v3 offset:29696
    v_mfma_f32_16x16x32_bf16 v[28:31], v[188:191], v[48:51], v[28:31]
    v_mfma_f32_16x16x32_bf16 v[32:35], v[192:195], v[48:51], v[32:35]
    s_waitcnt lgkmcnt(2)
    v_mfma_f32_16x16x32_bf16 v[24:27], v[196:199], v[52:55], v[24:27]
    ds_read_b128 v[48:51], v3 offset:30720
    v_mfma_f32_16x16x32_bf16 v[28:31], v[200:203], v[52:55], v[28:31]
    v_mfma_f32_16x16x32_bf16 v[32:35], v[204:207], v[52:55], v[32:35]
    s_waitcnt lgkmcnt(2)
    v_mfma_f32_16x16x32_bf16 v[24:27], v[208:211], v[40:43], v[24:27]
    ds_read_b128 v[52:55], v3 offset:31744
    v_mfma_f32_16x16x32_bf16 v[28:31], v[212:215], v[40:43], v[28:31]
    v_mfma_f32_16x16x32_bf16 v[32:35], v[216:219], v[40:43], v[32:35]
    s_waitcnt lgkmcnt(2)
    v_mfma_f32_16x16x32_bf16 v[24:27], v[220:223], v[44:47], v[24:27]
    v_mfma_f32_16x16x32_bf16 v[28:31], v[224:227], v[44:47], v[28:31]
    v_mfma_f32_16x16x32_bf16 v[32:35], v[228:231], v[44:47], v[32:35]
    s_waitcnt lgkmcnt(1)
    v_mfma_f32_16x16x32_bf16 v[24:27], v[232:235], v[48:51], v[24:27]
    s_waitcnt vmcnt(0)
    buffer_store_dword v6, v22, s[12:15], s17 offen sc1
    v_mfma_f32_16x16x32_bf16 v[28:31], v[236:239], v[48:51], v[28:31]
    s_mov_b32 s14, s6
    s_add_u32 s17, s17, 8192
    v_mfma_f32_16x16x32_bf16 v[32:35], v[240:243], v[48:51], v[32:35]
    s_waitcnt lgkmcnt(0)
    v_mfma_f32_16x16x32_bf16 v[24:27], v[244:247], v[52:55], v[24:27]
    v_mfma_f32_16x16x32_bf16 v[28:31], v[248:251], v[52:55], v[28:31]
    v_mfma_f32_16x16x32_bf16 v[32:35], v[252:255], v[52:55], v[32:35]
    s_nop 5
    v_fma_f32 v116, v24, v21, v80
    v_fma_f32 v117, v25, v21, v81
    v_fma_f32 v118, v26, v21, v82
    v_fma_f32 v119, v27, v21, v83
    v_fma_f32 v120, v28, v21, v84
    v_fma_f32 v121, v29, v21, v85
    v_fma_f32 v122, v30, v21, v86
    v_fma_f32 v123, v31, v21, v87
    v_mul_f32 v116, v116, |v116|
    v_mul_f32 v117, v117, |v117|
    v_mul_f32 v118, v118, |v118|
    v_mul_f32 v119, v119, |v119|
    v_mul_f32 v120, v120, |v120|
    v_mul_f32 v121, v121, |v121|
    v_mul_f32 v122, v122, |v122|
    v_mul_f32 v123, v123, |v123|
    v_cvt_pk_bf16_f32 v116, v116, v117
    v_cvt_pk_bf16_f32 v118, v118, v119
    v_cvt_pk_bf16_f32 v120, v120, v121
    v_cvt_pk_bf16_f32 v122, v122, v123
    v_pk_max_i16 v92, v116, 0
    v_pk_max_i16 v93, v118, 0
    v_pk_max_i16 v94, v120, 0
    v_pk_max_i16 v95, v122, 0
    buffer_store_dwordx4 v[92:95], v1, s[12:15], s36 offen sc1
    v_fma_f32 v124, v32, v21, v88
    v_fma_f32 v125, v33, v21, v89
    v_fma_f32 v126, v34, v21, v90
    v_fma_f32 v127, v35, v21, v91
    v_mul_f32 v124, v124, |v124|
    v_mul_f32 v125, v125, |v125|
    v_mul_f32 v126, v126, |v126|
    v_mul_f32 v127, v127, |v127|
    v_cvt_pk_bf16_f32 v124, v124, v125
    v_cvt_pk_bf16_f32 v126, v126, v127
    v_pk_max_i16 v96, v124, 0
    v_pk_max_i16 v97, v126, 0
    v_pk_max_i16 v98, v124, 0
    v_pk_max_i16 v99, v126, 0
    s_nop 0
    v_permlane32_swap_b32 v96, v98
    v_permlane32_swap_b32 v97, v99
    buffer_store_dwordx4 v[96:99], v7, s[12:15], s36 offen sc1
    s_add_u32 s54, s31, 1
    v_mov_b32 v6, s54
Lffa_late1:
    s_mov_b32 s16, s39
    buffer_load_dword v5, v4, s[4:7], s16 offen sc1
    s_waitcnt vmcnt(1)
    buffer_store_dword v6, v22, s[12:15], s17 offen sc1
    s_cmp_ge_i32 s31, 63
    s_cbranch_scc1 L_exit
    s_waitcnt vmcnt(1)
    v_cmp_gt_i32 vcc, s32, v5
    s_sub_u32 s43, s43, 1
    s_cmp_lt_i32 s43, 0
    s_cbranch_scc1 Lffa_rdy1
    s_and_b64 vcc, vcc, s[18:19]
    s_cbranch_scc0 Lffa_rdy1
Lffa_spin1:
    buffer_load_dword v5, v4, s[4:7], s16 offen sc1
    s_waitcnt vmcnt(0)
    v_cmp_gt_i32 vcc, s32, v5
    s_sub_u32 s43, s43, 1
    s_cmp_lt_i32 s43, 0
    s_cbranch_scc1 Lffa_rdy1
    s_and_b64 vcc, vcc, s[18:19]
    s_cbranch_scc0 Lffa_rdy1
    s_sleep 8
    s_branch Lffa_spin1
Lffa_rdy1:
    s_add_u32 s16, s16, 8192
    buffer_load_dword v5, v4, s[4:7], s16 offen sc1
    s_mov_b32 s10, s6
    s_add_u32 m0, s34, 0
    s_nop 0
    buffer_load_dwordx4 v1, s[8:11], s33 offen offset:0 sc1 lds
    buffer_load_dwordx4 v1, s[8:11], s33 offen offset:1024 sc1 lds
    buffer_load_dwordx4 v1, s[8:11], s33 offen offset:2048 sc1 lds
    buffer_load_dwordx4 v1, s[8:11], s33 offen offset:3072 sc1 lds
    s_add_u32 m0, s34, 4096
    s_add_u32 s37, s33, 4096
    buffer_load_dwordx4 v1, s[8:11], s37 offen offset:0 sc1 lds
    buffer_load_dwordx4 v1, s[8:11], s37 offen offset:1024 sc1 lds
    buffer_load_dwordx4 v1, s[8:11], s37 offen offset:2048 sc1 lds
    buffer_load_dwordx4 v1, s[8:11], s37 offen offset:3072 sc1 lds
    s_add_u32 m0, s34, 8192
    s_add_u32 s37, s33, 8192
    buffer_load_dwordx4 v1, s[8:11], s37 offen offset:0 sc1 lds
    s_waitcnt vmcnt(9)
    s_add_u32 s32, s32, 1
    s_add_u32 s33, s33, 36864
    s_add_u32 s34, s34, 36864
    s_cmp_ge_u32 s34, 147456
    s_cselect_b32 s38, 147456, 0
    s_sub_u32 s34, s34, s38
    v_cmp_gt_i32 vcc, s32, v5
    s_nop 0
    s_and_b64 vcc, vcc, s[18:19]
    s_cselect_b32 s10, 0, s6
    s_add_u32 m0, s34, 0
    s_nop 0
    buffer_load_dwordx4 v1, s[8:11], s33 offen offset:0 sc1 lds
    buffer_load_dwordx4 v1, s[8:11], s33 offen offset:1024 sc1 lds
    buffer_load_dwordx4 v1, s[8:11], s33 offen offset:2048 sc1 lds
    buffer_load_dwordx4 v1, s[8:11], s33 offen offset:3072 sc1 lds
    s_waitcnt vmcnt(4)
Lffa_go1:
    s_mov_b32 s14, 0
    s_barrier
    ds_read_b128 v[40:43], v2 offset:0
    ds_read_b128 v[44:47], v2 offset:1024
    ds_read_b128 v[48:51], v2 offset:2048
    s_branch Lffa_body0
Lffb_start:
    s_mov_b32 s12, s76
    s_mov_b32 s13, s77
    s_mov_b32 s14, 0x700000
    s_mov_b32 s15, 0x00020000
    v_lshrrev_b32 v24, 3, v0
    v_mul_u32_u24 v24, 2048, v24
    v_bfe_u32 v25, v0, 4, 2
    v_lshlrev_b32 v25, 1, v25
    v_and_b32 v26, 7, v0
    v_xor_b32 v25, v25, v26
    v_lshl_add_u32 v40, v25, 4, v24
    v_add_u32 v41, 15360, v40
    s_sub_u32 s38, s29, 44
    s_and_b32 s39, s38, 3
    s_lshr_b32 s38, s38, 2
    s_mul_i32 s86, s38, 0x180000
    s_mul_i32 s53, s39, 0x200
    s_add_u32 s86, s86, s53
    s_mul_i32 s37, s30, 32768
    s_add_u32 s86, s86, s37
    s_lshl_b32 s87, s30, 11
    s_add_u32 m0, s87, 0
    s_add_u32 s37, s86, 0
    buffer_load_dwordx4 v40, s[12:15], s37 offen lds
    buffer_load_dwordx4 v41, s[12:15], s37 offen offset:1024 lds
    s_add_u32 m0, s87, 8192
    s_add_u32 s37, s86, 128
    buffer_load_dwordx4 v40, s[12:15], s37 offen lds
    buffer_load_dwordx4 v41, s[12:15], s37 offen offset:1024 lds
    s_add_u32 m0, s87, 16384
    s_add_u32 s37, s86, 256
    buffer_load_dwordx4 v40, s[12:15], s37 offen lds
    buffer_load_dwordx4 v41, s[12:15], s37 offen offset:1024 lds
    s_add_u32 m0, s87, 24576
    s_add_u32 s37, s86, 384
    buffer_load_dwordx4 v40, s[12:15], s37 offen lds
    buffer_load_dwordx4 v41, s[12:15], s37 offen offset:1024 lds
    s_add_u32 m0, s87, 32768
    s_add_u32 s37, s86, 131072
    buffer_load_dwordx4 v40, s[12:15], s37 offen lds
    buffer_load_dwordx4 v41, s[12:15], s37 offen offset:1024 lds
    s_add_u32 m0, s87, 40960
    s_add_u32 s37, s86, 131200
    buffer_load_dwordx4 v40, s[12:15], s37 offen lds
    buffer_load_dwordx4 v41, s[12:15], s37 offen offset:1024 lds
    s_add_u32 m0, s87, 49152
    s_add_u32 s37, s86, 131328
    buffer_load_dwordx4 v40, s[12:15], s37 offen lds
    buffer_load_dwordx4 v41, s[12:15], s37 offen offset:1024 lds
    s_add_u32 m0, s87, 57344
    s_add_u32 s37, s86, 131456
    buffer_load_dwordx4 v40, s[12:15], s37 offen lds
    buffer_load_dwordx4 v41, s[12:15], s37 offen offset:1024 lds
    s_add_u32 m0, s87, 65536
    s_add_u32 s37, s86, 262144
    buffer_load_dwordx4 v40, s[12:15], s37 offen lds
    buffer_load_dwordx4 v41, s[12:15], s37 offen offset:1024 lds
    s_add_u32 m0, s87, 73728
    s_add_u32 s37, s86, 262272
    buffer_load_dwordx4 v40, s[12:15], s37 offen lds
    buffer_load_dwordx4 v41, s[12:15], s37 offen offset:1024 lds
    s_add_u32 m0, s87, 81920
    s_add_u32 s37, s86, 262400
    buffer_load_dwordx4 v40, s[12:15], s37 offen lds
    buffer_load_dwordx4 v41, s[12:15], s37 offen offset:1024 lds
    s_add_u32 m0, s87, 90112
    s_add_u32 s37, s86, 262528
    buffer_load_dwordx4 v40, s[12:15], s37 offen lds
    buffer_load_dwordx4 v41, s[12:15], s37 offen offset:1024 lds
    s_add_u32 m0, s87, 98304
    s_add_u32 s37, s86, 393216
    buffer_load_dwordx4 v40, s[12:15], s37 offen lds
    buffer_load_dwordx4 v41, s[12:15], s37 offen offset:1024 lds
    s_add_u32 m0, s87, 106496
    s_add_u32 s37, s86, 393344
    buffer_load_dwordx4 v40, s[12:15], s37 offen lds
    buffer_load_dwordx4 v41, s[12:15], s37 offen offset:1024 lds
    s_add_u32 m0, s87, 114688
    s_add_u32 s37, s86, 393472
    buffer_load_dwordx4 v40, s[12:15], s37 offen lds
    buffer_load_dwordx4 v41, s[12:15], s37 offen offset:1024 lds
    s_add_u32 m0, s87, 122880
    s_add_u32 s37, s86, 393600
    buffer_load_dwordx4 v40, s[12:15], s37 offen lds
    buffer_load_dwordx4 v41, s[12:15], s37 offen offset:1024 lds
    v_bfe_u32 v24, v0, 3, 2
    v_and_b32 v25, 3, v0
    v_lshlrev_b32 v25, 3, v25
    v_lshrrev_b32 v26, 2, v0
    v_lshl_add_u32 v26, v26, 7, v25
    v_lshrrev_b32 v27, 5, v0
    v_lshl_add_u32 v27, v27, 10, v26
    s_mov_b32 s37, s30
    s_mov_b32 s38, 0
    s_lshl_b32 s37, s37, 13
    v_xor_b32 v28, s38, v24
    v_lshl_add_u32 v28, v28, 5, s37
    v_add_u32 v42, v28, v26
    v_add_u32 v46, v28, v27
    s_mov_b32 s37, s30
    s_mov_b32 s38, 1
    s_lshl_b32 s37, s37, 13
    v_xor_b32 v28, s38, v24
    v_lshl_add_u32 v28, v28, 5, s37
    v_add_u32 v43, v28, v26
    v_add_u32 v47, v28, v27
    s_mov_b32 s37, s30
    s_mov_b32 s38, 2
    s_lshl_b32 s37, s37, 13
    v_xor_b32 v28, s38, v24
    v_lshl_add_u32 v28, v28, 5, s37
    v_add_u32 v44, v28, v26
    v_add_u32 v48, v28, v27
    s_mov_b32 s37, s30
    s_mov_b32 s38, 3
    s_lshl_b32 s37, s37, 13
    v_xor_b32 v28, s38, v24
    v_lshl_add_u32 v28, v28, 5, s37
    v_add_u32 v45, v28, v26
    v_add_u32 v49, v28, v27
    s_sub_u32 s38, s29, 44
    s_and_b32 s39, s38, 3
    s_lshr_b32 s38, s38, 2
    s_mul_i32 s37, s28, 0x80000
    s_mul_i32 s53, s38, 0x200
    s_add_u32 s37, s37, s53
    s_add_u32 s37, s37, 0x6000c00
    v_min_u32 v4, 15, v0
    v_lshl_add_u32 v4, v4, 5, s37
    s_mov_b32 s32, 1
    s_mul_i32 s33, s28, 0x720000
    s_mul_i32 s53, s38, 0x6000
    s_add_u32 s33, s33, s53
    s_add_u32 s33, s33, 0x2000000
    s_mul_i32 s36, s28, 0x800000
    s_mul_i32 s53, s38, 0x8000
    s_add_u32 s36, s36, s53
    s_mul_i32 s53, s39, 0x2000
    s_add_u32 s36, s36, s53
    s_mul_i32 s53, s30, 0x800
    s_add_u32 s36, s36, s53
    s_add_u32 s36, s36, 0x3fe0000
    s_mov_b32 s31, -1
    s_mov_b32 s35, 0
    s_mov_b32 s16, 0
    v_mov_b32 v5, 0
    s_mul_i32 s17, s28, 0x80000
    s_mul_i32 s53, s29, 0x80
    s_add_u32 s17, s17, s53
    s_mul_i32 s53, s30, 0x20
    s_add_u32 s17, s17, s53
    s_add_u32 s17, s17, 0x5ffe000
    v_cmp_eq_u32 vcc, 0, v0
    v_mov_b32 v64, 0x40000000
    s_nop 0
    v_cndmask_b32 v64, v64, v0, vcc
    v_mov_b32 v2, v1
    s_mul_i32 s34, s30, 6144
    s_add_u32 s33, s33, s34
    s_mov_b64 s[18:19], 0xffff
    v_mov_b32 v8, 0x40000000
    v_cndmask_b32 v4, v8, v4, s[18:19]
    v_add_u32 v50, 0, v42
    v_add_u32 v51, 0, v43
    v_add_u32 v52, 0, v44
    v_add_u32 v53, 0, v45
    s_waitcnt vmcnt(24)
    s_barrier
    ds_read_b64_tr_b16 a[0:1], v50 offset:0
    ds_read_b64_tr_b16 a[2:3], v50 offset:2048
    ds_read_b64_tr_b16 a[4:5], v51 offset:0
    ds_read_b64_tr_b16 a[6:7], v51 offset:2048
    ds_read_b64_tr_b16 a[8:9], v52 offset:0
    ds_read_b64_tr_b16 a[10:11], v52 offset:2048
    ds_read_b64_tr_b16 a[12:13], v53 offset:0
    ds_read_b64_tr_b16 a[14:15], v53 offset:2048
    ds_read_b64_tr_b16 a[16:17], v50 offset:4096
    ds_read_b64_tr_b16 a[18:19], v50 offset:6144
    ds_read_b64_tr_b16 a[20:21], v51 offset:4096
    ds_read_b64_tr_b16 a[22:23], v51 offset:6144
    ds_read_b64_tr_b16 a[24:25], v52 offset:4096
    ds_read_b64_tr_b16 a[26:27], v52 offset:6144
    ds_read_b64_tr_b16 a[28:29], v53 offset:4096
    ds_read_b64_tr_b16 a[30:31], v53 offset:6144
    s_add_u32 m0, s87, 131072
    s_add_u32 s37, s86, 524288
    buffer_load_dwordx4 v40, s[12:15], s37 offen lds
    buffer_load_dwordx4 v41, s[12:15], s37 offen offset:1024 lds
    s_add_u32 m0, s87, 139264
    s_add_u32 s37, s86, 524416
    buffer_load_dwordx4 v40, s[12:15], s37 offen lds
    buffer_load_dwordx4 v41, s[12:15], s37 offen offset:1024 lds
    s_add_u32 m0, s87, 147456
    s_add_u32 s37, s86, 524544
    buffer_load_dwordx4 v40, s[12:15], s37 offen lds
    buffer_load_dwordx4 v41, s[12:15], s37 offen offset:1024 lds
    s_add_u32 m0, s87, 155648
    s_add_u32 s37, s86, 524672
    buffer_load_dwordx4 v40, s[12:15], s37 offen lds
    buffer_load_dwordx4 v41, s[12:15], s37 offen offset:1024 lds
    s_waitcnt lgkmcnt(0)
    v_add_u32 v50, 32768, v42
    v_add_u32 v51, 32768, v43
    v_add_u32 v52, 32768, v44
    v_add_u32 v53, 32768, v45
    s_waitcnt vmcnt(24)
    s_barrier
    ds_read_b64_tr_b16 a[32:33], v50 offset:0
    ds_read_b64_tr_b16 a[34:35], v50 offset:2048
    ds_read_b64_tr_b16 a[36:37], v51 offset:0
    ds_read_b64_tr_b16 a[38:39], v51 offset:2048
    ds_read_b64_tr_b16 a[40:41], v52 offset:0
    ds_read_b64_tr_b16 a[42:43], v52 offset:2048
    ds_read_b64_tr_b16 a[44:45], v53 offset:0
    ds_read_b64_tr_b16 a[46:47], v53 offset:2048
    ds_read_b64_tr_b16 a[48:49], v50 offset:4096
    ds_read_b64_tr_b16 a[50:51], v50 offset:6144
    ds_read_b64_tr_b16 a[52:53], v51 offset:4096
    ds_read_b64_tr_b16 a[54:55], v51 offset:6144
    ds_read_b64_tr_b16 a[56:57], v52 offset:4096
    ds_read_b64_tr_b16 a[58:59], v52 offset:6144
    ds_read_b64_tr_b16 a[60:61], v53 offset:4096
    ds_read_b64_tr_b16 a[62:63], v53 offset:6144
    s_add_u32 m0, s87, 0
    s_add_u32 s37, s86, 655360
    buffer_load_dwordx4 v40, s[12:15], s37 offen lds
    buffer_load_dwordx4 v41, s[12:15], s37 offen offset:1024 lds
    s_add_u32 m0, s87, 8192
    s_add_u32 s37, s86, 655488
    buffer_load_dwordx4 v40, s[12:15], s37 offen lds
    buffer_load_dwordx4 v41, s[12:15], s37 offen offset:1024 lds
    s_add_u32 m0, s87, 16384
    s_add_u32 s37, s86, 655616
    buffer_load_dwordx4 v40, s[12:15], s37 offen lds
    buffer_load_dwordx4 v41, s[12:15], s37 offen offset:1024 lds
    s_add_u32 m0, s87, 24576
    s_add_u32 s37, s86, 655744
    buffer_load_dwordx4 v40, s[12:15], s37 offen lds
    buffer_load_dwordx4 v41, s[12:15], s37 offen offset:1024 lds
    s_waitcnt lgkmcnt(0)
    v_add_u32 v50, 65536, v46
    v_add_u32 v51, 65536, v47
    v_add_u32 v52, 65536, v48
    v_add_u32 v53, 65536, v49
    s_waitcnt vmcnt(24)
    s_barrier
    ds_read_b64_tr_b16 a[64:65], v50 offset:0
    ds_read_b64_tr_b16 a[66:67], v50 offset:1024
    ds_read_b64_tr_b16 a[68:69], v51 offset:0
    ds_read_b64_tr_b16 a[70:71], v51 offset:1024
    ds_read_b64_tr_b16 a[72:73], v52 offset:0
    ds_read_b64_tr_b16 a[74:75], v52 offset:1024
    ds_read_b64_tr_b16 a[76:77], v53 offset:0
    ds_read_b64_tr_b16 a[78:79], v53 offset:1024
    ds_read_b64_tr_b16 a[80:81], v50 offset:4096
    ds_read_b64_tr_b16 a[82:83], v50 offset:5120
    ds_read_b64_tr_b16 a[84:85], v51 offset:4096
    ds_read_b64_tr_b16 a[86:87], v51 offset:5120
    ds_read_b64_tr_b16 a[88:89], v52 offset:4096
    ds_read_b64_tr_b16 a[90:91], v52 offset:5120
    ds_read_b64_tr_b16 a[92:93], v53 offset:4096
    ds_read_b64_tr_b16 a[94:95], v53 offset:5120
    s_add_u32 m0, s87, 32768
    s_add_u32 s37, s86, 786432
    buffer_load_dwordx4 v40, s[12:15], s37 offen lds
    buffer_load_dwordx4 v41, s[12:15], s37 offen offset:1024 lds
    s_add_u32 m0, s87, 40960
    s_add_u32 s37, s86, 786560
    buffer_load_dwordx4 v40, s[12:15], s37 offen lds
    buffer_load_dwordx4 v41, s[12:15], s37 offen offset:1024 lds
    s_add_u32 m0, s87, 49152
    s_add_u32 s37, s86, 786688
    buffer_load_dwordx4 v40, s[12:15], s37 offen lds
    buffer_load_dwordx4 v41, s[12:15], s37 offen offset:1024 lds
    s_add_u32 m0, s87, 57344
    s_add_u32 s37, s86, 786816
    buffer_load_dwordx4 v40, s[12:15], s37 offen lds
    buffer_load_dwordx4 v41, s[12:15], s37 offen offset:1024 lds
    s_waitcnt lgkmcnt(0)
    v_add_u32 v50, 98304, v42
    v_add_u32 v51, 98304, v43
    v_add_u32 v52, 98304, v44
    v_add_u32 v53, 98304, v45
    s_waitcnt vmcnt(24)
    s_barrier
    ds_read_b64_tr_b16 a[96:97], v50 offset:0
    ds_read_b64_tr_b16 a[98:99], v50 offset:2048
    ds_read_b64_tr_b16 a[100:101], v51 offset:0
    ds_read_b64_tr_b16 a[102:103], v51 offset:2048
    ds_read_b64_tr_b16 a[104:105], v52 offset:0
    ds_read_b64_tr_b16 a[106:107], v52 offset:2048
    ds_read_b64_tr_b16 a[108:109], v53 offset:0
    ds_read_b64_tr_b16 a[110:111], v53 offset:2048
    ds_read_b64_tr_b16 a[112:113], v50 offset:4096
    ds_read_b64_tr_b16 a[114:115], v50 offset:6144
    ds_read_b64_tr_b16 a[116:117], v51 offset:4096
    ds_read_b64_tr_b16 a[118:119], v51 offset:6144
    ds_read_b64_tr_b16 a[120:121], v52 offset:4096
    ds_read_b64_tr_b16 a[122:123], v52 offset:6144
    ds_read_b64_tr_b16 a[124:125], v53 offset:4096
    ds_read_b64_tr_b16 a[126:127], v53 offset:6144
    s_add_u32 m0, s87, 65536
    s_add_u32 s37, s86, 917504
    buffer_load_dwordx4 v40, s[12:15], s37 offen lds
    buffer_load_dwordx4 v41, s[12:15], s37 offen offset:1024 lds
    s_add_u32 m0, s87, 73728
    s_add_u32 s37, s86, 917632
    buffer_load_dwordx4 v40, s[12:15], s37 offen lds
    buffer_load_dwordx4 v41, s[12:15], s37 offen offset:1024 lds
    s_add_u32 m0, s87, 81920
    s_add_u32 s37, s86, 917760
    buffer_load_dwordx4 v40, s[12:15], s37 offen lds
    buffer_load_dwordx4 v41, s[12:15], s37 offen offset:1024 lds
    s_add_u32 m0, s87, 90112
    s_add_u32 s37, s86, 917888
    buffer_load_dwordx4 v40, s[12:15], s37 offen lds
    buffer_load_dwordx4 v41, s[12:15], s37 offen offset:1024 lds
    s_waitcnt lgkmcnt(0)
    v_add_u32 v50, 131072, v42
    v_add_u32 v51, 131072, v43
    v_add_u32 v52, 131072, v44
    v_add_u32 v53, 131072, v45
    s_waitcnt vmcnt(24)
    s_barrier
    ds_read_b64_tr_b16 a[128:129], v50 offset:0
    ds_read_b64_tr_b16 a[130:131], v50 offset:2048
    ds_read_b64_tr_b16 a[132:133], v51 offset:0
    ds_read_b64_tr_b16 a[134:135], v51 offset:2048
    ds_read_b64_tr_b16 a[136:137], v52 offset:0
    ds_read_b64_tr_b16 a[138:139], v52 offset:2048
    ds_read_b64_tr_b16 a[140:141], v53 offset:0
    ds_read_b64_tr_b16 a[142:143], v53 offset:2048
    ds_read_b64_tr_b16 a[144:145], v50 offset:4096
    ds_read_b64_tr_b16 a[146:147], v50 offset:6144
    ds_read_b64_tr_b16 a[148:149], v51 offset:4096
    ds_read_b64_tr_b16 a[150:151], v51 offset:6144
    ds_read_b64_tr_b16 a[152:153], v52 offset:4096
    ds_read_b64_tr_b16 a[154:155], v52 offset:6144
    ds_read_b64_tr_b16 a[156:157], v53 offset:4096
    ds_read_b64_tr_b16 a[158:159], v53 offset:6144
    s_add_u32 m0, s87, 98304
    s_add_u32 s37, s86, 1048576
    buffer_load_dwordx4 v40, s[12:15], s37 offen lds
    buffer_load_dwordx4 v41, s[12:15], s37 offen offset:1024 lds
    s_add_u32 m0, s87, 106496
    s_add_u32 s37, s86, 1048704
    buffer_load_dwordx4 v40, s[12:15], s37 offen lds
    buffer_load_dwordx4 v41, s[12:15], s37 offen offset:1024 lds
    s_add_u32 m0, s87, 114688
    s_add_u32 s37, s86, 1048832
    buffer_load_dwordx4 v40, s[12:15], s37 offen lds
    buffer_load_dwordx4 v41, s[12:15], s37 offen offset:1024 lds
    s_add_u32 m0, s87, 122880
    s_add_u32 s37, s86, 1048960
    buffer_load_dwordx4 v40, s[12:15], s37 offen lds
    buffer_load_dwordx4 v41, s[12:15], s37 offen offset:1024 lds
    s_waitcnt lgkmcnt(0)
    v_add_u32 v50, 0, v46
    v_add_u32 v51, 0, v47
    v_add_u32 v52, 0, v48
    v_add_u32 v53, 0, v49
    s_waitcnt vmcnt(24)
    s_barrier
    ds_read_b64_tr_b16 a[160:161], v50 offset:0
    ds_read_b64_tr_b16 a[162:163], v50 offset:1024
    ds_read_b64_tr_b16 a[164:165], v51 offset:0
    ds_read_b64_tr_b16 a[166:167], v51 offset:1024
    ds_read_b64_tr_b16 a[168:169], v52 offset:0
    ds_read_b64_tr_b16 a[170:171], v52 offset:1024
    ds_read_b64_tr_b16 a[172:173], v53 offset:0
    ds_read_b64_tr_b16 a[174:175], v53 offset:1024
    ds_read_b64_tr_b16 a[176:177], v50 offset:4096
    ds_read_b64_tr_b16 a[178:179], v50 offset:5120
    ds_read_b64_tr_b16 a[180:181], v51 offset:4096
    ds_read_b64_tr_b16 a[182:183], v51 offset:5120
    ds_read_b64_tr_b16 a[184:185], v52 offset:4096
    ds_read_b64_tr_b16 a[186:187], v52 offset:5120
    ds_read_b64_tr_b16 a[188:189], v53 offset:4096
    ds_read_b64_tr_b16 a[190:191], v53 offset:5120
    s_add_u32 m0, s87, 131072
    s_add_u32 s37, s86, 1179648
    buffer_load_dwordx4 v40, s[12:15], s37 offen lds
    buffer_load_dwordx4 v41, s[12:15], s37 offen offset:1024 lds
    s_add_u32 m0, s87, 139264
    s_add_u32 s37, s86, 1179776
    buffer_load_dwordx4 v40, s[12:15], s37 offen lds
    buffer_load_dwordx4 v41, s[12:15], s37 offen offset:1024 lds
    s_add_u32 m0, s87, 147456
    s_add_u32 s37, s86, 1179904
    buffer_load_dwordx4 v40, s[12:15], s37 offen lds
    buffer_load_dwordx4 v41, s[12:15], s37 offen offset:1024 lds
    s_add_u32 m0, s87, 155648
    s_add_u32 s37, s86, 1180032
    buffer_load_dwordx4 v40, s[12:15], s37 offen lds
    buffer_load_dwordx4 v41, s[12:15], s37 offen offset:1024 lds
    s_waitcnt lgkmcnt(0)
    v_add_u32 v50, 32768, v42
    v_add_u32 v51, 32768, v43
    v_add_u32 v52, 32768, v44
    v_add_u32 v53, 32768, v45
    s_waitcnt vmcnt(24)
    s_barrier
    ds_read_b64_tr_b16 a[192:193], v50 offset:0
    ds_read_b64_tr_b16 a[194:195], v50 offset:2048
    ds_read_b64_tr_b16 a[196:197], v51 offset:0
    ds_read_b64_tr_b16 a[198:199], v51 offset:2048
    ds_read_b64_tr_b16 a[200:201], v52 offset:0
    ds_read_b64_tr_b16 a[202:203], v52 offset:2048
    ds_read_b64_tr_b16 a[204:205], v53 offset:0
    ds_read_b64_tr_b16 a[206:207], v53 offset:2048
    ds_read_b64_tr_b16 a[208:209], v50 offset:4096
    ds_read_b64_tr_b16 a[210:211], v50 offset:6144
    ds_read_b64_tr_b16 a[212:213], v51 offset:4096
    ds_read_b64_tr_b16 a[214:215], v51 offset:6144
    ds_read_b64_tr_b16 a[216:217], v52 offset:4096
    ds_read_b64_tr_b16 a[218:219], v52 offset:6144
    ds_read_b64_tr_b16 a[220:221], v53 offset:4096
    ds_read_b64_tr_b16 a[222:223], v53 offset:6144
    s_add_u32 m0, s87, 0
    s_add_u32 s37, s86, 1310720
    buffer_load_dwordx4 v40, s[12:15], s37 offen lds
    buffer_load_dwordx4 v41, s[12:15], s37 offen offset:1024 lds
    s_add_u32 m0, s87, 8192
    s_add_u32 s37, s86, 1310848
    buffer_load_dwordx4 v40, s[12:15], s37 offen lds
    buffer_load_dwordx4 v41, s[12:15], s37 offen offset:1024 lds
    s_add_u32 m0, s87, 16384
    s_add_u32 s37, s86, 1310976
    buffer_load_dwordx4 v40, s[12:15], s37 offen lds
    buffer_load_dwordx4 v41, s[12:15], s37 offen offset:1024 lds
    s_add_u32 m0, s87, 24576
    s_add_u32 s37, s86, 1311104
    buffer_load_dwordx4 v40, s[12:15], s37 offen lds
    buffer_load_dwordx4 v41, s[12:15], s37 offen offset:1024 lds
    s_waitcnt lgkmcnt(0)
    v_add_u32 v50, 65536, v42
    v_add_u32 v51, 65536, v43
    v_add_u32 v52, 65536, v44
    v_add_u32 v53, 65536, v45
    s_waitcnt vmcnt(24)
    s_barrier
    ds_read_b64_tr_b16 a[224:225], v50 offset:0
    ds_read_b64_tr_b16 a[226:227], v50 offset:2048
    ds_read_b64_tr_b16 a[228:229], v51 offset:0
    ds_read_b64_tr_b16 a[230:231], v51 offset:2048
    ds_read_b64_tr_b16 a[232:233], v52 offset:0
    ds_read_b64_tr_b16 a[234:235], v52 offset:2048
    ds_read_b64_tr_b16 a[236:237], v53 offset:0
    ds_read_b64_tr_b16 a[238:239], v53 offset:2048
    ds_read_b64_tr_b16 a[240:241], v50 offset:4096
    ds_read_b64_tr_b16 a[242:243], v50 offset:6144
    ds_read_b64_tr_b16 a[244:245], v51 offset:4096
    ds_read_b64_tr_b16 a[246:247], v51 offset:6144
    ds_read_b64_tr_b16 a[248:249], v52 offset:4096
    ds_read_b64_tr_b16 a[250:251], v52 offset:6144
    ds_read_b64_tr_b16 a[252:253], v53 offset:4096
    ds_read_b64_tr_b16 a[254:255], v53 offset:6144
    s_add_u32 m0, s87, 32768
    s_add_u32 s37, s86, 1441792
    buffer_load_dwordx4 v40, s[12:15], s37 offen lds
    buffer_load_dwordx4 v41, s[12:15], s37 offen offset:1024 lds
    s_add_u32 m0, s87, 40960
    s_add_u32 s37, s86, 1441920
    buffer_load_dwordx4 v40, s[12:15], s37 offen lds
    buffer_load_dwordx4 v41, s[12:15], s37 offen offset:1024 lds
    s_add_u32 m0, s87, 49152
    s_add_u32 s37, s86, 1442048
    buffer_load_dwordx4 v40, s[12:15], s37 offen lds
    buffer_load_dwordx4 v41, s[12:15], s37 offen offset:1024 lds
    s_add_u32 m0, s87, 57344
    s_add_u32 s37, s86, 1442176
    buffer_load_dwordx4 v40, s[12:15], s37 offen lds
    buffer_load_dwordx4 v41, s[12:15], s37 offen offset:1024 lds
    s_waitcnt lgkmcnt(0)
    v_add_u32 v50, 98304, v46
    v_add_u32 v51, 98304, v47
    v_add_u32 v52, 98304, v48
    v_add_u32 v53, 98304, v49
    s_waitcnt vmcnt(24)
    s_barrier
    ds_read_b64_tr_b16 v[128:129], v50 offset:0
    ds_read_b64_tr_b16 v[130:131], v50 offset:1024
    ds_read_b64_tr_b16 v[132:133], v51 offset:0
    ds_read_b64_tr_b16 v[134:135], v51 offset:1024
    ds_read_b64_tr_b16 v[136:137], v52 offset:0
    ds_read_b64_tr_b16 v[138:139], v52 offset:1024
    ds_read_b64_tr_b16 v[140:141], v53 offset:0
    ds_read_b64_tr_b16 v[142:143], v53 offset:1024
    ds_read_b64_tr_b16 v[144:145], v50 offset:4096
    ds_read_b64_tr_b16 v[146:147], v50 offset:5120
    ds_read_b64_tr_b16 v[148:149], v51 offset:4096
    ds_read_b64_tr_b16 v[150:151], v51 offset:5120
    ds_read_b64_tr_b16 v[152:153], v52 offset:4096
    ds_read_b64_tr_b16 v[154:155], v52 offset:5120
    ds_read_b64_tr_b16 v[156:157], v53 offset:4096
    ds_read_b64_tr_b16 v[158:159], v53 offset:5120
    s_waitcnt lgkmcnt(0)
    v_add_u32 v50, 131072, v42
    v_add_u32 v51, 131072, v43
    v_add_u32 v52, 131072, v44
    v_add_u32 v53, 131072, v45
    s_waitcnt vmcnt(16)
    s_barrier
    ds_read_b64_tr_b16 v[160:161], v50 offset:0
    ds_read_b64_tr_b16 v[162:163], v50 offset:2048
    ds_read_b64_tr_b16 v[164:165], v51 offset:0
    ds_read_b64_tr_b16 v[166:167], v51 offset:2048
    ds_read_b64_tr_b16 v[168:169], v52 offset:0
    ds_read_b64_tr_b16 v[170:171], v52 offset:2048
    ds_read_b64_tr_b16 v[172:173], v53 offset:0
    ds_read_b64_tr_b16 v[174:175], v53 offset:2048
    ds_read_b64_tr_b16 v[176:177], v50 offset:4096
    ds_read_b64_tr_b16 v[178:179], v50 offset:6144
    ds_read_b64_tr_b16 v[180:181], v51 offset:4096
    ds_read_b64_tr_b16 v[182:183], v51 offset:6144
    ds_read_b64_tr_b16 v[184:185], v52 offset:4096
    ds_read_b64_tr_b16 v[186:187], v52 offset:6144
    ds_read_b64_tr_b16 v[188:189], v53 offset:4096
    ds_read_b64_tr_b16 v[190:191], v53 offset:6144
    s_waitcnt lgkmcnt(0)
    v_add_u32 v50, 0, v42
    v_add_u32 v51, 0, v43
    v_add_u32 v52, 0, v44
    v_add_u32 v53, 0, v45
    s_waitcnt vmcnt(8)
    s_barrier
    ds_read_b64_tr_b16 v[192:193], v50 offset:0
    ds_read_b64_tr_b16 v[194:195], v50 offset:2048
    ds_read_b64_tr_b16 v[196:197], v51 offset:0
    ds_read_b64_tr_b16 v[198:199], v51 offset:2048
    ds_read_b64_tr_b16 v[200:201], v52 offset:0
    ds_read_b64_tr_b16 v[202:203], v52 offset:2048
    ds_read_b64_tr_b16 v[204:205], v53 offset:0
    ds_read_b64_tr_b16 v[206:207], v53 offset:2048
    ds_read_b64_tr_b16 v[208:209], v50 offset:4096
    ds_read_b64_tr_b16 v[210:211], v50 offset:6144
    ds_read_b64_tr_b16 v[212:213], v51 offset:4096
    ds_read_b64_tr_b16 v[214:215], v51 offset:6144
    ds_read_b64_tr_b16 v[216:217], v52 offset:4096
    ds_read_b64_tr_b16 v[218:219], v52 offset:6144
    ds_read_b64_tr_b16 v[220:221], v53 offset:4096
    ds_read_b64_tr_b16 v[222:223], v53 offset:6144
    s_waitcnt lgkmcnt(0)
    v_add_u32 v50, 32768, v46
    v_add_u32 v51, 32768, v47
    v_add_u32 v52, 32768, v48
    v_add_u32 v53, 32768, v49
    s_waitcnt vmcnt(0)
    s_barrier
    ds_read_b64_tr_b16 v[224:225], v50 offset:0
    ds_read_b64_tr_b16 v[226:227], v50 offset:1024
    ds_read_b64_tr_b16 v[228:229], v51 offset:0
    ds_read_b64_tr_b16 v[230:231], v51 offset:1024
    ds_read_b64_tr_b16 v[232:233], v52 offset:0
    ds_read_b64_tr_b16 v[234:235], v52 offset:1024
    ds_read_b64_tr_b16 v[236:237], v53 offset:0
    ds_read_b64_tr_b16 v[238:239], v53 offset:1024
    ds_read_b64_tr_b16 v[240:241], v50 offset:4096
    ds_read_b64_tr_b16 v[242:243], v50 offset:5120
    ds_read_b64_tr_b16 v[244:245], v51 offset:4096
    ds_read_b64_tr_b16 v[246:247], v51 offset:5120
    ds_read_b64_tr_b16 v[248:249], v52 offset:4096
    ds_read_b64_tr_b16 v[250:251], v52 offset:5120
    ds_read_b64_tr_b16 v[252:253], v53 offset:4096
    ds_read_b64_tr_b16 v[254:255], v53 offset:5120
    s_waitcnt lgkmcnt(0)
    s_mov_b32 s12, s84
    s_mov_b32 s13, s85
    s_mov_b32 s14, 0x6200000
    s_mov_b32 s15, 0x00020000
    s_barrier
    s_mov_b32 s20, s82
    s_mov_b32 s21, s83
    s_mov_b32 s22, 0x100
    s_mov_b32 s23, 0x00020000
    v_and_b32 v8, 15, v0
    v_lshlrev_b32 v8, 4, v8
    buffer_load_dword v9, v8, s[20:23], 0 offen sc1
    s_waitcnt vmcnt(0)
Lffb_wa:
    v_cmp_gt_u32 vcc, 8, v9
    s_sub_u32 s43, s43, 1
    s_cmp_lt_i32 s43, 0
    s_cbranch_scc1 Lffb_all
    s_cbranch_vccz Lffb_all
    s_sleep 2
    buffer_load_dword v9, v8, s[20:23], 0 offen sc1
    s_waitcnt vmcnt(0)
    s_branch Lffb_wa
Lffb_all:
    s_branch Lffb_spin1
    .p2align 6
Lffb_body0:
    s_waitcnt lgkmcnt(2)
    v_mfma_f32_16x16x32_bf16 v[8:11], a[0:3], v[40:43], 0
    ds_read_b128 v[52:55], v2 offset:3072
    s_add_u32 s16, s16, 8192
    v_mfma_f32_16x16x32_bf16 v[12:15], a[4:7], v[40:43], 0
    s_cmp_eq_u32 s10, 0
    s_cbranch_scc1 Lffb_slow0
    v_mfma_f32_16x16x32_bf16 v[16:19], a[8:11], v[40:43], 0
    buffer_load_dwordx4 v1, s[8:11], s33 offen offset:2048 sc1 lds
    v_mfma_f32_16x16x32_bf16 v[20:23], a[12:15], v[40:43], 0
    s_waitcnt lgkmcnt(2)
    v_cvt_pk_bf16_f32 v56, v24, v25
    v_cvt_pk_bf16_f32 v57, v26, v27
    v_mfma_f32_16x16x32_bf16 v[8:11], a[16:19], v[44:47], v[8:11]
    ds_read_b128 v[40:43], v2 offset:4096
    v_cvt_pk_bf16_f32 v58, v28, v29
    v_mfma_f32_16x16x32_bf16 v[12:15], a[20:23], v[44:47], v[12:15]
    s_add_u32 s31, s31, 1
    v_mov_b32 v6, s31
    v_cvt_pk_bf16_f32 v59, v30, v31
    v_mfma_f32_16x16x32_bf16 v[16:19], a[24:27], v[44:47], v[16:19]
    buffer_store_dwordx4 v[56:59], v1, s[12:15], s36 offen offset:0 sc1
    v_cvt_pk_bf16_f32 v60, v32, v33
    v_mfma_f32_16x16x32_bf16 v[20:23], a[28:31], v[44:47], v[20:23]
    s_waitcnt lgkmcnt(2)
    v_cvt_pk_bf16_f32 v61, v34, v35
    v_cvt_pk_bf16_f32 v62, v36, v37
    v_mfma_f32_16x16x32_bf16 v[8:11], a[32:35], v[48:51], v[8:11]
    ds_read_b128 v[44:47], v2 offset:5120
    v_cvt_pk_bf16_f32 v63, v38, v39
    v_mfma_f32_16x16x32_bf16 v[12:15], a[36:39], v[48:51], v[12:15]
    s_add_u32 s35, s35, 36864
    s_cmp_eq_u32 s35, 147456
    s_cselect_b32 s35, 0, s35
    v_mfma_f32_16x16x32_bf16 v[16:19], a[40:43], v[48:51], v[16:19]
    buffer_store_dwordx4 v[60:63], v1, s[12:15], s36 offen offset:1024 sc1
    v_add_u32 v3, s35, v1
    v_mfma_f32_16x16x32_bf16 v[20:23], a[44:47], v[48:51], v[20:23]
    s_waitcnt lgkmcnt(2)
    s_add_u32 s36, s36, 131072
    v_mfma_f32_16x16x32_bf16 v[8:11], a[48:51], v[52:55], v[8:11]
    ds_read_b128 v[48:51], v2 offset:6144
    v_mfma_f32_16x16x32_bf16 v[12:15], a[52:55], v[52:55], v[12:15]
    v_mfma_f32_16x16x32_bf16 v[16:19], a[56:59], v[52:55], v[16:19]
    buffer_load_dwordx4 v1, s[8:11], s33 offen offset:3072 sc1 lds
    v_mfma_f32_16x16x32_bf16 v[20:23], a[60:63], v[52:55], v[20:23]
    s_waitcnt lgkmcnt(2)
    s_add_u32 m0, s34, 4096
    s_add_u32 s37, s33, 4096
    v_mfma_f32_16x16x32_bf16 v[8:11], a[64:67], v[40:43], v[8:11]
    ds_read_b128 v[52:55], v2 offset:7168
    v_mfma_f32_16x16x32_bf16 v[12:15], a[68:71], v[40:43], v[12:15]
    v_mfma_f32_16x16x32_bf16 v[16:19], a[72:75], v[40:43], v[16:19]
    buffer_load_dwordx4 v1, s[8:11], s37 offen offset:0 sc1 lds
    v_mfma_f32_16x16x32_bf16 v[20:23], a[76:79], v[40:43], v[20:23]
    s_waitcnt lgkmcnt(2)
    v_mfma_f32_16x16x32_bf16 v[8:11], a[80:83], v[44:47], v[8:11]
    ds_read_b128 v[40:43], v2 offset:8192
    v_mfma_f32_16x16x32_bf16 v[12:15], a[84:87], v[44:47], v[12:15]
    v_mfma_f32_16x16x32_bf16 v[16:19], a[88:91], v[44:47], v[16:19]
    buffer_load_dword v5, v4, s[4:7], s16 offen sc1
    v_mfma_f32_16x16x32_bf16 v[20:23], a[92:95], v[44:47], v[20:23]
    s_waitcnt lgkmcnt(2)
    v_mfma_f32_16x16x32_bf16 v[8:11], a[96:99], v[48:51], v[8:11]
    ds_read_b128 v[44:47], v2 offset:9216
    v_mfma_f32_16x16x32_bf16 v[12:15], a[100:103], v[48:51], v[12:15]
    v_mfma_f32_16x16x32_bf16 v[16:19], a[104:107], v[48:51], v[16:19]
    buffer_load_dwordx4 v1, s[8:11], s37 offen offset:1024 sc1 lds
    v_mfma_f32_16x16x32_bf16 v[20:23], a[108:111], v[48:51], v[20:23]
    s_waitcnt lgkmcnt(2)
    v_mfma_f32_16x16x32_bf16 v[8:11], a[112:115], v[52:55], v[8:11]
    ds_read_b128 v[48:51], v2 offset:10240
    v_mfma_f32_16x16x32_bf16 v[12:15], a[116:119], v[52:55], v[12:15]
    v_mfma_f32_16x16x32_bf16 v[16:19], a[120:123], v[52:55], v[16:19]
    v_mfma_f32_16x16x32_bf16 v[20:23], a[124:127], v[52:55], v[20:23]
    s_waitcnt lgkmcnt(2)
    v_mfma_f32_16x16x32_bf16 v[8:11], a[128:131], v[40:43], v[8:11]
    ds_read_b128 v[52:55], v2 offset:11264
    v_mfma_f32_16x16x32_bf16 v[12:15], a[132:135], v[40:43], v[12:15]
    v_mfma_f32_16x16x32_bf16 v[16:19], a[136:139], v[40:43], v[16:19]
    v_mfma_f32_16x16x32_bf16 v[20:23], a[140:143], v[40:43], v[20:23]
    s_waitcnt lgkmcnt(2)
    v_mfma_f32_16x16x32_bf16 v[8:11], a[144:147], v[44:47], v[8:11]
    ds_read_b128 v[40:43], v2 offset:12288
    v_mfma_f32_16x16x32_bf16 v[12:15], a[148:151], v[44:47], v[12:15]
    v_mfma_f32_16x16x32_bf16 v[16:19], a[152:155], v[44:47], v[16:19]
    v_mfma_f32_16x16x32_bf16 v[20:23], a[156:159], v[44:47], v[20:23]
    s_waitcnt lgkmcnt(2)
    v_mfma_f32_16x16x32_bf16 v[8:11], a[160:163], v[48:51], v[8:11]
    ds_read_b128 v[44:47], v2 offset:13312
    v_mfma_f32_16x16x32_bf16 v[12:15], a[164:167], v[48:51], v[12:15]
    v_mfma_f32_16x16x32_bf16 v[16:19], a[168:171], v[48:51], v[16:19]
    v_mfma_f32_16x16x32_bf16 v[20:23], a[172:175], v[48:51], v[20:23]
    s_waitcnt lgkmcnt(2)
    v_mfma_f32_16x16x32_bf16 v[8:11], a[176:179], v[52:55], v[8:11]
    ds_read_b128 v[48:51], v2 offset:14336
    v_mfma_f32_16x16x32_bf16 v[12:15], a[180:183], v[52:55], v[12:15]
    v_mfma_f32_16x16x32_bf16 v[16:19], a[184:187], v[52:55], v[16:19]
    v_mfma_f32_16x16x32_bf16 v[20:23], a[188:191], v[52:55], v[20:23]
    s_waitcnt lgkmcnt(2)
    v_mfma_f32_16x16x32_bf16 v[8:11], a[192:195], v[40:43], v[8:11]
    ds_read_b128 v[52:55], v2 offset:15360
    v_mfma_f32_16x16x32_bf16 v[12:15], a[196:199], v[40:43], v[12:15]
    v_mfma_f32_16x16x32_bf16 v[16:19], a[200:203], v[40:43], v[16:19]
    v_mfma_f32_16x16x32_bf16 v[20:23], a[204:207], v[40:43], v[20:23]
    s_waitcnt lgkmcnt(2)
    v_mfma_f32_16x16x32_bf16 v[8:11], a[208:211], v[44:47], v[8:11]
    ds_read_b128 v[40:43], v2 offset:16384
    v_mfma_f32_16x16x32_bf16 v[12:15], a[212:215], v[44:47], v[12:15]
    v_mfma_f32_16x16x32_bf16 v[16:19], a[216:219], v[44:47], v[16:19]
    v_mfma_f32_16x16x32_bf16 v[20:23], a[220:223], v[44:47], v[20:23]
    s_waitcnt lgkmcnt(2)
    v_mfma_f32_16x16x32_bf16 v[8:11], a[224:227], v[48:51], v[8:11]
    ds_read_b128 v[44:47], v2 offset:17408
    v_mfma_f32_16x16x32_bf16 v[12:15], a[228:231], v[48:51], v[12:15]
    v_mfma_f32_16x16x32_bf16 v[16:19], a[232:235], v[48:51], v[16:19]
    v_mfma_f32_16x16x32_bf16 v[20:23], a[236:239], v[48:51], v[20:23]
    s_waitcnt lgkmcnt(2)
    v_mfma_f32_16x16x32_bf16 v[8:11], a[240:243], v[52:55], v[8:11]
    ds_read_b128 v[48:51], v2 offset:18432
    s_waitcnt vmcnt(4)
    v_mfma_f32_16x16x32_bf16 v[12:15], a[244:247], v[52:55], v[12:15]
    buffer_store_dword v6, v64, s[12:15], s17 offen sc1
    s_mov_b32 s14, s6
    v_mfma_f32_16x16x32_bf16 v[16:19], a[248:251], v[52:55], v[16:19]
    s_add_u32 s17, s17, 8192
    v_mfma_f32_16x16x32_bf16 v[20:23], a[252:255], v[52:55], v[20:23]
    s_waitcnt lgkmcnt(2)
    v_mfma_f32_16x16x32_bf16 v[8:11], v[128:131], v[40:43], v[8:11]
    ds_read_b128 v[52:55], v2 offset:19456
    v_mfma_f32_16x16x32_bf16 v[12:15], v[132:135], v[40:43], v[12:15]
    v_mfma_f32_16x16x32_bf16 v[16:19], v[136:139], v[40:43], v[16:19]
    v_mfma_f32_16x16x32_bf16 v[20:23], v[140:143], v[40:43], v[20:23]
    s_waitcnt lgkmcnt(2)
    v_mfma_f32_16x16x32_bf16 v[8:11], v[144:147], v[44:47], v[8:11]
    ds_read_b128 v[40:43], v2 offset:20480
    v_mfma_f32_16x16x32_bf16 v[12:15], v[148:151], v[44:47], v[12:15]
    v_mfma_f32_16x16x32_bf16 v[16:19], v[152:155], v[44:47], v[16:19]
    v_mfma_f32_16x16x32_bf16 v[20:23], v[156:159], v[44:47], v[20:23]
    s_waitcnt lgkmcnt(2)
    v_mfma_f32_16x16x32_bf16 v[8:11], v[160:163], v[48:51], v[8:11]
    ds_read_b128 v[44:47], v2 offset:21504
    v_mfma_f32_16x16x32_bf16 v[12:15], v[164:167], v[48:51], v[12:15]
    v_mfma_f32_16x16x32_bf16 v[16:19], v[168:171], v[48:51], v[16:19]
    s_add_u32 s32, s32, 1
    s_add_u32 s33, s33, 116736
    s_add_u32 s34, s34, 36864
    v_mfma_f32_16x16x32_bf16 v[20:23], v[172:175], v[48:51], v[20:23]
    s_waitcnt lgkmcnt(2)
    s_cmp_ge_u32 s34, 147456
    s_cselect_b32 s38, 147456, 0
    v_mfma_f32_16x16x32_bf16 v[8:11], v[176:179], v[52:55], v[8:11]
    ds_read_b128 v[48:51], v2 offset:22528
    s_sub_u32 s34, s34, s38
    v_mfma_f32_16x16x32_bf16 v[12:15], v[180:183], v[52:55], v[12:15]
    v_mfma_f32_16x16x32_bf16 v[16:19], v[184:187], v[52:55], v[16:19]
    v_mfma_f32_16x16x32_bf16 v[20:23], v[188:191], v[52:55], v[20:23]
    s_waitcnt lgkmcnt(2)
    v_mfma_f32_16x16x32_bf16 v[8:11], v[192:195], v[40:43], v[8:11]
    ds_read_b128 v[52:55], v2 offset:23552
    v_mfma_f32_16x16x32_bf16 v[12:15], v[196:199], v[40:43], v[12:15]
    s_waitcnt vmcnt(1)
    s_barrier
    v_mfma_f32_16x16x32_bf16 v[16:19], v[200:203], v[40:43], v[16:19]
    v_cmp_gt_i32 vcc, s32, v5
    v_mfma_f32_16x16x32_bf16 v[20:23], v[204:207], v[40:43], v[20:23]
    s_waitcnt lgkmcnt(2)
    v_mfma_f32_16x16x32_bf16 v[8:11], v[208:211], v[44:47], v[8:11]
    ds_read_b128 v[40:43], v3 offset:0
    v_mfma_f32_16x16x32_bf16 v[12:15], v[212:215], v[44:47], v[12:15]
    s_and_b64 vcc, vcc, s[18:19]
    s_cselect_b32 s10, 0, s6
    s_add_u32 m0, s34, 0
    v_mfma_f32_16x16x32_bf16 v[16:19], v[216:219], v[44:47], v[16:19]
    buffer_load_dwordx4 v1, s[8:11], s33 offen offset:0 sc1 lds
    v_mfma_f32_16x16x32_bf16 v[20:23], v[220:223], v[44:47], v[20:23]
    s_waitcnt lgkmcnt(2)
    v_mfma_f32_16x16x32_bf16 v[8:11], v[224:227], v[48:51], v[8:11]
    ds_read_b128 v[44:47], v3 offset:1024
    v_mfma_f32_16x16x32_bf16 v[12:15], v[228:231], v[48:51], v[12:15]
    v_mfma_f32_16x16x32_bf16 v[16:19], v[232:235], v[48:51], v[16:19]
    buffer_load_dwordx4 v1, s[8:11], s33 offen offset:1024 sc1 lds
    v_mfma_f32_16x16x32_bf16 v[20:23], v[236:239], v[48:51], v[20:23]
    s_waitcnt lgkmcnt(2)
    v_mfma_f32_16x16x32_bf16 v[8:11], v[240:243], v[52:55], v[8:11]
    ds_read_b128 v[48:51], v3 offset:2048
    v_mfma_f32_16x16x32_bf16 v[12:15], v[244:247], v[52:55], v[12:15]
    v_mfma_f32_16x16x32_bf16 v[16:19], v[248:251], v[52:55], v[16:19]
    v_mfma_f32_16x16x32_bf16 v[20:23], v[252:255], v[52:55], v[20:23]
Lffb_body1:
    s_waitcnt lgkmcnt(2)
    v_mfma_f32_16x16x32_bf16 v[24:27], a[0:3], v[40:43], 0
    ds_read_b128 v[52:55], v3 offset:3072
    s_add_u32 s16, s16, 8192
    v_mfma_f32_16x16x32_bf16 v[28:31], a[4:7], v[40:43], 0
    s_cmp_eq_u32 s10, 0
    s_cbranch_scc1 Lffb_slow1
    v_mfma_f32_16x16x32_bf16 v[32:35], a[8:11], v[40:43], 0
    buffer_load_dwordx4 v1, s[8:11], s33 offen offset:2048 sc1 lds
    v_mfma_f32_16x16x32_bf16 v[36:39], a[12:15], v[40:43], 0
    s_waitcnt lgkmcnt(2)
    v_cvt_pk_bf16_f32 v56, v8, v9
    v_cvt_pk_bf16_f32 v57, v10, v11
    v_mfma_f32_16x16x32_bf16 v[24:27], a[16:19], v[44:47], v[24:27]
    ds_read_b128 v[40:43], v3 offset:4096
    v_cvt_pk_bf16_f32 v58, v12, v13
    v_mfma_f32_16x16x32_bf16 v[28:31], a[20:23], v[44:47], v[28:31]
    s_add_u32 s31, s31, 1
    v_mov_b32 v6, s31
    v_cvt_pk_bf16_f32 v59, v14, v15
    v_mfma_f32_16x16x32_bf16 v[32:35], a[24:27], v[44:47], v[32:35]
    buffer_store_dwordx4 v[56:59], v1, s[12:15], s36 offen offset:0 sc1
    v_cvt_pk_bf16_f32 v60, v16, v17
    v_mfma_f32_16x16x32_bf16 v[36:39], a[28:31], v[44:47], v[36:39]
    s_waitcnt lgkmcnt(2)
    v_cvt_pk_bf16_f32 v61, v18, v19
    v_cvt_pk_bf16_f32 v62, v20, v21
    v_mfma_f32_16x16x32_bf16 v[24:27], a[32:35], v[48:51], v[24:27]
    ds_read_b128 v[44:47], v3 offset:5120
    v_cvt_pk_bf16_f32 v63, v22, v23
    v_mfma_f32_16x16x32_bf16 v[28:31], a[36:39], v[48:51], v[28:31]
    s_add_u32 s35, s35, 36864
    s_cmp_eq_u32 s35, 147456
    s_cselect_b32 s35, 0, s35
    v_mfma_f32_16x16x32_bf16 v[32:35], a[40:43], v[48:51], v[32:35]
    buffer_store_dwordx4 v[60:63], v1, s[12:15], s36 offen offset:1024 sc1
    v_add_u32 v2, s35, v1
    v_mfma_f32_16x16x32_bf16 v[36:39], a[44:47], v[48:51], v[36:39]
    s_waitcnt lgkmcnt(2)
    s_add_u32 s36, s36, 131072
    v_mfma_f32_16x16x32_bf16 v[24:27], a[48:51], v[52:55], v[24:27]
    ds_read_b128 v[48:51], v3 offset:6144
    v_mfma_f32_16x16x32_bf16 v[28:31], a[52:55], v[52:55], v[28:31]
    v_mfma_f32_16x16x32_bf16 v[32:35], a[56:59], v[52:55], v[32:35]
    buffer_load_dwordx4 v1, s[8:11], s33 offen offset:3072 sc1 lds
    v_mfma_f32_16x16x32_bf16 v[36:39], a[60:63], v[52:55], v[36:39]
    s_waitcnt lgkmcnt(2)
    s_add_u32 m0, s34, 4096
    s_add_u32 s37, s33, 4096
    v_mfma_f32_16x16x32_bf16 v[24:27], a[64:67], v[40:43], v[24:27]
    ds_read_b128 v[52:55], v3 offset:7168
    v_mfma_f32_16x16x32_bf16 v[28:31], a[68:71], v[40:43], v[28:31]
    v_mfma_f32_16x16x32_bf16 v[32:35], a[72:75], v[40:43], v[32:35]
    buffer_load_dwordx4 v1, s[8:11], s37 offen offset:0 sc1 lds
    v_mfma_f32_16x16x32_bf16 v[36:39], a[76:79], v[40:43], v[36:39]
    s_waitcnt lgkmcnt(2)
    v_mfma_f32_16x16x32_bf16 v[24:27], a[80:83], v[44:47], v[24:27]
    ds_read_b128 v[40:43], v3 offset:8192
    v_mfma_f32_16x16x32_bf16 v[28:31], a[84:87], v[44:47], v[28:31]
    v_mfma_f32_16x16x32_bf16 v[32:35], a[88:91], v[44:47], v[32:35]
    buffer_load_dword v5, v4, s[4:7], s16 offen sc1
    v_mfma_f32_16x16x32_bf16 v[36:39], a[92:95], v[44:47], v[36:39]
    s_waitcnt lgkmcnt(2)
    v_mfma_f32_16x16x32_bf16 v[24:27], a[96:99], v[48:51], v[24:27]
    ds_read_b128 v[44:47], v3 offset:9216
    v_mfma_f32_16x16x32_bf16 v[28:31], a[100:103], v[48:51], v[28:31]
    v_mfma_f32_16x16x32_bf16 v[32:35], a[104:107], v[48:51], v[32:35]
    buffer_load_dwordx4 v1, s[8:11], s37 offen offset:1024 sc1 lds
    v_mfma_f32_16x16x32_bf16 v[36:39], a[108:111], v[48:51], v[36:39]
    s_waitcnt lgkmcnt(2)
    v_mfma_f32_16x16x32_bf16 v[24:27], a[112:115], v[52:55], v[24:27]
    ds_read_b128 v[48:51], v3 offset:10240
    v_mfma_f32_16x16x32_bf16 v[28:31], a[116:119], v[52:55], v[28:31]
    v_mfma_f32_16x16x32_bf16 v[32:35], a[120:123], v[52:55], v[32:35]
    v_mfma_f32_16x16x32_bf16 v[36:39], a[124:127], v[52:55], v[36:39]
    s_waitcnt lgkmcnt(2)
    v_mfma_f32_16x16x32_bf16 v[24:27], a[128:131], v[40:43], v[24:27]
    ds_read_b128 v[52:55], v3 offset:11264
    v_mfma_f32_16x16x32_bf16 v[28:31], a[132:135], v[40:43], v[28:31]
    v_mfma_f32_16x16x32_bf16 v[32:35], a[136:139], v[40:43], v[32:35]
    v_mfma_f32_16x16x32_bf16 v[36:39], a[140:143], v[40:43], v[36:39]
    s_waitcnt lgkmcnt(2)
    v_mfma_f32_16x16x32_bf16 v[24:27], a[144:147], v[44:47], v[24:27]
    ds_read_b128 v[40:43], v3 offset:12288
    v_mfma_f32_16x16x32_bf16 v[28:31], a[148:151], v[44:47], v[28:31]
    v_mfma_f32_16x16x32_bf16 v[32:35], a[152:155], v[44:47], v[32:35]
    v_mfma_f32_16x16x32_bf16 v[36:39], a[156:159], v[44:47], v[36:39]
    s_waitcnt lgkmcnt(2)
    v_mfma_f32_16x16x32_bf16 v[24:27], a[160:163], v[48:51], v[24:27]
    ds_read_b128 v[44:47], v3 offset:13312
    v_mfma_f32_16x16x32_bf16 v[28:31], a[164:167], v[48:51], v[28:31]
    v_mfma_f32_16x16x32_bf16 v[32:35], a[168:171], v[48:51], v[32:35]
    v_mfma_f32_16x16x32_bf16 v[36:39], a[172:175], v[48:51], v[36:39]
    s_waitcnt lgkmcnt(2)
    v_mfma_f32_16x16x32_bf16 v[24:27], a[176:179], v[52:55], v[24:27]
    ds_read_b128 v[48:51], v3 offset:14336
    v_mfma_f32_16x16x32_bf16 v[28:31], a[180:183], v[52:55], v[28:31]
    v_mfma_f32_16x16x32_bf16 v[32:35], a[184:187], v[52:55], v[32:35]
    v_mfma_f32_16x16x32_bf16 v[36:39], a[188:191], v[52:55], v[36:39]
    s_waitcnt lgkmcnt(2)
    v_mfma_f32_16x16x32_bf16 v[24:27], a[192:195], v[40:43], v[24:27]
    ds_read_b128 v[52:55], v3 offset:15360
    v_mfma_f32_16x16x32_bf16 v[28:31], a[196:199], v[40:43], v[28:31]
    v_mfma_f32_16x16x32_bf16 v[32:35], a[200:203], v[40:43], v[32:35]
    v_mfma_f32_16x16x32_bf16 v[36:39], a[204:207], v[40:43], v[36:39]
    s_waitcnt lgkmcnt(2)
    v_mfma_f32_16x16x32_bf16 v[24:27], a[208:211], v[44:47], v[24:27]
    ds_read_b128 v[40:43], v3 offset:16384
    v_mfma_f32_16x16x32_bf16 v[28:31], a[212:215], v[44:47], v[28:31]
    v_mfma_f32_16x16x32_bf16 v[32:35], a[216:219], v[44:47], v[32:35]
    v_mfma_f32_16x16x32_bf16 v[36:39], a[220:223], v[44:47], v[36:39]
    s_waitcnt lgkmcnt(2)
    v_mfma_f32_16x16x32_bf16 v[24:27], a[224:227], v[48:51], v[24:27]
    ds_read_b128 v[44:47], v3 offset:17408
    v_mfma_f32_16x16x32_bf16 v[28:31], a[228:231], v[48:51], v[28:31]
    v_mfma_f32_16x16x32_bf16 v[32:35], a[232:235], v[48:51], v[32:35]
    v_mfma_f32_16x16x32_bf16 v[36:39], a[236:239], v[48:51], v[36:39]
    s_waitcnt lgkmcnt(2)
    v_mfma_f32_16x16x32_bf16 v[24:27], a[240:243], v[52:55], v[24:27]
    ds_read_b128 v[48:51], v3 offset:18432
    s_waitcnt vmcnt(4)
    v_mfma_f32_16x16x32_bf16 v[28:31], a[244:247], v[52:55], v[28:31]
    buffer_store_dword v6, v64, s[12:15], s17 offen sc1
    s_mov_b32 s14, s6
    v_mfma_f32_16x16x32_bf16 v[32:35], a[248:251], v[52:55], v[32:35]
    s_add_u32 s17, s17, 8192
    v_mfma_f32_16x16x32_bf16 v[36:39], a[252:255], v[52:55], v[36:39]
    s_waitcnt lgkmcnt(2)
    v_mfma_f32_16x16x32_bf16 v[24:27], v[128:131], v[40:43], v[24:27]
    ds_read_b128 v[52:55], v3 offset:19456
    v_mfma_f32_16x16x32_bf16 v[28:31], v[132:135], v[40:43], v[28:31]
    v_mfma_f32_16x16x32_bf16 v[32:35], v[136:139], v[40:43], v[32:35]
    v_mfma_f32_16x16x32_bf16 v[36:39], v[140:143], v[40:43], v[36:39]
    s_waitcnt lgkmcnt(2)
    v_mfma_f32_16x16x32_bf16 v[24:27], v[144:147], v[44:47], v[24:27]
    ds_read_b128 v[40:43], v3 offset:20480
    v_mfma_f32_16x16x32_bf16 v[28:31], v[148:151], v[44:47], v[28:31]
    v_mfma_f32_16x16x32_bf16 v[32:35], v[152:155], v[44:47], v[32:35]
    v_mfma_f32_16x16x32_bf16 v[36:39], v[156:159], v[44:47], v[36:39]
    s_waitcnt lgkmcnt(2)
    v_mfma_f32_16x16x32_bf16 v[24:27], v[160:163], v[48:51], v[24:27]
    ds_read_b128 v[44:47], v3 offset:21504
    v_mfma_f32_16x16x32_bf16 v[28:31], v[164:167], v[48:51], v[28:31]
    v_mfma_f32_16x16x32_bf16 v[32:35], v[168:171], v[48:51], v[32:35]
    s_add_u32 s32, s32, 1
    s_add_u32 s33, s33, 116736
    s_add_u32 s34, s34, 36864
    v_mfma_f32_16x16x32_bf16 v[36:39], v[172:175], v[48:51], v[36:39]
    s_waitcnt lgkmcnt(2)
    s_cmp_ge_u32 s34, 147456
    s_cselect_b32 s38, 147456, 0
    v_mfma_f32_16x16x32_bf16 v[24:27], v[176:179], v[52:55], v[24:27]
    ds_read_b128 v[48:51], v3 offset:22528
    s_sub_u32 s34, s34, s38
    v_mfma_f32_16x16x32_bf16 v[28:31], v[180:183], v[52:55], v[28:31]
    v_mfma_f32_16x16x32_bf16 v[32:35], v[184:187], v[52:55], v[32:35]
    v_mfma_f32_16x16x32_bf16 v[36:39], v[188:191], v[52:55], v[36:39]
    s_waitcnt lgkmcnt(2)
    v_mfma_f32_16x16x32_bf16 v[24:27], v[192:195], v[40:43], v[24:27]
    ds_read_b128 v[52:55], v3 offset:23552
    v_mfma_f32_16x16x32_bf16 v[28:31], v[196:199], v[40:43], v[28:31]
    s_waitcnt vmcnt(1)
    s_barrier
    v_mfma_f32_16x16x32_bf16 v[32:35], v[200:203], v[40:43], v[32:35]
    v_cmp_gt_i32 vcc, s32, v5
    v_mfma_f32_16x16x32_bf16 v[36:39], v[204:207], v[40:43], v[36:39]
    s_waitcnt lgkmcnt(2)
    v_mfma_f32_16x16x32_bf16 v[24:27], v[208:211], v[44:47], v[24:27]
    ds_read_b128 v[40:43], v2 offset:0
    v_mfma_f32_16x16x32_bf16 v[28:31], v[212:215], v[44:47], v[28:31]
    s_and_b64 vcc, vcc, s[18:19]
    s_cselect_b32 s10, 0, s6
    s_add_u32 m0, s34, 0
    v_mfma_f32_16x16x32_bf16 v[32:35], v[216:219], v[44:47], v[32:35]
    buffer_load_dwordx4 v1, s[8:11], s33 offen offset:0 sc1 lds
    v_mfma_f32_16x16x32_bf16 v[36:39], v[220:223], v[44:47], v[36:39]
    s_waitcnt lgkmcnt(2)
    v_mfma_f32_16x16x32_bf16 v[24:27], v[224:227], v[48:51], v[24:27]
    ds_read_b128 v[44:47], v2 offset:1024
    v_mfma_f32_16x16x32_bf16 v[28:31], v[228:231], v[48:51], v[28:31]
    v_mfma_f32_16x16x32_bf16 v[32:35], v[232:235], v[48:51], v[32:35]
    buffer_load_dwordx4 v1, s[8:11], s33 offen offset:1024 sc1 lds
    v_mfma_f32_16x16x32_bf16 v[36:39], v[236:239], v[48:51], v[36:39]
    s_waitcnt lgkmcnt(2)
    v_mfma_f32_16x16x32_bf16 v[24:27], v[240:243], v[52:55], v[24:27]
    ds_read_b128 v[48:51], v2 offset:2048
    v_mfma_f32_16x16x32_bf16 v[28:31], v[244:247], v[52:55], v[28:31]
    v_mfma_f32_16x16x32_bf16 v[32:35], v[248:251], v[52:55], v[32:35]
    v_mfma_f32_16x16x32_bf16 v[36:39], v[252:255], v[52:55], v[36:39]
Lffb_back:
    s_cmp_lt_i32 s31, 63
    s_cbranch_scc1 Lffb_body0
    s_branch L_exit
Lffb_slow0:
    s_sub_u32 s39, s16, 8192
    v_mfma_f32_16x16x32_bf16 v[16:19], a[8:11], v[40:43], 0
    buffer_load_dword v65, v4, s[4:7], s39 offen sc1
    v_mfma_f32_16x16x32_bf16 v[20:23], a[12:15], v[40:43], 0
    s_waitcnt lgkmcnt(2)
    v_cvt_pk_bf16_f32 v56, v24, v25
    v_cvt_pk_bf16_f32 v57, v26, v27
    v_mfma_f32_16x16x32_bf16 v[8:11], a[16:19], v[44:47], v[8:11]
    ds_read_b128 v[40:43], v2 offset:4096
    v_cvt_pk_bf16_f32 v58, v28, v29
    v_mfma_f32_16x16x32_bf16 v[12:15], a[20:23], v[44:47], v[12:15]
    s_add_u32 s31, s31, 1
    v_mov_b32 v6, s31
    v_cvt_pk_bf16_f32 v59, v30, v31
    v_mfma_f32_16x16x32_bf16 v[16:19], a[24:27], v[44:47], v[16:19]
    buffer_store_dwordx4 v[56:59], v1, s[12:15], s36 offen offset:0 sc1
    v_cvt_pk_bf16_f32 v60, v32, v33
    v_mfma_f32_16x16x32_bf16 v[20:23], a[28:31], v[44:47], v[20:23]
    s_waitcnt lgkmcnt(2)
    v_cvt_pk_bf16_f32 v61, v34, v35
    v_cvt_pk_bf16_f32 v62, v36, v37
    v_mfma_f32_16x16x32_bf16 v[8:11], a[32:35], v[48:51], v[8:11]
    ds_read_b128 v[44:47], v2 offset:5120
    v_cvt_pk_bf16_f32 v63, v38, v39
    v_mfma_f32_16x16x32_bf16 v[12:15], a[36:39], v[48:51], v[12:15]
    s_add_u32 s35, s35, 36864
    s_cmp_eq_u32 s35, 147456
    s_cselect_b32 s35, 0, s35
    v_mfma_f32_16x16x32_bf16 v[16:19], a[40:43], v[48:51], v[16:19]
    buffer_store_dwordx4 v[60:63], v1, s[12:15], s36 offen offset:1024 sc1
    v_add_u32 v3, s35, v1
    v_mfma_f32_16x16x32_bf16 v[20:23], a[44:47], v[48:51], v[20:23]
    s_waitcnt lgkmcnt(2)
    s_add_u32 s36, s36, 131072
    v_mfma_f32_16x16x32_bf16 v[8:11], a[48:51], v[52:55], v[8:11]
    ds_read_b128 v[48:51], v2 offset:6144
    v_mfma_f32_16x16x32_bf16 v[12:15], a[52:55], v[52:55], v[12:15]
    v_mfma_f32_16x16x32_bf16 v[16:19], a[56:59], v[52:55], v[16:19]
    v_mfma_f32_16x16x32_bf16 v[20:23], a[60:63], v[52:55], v[20:23]
    s_waitcnt lgkmcnt(2)
    v_mfma_f32_16x16x32_bf16 v[8:11], a[64:67], v[40:43], v[8:11]
    ds_read_b128 v[52:55], v2 offset:7168
    v_mfma_f32_16x16x32_bf16 v[12:15], a[68:71], v[40:43], v[12:15]
    v_mfma_f32_16x16x32_bf16 v[16:19], a[72:75], v[40:43], v[16:19]
    v_mfma_f32_16x16x32_bf16 v[20:23], a[76:79], v[40:43], v[20:23]
    s_waitcnt lgkmcnt(2)
    v_mfma_f32_16x16x32_bf16 v[8:11], a[80:83], v[44:47], v[8:11]
    ds_read_b128 v[40:43], v2 offset:8192
    v_mfma_f32_16x16x32_bf16 v[12:15], a[84:87], v[44:47], v[12:15]
    v_mfma_f32_16x16x32_bf16 v[16:19], a[88:91], v[44:47], v[16:19]
    v_mfma_f32_16x16x32_bf16 v[20:23], a[92:95], v[44:47], v[20:23]
    s_waitcnt lgkmcnt(2)
    v_mfma_f32_16x16x32_bf16 v[8:11], a[96:99], v[48:51], v[8:11]
    ds_read_b128 v[44:47], v2 offset:9216
    v_mfma_f32_16x16x32_bf16 v[12:15], a[100:103], v[48:51], v[12:15]
    v_mfma_f32_16x16x32_bf16 v[16:19], a[104:107], v[48:51], v[16:19]
    v_mfma_f32_16x16x32_bf16 v[20:23], a[108:111], v[48:51], v[20:23]
    s_waitcnt lgkmcnt(2)
    v_mfma_f32_16x16x32_bf16 v[8:11], a[112:115], v[52:55], v[8:11]
    ds_read_b128 v[48:51], v2 offset:10240
    v_mfma_f32_16x16x32_bf16 v[12:15], a[116:119], v[52:55], v[12:15]
    v_mfma_f32_16x16x32_bf16 v[16:19], a[120:123], v[52:55], v[16:19]
    v_mfma_f32_16x16x32_bf16 v[20:23], a[124:127], v[52:55], v[20:23]
    s_waitcnt lgkmcnt(2)
    v_mfma_f32_16x16x32_bf16 v[8:11], a[128:131], v[40:43], v[8:11]
    ds_read_b128 v[52:55], v2 offset:11264
    s_waitcnt vmcnt(2)
    v_mfma_f32_16x16x32_bf16 v[12:15], a[132:135], v[40:43], v[12:15]
    v_cmp_gt_i32 vcc, s32, v65
    v_mfma_f32_16x16x32_bf16 v[16:19], a[136:139], v[40:43], v[16:19]
    v_mfma_f32_16x16x32_bf16 v[20:23], a[140:143], v[40:43], v[20:23]
    s_waitcnt lgkmcnt(2)
    s_and_b64 vcc, vcc, s[18:19]
    s_cselect_b32 s10, 0, s6
    v_mfma_f32_16x16x32_bf16 v[8:11], a[144:147], v[44:47], v[8:11]
    ds_read_b128 v[40:43], v2 offset:12288
    v_mfma_f32_16x16x32_bf16 v[12:15], a[148:151], v[44:47], v[12:15]
    s_cmp_eq_u32 s10, 0
    s_cbranch_scc1 Lffb_slowc0
    v_mfma_f32_16x16x32_bf16 v[16:19], a[152:155], v[44:47], v[16:19]
    s_add_u32 m0, s34, 0
    v_mfma_f32_16x16x32_bf16 v[20:23], a[156:159], v[44:47], v[20:23]
    s_waitcnt lgkmcnt(2)
    buffer_load_dwordx4 v1, s[8:11], s33 offen offset:0 sc1 lds
    v_mfma_f32_16x16x32_bf16 v[8:11], a[160:163], v[48:51], v[8:11]
    ds_read_b128 v[44:47], v2 offset:13312
    v_mfma_f32_16x16x32_bf16 v[12:15], a[164:167], v[48:51], v[12:15]
    v_mfma_f32_16x16x32_bf16 v[16:19], a[168:171], v[48:51], v[16:19]
    v_mfma_f32_16x16x32_bf16 v[20:23], a[172:175], v[48:51], v[20:23]
    s_waitcnt lgkmcnt(2)
    buffer_load_dwordx4 v1, s[8:11], s33 offen offset:1024 sc1 lds
    v_mfma_f32_16x16x32_bf16 v[8:11], a[176:179], v[52:55], v[8:11]
    ds_read_b128 v[48:51], v2 offset:14336
    v_mfma_f32_16x16x32_bf16 v[12:15], a[180:183], v[52:55], v[12:15]
    v_mfma_f32_16x16x32_bf16 v[16:19], a[184:187], v[52:55], v[16:19]
    v_mfma_f32_16x16x32_bf16 v[20:23], a[188:191], v[52:55], v[20:23]
    s_waitcnt lgkmcnt(2)
    buffer_load_dword v5, v4, s[4:7], s16 offen sc1
    v_mfma_f32_16x16x32_bf16 v[8:11], a[192:195], v[40:43], v[8:11]
    ds_read_b128 v[52:55], v2 offset:15360
    v_mfma_f32_16x16x32_bf16 v[12:15], a[196:199], v[40:43], v[12:15]
    v_mfma_f32_16x16x32_bf16 v[16:19], a[200:203], v[40:43], v[16:19]
    v_mfma_f32_16x16x32_bf16 v[20:23], a[204:207], v[40:43], v[20:23]
    s_waitcnt lgkmcnt(2)
    buffer_load_dwordx4 v1, s[8:11], s33 offen offset:2048 sc1 lds
    v_mfma_f32_16x16x32_bf16 v[8:11], a[208:211], v[44:47], v[8:11]
    ds_read_b128 v[40:43], v2 offset:16384
    v_mfma_f32_16x16x32_bf16 v[12:15], a[212:215], v[44:47], v[12:15]
    v_mfma_f32_16x16x32_bf16 v[16:19], a[216:219], v[44:47], v[16:19]
    v_mfma_f32_16x16x32_bf16 v[20:23], a[220:223], v[44:47], v[20:23]
    s_waitcnt lgkmcnt(2)
    buffer_load_dwordx4 v1, s[8:11], s33 offen offset:3072 sc1 lds
    v_mfma_f32_16x16x32_bf16 v[8:11], a[224:227], v[48:51], v[8:11]
    ds_read_b128 v[44:47], v2 offset:17408
    s_add_u32 m0, s34, 4096
    v_mfma_f32_16x16x32_bf16 v[12:15], a[228:231], v[48:51], v[12:15]
    s_add_u32 s37, s33, 4096
    v_mfma_f32_16x16x32_bf16 v[16:19], a[232:235], v[48:51], v[16:19]
    v_mfma_f32_16x16x32_bf16 v[20:23], a[236:239], v[48:51], v[20:23]
    s_waitcnt lgkmcnt(2)
    buffer_load_dwordx4 v1, s[8:11], s37 offen offset:0 sc1 lds
    v_mfma_f32_16x16x32_bf16 v[8:11], a[240:243], v[52:55], v[8:11]
    ds_read_b128 v[48:51], v2 offset:18432
    s_waitcnt vmcnt(6)
    v_mfma_f32_16x16x32_bf16 v[12:15], a[244:247], v[52:55], v[12:15]
    buffer_store_dword v6, v64, s[12:15], s17 offen sc1
    s_mov_b32 s14, s6
    v_mfma_f32_16x16x32_bf16 v[16:19], a[248:251], v[52:55], v[16:19]
    s_add_u32 s17, s17, 8192
    v_mfma_f32_16x16x32_bf16 v[20:23], a[252:255], v[52:55], v[20:23]
    s_waitcnt lgkmcnt(2)
    buffer_load_dwordx4 v1, s[8:11], s37 offen offset:1024 sc1 lds
    v_mfma_f32_16x16x32_bf16 v[8:11], v[128:131], v[40:43], v[8:11]
    ds_read_b128 v[52:55], v2 offset:19456
    s_add_u32 s32, s32, 1
    v_mfma_f32_16x16x32_bf16 v[12:15], v[132:135], v[40:43], v[12:15]
    s_add_u32 s33, s33, 116736
    s_add_u32 s34, s34, 36864
    v_mfma_f32_16x16x32_bf16 v[16:19], v[136:139], v[40:43], v[16:19]
    s_cmp_ge_u32 s34, 147456
    s_cselect_b32 s38, 147456, 0
    s_sub_u32 s34, s34, s38
    v_mfma_f32_16x16x32_bf16 v[20:23], v[140:143], v[40:43], v[20:23]
    s_waitcnt lgkmcnt(2)
    v_mfma_f32_16x16x32_bf16 v[8:11], v[144:147], v[44:47], v[8:11]
    ds_read_b128 v[40:43], v2 offset:20480
    v_mfma_f32_16x16x32_bf16 v[12:15], v[148:151], v[44:47], v[12:15]
    v_mfma_f32_16x16x32_bf16 v[16:19], v[152:155], v[44:47], v[16:19]
    v_mfma_f32_16x16x32_bf16 v[20:23], v[156:159], v[44:47], v[20:23]
    s_waitcnt lgkmcnt(2)
    v_mfma_f32_16x16x32_bf16 v[8:11], v[160:163], v[48:51], v[8:11]
    ds_read_b128 v[44:47], v2 offset:21504
    v_mfma_f32_16x16x32_bf16 v[12:15], v[164:167], v[48:51], v[12:15]
    v_mfma_f32_16x16x32_bf16 v[16:19], v[168:171], v[48:51], v[16:19]
    v_mfma_f32_16x16x32_bf16 v[20:23], v[172:175], v[48:51], v[20:23]
    s_waitcnt lgkmcnt(2)
    v_mfma_f32_16x16x32_bf16 v[8:11], v[176:179], v[52:55], v[8:11]
    ds_read_b128 v[48:51], v2 offset:22528
    v_mfma_f32_16x16x32_bf16 v[12:15], v[180:183], v[52:55], v[12:15]
    v_mfma_f32_16x16x32_bf16 v[16:19], v[184:187], v[52:55], v[16:19]
    v_mfma_f32_16x16x32_bf16 v[20:23], v[188:191], v[52:55], v[20:23]
    s_waitcnt lgkmcnt(2)
    v_mfma_f32_16x16x32_bf16 v[8:11], v[192:195], v[40:43], v[8:11]
    ds_read_b128 v[52:55], v2 offset:23552
    v_mfma_f32_16x16x32_bf16 v[12:15], v[196:199], v[40:43], v[12:15]
    s_waitcnt vmcnt(0)
    s_barrier
    v_mfma_f32_16x16x32_bf16 v[16:19], v[200:203], v[40:43], v[16:19]
    v_cmp_gt_i32 vcc, s32, v5
    v_mfma_f32_16x16x32_bf16 v[20:23], v[204:207], v[40:43], v[20:23]
    s_waitcnt lgkmcnt(2)
    v_mfma_f32_16x16x32_bf16 v[8:11], v[208:211], v[44:47], v[8:11]
    ds_read_b128 v[40:43], v3 offset:0
    v_mfma_f32_16x16x32_bf16 v[12:15], v[212:215], v[44:47], v[12:15]
    s_and_b64 vcc, vcc, s[18:19]
    s_cselect_b32 s10, 0, s6
    s_add_u32 m0, s34, 0
    v_mfma_f32_16x16x32_bf16 v[16:19], v[216:219], v[44:47], v[16:19]
    buffer_load_dwordx4 v1, s[8:11], s33 offen offset:0 sc1 lds
    v_mfma_f32_16x16x32_bf16 v[20:23], v[220:223], v[44:47], v[20:23]
    s_waitcnt lgkmcnt(2)
    v_mfma_f32_16x16x32_bf16 v[8:11], v[224:227], v[48:51], v[8:11]
    ds_read_b128 v[44:47], v3 offset:1024
    v_mfma_f32_16x16x32_bf16 v[12:15], v[228:231], v[48:51], v[12:15]
    v_mfma_f32_16x16x32_bf16 v[16:19], v[232:235], v[48:51], v[16:19]
    buffer_load_dwordx4 v1, s[8:11], s33 offen offset:1024 sc1 lds
    v_mfma_f32_16x16x32_bf16 v[20:23], v[236:239], v[48:51], v[20:23]
    s_waitcnt lgkmcnt(2)
    v_mfma_f32_16x16x32_bf16 v[8:11], v[240:243], v[52:55], v[8:11]
    ds_read_b128 v[48:51], v3 offset:2048
    v_mfma_f32_16x16x32_bf16 v[12:15], v[244:247], v[52:55], v[12:15]
    v_mfma_f32_16x16x32_bf16 v[16:19], v[248:251], v[52:55], v[16:19]
    v_mfma_f32_16x16x32_bf16 v[20:23], v[252:255], v[52:55], v[20:23]
    s_nop 1
    s_branch Lffb_body1
Lffb_slowc0:
    v_mfma_f32_16x16x32_bf16 v[16:19], a[152:155], v[44:47], v[16:19]
    v_mfma_f32_16x16x32_bf16 v[20:23], a[156:159], v[44:47], v[20:23]
    s_waitcnt lgkmcnt(2)
    v_mfma_f32_16x16x32_bf16 v[8:11], a[160:163], v[48:51], v[8:11]
    ds_read_b128 v[44:47], v2 offset:13312
    v_mfma_f32_16x16x32_bf16 v[12:15], a[164:167], v[48:51], v[12:15]
    v_mfma_f32_16x16x32_bf16 v[16:19], a[168:171], v[48:51], v[16:19]
    v_mfma_f32_16x16x32_bf16 v[20:23], a[172:175], v[48:51], v[20:23]
    s_waitcnt lgkmcnt(2)
    v_mfma_f32_16x16x32_bf16 v[8:11], a[176:179], v[52:55], v[8:11]
    ds_read_b128 v[48:51], v2 offset:14336
    v_mfma_f32_16x16x32_bf16 v[12:15], a[180:183], v[52:55], v[12:15]
    v_mfma_f32_16x16x32_bf16 v[16:19], a[184:187], v[52:55], v[16:19]
    v_mfma_f32_16x16x32_bf16 v[20:23], a[188:191], v[52:55], v[20:23]
    s_waitcnt lgkmcnt(2)
    v_mfma_f32_16x16x32_bf16 v[8:11], a[192:195], v[40:43], v[8:11]
    ds_read_b128 v[52:55], v2 offset:15360
    v_mfma_f32_16x16x32_bf16 v[12:15], a[196:199], v[40:43], v[12:15]
    v_mfma_f32_16x16x32_bf16 v[16:19], a[200:203], v[40:43], v[16:19]
    v_mfma_f32_16x16x32_bf16 v[20:23], a[204:207], v[40:43], v[20:23]
    s_waitcnt lgkmcnt(2)
    v_mfma_f32_16x16x32_bf16 v[8:11], a[208:211], v[44:47], v[8:11]
    ds_read_b128 v[40:43], v2 offset:16384
    v_mfma_f32_16x16x32_bf16 v[12:15], a[212:215], v[44:47], v[12:15]
    v_mfma_f32_16x16x32_bf16 v[16:19], a[216:219], v[44:47], v[16:19]
    v_mfma_f32_16x16x32_bf16 v[20:23], a[220:223], v[44:47], v[20:23]
    s_waitcnt lgkmcnt(2)
    v_mfma_f32_16x16x32_bf16 v[8:11], a[224:227], v[48:51], v[8:11]
    ds_read_b128 v[44:47], v2 offset:17408
    v_mfma_f32_16x16x32_bf16 v[12:15], a[228:231], v[48:51], v[12:15]
    v_mfma_f32_16x16x32_bf16 v[16:19], a[232:235], v[48:51], v[16:19]
    v_mfma_f32_16x16x32_bf16 v[20:23], a[236:239], v[48:51], v[20:23]
    s_waitcnt lgkmcnt(2)
    v_mfma_f32_16x16x32_bf16 v[8:11], a[240:243], v[52:55], v[8:11]
    ds_read_b128 v[48:51], v2 offset:18432
    s_waitcnt vmcnt(0)
    v_mfma_f32_16x16x32_bf16 v[12:15], a[244:247], v[52:55], v[12:15]
    buffer_store_dword v6, v64, s[12:15], s17 offen sc1
    s_mov_b32 s14, s6
    v_mfma_f32_16x16x32_bf16 v[16:19], a[248:251], v[52:55], v[16:19]
    s_add_u32 s17, s17, 8192
    v_mfma_f32_16x16x32_bf16 v[20:23], a[252:255], v[52:55], v[20:23]
    s_waitcnt lgkmcnt(2)
    v_mfma_f32_16x16x32_bf16 v[8:11], v[128:131], v[40:43], v[8:11]
    ds_read_b128 v[52:55], v2 offset:19456
    v_mfma_f32_16x16x32_bf16 v[12:15], v[132:135], v[40:43], v[12:15]
    v_mfma_f32_16x16x32_bf16 v[16:19], v[136:139], v[40:43], v[16:19]
    v_mfma_f32_16x16x32_bf16 v[20:23], v[140:143], v[40:43], v[20:23]
    s_waitcnt lgkmcnt(2)
    v_mfma_f32_16x16x32_bf16 v[8:11], v[144:147], v[44:47], v[8:11]
    ds_read_b128 v[40:43], v2 offset:20480
    v_mfma_f32_16x16x32_bf16 v[12:15], v[148:151], v[44:47], v[12:15]
    v_mfma_f32_16x16x32_bf16 v[16:19], v[152:155], v[44:47], v[16:19]
    v_mfma_f32_16x16x32_bf16 v[20:23], v[156:159], v[44:47], v[20:23]
    s_waitcnt lgkmcnt(2)
    v_mfma_f32_16x16x32_bf16 v[8:11], v[160:163], v[48:51], v[8:11]
    ds_read_b128 v[44:47], v2 offset:21504
    v_mfma_f32_16x16x32_bf16 v[12:15], v[164:167], v[48:51], v[12:15]
    v_mfma_f32_16x16x32_bf16 v[16:19], v[168:171], v[48:51], v[16:19]
    v_mfma_f32_16x16x32_bf16 v[20:23], v[172:175], v[48:51], v[20:23]
    s_waitcnt lgkmcnt(2)
    v_mfma_f32_16x16x32_bf16 v[8:11], v[176:179], v[52:55], v[8:11]
    ds_read_b128 v[48:51], v2 offset:22528
    v_mfma_f32_16x16x32_bf16 v[12:15], v[180:183], v[52:55], v[12:15]
    v_mfma_f32_16x16x32_bf16 v[16:19], v[184:187], v[52:55], v[16:19]
    v_mfma_f32_16x16x32_bf16 v[20:23], v[188:191], v[52:55], v[20:23]
    s_waitcnt lgkmcnt(2)
    v_mfma_f32_16x16x32_bf16 v[8:11], v[192:195], v[40:43], v[8:11]
    ds_read_b128 v[52:55], v2 offset:23552
    v_mfma_f32_16x16x32_bf16 v[12:15], v[196:199], v[40:43], v[12:15]
    v_mfma_f32_16x16x32_bf16 v[16:19], v[200:203], v[40:43], v[16:19]
    v_mfma_f32_16x16x32_bf16 v[20:23], v[204:207], v[40:43], v[20:23]
    s_waitcnt lgkmcnt(2)
    v_mfma_f32_16x16x32_bf16 v[8:11], v[208:211], v[44:47], v[8:11]
    v_mfma_f32_16x16x32_bf16 v[12:15], v[212:215], v[44:47], v[12:15]
    v_mfma_f32_16x16x32_bf16 v[16:19], v[216:219], v[44:47], v[16:19]
    v_mfma_f32_16x16x32_bf16 v[20:23], v[220:223], v[44:47], v[20:23]
    s_waitcnt lgkmcnt(1)
    v_mfma_f32_16x16x32_bf16 v[8:11], v[224:227], v[48:51], v[8:11]
    v_mfma_f32_16x16x32_bf16 v[12:15], v[228:231], v[48:51], v[12:15]
    v_mfma_f32_16x16x32_bf16 v[16:19], v[232:235], v[48:51], v[16:19]
    v_mfma_f32_16x16x32_bf16 v[20:23], v[236:239], v[48:51], v[20:23]
    s_waitcnt lgkmcnt(0)
    v_mfma_f32_16x16x32_bf16 v[8:11], v[240:243], v[52:55], v[8:11]
    v_mfma_f32_16x16x32_bf16 v[12:15], v[244:247], v[52:55], v[12:15]
    v_mfma_f32_16x16x32_bf16 v[16:19], v[248:251], v[52:55], v[16:19]
    v_mfma_f32_16x16x32_bf16 v[20:23], v[252:255], v[52:55], v[20:23]
    s_nop 4
    v_cvt_pk_bf16_f32 v56, v8, v9
    v_cvt_pk_bf16_f32 v57, v10, v11
    v_cvt_pk_bf16_f32 v58, v12, v13
    v_cvt_pk_bf16_f32 v59, v14, v15
    buffer_store_dwordx4 v[56:59], v1, s[12:15], s36 offen offset:0 sc1
    v_cvt_pk_bf16_f32 v60, v16, v17
    v_cvt_pk_bf16_f32 v61, v18, v19
    v_cvt_pk_bf16_f32 v62, v20, v21
    v_cvt_pk_bf16_f32 v63, v22, v23
    buffer_store_dwordx4 v[60:63], v1, s[12:15], s36 offen offset:1024 sc1
    s_add_u32 s54, s31, 1
    v_mov_b32 v6, s54
Lffb_late0:
    s_mov_b32 s16, s39
    buffer_load_dword v5, v4, s[4:7], s16 offen sc1
    s_waitcnt vmcnt(1)
    buffer_store_dword v6, v64, s[12:15], s17 offen sc1
    s_cmp_ge_i32 s31, 63
    s_cbranch_scc1 L_exit
    s_waitcnt vmcnt(1)
    v_cmp_gt_i32 vcc, s32, v5
    s_sub_u32 s43, s43, 1
    s_cmp_lt_i32 s43, 0
    s_cbranch_scc1 Lffb_rdy0
    s_and_b64 vcc, vcc, s[18:19]
    s_cbranch_scc0 Lffb_rdy0
Lffb_spin0:
    buffer_load_dword v5, v4, s[4:7], s16 offen sc1
    s_waitcnt vmcnt(0)
    v_cmp_gt_i32 vcc, s32, v5
    s_sub_u32 s43, s43, 1
    s_cmp_lt_i32 s43, 0
    s_cbranch_scc1 Lffb_rdy0
    s_and_b64 vcc, vcc, s[18:19]
    s_cbranch_scc0 Lffb_rdy0
    s_sleep 8
    s_branch Lffb_spin0
Lffb_rdy0:
    s_add_u32 s16, s16, 8192
    buffer_load_dword v5, v4, s[4:7], s16 offen sc1
    s_mov_b32 s10, s6
    s_add_u32 m0, s34, 0
    s_nop 0
    buffer_load_dwordx4 v1, s[8:11], s33 offen offset:0 sc1 lds
    buffer_load_dwordx4 v1, s[8:11], s33 offen offset:1024 sc1 lds
    buffer_load_dwordx4 v1, s[8:11], s33 offen offset:2048 sc1 lds
    buffer_load_dwordx4 v1, s[8:11], s33 offen offset:3072 sc1 lds
    s_add_u32 m0, s34, 4096
    s_add_u32 s37, s33, 4096
    buffer_load_dwordx4 v1, s[8:11], s37 offen offset:0 sc1 lds
    buffer_load_dwordx4 v1, s[8:11], s37 offen offset:1024 sc1 lds
    s_waitcnt vmcnt(6)
    s_add_u32 s32, s32, 1
    s_add_u32 s33, s33, 116736
    s_add_u32 s34, s34, 36864
    s_cmp_ge_u32 s34, 147456
    s_cselect_b32 s38, 147456, 0
    s_sub_u32 s34, s34, s38
    v_cmp_gt_i32 vcc, s32, v5
    s_nop 0
    s_and_b64 vcc, vcc, s[18:19]
    s_cselect_b32 s10, 0, s6
    s_add_u32 m0, s34, 0
    s_nop 0
    buffer_load_dwordx4 v1, s[8:11], s33 offen offset:0 sc1 lds
    buffer_load_dwordx4 v1, s[8:11], s33 offen offset:1024 sc1 lds
    s_waitcnt vmcnt(2)
Lffb_go0:
    s_mov_b32 s14, 0
    s_barrier
    ds_read_b128 v[40:43], v3 offset:0
    ds_read_b128 v[44:47], v3 offset:1024
    ds_read_b128 v[48:51], v3 offset:2048
    s_branch Lffb_body1
Lffb_slow1:
    s_sub_u32 s39, s16, 8192
    v_mfma_f32_16x16x32_bf16 v[32:35], a[8:11], v[40:43], 0
    buffer_load_dword v65, v4, s[4:7], s39 offen sc1
    v_mfma_f32_16x16x32_bf16 v[36:39], a[12:15], v[40:43], 0
    s_waitcnt lgkmcnt(2)
    v_cvt_pk_bf16_f32 v56, v8, v9
    v_cvt_pk_bf16_f32 v57, v10, v11
    v_mfma_f32_16x16x32_bf16 v[24:27], a[16:19], v[44:47], v[24:27]
    ds_read_b128 v[40:43], v3 offset:4096
    v_cvt_pk_bf16_f32 v58, v12, v13
    v_mfma_f32_16x16x32_bf16 v[28:31], a[20:23], v[44:47], v[28:31]
    s_add_u32 s31, s31, 1
    v_mov_b32 v6, s31
    v_cvt_pk_bf16_f32 v59, v14, v15
    v_mfma_f32_16x16x32_bf16 v[32:35], a[24:27], v[44:47], v[32:35]
    buffer_store_dwordx4 v[56:59], v1, s[12:15], s36 offen offset:0 sc1
    v_cvt_pk_bf16_f32 v60, v16, v17
    v_mfma_f32_16x16x32_bf16 v[36:39], a[28:31], v[44:47], v[36:39]
    s_waitcnt lgkmcnt(2)
    v_cvt_pk_bf16_f32 v61, v18, v19
    v_cvt_pk_bf16_f32 v62, v20, v21
    v_mfma_f32_16x16x32_bf16 v[24:27], a[32:35], v[48:51], v[24:27]
    ds_read_b128 v[44:47], v3 offset:5120
    v_cvt_pk_bf16_f32 v63, v22, v23
    v_mfma_f32_16x16x32_bf16 v[28:31], a[36:39], v[48:51], v[28:31]
    s_add_u32 s35, s35, 36864
    s_cmp_eq_u32 s35, 147456
    s_cselect_b32 s35, 0, s35
    v_mfma_f32_16x16x32_bf16 v[32:35], a[40:43], v[48:51], v[32:35]
    buffer_store_dwordx4 v[60:63], v1, s[12:15], s36 offen offset:1024 sc1
    v_add_u32 v2, s35, v1
    v_mfma_f32_16x16x32_bf16 v[36:39], a[44:47], v[48:51], v[36:39]
    s_waitcnt lgkmcnt(2)
    s_add_u32 s36, s36, 131072
    v_mfma_f32_16x16x32_bf16 v[24:27], a[48:51], v[52:55], v[24:27]
    ds_read_b128 v[48:51], v3 offset:6144
    v_mfma_f32_16x16x32_bf16 v[28:31], a[52:55], v[52:55], v[28:31]
    v_mfma_f32_16x16x32_bf16 v[32:35], a[56:59], v[52:55], v[32:35]
    v_mfma_f32_16x16x32_bf16 v[36:39], a[60:63], v[52:55], v[36:39]
    s_waitcnt lgkmcnt(2)
    v_mfma_f32_16x16x32_bf16 v[24:27], a[64:67], v[40:43], v[24:27]
    ds_read_b128 v[52:55], v3 offset:7168
    v_mfma_f32_16x16x32_bf16 v[28:31], a[68:71], v[40:43], v[28:31]
    v_mfma_f32_16x16x32_bf16 v[32:35], a[72:75], v[40:43], v[32:35]
    v_mfma_f32_16x16x32_bf16 v[36:39], a[76:79], v[40:43], v[36:39]
    s_waitcnt lgkmcnt(2)
    v_mfma_f32_16x16x32_bf16 v[24:27], a[80:83], v[44:47], v[24:27]
    ds_read_b128 v[40:43], v3 offset:8192
    v_mfma_f32_16x16x32_bf16 v[28:31], a[84:87], v[44:47], v[28:31]
    v_mfma_f32_16x16x32_bf16 v[32:35], a[88:91], v[44:47], v[32:35]
    v_mfma_f32_16x16x32_bf16 v[36:39], a[92:95], v[44:47], v[36:39]
    s_waitcnt lgkmcnt(2)
    v_mfma_f32_16x16x32_bf16 v[24:27], a[96:99], v[48:51], v[24:27]
    ds_read_b128 v[44:47], v3 offset:9216
    v_mfma_f32_16x16x32_bf16 v[28:31], a[100:103], v[48:51], v[28:31]
    v_mfma_f32_16x16x32_bf16 v[32:35], a[104:107], v[48:51], v[32:35]
    v_mfma_f32_16x16x32_bf16 v[36:39], a[108:111], v[48:51], v[36:39]
    s_waitcnt lgkmcnt(2)
    v_mfma_f32_16x16x32_bf16 v[24:27], a[112:115], v[52:55], v[24:27]
    ds_read_b128 v[48:51], v3 offset:10240
    v_mfma_f32_16x16x32_bf16 v[28:31], a[116:119], v[52:55], v[28:31]
    v_mfma_f32_16x16x32_bf16 v[32:35], a[120:123], v[52:55], v[32:35]
    v_mfma_f32_16x16x32_bf16 v[36:39], a[124:127], v[52:55], v[36:39]
    s_waitcnt lgkmcnt(2)
    v_mfma_f32_16x16x32_bf16 v[24:27], a[128:131], v[40:43], v[24:27]
    ds_read_b128 v[52:55], v3 offset:11264
    s_waitcnt vmcnt(2)
    v_mfma_f32_16x16x32_bf16 v[28:31], a[132:135], v[40:43], v[28:31]
    v_cmp_gt_i32 vcc, s32, v65
    v_mfma_f32_16x16x32_bf16 v[32:35], a[136:139], v[40:43], v[32:35]
    v_mfma_f32_16x16x32_bf16 v[36:39], a[140:143], v[40:43], v[36:39]
    s_waitcnt lgkmcnt(2)
    s_and_b64 vcc, vcc, s[18:19]
    s_cselect_b32 s10, 0, s6
    v_mfma_f32_16x16x32_bf16 v[24:27], a[144:147], v[44:47], v[24:27]
    ds_read_b128 v[40:43], v3 offset:12288
    v_mfma_f32_16x16x32_bf16 v[28:31], a[148:151], v[44:47], v[28:31]
    s_cmp_eq_u32 s10, 0
    s_cbranch_scc1 Lffb_slowc1
    v_mfma_f32_16x16x32_bf16 v[32:35], a[152:155], v[44:47], v[32:35]
    s_add_u32 m0, s34, 0
    v_mfma_f32_16x16x32_bf16 v[36:39], a[156:159], v[44:47], v[36:39]
    s_waitcnt lgkmcnt(2)
    buffer_load_dwordx4 v1, s[8:11], s33 offen offset:0 sc1 lds
    v_mfma_f32_16x16x32_bf16 v[24:27], a[160:163], v[48:51], v[24:27]
    ds_read_b128 v[44:47], v3 offset:13312
    v_mfma_f32_16x16x32_bf16 v[28:31], a[164:167], v[48:51], v[28:31]
    v_mfma_f32_16x16x32_bf16 v[32:35], a[168:171], v[48:51], v[32:35]
    v_mfma_f32_16x16x32_bf16 v[36:39], a[172:175], v[48:51], v[36:39]
    s_waitcnt lgkmcnt(2)
    buffer_load_dwordx4 v1, s[8:11], s33 offen offset:1024 sc1 lds
    v_mfma_f32_16x16x32_bf16 v[24:27], a[176:179], v[52:55], v[24:27]
    ds_read_b128 v[48:51], v3 offset:14336
    v_mfma_f32_16x16x32_bf16 v[28:31], a[180:183], v[52:55], v[28:31]
    v_mfma_f32_16x16x32_bf16 v[32:35], a[184:187], v[52:55], v[32:35]
    v_mfma_f32_16x16x32_bf16 v[36:39], a[188:191], v[52:55], v[36:39]
    s_waitcnt lgkmcnt(2)
    buffer_load_dword v5, v4, s[4:7], s16 offen sc1
    v_mfma_f32_16x16x32_bf16 v[24:27], a[192:195], v[40:43], v[24:27]
    ds_read_b128 v[52:55], v3 offset:15360
    v_mfma_f32_16x16x32_bf16 v[28:31], a[196:199], v[40:43], v[28:31]
    v_mfma_f32_16x16x32_bf16 v[32:35], a[200:203], v[40:43], v[32:35]
    v_mfma_f32_16x16x32_bf16 v[36:39], a[204:207], v[40:43], v[36:39]
    s_waitcnt lgkmcnt(2)
    buffer_load_dwordx4 v1, s[8:11], s33 offen offset:2048 sc1 lds
    v_mfma_f32_16x16x32_bf16 v[24:27], a[208:211], v[44:47], v[24:27]
    ds_read_b128 v[40:43], v3 offset:16384
    v_mfma_f32_16x16x32_bf16 v[28:31], a[212:215], v[44:47], v[28:31]
    v_mfma_f32_16x16x32_bf16 v[32:35], a[216:219], v[44:47], v[32:35]
    v_mfma_f32_16x16x32_bf16 v[36:39], a[220:223], v[44:47], v[36:39]
    s_waitcnt lgkmcnt(2)
    buffer_load_dwordx4 v1, s[8:11], s33 offen offset:3072 sc1 lds
    v_mfma_f32_16x16x32_bf16 v[24:27], a[224:227], v[48:51], v[24:27]
    ds_read_b128 v[44:47], v3 offset:17408
    s_add_u32 m0, s34, 4096
    v_mfma_f32_16x16x32_bf16 v[28:31], a[228:231], v[48:51], v[28:31]
    s_add_u32 s37, s33, 4096
    v_mfma_f32_16x16x32_bf16 v[32:35], a[232:235], v[48:51], v[32:35]
    v_mfma_f32_16x16x32_bf16 v[36:39], a[236:239], v[48:51], v[36:39]
    s_waitcnt lgkmcnt(2)
    buffer_load_dwordx4 v1, s[8:11], s37 offen offset:0 sc1 lds
    v_mfma_f32_16x16x32_bf16 v[24:27], a[240:243], v[52:55], v[24:27]
    ds_read_b128 v[48:51], v3 offset:18432
    s_waitcnt vmcnt(6)
    v_mfma_f32_16x16x32_bf16 v[28:31], a[244:247], v[52:55], v[28:31]
    buffer_store_dword v6, v64, s[12:15], s17 offen sc1
    s_mov_b32 s14, s6
    v_mfma_f32_16x16x32_bf16 v[32:35], a[248:251], v[52:55], v[32:35]
    s_add_u32 s17, s17, 8192
    v_mfma_f32_16x16x32_bf16 v[36:39], a[252:255], v[52:55], v[36:39]
    s_waitcnt lgkmcnt(2)
    buffer_load_dwordx4 v1, s[8:11], s37 offen offset:1024 sc1 lds
    v_mfma_f32_16x16x32_bf16 v[24:27], v[128:131], v[40:43], v[24:27]
    ds_read_b128 v[52:55], v3 offset:19456
    s_add_u32 s32, s32, 1
    v_mfma_f32_16x16x32_bf16 v[28:31], v[132:135], v[40:43], v[28:31]
    s_add_u32 s33, s33, 116736
    s_add_u32 s34, s34, 36864
    v_mfma_f32_16x16x32_bf16 v[32:35], v[136:139], v[40:43], v[32:35]
    s_cmp_ge_u32 s34, 147456
    s_cselect_b32 s38, 147456, 0
    s_sub_u32 s34, s34, s38
    v_mfma_f32_16x16x32_bf16 v[36:39], v[140:143], v[40:43], v[36:39]
    s_waitcnt lgkmcnt(2)
    v_mfma_f32_16x16x32_bf16 v[24:27], v[144:147], v[44:47], v[24:27]
    ds_read_b128 v[40:43], v3 offset:20480
    v_mfma_f32_16x16x32_bf16 v[28:31], v[148:151], v[44:47], v[28:31]
    v_mfma_f32_16x16x32_bf16 v[32:35], v[152:155], v[44:47], v[32:35]
    v_mfma_f32_16x16x32_bf16 v[36:39], v[156:159], v[44:47], v[36:39]
    s_waitcnt lgkmcnt(2)
    v_mfma_f32_16x16x32_bf16 v[24:27], v[160:163], v[48:51], v[24:27]
    ds_read_b128 v[44:47], v3 offset:21504
    v_mfma_f32_16x16x32_bf16 v[28:31], v[164:167], v[48:51], v[28:31]
    v_mfma_f32_16x16x32_bf16 v[32:35], v[168:171], v[48:51], v[32:35]
    v_mfma_f32_16x16x32_bf16 v[36:39], v[172:175], v[48:51], v[36:39]
    s_waitcnt lgkmcnt(2)
    v_mfma_f32_16x16x32_bf16 v[24:27], v[176:179], v[52:55], v[24:27]
    ds_read_b128 v[48:51], v3 offset:22528
    v_mfma_f32_16x16x32_bf16 v[28:31], v[180:183], v[52:55], v[28:31]
    v_mfma_f32_16x16x32_bf16 v[32:35], v[184:187], v[52:55], v[32:35]
    v_mfma_f32_16x16x32_bf16 v[36:39], v[188:191], v[52:55], v[36:39]
    s_waitcnt lgkmcnt(2)
    v_mfma_f32_16x16x32_bf16 v[24:27], v[192:195], v[40:43], v[24:27]
    ds_read_b128 v[52:55], v3 offset:23552
    v_mfma_f32_16x16x32_bf16 v[28:31], v[196:199], v[40:43], v[28:31]
    s_waitcnt vmcnt(0)
    s_barrier
    v_mfma_f32_16x16x32_bf16 v[32:35], v[200:203], v[40:43], v[32:35]
    v_cmp_gt_i32 vcc, s32, v5
    v_mfma_f32_16x16x32_bf16 v[36:39], v[204:207], v[40:43], v[36:39]
    s_waitcnt lgkmcnt(2)
    v_mfma_f32_16x16x32_bf16 v[24:27], v[208:211], v[44:47], v[24:27]
    ds_read_b128 v[40:43], v2 offset:0
    v_mfma_f32_16x16x32_bf16 v[28:31], v[212:215], v[44:47], v[28:31]
    s_and_b64 vcc, vcc, s[18:19]
    s_cselect_b32 s10, 0, s6
    s_add_u32 m0, s34, 0
    v_mfma_f32_16x16x32_bf16 v[32:35], v[216:219], v[44:47], v[32:35]
    buffer_load_dwordx4 v1, s[8:11], s33 offen offset:0 sc1 lds
    v_mfma_f32_16x16x32_bf16 v[36:39], v[220:223], v[44:47], v[36:39]
    s_waitcnt lgkmcnt(2)
    v_mfma_f32_16x16x32_bf16 v[24:27], v[224:227], v[48:51], v[24:27]
    ds_read_b128 v[44:47], v2 offset:1024
    v_mfma_f32_16x16x32_bf16 v[28:31], v[228:231], v[48:51], v[28:31]
    v_mfma_f32_16x16x32_bf16 v[32:35], v[232:235], v[48:51], v[32:35]
    buffer_load_dwordx4 v1, s[8:11], s33 offen offset:1024 sc1 lds
    v_mfma_f32_16x16x32_bf16 v[36:39], v[236:239], v[48:51], v[36:39]
    s_waitcnt lgkmcnt(2)
    v_mfma_f32_16x16x32_bf16 v[24:27], v[240:243], v[52:55], v[24:27]
    ds_read_b128 v[48:51], v2 offset:2048
    v_mfma_f32_16x16x32_bf16 v[28:31], v[244:247], v[52:55], v[28:31]
    v_mfma_f32_16x16x32_bf16 v[32:35], v[248:251], v[52:55], v[32:35]
    v_mfma_f32_16x16x32_bf16 v[36:39], v[252:255], v[52:55], v[36:39]
    s_cmp_lt_i32 s31, 63
    s_cbranch_scc1 Lffb_body0
    s_branch L_exit
Lffb_slowc1:
    v_mfma_f32_16x16x32_bf16 v[32:35], a[152:155], v[44:47], v[32:35]
    v_mfma_f32_16x16x32_bf16 v[36:39], a[156:159], v[44:47], v[36:39]
    s_waitcnt lgkmcnt(2)
    v_mfma_f32_16x16x32_bf16 v[24:27], a[160:163], v[48:51], v[24:27]
    ds_read_b128 v[44:47], v3 offset:13312
    v_mfma_f32_16x16x32_bf16 v[28:31], a[164:167], v[48:51], v[28:31]
    v_mfma_f32_16x16x32_bf16 v[32:35], a[168:171], v[48:51], v[32:35]
    v_mfma_f32_16x16x32_bf16 v[36:39], a[172:175], v[48:51], v[36:39]
    s_waitcnt lgkmcnt(2)
    v_mfma_f32_16x16x32_bf16 v[24:27], a[176:179], v[52:55], v[24:27]
    ds_read_b128 v[48:51], v3 offset:14336
    v_mfma_f32_16x16x32_bf16 v[28:31], a[180:183], v[52:55], v[28:31]
    v_mfma_f32_16x16x32_bf16 v[32:35], a[184:187], v[52:55], v[32:35]
    v_mfma_f32_16x16x32_bf16 v[36:39], a[188:191], v[52:55], v[36:39]
    s_waitcnt lgkmcnt(2)
    v_mfma_f32_16x16x32_bf16 v[24:27], a[192:195], v[40:43], v[24:27]
    ds_read_b128 v[52:55], v3 offset:15360
    v_mfma_f32_16x16x32_bf16 v[28:31], a[196:199], v[40:43], v[28:31]
    v_mfma_f32_16x16x32_bf16 v[32:35], a[200:203], v[40:43], v[32:35]
    v_mfma_f32_16x16x32_bf16 v[36:39], a[204:207], v[40:43], v[36:39]
    s_waitcnt lgkmcnt(2)
    v_mfma_f32_16x16x32_bf16 v[24:27], a[208:211], v[44:47], v[24:27]
    ds_read_b128 v[40:43], v3 offset:16384
    v_mfma_f32_16x16x32_bf16 v[28:31], a[212:215], v[44:47], v[28:31]
    v_mfma_f32_16x16x32_bf16 v[32:35], a[216:219], v[44:47], v[32:35]
    v_mfma_f32_16x16x32_bf16 v[36:39], a[220:223], v[44:47], v[36:39]
    s_waitcnt lgkmcnt(2)
    v_mfma_f32_16x16x32_bf16 v[24:27], a[224:227], v[48:51], v[24:27]
    ds_read_b128 v[44:47], v3 offset:17408
    v_mfma_f32_16x16x32_bf16 v[28:31], a[228:231], v[48:51], v[28:31]
    v_mfma_f32_16x16x32_bf16 v[32:35], a[232:235], v[48:51], v[32:35]
    v_mfma_f32_16x16x32_bf16 v[36:39], a[236:239], v[48:51], v[36:39]
    s_waitcnt lgkmcnt(2)
    v_mfma_f32_16x16x32_bf16 v[24:27], a[240:243], v[52:55], v[24:27]
    ds_read_b128 v[48:51], v3 offset:18432
    s_waitcnt vmcnt(0)
    v_mfma_f32_16x16x32_bf16 v[28:31], a[244:247], v[52:55], v[28:31]
    buffer_store_dword v6, v64, s[12:15], s17 offen sc1
    s_mov_b32 s14, s6
    v_mfma_f32_16x16x32_bf16 v[32:35], a[248:251], v[52:55], v[32:35]
    s_add_u32 s17, s17, 8192
    v_mfma_f32_16x16x32_bf16 v[36:39], a[252:255], v[52:55], v[36:39]
    s_waitcnt lgkmcnt(2)
    v_mfma_f32_16x16x32_bf16 v[24:27], v[128:131], v[40:43], v[24:27]
    ds_read_b128 v[52:55], v3 offset:19456
    v_mfma_f32_16x16x32_bf16 v[28:31], v[132:135], v[40:43], v[28:31]
    v_mfma_f32_16x16x32_bf16 v[32:35], v[136:139], v[40:43], v[32:35]
    v_mfma_f32_16x16x32_bf16 v[36:39], v[140:143], v[40:43], v[36:39]
    s_waitcnt lgkmcnt(2)
    v_mfma_f32_16x16x32_bf16 v[24:27], v[144:147], v[44:47], v[24:27]
    ds_read_b128 v[40:43], v3 offset:20480
    v_mfma_f32_16x16x32_bf16 v[28:31], v[148:151], v[44:47], v[28:31]
    v_mfma_f32_16x16x32_bf16 v[32:35], v[152:155], v[44:47], v[32:35]
    v_mfma_f32_16x16x32_bf16 v[36:39], v[156:159], v[44:47], v[36:39]
    s_waitcnt lgkmcnt(2)
    v_mfma_f32_16x16x32_bf16 v[24:27], v[160:163], v[48:51], v[24:27]
    ds_read_b128 v[44:47], v3 offset:21504
    v_mfma_f32_16x16x32_bf16 v[28:31], v[164:167], v[48:51], v[28:31]
    v_mfma_f32_16x16x32_bf16 v[32:35], v[168:171], v[48:51], v[32:35]
    v_mfma_f32_16x16x32_bf16 v[36:39], v[172:175], v[48:51], v[36:39]
    s_waitcnt lgkmcnt(2)
    v_mfma_f32_16x16x32_bf16 v[24:27], v[176:179], v[52:55], v[24:27]
    ds_read_b128 v[48:51], v3 offset:22528
    v_mfma_f32_16x16x32_bf16 v[28:31], v[180:183], v[52:55], v[28:31]
    v_mfma_f32_16x16x32_bf16 v[32:35], v[184:187], v[52:55], v[32:35]
    v_mfma_f32_16x16x32_bf16 v[36:39], v[188:191], v[52:55], v[36:39]
    s_waitcnt lgkmcnt(2)
    v_mfma_f32_16x16x32_bf16 v[24:27], v[192:195], v[40:43], v[24:27]
    ds_read_b128 v[52:55], v3 offset:23552
    v_mfma_f32_16x16x32_bf16 v[28:31], v[196:199], v[40:43], v[28:31]
    v_mfma_f32_16x16x32_bf16 v[32:35], v[200:203], v[40:43], v[32:35]
    v_mfma_f32_16x16x32_bf16 v[36:39], v[204:207], v[40:43], v[36:39]
    s_waitcnt lgkmcnt(2)
    v_mfma_f32_16x16x32_bf16 v[24:27], v[208:211], v[44:47], v[24:27]
    v_mfma_f32_16x16x32_bf16 v[28:31], v[212:215], v[44:47], v[28:31]
    v_mfma_f32_16x16x32_bf16 v[32:35], v[216:219], v[44:47], v[32:35]
    v_mfma_f32_16x16x32_bf16 v[36:39], v[220:223], v[44:47], v[36:39]
    s_waitcnt lgkmcnt(1)
    v_mfma_f32_16x16x32_bf16 v[24:27], v[224:227], v[48:51], v[24:27]
    v_mfma_f32_16x16x32_bf16 v[28:31], v[228:231], v[48:51], v[28:31]
    v_mfma_f32_16x16x32_bf16 v[32:35], v[232:235], v[48:51], v[32:35]
    v_mfma_f32_16x16x32_bf16 v[36:39], v[236:239], v[48:51], v[36:39]
    s_waitcnt lgkmcnt(0)
    v_mfma_f32_16x16x32_bf16 v[24:27], v[240:243], v[52:55], v[24:27]
    v_mfma_f32_16x16x32_bf16 v[28:31], v[244:247], v[52:55], v[28:31]
    v_mfma_f32_16x16x32_bf16 v[32:35], v[248:251], v[52:55], v[32:35]
    v_mfma_f32_16x16x32_bf16 v[36:39], v[252:255], v[52:55], v[36:39]
    s_nop 4
    v_cvt_pk_bf16_f32 v56, v24, v25
    v_cvt_pk_bf16_f32 v57, v26, v27
    v_cvt_pk_bf16_f32 v58, v28, v29
    v_cvt_pk_bf16_f32 v59, v30, v31
    buffer_store_dwordx4 v[56:59], v1, s[12:15], s36 offen offset:0 sc1
    v_cvt_pk_bf16_f32 v60, v32, v33
    v_cvt_pk_bf16_f32 v61, v34, v35
    v_cvt_pk_bf16_f32 v62, v36, v37
    v_cvt_pk_bf16_f32 v63, v38, v39
    buffer_store_dwordx4 v[60:63], v1, s[12:15], s36 offen offset:1024 sc1
    s_add_u32 s54, s31, 1
    v_mov_b32 v6, s54
Lffb_late1:
    s_mov_b32 s16, s39
    buffer_load_dword v5, v4, s[4:7], s16 offen sc1
    s_waitcnt vmcnt(1)
    buffer_store_dword v6, v64, s[12:15], s17 offen sc1
    s_cmp_ge_i32 s31, 63
    s_cbranch_scc1 L_exit
    s_waitcnt vmcnt(1)
    v_cmp_gt_i32 vcc, s32, v5
    s_sub_u32 s43, s43, 1
    s_cmp_lt_i32 s43, 0
    s_cbranch_scc1 Lffb_rdy1
    s_and_b64 vcc, vcc, s[18:19]
    s_cbranch_scc0 Lffb_rdy1
Lffb_spin1:
    buffer_load_dword v5, v4, s[4:7], s16 offen sc1
    s_waitcnt vmcnt(0)
    v_cmp_gt_i32 vcc, s32, v5
    s_sub_u32 s43, s43, 1
    s_cmp_lt_i32 s43, 0
    s_cbranch_scc1 Lffb_rdy1
    s_and_b64 vcc, vcc, s[18:19]
    s_cbranch_scc0 Lffb_rdy1
    s_sleep 8
    s_branch Lffb_spin1
Lffb_rdy1:
    s_add_u32 s16, s16, 8192
    buffer_load_dword v5, v4, s[4:7], s16 offen sc1
    s_mov_b32 s10, s6
    s_add_u32 m0, s34, 0
    s_nop 0
    buffer_load_dwordx4 v1, s[8:11], s33 offen offset:0 sc1 lds
    buffer_load_dwordx4 v1, s[8:11], s33 offen offset:1024 sc1 lds
    buffer_load_dwordx4 v1, s[8:11], s33 offen offset:2048 sc1 lds
    buffer_load_dwordx4 v1, s[8:11], s33 offen offset:3072 sc1 lds
    s_add_u32 m0, s34, 4096
    s_add_u32 s37, s33, 4096
    buffer_load_dwordx4 v1, s[8:11], s37 offen offset:0 sc1 lds
    buffer_load_dwordx4 v1, s[8:11], s37 offen offset:1024 sc1 lds
    s_waitcnt vmcnt(6)
    s_add_u32 s32, s32, 1
    s_add_u32 s33, s33, 116736
    s_add_u32 s34, s34, 36864
    s_cmp_ge_u32 s34, 147456
    s_cselect_b32 s38, 147456, 0
    s_sub_u32 s34, s34, s38
    v_cmp_gt_i32 vcc, s32, v5
    s_nop 0
    s_and_b64 vcc, vcc, s[18:19]
    s_cselect_b32 s10, 0, s6
    s_add_u32 m0, s34, 0
    s_nop 0
    buffer_load_dwordx4 v1, s[8:11], s33 offen offset:0 sc1 lds
    buffer_load_dwordx4 v1, s[8:11], s33 offen offset:1024 sc1 lds
    s_waitcnt vmcnt(2)
Lffb_go1:
    s_mov_b32 s14, 0
    s_barrier
    ds_read_b128 v[40:43], v2 offset:0
    ds_read_b128 v[44:47], v2 offset:1024
    ds_read_b128 v[48:51], v2 offset:2048
    s_branch Lffb_body0
L_exit:
L_end:
    s_endpgm
.section .rodata,"a"
.p2align 6
.amdhsa_kernel interleave_layers__sliding_local_dilated__dense_activation_squared_relu__prompt_kernel
  .amdhsa_next_free_vgpr 512
  .amdhsa_next_free_sgpr 102
  .amdhsa_accum_offset 256
  .amdhsa_group_segment_fixed_size 0
  .amdhsa_kernarg_size 88
  .amdhsa_user_sgpr_count 2
  .amdhsa_user_sgpr_kernarg_segment_ptr 1
  .amdhsa_system_sgpr_workgroup_id_x 1
.end_amdhsa_kernel
```

```asm
; @launch grid=(256,1,1) block=(256,1,1) lds=163840
.amdgcn_target "amdgcn-amd-amdhsa--gfx950"
.text
.globl interleave_layers__sliding_local_dilated__dense_activation_squared_relu__prompt_kernel
.p2align 8
.type interleave_layers__sliding_local_dilated__dense_activation_squared_relu__prompt_kernel,@function
interleave_layers__sliding_local_dilated__dense_activation_squared_relu__prompt_kernel:
    s_load_dwordx16 s[64:79], s[0:1], 0x0
    s_load_dwordx4 s[80:83], s[0:1], 0x40
    s_load_dwordx2 s[84:85], s[0:1], 0x50
    s_cmp_ge_u32 s2, 256
    s_cbranch_scc1 L_end
    v_lshrrev_b32 v1, 6, v0
    s_nop 0
    v_readfirstlane_b32 s30, v1
    v_and_b32 v0, 63, v0
    v_lshlrev_b32 v1, 4, v0
    s_lshr_b32 s53, s2, 4
    s_cmp_lt_u32 s53, 8
    s_mov_b32 s38, 0x2c281b1a
    s_mov_b32 s39, 0x3c31302d
    s_cselect_b32 s38, 0x3020100, s38
    s_cselect_b32 s39, 0x19181110, s39
    s_lshl_b32 s37, s53, 3
    s_lshr_b64 s[38:39], s[38:39], s37
    s_and_b32 s29, s38, 63
    s_mov_b32 s38, 0x11221111
    s_mov_b32 s39, 0x43333011
    s_lshl_b32 s37, s53, 2
    s_lshr_b64 s[38:39], s[38:39], s37
    s_and_b32 s53, s38, 7
    s_mov_b32 s38, 0xc8403210
    s_mov_b32 s39, 0xa8206240
    s_cmp_eq_u32 s53, 4
    s_cselect_b32 s38, 0x1302, s38
    s_mov_b32 s3, s2
    s_lshr_b32 s37, s2, 2
    s_xor_b32 s37, s37, s2
    s_and_b32 s37, s37, 2
    s_mul_i32 s37, s37, 5
    s_bitcmp1_b32 0x14, s53
    s_cselect_b32 s37, s37, 0
    s_xor_b32 s3, s2, s37
    s_and_b32 s37, s3, 3
    s_lshl_b32 s28, s53, 2
    s_add_u32 s37, s37, s28
    s_lshl_b32 s37, s37, 2
    s_lshr_b64 s[38:39], s[38:39], s37
    s_and_b32 s38, s38, 15
    s_add_u32 s29, s29, s38
    s_bfe_u32 s28, s3, 0x20002
    s_cmp_ge_u32 s53, 2
    s_cselect_b32 s37, 1, 0
    s_xor_b32 s28, s28, s37
    s_mov_b32 s43, 0x40000
    s_mov_b32 s55, 0
    s_waitcnt lgkmcnt(0)
    s_mov_b32 s4, s84
    s_mov_b32 s5, s85
    s_mov_b32 s6, 0x6200000
    s_mov_b32 s7, 0x00020000
    s_mov_b32 s8, s84
    s_mov_b32 s9, s85
    s_mov_b32 s10, 0x6200000
    s_mov_b32 s11, 0x00020000
    s_cmp_lt_u32 s29, 16
    s_cbranch_scc1 Lqkv_start
    s_cmp_ge_u32 s2, 128
    s_cbranch_scc1 L_prep
    s_lshr_b32 s38, s2, 3
    s_mov_b32 s24, s66
    s_mov_b32 s25, s67
    s_mov_b32 s26, 0x600000
    s_mov_b32 s27, 0x00020000
    v_lshrrev_b32 v12, 2, v0
    v_mul_u32_u24 v12, 6144, v12
    v_and_b32 v14, 3, v0
    v_lshl_add_u32 v12, v14, 7, v12
    s_and_b32 s41, s2, 3
    s_mul_i32 s37, s38, 0x60000
    s_mul_i32 s53, s30, 0x18000
    s_add_u32 s37, s37, s53
    s_mul_i32 s53, s41, 0x200
    s_add_u32 s37, s37, s53
    s_add_u32 s37, s37, 0xffd00000
    buffer_load_dword v13, v12, s[24:27], s37 offen
    s_add_u32 s37, s37, 2048
    buffer_load_dword v14, v12, s[24:27], s37 offen
    s_add_u32 s37, s37, 2048
    buffer_load_dword v15, v12, s[24:27], s37 offen
    s_getpc_b64 s[24:25]
L_pc84:
    s_sub_u32 s24, s24, L_pc84-interleave_layers__sliding_local_dilated__dense_activation_squared_relu__prompt_kernel
    s_subb_u32 s25, s25, 0
    s_mov_b32 s26, L_end-interleave_layers__sliding_local_dilated__dense_activation_squared_relu__prompt_kernel
    s_mov_b32 s27, 0x00020000
    s_mul_i32 s37, s38, 0x200
    s_mul_i32 s53, s30, 0x80
    s_add_u32 s37, s37, s53
    s_add_u32 s37, s37, 0xfffff000
    v_min_u32 v12, 11, v0
    v_mul_u32_u24 v12, 12288, v12
    buffer_load_dword v55, v12, s[24:27], s37 offen
    s_waitcnt vmcnt(1)
    s_branch L_noprep
L_prep:
    s_and_b32 s33, s2, 3
    s_bfe_u32 s34, s2, 0x50002
    s_mov_b32 s20, s64
    s_mov_b32 s21, s65
    s_mov_b32 s22, 0x400000
    s_mov_b32 s23, 0x00020000
    v_bfe_u32 v8, v0, 4, 1
    v_lshlrev_b32 v8, 5, v8
    v_lshrrev_b32 v10, 5, v0
    v_lshl_add_u32 v8, v10, 4, v8
    v_and_b32 v10, 15, v0
    v_lshl_add_u32 v8, v10, 11, v8
    s_mul_i32 s37, s33, 0x100000
    s_mul_i32 s53, s34, 0xffff8000
    s_add_u32 s37, s37, s53
    s_mul_i32 s53, s30, 0x200
    s_add_u32 s37, s37, s53
    s_add_u32 s37, s37, 0xf8000
    buffer_load_dwordx4 v[16:19], v8, s[20:23], s37 offen offset:0
    buffer_load_dwordx4 v[20:23], v8, s[20:23], s37 offen offset:64
    buffer_load_dwordx4 v[24:27], v8, s[20:23], s37 offen offset:128
    buffer_load_dwordx4 v[28:31], v8, s[20:23], s37 offen offset:192
    buffer_load_dwordx4 v[32:35], v8, s[20:23], s37 offen offset:256
    buffer_load_dwordx4 v[36:39], v8, s[20:23], s37 offen offset:320
    buffer_load_dwordx4 v[40:43], v8, s[20:23], s37 offen offset:384
    buffer_load_dwordx4 v[44:47], v8, s[20:23], s37 offen offset:448
    s_mul_i32 s37, s2, 0x4000
    s_mul_i32 s53, s30, 0x1000
    s_add_u32 s37, s37, s53
    s_add_u32 s37, s37, 0x5e00000
    v_mov_b32 v60, 0
    v_mov_b32 v61, 0
    v_mov_b32 v62, 0
    v_mov_b32 v63, 0
    buffer_store_dwordx4 v[60:63], v1, s[4:7], s37 offen offset:0 sc1
    buffer_store_dwordx4 v[60:63], v1, s[4:7], s37 offen offset:1024 sc1
    buffer_store_dwordx4 v[60:63], v1, s[4:7], s37 offen offset:2048 sc1
    buffer_store_dwordx4 v[60:63], v1, s[4:7], s37 offen offset:3072 sc1
    v_mov_b32 v56, 0x3f803f80
    v_mov_b32 v57, 0x3f803f80
    v_mov_b32 v58, 0x3f803f80
    v_mov_b32 v59, 0x3f803f80
    s_mov_b32 s44, 0xaaaaaaaa
    s_mov_b32 s45, 0xaaaaaaaa
    s_mov_b32 s46, 0xcccccccc
    s_mov_b32 s47, 0xcccccccc
    s_mov_b32 s38, 0xf0000f
    s_mov_b32 s39, 0xf0000f00
    v_and_b32 v10, 15, v0
    v_lshlrev_b32 v10, 3, v10
    v_mov_b32 v9, 0x40000000
    v_cndmask_b32 v9, v9, v10, s[38:39]
    s_mul_i32 s36, s33, 0x220000
    s_mul_i32 s53, s34, 0x8800
    s_add_u32 s36, s36, s53
    s_mul_i32 s53, s30, 0x2000
    s_add_u32 s36, s36, s53
    s_add_u32 s42, s36, 4096
    s_mul_i32 s40, s33, 0x220000
    s_mul_i32 s53, s34, 0x8800
    s_add_u32 s40, s40, s53
    s_mul_i32 s53, s30, 0x200
    s_add_u32 s40, s40, s53
    s_add_u32 s40, s40, 0x8000
    s_waitcnt vmcnt(4)
    v_permlane16_swap_b32 v16, v18
    v_permlane16_swap_b32 v17, v19
    buffer_store_dwordx4 v[16:19], v1, s[4:7], s36 offen offset:0 sc1
    v_permlane16_swap_b32 v20, v22
    v_permlane16_swap_b32 v21, v23
    buffer_store_dwordx4 v[20:23], v1, s[4:7], s36 offen offset:1024 sc1
    v_permlane16_swap_b32 v24, v26
    v_permlane16_swap_b32 v25, v27
    buffer_store_dwordx4 v[24:27], v1, s[4:7], s36 offen offset:2048 sc1
    v_permlane16_swap_b32 v28, v30
    v_permlane16_swap_b32 v29, v31
    buffer_store_dwordx4 v[28:31], v1, s[4:7], s36 offen offset:3072 sc1
    v_permlane16_swap_b32 v32, v34
    v_permlane16_swap_b32 v33, v35
    buffer_store_dwordx4 v[32:35], v1, s[4:7], s42 offen offset:0 sc1
    v_permlane16_swap_b32 v36, v38
    v_permlane16_swap_b32 v37, v39
    buffer_store_dwordx4 v[36:39], v1, s[4:7], s42 offen offset:1024 sc1
    v_permlane16_swap_b32 v40, v42
    v_permlane16_swap_b32 v41, v43
    buffer_store_dwordx4 v[40:43], v1, s[4:7], s42 offen offset:2048 sc1
    v_permlane16_swap_b32 v44, v46
    v_permlane16_swap_b32 v45, v47
    buffer_store_dwordx4 v[44:47], v1, s[4:7], s42 offen offset:3072 sc1
    v_mfma_f32_16x16x32_bf16 v[68:71], v[16:19], v[16:19], 0
    v_mfma_f32_16x16x32_bf16 v[76:79], v[24:27], v[24:27], 0
    v_mfma_f32_16x16x32_bf16 v[84:87], v[32:35], v[32:35], 0
    v_mfma_f32_16x16x32_bf16 v[92:95], v[40:43], v[40:43], 0
    v_mfma_f32_16x16x32_bf16 v[64:67], v[56:59], v[16:19], 0
    v_mfma_f32_16x16x32_bf16 v[72:75], v[56:59], v[24:27], 0
    v_mfma_f32_16x16x32_bf16 v[80:83], v[56:59], v[32:35], 0
    v_mfma_f32_16x16x32_bf16 v[88:91], v[56:59], v[40:43], 0
    v_mfma_f32_16x16x32_bf16 v[68:71], v[20:23], v[20:23], v[68:71]
    v_mfma_f32_16x16x32_bf16 v[76:79], v[28:31], v[28:31], v[76:79]
    v_mfma_f32_16x16x32_bf16 v[84:87], v[36:39], v[36:39], v[84:87]
    v_mfma_f32_16x16x32_bf16 v[92:95], v[44:47], v[44:47], v[92:95]
    v_mfma_f32_16x16x32_bf16 v[64:67], v[56:59], v[20:23], v[64:67]
    v_mfma_f32_16x16x32_bf16 v[72:75], v[56:59], v[28:31], v[72:75]
    v_mfma_f32_16x16x32_bf16 v[80:83], v[56:59], v[36:39], v[80:83]
    v_mfma_f32_16x16x32_bf16 v[88:91], v[56:59], v[44:47], v[88:91]
    s_nop 0
    v_cndmask_b32 v68, v68, v69, s[44:45]
    v_cndmask_b32 v76, v76, v77, s[44:45]
    v_cndmask_b32 v84, v84, v85, s[44:45]
    v_cndmask_b32 v92, v92, v93, s[44:45]
    v_cndmask_b32 v70, v70, v71, s[44:45]
    v_cndmask_b32 v78, v78, v79, s[44:45]
    v_cndmask_b32 v86, v86, v87, s[44:45]
    v_cndmask_b32 v94, v94, v95, s[44:45]
    v_cndmask_b32 v65, v68, v70, s[46:47]
    v_cndmask_b32 v73, v76, v78, s[46:47]
    v_cndmask_b32 v81, v84, v86, s[46:47]
    v_cndmask_b32 v89, v92, v94, s[46:47]
    buffer_store_dwordx2 v[64:65], v9, s[4:7], s40 offen offset:0 sc1
    buffer_store_dwordx2 v[72:73], v9, s[4:7], s40 offen offset:128 sc1
    buffer_store_dwordx2 v[80:81], v9, s[4:7], s40 offen offset:256 sc1
    buffer_store_dwordx2 v[88:89], v9, s[4:7], s40 offen offset:384 sc1
    s_lshr_b32 s38, s2, 3
    s_mov_b32 s24, s66
    s_mov_b32 s25, s67
    s_mov_b32 s26, 0x600000
    s_mov_b32 s27, 0x00020000
    v_lshrrev_b32 v12, 2, v0
    v_mul_u32_u24 v12, 6144, v12
    v_and_b32 v14, 3, v0
    v_lshl_add_u32 v12, v14, 7, v12
    s_and_b32 s41, s2, 3
    s_lshr_b32 s39, s30, 1
    s_mul_i32 s37, s38, 0x30000
    s_mul_i32 s53, s39, 0x18000
    s_add_u32 s37, s37, s53
    s_mul_i32 s53, s41, 0x200
    s_add_u32 s37, s37, s53
    s_and_b32 s39, s30, 1
    s_lshl_b32 s39, s39, 11
    s_add_u32 s37, s37, s39
    buffer_load_dword v13, v12, s[24:27], s37 offen
    s_add_u32 s37, s37, 2048
    buffer_load_dword v14, v12, s[24:27], s37 offen
    s_getpc_b64 s[24:25]
L_pc244:
    s_sub_u32 s24, s24, L_pc244-interleave_layers__sliding_local_dilated__dense_activation_squared_relu__prompt_kernel
    s_subb_u32 s25, s25, 0
    s_mov_b32 s26, L_end-interleave_layers__sliding_local_dilated__dense_activation_squared_relu__prompt_kernel
    s_mov_b32 s27, 0x00020000
    s_mul_i32 s37, s38, 0x200
    s_mul_i32 s53, s30, 0x80
    s_add_u32 s37, s37, s53
    s_add_u32 s37, s37, 0xfffff000
    v_min_u32 v12, 11, v0
    v_mul_u32_u24 v12, 12288, v12
    buffer_load_dword v55, v12, s[24:27], s37 offen
    s_waitcnt vmcnt(3)
    s_barrier
    s_mov_b32 s20, s82
    s_mov_b32 s21, s83
    s_mov_b32 s22, 0x100
    s_mov_b32 s23, 0x00020000
    s_cmp_eq_u32 s30, 0
    s_cselect_b32 s22, 256, 0
    s_and_b32 s37, s2, 15
    s_lshl_b32 s37, s37, 4
    v_mov_b32 v6, 1
    v_lshlrev_b32 v5, 8, v0
    buffer_atomic_add v6, v5, s[20:23], s37 offen
    s_waitcnt vmcnt(2)
L_noprep:
    s_cmp_lt_u32 s29, 24
    s_cbranch_scc1 Lwo_start
    s_cmp_lt_u32 s29, 43
    s_cbranch_scc1 Lffa_start
    s_cmp_lt_u32 s29, 44
    s_cbranch_scc1 L_end
    s_cmp_lt_u32 s29, 60
    s_cbranch_scc1 Lffb_start
Lred_start:
    s_mov_b32 s12, s76
    s_mov_b32 s13, s77
    s_mov_b32 s14, 0x700000
    s_mov_b32 s15, 0x00020000
    v_lshrrev_b32 v24, 3, v0
    v_mul_u32_u24 v24, 2048, v24
    v_bfe_u32 v25, v0, 4, 2
    v_lshlrev_b32 v25, 1, v25
    v_and_b32 v26, 7, v0
    v_xor_b32 v25, v25, v26
    v_lshl_add_u32 v40, v25, 4, v24
    v_add_u32 v41, 15360, v40
    s_sub_u32 s38, s29, 44
    s_and_b32 s39, s38, 3
    s_lshr_b32 s38, s38, 2
    s_mul_i32 s86, s38, 0x180000
    s_mul_i32 s53, s39, 0x200
    s_add_u32 s86, s86, s53
    s_mul_i32 s37, s30, 32768
    s_add_u32 s86, s86, s37
    s_lshl_b32 s87, s30, 11
    s_add_u32 m0, s87, 0
    s_add_u32 s37, s86, 0
    buffer_load_dwordx4 v40, s[12:15], s37 offen offset:0 lds
    buffer_load_dwordx4 v41, s[12:15], s37 offen offset:1024 lds
    s_add_u32 m0, s87, 8192
    s_add_u32 s37, s86, 128
    buffer_load_dwordx4 v40, s[12:15], s37 offen offset:0 lds
    buffer_load_dwordx4 v41, s[12:15], s37 offen offset:1024 lds
    s_add_u32 m0, s87, 16384
    s_add_u32 s37, s86, 256
    buffer_load_dwordx4 v40, s[12:15], s37 offen offset:0 lds
    buffer_load_dwordx4 v41, s[12:15], s37 offen offset:1024 lds
    s_add_u32 m0, s87, 24576
    s_add_u32 s37, s86, 384
    buffer_load_dwordx4 v40, s[12:15], s37 offen offset:0 lds
    buffer_load_dwordx4 v41, s[12:15], s37 offen offset:1024 lds
    s_add_u32 m0, s87, 32768
    s_add_u32 s37, s86, 131072
    buffer_load_dwordx4 v40, s[12:15], s37 offen offset:0 lds
    buffer_load_dwordx4 v41, s[12:15], s37 offen offset:1024 lds
    s_add_u32 m0, s87, 40960
    s_add_u32 s37, s86, 131200
    buffer_load_dwordx4 v40, s[12:15], s37 offen offset:0 lds
    buffer_load_dwordx4 v41, s[12:15], s37 offen offset:1024 lds
    s_add_u32 m0, s87, 49152
    s_add_u32 s37, s86, 131328
    buffer_load_dwordx4 v40, s[12:15], s37 offen offset:0 lds
    buffer_load_dwordx4 v41, s[12:15], s37 offen offset:1024 lds
    s_add_u32 m0, s87, 57344
    s_add_u32 s37, s86, 131456
    buffer_load_dwordx4 v40, s[12:15], s37 offen offset:0 lds
    buffer_load_dwordx4 v41, s[12:15], s37 offen offset:1024 lds
    s_add_u32 m0, s87, 65536
    s_add_u32 s37, s86, 262144
    buffer_load_dwordx4 v40, s[12:15], s37 offen offset:0 lds
    buffer_load_dwordx4 v41, s[12:15], s37 offen offset:1024 lds
    s_add_u32 m0, s87, 73728
    s_add_u32 s37, s86, 262272
    buffer_load_dwordx4 v40, s[12:15], s37 offen offset:0 lds
    buffer_load_dwordx4 v41, s[12:15], s37 offen offset:1024 lds
    s_add_u32 m0, s87, 81920
    s_add_u32 s37, s86, 262400
    buffer_load_dwordx4 v40, s[12:15], s37 offen offset:0 lds
    buffer_load_dwordx4 v41, s[12:15], s37 offen offset:1024 lds
    s_add_u32 m0, s87, 90112
    s_add_u32 s37, s86, 262528
    buffer_load_dwordx4 v40, s[12:15], s37 offen offset:0 lds
    buffer_load_dwordx4 v41, s[12:15], s37 offen offset:1024 lds
    s_add_u32 m0, s87, 98304
    s_add_u32 s37, s86, 393216
    buffer_load_dwordx4 v40, s[12:15], s37 offen offset:0 lds
    buffer_load_dwordx4 v41, s[12:15], s37 offen offset:1024 lds
    s_add_u32 m0, s87, 106496
    s_add_u32 s37, s86, 393344
    buffer_load_dwordx4 v40, s[12:15], s37 offen offset:0 lds
    buffer_load_dwordx4 v41, s[12:15], s37 offen offset:1024 lds
    s_add_u32 m0, s87, 114688
    s_add_u32 s37, s86, 393472
    buffer_load_dwordx4 v40, s[12:15], s37 offen offset:0 lds
    buffer_load_dwordx4 v41, s[12:15], s37 offen offset:1024 lds
    s_add_u32 m0, s87, 122880
    s_add_u32 s37, s86, 393600
    buffer_load_dwordx4 v40, s[12:15], s37 offen offset:0 lds
    buffer_load_dwordx4 v41, s[12:15], s37 offen offset:1024 lds
    v_bfe_u32 v24, v0, 3, 2
    v_and_b32 v25, 3, v0
    v_lshlrev_b32 v25, 3, v25
    v_lshrrev_b32 v26, 2, v0
    v_lshl_add_u32 v26, v26, 7, v25
    v_lshrrev_b32 v27, 5, v0
    v_lshl_add_u32 v27, v27, 10, v26
    s_mov_b32 s37, s30
    s_mov_b32 s38, 0
    s_lshl_b32 s37, s37, 13
    v_xor_b32 v28, s38, v24
    v_lshl_add_u32 v28, v28, 5, s37
    v_add_u32 v42, v28, v26
    v_add_u32 v46, v28, v27
    s_mov_b32 s37, s30
    s_mov_b32 s38, 1
    s_lshl_b32 s37, s37, 13
    v_xor_b32 v28, s38, v24
    v_lshl_add_u32 v28, v28, 5, s37
    v_add_u32 v43, v28, v26
    v_add_u32 v47, v28, v27
    s_mov_b32 s37, s30
    s_mov_b32 s38, 2
    s_lshl_b32 s37, s37, 13
    v_xor_b32 v28, s38, v24
    v_lshl_add_u32 v28, v28, 5, s37
    v_add_u32 v44, v28, v26
    v_add_u32 v48, v28, v27
    s_mov_b32 s37, s30
    s_mov_b32 s38, 3
    s_lshl_b32 s37, s37, 13
    v_xor_b32 v28, s38, v24
    v_lshl_add_u32 v28, v28, 5, s37
    v_add_u32 v45, v28, v26
    v_add_u32 v49, v28, v27
    s_mov_b32 s20, s78
    s_mov_b32 s21, s79
    s_mov_b32 s22, 0x800
    s_mov_b32 s23, 0x00020000
    v_lshrrev_b32 v8, 4, v0
    v_lshlrev_b32 v8, 3, v8
    s_mul_i32 s37, s29, 0x200
    s_mul_i32 s53, s30, 0x80
    s_add_u32 s37, s37, s53
    s_add_u32 s37, s37, 0xffff8800
    buffer_load_dwordx2 v[10:11], v8, s[20:23], s37 offen
    s_mul_i32 s37, s29, 0x200
    s_mul_i32 s53, s30, 0x80
    s_add_u32 s37, s37, s53
    s_add_u32 s37, s37, 0xffff8820
    buffer_load_dwordx2 v[12:13], v8, s[20:23], s37 offen
    s_mul_i32 s37, s29, 0x200
    s_mul_i32 s53, s30, 0x80
    s_add_u32 s37, s37, s53
    s_add_u32 s37, s37, 0xffff8840
    buffer_load_dwordx2 v[14:15], v8, s[20:23], s37 offen
    s_mul_i32 s37, s29, 0x200
    s_mul_i32 s53, s30, 0x80
    s_add_u32 s37, s37, s53
    s_add_u32 s37, s37, 0xffff8860
    buffer_load_dwordx2 v[16:17], v8, s[20:23], s37 offen
    s_waitcnt vmcnt(0)
    v_lshlrev_b32 v100, 16, v10
    v_and_b32 v101, 0xffff0000, v10
    v_lshlrev_b32 v102, 16, v11
    v_and_b32 v103, 0xffff0000, v11
    v_lshlrev_b32 v104, 16, v12
    v_and_b32 v105, 0xffff0000, v12
    v_lshlrev_b32 v106, 16, v13
    v_and_b32 v107, 0xffff0000, v13
    v_lshlrev_b32 v108, 16, v14
    v_and_b32 v109, 0xffff0000, v14
    v_lshlrev_b32 v110, 16, v15
    v_and_b32 v111, 0xffff0000, v15
    v_lshlrev_b32 v112, 16, v16
    v_and_b32 v113, 0xffff0000, v16
    v_lshlrev_b32 v114, 16, v17
    v_and_b32 v115, 0xffff0000, v17
    v_mov_b32 v90, 0x3f803f80
    v_mov_b32 v91, 0x3f803f80
    v_mov_b32 v92, 0x3f803f80
    v_mov_b32 v93, 0x3f803f80
    s_mov_b32 s44, 0xaaaaaaaa
    s_mov_b32 s45, 0xaaaaaaaa
    s_mov_b32 s46, 0xcccccccc
    s_mov_b32 s47, 0xcccccccc
    s_mov_b32 s38, 0xf0000f
    s_mov_b32 s39, 0xf0000f00
    v_and_b32 v8, 15, v0
    v_lshlrev_b32 v8, 3, v8
    v_mov_b32 v7, 0x40000000
    v_cndmask_b32 v7, v7, v8, s[38:39]
    s_mul_i32 s37, s29, 0xffffe200
    s_mul_i32 s53, s30, 0xfffff880
    s_add_u32 s37, s37, s53
    s_add_u32 s37, s37, 0x78800
    v_add_u32 v7, s37, v7
    v_mov_b32 v94, 0
    v_mov_b32 v95, 0
    v_mov_b32 v98, 0
    v_mov_b32 v99, 0
    v_mov_b32 v8, 0x3f80
    v_mov_b32 v9, 0x3f800000
    s_mov_b32 s38, 0x100001
    s_mov_b32 s39, 0x10000100
    v_cndmask_b32 v96, v94, v8, s[38:39]
    s_mov_b32 s38, 0x200002
    s_mov_b32 s39, 0x20000200
    v_cndmask_b32 v96, v96, v9, s[38:39]
    s_mov_b32 s38, 0x400004
    s_mov_b32 s39, 0x40000400
    v_cndmask_b32 v97, v94, v8, s[38:39]
    s_mov_b32 s38, 0x800008
    s_mov_b32 s39, 0x80000800
    v_cndmask_b32 v97, v97, v9, s[38:39]
    s_mul_i32 s37, s30, 0x800
    s_add_u32 s37, s37, 0x24000
    v_add_u32 v222, s37, v1
    v_and_b32 v8, 15, v0
    v_lshl_add_u32 v9, v8, 7, s37
    v_bfe_u32 v10, v0, 4, 1
    v_lshl_add_u32 v9, v10, 3, v9
    v_lshrrev_b32 v10, 5, v0
    v_and_b32 v8, 7, v0
    v_xor_b32 v10, v10, v8
    v_add_u32 v210, 0, v222
    v_xor_b32 v11, 0, v10
    v_lshl_add_u32 v216, v11, 4, v9
    v_add_u32 v211, 8, v222
    v_xor_b32 v11, 2, v10
    v_lshl_add_u32 v217, v11, 4, v9
    v_add_u32 v212, 1024, v222
    v_xor_b32 v11, 4, v10
    v_lshl_add_u32 v218, v11, 4, v9
    v_add_u32 v213, 1032, v222
    v_xor_b32 v11, 6, v10
    v_lshl_add_u32 v219, v11, 4, v9
    v_lshrrev_b32 v9, 3, v0
    v_xor_b32 v8, v8, v9
    v_lshlrev_b32 v8, 4, v8
    v_add_u32 v214, 0, v1
    v_add_u32 v215, 1024, v1
    v_lshl_add_u32 v220, v9, 11, v8
    v_add_u32 v221, 16384, v220
    v_mov_b32 v204, v210
    v_mov_b32 v205, v211
    v_mov_b32 v206, v212
    v_mov_b32 v207, v213
    v_mov_b32 v208, v214
    v_mov_b32 v209, v215
    s_mul_i32 s37, s28, 0x80000
    s_add_u32 s37, s37, 0x6005200
    v_min_u32 v4, 27, v0
    v_lshl_add_u32 v4, v4, 5, s37
    s_mul_i32 s37, s28, 0x80000
    s_mul_i32 s53, s29, 0x80
    s_add_u32 s37, s37, s53
    s_add_u32 s37, s37, 0x5fff800
    v_lshrrev_b32 v8, 2, v0
    v_lshl_add_u32 v8, v8, 9, s37
    v_and_b32 v9, 3, v0
    v_lshl_add_u32 v8, v9, 5, v8
    v_cmp_gt_u32 vcc, 16, v0
    s_nop 1
    v_cndmask_b32 v4, v4, v8, vcc
    v_subrev_u32 v4, 16384, v4
    s_mov_b32 s32, 1
    s_mul_i32 s33, s28, 0x720000
    s_add_u32 s33, s33, 0x2018000
    s_mul_i32 s40, s28, 0x800000
    s_mul_i32 s53, s29, 0x2000
    s_add_u32 s40, s40, s53
    s_mul_i32 s53, s30, 0x800
    s_add_u32 s40, s40, s53
    s_add_u32 s40, s40, 0x3f88000
    s_mul_i32 s41, s28, 0x240000
    s_mul_i32 s53, s29, 0x2000
    s_add_u32 s41, s41, s53
    s_mul_i32 s53, s30, 0x800
    s_add_u32 s41, s41, s53
    s_add_u32 s41, s41, 0x1188000
    s_mul_i32 s36, s28, 0x220000
    s_mul_i32 s53, s29, 0x2000
    s_add_u32 s36, s36, s53
    s_mul_i32 s53, s30, 0x800
    s_add_u32 s36, s36, s53
    s_add_u32 s36, s36, 0x8f800
    s_mul_i32 s42, s28, 0x100000
    s_mul_i32 s53, s29, 0x200
    s_add_u32 s42, s42, s53
    s_mul_i32 s53, s30, 0x80
    s_add_u32 s42, s42, s53
    s_add_u32 s42, s42, 0x1f8800
    s_mov_b32 s24, s84
    s_mov_b32 s25, s85
    s_mov_b32 s26, 0x0
    s_mov_b32 s27, 0x00020000
    s_mov_b32 s54, 0
    s_mov_b32 s31, -1
    s_mov_b32 s35, 0
    s_mov_b32 s16, 0
    v_mov_b32 v5, 0
    s_mul_i32 s17, s28, 0x80000
    s_mul_i32 s53, s29, 0x80
    s_add_u32 s17, s17, s53
    s_mul_i32 s53, s30, 0x20
    s_add_u32 s17, s17, s53
    s_add_u32 s17, s17, 0x5ffc000
    v_cmp_eq_u32 vcc, 0, v0
    v_mov_b32 v80, 0x40000000
    s_nop 0
    v_cndmask_b32 v80, v80, v0, vcc
    v_mov_b32 v2, v1
    s_mul_i32 s34, s30, 4096
    s_add_u32 s33, s33, s34
    s_mov_b64 s[18:19], 0xfffffff
    v_mov_b32 v8, 0x40000000
    v_cndmask_b32 v4, v8, v4, s[18:19]
    v_add_u32 v12, 0, v42
    v_add_u32 v13, 0, v43
    v_add_u32 v14, 0, v44
    v_add_u32 v15, 0, v45
    s_waitcnt vmcnt(24) lgkmcnt(0)
    s_barrier
    s_add_u32 m0, s87, 131072
    s_add_u32 s37, s86, 524288
    buffer_load_dwordx4 v40, s[12:15], s37 offen offset:0 lds
    ds_read_b64_tr_b16 a[0:1], v12 offset:0
    ds_read_b64_tr_b16 a[2:3], v12 offset:2048
    ds_read_b64_tr_b16 a[4:5], v13 offset:0
    buffer_load_dwordx4 v41, s[12:15], s37 offen offset:1024 lds
    ds_read_b64_tr_b16 a[6:7], v13 offset:2048
    ds_read_b64_tr_b16 a[8:9], v14 offset:0
    ds_read_b64_tr_b16 a[10:11], v14 offset:2048
    s_add_u32 m0, s87, 139264
    s_add_u32 s37, s86, 524416
    buffer_load_dwordx4 v40, s[12:15], s37 offen offset:0 lds
    ds_read_b64_tr_b16 a[12:13], v15 offset:0
    ds_read_b64_tr_b16 a[14:15], v15 offset:2048
    ds_read_b64_tr_b16 a[16:17], v12 offset:4096
    buffer_load_dwordx4 v41, s[12:15], s37 offen offset:1024 lds
    ds_read_b64_tr_b16 a[18:19], v12 offset:6144
    ds_read_b64_tr_b16 a[20:21], v13 offset:4096
    ds_read_b64_tr_b16 a[22:23], v13 offset:6144
    s_add_u32 m0, s87, 147456
    s_add_u32 s37, s86, 524544
    buffer_load_dwordx4 v40, s[12:15], s37 offen offset:0 lds
    ds_read_b64_tr_b16 a[24:25], v14 offset:4096
    ds_read_b64_tr_b16 a[26:27], v14 offset:6144
    ds_read_b64_tr_b16 a[28:29], v15 offset:4096
    buffer_load_dwordx4 v41, s[12:15], s37 offen offset:1024 lds
    ds_read_b64_tr_b16 a[30:31], v15 offset:6144
    v_add_u32 v16, 32768, v42
    v_add_u32 v17, 32768, v43
    s_add_u32 m0, s87, 155648
    s_add_u32 s37, s86, 524672
    buffer_load_dwordx4 v40, s[12:15], s37 offen offset:0 lds
    v_add_u32 v18, 32768, v44
    v_add_u32 v19, 32768, v45
    buffer_load_dwordx4 v41, s[12:15], s37 offen offset:1024 lds
    s_waitcnt vmcnt(24) lgkmcnt(0)
    s_barrier
    s_add_u32 m0, s87, 0
    s_add_u32 s37, s86, 655360
    buffer_load_dwordx4 v40, s[12:15], s37 offen offset:0 lds
    ds_read_b64_tr_b16 a[32:33], v16 offset:0
    ds_read_b64_tr_b16 a[34:35], v16 offset:2048
    ds_read_b64_tr_b16 a[36:37], v17 offset:0
    buffer_load_dwordx4 v41, s[12:15], s37 offen offset:1024 lds
    ds_read_b64_tr_b16 a[38:39], v17 offset:2048
    ds_read_b64_tr_b16 a[40:41], v18 offset:0
    ds_read_b64_tr_b16 a[42:43], v18 offset:2048
    s_add_u32 m0, s87, 8192
    s_add_u32 s37, s86, 655488
    buffer_load_dwordx4 v40, s[12:15], s37 offen offset:0 lds
    ds_read_b64_tr_b16 a[44:45], v19 offset:0
    ds_read_b64_tr_b16 a[46:47], v19 offset:2048
    ds_read_b64_tr_b16 a[48:49], v16 offset:4096
    buffer_load_dwordx4 v41, s[12:15], s37 offen offset:1024 lds
    ds_read_b64_tr_b16 a[50:51], v16 offset:6144
    ds_read_b64_tr_b16 a[52:53], v17 offset:4096
    ds_read_b64_tr_b16 a[54:55], v17 offset:6144
    s_add_u32 m0, s87, 16384
    s_add_u32 s37, s86, 655616
    buffer_load_dwordx4 v40, s[12:15], s37 offen offset:0 lds
    ds_read_b64_tr_b16 a[56:57], v18 offset:4096
    ds_read_b64_tr_b16 a[58:59], v18 offset:6144
    ds_read_b64_tr_b16 a[60:61], v19 offset:4096
    buffer_load_dwordx4 v41, s[12:15], s37 offen offset:1024 lds
    ds_read_b64_tr_b16 a[62:63], v19 offset:6144
    v_add_u32 v12, 65536, v46
    v_add_u32 v13, 65536, v47
    s_add_u32 m0, s87, 24576
    s_add_u32 s37, s86, 655744
    buffer_load_dwordx4 v40, s[12:15], s37 offen offset:0 lds
    v_add_u32 v14, 65536, v48
    v_add_u32 v15, 65536, v49
    buffer_load_dwordx4 v41, s[12:15], s37 offen offset:1024 lds
    s_waitcnt vmcnt(24) lgkmcnt(0)
    s_barrier
    s_add_u32 m0, s87, 32768
    s_add_u32 s37, s86, 786432
    buffer_load_dwordx4 v40, s[12:15], s37 offen offset:0 lds
    ds_read_b64_tr_b16 a[64:65], v12 offset:0
    ds_read_b64_tr_b16 a[66:67], v12 offset:1024
    ds_read_b64_tr_b16 a[68:69], v13 offset:0
    buffer_load_dwordx4 v41, s[12:15], s37 offen offset:1024 lds
    ds_read_b64_tr_b16 a[70:71], v13 offset:1024
    ds_read_b64_tr_b16 a[72:73], v14 offset:0
    ds_read_b64_tr_b16 a[74:75], v14 offset:1024
    s_add_u32 m0, s87, 40960
    s_add_u32 s37, s86, 786560
    buffer_load_dwordx4 v40, s[12:15], s37 offen offset:0 lds
    ds_read_b64_tr_b16 a[76:77], v15 offset:0
    ds_read_b64_tr_b16 a[78:79], v15 offset:1024
    ds_read_b64_tr_b16 a[80:81], v12 offset:4096
    buffer_load_dwordx4 v41, s[12:15], s37 offen offset:1024 lds
    ds_read_b64_tr_b16 a[82:83], v12 offset:5120
    ds_read_b64_tr_b16 a[84:85], v13 offset:4096
    ds_read_b64_tr_b16 a[86:87], v13 offset:5120
    s_add_u32 m0, s87, 49152
    s_add_u32 s37, s86, 786688
    buffer_load_dwordx4 v40, s[12:15], s37 offen offset:0 lds
    ds_read_b64_tr_b16 a[88:89], v14 offset:4096
    ds_read_b64_tr_b16 a[90:91], v14 offset:5120
    ds_read_b64_tr_b16 a[92:93], v15 offset:4096
    buffer_load_dwordx4 v41, s[12:15], s37 offen offset:1024 lds
    ds_read_b64_tr_b16 a[94:95], v15 offset:5120
    v_add_u32 v16, 98304, v42
    v_add_u32 v17, 98304, v43
    s_add_u32 m0, s87, 57344
    s_add_u32 s37, s86, 786816
    buffer_load_dwordx4 v40, s[12:15], s37 offen offset:0 lds
    v_add_u32 v18, 98304, v44
    v_add_u32 v19, 98304, v45
    buffer_load_dwordx4 v41, s[12:15], s37 offen offset:1024 lds
    s_waitcnt vmcnt(24) lgkmcnt(0)
    s_barrier
    s_add_u32 m0, s87, 65536
    s_add_u32 s37, s86, 917504
    buffer_load_dwordx4 v40, s[12:15], s37 offen offset:0 lds
    ds_read_b64_tr_b16 a[96:97], v16 offset:0
    ds_read_b64_tr_b16 a[98:99], v16 offset:2048
    ds_read_b64_tr_b16 a[100:101], v17 offset:0
    buffer_load_dwordx4 v41, s[12:15], s37 offen offset:1024 lds
    ds_read_b64_tr_b16 a[102:103], v17 offset:2048
    ds_read_b64_tr_b16 a[104:105], v18 offset:0
    ds_read_b64_tr_b16 a[106:107], v18 offset:2048
    s_add_u32 m0, s87, 73728
    s_add_u32 s37, s86, 917632
    buffer_load_dwordx4 v40, s[12:15], s37 offen offset:0 lds
    ds_read_b64_tr_b16 a[108:109], v19 offset:0
    ds_read_b64_tr_b16 a[110:111], v19 offset:2048
    ds_read_b64_tr_b16 a[112:113], v16 offset:4096
    buffer_load_dwordx4 v41, s[12:15], s37 offen offset:1024 lds
    ds_read_b64_tr_b16 a[114:115], v16 offset:6144
    ds_read_b64_tr_b16 a[116:117], v17 offset:4096
    ds_read_b64_tr_b16 a[118:119], v17 offset:6144
    s_add_u32 m0, s87, 81920
    s_add_u32 s37, s86, 917760
    buffer_load_dwordx4 v40, s[12:15], s37 offen offset:0 lds
    ds_read_b64_tr_b16 a[120:121], v18 offset:4096
    ds_read_b64_tr_b16 a[122:123], v18 offset:6144
    ds_read_b64_tr_b16 a[124:125], v19 offset:4096
    buffer_load_dwordx4 v41, s[12:15], s37 offen offset:1024 lds
    ds_read_b64_tr_b16 a[126:127], v19 offset:6144
    v_add_u32 v12, 131072, v42
    v_add_u32 v13, 131072, v43
    s_add_u32 m0, s87, 90112
    s_add_u32 s37, s86, 917888
    buffer_load_dwordx4 v40, s[12:15], s37 offen offset:0 lds
    v_add_u32 v14, 131072, v44
    v_add_u32 v15, 131072, v45
    buffer_load_dwordx4 v41, s[12:15], s37 offen offset:1024 lds
    s_waitcnt vmcnt(24) lgkmcnt(0)
    s_barrier
    ds_read_b64_tr_b16 a[128:129], v12 offset:0
    ds_read_b64_tr_b16 a[130:131], v12 offset:2048
    ds_read_b64_tr_b16 a[132:133], v13 offset:0
    ds_read_b64_tr_b16 a[134:135], v13 offset:2048
    ds_read_b64_tr_b16 a[136:137], v14 offset:0
    ds_read_b64_tr_b16 a[138:139], v14 offset:2048
    ds_read_b64_tr_b16 a[140:141], v15 offset:0
    ds_read_b64_tr_b16 a[142:143], v15 offset:2048
    ds_read_b64_tr_b16 a[144:145], v12 offset:4096
    ds_read_b64_tr_b16 a[146:147], v12 offset:6144
    ds_read_b64_tr_b16 a[148:149], v13 offset:4096
    ds_read_b64_tr_b16 a[150:151], v13 offset:6144
    ds_read_b64_tr_b16 a[152:153], v14 offset:4096
    ds_read_b64_tr_b16 a[154:155], v14 offset:6144
    ds_read_b64_tr_b16 a[156:157], v15 offset:4096
    ds_read_b64_tr_b16 a[158:159], v15 offset:6144
    v_add_u32 v16, 0, v46
    v_add_u32 v17, 0, v47
    v_add_u32 v18, 0, v48
    v_add_u32 v19, 0, v49
    s_waitcnt vmcnt(16) lgkmcnt(0)
    s_barrier
    ds_read_b64_tr_b16 a[160:161], v16 offset:0
    ds_read_b64_tr_b16 a[162:163], v16 offset:1024
    ds_read_b64_tr_b16 a[164:165], v17 offset:0
    ds_read_b64_tr_b16 a[166:167], v17 offset:1024
    ds_read_b64_tr_b16 a[168:169], v18 offset:0
    ds_read_b64_tr_b16 a[170:171], v18 offset:1024
    ds_read_b64_tr_b16 a[172:173], v19 offset:0
    ds_read_b64_tr_b16 a[174:175], v19 offset:1024
    ds_read_b64_tr_b16 a[176:177], v16 offset:4096
    ds_read_b64_tr_b16 a[178:179], v16 offset:5120
    ds_read_b64_tr_b16 a[180:181], v17 offset:4096
    ds_read_b64_tr_b16 a[182:183], v17 offset:5120
    ds_read_b64_tr_b16 a[184:185], v18 offset:4096
    ds_read_b64_tr_b16 a[186:187], v18 offset:5120
    ds_read_b64_tr_b16 a[188:189], v19 offset:4096
    ds_read_b64_tr_b16 a[190:191], v19 offset:5120
    v_add_u32 v12, 32768, v42
    v_add_u32 v13, 32768, v43
    v_add_u32 v14, 32768, v44
    v_add_u32 v15, 32768, v45
    s_waitcnt vmcnt(8) lgkmcnt(0)
    s_barrier
    ds_read_b64_tr_b16 a[192:193], v12 offset:0
    ds_read_b64_tr_b16 a[194:195], v12 offset:2048
    ds_read_b64_tr_b16 a[196:197], v13 offset:0
    ds_read_b64_tr_b16 a[198:199], v13 offset:2048
    ds_read_b64_tr_b16 a[200:201], v14 offset:0
    ds_read_b64_tr_b16 a[202:203], v14 offset:2048
    ds_read_b64_tr_b16 a[204:205], v15 offset:0
    ds_read_b64_tr_b16 a[206:207], v15 offset:2048
    ds_read_b64_tr_b16 a[208:209], v12 offset:4096
    ds_read_b64_tr_b16 a[210:211], v12 offset:6144
    ds_read_b64_tr_b16 a[212:213], v13 offset:4096
    ds_read_b64_tr_b16 a[214:215], v13 offset:6144
    ds_read_b64_tr_b16 a[216:217], v14 offset:4096
    ds_read_b64_tr_b16 a[218:219], v14 offset:6144
    ds_read_b64_tr_b16 a[220:221], v15 offset:4096
    ds_read_b64_tr_b16 a[222:223], v15 offset:6144
    v_add_u32 v16, 65536, v42
    v_add_u32 v17, 65536, v43
    v_add_u32 v18, 65536, v44
    v_add_u32 v19, 65536, v45
    s_waitcnt vmcnt(0) lgkmcnt(0)
    s_barrier
    ds_read_b64_tr_b16 a[224:225], v16 offset:0
    ds_read_b64_tr_b16 a[226:227], v16 offset:2048
    ds_read_b64_tr_b16 a[228:229], v17 offset:0
    ds_read_b64_tr_b16 a[230:231], v17 offset:2048
    ds_read_b64_tr_b16 a[232:233], v18 offset:0
    ds_read_b64_tr_b16 a[234:235], v18 offset:2048
    ds_read_b64_tr_b16 a[236:237], v19 offset:0
    ds_read_b64_tr_b16 a[238:239], v19 offset:2048
    ds_read_b64_tr_b16 a[240:241], v16 offset:4096
    ds_read_b64_tr_b16 a[242:243], v16 offset:6144
    ds_read_b64_tr_b16 a[244:245], v17 offset:4096
    ds_read_b64_tr_b16 a[246:247], v17 offset:6144
    ds_read_b64_tr_b16 a[248:249], v18 offset:4096
    ds_read_b64_tr_b16 a[250:251], v18 offset:6144
    ds_read_b64_tr_b16 a[252:253], v19 offset:4096
    ds_read_b64_tr_b16 a[254:255], v19 offset:6144
    s_waitcnt lgkmcnt(0)
    s_mov_b32 s12, s84
    s_mov_b32 s13, s85
    s_mov_b32 s14, 0x6200000
    s_mov_b32 s15, 0x00020000
    s_barrier
    s_mov_b32 s20, s82
    s_mov_b32 s21, s83
    s_mov_b32 s22, 0x100
    s_mov_b32 s23, 0x00020000
    v_and_b32 v8, 15, v0
    v_lshlrev_b32 v8, 4, v8
    buffer_load_dword v9, v8, s[20:23], 0 offen sc1
    s_waitcnt vmcnt(0)
Lred_wa:
    v_cmp_gt_u32 vcc, 8, v9
    s_sub_u32 s43, s43, 1
    s_cmp_lt_i32 s43, 0
    s_cbranch_scc1 Lred_all
    s_cbranch_vccz Lred_all
    s_sleep 2
    buffer_load_dword v9, v8, s[20:23], 0 offen sc1
    s_waitcnt vmcnt(0)
    s_branch Lred_wa
Lred_all:
    s_mov_b32 s18, 0xfff0000
    s_mov_b32 s14, 0
    s_mov_b32 s20, s84
    s_mov_b32 s21, s85
    s_mov_b32 s22, 0x0
    s_mov_b32 s23, 0x00020000
Lred_spin0:
    buffer_load_dword v5, v4, s[4:7], s16 offen sc1
    s_waitcnt vmcnt(0)
    v_cmp_gt_i32 vcc, s32, v5
    s_sub_u32 s43, s43, 1
    s_cmp_lt_i32 s43, 0
    s_cbranch_scc1 Lred_rdy0
    s_and_b64 vcc, vcc, s[18:19]
    s_cbranch_scc0 Lred_rdy0
    s_sleep 8
    s_branch Lred_spin0
Lred_rdy0:
    s_mov_b32 s10, s6
    s_add_u32 m0, s34, 0
    s_nop 0
    buffer_load_dwordx4 v1, s[8:11], s33 offen offset:0 sc1 lds
    buffer_load_dwordx4 v1, s[8:11], s33 offen offset:1024 sc1 lds
    buffer_load_dwordx4 v1, s[8:11], s33 offen offset:2048 sc1 lds
    buffer_load_dwordx4 v1, s[8:11], s33 offen offset:3072 sc1 lds
    s_add_u32 s33, s33, 116736
    s_add_u32 s34, s34, 36864
    s_cmp_ge_u32 s34, 147456
    s_cselect_b32 s38, 147456, 0
    s_sub_u32 s34, s34, s38
    buffer_load_dwordx4 v[180:183], v1, s[4:7], s41 offen offset:0 sc1
    buffer_load_dwordx4 v[184:187], v1, s[4:7], s41 offen offset:1024 sc1
    s_add_u32 s41, s41, 36864
    s_add_u32 s16, s16, 8192
Lred_spin1:
    buffer_load_dword v5, v4, s[4:7], s16 offen sc1
    s_waitcnt vmcnt(0)
    v_cmp_gt_i32 vcc, s32, v5
    s_sub_u32 s43, s43, 1
    s_cmp_lt_i32 s43, 0
    s_cbranch_scc1 Lred_rdy1
    s_and_b64 vcc, vcc, s[18:19]
    s_cbranch_scc0 Lred_rdy1
    s_sleep 8
    s_branch Lred_spin1
Lred_rdy1:
    s_mov_b32 s10, s6
    s_add_u32 m0, s34, 0
    s_nop 0
    buffer_load_dwordx4 v1, s[8:11], s33 offen offset:0 sc1 lds
    buffer_load_dwordx4 v1, s[8:11], s33 offen offset:1024 sc1 lds
    buffer_load_dwordx4 v1, s[8:11], s33 offen offset:2048 sc1 lds
    buffer_load_dwordx4 v1, s[8:11], s33 offen offset:3072 sc1 lds
    s_add_u32 s33, s33, 116736
    s_add_u32 s34, s34, 36864
    s_cmp_ge_u32 s34, 147456
    s_cselect_b32 s38, 147456, 0
    s_sub_u32 s34, s34, s38
    s_add_u32 s16, s16, 8192
    s_mov_b32 s18, 0xfffffff
    s_mov_b32 s31, -2
    v_mov_b32 v5, 0
    s_waitcnt vmcnt(0)
    s_branch Lred_top1
    .p2align 6
Lred_run0:
    s_waitcnt vmcnt(17)
    v_mfma_f32_16x16x32_bf16 v[20:23], v[94:97], v[120:123], v[20:23]
    s_barrier
    v_mfma_f32_16x16x32_bf16 v[16:19], v[96:99], v[120:123], v[16:19]
    s_waitcnt vmcnt(9)
    v_add_u32 v3, s35, v1
    v_cmp_gt_i32 vcc, s32, v5
    v_mfma_f32_16x16x32_bf16 v[12:15], v[94:97], v[116:119], v[12:15]
    v_mfma_f32_16x16x32_bf16 v[8:11], v[96:99], v[116:119], v[8:11]
    s_and_b64 vcc, vcc, s[18:19]
    s_cbranch_scc1 Lred_v01
    v_mfma_f32_16x16x32_bf16 v[8:11], v[96:99], v[124:127], v[8:11]
    s_add_u32 s16, s16, 8192
    v_mfma_f32_16x16x32_bf16 v[12:15], v[94:97], v[124:127], v[12:15]
    buffer_load_dwordx4 v[148:151], v1, s[4:7], s40 offen offset:0 sc1
    v_mfma_f32_16x16x32_bf16 v[16:19], v[96:99], v[128:131], v[16:19]
    ds_read_b128 v[40:43], v3 offset:0
    s_add_u32 s31, s31, 1
    v_mfma_f32_16x16x32_bf16 v[20:23], v[94:97], v[128:131], v[20:23]
    v_mov_b32 v6, s31
    v_mfma_f32_16x16x32_bf16 v[20:23], v[94:97], v[136:139], v[20:23]
    ds_read_b128 v[44:47], v3 offset:1024
    s_waitcnt vmcnt(7)
    v_mfma_f32_16x16x32_bf16 v[16:19], v[96:99], v[136:139], v[16:19]
    buffer_load_dwordx4 v[152:155], v1, s[4:7], s40 offen offset:1024 sc1
    v_mfma_f32_16x16x32_bf16 v[12:15], v[94:97], v[132:135], v[12:15]
    ds_read_b128 v[48:51], v3 offset:2048
    s_add_u32 s37, s40, 32768
    v_mfma_f32_16x16x32_bf16 v[8:11], v[96:99], v[132:135], v[8:11]
    buffer_store_dword v6, v80, s[20:23], s17 offen sc1
    s_add_u32 s17, s17, 8192
    v_mfma_f32_16x16x32_bf16 v[8:11], v[96:99], v[140:143], v[8:11]
    ds_read_b128 v[52:55], v3 offset:3072
    v_mfma_f32_16x16x32_bf16 v[12:15], v[94:97], v[140:143], v[12:15]
    buffer_load_dwordx4 v[156:159], v1, s[4:7], s37 offen offset:0 sc1
    v_mfma_f32_16x16x32_bf16 v[16:19], v[96:99], v[144:147], v[16:19]
    v_mfma_f32_16x16x32_bf16 v[20:23], v[94:97], v[144:147], v[20:23]
    s_waitcnt lgkmcnt(2)
    v_mfma_f32_16x16x32_bf16 v[24:27], a[0:3], v[40:43], v[100:103]
    ds_read_b128 v[56:59], v3 offset:4096
    v_cvt_pk_bf16_f32 v72, v8, v9
    v_mfma_f32_16x16x32_bf16 v[24:27], a[16:19], v[44:47], v[24:27]
    buffer_load_dwordx4 v[160:163], v1, s[4:7], s37 offen offset:1024 sc1
    v_mfma_f32_16x16x32_bf16 v[28:31], a[20:23], v[44:47], v[104:107]
    s_add_u32 s37, s40, 65536
    v_cvt_pk_bf16_f32 v73, v10, v11
    v_mfma_f32_16x16x32_bf16 v[28:31], a[4:7], v[40:43], v[28:31]
    ds_write_b64 v204, v[72:73]
    v_mfma_f32_16x16x32_bf16 v[32:35], a[8:11], v[40:43], v[108:111]
    ds_read_b128 v[60:63], v3 offset:5120
    v_cvt_pk_bf16_f32 v74, v12, v13
    v_mfma_f32_16x16x32_bf16 v[32:35], a[24:27], v[44:47], v[32:35]
    buffer_load_dwordx4 v[164:167], v1, s[4:7], s37 offen offset:0 sc1
    v_mfma_f32_16x16x32_bf16 v[36:39], a[28:31], v[44:47], v[112:115]
    v_cvt_pk_bf16_f32 v75, v14, v15
    v_mfma_f32_16x16x32_bf16 v[36:39], a[12:15], v[40:43], v[36:39]
    s_waitcnt lgkmcnt(3)
    ds_write_b64 v205, v[74:75]
    v_mfma_f32_16x16x32_bf16 v[36:39], a[44:47], v[48:51], v[36:39]
    ds_read_b128 v[64:67], v3 offset:6144
    v_cvt_pk_bf16_f32 v76, v16, v17
    v_mfma_f32_16x16x32_bf16 v[36:39], a[60:63], v[52:55], v[36:39]
    buffer_load_dwordx4 v[168:171], v1, s[4:7], s37 offen offset:1024 sc1
    v_mfma_f32_16x16x32_bf16 v[32:35], a[56:59], v[52:55], v[32:35]
    s_add_u32 s37, s40, 98304
    v_cvt_pk_bf16_f32 v77, v18, v19
    v_mfma_f32_16x16x32_bf16 v[32:35], a[40:43], v[48:51], v[32:35]
    ds_write_b64 v206, v[76:77]
    v_mfma_f32_16x16x32_bf16 v[28:31], a[36:39], v[48:51], v[28:31]
    ds_read_b128 v[68:71], v3 offset:7168
    v_cvt_pk_bf16_f32 v78, v20, v21
    v_mfma_f32_16x16x32_bf16 v[28:31], a[52:55], v[52:55], v[28:31]
    buffer_load_dwordx4 v[172:175], v1, s[4:7], s37 offen offset:0 sc1
    v_mfma_f32_16x16x32_bf16 v[24:27], a[48:51], v[52:55], v[24:27]
    v_cvt_pk_bf16_f32 v79, v22, v23
    v_mfma_f32_16x16x32_bf16 v[24:27], a[32:35], v[48:51], v[24:27]
    s_waitcnt lgkmcnt(4)
    ds_write_b64 v207, v[78:79]
    v_mfma_f32_16x16x32_bf16 v[24:27], a[64:67], v[56:59], v[24:27]
    ds_read_b128 v[40:43], v3 offset:8192
    v_mfma_f32_16x16x32_bf16 v[24:27], a[80:83], v[60:63], v[24:27]
    buffer_load_dwordx4 v[176:179], v1, s[4:7], s37 offen offset:1024 sc1
    v_mfma_f32_16x16x32_bf16 v[28:31], a[84:87], v[60:63], v[28:31]
    s_add_u32 m0, s34, 0
    ds_read_b128 v[196:199], v222 offset:0
    v_mfma_f32_16x16x32_bf16 v[28:31], a[68:71], v[56:59], v[28:31]
    ds_read_b128 v[200:203], v222 offset:1024
    v_mfma_f32_16x16x32_bf16 v[86:89], v[72:75], v[72:75], 0
    v_mfma_f32_16x16x32_bf16 v[82:85], v[90:93], v[72:75], 0
    buffer_load_dword v5, v4, s[4:7], s16 offen sc1
    v_mfma_f32_16x16x32_bf16 v[86:89], v[76:79], v[76:79], v[86:89]
    v_mfma_f32_16x16x32_bf16 v[82:85], v[90:93], v[76:79], v[82:85]
    s_waitcnt lgkmcnt(1)
    v_mfma_f32_16x16x32_bf16 v[32:35], a[72:75], v[56:59], v[32:35]
    ds_read_b128 v[44:47], v3 offset:9216
    v_mfma_f32_16x16x32_bf16 v[32:35], a[88:91], v[60:63], v[32:35]
    buffer_store_dwordx4 v[196:199], v208, s[24:27], s54 offen sc1
    s_waitcnt lgkmcnt(1)
    v_mfma_f32_16x16x32_bf16 v[36:39], a[92:95], v[60:63], v[36:39]
    v_mfma_f32_16x16x32_bf16 v[36:39], a[76:79], v[56:59], v[36:39]
    v_mfma_f32_16x16x32_bf16 v[36:39], a[108:111], v[64:67], v[36:39]
    ds_read_b128 v[48:51], v3 offset:10240
    v_mfma_f32_16x16x32_bf16 v[36:39], a[124:127], v[68:71], v[36:39]
    buffer_store_dwordx4 v[200:203], v209, s[24:27], s54 offen sc1
    v_cndmask_b32 v86, v86, v87, s[44:45]
    v_mfma_f32_16x16x32_bf16 v[32:35], a[120:123], v[68:71], v[32:35]
    v_cndmask_b32 v88, v88, v89, s[44:45]
    v_cndmask_b32 v83, v86, v88, s[46:47]
    v_mfma_f32_16x16x32_bf16 v[32:35], a[104:107], v[64:67], v[32:35]
    buffer_store_dwordx2 v[82:83], v7, s[12:15], s36 offen offset:0 sc1
    s_mov_b32 s22, s14
    v_mfma_f32_16x16x32_bf16 v[28:31], a[100:103], v[64:67], v[28:31]
    ds_read_b128 v[52:55], v3 offset:11264
    s_add_u32 s36, s36, 34816
    v_mfma_f32_16x16x32_bf16 v[28:31], a[116:119], v[68:71], v[28:31]
    buffer_load_dwordx4 v1, s[8:11], s33 offen offset:0 sc1 lds
    v_mfma_f32_16x16x32_bf16 v[24:27], a[112:115], v[68:71], v[24:27]
    s_sub_u32 s42, s42, 32768
    v_mfma_f32_16x16x32_bf16 v[24:27], a[96:99], v[64:67], v[24:27]
    s_waitcnt lgkmcnt(2)
    v_mfma_f32_16x16x32_bf16 v[24:27], a[128:131], v[40:43], v[24:27]
    ds_read_b128 v[56:59], v3 offset:12288
    v_mfma_f32_16x16x32_bf16 v[24:27], a[144:147], v[44:47], v[24:27]
    buffer_load_dwordx4 v1, s[8:11], s33 offen offset:1024 sc1 lds
    v_mfma_f32_16x16x32_bf16 v[28:31], a[148:151], v[44:47], v[28:31]
    s_cmp_lt_i32 s31, 31
    s_cselect_b32 s14, s6, 0
    s_cselect_b32 s54, s36, s42
    v_mfma_f32_16x16x32_bf16 v[28:31], a[132:135], v[40:43], v[28:31]
    s_cmp_lt_i32 s31, 31
    s_cselect_b64 s[24:25], s[4:5], s[80:81]
    s_cselect_b32 s26, s6, 0x400000
    v_mfma_f32_16x16x32_bf16 v[32:35], a[136:139], v[40:43], v[32:35]
    ds_read_b128 v[60:63], v3 offset:13312
    v_mfma_f32_16x16x32_bf16 v[32:35], a[152:155], v[44:47], v[32:35]
    buffer_load_dwordx4 v1, s[8:11], s33 offen offset:2048 sc1 lds
    v_mfma_f32_16x16x32_bf16 v[36:39], a[156:159], v[44:47], v[36:39]
    s_cmp_lt_i32 s31, 31
    s_cselect_b64 s[48:49], 0, -1
    v_cndmask_b32 v204, v210, v216, s[48:49]
    v_mfma_f32_16x16x32_bf16 v[36:39], a[140:143], v[40:43], v[36:39]
    s_waitcnt lgkmcnt(2)
    v_cndmask_b32 v205, v211, v217, s[48:49]
    v_cndmask_b32 v206, v212, v218, s[48:49]
    v_mfma_f32_16x16x32_bf16 v[36:39], a[172:175], v[48:51], v[36:39]
    ds_read_b128 v[64:67], v3 offset:14336
    v_cndmask_b32 v207, v213, v219, s[48:49]
    v_mfma_f32_16x16x32_bf16 v[36:39], a[188:191], v[52:55], v[36:39]
    buffer_load_dwordx4 v1, s[8:11], s33 offen offset:3072 sc1 lds
    v_mfma_f32_16x16x32_bf16 v[32:35], a[184:187], v[52:55], v[32:35]
    s_add_u32 s32, s32, 1
    s_add_u32 s40, s40, 131072
    s_add_u32 s33, s33, 116736
    v_mfma_f32_16x16x32_bf16 v[32:35], a[168:171], v[48:51], v[32:35]
    s_add_u32 s34, s34, 36864
    s_cmp_ge_u32 s34, 147456
    s_cselect_b32 s38, 147456, 0
    v_mfma_f32_16x16x32_bf16 v[28:31], a[164:167], v[48:51], v[28:31]
    ds_read_b128 v[68:71], v3 offset:15360
    s_sub_u32 s34, s34, s38
    v_mfma_f32_16x16x32_bf16 v[28:31], a[180:183], v[52:55], v[28:31]
    s_cmp_ge_i32 s32, 63
    s_cselect_b32 s18, 0xffff, s18
    v_cndmask_b32 v208, v214, v220, s[48:49]
    v_mfma_f32_16x16x32_bf16 v[24:27], a[176:179], v[52:55], v[24:27]
    buffer_load_dwordx4 v[180:183], v1, s[4:7], s41 offen offset:0 sc1
    v_mfma_f32_16x16x32_bf16 v[24:27], a[160:163], v[48:51], v[24:27]
    s_waitcnt lgkmcnt(2)
    v_cndmask_b32 v209, v215, v221, s[48:49]
    s_add_u32 s35, s35, 36864
    v_mfma_f32_16x16x32_bf16 v[24:27], a[192:195], v[56:59], v[24:27]
    s_cmp_eq_u32 s35, 147456
    s_cselect_b32 s35, 0, s35
    v_mfma_f32_16x16x32_bf16 v[24:27], a[208:211], v[60:63], v[24:27]
    v_mfma_f32_16x16x32_bf16 v[28:31], a[212:215], v[60:63], v[28:31]
    buffer_load_dwordx4 v[184:187], v1, s[4:7], s41 offen offset:1024 sc1
    v_mfma_f32_16x16x32_bf16 v[28:31], a[196:199], v[56:59], v[28:31]
    s_add_u32 s41, s41, 36864
    v_mfma_f32_16x16x32_bf16 v[32:35], a[200:203], v[56:59], v[32:35]
    v_mfma_f32_16x16x32_bf16 v[32:35], a[216:219], v[60:63], v[32:35]
    v_mfma_f32_16x16x32_bf16 v[36:39], a[220:223], v[60:63], v[36:39]
    v_mfma_f32_16x16x32_bf16 v[36:39], a[204:207], v[56:59], v[36:39]
    s_waitcnt lgkmcnt(0)
    v_mfma_f32_16x16x32_bf16 v[36:39], a[236:239], v[64:67], v[36:39]
    v_mfma_f32_16x16x32_bf16 v[36:39], a[252:255], v[68:71], v[36:39]
    v_mfma_f32_16x16x32_bf16 v[32:35], a[248:251], v[68:71], v[32:35]
    v_mfma_f32_16x16x32_bf16 v[32:35], a[232:235], v[64:67], v[32:35]
    v_mfma_f32_16x16x32_bf16 v[28:31], a[228:231], v[64:67], v[28:31]
    v_mfma_f32_16x16x32_bf16 v[28:31], a[244:247], v[68:71], v[28:31]
    v_mfma_f32_16x16x32_bf16 v[24:27], a[240:243], v[68:71], v[24:27]
    v_mfma_f32_16x16x32_bf16 v[24:27], a[224:227], v[64:67], v[24:27]
    s_waitcnt vmcnt(19)
    v_mfma_f32_16x16x32_bf16 v[24:27], v[96:99], v[188:191], v[24:27]
    v_mfma_f32_16x16x32_bf16 v[28:31], v[94:97], v[188:191], v[28:31]
    v_mfma_f32_16x16x32_bf16 v[32:35], v[96:99], v[192:195], v[32:35]
    v_mfma_f32_16x16x32_bf16 v[36:39], v[94:97], v[192:195], v[36:39]
    s_cmp_lt_i32 s31, 63
    s_cbranch_scc1 Lred_run1
    s_branch L_exit
Lred_run1:
    s_waitcnt vmcnt(17)
    v_mfma_f32_16x16x32_bf16 v[36:39], v[94:97], v[152:155], v[36:39]
    s_barrier
    v_mfma_f32_16x16x32_bf16 v[32:35], v[96:99], v[152:155], v[32:35]
    s_waitcnt vmcnt(9)
    v_add_u32 v2, s35, v1
    v_cmp_gt_i32 vcc, s32, v5
    v_mfma_f32_16x16x32_bf16 v[28:31], v[94:97], v[148:151], v[28:31]
    v_mfma_f32_16x16x32_bf16 v[24:27], v[96:99], v[148:151], v[24:27]
    s_and_b64 vcc, vcc, s[18:19]
    s_cbranch_scc1 Lred_v11
    v_mfma_f32_16x16x32_bf16 v[24:27], v[96:99], v[156:159], v[24:27]
    s_add_u32 s16, s16, 8192
    v_mfma_f32_16x16x32_bf16 v[28:31], v[94:97], v[156:159], v[28:31]
    buffer_load_dwordx4 v[116:119], v1, s[4:7], s40 offen offset:0 sc1
    v_mfma_f32_16x16x32_bf16 v[32:35], v[96:99], v[160:163], v[32:35]
    ds_read_b128 v[40:43], v2 offset:0
    s_add_u32 s31, s31, 1
    v_mfma_f32_16x16x32_bf16 v[36:39], v[94:97], v[160:163], v[36:39]
    v_mov_b32 v6, s31
    v_mfma_f32_16x16x32_bf16 v[36:39], v[94:97], v[168:171], v[36:39]
    ds_read_b128 v[44:47], v2 offset:1024
    s_waitcnt vmcnt(7)
    v_mfma_f32_16x16x32_bf16 v[32:35], v[96:99], v[168:171], v[32:35]
    buffer_load_dwordx4 v[120:123], v1, s[4:7], s40 offen offset:1024 sc1
    v_mfma_f32_16x16x32_bf16 v[28:31], v[94:97], v[164:167], v[28:31]
    ds_read_b128 v[48:51], v2 offset:2048
    s_add_u32 s37, s40, 32768
    v_mfma_f32_16x16x32_bf16 v[24:27], v[96:99], v[164:167], v[24:27]
    buffer_store_dword v6, v80, s[20:23], s17 offen sc1
    s_add_u32 s17, s17, 8192
    v_mfma_f32_16x16x32_bf16 v[24:27], v[96:99], v[172:175], v[24:27]
    ds_read_b128 v[52:55], v2 offset:3072
    v_mfma_f32_16x16x32_bf16 v[28:31], v[94:97], v[172:175], v[28:31]
    buffer_load_dwordx4 v[124:127], v1, s[4:7], s37 offen offset:0 sc1
    v_mfma_f32_16x16x32_bf16 v[32:35], v[96:99], v[176:179], v[32:35]
    v_mfma_f32_16x16x32_bf16 v[36:39], v[94:97], v[176:179], v[36:39]
    s_waitcnt lgkmcnt(2)
    v_mfma_f32_16x16x32_bf16 v[8:11], a[0:3], v[40:43], v[100:103]
    ds_read_b128 v[56:59], v2 offset:4096
    v_cvt_pk_bf16_f32 v72, v24, v25
    v_mfma_f32_16x16x32_bf16 v[8:11], a[16:19], v[44:47], v[8:11]
    buffer_load_dwordx4 v[128:131], v1, s[4:7], s37 offen offset:1024 sc1
    v_mfma_f32_16x16x32_bf16 v[12:15], a[20:23], v[44:47], v[104:107]
    s_add_u32 s37, s40, 65536
    v_cvt_pk_bf16_f32 v73, v26, v27
    v_mfma_f32_16x16x32_bf16 v[12:15], a[4:7], v[40:43], v[12:15]
    ds_write_b64 v204, v[72:73]
    v_mfma_f32_16x16x32_bf16 v[16:19], a[8:11], v[40:43], v[108:111]
    ds_read_b128 v[60:63], v2 offset:5120
    v_cvt_pk_bf16_f32 v74, v28, v29
    v_mfma_f32_16x16x32_bf16 v[16:19], a[24:27], v[44:47], v[16:19]
    buffer_load_dwordx4 v[132:135], v1, s[4:7], s37 offen offset:0 sc1
    v_mfma_f32_16x16x32_bf16 v[20:23], a[28:31], v[44:47], v[112:115]
    v_cvt_pk_bf16_f32 v75, v30, v31
    v_mfma_f32_16x16x32_bf16 v[20:23], a[12:15], v[40:43], v[20:23]
    s_waitcnt lgkmcnt(3)
    ds_write_b64 v205, v[74:75]
    v_mfma_f32_16x16x32_bf16 v[20:23], a[44:47], v[48:51], v[20:23]
    ds_read_b128 v[64:67], v2 offset:6144
    v_cvt_pk_bf16_f32 v76, v32, v33
    v_mfma_f32_16x16x32_bf16 v[20:23], a[60:63], v[52:55], v[20:23]
    buffer_load_dwordx4 v[136:139], v1, s[4:7], s37 offen offset:1024 sc1
    v_mfma_f32_16x16x32_bf16 v[16:19], a[56:59], v[52:55], v[16:19]
    s_add_u32 s37, s40, 98304
    v_cvt_pk_bf16_f32 v77, v34, v35
    v_mfma_f32_16x16x32_bf16 v[16:19], a[40:43], v[48:51], v[16:19]
    ds_write_b64 v206, v[76:77]
    v_mfma_f32_16x16x32_bf16 v[12:15], a[36:39], v[48:51], v[12:15]
    ds_read_b128 v[68:71], v2 offset:7168
    v_cvt_pk_bf16_f32 v78, v36, v37
    v_mfma_f32_16x16x32_bf16 v[12:15], a[52:55], v[52:55], v[12:15]
    buffer_load_dwordx4 v[140:143], v1, s[4:7], s37 offen offset:0 sc1
    v_mfma_f32_16x16x32_bf16 v[8:11], a[48:51], v[52:55], v[8:11]
    v_cvt_pk_bf16_f32 v79, v38, v39
    v_mfma_f32_16x16x32_bf16 v[8:11], a[32:35], v[48:51], v[8:11]
    s_waitcnt lgkmcnt(4)
    ds_write_b64 v207, v[78:79]
    v_mfma_f32_16x16x32_bf16 v[8:11], a[64:67], v[56:59], v[8:11]
    ds_read_b128 v[40:43], v2 offset:8192
    v_mfma_f32_16x16x32_bf16 v[8:11], a[80:83], v[60:63], v[8:11]
    buffer_load_dwordx4 v[144:147], v1, s[4:7], s37 offen offset:1024 sc1
    v_mfma_f32_16x16x32_bf16 v[12:15], a[84:87], v[60:63], v[12:15]
    s_add_u32 m0, s34, 0
    ds_read_b128 v[196:199], v222 offset:0
    v_mfma_f32_16x16x32_bf16 v[12:15], a[68:71], v[56:59], v[12:15]
    ds_read_b128 v[200:203], v222 offset:1024
    v_mfma_f32_16x16x32_bf16 v[86:89], v[72:75], v[72:75], 0
    v_mfma_f32_16x16x32_bf16 v[82:85], v[90:93], v[72:75], 0
    buffer_load_dword v5, v4, s[4:7], s16 offen sc1
    v_mfma_f32_16x16x32_bf16 v[86:89], v[76:79], v[76:79], v[86:89]
    v_mfma_f32_16x16x32_bf16 v[82:85], v[90:93], v[76:79], v[82:85]
    s_waitcnt lgkmcnt(1)
    v_mfma_f32_16x16x32_bf16 v[16:19], a[72:75], v[56:59], v[16:19]
    ds_read_b128 v[44:47], v2 offset:9216
    v_mfma_f32_16x16x32_bf16 v[16:19], a[88:91], v[60:63], v[16:19]
    buffer_store_dwordx4 v[196:199], v208, s[24:27], s54 offen sc1
    s_waitcnt lgkmcnt(1)
    v_mfma_f32_16x16x32_bf16 v[20:23], a[92:95], v[60:63], v[20:23]
    v_mfma_f32_16x16x32_bf16 v[20:23], a[76:79], v[56:59], v[20:23]
    v_mfma_f32_16x16x32_bf16 v[20:23], a[108:111], v[64:67], v[20:23]
    ds_read_b128 v[48:51], v2 offset:10240
    v_mfma_f32_16x16x32_bf16 v[20:23], a[124:127], v[68:71], v[20:23]
    buffer_store_dwordx4 v[200:203], v209, s[24:27], s54 offen sc1
    v_cndmask_b32 v86, v86, v87, s[44:45]
    v_mfma_f32_16x16x32_bf16 v[16:19], a[120:123], v[68:71], v[16:19]
    v_cndmask_b32 v88, v88, v89, s[44:45]
    v_cndmask_b32 v83, v86, v88, s[46:47]
    v_mfma_f32_16x16x32_bf16 v[16:19], a[104:107], v[64:67], v[16:19]
    buffer_store_dwordx2 v[82:83], v7, s[12:15], s36 offen offset:0 sc1
    s_mov_b32 s22, s14
    v_mfma_f32_16x16x32_bf16 v[12:15], a[100:103], v[64:67], v[12:15]
    ds_read_b128 v[52:55], v2 offset:11264
    s_add_u32 s36, s36, 34816
    v_mfma_f32_16x16x32_bf16 v[12:15], a[116:119], v[68:71], v[12:15]
    buffer_load_dwordx4 v1, s[8:11], s33 offen offset:0 sc1 lds
    v_mfma_f32_16x16x32_bf16 v[8:11], a[112:115], v[68:71], v[8:11]
    s_sub_u32 s42, s42, 32768
    v_mfma_f32_16x16x32_bf16 v[8:11], a[96:99], v[64:67], v[8:11]
    s_waitcnt lgkmcnt(2)
    v_mfma_f32_16x16x32_bf16 v[8:11], a[128:131], v[40:43], v[8:11]
    ds_read_b128 v[56:59], v2 offset:12288
    v_mfma_f32_16x16x32_bf16 v[8:11], a[144:147], v[44:47], v[8:11]
    buffer_load_dwordx4 v1, s[8:11], s33 offen offset:1024 sc1 lds
    v_mfma_f32_16x16x32_bf16 v[12:15], a[148:151], v[44:47], v[12:15]
    s_cmp_lt_i32 s31, 31
    s_cselect_b32 s14, s6, 0
    s_cselect_b32 s54, s36, s42
    v_mfma_f32_16x16x32_bf16 v[12:15], a[132:135], v[40:43], v[12:15]
    s_cmp_lt_i32 s31, 31
    s_cselect_b64 s[24:25], s[4:5], s[80:81]
    s_cselect_b32 s26, s6, 0x400000
    v_mfma_f32_16x16x32_bf16 v[16:19], a[136:139], v[40:43], v[16:19]
    ds_read_b128 v[60:63], v2 offset:13312
    v_mfma_f32_16x16x32_bf16 v[16:19], a[152:155], v[44:47], v[16:19]
    buffer_load_dwordx4 v1, s[8:11], s33 offen offset:2048 sc1 lds
    v_mfma_f32_16x16x32_bf16 v[20:23], a[156:159], v[44:47], v[20:23]
    s_cmp_lt_i32 s31, 31
    s_cselect_b64 s[48:49], 0, -1
    v_cndmask_b32 v204, v210, v216, s[48:49]
    v_mfma_f32_16x16x32_bf16 v[20:23], a[140:143], v[40:43], v[20:23]
    s_waitcnt lgkmcnt(2)
    v_cndmask_b32 v205, v211, v217, s[48:49]
    v_cndmask_b32 v206, v212, v218, s[48:49]
    v_mfma_f32_16x16x32_bf16 v[20:23], a[172:175], v[48:51], v[20:23]
    ds_read_b128 v[64:67], v2 offset:14336
    v_cndmask_b32 v207, v213, v219, s[48:49]
    v_mfma_f32_16x16x32_bf16 v[20:23], a[188:191], v[52:55], v[20:23]
    buffer_load_dwordx4 v1, s[8:11], s33 offen offset:3072 sc1 lds
    v_mfma_f32_16x16x32_bf16 v[16:19], a[184:187], v[52:55], v[16:19]
    s_add_u32 s32, s32, 1
    s_add_u32 s40, s40, 131072
    s_add_u32 s33, s33, 116736
    v_mfma_f32_16x16x32_bf16 v[16:19], a[168:171], v[48:51], v[16:19]
    s_add_u32 s34, s34, 36864
    s_cmp_ge_u32 s34, 147456
    s_cselect_b32 s38, 147456, 0
    v_mfma_f32_16x16x32_bf16 v[12:15], a[164:167], v[48:51], v[12:15]
    ds_read_b128 v[68:71], v2 offset:15360
    s_sub_u32 s34, s34, s38
    v_mfma_f32_16x16x32_bf16 v[12:15], a[180:183], v[52:55], v[12:15]
    s_cmp_ge_i32 s32, 63
    s_cselect_b32 s18, 0xffff, s18
    v_cndmask_b32 v208, v214, v220, s[48:49]
    v_mfma_f32_16x16x32_bf16 v[8:11], a[176:179], v[52:55], v[8:11]
    buffer_load_dwordx4 v[188:191], v1, s[4:7], s41 offen offset:0 sc1
    v_mfma_f32_16x16x32_bf16 v[8:11], a[160:163], v[48:51], v[8:11]
    s_waitcnt lgkmcnt(2)
    v_cndmask_b32 v209, v215, v221, s[48:49]
    s_add_u32 s35, s35, 36864
    v_mfma_f32_16x16x32_bf16 v[8:11], a[192:195], v[56:59], v[8:11]
    s_cmp_eq_u32 s35, 147456
    s_cselect_b32 s35, 0, s35
    v_mfma_f32_16x16x32_bf16 v[8:11], a[208:211], v[60:63], v[8:11]
    v_mfma_f32_16x16x32_bf16 v[12:15], a[212:215], v[60:63], v[12:15]
    buffer_load_dwordx4 v[192:195], v1, s[4:7], s41 offen offset:1024 sc1
    v_mfma_f32_16x16x32_bf16 v[12:15], a[196:199], v[56:59], v[12:15]
    s_add_u32 s41, s41, 36864
    v_mfma_f32_16x16x32_bf16 v[16:19], a[200:203], v[56:59], v[16:19]
    v_mfma_f32_16x16x32_bf16 v[16:19], a[216:219], v[60:63], v[16:19]
    v_mfma_f32_16x16x32_bf16 v[20:23], a[220:223], v[60:63], v[20:23]
    v_mfma_f32_16x16x32_bf16 v[20:23], a[204:207], v[56:59], v[20:23]
    s_waitcnt lgkmcnt(0)
    v_mfma_f32_16x16x32_bf16 v[20:23], a[236:239], v[64:67], v[20:23]
    v_mfma_f32_16x16x32_bf16 v[20:23], a[252:255], v[68:71], v[20:23]
    v_mfma_f32_16x16x32_bf16 v[16:19], a[248:251], v[68:71], v[16:19]
    v_mfma_f32_16x16x32_bf16 v[16:19], a[232:235], v[64:67], v[16:19]
    v_mfma_f32_16x16x32_bf16 v[12:15], a[228:231], v[64:67], v[12:15]
    v_mfma_f32_16x16x32_bf16 v[12:15], a[244:247], v[68:71], v[12:15]
    v_mfma_f32_16x16x32_bf16 v[8:11], a[240:243], v[68:71], v[8:11]
    v_mfma_f32_16x16x32_bf16 v[8:11], a[224:227], v[64:67], v[8:11]
    s_waitcnt vmcnt(19)
    v_mfma_f32_16x16x32_bf16 v[8:11], v[96:99], v[180:183], v[8:11]
    v_mfma_f32_16x16x32_bf16 v[12:15], v[94:97], v[180:183], v[12:15]
    v_mfma_f32_16x16x32_bf16 v[16:19], v[96:99], v[184:187], v[16:19]
    v_mfma_f32_16x16x32_bf16 v[20:23], v[94:97], v[184:187], v[20:23]
    s_cmp_lt_i32 s31, 63
    s_cbranch_scc1 Lred_run0
    s_branch L_exit
Lred_top0:
    s_waitcnt vmcnt(10)
    v_mfma_f32_16x16x32_bf16 v[20:23], v[94:97], v[120:123], v[20:23]
    s_barrier
    v_mfma_f32_16x16x32_bf16 v[16:19], v[96:99], v[120:123], v[16:19]
    s_waitcnt vmcnt(9)
    v_add_u32 v3, s35, v1
    v_cmp_gt_i32 vcc, s32, v5
    v_mfma_f32_16x16x32_bf16 v[12:15], v[94:97], v[116:119], v[12:15]
    v_mfma_f32_16x16x32_bf16 v[8:11], v[96:99], v[116:119], v[8:11]
    s_waitcnt vmcnt(8)
    s_and_b64 vcc, vcc, s[18:19]
    s_cbranch_scc1 Lred_v01
    v_mfma_f32_16x16x32_bf16 v[8:11], v[96:99], v[124:127], v[8:11]
    s_add_u32 s16, s16, 8192
    v_mfma_f32_16x16x32_bf16 v[12:15], v[94:97], v[124:127], v[12:15]
    buffer_load_dwordx4 v[148:151], v1, s[4:7], s40 offen offset:0 sc1
    v_mfma_f32_16x16x32_bf16 v[16:19], v[96:99], v[128:131], v[16:19]
    ds_read_b128 v[40:43], v3 offset:0
    s_add_u32 s31, s31, 1
    v_mfma_f32_16x16x32_bf16 v[20:23], v[94:97], v[128:131], v[20:23]
    s_waitcnt vmcnt(7)
    v_mov_b32 v6, s31
    v_mfma_f32_16x16x32_bf16 v[20:23], v[94:97], v[136:139], v[20:23]
    ds_read_b128 v[44:47], v3 offset:1024
    v_mfma_f32_16x16x32_bf16 v[16:19], v[96:99], v[136:139], v[16:19]
    buffer_load_dwordx4 v[152:155], v1, s[4:7], s40 offen offset:1024 sc1
    v_mfma_f32_16x16x32_bf16 v[12:15], v[94:97], v[132:135], v[12:15]
    ds_read_b128 v[48:51], v3 offset:2048
    s_add_u32 s37, s40, 32768
    v_mfma_f32_16x16x32_bf16 v[8:11], v[96:99], v[132:135], v[8:11]
    s_waitcnt vmcnt(6)
    buffer_store_dword v6, v80, s[20:23], s17 offen sc1
    v_mfma_f32_16x16x32_bf16 v[8:11], v[96:99], v[140:143], v[8:11]
    ds_read_b128 v[52:55], v3 offset:3072
    s_add_u32 s17, s17, 8192
    v_mfma_f32_16x16x32_bf16 v[12:15], v[94:97], v[140:143], v[12:15]
    buffer_load_dwordx4 v[156:159], v1, s[4:7], s37 offen offset:0 sc1
    v_mfma_f32_16x16x32_bf16 v[16:19], v[96:99], v[144:147], v[16:19]
    v_mfma_f32_16x16x32_bf16 v[20:23], v[94:97], v[144:147], v[20:23]
    s_waitcnt lgkmcnt(2)
    v_mfma_f32_16x16x32_bf16 v[24:27], a[0:3], v[40:43], v[100:103]
    ds_read_b128 v[56:59], v3 offset:4096
    v_cvt_pk_bf16_f32 v72, v8, v9
    v_mfma_f32_16x16x32_bf16 v[24:27], a[16:19], v[44:47], v[24:27]
    buffer_load_dwordx4 v[160:163], v1, s[4:7], s37 offen offset:1024 sc1
    v_mfma_f32_16x16x32_bf16 v[28:31], a[20:23], v[44:47], v[104:107]
    s_add_u32 s37, s40, 65536
    v_cvt_pk_bf16_f32 v73, v10, v11
    v_mfma_f32_16x16x32_bf16 v[28:31], a[4:7], v[40:43], v[28:31]
    ds_write_b64 v204, v[72:73]
    v_mfma_f32_16x16x32_bf16 v[32:35], a[8:11], v[40:43], v[108:111]
    ds_read_b128 v[60:63], v3 offset:5120
    v_cvt_pk_bf16_f32 v74, v12, v13
    v_mfma_f32_16x16x32_bf16 v[32:35], a[24:27], v[44:47], v[32:35]
    buffer_load_dwordx4 v[164:167], v1, s[4:7], s37 offen offset:0 sc1
    v_mfma_f32_16x16x32_bf16 v[36:39], a[28:31], v[44:47], v[112:115]
    v_cvt_pk_bf16_f32 v75, v14, v15
    v_mfma_f32_16x16x32_bf16 v[36:39], a[12:15], v[40:43], v[36:39]
    s_waitcnt lgkmcnt(3)
    ds_write_b64 v205, v[74:75]
    v_mfma_f32_16x16x32_bf16 v[36:39], a[44:47], v[48:51], v[36:39]
    ds_read_b128 v[64:67], v3 offset:6144
    v_cvt_pk_bf16_f32 v76, v16, v17
    v_mfma_f32_16x16x32_bf16 v[36:39], a[60:63], v[52:55], v[36:39]
    buffer_load_dwordx4 v[168:171], v1, s[4:7], s37 offen offset:1024 sc1
    v_mfma_f32_16x16x32_bf16 v[32:35], a[56:59], v[52:55], v[32:35]
    s_add_u32 s37, s40, 98304
    v_cvt_pk_bf16_f32 v77, v18, v19
    v_mfma_f32_16x16x32_bf16 v[32:35], a[40:43], v[48:51], v[32:35]
    ds_write_b64 v206, v[76:77]
    v_mfma_f32_16x16x32_bf16 v[28:31], a[36:39], v[48:51], v[28:31]
    ds_read_b128 v[68:71], v3 offset:7168
    v_cvt_pk_bf16_f32 v78, v20, v21
    v_mfma_f32_16x16x32_bf16 v[28:31], a[52:55], v[52:55], v[28:31]
    buffer_load_dwordx4 v[172:175], v1, s[4:7], s37 offen offset:0 sc1
    v_mfma_f32_16x16x32_bf16 v[24:27], a[48:51], v[52:55], v[24:27]
    v_cvt_pk_bf16_f32 v79, v22, v23
    v_mfma_f32_16x16x32_bf16 v[24:27], a[32:35], v[48:51], v[24:27]
    s_waitcnt lgkmcnt(4)
    ds_write_b64 v207, v[78:79]
    v_mfma_f32_16x16x32_bf16 v[24:27], a[64:67], v[56:59], v[24:27]
    ds_read_b128 v[40:43], v3 offset:8192
    v_mfma_f32_16x16x32_bf16 v[24:27], a[80:83], v[60:63], v[24:27]
    buffer_load_dwordx4 v[176:179], v1, s[4:7], s37 offen offset:1024 sc1
    v_mfma_f32_16x16x32_bf16 v[28:31], a[84:87], v[60:63], v[28:31]
    s_add_u32 m0, s34, 0
    ds_read_b128 v[196:199], v222 offset:0
    v_mfma_f32_16x16x32_bf16 v[28:31], a[68:71], v[56:59], v[28:31]
    ds_read_b128 v[200:203], v222 offset:1024
    v_mfma_f32_16x16x32_bf16 v[86:89], v[72:75], v[72:75], 0
    v_mfma_f32_16x16x32_bf16 v[82:85], v[90:93], v[72:75], 0
    buffer_load_dword v5, v4, s[4:7], s16 offen sc1
    v_mfma_f32_16x16x32_bf16 v[86:89], v[76:79], v[76:79], v[86:89]
    v_mfma_f32_16x16x32_bf16 v[82:85], v[90:93], v[76:79], v[82:85]
    s_waitcnt lgkmcnt(1)
    v_mfma_f32_16x16x32_bf16 v[32:35], a[72:75], v[56:59], v[32:35]
    ds_read_b128 v[44:47], v3 offset:9216
    v_mfma_f32_16x16x32_bf16 v[32:35], a[88:91], v[60:63], v[32:35]
    buffer_store_dwordx4 v[196:199], v208, s[24:27], s54 offen sc1
    s_waitcnt lgkmcnt(1)
    v_mfma_f32_16x16x32_bf16 v[36:39], a[92:95], v[60:63], v[36:39]
    v_mfma_f32_16x16x32_bf16 v[36:39], a[76:79], v[56:59], v[36:39]
    v_mfma_f32_16x16x32_bf16 v[36:39], a[108:111], v[64:67], v[36:39]
    ds_read_b128 v[48:51], v3 offset:10240
    v_mfma_f32_16x16x32_bf16 v[36:39], a[124:127], v[68:71], v[36:39]
    buffer_store_dwordx4 v[200:203], v209, s[24:27], s54 offen sc1
    v_cndmask_b32 v86, v86, v87, s[44:45]
    v_mfma_f32_16x16x32_bf16 v[32:35], a[120:123], v[68:71], v[32:35]
    v_cndmask_b32 v88, v88, v89, s[44:45]
    v_cndmask_b32 v83, v86, v88, s[46:47]
    v_mfma_f32_16x16x32_bf16 v[32:35], a[104:107], v[64:67], v[32:35]
    buffer_store_dwordx2 v[82:83], v7, s[12:15], s36 offen offset:0 sc1
    s_mov_b32 s22, s14
    v_mfma_f32_16x16x32_bf16 v[28:31], a[100:103], v[64:67], v[28:31]
    ds_read_b128 v[52:55], v3 offset:11264
    s_add_u32 s36, s36, 34816
    v_mfma_f32_16x16x32_bf16 v[28:31], a[116:119], v[68:71], v[28:31]
    buffer_load_dwordx4 v1, s[8:11], s33 offen offset:0 sc1 lds
    v_mfma_f32_16x16x32_bf16 v[24:27], a[112:115], v[68:71], v[24:27]
    s_sub_u32 s42, s42, 32768
    v_mfma_f32_16x16x32_bf16 v[24:27], a[96:99], v[64:67], v[24:27]
    s_waitcnt lgkmcnt(2)
    v_mfma_f32_16x16x32_bf16 v[24:27], a[128:131], v[40:43], v[24:27]
    ds_read_b128 v[56:59], v3 offset:12288
    v_mfma_f32_16x16x32_bf16 v[24:27], a[144:147], v[44:47], v[24:27]
    buffer_load_dwordx4 v1, s[8:11], s33 offen offset:1024 sc1 lds
    v_mfma_f32_16x16x32_bf16 v[28:31], a[148:151], v[44:47], v[28:31]
    s_cmp_lt_i32 s31, 31
    s_cselect_b32 s14, s6, 0
    s_cselect_b32 s54, s36, s42
    v_mfma_f32_16x16x32_bf16 v[28:31], a[132:135], v[40:43], v[28:31]
    s_cmp_lt_i32 s31, 31
    s_cselect_b64 s[24:25], s[4:5], s[80:81]
    s_cselect_b32 s26, s6, 0x400000
    v_mfma_f32_16x16x32_bf16 v[32:35], a[136:139], v[40:43], v[32:35]
    ds_read_b128 v[60:63], v3 offset:13312
    v_mfma_f32_16x16x32_bf16 v[32:35], a[152:155], v[44:47], v[32:35]
    buffer_load_dwordx4 v1, s[8:11], s33 offen offset:2048 sc1 lds
    v_mfma_f32_16x16x32_bf16 v[36:39], a[156:159], v[44:47], v[36:39]
    s_cmp_lt_i32 s31, 31
    s_cselect_b64 s[48:49], 0, -1
    v_cndmask_b32 v204, v210, v216, s[48:49]
    v_mfma_f32_16x16x32_bf16 v[36:39], a[140:143], v[40:43], v[36:39]
    s_waitcnt lgkmcnt(2)
    v_cndmask_b32 v205, v211, v217, s[48:49]
    v_cndmask_b32 v206, v212, v218, s[48:49]
    v_mfma_f32_16x16x32_bf16 v[36:39], a[172:175], v[48:51], v[36:39]
    ds_read_b128 v[64:67], v3 offset:14336
    v_cndmask_b32 v207, v213, v219, s[48:49]
    v_mfma_f32_16x16x32_bf16 v[36:39], a[188:191], v[52:55], v[36:39]
    buffer_load_dwordx4 v1, s[8:11], s33 offen offset:3072 sc1 lds
    v_mfma_f32_16x16x32_bf16 v[32:35], a[184:187], v[52:55], v[32:35]
    s_add_u32 s32, s32, 1
    s_add_u32 s40, s40, 131072
    s_add_u32 s33, s33, 116736
    v_mfma_f32_16x16x32_bf16 v[32:35], a[168:171], v[48:51], v[32:35]
    s_add_u32 s34, s34, 36864
    s_cmp_ge_u32 s34, 147456
    s_cselect_b32 s38, 147456, 0
    v_mfma_f32_16x16x32_bf16 v[28:31], a[164:167], v[48:51], v[28:31]
    ds_read_b128 v[68:71], v3 offset:15360
    s_sub_u32 s34, s34, s38
    v_mfma_f32_16x16x32_bf16 v[28:31], a[180:183], v[52:55], v[28:31]
    s_cmp_ge_i32 s32, 63
    s_cselect_b32 s18, 0xffff, s18
    v_cndmask_b32 v208, v214, v220, s[48:49]
    v_mfma_f32_16x16x32_bf16 v[24:27], a[176:179], v[52:55], v[24:27]
    buffer_load_dwordx4 v[180:183], v1, s[4:7], s41 offen offset:0 sc1
    v_mfma_f32_16x16x32_bf16 v[24:27], a[160:163], v[48:51], v[24:27]
    s_waitcnt lgkmcnt(2)
    v_cndmask_b32 v209, v215, v221, s[48:49]
    s_add_u32 s35, s35, 36864
    v_mfma_f32_16x16x32_bf16 v[24:27], a[192:195], v[56:59], v[24:27]
    s_cmp_eq_u32 s35, 147456
    s_cselect_b32 s35, 0, s35
    v_mfma_f32_16x16x32_bf16 v[24:27], a[208:211], v[60:63], v[24:27]
    v_mfma_f32_16x16x32_bf16 v[28:31], a[212:215], v[60:63], v[28:31]
    buffer_load_dwordx4 v[184:187], v1, s[4:7], s41 offen offset:1024 sc1
    v_mfma_f32_16x16x32_bf16 v[28:31], a[196:199], v[56:59], v[28:31]
    s_add_u32 s41, s41, 36864
    v_mfma_f32_16x16x32_bf16 v[32:35], a[200:203], v[56:59], v[32:35]
    v_mfma_f32_16x16x32_bf16 v[32:35], a[216:219], v[60:63], v[32:35]
    v_mfma_f32_16x16x32_bf16 v[36:39], a[220:223], v[60:63], v[36:39]
    v_mfma_f32_16x16x32_bf16 v[36:39], a[204:207], v[56:59], v[36:39]
    s_waitcnt lgkmcnt(0)
    v_mfma_f32_16x16x32_bf16 v[36:39], a[236:239], v[64:67], v[36:39]
    v_mfma_f32_16x16x32_bf16 v[36:39], a[252:255], v[68:71], v[36:39]
    v_mfma_f32_16x16x32_bf16 v[32:35], a[248:251], v[68:71], v[32:35]
    v_mfma_f32_16x16x32_bf16 v[32:35], a[232:235], v[64:67], v[32:35]
    v_mfma_f32_16x16x32_bf16 v[28:31], a[228:231], v[64:67], v[28:31]
    v_mfma_f32_16x16x32_bf16 v[28:31], a[244:247], v[68:71], v[28:31]
    v_mfma_f32_16x16x32_bf16 v[24:27], a[240:243], v[68:71], v[24:27]
    v_mfma_f32_16x16x32_bf16 v[24:27], a[224:227], v[64:67], v[24:27]
    s_waitcnt vmcnt(19)
    v_mfma_f32_16x16x32_bf16 v[24:27], v[96:99], v[188:191], v[24:27]
    v_mfma_f32_16x16x32_bf16 v[28:31], v[94:97], v[188:191], v[28:31]
    v_mfma_f32_16x16x32_bf16 v[32:35], v[96:99], v[192:195], v[32:35]
    v_mfma_f32_16x16x32_bf16 v[36:39], v[94:97], v[192:195], v[36:39]
    s_cmp_lt_i32 s31, 63
    s_cbranch_scc1 Lred_run1
    s_branch L_exit
Lred_v01:
    s_nop 1
    s_waitcnt vmcnt(8)
    v_mfma_f32_16x16x32_bf16 v[8:11], v[96:99], v[124:127], v[8:11]
    buffer_load_dword v5, v4, s[4:7], s16 offen sc1
    v_mfma_f32_16x16x32_bf16 v[12:15], v[94:97], v[124:127], v[12:15]
    s_add_u32 s31, s31, 1
    v_mov_b32 v6, s31
    v_mfma_f32_16x16x32_bf16 v[16:19], v[96:99], v[128:131], v[16:19]
    ds_read_b128 v[40:43], v3 offset:0
    v_mfma_f32_16x16x32_bf16 v[20:23], v[94:97], v[128:131], v[20:23]
    s_waitcnt vmcnt(7)
    v_mfma_f32_16x16x32_bf16 v[20:23], v[94:97], v[136:139], v[20:23]
    ds_read_b128 v[44:47], v3 offset:1024
    v_mfma_f32_16x16x32_bf16 v[16:19], v[96:99], v[136:139], v[16:19]
    buffer_store_dword v6, v80, s[20:23], s17 offen sc1
    s_add_u32 s17, s17, 8192
    v_mfma_f32_16x16x32_bf16 v[12:15], v[94:97], v[132:135], v[12:15]
    ds_read_b128 v[48:51], v3 offset:2048
    v_mfma_f32_16x16x32_bf16 v[8:11], v[96:99], v[132:135], v[8:11]
    s_waitcnt vmcnt(6)
    v_mfma_f32_16x16x32_bf16 v[8:11], v[96:99], v[140:143], v[8:11]
    ds_read_b128 v[52:55], v3 offset:3072
    v_mfma_f32_16x16x32_bf16 v[12:15], v[94:97], v[140:143], v[12:15]
    v_mfma_f32_16x16x32_bf16 v[16:19], v[96:99], v[144:147], v[16:19]
    v_mfma_f32_16x16x32_bf16 v[20:23], v[94:97], v[144:147], v[20:23]
    s_waitcnt lgkmcnt(2)
    v_mfma_f32_16x16x32_bf16 v[24:27], a[0:3], v[40:43], v[100:103]
    ds_read_b128 v[56:59], v3 offset:4096
    v_mfma_f32_16x16x32_bf16 v[24:27], a[16:19], v[44:47], v[24:27]
    v_cvt_pk_bf16_f32 v72, v8, v9
    v_cvt_pk_bf16_f32 v73, v10, v11
    v_mfma_f32_16x16x32_bf16 v[28:31], a[20:23], v[44:47], v[104:107]
    ds_write_b64 v204, v[72:73]
    v_mfma_f32_16x16x32_bf16 v[28:31], a[4:7], v[40:43], v[28:31]
    v_cvt_pk_bf16_f32 v74, v12, v13
    v_cvt_pk_bf16_f32 v75, v14, v15
    v_mfma_f32_16x16x32_bf16 v[32:35], a[8:11], v[40:43], v[108:111]
    ds_read_b128 v[60:63], v3 offset:5120
    v_mfma_f32_16x16x32_bf16 v[32:35], a[24:27], v[44:47], v[32:35]
    ds_write_b64 v205, v[74:75]
    v_mfma_f32_16x16x32_bf16 v[36:39], a[28:31], v[44:47], v[112:115]
    s_waitcnt vmcnt(1)
    v_cmp_gt_i32 vcc, s32, v5
    v_cvt_pk_bf16_f32 v76, v16, v17
    v_mfma_f32_16x16x32_bf16 v[36:39], a[12:15], v[40:43], v[36:39]
    s_waitcnt lgkmcnt(4)
    v_cvt_pk_bf16_f32 v77, v18, v19
    v_mfma_f32_16x16x32_bf16 v[36:39], a[44:47], v[48:51], v[36:39]
    ds_read_b128 v[64:67], v3 offset:6144
    v_mfma_f32_16x16x32_bf16 v[36:39], a[60:63], v[52:55], v[36:39]
    s_and_b64 vcc, vcc, s[18:19]
    s_cbranch_scc1 Lred_v02
    v_mfma_f32_16x16x32_bf16 v[32:35], a[56:59], v[52:55], v[32:35]
    s_add_u32 s16, s16, 8192
    v_mfma_f32_16x16x32_bf16 v[32:35], a[40:43], v[48:51], v[32:35]
    buffer_load_dwordx4 v[148:151], v1, s[4:7], s40 offen offset:0 sc1
    v_mfma_f32_16x16x32_bf16 v[28:31], a[36:39], v[48:51], v[28:31]
    ds_read_b128 v[68:71], v3 offset:7168
    v_mfma_f32_16x16x32_bf16 v[28:31], a[52:55], v[52:55], v[28:31]
    ds_write_b64 v206, v[76:77]
    v_mfma_f32_16x16x32_bf16 v[24:27], a[48:51], v[52:55], v[24:27]
    v_cvt_pk_bf16_f32 v78, v20, v21
    v_cvt_pk_bf16_f32 v79, v22, v23
    v_mfma_f32_16x16x32_bf16 v[24:27], a[32:35], v[48:51], v[24:27]
    s_waitcnt lgkmcnt(4)
    buffer_load_dwordx4 v[152:155], v1, s[4:7], s40 offen offset:1024 sc1
    v_mfma_f32_16x16x32_bf16 v[24:27], a[64:67], v[56:59], v[24:27]
    ds_read_b128 v[40:43], v3 offset:8192
    s_add_u32 s37, s40, 32768
    v_mfma_f32_16x16x32_bf16 v[24:27], a[80:83], v[60:63], v[24:27]
    ds_write_b64 v207, v[78:79]
    v_mfma_f32_16x16x32_bf16 v[28:31], a[84:87], v[60:63], v[28:31]
    ds_read_b128 v[196:199], v222 offset:0
    v_mfma_f32_16x16x32_bf16 v[28:31], a[68:71], v[56:59], v[28:31]
    buffer_load_dword v5, v4, s[4:7], s16 offen sc1
    v_mfma_f32_16x16x32_bf16 v[32:35], a[72:75], v[56:59], v[32:35]
    ds_read_b128 v[44:47], v3 offset:9216
    v_mfma_f32_16x16x32_bf16 v[32:35], a[88:91], v[60:63], v[32:35]
    ds_read_b128 v[200:203], v222 offset:1024
    v_mfma_f32_16x16x32_bf16 v[86:89], v[72:75], v[72:75], 0
    v_mfma_f32_16x16x32_bf16 v[82:85], v[90:93], v[72:75], 0
    buffer_load_dwordx4 v[156:159], v1, s[4:7], s37 offen offset:0 sc1
    v_mfma_f32_16x16x32_bf16 v[86:89], v[76:79], v[76:79], v[86:89]
    v_mfma_f32_16x16x32_bf16 v[82:85], v[90:93], v[76:79], v[82:85]
    s_waitcnt lgkmcnt(2)
    v_mfma_f32_16x16x32_bf16 v[36:39], a[92:95], v[60:63], v[36:39]
    v_mfma_f32_16x16x32_bf16 v[36:39], a[76:79], v[56:59], v[36:39]
    buffer_store_dwordx4 v[196:199], v208, s[24:27], s54 offen sc1
    s_waitcnt lgkmcnt(0)
    v_mfma_f32_16x16x32_bf16 v[36:39], a[108:111], v[64:67], v[36:39]
    ds_read_b128 v[48:51], v3 offset:10240
    v_mfma_f32_16x16x32_bf16 v[36:39], a[124:127], v[68:71], v[36:39]
    v_mfma_f32_16x16x32_bf16 v[32:35], a[120:123], v[68:71], v[32:35]
    v_mfma_f32_16x16x32_bf16 v[32:35], a[104:107], v[64:67], v[32:35]
    buffer_store_dwordx4 v[200:203], v209, s[24:27], s54 offen sc1
    v_cndmask_b32 v86, v86, v87, s[44:45]
    v_mfma_f32_16x16x32_bf16 v[28:31], a[100:103], v[64:67], v[28:31]
    ds_read_b128 v[52:55], v3 offset:11264
    v_cndmask_b32 v88, v88, v89, s[44:45]
    v_mfma_f32_16x16x32_bf16 v[28:31], a[116:119], v[68:71], v[28:31]
    v_cndmask_b32 v83, v86, v88, s[46:47]
    v_mfma_f32_16x16x32_bf16 v[24:27], a[112:115], v[68:71], v[24:27]
    buffer_store_dwordx2 v[82:83], v7, s[12:15], s36 offen offset:0 sc1
    s_mov_b32 s22, s14
    v_mfma_f32_16x16x32_bf16 v[24:27], a[96:99], v[64:67], v[24:27]
    buffer_load_dwordx4 v[160:163], v1, s[4:7], s37 offen offset:1024 sc1
    v_mfma_f32_16x16x32_bf16 v[24:27], a[128:131], v[40:43], v[24:27]
    ds_read_b128 v[56:59], v3 offset:12288
    s_add_u32 s37, s40, 65536
    v_mfma_f32_16x16x32_bf16 v[24:27], a[144:147], v[44:47], v[24:27]
    s_add_u32 s36, s36, 34816
    s_sub_u32 s42, s42, 32768
    v_mfma_f32_16x16x32_bf16 v[28:31], a[148:151], v[44:47], v[28:31]
    s_cmp_lt_i32 s31, 31
    s_cselect_b32 s14, s6, 0
    s_cselect_b32 s54, s36, s42
    v_mfma_f32_16x16x32_bf16 v[28:31], a[132:135], v[40:43], v[28:31]
    buffer_load_dwordx4 v[164:167], v1, s[4:7], s37 offen offset:0 sc1
    v_mfma_f32_16x16x32_bf16 v[32:35], a[136:139], v[40:43], v[32:35]
    ds_read_b128 v[60:63], v3 offset:13312
    v_mfma_f32_16x16x32_bf16 v[32:35], a[152:155], v[44:47], v[32:35]
    s_cmp_lt_i32 s31, 31
    s_cselect_b64 s[24:25], s[4:5], s[80:81]
    s_cselect_b32 s26, s6, 0x400000
    v_mfma_f32_16x16x32_bf16 v[36:39], a[156:159], v[44:47], v[36:39]
    s_cmp_lt_i32 s31, 31
    s_cselect_b64 s[48:49], 0, -1
    v_cndmask_b32 v204, v210, v216, s[48:49]
    v_mfma_f32_16x16x32_bf16 v[36:39], a[140:143], v[40:43], v[36:39]
    s_waitcnt lgkmcnt(2)
    buffer_load_dwordx4 v[168:171], v1, s[4:7], s37 offen offset:1024 sc1
    v_mfma_f32_16x16x32_bf16 v[36:39], a[172:175], v[48:51], v[36:39]
    ds_read_b128 v[64:67], v3 offset:14336
    s_add_u32 s37, s40, 98304
    v_mfma_f32_16x16x32_bf16 v[36:39], a[188:191], v[52:55], v[36:39]
    v_cndmask_b32 v205, v211, v217, s[48:49]
    v_cndmask_b32 v206, v212, v218, s[48:49]
    v_mfma_f32_16x16x32_bf16 v[32:35], a[184:187], v[52:55], v[32:35]
    v_cndmask_b32 v207, v213, v219, s[48:49]
    v_cndmask_b32 v208, v214, v220, s[48:49]
    v_mfma_f32_16x16x32_bf16 v[32:35], a[168:171], v[48:51], v[32:35]
    buffer_load_dwordx4 v[172:175], v1, s[4:7], s37 offen offset:0 sc1
    v_mfma_f32_16x16x32_bf16 v[28:31], a[164:167], v[48:51], v[28:31]
    ds_read_b128 v[68:71], v3 offset:15360
    v_cndmask_b32 v209, v215, v221, s[48:49]
    v_mfma_f32_16x16x32_bf16 v[28:31], a[180:183], v[52:55], v[28:31]
    s_add_u32 s35, s35, 36864
    s_cmp_eq_u32 s35, 147456
    s_cselect_b32 s35, 0, s35
    v_mfma_f32_16x16x32_bf16 v[24:27], a[176:179], v[52:55], v[24:27]
    v_mfma_f32_16x16x32_bf16 v[24:27], a[160:163], v[48:51], v[24:27]
    s_waitcnt lgkmcnt(2)
    buffer_load_dwordx4 v[176:179], v1, s[4:7], s37 offen offset:1024 sc1
    v_mfma_f32_16x16x32_bf16 v[24:27], a[192:195], v[56:59], v[24:27]
    s_add_u32 m0, s34, 0
    v_mfma_f32_16x16x32_bf16 v[24:27], a[208:211], v[60:63], v[24:27]
    v_mfma_f32_16x16x32_bf16 v[28:31], a[212:215], v[60:63], v[28:31]
    v_mfma_f32_16x16x32_bf16 v[28:31], a[196:199], v[56:59], v[28:31]
    buffer_load_dwordx4 v1, s[8:11], s33 offen offset:0 sc1 lds
    v_mfma_f32_16x16x32_bf16 v[32:35], a[200:203], v[56:59], v[32:35]
    v_mfma_f32_16x16x32_bf16 v[32:35], a[216:219], v[60:63], v[32:35]
    v_mfma_f32_16x16x32_bf16 v[36:39], a[220:223], v[60:63], v[36:39]
    v_mfma_f32_16x16x32_bf16 v[36:39], a[204:207], v[56:59], v[36:39]
    s_waitcnt lgkmcnt(0)
    buffer_load_dwordx4 v1, s[8:11], s33 offen offset:1024 sc1 lds
    v_mfma_f32_16x16x32_bf16 v[36:39], a[236:239], v[64:67], v[36:39]
    v_mfma_f32_16x16x32_bf16 v[36:39], a[252:255], v[68:71], v[36:39]
    v_mfma_f32_16x16x32_bf16 v[32:35], a[248:251], v[68:71], v[32:35]
    v_mfma_f32_16x16x32_bf16 v[32:35], a[232:235], v[64:67], v[32:35]
    buffer_load_dwordx4 v1, s[8:11], s33 offen offset:2048 sc1 lds
    v_mfma_f32_16x16x32_bf16 v[28:31], a[228:231], v[64:67], v[28:31]
    v_mfma_f32_16x16x32_bf16 v[28:31], a[244:247], v[68:71], v[28:31]
    v_mfma_f32_16x16x32_bf16 v[24:27], a[240:243], v[68:71], v[24:27]
    v_mfma_f32_16x16x32_bf16 v[24:27], a[224:227], v[64:67], v[24:27]
    buffer_load_dwordx4 v1, s[8:11], s33 offen offset:3072 sc1 lds
    v_mfma_f32_16x16x32_bf16 v[24:27], v[96:99], v[188:191], v[24:27]
    s_add_u32 s32, s32, 1
    s_add_u32 s40, s40, 131072
    s_add_u32 s33, s33, 116736
    v_mfma_f32_16x16x32_bf16 v[28:31], v[94:97], v[188:191], v[28:31]
    s_add_u32 s34, s34, 36864
    s_cmp_ge_u32 s34, 147456
    s_cselect_b32 s38, 147456, 0
    v_mfma_f32_16x16x32_bf16 v[32:35], v[96:99], v[192:195], v[32:35]
    s_sub_u32 s34, s34, s38
    s_cmp_ge_i32 s32, 63
    s_cselect_b32 s18, 0xffff, s18
    v_mfma_f32_16x16x32_bf16 v[36:39], v[94:97], v[192:195], v[36:39]
    buffer_load_dwordx4 v[180:183], v1, s[4:7], s41 offen offset:0 sc1
    buffer_load_dwordx4 v[184:187], v1, s[4:7], s41 offen offset:1024 sc1
    s_add_u32 s41, s41, 36864
    s_cmp_lt_i32 s31, 63
    s_cbranch_scc1 Lred_top1
    s_branch L_exit
Lred_v02:
    v_mfma_f32_16x16x32_bf16 v[32:35], a[56:59], v[52:55], v[32:35]
    buffer_load_dword v5, v4, s[4:7], s16 offen sc1
    v_mfma_f32_16x16x32_bf16 v[32:35], a[40:43], v[48:51], v[32:35]
    ds_write_b64 v206, v[76:77]
    v_mfma_f32_16x16x32_bf16 v[28:31], a[36:39], v[48:51], v[28:31]
    ds_read_b128 v[68:71], v3 offset:7168
    v_cvt_pk_bf16_f32 v78, v20, v21
    v_mfma_f32_16x16x32_bf16 v[28:31], a[52:55], v[52:55], v[28:31]
    v_cvt_pk_bf16_f32 v79, v22, v23
    v_mfma_f32_16x16x32_bf16 v[24:27], a[48:51], v[52:55], v[24:27]
    ds_write_b64 v207, v[78:79]
    v_mfma_f32_16x16x32_bf16 v[24:27], a[32:35], v[48:51], v[24:27]
    s_waitcnt lgkmcnt(5)
    ds_read_b128 v[196:199], v222 offset:0
    v_mfma_f32_16x16x32_bf16 v[24:27], a[64:67], v[56:59], v[24:27]
    ds_read_b128 v[40:43], v3 offset:8192
    v_mfma_f32_16x16x32_bf16 v[24:27], a[80:83], v[60:63], v[24:27]
    ds_read_b128 v[200:203], v222 offset:1024
    v_mfma_f32_16x16x32_bf16 v[86:89], v[72:75], v[72:75], 0
    buffer_load_dwordx4 v[180:183], v1, s[4:7], s41 offen offset:0 sc1
    v_mfma_f32_16x16x32_bf16 v[82:85], v[90:93], v[72:75], 0
    v_mfma_f32_16x16x32_bf16 v[86:89], v[76:79], v[76:79], v[86:89]
    v_mfma_f32_16x16x32_bf16 v[82:85], v[90:93], v[76:79], v[82:85]
    s_waitcnt lgkmcnt(2)
    v_mfma_f32_16x16x32_bf16 v[28:31], a[84:87], v[60:63], v[28:31]
    buffer_store_dwordx4 v[196:199], v208, s[24:27], s54 offen sc1
    s_waitcnt lgkmcnt(0)
    v_mfma_f32_16x16x32_bf16 v[28:31], a[68:71], v[56:59], v[28:31]
    v_mfma_f32_16x16x32_bf16 v[32:35], a[72:75], v[56:59], v[32:35]
    ds_read_b128 v[44:47], v3 offset:9216
    v_mfma_f32_16x16x32_bf16 v[32:35], a[88:91], v[60:63], v[32:35]
    v_mfma_f32_16x16x32_bf16 v[36:39], a[92:95], v[60:63], v[36:39]
    buffer_store_dwordx4 v[200:203], v209, s[24:27], s54 offen sc1
    v_cndmask_b32 v86, v86, v87, s[44:45]
    v_mfma_f32_16x16x32_bf16 v[36:39], a[76:79], v[56:59], v[36:39]
    v_cndmask_b32 v88, v88, v89, s[44:45]
    v_cndmask_b32 v83, v86, v88, s[46:47]
    v_mfma_f32_16x16x32_bf16 v[36:39], a[108:111], v[64:67], v[36:39]
    ds_read_b128 v[48:51], v3 offset:10240
    s_waitcnt vmcnt(3)
    v_mfma_f32_16x16x32_bf16 v[36:39], a[124:127], v[68:71], v[36:39]
    buffer_store_dwordx2 v[82:83], v7, s[12:15], s36 offen offset:0 sc1
    v_cmp_gt_i32 vcc, s32, v5
    v_mfma_f32_16x16x32_bf16 v[32:35], a[120:123], v[68:71], v[32:35]
    s_mov_b32 s22, s14
    s_add_u32 s36, s36, 34816
    s_sub_u32 s42, s42, 32768
    v_mfma_f32_16x16x32_bf16 v[32:35], a[104:107], v[64:67], v[32:35]
    s_and_b64 vcc, vcc, s[18:19]
    s_cbranch_scc1 Lred_v03
    v_mfma_f32_16x16x32_bf16 v[28:31], a[100:103], v[64:67], v[28:31]
    ds_read_b128 v[52:55], v3 offset:11264
    s_add_u32 s16, s16, 8192
    v_mfma_f32_16x16x32_bf16 v[28:31], a[116:119], v[68:71], v[28:31]
    buffer_load_dword v5, v4, s[4:7], s16 offen sc1
    v_mfma_f32_16x16x32_bf16 v[24:27], a[112:115], v[68:71], v[24:27]
    s_cmp_lt_i32 s31, 31
    s_cselect_b32 s14, s6, 0
    s_cselect_b32 s54, s36, s42
    v_mfma_f32_16x16x32_bf16 v[24:27], a[96:99], v[64:67], v[24:27]
    s_waitcnt lgkmcnt(2)
    v_mfma_f32_16x16x32_bf16 v[24:27], a[128:131], v[40:43], v[24:27]
    ds_read_b128 v[56:59], v3 offset:12288
    v_mfma_f32_16x16x32_bf16 v[24:27], a[144:147], v[44:47], v[24:27]
    buffer_load_dwordx4 v[148:151], v1, s[4:7], s40 offen offset:0 sc1
    v_mfma_f32_16x16x32_bf16 v[28:31], a[148:151], v[44:47], v[28:31]
    s_cmp_lt_i32 s31, 31
    s_cselect_b64 s[24:25], s[4:5], s[80:81]
    s_cselect_b32 s26, s6, 0x400000
    v_mfma_f32_16x16x32_bf16 v[28:31], a[132:135], v[40:43], v[28:31]
    s_cmp_lt_i32 s31, 31
    s_cselect_b64 s[48:49], 0, -1
    v_cndmask_b32 v204, v210, v216, s[48:49]
    v_mfma_f32_16x16x32_bf16 v[32:35], a[136:139], v[40:43], v[32:35]
    ds_read_b128 v[60:63], v3 offset:13312
    v_cndmask_b32 v205, v211, v217, s[48:49]
    v_mfma_f32_16x16x32_bf16 v[32:35], a[152:155], v[44:47], v[32:35]
    buffer_load_dwordx4 v[152:155], v1, s[4:7], s40 offen offset:1024 sc1
    v_mfma_f32_16x16x32_bf16 v[36:39], a[156:159], v[44:47], v[36:39]
    s_add_u32 s37, s40, 32768
    v_cndmask_b32 v206, v212, v218, s[48:49]
    v_cndmask_b32 v207, v213, v219, s[48:49]
    v_mfma_f32_16x16x32_bf16 v[36:39], a[140:143], v[40:43], v[36:39]
    s_waitcnt lgkmcnt(2)
    v_cndmask_b32 v208, v214, v220, s[48:49]
    v_cndmask_b32 v209, v215, v221, s[48:49]
    v_mfma_f32_16x16x32_bf16 v[36:39], a[172:175], v[48:51], v[36:39]
    ds_read_b128 v[64:67], v3 offset:14336
    s_add_u32 s35, s35, 36864
    v_mfma_f32_16x16x32_bf16 v[36:39], a[188:191], v[52:55], v[36:39]
    buffer_load_dwordx4 v[156:159], v1, s[4:7], s37 offen offset:0 sc1
    v_mfma_f32_16x16x32_bf16 v[32:35], a[184:187], v[52:55], v[32:35]
    s_cmp_eq_u32 s35, 147456
    s_cselect_b32 s35, 0, s35
    v_mfma_f32_16x16x32_bf16 v[32:35], a[168:171], v[48:51], v[32:35]
    v_mfma_f32_16x16x32_bf16 v[28:31], a[164:167], v[48:51], v[28:31]
    ds_read_b128 v[68:71], v3 offset:15360
    v_mfma_f32_16x16x32_bf16 v[28:31], a[180:183], v[52:55], v[28:31]
    buffer_load_dwordx4 v[160:163], v1, s[4:7], s37 offen offset:1024 sc1
    v_mfma_f32_16x16x32_bf16 v[24:27], a[176:179], v[52:55], v[24:27]
    s_add_u32 s37, s40, 65536
    v_mfma_f32_16x16x32_bf16 v[24:27], a[160:163], v[48:51], v[24:27]
    s_waitcnt lgkmcnt(2)
    v_mfma_f32_16x16x32_bf16 v[24:27], a[192:195], v[56:59], v[24:27]
    v_mfma_f32_16x16x32_bf16 v[24:27], a[208:211], v[60:63], v[24:27]
    buffer_load_dwordx4 v[164:167], v1, s[4:7], s37 offen offset:0 sc1
    v_mfma_f32_16x16x32_bf16 v[28:31], a[212:215], v[60:63], v[28:31]
    v_mfma_f32_16x16x32_bf16 v[28:31], a[196:199], v[56:59], v[28:31]
    v_mfma_f32_16x16x32_bf16 v[32:35], a[200:203], v[56:59], v[32:35]
    v_mfma_f32_16x16x32_bf16 v[32:35], a[216:219], v[60:63], v[32:35]
    buffer_load_dwordx4 v[168:171], v1, s[4:7], s37 offen offset:1024 sc1
    v_mfma_f32_16x16x32_bf16 v[36:39], a[220:223], v[60:63], v[36:39]
    s_add_u32 s37, s40, 98304
    v_mfma_f32_16x16x32_bf16 v[36:39], a[204:207], v[56:59], v[36:39]
    s_waitcnt lgkmcnt(0)
    v_mfma_f32_16x16x32_bf16 v[36:39], a[236:239], v[64:67], v[36:39]
    v_mfma_f32_16x16x32_bf16 v[36:39], a[252:255], v[68:71], v[36:39]
    buffer_load_dwordx4 v[172:175], v1, s[4:7], s37 offen offset:0 sc1
    v_mfma_f32_16x16x32_bf16 v[32:35], a[248:251], v[68:71], v[32:35]
    v_mfma_f32_16x16x32_bf16 v[32:35], a[232:235], v[64:67], v[32:35]
    v_mfma_f32_16x16x32_bf16 v[28:31], a[228:231], v[64:67], v[28:31]
    v_mfma_f32_16x16x32_bf16 v[28:31], a[244:247], v[68:71], v[28:31]
    buffer_load_dwordx4 v[176:179], v1, s[4:7], s37 offen offset:1024 sc1
    v_mfma_f32_16x16x32_bf16 v[24:27], a[240:243], v[68:71], v[24:27]
    s_add_u32 m0, s34, 0
    v_mfma_f32_16x16x32_bf16 v[24:27], a[224:227], v[64:67], v[24:27]
    v_mfma_f32_16x16x32_bf16 v[24:27], v[96:99], v[188:191], v[24:27]
    v_mfma_f32_16x16x32_bf16 v[28:31], v[94:97], v[188:191], v[28:31]
    buffer_load_dwordx4 v1, s[8:11], s33 offen offset:0 sc1 lds
    v_mfma_f32_16x16x32_bf16 v[32:35], v[96:99], v[192:195], v[32:35]
    v_mfma_f32_16x16x32_bf16 v[36:39], v[94:97], v[192:195], v[36:39]
    buffer_load_dwordx4 v1, s[8:11], s33 offen offset:1024 sc1 lds
    buffer_load_dwordx4 v1, s[8:11], s33 offen offset:2048 sc1 lds
    buffer_load_dwordx4 v1, s[8:11], s33 offen offset:3072 sc1 lds
    s_add_u32 s32, s32, 1
    s_add_u32 s40, s40, 131072
    s_add_u32 s33, s33, 116736
    s_add_u32 s34, s34, 36864
    s_cmp_ge_u32 s34, 147456
    s_cselect_b32 s38, 147456, 0
    s_sub_u32 s34, s34, s38
    s_cmp_ge_i32 s32, 63
    s_cselect_b32 s18, 0xffff, s18
    buffer_load_dwordx4 v[184:187], v1, s[4:7], s41 offen offset:1024 sc1
    s_add_u32 s41, s41, 36864
    s_cmp_lt_i32 s31, 63
    s_cbranch_scc1 Lred_top1
    s_branch L_exit
Lred_v03:
    v_mfma_f32_16x16x32_bf16 v[28:31], a[100:103], v[64:67], v[28:31]
    ds_read_b128 v[52:55], v3 offset:11264
    v_mfma_f32_16x16x32_bf16 v[28:31], a[116:119], v[68:71], v[28:31]
    buffer_load_dword v5, v4, s[4:7], s16 offen sc1
    v_mfma_f32_16x16x32_bf16 v[24:27], a[112:115], v[68:71], v[24:27]
    s_cmp_lt_i32 s31, 31
    s_cselect_b32 s14, s6, 0
    s_cselect_b32 s54, s36, s42
    v_mfma_f32_16x16x32_bf16 v[24:27], a[96:99], v[64:67], v[24:27]
    s_waitcnt lgkmcnt(2)
    v_mfma_f32_16x16x32_bf16 v[24:27], a[128:131], v[40:43], v[24:27]
    ds_read_b128 v[56:59], v3 offset:12288
    v_mfma_f32_16x16x32_bf16 v[24:27], a[144:147], v[44:47], v[24:27]
    s_cmp_lt_i32 s31, 31
    s_cselect_b64 s[24:25], s[4:5], s[80:81]
    s_cselect_b32 s26, s6, 0x400000
    v_mfma_f32_16x16x32_bf16 v[28:31], a[148:151], v[44:47], v[28:31]
    s_cmp_lt_i32 s31, 31
    s_cselect_b64 s[48:49], 0, -1
    v_cndmask_b32 v204, v210, v216, s[48:49]
    v_mfma_f32_16x16x32_bf16 v[28:31], a[132:135], v[40:43], v[28:31]
    buffer_load_dwordx4 v[184:187], v1, s[4:7], s41 offen offset:1024 sc1
    v_mfma_f32_16x16x32_bf16 v[32:35], a[136:139], v[40:43], v[32:35]
    ds_read_b128 v[60:63], v3 offset:13312
    v_cndmask_b32 v205, v211, v217, s[48:49]
    v_mfma_f32_16x16x32_bf16 v[32:35], a[152:155], v[44:47], v[32:35]
    s_add_u32 s41, s41, 36864
    v_cndmask_b32 v206, v212, v218, s[48:49]
    v_cndmask_b32 v207, v213, v219, s[48:49]
    v_mfma_f32_16x16x32_bf16 v[36:39], a[156:159], v[44:47], v[36:39]
    v_cndmask_b32 v208, v214, v220, s[48:49]
    v_cndmask_b32 v209, v215, v221, s[48:49]
    v_mfma_f32_16x16x32_bf16 v[36:39], a[140:143], v[40:43], v[36:39]
    s_waitcnt lgkmcnt(2)
    s_add_u32 s35, s35, 36864
    v_mfma_f32_16x16x32_bf16 v[36:39], a[172:175], v[48:51], v[36:39]
    ds_read_b128 v[64:67], v3 offset:14336
    v_mfma_f32_16x16x32_bf16 v[36:39], a[188:191], v[52:55], v[36:39]
    s_cmp_eq_u32 s35, 147456
    s_cselect_b32 s35, 0, s35
    v_mfma_f32_16x16x32_bf16 v[32:35], a[184:187], v[52:55], v[32:35]
    v_mfma_f32_16x16x32_bf16 v[32:35], a[168:171], v[48:51], v[32:35]
    v_mfma_f32_16x16x32_bf16 v[28:31], a[164:167], v[48:51], v[28:31]
    ds_read_b128 v[68:71], v3 offset:15360
    v_mfma_f32_16x16x32_bf16 v[28:31], a[180:183], v[52:55], v[28:31]
    v_mfma_f32_16x16x32_bf16 v[24:27], a[176:179], v[52:55], v[24:27]
    v_mfma_f32_16x16x32_bf16 v[24:27], a[160:163], v[48:51], v[24:27]
    s_waitcnt vmcnt(1) lgkmcnt(2)
    v_cmp_gt_i32 vcc, s32, v5
    v_mfma_f32_16x16x32_bf16 v[24:27], a[192:195], v[56:59], v[24:27]
    v_mfma_f32_16x16x32_bf16 v[24:27], a[208:211], v[60:63], v[24:27]
    s_and_b64 vcc, vcc, s[18:19]
    s_cbranch_scc1 Lred_v04
    v_mfma_f32_16x16x32_bf16 v[28:31], a[212:215], v[60:63], v[28:31]
    s_add_u32 s16, s16, 8192
    v_mfma_f32_16x16x32_bf16 v[28:31], a[196:199], v[56:59], v[28:31]
    buffer_load_dword v5, v4, s[4:7], s16 offen sc1
    v_mfma_f32_16x16x32_bf16 v[32:35], a[200:203], v[56:59], v[32:35]
    v_mfma_f32_16x16x32_bf16 v[32:35], a[216:219], v[60:63], v[32:35]
    v_mfma_f32_16x16x32_bf16 v[36:39], a[220:223], v[60:63], v[36:39]
    v_mfma_f32_16x16x32_bf16 v[36:39], a[204:207], v[56:59], v[36:39]
    s_waitcnt lgkmcnt(0)
    buffer_load_dwordx4 v[148:151], v1, s[4:7], s40 offen offset:0 sc1
    v_mfma_f32_16x16x32_bf16 v[36:39], a[236:239], v[64:67], v[36:39]
    v_mfma_f32_16x16x32_bf16 v[36:39], a[252:255], v[68:71], v[36:39]
    v_mfma_f32_16x16x32_bf16 v[32:35], a[248:251], v[68:71], v[32:35]
    v_mfma_f32_16x16x32_bf16 v[32:35], a[232:235], v[64:67], v[32:35]
    buffer_load_dwordx4 v[152:155], v1, s[4:7], s40 offen offset:1024 sc1
    v_mfma_f32_16x16x32_bf16 v[28:31], a[228:231], v[64:67], v[28:31]
    s_add_u32 s37, s40, 32768
    v_mfma_f32_16x16x32_bf16 v[28:31], a[244:247], v[68:71], v[28:31]
    v_mfma_f32_16x16x32_bf16 v[24:27], a[240:243], v[68:71], v[24:27]
    v_mfma_f32_16x16x32_bf16 v[24:27], a[224:227], v[64:67], v[24:27]
    buffer_load_dwordx4 v[156:159], v1, s[4:7], s37 offen offset:0 sc1
    v_mfma_f32_16x16x32_bf16 v[24:27], v[96:99], v[188:191], v[24:27]
    v_mfma_f32_16x16x32_bf16 v[28:31], v[94:97], v[188:191], v[28:31]
    v_mfma_f32_16x16x32_bf16 v[32:35], v[96:99], v[192:195], v[32:35]
    v_mfma_f32_16x16x32_bf16 v[36:39], v[94:97], v[192:195], v[36:39]
    buffer_load_dwordx4 v[160:163], v1, s[4:7], s37 offen offset:1024 sc1
    s_add_u32 s37, s40, 65536
    buffer_load_dwordx4 v[164:167], v1, s[4:7], s37 offen offset:0 sc1
    buffer_load_dwordx4 v[168:171], v1, s[4:7], s37 offen offset:1024 sc1
    s_add_u32 s37, s40, 98304
    buffer_load_dwordx4 v[172:175], v1, s[4:7], s37 offen offset:0 sc1
    buffer_load_dwordx4 v[176:179], v1, s[4:7], s37 offen offset:1024 sc1
    s_add_u32 m0, s34, 0
    s_nop 0
    buffer_load_dwordx4 v1, s[8:11], s33 offen offset:0 sc1 lds
    buffer_load_dwordx4 v1, s[8:11], s33 offen offset:1024 sc1 lds
    buffer_load_dwordx4 v1, s[8:11], s33 offen offset:2048 sc1 lds
    buffer_load_dwordx4 v1, s[8:11], s33 offen offset:3072 sc1 lds
    s_add_u32 s32, s32, 1
    s_add_u32 s40, s40, 131072
    s_add_u32 s33, s33, 116736
    s_add_u32 s34, s34, 36864
    s_cmp_ge_u32 s34, 147456
    s_cselect_b32 s38, 147456, 0
    s_sub_u32 s34, s34, s38
    s_cmp_ge_i32 s32, 63
    s_cselect_b32 s18, 0xffff, s18
    s_cmp_lt_i32 s31, 63
    s_cbranch_scc1 Lred_top1
    s_branch L_exit
Lred_v04:
    v_mfma_f32_16x16x32_bf16 v[28:31], a[212:215], v[60:63], v[28:31]
    buffer_load_dword v5, v4, s[4:7], s16 offen sc1
    v_mfma_f32_16x16x32_bf16 v[28:31], a[196:199], v[56:59], v[28:31]
    v_mfma_f32_16x16x32_bf16 v[32:35], a[200:203], v[56:59], v[32:35]
    v_mfma_f32_16x16x32_bf16 v[32:35], a[216:219], v[60:63], v[32:35]
    v_mfma_f32_16x16x32_bf16 v[36:39], a[220:223], v[60:63], v[36:39]
    v_mfma_f32_16x16x32_bf16 v[36:39], a[204:207], v[56:59], v[36:39]
    s_waitcnt lgkmcnt(0)
    v_mfma_f32_16x16x32_bf16 v[36:39], a[236:239], v[64:67], v[36:39]
    v_mfma_f32_16x16x32_bf16 v[36:39], a[252:255], v[68:71], v[36:39]
    v_mfma_f32_16x16x32_bf16 v[32:35], a[248:251], v[68:71], v[32:35]
    v_mfma_f32_16x16x32_bf16 v[32:35], a[232:235], v[64:67], v[32:35]
    v_mfma_f32_16x16x32_bf16 v[28:31], a[228:231], v[64:67], v[28:31]
    v_mfma_f32_16x16x32_bf16 v[28:31], a[244:247], v[68:71], v[28:31]
    v_mfma_f32_16x16x32_bf16 v[24:27], a[240:243], v[68:71], v[24:27]
    v_mfma_f32_16x16x32_bf16 v[24:27], a[224:227], v[64:67], v[24:27]
    v_mfma_f32_16x16x32_bf16 v[24:27], v[96:99], v[188:191], v[24:27]
    v_mfma_f32_16x16x32_bf16 v[28:31], v[94:97], v[188:191], v[28:31]
    v_mfma_f32_16x16x32_bf16 v[32:35], v[96:99], v[192:195], v[32:35]
    v_mfma_f32_16x16x32_bf16 v[36:39], v[94:97], v[192:195], v[36:39]
    s_waitcnt vmcnt(0)
    v_cmp_gt_i32 vcc, s32, v5
    s_sub_u32 s43, s43, 1
    s_cmp_lt_i32 s43, 0
    s_cbranch_scc1 Lred_rdy0x
    s_and_b64 vcc, vcc, s[18:19]
    s_cbranch_scc0 Lred_rdy0x
Lred_spin0x:
    buffer_load_dword v5, v4, s[4:7], s16 offen sc1
    s_waitcnt vmcnt(0)
    v_cmp_gt_i32 vcc, s32, v5
    s_sub_u32 s43, s43, 1
    s_cmp_lt_i32 s43, 0
    s_cbranch_scc1 Lred_rdy0x
    s_and_b64 vcc, vcc, s[18:19]
    s_cbranch_scc0 Lred_rdy0x
    s_sleep 8
    s_branch Lred_spin0x
Lred_rdy0x:
    s_add_u32 s16, s16, 8192
    buffer_load_dword v5, v4, s[4:7], s16 offen sc1
    buffer_load_dwordx4 v[148:151], v1, s[4:7], s40 offen offset:0 sc1
    buffer_load_dwordx4 v[152:155], v1, s[4:7], s40 offen offset:1024 sc1
    s_add_u32 s37, s40, 32768
    buffer_load_dwordx4 v[156:159], v1, s[4:7], s37 offen offset:0 sc1
    buffer_load_dwordx4 v[160:163], v1, s[4:7], s37 offen offset:1024 sc1
    s_add_u32 s37, s40, 65536
    buffer_load_dwordx4 v[164:167], v1, s[4:7], s37 offen offset:0 sc1
    buffer_load_dwordx4 v[168:171], v1, s[4:7], s37 offen offset:1024 sc1
    s_add_u32 s37, s40, 98304
    buffer_load_dwordx4 v[172:175], v1, s[4:7], s37 offen offset:0 sc1
    buffer_load_dwordx4 v[176:179], v1, s[4:7], s37 offen offset:1024 sc1
    s_add_u32 m0, s34, 0
    s_nop 0
    buffer_load_dwordx4 v1, s[8:11], s33 offen offset:0 sc1 lds
    buffer_load_dwordx4 v1, s[8:11], s33 offen offset:1024 sc1 lds
    buffer_load_dwordx4 v1, s[8:11], s33 offen offset:2048 sc1 lds
    buffer_load_dwordx4 v1, s[8:11], s33 offen offset:3072 sc1 lds
    s_add_u32 s32, s32, 1
    s_add_u32 s40, s40, 131072
    s_add_u32 s33, s33, 116736
    s_add_u32 s34, s34, 36864
    s_cmp_ge_u32 s34, 147456
    s_cselect_b32 s38, 147456, 0
    s_sub_u32 s34, s34, s38
    s_cmp_ge_i32 s32, 63
    s_cselect_b32 s18, 0xffff, s18
    s_branch Lred_top1
Lred_top1:
    s_waitcnt vmcnt(10)
    v_mfma_f32_16x16x32_bf16 v[36:39], v[94:97], v[152:155], v[36:39]
    s_barrier
    v_mfma_f32_16x16x32_bf16 v[32:35], v[96:99], v[152:155], v[32:35]
    s_waitcnt vmcnt(9)
    v_add_u32 v2, s35, v1
    v_cmp_gt_i32 vcc, s32, v5
    v_mfma_f32_16x16x32_bf16 v[28:31], v[94:97], v[148:151], v[28:31]
    v_mfma_f32_16x16x32_bf16 v[24:27], v[96:99], v[148:151], v[24:27]
    s_waitcnt vmcnt(8)
    s_and_b64 vcc, vcc, s[18:19]
    s_cbranch_scc1 Lred_v11
    v_mfma_f32_16x16x32_bf16 v[24:27], v[96:99], v[156:159], v[24:27]
    s_add_u32 s16, s16, 8192
    v_mfma_f32_16x16x32_bf16 v[28:31], v[94:97], v[156:159], v[28:31]
    buffer_load_dwordx4 v[116:119], v1, s[4:7], s40 offen offset:0 sc1
    v_mfma_f32_16x16x32_bf16 v[32:35], v[96:99], v[160:163], v[32:35]
    ds_read_b128 v[40:43], v2 offset:0
    s_add_u32 s31, s31, 1
    v_mfma_f32_16x16x32_bf16 v[36:39], v[94:97], v[160:163], v[36:39]
    s_waitcnt vmcnt(7)
    v_mov_b32 v6, s31
    v_mfma_f32_16x16x32_bf16 v[36:39], v[94:97], v[168:171], v[36:39]
    ds_read_b128 v[44:47], v2 offset:1024
    v_mfma_f32_16x16x32_bf16 v[32:35], v[96:99], v[168:171], v[32:35]
    buffer_load_dwordx4 v[120:123], v1, s[4:7], s40 offen offset:1024 sc1
    v_mfma_f32_16x16x32_bf16 v[28:31], v[94:97], v[164:167], v[28:31]
    ds_read_b128 v[48:51], v2 offset:2048
    s_add_u32 s37, s40, 32768
    v_mfma_f32_16x16x32_bf16 v[24:27], v[96:99], v[164:167], v[24:27]
    s_waitcnt vmcnt(6)
    buffer_store_dword v6, v80, s[20:23], s17 offen sc1
    v_mfma_f32_16x16x32_bf16 v[24:27], v[96:99], v[172:175], v[24:27]
    ds_read_b128 v[52:55], v2 offset:3072
    s_add_u32 s17, s17, 8192
    v_mfma_f32_16x16x32_bf16 v[28:31], v[94:97], v[172:175], v[28:31]
    buffer_load_dwordx4 v[124:127], v1, s[4:7], s37 offen offset:0 sc1
    v_mfma_f32_16x16x32_bf16 v[32:35], v[96:99], v[176:179], v[32:35]
    v_mfma_f32_16x16x32_bf16 v[36:39], v[94:97], v[176:179], v[36:39]
    s_waitcnt lgkmcnt(2)
    v_mfma_f32_16x16x32_bf16 v[8:11], a[0:3], v[40:43], v[100:103]
    ds_read_b128 v[56:59], v2 offset:4096
    v_cvt_pk_bf16_f32 v72, v24, v25
    v_mfma_f32_16x16x32_bf16 v[8:11], a[16:19], v[44:47], v[8:11]
    buffer_load_dwordx4 v[128:131], v1, s[4:7], s37 offen offset:1024 sc1
    v_mfma_f32_16x16x32_bf16 v[12:15], a[20:23], v[44:47], v[104:107]
    s_add_u32 s37, s40, 65536
    v_cvt_pk_bf16_f32 v73, v26, v27
    v_mfma_f32_16x16x32_bf16 v[12:15], a[4:7], v[40:43], v[12:15]
    ds_write_b64 v204, v[72:73]
    v_mfma_f32_16x16x32_bf16 v[16:19], a[8:11], v[40:43], v[108:111]
    ds_read_b128 v[60:63], v2 offset:5120
    v_cvt_pk_bf16_f32 v74, v28, v29
    v_mfma_f32_16x16x32_bf16 v[16:19], a[24:27], v[44:47], v[16:19]
    buffer_load_dwordx4 v[132:135], v1, s[4:7], s37 offen offset:0 sc1
    v_mfma_f32_16x16x32_bf16 v[20:23], a[28:31], v[44:47], v[112:115]
    v_cvt_pk_bf16_f32 v75, v30, v31
    v_mfma_f32_16x16x32_bf16 v[20:23], a[12:15], v[40:43], v[20:23]
    s_waitcnt lgkmcnt(3)
    ds_write_b64 v205, v[74:75]
    v_mfma_f32_16x16x32_bf16 v[20:23], a[44:47], v[48:51], v[20:23]
    ds_read_b128 v[64:67], v2 offset:6144
    v_cvt_pk_bf16_f32 v76, v32, v33
    v_mfma_f32_16x16x32_bf16 v[20:23], a[60:63], v[52:55], v[20:23]
    buffer_load_dwordx4 v[136:139], v1, s[4:7], s37 offen offset:1024 sc1
    v_mfma_f32_16x16x32_bf16 v[16:19], a[56:59], v[52:55], v[16:19]
    s_add_u32 s37, s40, 98304
    v_cvt_pk_bf16_f32 v77, v34, v35
    v_mfma_f32_16x16x32_bf16 v[16:19], a[40:43], v[48:51], v[16:19]
    ds_write_b64 v206, v[76:77]
    v_mfma_f32_16x16x32_bf16 v[12:15], a[36:39], v[48:51], v[12:15]
    ds_read_b128 v[68:71], v2 offset:7168
    v_cvt_pk_bf16_f32 v78, v36, v37
    v_mfma_f32_16x16x32_bf16 v[12:15], a[52:55], v[52:55], v[12:15]
    buffer_load_dwordx4 v[140:143], v1, s[4:7], s37 offen offset:0 sc1
    v_mfma_f32_16x16x32_bf16 v[8:11], a[48:51], v[52:55], v[8:11]
    v_cvt_pk_bf16_f32 v79, v38, v39
    v_mfma_f32_16x16x32_bf16 v[8:11], a[32:35], v[48:51], v[8:11]
    s_waitcnt lgkmcnt(4)
    ds_write_b64 v207, v[78:79]
    v_mfma_f32_16x16x32_bf16 v[8:11], a[64:67], v[56:59], v[8:11]
    ds_read_b128 v[40:43], v2 offset:8192
    v_mfma_f32_16x16x32_bf16 v[8:11], a[80:83], v[60:63], v[8:11]
    buffer_load_dwordx4 v[144:147], v1, s[4:7], s37 offen offset:1024 sc1
    v_mfma_f32_16x16x32_bf16 v[12:15], a[84:87], v[60:63], v[12:15]
    s_add_u32 m0, s34, 0
    ds_read_b128 v[196:199], v222 offset:0
    v_mfma_f32_16x16x32_bf16 v[12:15], a[68:71], v[56:59], v[12:15]
    ds_read_b128 v[200:203], v222 offset:1024
    v_mfma_f32_16x16x32_bf16 v[86:89], v[72:75], v[72:75], 0
    v_mfma_f32_16x16x32_bf16 v[82:85], v[90:93], v[72:75], 0
    buffer_load_dword v5, v4, s[4:7], s16 offen sc1
    v_mfma_f32_16x16x32_bf16 v[86:89], v[76:79], v[76:79], v[86:89]
    v_mfma_f32_16x16x32_bf16 v[82:85], v[90:93], v[76:79], v[82:85]
    s_waitcnt lgkmcnt(1)
    v_mfma_f32_16x16x32_bf16 v[16:19], a[72:75], v[56:59], v[16:19]
    ds_read_b128 v[44:47], v2 offset:9216
    v_mfma_f32_16x16x32_bf16 v[16:19], a[88:91], v[60:63], v[16:19]
    buffer_store_dwordx4 v[196:199], v208, s[24:27], s54 offen sc1
    s_waitcnt lgkmcnt(1)
    v_mfma_f32_16x16x32_bf16 v[20:23], a[92:95], v[60:63], v[20:23]
    v_mfma_f32_16x16x32_bf16 v[20:23], a[76:79], v[56:59], v[20:23]
    v_mfma_f32_16x16x32_bf16 v[20:23], a[108:111], v[64:67], v[20:23]
    ds_read_b128 v[48:51], v2 offset:10240
    v_mfma_f32_16x16x32_bf16 v[20:23], a[124:127], v[68:71], v[20:23]
    buffer_store_dwordx4 v[200:203], v209, s[24:27], s54 offen sc1
    v_cndmask_b32 v86, v86, v87, s[44:45]
    v_mfma_f32_16x16x32_bf16 v[16:19], a[120:123], v[68:71], v[16:19]
    v_cndmask_b32 v88, v88, v89, s[44:45]
    v_cndmask_b32 v83, v86, v88, s[46:47]
    v_mfma_f32_16x16x32_bf16 v[16:19], a[104:107], v[64:67], v[16:19]
    buffer_store_dwordx2 v[82:83], v7, s[12:15], s36 offen offset:0 sc1
    s_mov_b32 s22, s14
    v_mfma_f32_16x16x32_bf16 v[12:15], a[100:103], v[64:67], v[12:15]
    ds_read_b128 v[52:55], v2 offset:11264
    s_add_u32 s36, s36, 34816
    v_mfma_f32_16x16x32_bf16 v[12:15], a[116:119], v[68:71], v[12:15]
    buffer_load_dwordx4 v1, s[8:11], s33 offen offset:0 sc1 lds
    v_mfma_f32_16x16x32_bf16 v[8:11], a[112:115], v[68:71], v[8:11]
    s_sub_u32 s42, s42, 32768
    v_mfma_f32_16x16x32_bf16 v[8:11], a[96:99], v[64:67], v[8:11]
    s_waitcnt lgkmcnt(2)
    v_mfma_f32_16x16x32_bf16 v[8:11], a[128:131], v[40:43], v[8:11]
    ds_read_b128 v[56:59], v2 offset:12288
    v_mfma_f32_16x16x32_bf16 v[8:11], a[144:147], v[44:47], v[8:11]
    buffer_load_dwordx4 v1, s[8:11], s33 offen offset:1024 sc1 lds
    v_mfma_f32_16x16x32_bf16 v[12:15], a[148:151], v[44:47], v[12:15]
    s_cmp_lt_i32 s31, 31
    s_cselect_b32 s14, s6, 0
    s_cselect_b32 s54, s36, s42
    v_mfma_f32_16x16x32_bf16 v[12:15], a[132:135], v[40:43], v[12:15]
    s_cmp_lt_i32 s31, 31
    s_cselect_b64 s[24:25], s[4:5], s[80:81]
    s_cselect_b32 s26, s6, 0x400000
    v_mfma_f32_16x16x32_bf16 v[16:19], a[136:139], v[40:43], v[16:19]
    ds_read_b128 v[60:63], v2 offset:13312
    v_mfma_f32_16x16x32_bf16 v[16:19], a[152:155], v[44:47], v[16:19]
    buffer_load_dwordx4 v1, s[8:11], s33 offen offset:2048 sc1 lds
    v_mfma_f32_16x16x32_bf16 v[20:23], a[156:159], v[44:47], v[20:23]
    s_cmp_lt_i32 s31, 31
    s_cselect_b64 s[48:49], 0, -1
    v_cndmask_b32 v204, v210, v216, s[48:49]
    v_mfma_f32_16x16x32_bf16 v[20:23], a[140:143], v[40:43], v[20:23]
    s_waitcnt lgkmcnt(2)
    v_cndmask_b32 v205, v211, v217, s[48:49]
    v_cndmask_b32 v206, v212, v218, s[48:49]
    v_mfma_f32_16x16x32_bf16 v[20:23], a[172:175], v[48:51], v[20:23]
    ds_read_b128 v[64:67], v2 offset:14336
    v_cndmask_b32 v207, v213, v219, s[48:49]
    v_mfma_f32_16x16x32_bf16 v[20:23], a[188:191], v[52:55], v[20:23]
    buffer_load_dwordx4 v1, s[8:11], s33 offen offset:3072 sc1 lds
    v_mfma_f32_16x16x32_bf16 v[16:19], a[184:187], v[52:55], v[16:19]
    s_add_u32 s32, s32, 1
    s_add_u32 s40, s40, 131072
    s_add_u32 s33, s33, 116736
    v_mfma_f32_16x16x32_bf16 v[16:19], a[168:171], v[48:51], v[16:19]
    s_add_u32 s34, s34, 36864
    s_cmp_ge_u32 s34, 147456
    s_cselect_b32 s38, 147456, 0
    v_mfma_f32_16x16x32_bf16 v[12:15], a[164:167], v[48:51], v[12:15]
    ds_read_b128 v[68:71], v2 offset:15360
    s_sub_u32 s34, s34, s38
    v_mfma_f32_16x16x32_bf16 v[12:15], a[180:183], v[52:55], v[12:15]
    s_cmp_ge_i32 s32, 63
    s_cselect_b32 s18, 0xffff, s18
    v_cndmask_b32 v208, v214, v220, s[48:49]
    v_mfma_f32_16x16x32_bf16 v[8:11], a[176:179], v[52:55], v[8:11]
    buffer_load_dwordx4 v[188:191], v1, s[4:7], s41 offen offset:0 sc1
    v_mfma_f32_16x16x32_bf16 v[8:11], a[160:163], v[48:51], v[8:11]
    s_waitcnt lgkmcnt(2)
    v_cndmask_b32 v209, v215, v221, s[48:49]
    s_add_u32 s35, s35, 36864
    v_mfma_f32_16x16x32_bf16 v[8:11], a[192:195], v[56:59], v[8:11]
    s_cmp_eq_u32 s35, 147456
    s_cselect_b32 s35, 0, s35
    v_mfma_f32_16x16x32_bf16 v[8:11], a[208:211], v[60:63], v[8:11]
    v_mfma_f32_16x16x32_bf16 v[12:15], a[212:215], v[60:63], v[12:15]
    buffer_load_dwordx4 v[192:195], v1, s[4:7], s41 offen offset:1024 sc1
    v_mfma_f32_16x16x32_bf16 v[12:15], a[196:199], v[56:59], v[12:15]
    s_add_u32 s41, s41, 36864
    v_mfma_f32_16x16x32_bf16 v[16:19], a[200:203], v[56:59], v[16:19]
    v_mfma_f32_16x16x32_bf16 v[16:19], a[216:219], v[60:63], v[16:19]
    v_mfma_f32_16x16x32_bf16 v[20:23], a[220:223], v[60:63], v[20:23]
    v_mfma_f32_16x16x32_bf16 v[20:23], a[204:207], v[56:59], v[20:23]
    s_waitcnt lgkmcnt(0)
    v_mfma_f32_16x16x32_bf16 v[20:23], a[236:239], v[64:67], v[20:23]
    v_mfma_f32_16x16x32_bf16 v[20:23], a[252:255], v[68:71], v[20:23]
    v_mfma_f32_16x16x32_bf16 v[16:19], a[248:251], v[68:71], v[16:19]
    v_mfma_f32_16x16x32_bf16 v[16:19], a[232:235], v[64:67], v[16:19]
    v_mfma_f32_16x16x32_bf16 v[12:15], a[228:231], v[64:67], v[12:15]
    v_mfma_f32_16x16x32_bf16 v[12:15], a[244:247], v[68:71], v[12:15]
    v_mfma_f32_16x16x32_bf16 v[8:11], a[240:243], v[68:71], v[8:11]
    v_mfma_f32_16x16x32_bf16 v[8:11], a[224:227], v[64:67], v[8:11]
    s_waitcnt vmcnt(19)
    v_mfma_f32_16x16x32_bf16 v[8:11], v[96:99], v[180:183], v[8:11]
    v_mfma_f32_16x16x32_bf16 v[12:15], v[94:97], v[180:183], v[12:15]
    v_mfma_f32_16x16x32_bf16 v[16:19], v[96:99], v[184:187], v[16:19]
    v_mfma_f32_16x16x32_bf16 v[20:23], v[94:97], v[184:187], v[20:23]
    s_cmp_lt_i32 s31, 63
    s_cbranch_scc1 Lred_run0
    s_branch L_exit
Lred_v11:
    s_nop 1
    s_waitcnt vmcnt(8)
    v_mfma_f32_16x16x32_bf16 v[24:27], v[96:99], v[156:159], v[24:27]
    buffer_load_dword v5, v4, s[4:7], s16 offen sc1
    v_mfma_f32_16x16x32_bf16 v[28:31], v[94:97], v[156:159], v[28:31]
    s_add_u32 s31, s31, 1
    v_mov_b32 v6, s31
    v_mfma_f32_16x16x32_bf16 v[32:35], v[96:99], v[160:163], v[32:35]
    ds_read_b128 v[40:43], v2 offset:0
    v_mfma_f32_16x16x32_bf16 v[36:39], v[94:97], v[160:163], v[36:39]
    s_waitcnt vmcnt(7)
    v_mfma_f32_16x16x32_bf16 v[36:39], v[94:97], v[168:171], v[36:39]
    ds_read_b128 v[44:47], v2 offset:1024
    v_mfma_f32_16x16x32_bf16 v[32:35], v[96:99], v[168:171], v[32:35]
    buffer_store_dword v6, v80, s[20:23], s17 offen sc1
    s_add_u32 s17, s17, 8192
    v_mfma_f32_16x16x32_bf16 v[28:31], v[94:97], v[164:167], v[28:31]
    ds_read_b128 v[48:51], v2 offset:2048
    v_mfma_f32_16x16x32_bf16 v[24:27], v[96:99], v[164:167], v[24:27]
    s_waitcnt vmcnt(6)
    v_mfma_f32_16x16x32_bf16 v[24:27], v[96:99], v[172:175], v[24:27]
    ds_read_b128 v[52:55], v2 offset:3072
    v_mfma_f32_16x16x32_bf16 v[28:31], v[94:97], v[172:175], v[28:31]
    v_mfma_f32_16x16x32_bf16 v[32:35], v[96:99], v[176:179], v[32:35]
    v_mfma_f32_16x16x32_bf16 v[36:39], v[94:97], v[176:179], v[36:39]
    s_waitcnt lgkmcnt(2)
    v_mfma_f32_16x16x32_bf16 v[8:11], a[0:3], v[40:43], v[100:103]
    ds_read_b128 v[56:59], v2 offset:4096
    v_mfma_f32_16x16x32_bf16 v[8:11], a[16:19], v[44:47], v[8:11]
    v_cvt_pk_bf16_f32 v72, v24, v25
    v_cvt_pk_bf16_f32 v73, v26, v27
    v_mfma_f32_16x16x32_bf16 v[12:15], a[20:23], v[44:47], v[104:107]
    ds_write_b64 v204, v[72:73]
    v_mfma_f32_16x16x32_bf16 v[12:15], a[4:7], v[40:43], v[12:15]
    v_cvt_pk_bf16_f32 v74, v28, v29
    v_cvt_pk_bf16_f32 v75, v30, v31
    v_mfma_f32_16x16x32_bf16 v[16:19], a[8:11], v[40:43], v[108:111]
    ds_read_b128 v[60:63], v2 offset:5120
    v_mfma_f32_16x16x32_bf16 v[16:19], a[24:27], v[44:47], v[16:19]
    ds_write_b64 v205, v[74:75]
    v_mfma_f32_16x16x32_bf16 v[20:23], a[28:31], v[44:47], v[112:115]
    s_waitcnt vmcnt(1)
    v_cmp_gt_i32 vcc, s32, v5
    v_cvt_pk_bf16_f32 v76, v32, v33
    v_mfma_f32_16x16x32_bf16 v[20:23], a[12:15], v[40:43], v[20:23]
    s_waitcnt lgkmcnt(4)
    v_cvt_pk_bf16_f32 v77, v34, v35
    v_mfma_f32_16x16x32_bf16 v[20:23], a[44:47], v[48:51], v[20:23]
    ds_read_b128 v[64:67], v2 offset:6144
    v_mfma_f32_16x16x32_bf16 v[20:23], a[60:63], v[52:55], v[20:23]
    s_and_b64 vcc, vcc, s[18:19]
    s_cbranch_scc1 Lred_v12
    v_mfma_f32_16x16x32_bf16 v[16:19], a[56:59], v[52:55], v[16:19]
    s_add_u32 s16, s16, 8192
    v_mfma_f32_16x16x32_bf16 v[16:19], a[40:43], v[48:51], v[16:19]
    buffer_load_dwordx4 v[116:119], v1, s[4:7], s40 offen offset:0 sc1
    v_mfma_f32_16x16x32_bf16 v[12:15], a[36:39], v[48:51], v[12:15]
    ds_read_b128 v[68:71], v2 offset:7168
    v_mfma_f32_16x16x32_bf16 v[12:15], a[52:55], v[52:55], v[12:15]
    ds_write_b64 v206, v[76:77]
    v_mfma_f32_16x16x32_bf16 v[8:11], a[48:51], v[52:55], v[8:11]
    v_cvt_pk_bf16_f32 v78, v36, v37
    v_cvt_pk_bf16_f32 v79, v38, v39
    v_mfma_f32_16x16x32_bf16 v[8:11], a[32:35], v[48:51], v[8:11]
    s_waitcnt lgkmcnt(4)
    buffer_load_dwordx4 v[120:123], v1, s[4:7], s40 offen offset:1024 sc1
    v_mfma_f32_16x16x32_bf16 v[8:11], a[64:67], v[56:59], v[8:11]
    ds_read_b128 v[40:43], v2 offset:8192
    s_add_u32 s37, s40, 32768
    v_mfma_f32_16x16x32_bf16 v[8:11], a[80:83], v[60:63], v[8:11]
    ds_write_b64 v207, v[78:79]
    v_mfma_f32_16x16x32_bf16 v[12:15], a[84:87], v[60:63], v[12:15]
    ds_read_b128 v[196:199], v222 offset:0
    v_mfma_f32_16x16x32_bf16 v[12:15], a[68:71], v[56:59], v[12:15]
    buffer_load_dword v5, v4, s[4:7], s16 offen sc1
    v_mfma_f32_16x16x32_bf16 v[16:19], a[72:75], v[56:59], v[16:19]
    ds_read_b128 v[44:47], v2 offset:9216
    v_mfma_f32_16x16x32_bf16 v[16:19], a[88:91], v[60:63], v[16:19]
    ds_read_b128 v[200:203], v222 offset:1024
    v_mfma_f32_16x16x32_bf16 v[86:89], v[72:75], v[72:75], 0
    v_mfma_f32_16x16x32_bf16 v[82:85], v[90:93], v[72:75], 0
    buffer_load_dwordx4 v[124:127], v1, s[4:7], s37 offen offset:0 sc1
    v_mfma_f32_16x16x32_bf16 v[86:89], v[76:79], v[76:79], v[86:89]
    v_mfma_f32_16x16x32_bf16 v[82:85], v[90:93], v[76:79], v[82:85]
    s_waitcnt lgkmcnt(2)
    v_mfma_f32_16x16x32_bf16 v[20:23], a[92:95], v[60:63], v[20:23]
    v_mfma_f32_16x16x32_bf16 v[20:23], a[76:79], v[56:59], v[20:23]
    buffer_store_dwordx4 v[196:199], v208, s[24:27], s54 offen sc1
    s_waitcnt lgkmcnt(0)
    v_mfma_f32_16x16x32_bf16 v[20:23], a[108:111], v[64:67], v[20:23]
    ds_read_b128 v[48:51], v2 offset:10240
    v_mfma_f32_16x16x32_bf16 v[20:23], a[124:127], v[68:71], v[20:23]
    v_mfma_f32_16x16x32_bf16 v[16:19], a[120:123], v[68:71], v[16:19]
    v_mfma_f32_16x16x32_bf16 v[16:19], a[104:107], v[64:67], v[16:19]
    buffer_store_dwordx4 v[200:203], v209, s[24:27], s54 offen sc1
    v_cndmask_b32 v86, v86, v87, s[44:45]
    v_mfma_f32_16x16x32_bf16 v[12:15], a[100:103], v[64:67], v[12:15]
    ds_read_b128 v[52:55], v2 offset:11264
    v_cndmask_b32 v88, v88, v89, s[44:45]
    v_mfma_f32_16x16x32_bf16 v[12:15], a[116:119], v[68:71], v[12:15]
    v_cndmask_b32 v83, v86, v88, s[46:47]
    v_mfma_f32_16x16x32_bf16 v[8:11], a[112:115], v[68:71], v[8:11]
    buffer_store_dwordx2 v[82:83], v7, s[12:15], s36 offen offset:0 sc1
    s_mov_b32 s22, s14
    v_mfma_f32_16x16x32_bf16 v[8:11], a[96:99], v[64:67], v[8:11]
    buffer_load_dwordx4 v[128:131], v1, s[4:7], s37 offen offset:1024 sc1
    v_mfma_f32_16x16x32_bf16 v[8:11], a[128:131], v[40:43], v[8:11]
    ds_read_b128 v[56:59], v2 offset:12288
    s_add_u32 s37, s40, 65536
    v_mfma_f32_16x16x32_bf16 v[8:11], a[144:147], v[44:47], v[8:11]
    s_add_u32 s36, s36, 34816
    s_sub_u32 s42, s42, 32768
    v_mfma_f32_16x16x32_bf16 v[12:15], a[148:151], v[44:47], v[12:15]
    s_cmp_lt_i32 s31, 31
    s_cselect_b32 s14, s6, 0
    s_cselect_b32 s54, s36, s42
    v_mfma_f32_16x16x32_bf16 v[12:15], a[132:135], v[40:43], v[12:15]
    buffer_load_dwordx4 v[132:135], v1, s[4:7], s37 offen offset:0 sc1
    v_mfma_f32_16x16x32_bf16 v[16:19], a[136:139], v[40:43], v[16:19]
    ds_read_b128 v[60:63], v2 offset:13312
    v_mfma_f32_16x16x32_bf16 v[16:19], a[152:155], v[44:47], v[16:19]
    s_cmp_lt_i32 s31, 31
    s_cselect_b64 s[24:25], s[4:5], s[80:81]
    s_cselect_b32 s26, s6, 0x400000
    v_mfma_f32_16x16x32_bf16 v[20:23], a[156:159], v[44:47], v[20:23]
    s_cmp_lt_i32 s31, 31
    s_cselect_b64 s[48:49], 0, -1
    v_cndmask_b32 v204, v210, v216, s[48:49]
    v_mfma_f32_16x16x32_bf16 v[20:23], a[140:143], v[40:43], v[20:23]
    s_waitcnt lgkmcnt(2)
    buffer_load_dwordx4 v[136:139], v1, s[4:7], s37 offen offset:1024 sc1
    v_mfma_f32_16x16x32_bf16 v[20:23], a[172:175], v[48:51], v[20:23]
    ds_read_b128 v[64:67], v2 offset:14336
    s_add_u32 s37, s40, 98304
    v_mfma_f32_16x16x32_bf16 v[20:23], a[188:191], v[52:55], v[20:23]
    v_cndmask_b32 v205, v211, v217, s[48:49]
    v_cndmask_b32 v206, v212, v218, s[48:49]
    v_mfma_f32_16x16x32_bf16 v[16:19], a[184:187], v[52:55], v[16:19]
    v_cndmask_b32 v207, v213, v219, s[48:49]
    v_cndmask_b32 v208, v214, v220, s[48:49]
    v_mfma_f32_16x16x32_bf16 v[16:19], a[168:171], v[48:51], v[16:19]
    buffer_load_dwordx4 v[140:143], v1, s[4:7], s37 offen offset:0 sc1
    v_mfma_f32_16x16x32_bf16 v[12:15], a[164:167], v[48:51], v[12:15]
    ds_read_b128 v[68:71], v2 offset:15360
    v_cndmask_b32 v209, v215, v221, s[48:49]
    v_mfma_f32_16x16x32_bf16 v[12:15], a[180:183], v[52:55], v[12:15]
    s_add_u32 s35, s35, 36864
    s_cmp_eq_u32 s35, 147456
    s_cselect_b32 s35, 0, s35
    v_mfma_f32_16x16x32_bf16 v[8:11], a[176:179], v[52:55], v[8:11]
    v_mfma_f32_16x16x32_bf16 v[8:11], a[160:163], v[48:51], v[8:11]
    s_waitcnt lgkmcnt(2)
    buffer_load_dwordx4 v[144:147], v1, s[4:7], s37 offen offset:1024 sc1
    v_mfma_f32_16x16x32_bf16 v[8:11], a[192:195], v[56:59], v[8:11]
    s_add_u32 m0, s34, 0
    v_mfma_f32_16x16x32_bf16 v[8:11], a[208:211], v[60:63], v[8:11]
    v_mfma_f32_16x16x32_bf16 v[12:15], a[212:215], v[60:63], v[12:15]
    v_mfma_f32_16x16x32_bf16 v[12:15], a[196:199], v[56:59], v[12:15]
    buffer_load_dwordx4 v1, s[8:11], s33 offen offset:0 sc1 lds
    v_mfma_f32_16x16x32_bf16 v[16:19], a[200:203], v[56:59], v[16:19]
    v_mfma_f32_16x16x32_bf16 v[16:19], a[216:219], v[60:63], v[16:19]
    v_mfma_f32_16x16x32_bf16 v[20:23], a[220:223], v[60:63], v[20:23]
    v_mfma_f32_16x16x32_bf16 v[20:23], a[204:207], v[56:59], v[20:23]
    s_waitcnt lgkmcnt(0)
    buffer_load_dwordx4 v1, s[8:11], s33 offen offset:1024 sc1 lds
    v_mfma_f32_16x16x32_bf16 v[20:23], a[236:239], v[64:67], v[20:23]
    v_mfma_f32_16x16x32_bf16 v[20:23], a[252:255], v[68:71], v[20:23]
    v_mfma_f32_16x16x32_bf16 v[16:19], a[248:251], v[68:71], v[16:19]
    v_mfma_f32_16x16x32_bf16 v[16:19], a[232:235], v[64:67], v[16:19]
    buffer_load_dwordx4 v1, s[8:11], s33 offen offset:2048 sc1 lds
    v_mfma_f32_16x16x32_bf16 v[12:15], a[228:231], v[64:67], v[12:15]
    v_mfma_f32_16x16x32_bf16 v[12:15], a[244:247], v[68:71], v[12:15]
    v_mfma_f32_16x16x32_bf16 v[8:11], a[240:243], v[68:71], v[8:11]
    v_mfma_f32_16x16x32_bf16 v[8:11], a[224:227], v[64:67], v[8:11]
    buffer_load_dwordx4 v1, s[8:11], s33 offen offset:3072 sc1 lds
    v_mfma_f32_16x16x32_bf16 v[8:11], v[96:99], v[180:183], v[8:11]
    s_add_u32 s32, s32, 1
    s_add_u32 s40, s40, 131072
    s_add_u32 s33, s33, 116736
    v_mfma_f32_16x16x32_bf16 v[12:15], v[94:97], v[180:183], v[12:15]
    s_add_u32 s34, s34, 36864
    s_cmp_ge_u32 s34, 147456
    s_cselect_b32 s38, 147456, 0
    v_mfma_f32_16x16x32_bf16 v[16:19], v[96:99], v[184:187], v[16:19]
    s_sub_u32 s34, s34, s38
    s_cmp_ge_i32 s32, 63
    s_cselect_b32 s18, 0xffff, s18
    v_mfma_f32_16x16x32_bf16 v[20:23], v[94:97], v[184:187], v[20:23]
    buffer_load_dwordx4 v[188:191], v1, s[4:7], s41 offen offset:0 sc1
    buffer_load_dwordx4 v[192:195], v1, s[4:7], s41 offen offset:1024 sc1
    s_add_u32 s41, s41, 36864
    s_cmp_lt_i32 s31, 63
    s_cbranch_scc1 Lred_top0
    s_branch L_exit
Lred_v12:
    s_cmp_lt_i32 s31, 63
    s_cbranch_scc1 Lred_more
    ds_write_b64 v206, v[76:77]
    v_cvt_pk_bf16_f32 v78, v36, v37
    v_cvt_pk_bf16_f32 v79, v38, v39
    ds_write_b64 v207, v[78:79]
    ds_read_b128 v[196:199], v222 offset:0
    ds_read_b128 v[200:203], v222 offset:1024
    v_mfma_f32_16x16x32_bf16 v[86:89], v[72:75], v[72:75], 0
    v_mfma_f32_16x16x32_bf16 v[82:85], v[90:93], v[72:75], 0
    v_mfma_f32_16x16x32_bf16 v[86:89], v[76:79], v[76:79], v[86:89]
    v_mfma_f32_16x16x32_bf16 v[82:85], v[90:93], v[76:79], v[82:85]
    s_waitcnt lgkmcnt(1)
    buffer_store_dwordx4 v[196:199], v208, s[24:27], s54 offen sc1
    s_waitcnt lgkmcnt(0)
    buffer_store_dwordx4 v[200:203], v209, s[24:27], s54 offen sc1
    s_nop 2
    v_cndmask_b32 v86, v86, v87, s[44:45]
    v_cndmask_b32 v88, v88, v89, s[44:45]
    v_cndmask_b32 v83, v86, v88, s[46:47]
    buffer_store_dwordx2 v[82:83], v7, s[12:15], s36 offen offset:0 sc1
    s_mov_b32 s22, s14
    s_add_u32 s36, s36, 34816
    s_sub_u32 s42, s42, 32768
    s_cmp_lt_i32 s31, 31
    s_cselect_b32 s14, s6, 0
    s_cselect_b32 s54, s36, s42
    s_cmp_lt_i32 s31, 31
    s_cselect_b64 s[24:25], s[4:5], s[80:81]
    s_cselect_b32 s26, s6, 0x400000
    s_cmp_lt_i32 s31, 31
    s_cselect_b64 s[48:49], 0, -1
    v_cndmask_b32 v204, v210, v216, s[48:49]
    v_cndmask_b32 v205, v211, v217, s[48:49]
    v_cndmask_b32 v206, v212, v218, s[48:49]
    v_cndmask_b32 v207, v213, v219, s[48:49]
    v_cndmask_b32 v208, v214, v220, s[48:49]
    v_cndmask_b32 v209, v215, v221, s[48:49]
    s_add_u32 s35, s35, 36864
    s_cmp_eq_u32 s35, 147456
    s_cselect_b32 s35, 0, s35
    s_branch L_exit
Lred_more:
    v_mfma_f32_16x16x32_bf16 v[16:19], a[56:59], v[52:55], v[16:19]
    buffer_load_dword v5, v4, s[4:7], s16 offen sc1
    v_mfma_f32_16x16x32_bf16 v[16:19], a[40:43], v[48:51], v[16:19]
    ds_write_b64 v206, v[76:77]
    v_mfma_f32_16x16x32_bf16 v[12:15], a[36:39], v[48:51], v[12:15]
    ds_read_b128 v[68:71], v2 offset:7168
    v_cvt_pk_bf16_f32 v78, v36, v37
    v_mfma_f32_16x16x32_bf16 v[12:15], a[52:55], v[52:55], v[12:15]
    v_cvt_pk_bf16_f32 v79, v38, v39
    v_mfma_f32_16x16x32_bf16 v[8:11], a[48:51], v[52:55], v[8:11]
    ds_write_b64 v207, v[78:79]
    v_mfma_f32_16x16x32_bf16 v[8:11], a[32:35], v[48:51], v[8:11]
    s_waitcnt lgkmcnt(5)
    ds_read_b128 v[196:199], v222 offset:0
    v_mfma_f32_16x16x32_bf16 v[8:11], a[64:67], v[56:59], v[8:11]
    ds_read_b128 v[40:43], v2 offset:8192
    v_mfma_f32_16x16x32_bf16 v[8:11], a[80:83], v[60:63], v[8:11]
    ds_read_b128 v[200:203], v222 offset:1024
    v_mfma_f32_16x16x32_bf16 v[86:89], v[72:75], v[72:75], 0
    buffer_load_dwordx4 v[188:191], v1, s[4:7], s41 offen offset:0 sc1
    v_mfma_f32_16x16x32_bf16 v[82:85], v[90:93], v[72:75], 0
    v_mfma_f32_16x16x32_bf16 v[86:89], v[76:79], v[76:79], v[86:89]
    v_mfma_f32_16x16x32_bf16 v[82:85], v[90:93], v[76:79], v[82:85]
    s_waitcnt lgkmcnt(2)
    v_mfma_f32_16x16x32_bf16 v[12:15], a[84:87], v[60:63], v[12:15]
    buffer_store_dwordx4 v[196:199], v208, s[24:27], s54 offen sc1
    s_waitcnt lgkmcnt(0)
    v_mfma_f32_16x16x32_bf16 v[12:15], a[68:71], v[56:59], v[12:15]
    v_mfma_f32_16x16x32_bf16 v[16:19], a[72:75], v[56:59], v[16:19]
    ds_read_b128 v[44:47], v2 offset:9216
    v_mfma_f32_16x16x32_bf16 v[16:19], a[88:91], v[60:63], v[16:19]
    v_mfma_f32_16x16x32_bf16 v[20:23], a[92:95], v[60:63], v[20:23]
    buffer_store_dwordx4 v[200:203], v209, s[24:27], s54 offen sc1
    v_cndmask_b32 v86, v86, v87, s[44:45]
    v_mfma_f32_16x16x32_bf16 v[20:23], a[76:79], v[56:59], v[20:23]
    v_cndmask_b32 v88, v88, v89, s[44:45]
    v_cndmask_b32 v83, v86, v88, s[46:47]
    v_mfma_f32_16x16x32_bf16 v[20:23], a[108:111], v[64:67], v[20:23]
    ds_read_b128 v[48:51], v2 offset:10240
    s_waitcnt vmcnt(3)
    v_mfma_f32_16x16x32_bf16 v[20:23], a[124:127], v[68:71], v[20:23]
    buffer_store_dwordx2 v[82:83], v7, s[12:15], s36 offen offset:0 sc1
    v_cmp_gt_i32 vcc, s32, v5
    v_mfma_f32_16x16x32_bf16 v[16:19], a[120:123], v[68:71], v[16:19]
    s_mov_b32 s22, s14
    s_add_u32 s36, s36, 34816
    s_sub_u32 s42, s42, 32768
    v_mfma_f32_16x16x32_bf16 v[16:19], a[104:107], v[64:67], v[16:19]
    s_and_b64 vcc, vcc, s[18:19]
    s_cbranch_scc1 Lred_v13
    v_mfma_f32_16x16x32_bf16 v[12:15], a[100:103], v[64:67], v[12:15]
    ds_read_b128 v[52:55], v2 offset:11264
    s_add_u32 s16, s16, 8192
    v_mfma_f32_16x16x32_bf16 v[12:15], a[116:119], v[68:71], v[12:15]
    buffer_load_dword v5, v4, s[4:7], s16 offen sc1
    v_mfma_f32_16x16x32_bf16 v[8:11], a[112:115], v[68:71], v[8:11]
    s_cmp_lt_i32 s31, 31
    s_cselect_b32 s14, s6, 0
    s_cselect_b32 s54, s36, s42
    v_mfma_f32_16x16x32_bf16 v[8:11], a[96:99], v[64:67], v[8:11]
    s_waitcnt lgkmcnt(2)
    v_mfma_f32_16x16x32_bf16 v[8:11], a[128:131], v[40:43], v[8:11]
    ds_read_b128 v[56:59], v2 offset:12288
    v_mfma_f32_16x16x32_bf16 v[8:11], a[144:147], v[44:47], v[8:11]
    buffer_load_dwordx4 v[116:119], v1, s[4:7], s40 offen offset:0 sc1
    v_mfma_f32_16x16x32_bf16 v[12:15], a[148:151], v[44:47], v[12:15]
    s_cmp_lt_i32 s31, 31
    s_cselect_b64 s[24:25], s[4:5], s[80:81]
    s_cselect_b32 s26, s6, 0x400000
    v_mfma_f32_16x16x32_bf16 v[12:15], a[132:135], v[40:43], v[12:15]
    s_cmp_lt_i32 s31, 31
    s_cselect_b64 s[48:49], 0, -1
    v_cndmask_b32 v204, v210, v216, s[48:49]
    v_mfma_f32_16x16x32_bf16 v[16:19], a[136:139], v[40:43], v[16:19]
    ds_read_b128 v[60:63], v2 offset:13312
    v_cndmask_b32 v205, v211, v217, s[48:49]
    v_mfma_f32_16x16x32_bf16 v[16:19], a[152:155], v[44:47], v[16:19]
    buffer_load_dwordx4 v[120:123], v1, s[4:7], s40 offen offset:1024 sc1
    v_mfma_f32_16x16x32_bf16 v[20:23], a[156:159], v[44:47], v[20:23]
    s_add_u32 s37, s40, 32768
    v_cndmask_b32 v206, v212, v218, s[48:49]
    v_cndmask_b32 v207, v213, v219, s[48:49]
    v_mfma_f32_16x16x32_bf16 v[20:23], a[140:143], v[40:43], v[20:23]
    s_waitcnt lgkmcnt(2)
    v_cndmask_b32 v208, v214, v220, s[48:49]
    v_cndmask_b32 v209, v215, v221, s[48:49]
    v_mfma_f32_16x16x32_bf16 v[20:23], a[172:175], v[48:51], v[20:23]
    ds_read_b128 v[64:67], v2 offset:14336
    s_add_u32 s35, s35, 36864
    v_mfma_f32_16x16x32_bf16 v[20:23], a[188:191], v[52:55], v[20:23]
    buffer_load_dwordx4 v[124:127], v1, s[4:7], s37 offen offset:0 sc1
    v_mfma_f32_16x16x32_bf16 v[16:19], a[184:187], v[52:55], v[16:19]
    s_cmp_eq_u32 s35, 147456
    s_cselect_b32 s35, 0, s35
    v_mfma_f32_16x16x32_bf16 v[16:19], a[168:171], v[48:51], v[16:19]
    v_mfma_f32_16x16x32_bf16 v[12:15], a[164:167], v[48:51], v[12:15]
    ds_read_b128 v[68:71], v2 offset:15360
    v_mfma_f32_16x16x32_bf16 v[12:15], a[180:183], v[52:55], v[12:15]
    buffer_load_dwordx4 v[128:131], v1, s[4:7], s37 offen offset:1024 sc1
    v_mfma_f32_16x16x32_bf16 v[8:11], a[176:179], v[52:55], v[8:11]
    s_add_u32 s37, s40, 65536
    v_mfma_f32_16x16x32_bf16 v[8:11], a[160:163], v[48:51], v[8:11]
    s_waitcnt lgkmcnt(2)
    v_mfma_f32_16x16x32_bf16 v[8:11], a[192:195], v[56:59], v[8:11]
    v_mfma_f32_16x16x32_bf16 v[8:11], a[208:211], v[60:63], v[8:11]
    buffer_load_dwordx4 v[132:135], v1, s[4:7], s37 offen offset:0 sc1
    v_mfma_f32_16x16x32_bf16 v[12:15], a[212:215], v[60:63], v[12:15]
    v_mfma_f32_16x16x32_bf16 v[12:15], a[196:199], v[56:59], v[12:15]
    v_mfma_f32_16x16x32_bf16 v[16:19], a[200:203], v[56:59], v[16:19]
    v_mfma_f32_16x16x32_bf16 v[16:19], a[216:219], v[60:63], v[16:19]
    buffer_load_dwordx4 v[136:139], v1, s[4:7], s37 offen offset:1024 sc1
    v_mfma_f32_16x16x32_bf16 v[20:23], a[220:223], v[60:63], v[20:23]
    s_add_u32 s37, s40, 98304
    v_mfma_f32_16x16x32_bf16 v[20:23], a[204:207], v[56:59], v[20:23]
    s_waitcnt lgkmcnt(0)
    v_mfma_f32_16x16x32_bf16 v[20:23], a[236:239], v[64:67], v[20:23]
    v_mfma_f32_16x16x32_bf16 v[20:23], a[252:255], v[68:71], v[20:23]
    buffer_load_dwordx4 v[140:143], v1, s[4:7], s37 offen offset:0 sc1
    v_mfma_f32_16x16x32_bf16 v[16:19], a[248:251], v[68:71], v[16:19]
    v_mfma_f32_16x16x32_bf16 v[16:19], a[232:235], v[64:67], v[16:19]
    v_mfma_f32_16x16x32_bf16 v[12:15], a[228:231], v[64:67], v[12:15]
    v_mfma_f32_16x16x32_bf16 v[12:15], a[244:247], v[68:71], v[12:15]
    buffer_load_dwordx4 v[144:147], v1, s[4:7], s37 offen offset:1024 sc1
    v_mfma_f32_16x16x32_bf16 v[8:11], a[240:243], v[68:71], v[8:11]
    s_add_u32 m0, s34, 0
    v_mfma_f32_16x16x32_bf16 v[8:11], a[224:227], v[64:67], v[8:11]
    v_mfma_f32_16x16x32_bf16 v[8:11], v[96:99], v[180:183], v[8:11]
    v_mfma_f32_16x16x32_bf16 v[12:15], v[94:97], v[180:183], v[12:15]
    buffer_load_dwordx4 v1, s[8:11], s33 offen offset:0 sc1 lds
    v_mfma_f32_16x16x32_bf16 v[16:19], v[96:99], v[184:187], v[16:19]
    v_mfma_f32_16x16x32_bf16 v[20:23], v[94:97], v[184:187], v[20:23]
    buffer_load_dwordx4 v1, s[8:11], s33 offen offset:1024 sc1 lds
    buffer_load_dwordx4 v1, s[8:11], s33 offen offset:2048 sc1 lds
    buffer_load_dwordx4 v1, s[8:11], s33 offen offset:3072 sc1 lds
    s_add_u32 s32, s32, 1
    s_add_u32 s40, s40, 131072
    s_add_u32 s33, s33, 116736
    s_add_u32 s34, s34, 36864
    s_cmp_ge_u32 s34, 147456
    s_cselect_b32 s38, 147456, 0
    s_sub_u32 s34, s34, s38
    s_cmp_ge_i32 s32, 63
    s_cselect_b32 s18, 0xffff, s18
    buffer_load_dwordx4 v[192:195], v1, s[4:7], s41 offen offset:1024 sc1
    s_add_u32 s41, s41, 36864
    s_cmp_lt_i32 s31, 63
    s_cbranch_scc1 Lred_top0
    s_branch L_exit
Lred_v13:
    v_mfma_f32_16x16x32_bf16 v[12:15], a[100:103], v[64:67], v[12:15]
    ds_read_b128 v[52:55], v2 offset:11264
    v_mfma_f32_16x16x32_bf16 v[12:15], a[116:119], v[68:71], v[12:15]
    buffer_load_dword v5, v4, s[4:7], s16 offen sc1
    v_mfma_f32_16x16x32_bf16 v[8:11], a[112:115], v[68:71], v[8:11]
    s_cmp_lt_i32 s31, 31
    s_cselect_b32 s14, s6, 0
    s_cselect_b32 s54, s36, s42
    v_mfma_f32_16x16x32_bf16 v[8:11], a[96:99], v[64:67], v[8:11]
    s_waitcnt lgkmcnt(2)
    v_mfma_f32_16x16x32_bf16 v[8:11], a[128:131], v[40:43], v[8:11]
    ds_read_b128 v[56:59], v2 offset:12288
    v_mfma_f32_16x16x32_bf16 v[8:11], a[144:147], v[44:47], v[8:11]
    s_cmp_lt_i32 s31, 31
    s_cselect_b64 s[24:25], s[4:5], s[80:81]
    s_cselect_b32 s26, s6, 0x400000
    v_mfma_f32_16x16x32_bf16 v[12:15], a[148:151], v[44:47], v[12:15]
    s_cmp_lt_i32 s31, 31
    s_cselect_b64 s[48:49], 0, -1
    v_cndmask_b32 v204, v210, v216, s[48:49]
    v_mfma_f32_16x16x32_bf16 v[12:15], a[132:135], v[40:43], v[12:15]
    buffer_load_dwordx4 v[192:195], v1, s[4:7], s41 offen offset:1024 sc1
    v_mfma_f32_16x16x32_bf16 v[16:19], a[136:139], v[40:43], v[16:19]
    ds_read_b128 v[60:63], v2 offset:13312
    v_cndmask_b32 v205, v211, v217, s[48:49]
    v_mfma_f32_16x16x32_bf16 v[16:19], a[152:155], v[44:47], v[16:19]
    s_add_u32 s41, s41, 36864
    v_cndmask_b32 v206, v212, v218, s[48:49]
    v_cndmask_b32 v207, v213, v219, s[48:49]
    v_mfma_f32_16x16x32_bf16 v[20:23], a[156:159], v[44:47], v[20:23]
    v_cndmask_b32 v208, v214, v220, s[48:49]
    v_cndmask_b32 v209, v215, v221, s[48:49]
    v_mfma_f32_16x16x32_bf16 v[20:23], a[140:143], v[40:43], v[20:23]
    s_waitcnt lgkmcnt(2)
    s_add_u32 s35, s35, 36864
    v_mfma_f32_16x16x32_bf16 v[20:23], a[172:175], v[48:51], v[20:23]
    ds_read_b128 v[64:67], v2 offset:14336
    v_mfma_f32_16x16x32_bf16 v[20:23], a[188:191], v[52:55], v[20:23]
    s_cmp_eq_u32 s35, 147456
    s_cselect_b32 s35, 0, s35
    v_mfma_f32_16x16x32_bf16 v[16:19], a[184:187], v[52:55], v[16:19]
    v_mfma_f32_16x16x32_bf16 v[16:19], a[168:171], v[48:51], v[16:19]
    v_mfma_f32_16x16x32_bf16 v[12:15], a[164:167], v[48:51], v[12:15]
    ds_read_b128 v[68:71], v2 offset:15360
    v_mfma_f32_16x16x32_bf16 v[12:15], a[180:183], v[52:55], v[12:15]
    v_mfma_f32_16x16x32_bf16 v[8:11], a[176:179], v[52:55], v[8:11]
    v_mfma_f32_16x16x32_bf16 v[8:11], a[160:163], v[48:51], v[8:11]
    s_waitcnt vmcnt(1) lgkmcnt(2)
    v_cmp_gt_i32 vcc, s32, v5
    v_mfma_f32_16x16x32_bf16 v[8:11], a[192:195], v[56:59], v[8:11]
    v_mfma_f32_16x16x32_bf16 v[8:11], a[208:211], v[60:63], v[8:11]
    s_and_b64 vcc, vcc, s[18:19]
    s_cbranch_scc1 Lred_v14
    v_mfma_f32_16x16x32_bf16 v[12:15], a[212:215], v[60:63], v[12:15]
    s_add_u32 s16, s16, 8192
    v_mfma_f32_16x16x32_bf16 v[12:15], a[196:199], v[56:59], v[12:15]
    buffer_load_dword v5, v4, s[4:7], s16 offen sc1
    v_mfma_f32_16x16x32_bf16 v[16:19], a[200:203], v[56:59], v[16:19]
    v_mfma_f32_16x16x32_bf16 v[16:19], a[216:219], v[60:63], v[16:19]
    v_mfma_f32_16x16x32_bf16 v[20:23], a[220:223], v[60:63], v[20:23]
    v_mfma_f32_16x16x32_bf16 v[20:23], a[204:207], v[56:59], v[20:23]
    s_waitcnt lgkmcnt(0)
    buffer_load_dwordx4 v[116:119], v1, s[4:7], s40 offen offset:0 sc1
    v_mfma_f32_16x16x32_bf16 v[20:23], a[236:239], v[64:67], v[20:23]
    v_mfma_f32_16x16x32_bf16 v[20:23], a[252:255], v[68:71], v[20:23]
    v_mfma_f32_16x16x32_bf16 v[16:19], a[248:251], v[68:71], v[16:19]
    v_mfma_f32_16x16x32_bf16 v[16:19], a[232:235], v[64:67], v[16:19]
    buffer_load_dwordx4 v[120:123], v1, s[4:7], s40 offen offset:1024 sc1
    v_mfma_f32_16x16x32_bf16 v[12:15], a[228:231], v[64:67], v[12:15]
    s_add_u32 s37, s40, 32768
    v_mfma_f32_16x16x32_bf16 v[12:15], a[244:247], v[68:71], v[12:15]
    v_mfma_f32_16x16x32_bf16 v[8:11], a[240:243], v[68:71], v[8:11]
    v_mfma_f32_16x16x32_bf16 v[8:11], a[224:227], v[64:67], v[8:11]
    buffer_load_dwordx4 v[124:127], v1, s[4:7], s37 offen offset:0 sc1
    v_mfma_f32_16x16x32_bf16 v[8:11], v[96:99], v[180:183], v[8:11]
    v_mfma_f32_16x16x32_bf16 v[12:15], v[94:97], v[180:183], v[12:15]
    v_mfma_f32_16x16x32_bf16 v[16:19], v[96:99], v[184:187], v[16:19]
    v_mfma_f32_16x16x32_bf16 v[20:23], v[94:97], v[184:187], v[20:23]
    buffer_load_dwordx4 v[128:131], v1, s[4:7], s37 offen offset:1024 sc1
    s_add_u32 s37, s40, 65536
    buffer_load_dwordx4 v[132:135], v1, s[4:7], s37 offen offset:0 sc1
    buffer_load_dwordx4 v[136:139], v1, s[4:7], s37 offen offset:1024 sc1
    s_add_u32 s37, s40, 98304
    buffer_load_dwordx4 v[140:143], v1, s[4:7], s37 offen offset:0 sc1
    buffer_load_dwordx4 v[144:147], v1, s[4:7], s37 offen offset:1024 sc1
    s_add_u32 m0, s34, 0
    s_nop 0
    buffer_load_dwordx4 v1, s[8:11], s33 offen offset:0 sc1 lds
    buffer_load_dwordx4 v1, s[8:11], s33 offen offset:1024 sc1 lds
    buffer_load_dwordx4 v1, s[8:11], s33 offen offset:2048 sc1 lds
    buffer_load_dwordx4 v1, s[8:11], s33 offen offset:3072 sc1 lds
    s_add_u32 s32, s32, 1
    s_add_u32 s40, s40, 131072
    s_add_u32 s33, s33, 116736
    s_add_u32 s34, s34, 36864
    s_cmp_ge_u32 s34, 147456
    s_cselect_b32 s38, 147456, 0
    s_sub_u32 s34, s34, s38
    s_cmp_ge_i32 s32, 63
    s_cselect_b32 s18, 0xffff, s18
    s_cmp_lt_i32 s31, 63
    s_cbranch_scc1 Lred_top0
    s_branch L_exit
Lred_v14:
    v_mfma_f32_16x16x32_bf16 v[12:15], a[212:215], v[60:63], v[12:15]
    buffer_load_dword v5, v4, s[4:7], s16 offen sc1
    v_mfma_f32_16x16x32_bf16 v[12:15], a[196:199], v[56:59], v[12:15]
    v_mfma_f32_16x16x32_bf16 v[16:19], a[200:203], v[56:59], v[16:19]
    v_mfma_f32_16x16x32_bf16 v[16:19], a[216:219], v[60:63], v[16:19]
    v_mfma_f32_16x16x32_bf16 v[20:23], a[220:223], v[60:63], v[20:23]
    v_mfma_f32_16x16x32_bf16 v[20:23], a[204:207], v[56:59], v[20:23]
    s_waitcnt lgkmcnt(0)
    v_mfma_f32_16x16x32_bf16 v[20:23], a[236:239], v[64:67], v[20:23]
    v_mfma_f32_16x16x32_bf16 v[20:23], a[252:255], v[68:71], v[20:23]
    v_mfma_f32_16x16x32_bf16 v[16:19], a[248:251], v[68:71], v[16:19]
    v_mfma_f32_16x16x32_bf16 v[16:19], a[232:235], v[64:67], v[16:19]
    v_mfma_f32_16x16x32_bf16 v[12:15], a[228:231], v[64:67], v[12:15]
    v_mfma_f32_16x16x32_bf16 v[12:15], a[244:247], v[68:71], v[12:15]
    v_mfma_f32_16x16x32_bf16 v[8:11], a[240:243], v[68:71], v[8:11]
    v_mfma_f32_16x16x32_bf16 v[8:11], a[224:227], v[64:67], v[8:11]
    v_mfma_f32_16x16x32_bf16 v[8:11], v[96:99], v[180:183], v[8:11]
    v_mfma_f32_16x16x32_bf16 v[12:15], v[94:97], v[180:183], v[12:15]
    v_mfma_f32_16x16x32_bf16 v[16:19], v[96:99], v[184:187], v[16:19]
    v_mfma_f32_16x16x32_bf16 v[20:23], v[94:97], v[184:187], v[20:23]
    s_waitcnt vmcnt(0)
    v_cmp_gt_i32 vcc, s32, v5
    s_sub_u32 s43, s43, 1
    s_cmp_lt_i32 s43, 0
    s_cbranch_scc1 Lred_rdy1x
    s_and_b64 vcc, vcc, s[18:19]
    s_cbranch_scc0 Lred_rdy1x
Lred_spin1x:
    buffer_load_dword v5, v4, s[4:7], s16 offen sc1
    s_waitcnt vmcnt(0)
    v_cmp_gt_i32 vcc, s32, v5
    s_sub_u32 s43, s43, 1
    s_cmp_lt_i32 s43, 0
    s_cbranch_scc1 Lred_rdy1x
    s_and_b64 vcc, vcc, s[18:19]
    s_cbranch_scc0 Lred_rdy1x
    s_sleep 8
    s_branch Lred_spin1x
Lred_rdy1x:
    s_add_u32 s16, s16, 8192
    buffer_load_dword v5, v4, s[4:7], s16 offen sc1
    buffer_load_dwordx4 v[116:119], v1, s[4:7], s40 offen offset:0 sc1
    buffer_load_dwordx4 v[120:123], v1, s[4:7], s40 offen offset:1024 sc1
    s_add_u32 s37, s40, 32768
    buffer_load_dwordx4 v[124:127], v1, s[4:7], s37 offen offset:0 sc1
    buffer_load_dwordx4 v[128:131], v1, s[4:7], s37 offen offset:1024 sc1
    s_add_u32 s37, s40, 65536
    buffer_load_dwordx4 v[132:135], v1, s[4:7], s37 offen offset:0 sc1
    buffer_load_dwordx4 v[136:139], v1, s[4:7], s37 offen offset:1024 sc1
    s_add_u32 s37, s40, 98304
    buffer_load_dwordx4 v[140:143], v1, s[4:7], s37 offen offset:0 sc1
    buffer_load_dwordx4 v[144:147], v1, s[4:7], s37 offen offset:1024 sc1
    s_add_u32 m0, s34, 0
    s_nop 0
    buffer_load_dwordx4 v1, s[8:11], s33 offen offset:0 sc1 lds
    buffer_load_dwordx4 v1, s[8:11], s33 offen offset:1024 sc1 lds
    buffer_load_dwordx4 v1, s[8:11], s33 offen offset:2048 sc1 lds
    buffer_load_dwordx4 v1, s[8:11], s33 offen offset:3072 sc1 lds
    s_add_u32 s32, s32, 1
    s_add_u32 s40, s40, 131072
    s_add_u32 s33, s33, 116736
    s_add_u32 s34, s34, 36864
    s_cmp_ge_u32 s34, 147456
    s_cselect_b32 s38, 147456, 0
    s_sub_u32 s34, s34, s38
    s_cmp_ge_i32 s32, 63
    s_cselect_b32 s18, 0xffff, s18
    s_branch Lred_top0
Lqkv_start:
    s_mov_b32 s12, s66
    s_mov_b32 s13, s67
    s_mov_b32 s14, 0x600000
    s_mov_b32 s15, 0x00020000
    v_lshrrev_b32 v24, 3, v0
    v_mul_u32_u24 v24, 6144, v24
    v_bfe_u32 v25, v0, 4, 2
    v_lshlrev_b32 v25, 1, v25
    v_and_b32 v26, 7, v0
    v_xor_b32 v25, v25, v26
    v_lshl_add_u32 v40, v25, 4, v24
    v_add_u32 v41, 48128, v40
    s_mul_i32 s86, s29, 0x80
    s_mul_i32 s37, s30, 98304
    s_add_u32 s86, s86, s37
    s_lshl_b32 s87, s30, 11
    s_add_u32 m0, s87, 40960
    s_add_u32 s37, s86, 0
    buffer_load_dwordx4 v40, s[12:15], s37 offen offset:0 lds
    buffer_load_dwordx4 v41, s[12:15], s37 offen offset:1024 lds
    s_add_u32 m0, s87, 49152
    s_add_u32 s37, s86, 2048
    buffer_load_dwordx4 v40, s[12:15], s37 offen offset:0 lds
    buffer_load_dwordx4 v41, s[12:15], s37 offen offset:1024 lds
    s_add_u32 m0, s87, 57344
    s_add_u32 s37, s86, 4096
    buffer_load_dwordx4 v40, s[12:15], s37 offen offset:0 lds
    buffer_load_dwordx4 v41, s[12:15], s37 offen offset:1024 lds
    s_add_u32 m0, s87, 65536
    s_add_u32 s37, s86, 393216
    buffer_load_dwordx4 v40, s[12:15], s37 offen offset:0 lds
    buffer_load_dwordx4 v41, s[12:15], s37 offen offset:1024 lds
    s_add_u32 m0, s87, 73728
    s_add_u32 s37, s86, 395264
    buffer_load_dwordx4 v40, s[12:15], s37 offen offset:0 lds
    buffer_load_dwordx4 v41, s[12:15], s37 offen offset:1024 lds
    s_add_u32 m0, s87, 81920
    s_add_u32 s37, s86, 397312
    buffer_load_dwordx4 v40, s[12:15], s37 offen offset:0 lds
    buffer_load_dwordx4 v41, s[12:15], s37 offen offset:1024 lds
    s_add_u32 m0, s87, 90112
    s_add_u32 s37, s86, 786432
    buffer_load_dwordx4 v40, s[12:15], s37 offen offset:0 lds
    buffer_load_dwordx4 v41, s[12:15], s37 offen offset:1024 lds
    s_add_u32 m0, s87, 98304
    s_add_u32 s37, s86, 788480
    buffer_load_dwordx4 v40, s[12:15], s37 offen offset:0 lds
    buffer_load_dwordx4 v41, s[12:15], s37 offen offset:1024 lds
    s_add_u32 m0, s87, 106496
    s_add_u32 s37, s86, 790528
    buffer_load_dwordx4 v40, s[12:15], s37 offen offset:0 lds
    buffer_load_dwordx4 v41, s[12:15], s37 offen offset:1024 lds
    s_add_u32 m0, s87, 114688
    s_add_u32 s37, s86, 1179648
    buffer_load_dwordx4 v40, s[12:15], s37 offen offset:0 lds
    buffer_load_dwordx4 v41, s[12:15], s37 offen offset:1024 lds
    s_add_u32 m0, s87, 122880
    s_add_u32 s37, s86, 1181696
    buffer_load_dwordx4 v40, s[12:15], s37 offen offset:0 lds
    buffer_load_dwordx4 v41, s[12:15], s37 offen offset:1024 lds
    s_add_u32 m0, s87, 131072
    s_add_u32 s37, s86, 1183744
    buffer_load_dwordx4 v40, s[12:15], s37 offen offset:0 lds
    buffer_load_dwordx4 v41, s[12:15], s37 offen offset:1024 lds
    v_bfe_u32 v24, v0, 3, 2
    v_and_b32 v25, 3, v0
    v_lshlrev_b32 v25, 3, v25
    v_lshrrev_b32 v26, 2, v0
    v_lshl_add_u32 v26, v26, 7, v25
    v_lshrrev_b32 v27, 5, v0
    v_lshl_add_u32 v27, v27, 10, v26
    s_mov_b32 s37, 0
    s_mov_b32 s38, s30
    s_lshl_b32 s37, s37, 13
    v_xor_b32 v28, s38, v24
    v_lshl_add_u32 v28, v28, 5, s37
    v_add_u32 v42, v28, v26
    v_add_u32 v46, v28, v27
    s_mov_b32 s37, 1
    s_mov_b32 s38, s30
    s_lshl_b32 s37, s37, 13
    v_xor_b32 v28, s38, v24
    v_lshl_add_u32 v28, v28, 5, s37
    v_add_u32 v43, v28, v26
    v_add_u32 v47, v28, v27
    s_mov_b32 s37, 2
    s_mov_b32 s38, s30
    s_lshl_b32 s37, s37, 13
    v_xor_b32 v28, s38, v24
    v_lshl_add_u32 v28, v28, 5, s37
    v_add_u32 v44, v28, v26
    v_add_u32 v48, v28, v27
    v_mov_b32 v28, 0x3f803f80
    v_mov_b32 v29, 0x3f803f80
    v_mov_b32 v30, 0x3f803f80
    v_mov_b32 v31, 0x3f803f80
    s_mul_i32 s37, s28, 0x80000
    s_add_u32 s37, s37, 0x6001e00
    v_min_u32 v4, 15, v0
    v_lshl_add_u32 v4, v4, 5, s37
    s_mul_i32 s37, s28, 0x80000
    s_mul_i32 s53, s29, 0x80
    s_add_u32 s37, s37, s53
    s_mul_i32 s53, s30, 0x20
    s_add_u32 s37, s37, s53
    s_add_u32 s37, s37, 0x5f80000
    v_mov_b32 v8, s37
    s_cmp_eq_u32 s28, 0
    s_cselect_b32 s37, 64, 16
    v_cmp_le_u32 vcc, s37, v0
    s_nop 1
    v_cndmask_b32 v4, v4, v8, vcc
    s_mul_i32 s33, s28, 0x220000
    s_lshr_b32 s38, s30, 1
    s_mul_i32 s36, s28, 0x200000
    s_mul_i32 s53, s29, 0x800
    s_add_u32 s36, s36, s53
    s_mul_i32 s53, s38, 0x400
    s_add_u32 s36, s36, s53
    s_add_u32 s36, s36, 0x9f0000
    s_and_b32 s38, s30, 1
    v_lshrrev_b32 v8, 5, v0
    v_cmp_eq_u32 vcc, s38, v8
    v_add_u32 v8, 0, v1
    v_mov_b32 v7, 0x40000000
    v_cndmask_b32 v7, v7, v8, vcc
    s_mul_i32 s40, s28, 0x10000
    s_mul_i32 s53, s29, 0x1000
    s_add_u32 s40, s40, s53
    s_mul_i32 s53, s30, 0x400
    s_add_u32 s40, s40, s53
    s_add_u32 s40, s40, 0x1c00000
    s_sub_u32 s41, s40, 327680
    s_mov_b32 s24, s84
    s_mov_b32 s25, s85
    s_mov_b32 s26, 0x6200000
    s_mov_b32 s27, 0x00020000
    s_cmp_eq_u32 s28, 0
    s_cselect_b32 s26, 0, s26
    s_cselect_b32 s42, 0xf149f2ca, 0
    v_mov_b32 v86, 0
    v_mov_b32 v87, 0
    v_mov_b32 v90, 0
    v_mov_b32 v91, 0
    s_lshl_b32 s37, s30, 9
    s_add_u32 s38, s37, 147456
    v_lshl_add_u32 v36, v0, 3, s38
    v_xor_b32 v37, 512, v36
    v_add_u32 v39, 4096, v36
    s_add_u32 s38, s37, 151552
    v_and_b32 v8, 15, v0
    v_lshl_add_u32 v8, v8, 5, s38
    v_lshrrev_b32 v9, 4, v0
    v_lshl_add_u32 v38, v9, 3, v8
    s_mov_b32 s44, 0xaaaaaaaa
    s_mov_b32 s45, 0xaaaaaaaa
    s_mov_b32 s48, 0xfff0ffff
    s_mov_b32 s49, 0xf000ff00
    s_mov_b32 s50, 0xffc0fffc
    s_mov_b32 s51, 0xc000fc00
    s_mov_b32 s52, 0x3e8293ee
    v_mov_b32 v10, 0x0c0c0c0c
    v_mov_b32 v8, 0xc0c0100
    v_mov_b32 v9, 0x1000c0c
    v_cndmask_b32 v8, v8, v9, s[44:45]
    v_cndmask_b32 v102, v8, v10, s[48:49]
    v_cndmask_b32 v104, v10, v8, s[48:49]
    v_mov_b32 v8, 0xc0c0302
    v_mov_b32 v9, 0x3020c0c
    v_cndmask_b32 v8, v8, v9, s[44:45]
    v_cndmask_b32 v103, v8, v10, s[50:51]
    v_cndmask_b32 v105, v10, v8, s[50:51]
    s_mov_b32 s31, -1
    s_mov_b32 s35, 0
    s_mov_b32 s16, 0
    v_mov_b32 v5, 0
    s_mul_i32 s17, s28, 0x80000
    s_mul_i32 s53, s29, 0x80
    s_add_u32 s17, s17, s53
    s_mul_i32 s53, s30, 0x20
    s_add_u32 s17, s17, s53
    s_add_u32 s17, s17, 0x5ffa000
    v_cmp_eq_u32 vcc, 0, v0
    v_mov_b32 v21, 0x40000000
    s_nop 0
    v_cndmask_b32 v21, v21, v0, vcc
    v_mov_b32 v2, v1
    s_mul_i32 s34, s30, 9216
    s_min_u32 s34, s34, 25600
    s_add_u32 s33, s33, s34
    v_lshlrev_b32 v20, 3, v0
    s_mov_b64 s[18:19], 0x1ffff
    v_mov_b32 v8, 0x40000000
    v_cndmask_b32 v4, v8, v4, s[18:19]
    v_add_u32 v12, 40960, v42
    v_add_u32 v13, 40960, v43
    v_add_u32 v14, 40960, v44
    s_waitcnt vmcnt(18) lgkmcnt(0)
    s_barrier
    s_add_u32 m0, s87, 139264
    s_add_u32 s37, s86, 1572864
    buffer_load_dwordx4 v40, s[12:15], s37 offen offset:0 lds
    ds_read_b64_tr_b16 a[0:1], v12 offset:0
    ds_read_b64_tr_b16 a[2:3], v12 offset:2048
    ds_read_b64_tr_b16 a[4:5], v13 offset:0
    buffer_load_dwordx4 v41, s[12:15], s37 offen offset:1024 lds
    ds_read_b64_tr_b16 a[6:7], v13 offset:2048
    ds_read_b64_tr_b16 a[8:9], v14 offset:0
    ds_read_b64_tr_b16 a[10:11], v14 offset:2048
    s_add_u32 m0, s87, 147456
    s_add_u32 s37, s86, 1574912
    buffer_load_dwordx4 v40, s[12:15], s37 offen offset:0 lds
    ds_read_b64_tr_b16 a[12:13], v12 offset:4096
    ds_read_b64_tr_b16 a[14:15], v12 offset:6144
    ds_read_b64_tr_b16 a[16:17], v13 offset:4096
    buffer_load_dwordx4 v41, s[12:15], s37 offen offset:1024 lds
    ds_read_b64_tr_b16 a[18:19], v13 offset:6144
    ds_read_b64_tr_b16 a[20:21], v14 offset:4096
    ds_read_b64_tr_b16 a[22:23], v14 offset:6144
    s_add_u32 m0, s87, 155648
    s_add_u32 s37, s86, 1576960
    buffer_load_dwordx4 v40, s[12:15], s37 offen offset:0 lds
    v_add_u32 v16, 65536, v42
    v_add_u32 v17, 65536, v43
    v_add_u32 v18, 65536, v44
    buffer_load_dwordx4 v41, s[12:15], s37 offen offset:1024 lds
    s_waitcnt vmcnt(18) lgkmcnt(0)
    s_barrier
    s_add_u32 m0, s87, 40960
    s_add_u32 s37, s86, 1966080
    buffer_load_dwordx4 v40, s[12:15], s37 offen offset:0 lds
    ds_read_b64_tr_b16 a[24:25], v16 offset:0
    ds_read_b64_tr_b16 a[26:27], v16 offset:2048
    ds_read_b64_tr_b16 a[28:29], v17 offset:0
    ds_read_b64_tr_b16 a[30:31], v17 offset:2048
    buffer_load_dwordx4 v41, s[12:15], s37 offen offset:1024 lds
    ds_read_b64_tr_b16 a[32:33], v18 offset:0
    ds_read_b64_tr_b16 a[34:35], v18 offset:2048
    ds_read_b64_tr_b16 a[36:37], v16 offset:4096
    ds_read_b64_tr_b16 a[38:39], v16 offset:6144
    s_add_u32 m0, s87, 49152
    s_add_u32 s37, s86, 1968128
    buffer_load_dwordx4 v40, s[12:15], s37 offen offset:0 lds
    ds_read_b64_tr_b16 a[40:41], v17 offset:4096
    ds_read_b64_tr_b16 a[42:43], v17 offset:6144
    ds_read_b64_tr_b16 a[44:45], v18 offset:4096
    ds_read_b64_tr_b16 a[46:47], v18 offset:6144
    buffer_load_dwordx4 v41, s[12:15], s37 offen offset:1024 lds
    v_mfma_f32_16x16x32_bf16 v[56:59], a[0:3], v[28:31], 0
    v_mfma_f32_16x16x32_bf16 v[60:63], a[4:7], v[28:31], 0
    v_mfma_f32_16x16x32_bf16 v[64:67], a[8:11], v[28:31], 0
    v_mfma_f32_16x16x32_bf16 v[56:59], a[12:15], v[28:31], v[56:59]
    s_add_u32 m0, s87, 57344
    s_add_u32 s37, s86, 1970176
    buffer_load_dwordx4 v40, s[12:15], s37 offen offset:0 lds
    v_mfma_f32_16x16x32_bf16 v[60:63], a[16:19], v[28:31], v[60:63]
    v_mfma_f32_16x16x32_bf16 v[64:67], a[20:23], v[28:31], v[64:67]
    v_add_u32 v12, 90112, v42
    v_add_u32 v13, 90112, v43
    buffer_load_dwordx4 v41, s[12:15], s37 offen offset:1024 lds
    v_add_u32 v14, 90112, v44
    s_waitcnt vmcnt(18) lgkmcnt(0)
    s_barrier
    s_add_u32 m0, s87, 65536
    s_add_u32 s37, s86, 2359296
    buffer_load_dwordx4 v40, s[12:15], s37 offen offset:0 lds
    ds_read_b64_tr_b16 a[48:49], v12 offset:0
    ds_read_b64_tr_b16 a[50:51], v12 offset:2048
    ds_read_b64_tr_b16 a[52:53], v13 offset:0
    ds_read_b64_tr_b16 a[54:55], v13 offset:2048
    buffer_load_dwordx4 v41, s[12:15], s37 offen offset:1024 lds
    ds_read_b64_tr_b16 a[56:57], v14 offset:0
    ds_read_b64_tr_b16 a[58:59], v14 offset:2048
    ds_read_b64_tr_b16 a[60:61], v12 offset:4096
    ds_read_b64_tr_b16 a[62:63], v12 offset:6144
    s_add_u32 m0, s87, 73728
    s_add_u32 s37, s86, 2361344
    buffer_load_dwordx4 v40, s[12:15], s37 offen offset:0 lds
    ds_read_b64_tr_b16 a[64:65], v13 offset:4096
    ds_read_b64_tr_b16 a[66:67], v13 offset:6144
    ds_read_b64_tr_b16 a[68:69], v14 offset:4096
    ds_read_b64_tr_b16 a[70:71], v14 offset:6144
    buffer_load_dwordx4 v41, s[12:15], s37 offen offset:1024 lds
    v_mfma_f32_16x16x32_bf16 v[56:59], a[24:27], v[28:31], v[56:59]
    v_mfma_f32_16x16x32_bf16 v[60:63], a[28:31], v[28:31], v[60:63]
    v_mfma_f32_16x16x32_bf16 v[64:67], a[32:35], v[28:31], v[64:67]
    v_mfma_f32_16x16x32_bf16 v[56:59], a[36:39], v[28:31], v[56:59]
    s_add_u32 m0, s87, 81920
    s_add_u32 s37, s86, 2363392
    buffer_load_dwordx4 v40, s[12:15], s37 offen offset:0 lds
    v_mfma_f32_16x16x32_bf16 v[60:63], a[40:43], v[28:31], v[60:63]
    v_mfma_f32_16x16x32_bf16 v[64:67], a[44:47], v[28:31], v[64:67]
    v_add_u32 v16, 114688, v42
    v_add_u32 v17, 114688, v43
    buffer_load_dwordx4 v41, s[12:15], s37 offen offset:1024 lds
    v_add_u32 v18, 114688, v44
    s_waitcnt vmcnt(18) lgkmcnt(0)
    s_barrier
    s_add_u32 m0, s87, 90112
    s_add_u32 s37, s86, 2752512
    buffer_load_dwordx4 v40, s[12:15], s37 offen offset:0 lds
    ds_read_b64_tr_b16 a[72:73], v16 offset:0
    ds_read_b64_tr_b16 a[74:75], v16 offset:2048
    ds_read_b64_tr_b16 a[76:77], v17 offset:0
    ds_read_b64_tr_b16 a[78:79], v17 offset:2048
    buffer_load_dwordx4 v41, s[12:15], s37 offen offset:1024 lds
    ds_read_b64_tr_b16 a[80:81], v18 offset:0
    ds_read_b64_tr_b16 a[82:83], v18 offset:2048
    ds_read_b64_tr_b16 a[84:85], v16 offset:4096
    ds_read_b64_tr_b16 a[86:87], v16 offset:6144
    s_add_u32 m0, s87, 98304
    s_add_u32 s37, s86, 2754560
    buffer_load_dwordx4 v40, s[12:15], s37 offen offset:0 lds
    ds_read_b64_tr_b16 a[88:89], v17 offset:4096
    ds_read_b64_tr_b16 a[90:91], v17 offset:6144
    ds_read_b64_tr_b16 a[92:93], v18 offset:4096
    ds_read_b64_tr_b16 a[94:95], v18 offset:6144
    buffer_load_dwordx4 v41, s[12:15], s37 offen offset:1024 lds
    v_mfma_f32_16x16x32_bf16 v[56:59], a[48:51], v[28:31], v[56:59]
    v_mfma_f32_16x16x32_bf16 v[60:63], a[52:55], v[28:31], v[60:63]
    v_mfma_f32_16x16x32_bf16 v[64:67], a[56:59], v[28:31], v[64:67]
    v_mfma_f32_16x16x32_bf16 v[56:59], a[60:63], v[28:31], v[56:59]
    s_add_u32 m0, s87, 106496
    s_add_u32 s37, s86, 2756608
    buffer_load_dwordx4 v40, s[12:15], s37 offen offset:0 lds
    v_mfma_f32_16x16x32_bf16 v[60:63], a[64:67], v[28:31], v[60:63]
    v_mfma_f32_16x16x32_bf16 v[64:67], a[68:71], v[28:31], v[64:67]
    v_add_u32 v12, 139264, v42
    v_add_u32 v13, 139264, v43
    buffer_load_dwordx4 v41, s[12:15], s37 offen offset:1024 lds
    v_add_u32 v14, 139264, v44
    s_waitcnt vmcnt(18) lgkmcnt(0)
    s_barrier
    s_add_u32 m0, s87, 114688
    s_add_u32 s37, s86, 3145728
    buffer_load_dwordx4 v40, s[12:15], s37 offen offset:0 lds
    ds_read_b64_tr_b16 a[96:97], v12 offset:0
    ds_read_b64_tr_b16 a[98:99], v12 offset:2048
    ds_read_b64_tr_b16 a[100:101], v13 offset:0
    ds_read_b64_tr_b16 a[102:103], v13 offset:2048
    buffer_load_dwordx4 v41, s[12:15], s37 offen offset:1024 lds
    ds_read_b64_tr_b16 a[104:105], v14 offset:0
    ds_read_b64_tr_b16 a[106:107], v14 offset:2048
    ds_read_b64_tr_b16 a[108:109], v12 offset:4096
    ds_read_b64_tr_b16 a[110:111], v12 offset:6144
    s_add_u32 m0, s87, 122880
    s_add_u32 s37, s86, 3147776
    buffer_load_dwordx4 v40, s[12:15], s37 offen offset:0 lds
    ds_read_b64_tr_b16 a[112:113], v13 offset:4096
    ds_read_b64_tr_b16 a[114:115], v13 offset:6144
    ds_read_b64_tr_b16 a[116:117], v14 offset:4096
    ds_read_b64_tr_b16 a[118:119], v14 offset:6144
    buffer_load_dwordx4 v41, s[12:15], s37 offen offset:1024 lds
    v_mfma_f32_16x16x32_bf16 v[56:59], a[72:75], v[28:31], v[56:59]
    v_mfma_f32_16x16x32_bf16 v[60:63], a[76:79], v[28:31], v[60:63]
    v_mfma_f32_16x16x32_bf16 v[64:67], a[80:83], v[28:31], v[64:67]
    v_mfma_f32_16x16x32_bf16 v[56:59], a[84:87], v[28:31], v[56:59]
    s_add_u32 m0, s87, 131072
    s_add_u32 s37, s86, 3149824
    buffer_load_dwordx4 v40, s[12:15], s37 offen offset:0 lds
    v_mfma_f32_16x16x32_bf16 v[60:63], a[88:91], v[28:31], v[60:63]
    v_mfma_f32_16x16x32_bf16 v[64:67], a[92:95], v[28:31], v[64:67]
    v_add_u32 v16, 40960, v42
    v_add_u32 v17, 40960, v43
    buffer_load_dwordx4 v41, s[12:15], s37 offen offset:1024 lds
    v_add_u32 v18, 40960, v44
    s_waitcnt vmcnt(18) lgkmcnt(0)
    s_barrier
    s_add_u32 m0, s87, 139264
    s_add_u32 s37, s86, 3538944
    buffer_load_dwordx4 v40, s[12:15], s37 offen offset:0 lds
    ds_read_b64_tr_b16 a[120:121], v16 offset:0
    ds_read_b64_tr_b16 a[122:123], v16 offset:2048
    ds_read_b64_tr_b16 a[124:125], v17 offset:0
    ds_read_b64_tr_b16 a[126:127], v17 offset:2048
    buffer_load_dwordx4 v41, s[12:15], s37 offen offset:1024 lds
    ds_read_b64_tr_b16 a[128:129], v18 offset:0
    ds_read_b64_tr_b16 a[130:131], v18 offset:2048
    ds_read_b64_tr_b16 a[132:133], v16 offset:4096
    ds_read_b64_tr_b16 a[134:135], v16 offset:6144
    s_add_u32 m0, s87, 147456
    s_add_u32 s37, s86, 3540992
    buffer_load_dwordx4 v40, s[12:15], s37 offen offset:0 lds
    ds_read_b64_tr_b16 a[136:137], v17 offset:4096
    ds_read_b64_tr_b16 a[138:139], v17 offset:6144
    ds_read_b64_tr_b16 a[140:141], v18 offset:4096
    ds_read_b64_tr_b16 a[142:143], v18 offset:6144
    buffer_load_dwordx4 v41, s[12:15], s37 offen offset:1024 lds
    v_mfma_f32_16x16x32_bf16 v[56:59], a[96:99], v[28:31], v[56:59]
    v_mfma_f32_16x16x32_bf16 v[60:63], a[100:103], v[28:31], v[60:63]
    v_mfma_f32_16x16x32_bf16 v[64:67], a[104:107], v[28:31], v[64:67]
    v_mfma_f32_16x16x32_bf16 v[56:59], a[108:111], v[28:31], v[56:59]
    s_add_u32 m0, s87, 155648
    s_add_u32 s37, s86, 3543040
    buffer_load_dwordx4 v40, s[12:15], s37 offen offset:0 lds
    v_mfma_f32_16x16x32_bf16 v[60:63], a[112:115], v[28:31], v[60:63]
    v_mfma_f32_16x16x32_bf16 v[64:67], a[116:119], v[28:31], v[64:67]
    v_add_u32 v12, 65536, v42
    v_add_u32 v13, 65536, v43
    buffer_load_dwordx4 v41, s[12:15], s37 offen offset:1024 lds
    v_add_u32 v14, 65536, v44
    s_waitcnt vmcnt(18) lgkmcnt(0)
    s_barrier
    s_add_u32 m0, s87, 40960
    s_add_u32 s37, s86, 3932160
    buffer_load_dwordx4 v40, s[12:15], s37 offen offset:0 lds
    ds_read_b64_tr_b16 a[144:145], v12 offset:0
    ds_read_b64_tr_b16 a[146:147], v12 offset:2048
    ds_read_b64_tr_b16 a[148:149], v13 offset:0
    ds_read_b64_tr_b16 a[150:151], v13 offset:2048
    buffer_load_dwordx4 v41, s[12:15], s37 offen offset:1024 lds
    ds_read_b64_tr_b16 a[152:153], v14 offset:0
    ds_read_b64_tr_b16 a[154:155], v14 offset:2048
    ds_read_b64_tr_b16 a[156:157], v12 offset:4096
    ds_read_b64_tr_b16 a[158:159], v12 offset:6144
    s_add_u32 m0, s87, 49152
    s_add_u32 s37, s86, 3934208
    buffer_load_dwordx4 v40, s[12:15], s37 offen offset:0 lds
    ds_read_b64_tr_b16 a[160:161], v13 offset:4096
    ds_read_b64_tr_b16 a[162:163], v13 offset:6144
    ds_read_b64_tr_b16 a[164:165], v14 offset:4096
    ds_read_b64_tr_b16 a[166:167], v14 offset:6144
    buffer_load_dwordx4 v41, s[12:15], s37 offen offset:1024 lds
    v_mfma_f32_16x16x32_bf16 v[56:59], a[120:123], v[28:31], v[56:59]
    v_mfma_f32_16x16x32_bf16 v[60:63], a[124:127], v[28:31], v[60:63]
    v_mfma_f32_16x16x32_bf16 v[64:67], a[128:131], v[28:31], v[64:67]
    v_mfma_f32_16x16x32_bf16 v[56:59], a[132:135], v[28:31], v[56:59]
    s_add_u32 m0, s87, 57344
    s_add_u32 s37, s86, 3936256
    buffer_load_dwordx4 v40, s[12:15], s37 offen offset:0 lds
    v_mfma_f32_16x16x32_bf16 v[60:63], a[136:139], v[28:31], v[60:63]
    v_mfma_f32_16x16x32_bf16 v[64:67], a[140:143], v[28:31], v[64:67]
    v_add_u32 v16, 90112, v42
    v_add_u32 v17, 90112, v43
    buffer_load_dwordx4 v41, s[12:15], s37 offen offset:1024 lds
    v_add_u32 v18, 90112, v44
    s_waitcnt vmcnt(18) lgkmcnt(0)
    s_barrier
    s_add_u32 m0, s87, 65536
    s_add_u32 s37, s86, 4325376
    buffer_load_dwordx4 v40, s[12:15], s37 offen offset:0 lds
    ds_read_b64_tr_b16 a[168:169], v16 offset:0
    ds_read_b64_tr_b16 a[170:171], v16 offset:2048
    ds_read_b64_tr_b16 a[172:173], v17 offset:0
    ds_read_b64_tr_b16 a[174:175], v17 offset:2048
    buffer_load_dwordx4 v41, s[12:15], s37 offen offset:1024 lds
    ds_read_b64_tr_b16 a[176:177], v18 offset:0
    ds_read_b64_tr_b16 a[178:179], v18 offset:2048
    ds_read_b64_tr_b16 a[180:181], v16 offset:4096
    ds_read_b64_tr_b16 a[182:183], v16 offset:6144
    s_add_u32 m0, s87, 73728
    s_add_u32 s37, s86, 4327424
    buffer_load_dwordx4 v40, s[12:15], s37 offen offset:0 lds
    ds_read_b64_tr_b16 a[184:185], v17 offset:4096
    ds_read_b64_tr_b16 a[186:187], v17 offset:6144
    ds_read_b64_tr_b16 a[188:189], v18 offset:4096
    ds_read_b64_tr_b16 a[190:191], v18 offset:6144
    buffer_load_dwordx4 v41, s[12:15], s37 offen offset:1024 lds
    v_mfma_f32_16x16x32_bf16 v[56:59], a[144:147], v[28:31], v[56:59]
    v_mfma_f32_16x16x32_bf16 v[60:63], a[148:151], v[28:31], v[60:63]
    v_mfma_f32_16x16x32_bf16 v[64:67], a[152:155], v[28:31], v[64:67]
    v_mfma_f32_16x16x32_bf16 v[56:59], a[156:159], v[28:31], v[56:59]
    s_add_u32 m0, s87, 81920
    s_add_u32 s37, s86, 4329472
    buffer_load_dwordx4 v40, s[12:15], s37 offen offset:0 lds
    v_mfma_f32_16x16x32_bf16 v[60:63], a[160:163], v[28:31], v[60:63]
    v_mfma_f32_16x16x32_bf16 v[64:67], a[164:167], v[28:31], v[64:67]
    v_add_u32 v12, 114688, v42
    v_add_u32 v13, 114688, v43
    buffer_load_dwordx4 v41, s[12:15], s37 offen offset:1024 lds
    v_add_u32 v14, 114688, v44
    s_waitcnt vmcnt(18) lgkmcnt(0)
    s_barrier
    s_mov_b32 s20, s82
    s_mov_b32 s21, s83
    s_mov_b32 s22, 0x100
    s_mov_b32 s23, 0x00020000
    v_and_b32 v8, 15, v0
    v_lshlrev_b32 v8, 4, v8
    buffer_load_dword v9, v8, s[20:23], 0 offen sc1
    s_add_u32 m0, s87, 90112
    s_add_u32 s37, s86, 4718592
    buffer_load_dwordx4 v40, s[12:15], s37 offen offset:0 lds
    ds_read_b64_tr_b16 a[192:193], v12 offset:0
    ds_read_b64_tr_b16 a[194:195], v12 offset:2048
    ds_read_b64_tr_b16 a[196:197], v13 offset:0
    ds_read_b64_tr_b16 a[198:199], v13 offset:2048
    buffer_load_dwordx4 v41, s[12:15], s37 offen offset:1024 lds
    ds_read_b64_tr_b16 a[200:201], v14 offset:0
    ds_read_b64_tr_b16 a[202:203], v14 offset:2048
    ds_read_b64_tr_b16 a[204:205], v12 offset:4096
    ds_read_b64_tr_b16 a[206:207], v12 offset:6144
    s_add_u32 m0, s87, 98304
    s_add_u32 s37, s86, 4720640
    buffer_load_dwordx4 v40, s[12:15], s37 offen offset:0 lds
    ds_read_b64_tr_b16 a[208:209], v13 offset:4096
    ds_read_b64_tr_b16 a[210:211], v13 offset:6144
    ds_read_b64_tr_b16 a[212:213], v14 offset:4096
    ds_read_b64_tr_b16 a[214:215], v14 offset:6144
    buffer_load_dwordx4 v41, s[12:15], s37 offen offset:1024 lds
    v_mfma_f32_16x16x32_bf16 v[56:59], a[168:171], v[28:31], v[56:59]
    v_mfma_f32_16x16x32_bf16 v[60:63], a[172:175], v[28:31], v[60:63]
    v_mfma_f32_16x16x32_bf16 v[64:67], a[176:179], v[28:31], v[64:67]
    v_mfma_f32_16x16x32_bf16 v[56:59], a[180:183], v[28:31], v[56:59]
    s_add_u32 m0, s87, 106496
    s_add_u32 s37, s86, 4722688
    buffer_load_dwordx4 v40, s[12:15], s37 offen offset:0 lds
    v_mfma_f32_16x16x32_bf16 v[60:63], a[184:187], v[28:31], v[60:63]
    v_mfma_f32_16x16x32_bf16 v[64:67], a[188:191], v[28:31], v[64:67]
    v_add_u32 v16, 139264, v42
    v_add_u32 v17, 139264, v43
    buffer_load_dwordx4 v41, s[12:15], s37 offen offset:1024 lds
    v_add_u32 v18, 139264, v44
    s_waitcnt vmcnt(19) lgkmcnt(0)
    s_barrier
    s_add_u32 m0, s87, 114688
    s_add_u32 s37, s86, 5111808
    buffer_load_dwordx4 v40, s[12:15], s37 offen offset:0 lds
    ds_read_b64_tr_b16 a[216:217], v16 offset:0
    ds_read_b64_tr_b16 a[218:219], v16 offset:2048
    ds_read_b64_tr_b16 a[220:221], v17 offset:0
    ds_read_b64_tr_b16 a[222:223], v17 offset:2048
    buffer_load_dwordx4 v41, s[12:15], s37 offen offset:1024 lds
    ds_read_b64_tr_b16 a[224:225], v18 offset:0
    ds_read_b64_tr_b16 a[226:227], v18 offset:2048
    ds_read_b64_tr_b16 a[228:229], v16 offset:4096
    ds_read_b64_tr_b16 a[230:231], v16 offset:6144
    s_add_u32 m0, s87, 122880
    s_add_u32 s37, s86, 5113856
    buffer_load_dwordx4 v40, s[12:15], s37 offen offset:0 lds
    ds_read_b64_tr_b16 a[232:233], v17 offset:4096
    ds_read_b64_tr_b16 a[234:235], v17 offset:6144
    ds_read_b64_tr_b16 a[236:237], v18 offset:4096
    ds_read_b64_tr_b16 a[238:239], v18 offset:6144
    buffer_load_dwordx4 v41, s[12:15], s37 offen offset:1024 lds
    v_mfma_f32_16x16x32_bf16 v[56:59], a[192:195], v[28:31], v[56:59]
    v_mfma_f32_16x16x32_bf16 v[60:63], a[196:199], v[28:31], v[60:63]
    v_mfma_f32_16x16x32_bf16 v[64:67], a[200:203], v[28:31], v[64:67]
    v_mfma_f32_16x16x32_bf16 v[56:59], a[204:207], v[28:31], v[56:59]
    s_add_u32 m0, s87, 131072
    s_add_u32 s37, s86, 5115904
    buffer_load_dwordx4 v40, s[12:15], s37 offen offset:0 lds
    v_mfma_f32_16x16x32_bf16 v[60:63], a[208:211], v[28:31], v[60:63]
    v_mfma_f32_16x16x32_bf16 v[64:67], a[212:215], v[28:31], v[64:67]
    v_add_u32 v12, 40960, v42
    v_add_u32 v13, 40960, v43
    buffer_load_dwordx4 v41, s[12:15], s37 offen offset:1024 lds
    v_add_u32 v14, 40960, v44
    s_waitcnt vmcnt(19) lgkmcnt(0)
    s_barrier
    s_add_u32 m0, s87, 139264
    s_add_u32 s37, s86, 5505024
    buffer_load_dwordx4 v40, s[12:15], s37 offen offset:0 lds
    ds_read_b64_tr_b16 a[240:241], v12 offset:0
    ds_read_b64_tr_b16 a[242:243], v12 offset:2048
    ds_read_b64_tr_b16 a[244:245], v13 offset:0
    ds_read_b64_tr_b16 a[246:247], v13 offset:2048
    buffer_load_dwordx4 v41, s[12:15], s37 offen offset:1024 lds
    ds_read_b64_tr_b16 a[248:249], v14 offset:0
    ds_read_b64_tr_b16 a[250:251], v14 offset:2048
    ds_read_b64_tr_b16 a[252:253], v12 offset:4096
    ds_read_b64_tr_b16 a[254:255], v12 offset:6144
    s_add_u32 m0, s87, 147456
    s_add_u32 s37, s86, 5507072
    buffer_load_dwordx4 v40, s[12:15], s37 offen offset:0 lds
    ds_read_b64_tr_b16 v[128:129], v13 offset:4096
    ds_read_b64_tr_b16 v[130:131], v13 offset:6144
    ds_read_b64_tr_b16 v[132:133], v14 offset:4096
    ds_read_b64_tr_b16 v[134:135], v14 offset:6144
    buffer_load_dwordx4 v41, s[12:15], s37 offen offset:1024 lds
    v_mfma_f32_16x16x32_bf16 v[56:59], a[216:219], v[28:31], v[56:59]
    v_mfma_f32_16x16x32_bf16 v[60:63], a[220:223], v[28:31], v[60:63]
    v_mfma_f32_16x16x32_bf16 v[64:67], a[224:227], v[28:31], v[64:67]
    v_mfma_f32_16x16x32_bf16 v[56:59], a[228:231], v[28:31], v[56:59]
    s_add_u32 m0, s87, 155648
    s_add_u32 s37, s86, 5509120
    buffer_load_dwordx4 v40, s[12:15], s37 offen offset:0 lds
    v_mfma_f32_16x16x32_bf16 v[60:63], a[232:235], v[28:31], v[60:63]
    v_mfma_f32_16x16x32_bf16 v[64:67], a[236:239], v[28:31], v[64:67]
    v_add_u32 v16, 65536, v42
    v_add_u32 v17, 65536, v43
    buffer_load_dwordx4 v41, s[12:15], s37 offen offset:1024 lds
    v_add_u32 v18, 65536, v44
    s_waitcnt vmcnt(19) lgkmcnt(0)
    s_barrier
    s_add_u32 m0, s87, 40960
    s_add_u32 s37, s86, 5898240
    buffer_load_dwordx4 v40, s[12:15], s37 offen offset:0 lds
    ds_read_b64_tr_b16 v[136:137], v16 offset:0
    ds_read_b64_tr_b16 v[138:139], v16 offset:2048
    ds_read_b64_tr_b16 v[140:141], v17 offset:0
    ds_read_b64_tr_b16 v[142:143], v17 offset:2048
    buffer_load_dwordx4 v41, s[12:15], s37 offen offset:1024 lds
    ds_read_b64_tr_b16 v[144:145], v18 offset:0
    ds_read_b64_tr_b16 v[146:147], v18 offset:2048
    ds_read_b64_tr_b16 v[148:149], v16 offset:4096
    ds_read_b64_tr_b16 v[150:151], v16 offset:6144
    s_add_u32 m0, s87, 49152
    s_add_u32 s37, s86, 5900288
    buffer_load_dwordx4 v40, s[12:15], s37 offen offset:0 lds
    ds_read_b64_tr_b16 v[152:153], v17 offset:4096
    ds_read_b64_tr_b16 v[154:155], v17 offset:6144
    ds_read_b64_tr_b16 v[156:157], v18 offset:4096
    ds_read_b64_tr_b16 v[158:159], v18 offset:6144
    buffer_load_dwordx4 v41, s[12:15], s37 offen offset:1024 lds
    v_mfma_f32_16x16x32_bf16 v[56:59], a[240:243], v[28:31], v[56:59]
    v_mfma_f32_16x16x32_bf16 v[60:63], a[244:247], v[28:31], v[60:63]
    v_mfma_f32_16x16x32_bf16 v[64:67], a[248:251], v[28:31], v[64:67]
    v_mfma_f32_16x16x32_bf16 v[56:59], a[252:255], v[28:31], v[56:59]
    s_add_u32 m0, s87, 57344
    s_add_u32 s37, s86, 5902336
    buffer_load_dwordx4 v40, s[12:15], s37 offen offset:0 lds
    v_mfma_f32_16x16x32_bf16 v[60:63], v[128:131], v[28:31], v[60:63]
    v_mfma_f32_16x16x32_bf16 v[64:67], v[132:135], v[28:31], v[64:67]
    v_add_u32 v12, 90112, v42
    v_add_u32 v13, 90112, v43
    buffer_load_dwordx4 v41, s[12:15], s37 offen offset:1024 lds
    v_add_u32 v14, 90112, v44
    s_waitcnt vmcnt(18) lgkmcnt(0)
    s_barrier
    ds_read_b64_tr_b16 v[160:161], v12 offset:0
    ds_read_b64_tr_b16 v[162:163], v12 offset:2048
    ds_read_b64_tr_b16 v[164:165], v13 offset:0
    ds_read_b64_tr_b16 v[166:167], v13 offset:2048
    ds_read_b64_tr_b16 v[168:169], v14 offset:0
    ds_read_b64_tr_b16 v[170:171], v14 offset:2048
    ds_read_b64_tr_b16 v[172:173], v12 offset:4096
    ds_read_b64_tr_b16 v[174:175], v12 offset:6144
    ds_read_b64_tr_b16 v[176:177], v13 offset:4096
    ds_read_b64_tr_b16 v[178:179], v13 offset:6144
    ds_read_b64_tr_b16 v[180:181], v14 offset:4096
    ds_read_b64_tr_b16 v[182:183], v14 offset:6144
    v_mfma_f32_16x16x32_bf16 v[56:59], v[136:139], v[28:31], v[56:59]
    v_mfma_f32_16x16x32_bf16 v[60:63], v[140:143], v[28:31], v[60:63]
    v_mfma_f32_16x16x32_bf16 v[64:67], v[144:147], v[28:31], v[64:67]
    v_mfma_f32_16x16x32_bf16 v[56:59], v[148:151], v[28:31], v[56:59]
    v_mfma_f32_16x16x32_bf16 v[60:63], v[152:155], v[28:31], v[60:63]
    v_mfma_f32_16x16x32_bf16 v[64:67], v[156:159], v[28:31], v[64:67]
    v_add_u32 v16, 114688, v42
    v_add_u32 v17, 114688, v43
    v_add_u32 v18, 114688, v44
Lqkv_wa:
    v_cmp_gt_u32 vcc, 8, v9
    s_sub_u32 s43, s43, 1
    s_cmp_lt_i32 s43, 0
    s_cbranch_scc1 Lqkv_all
    s_cbranch_vccz Lqkv_all
    s_sleep 2
    buffer_load_dword v9, v8, s[20:23], 0 offen sc1
    s_waitcnt vmcnt(0)
    s_branch Lqkv_wa
Lqkv_all:
    s_mov_b32 s10, s6
    s_add_u32 m0, s34, 0
    s_nop 0
    buffer_load_dwordx4 v1, s[8:11], s33 offen offset:0 sc1 lds
    buffer_load_dwordx4 v1, s[8:11], s33 offen offset:1024 sc1 lds
    buffer_load_dwordx4 v1, s[8:11], s33 offen offset:2048 sc1 lds
    buffer_load_dwordx4 v1, s[8:11], s33 offen offset:3072 sc1 lds
    s_add_u32 m0, s34, 4096
    s_add_u32 s37, s33, 4096
    buffer_load_dwordx4 v1, s[8:11], s37 offen offset:0 sc1 lds
    buffer_load_dwordx4 v1, s[8:11], s37 offen offset:1024 sc1 lds
    buffer_load_dwordx4 v1, s[8:11], s37 offen offset:2048 sc1 lds
    buffer_load_dwordx4 v1, s[8:11], s37 offen offset:3072 sc1 lds
    s_add_u32 m0, s34, 8192
    s_add_u32 s37, s33, 8192
    buffer_load_dwordx4 v1, s[8:11], s37 offen offset:0 sc1 lds
    s_waitcnt vmcnt(21) lgkmcnt(0)
    s_barrier
    ds_read_b64_tr_b16 v[184:185], v16 offset:0
    ds_read_b64_tr_b16 v[186:187], v16 offset:2048
    ds_read_b64_tr_b16 v[188:189], v17 offset:0
    ds_read_b64_tr_b16 v[190:191], v17 offset:2048
    ds_read_b64_tr_b16 v[192:193], v18 offset:0
    ds_read_b64_tr_b16 v[194:195], v18 offset:2048
    ds_read_b64_tr_b16 v[196:197], v16 offset:4096
    ds_read_b64_tr_b16 v[198:199], v16 offset:6144
    ds_read_b64_tr_b16 v[200:201], v17 offset:4096
    ds_read_b64_tr_b16 v[202:203], v17 offset:6144
    ds_read_b64_tr_b16 v[204:205], v18 offset:4096
    ds_read_b64_tr_b16 v[206:207], v18 offset:6144
    v_mfma_f32_16x16x32_bf16 v[56:59], v[160:163], v[28:31], v[56:59]
    v_mfma_f32_16x16x32_bf16 v[60:63], v[164:167], v[28:31], v[60:63]
    v_mfma_f32_16x16x32_bf16 v[64:67], v[168:171], v[28:31], v[64:67]
    v_mfma_f32_16x16x32_bf16 v[56:59], v[172:175], v[28:31], v[56:59]
    v_mfma_f32_16x16x32_bf16 v[60:63], v[176:179], v[28:31], v[60:63]
    v_mfma_f32_16x16x32_bf16 v[64:67], v[180:183], v[28:31], v[64:67]
    v_add_u32 v12, 139264, v42
    v_add_u32 v13, 139264, v43
    v_add_u32 v14, 139264, v44
    s_waitcnt vmcnt(15) lgkmcnt(0)
    s_barrier
    ds_read_b64_tr_b16 v[208:209], v12 offset:0
    ds_read_b64_tr_b16 v[210:211], v12 offset:2048
    ds_read_b64_tr_b16 v[212:213], v13 offset:0
    ds_read_b64_tr_b16 v[214:215], v13 offset:2048
    ds_read_b64_tr_b16 v[216:217], v14 offset:0
    ds_read_b64_tr_b16 v[218:219], v14 offset:2048
    ds_read_b64_tr_b16 v[220:221], v12 offset:4096
    ds_read_b64_tr_b16 v[222:223], v12 offset:6144
    ds_read_b64_tr_b16 v[224:225], v13 offset:4096
    ds_read_b64_tr_b16 v[226:227], v13 offset:6144
    ds_read_b64_tr_b16 v[228:229], v14 offset:4096
    ds_read_b64_tr_b16 v[230:231], v14 offset:6144
    v_mfma_f32_16x16x32_bf16 v[56:59], v[184:187], v[28:31], v[56:59]
    v_mfma_f32_16x16x32_bf16 v[60:63], v[188:191], v[28:31], v[60:63]
    v_mfma_f32_16x16x32_bf16 v[64:67], v[192:195], v[28:31], v[64:67]
    v_mfma_f32_16x16x32_bf16 v[56:59], v[196:199], v[28:31], v[56:59]
    v_mfma_f32_16x16x32_bf16 v[60:63], v[200:203], v[28:31], v[60:63]
    v_mfma_f32_16x16x32_bf16 v[64:67], v[204:207], v[28:31], v[64:67]
    v_add_u32 v16, 40960, v42
    v_add_u32 v17, 40960, v43
    v_add_u32 v18, 40960, v44
    s_waitcnt vmcnt(9) lgkmcnt(0)
    s_barrier
    ds_read_b64_tr_b16 v[232:233], v16 offset:0
    ds_read_b64_tr_b16 v[234:235], v16 offset:2048
    ds_read_b64_tr_b16 v[236:237], v17 offset:0
    ds_read_b64_tr_b16 v[238:239], v17 offset:2048
    ds_read_b64_tr_b16 v[240:241], v18 offset:0
    ds_read_b64_tr_b16 v[242:243], v18 offset:2048
    ds_read_b64_tr_b16 v[244:245], v16 offset:4096
    ds_read_b64_tr_b16 v[246:247], v16 offset:6144
    ds_read_b64_tr_b16 v[248:249], v17 offset:4096
    ds_read_b64_tr_b16 v[250:251], v17 offset:6144
    ds_read_b64_tr_b16 v[252:253], v18 offset:4096
    ds_read_b64_tr_b16 v[254:255], v18 offset:6144
    v_mfma_f32_16x16x32_bf16 v[56:59], v[208:211], v[28:31], v[56:59]
    v_mfma_f32_16x16x32_bf16 v[60:63], v[212:215], v[28:31], v[60:63]
    v_mfma_f32_16x16x32_bf16 v[64:67], v[216:219], v[28:31], v[64:67]
    v_mfma_f32_16x16x32_bf16 v[56:59], v[220:223], v[28:31], v[56:59]
    v_mfma_f32_16x16x32_bf16 v[60:63], v[224:227], v[28:31], v[60:63]
    v_mfma_f32_16x16x32_bf16 v[64:67], v[228:231], v[28:31], v[64:67]
    s_waitcnt lgkmcnt(0)
    v_mfma_f32_16x16x32_bf16 v[56:59], v[232:235], v[28:31], v[56:59]
    v_mfma_f32_16x16x32_bf16 v[60:63], v[236:239], v[28:31], v[60:63]
    v_mfma_f32_16x16x32_bf16 v[64:67], v[240:243], v[28:31], v[64:67]
    v_mfma_f32_16x16x32_bf16 v[56:59], v[244:247], v[28:31], v[56:59]
    v_mfma_f32_16x16x32_bf16 v[60:63], v[248:251], v[28:31], v[60:63]
    v_mfma_f32_16x16x32_bf16 v[64:67], v[252:255], v[28:31], v[64:67]
    s_mov_b32 s12, s84
    s_mov_b32 s13, s85
    s_mov_b32 s14, 0x6200000
    s_mov_b32 s15, 0x00020000
    s_waitcnt vmcnt(0)
    s_barrier
    ds_read_b128 v[40:43], v2 offset:0
    ds_read_b128 v[44:47], v2 offset:1024
    ds_read_b128 v[48:51], v2 offset:2048
    s_add_u32 s33, s33, 34816
    s_add_u32 s34, s34, 36864
    s_cmp_ge_u32 s34, 147456
    s_cselect_b32 s38, 147456, 0
    s_sub_u32 s34, s34, s38
    s_mov_b32 s10, s6
    s_add_u32 m0, s34, 0
    s_nop 0
    buffer_load_dwordx4 v1, s[8:11], s33 offen offset:0 sc1 lds
    buffer_load_dwordx4 v1, s[8:11], s33 offen offset:1024 sc1 lds
    buffer_load_dwordx4 v1, s[8:11], s33 offen offset:2048 sc1 lds
    buffer_load_dwordx4 v1, s[8:11], s33 offen offset:3072 sc1 lds
    s_add_u32 m0, s34, 4096
    s_add_u32 s37, s33, 4096
    buffer_load_dwordx4 v1, s[8:11], s37 offen offset:0 sc1 lds
    buffer_load_dwordx4 v1, s[8:11], s37 offen offset:1024 sc1 lds
    buffer_load_dwordx4 v1, s[8:11], s37 offen offset:2048 sc1 lds
    buffer_load_dwordx4 v1, s[8:11], s37 offen offset:3072 sc1 lds
    s_add_u32 m0, s34, 8192
    s_add_u32 s37, s33, 8192
    buffer_load_dwordx4 v1, s[8:11], s37 offen offset:0 sc1 lds
    s_mov_b32 s14, 0
    s_add_u32 s31, s31, 1
    s_sub_u32 s32, s31, 29
    s_min_i32 s32, s32, 32
    s_sub_u32 s54, s31, 2
    v_mov_b32 v6, s54
    s_min_i32 s39, s32, 31
    s_min_u32 s39, s39, 0x1000
    s_lshl_b32 s39, s39, 13
    s_add_u32 s33, s33, 34816
    s_add_u32 s34, s34, 36864
    s_cmp_ge_u32 s34, 147456
    s_cselect_b32 s38, 147456, 0
    s_sub_u32 s34, s34, s38
    s_branch Lqkv_g00
Lqkv_s10:
    s_waitcnt lgkmcnt(2)
    v_mfma_f32_16x16x32_bf16 v[24:27], a[0:3], v[40:43], 0
    ds_read_b128 v[52:55], v3 offset:3072
    s_waitcnt vmcnt(12)
    v_mfma_f32_16x16x32_bf16 v[28:31], a[4:7], v[40:43], 0
    s_add_u32 s35, s35, 36864
    v_cmp_gt_i32 vcc, s32, v5
    v_mov_b32 v106, s42
    v_mfma_f32_16x16x32_bf16 v[32:35], a[8:11], v[40:43], 0
    s_waitcnt lgkmcnt(2)
    v_mov_b32 v107, s42
    v_mov_b32 v108, s42
    v_mfma_f32_16x16x32_bf16 v[32:35], a[20:23], v[44:47], v[32:35]
    ds_read_b128 v[40:43], v3 offset:4096
    v_mov_b32 v109, s42
    v_mfma_f32_16x16x32_bf16 v[28:31], a[16:19], v[44:47], v[28:31]
    s_and_b64 vcc, vcc, s[18:19]
    s_cbranch_scc1 Lqkv_slows10
Lqkv_backs10:
    v_mfma_f32_16x16x32_bf16 v[24:27], a[12:15], v[44:47], v[24:27]
    s_waitcnt vmcnt(11) lgkmcnt(2)
    v_fma_f32 v16, -v68, v64, v16
    v_fma_f32 v17, -v68, v65, v17
    v_mfma_f32_16x16x32_bf16 v[106:109], v[96:99], v[88:91], v[106:109]
    s_mov_b32 s16, s39
    v_fma_f32 v18, -v68, v66, v18
    v_fma_f32 v19, -v68, v67, v19
    v_mfma_f32_16x16x32_bf16 v[24:27], a[24:27], v[48:51], v[24:27]
    ds_read_b128 v[44:47], v3 offset:5120
    v_mul_f32 v16, v16, v69
    v_mfma_f32_16x16x32_bf16 v[28:31], a[28:31], v[48:51], v[28:31]
    s_cmp_eq_u32 s35, 147456
    s_cselect_b32 s35, 0, s35
    v_cndmask_b32 v106, v106, v107, s[44:45]
    v_mfma_f32_16x16x32_bf16 v[32:35], a[32:35], v[48:51], v[32:35]
    s_waitcnt lgkmcnt(2)
    buffer_load_dword v5, v4, s[4:7], s16 offen sc1
    v_mfma_f32_16x16x32_bf16 v[32:35], a[44:47], v[52:55], v[32:35]
    ds_read_b128 v[48:51], v3 offset:6144
    v_cndmask_b32 v108, v108, v109, s[44:45]
    v_mfma_f32_16x16x32_bf16 v[28:31], a[40:43], v[52:55], v[28:31]
    s_add_u32 m0, s34, 0
    v_cndmask_b32 v120, v106, v118, s[48:49]
    v_cndmask_b32 v121, v108, v119, s[50:51]
    v_mfma_f32_16x16x32_bf16 v[24:27], a[36:39], v[52:55], v[24:27]
    s_waitcnt lgkmcnt(2)
    ds_write_b64 v36, v[120:121] offset:2048
    v_mfma_f32_16x16x32_bf16 v[24:27], a[48:51], v[40:43], v[24:27]
    ds_read_b128 v[52:55], v3 offset:7168
    v_mul_f32 v17, v17, v69
    v_mfma_f32_16x16x32_bf16 v[28:31], a[52:55], v[40:43], v[28:31]
    v_mul_f32 v18, v18, v69
    v_mul_f32 v19, v19, v69
    v_mfma_f32_16x16x32_bf16 v[32:35], a[56:59], v[40:43], v[32:35]
    s_waitcnt lgkmcnt(3)
    v_cvt_pk_bf16_f32 v16, v16, v17
    v_cvt_pk_bf16_f32 v17, v18, v19
    v_mfma_f32_16x16x32_bf16 v[32:35], a[68:71], v[44:47], v[32:35]
    ds_read_b128 v[40:43], v3 offset:8192
    v_mul_f32 v124, s52, v71
    v_mfma_f32_16x16x32_bf16 v[28:31], a[64:67], v[44:47], v[28:31]
    ds_write_b64 v38, v[16:17]
    v_mfma_f32_16x16x32_bf16 v[24:27], a[60:63], v[44:47], v[24:27]
    s_waitcnt vmcnt(2) lgkmcnt(3)
    buffer_load_dwordx4 v1, s[8:11], s33 offen offset:0 sc1 lds
    v_mfma_f32_16x16x32_bf16 v[24:27], a[72:75], v[48:51], v[24:27]
    ds_read_b128 v[44:47], v3 offset:9216
    s_waitcnt vmcnt(2)
    v_mfma_f32_16x16x32_bf16 v[28:31], a[76:79], v[48:51], v[28:31]
    s_barrier
    v_mfma_f32_16x16x32_bf16 v[32:35], a[80:83], v[48:51], v[32:35]
    s_waitcnt lgkmcnt(3)
    buffer_store_dword v6, v21, s[12:15], s17 offen sc1
    v_mfma_f32_16x16x32_bf16 v[32:35], a[92:95], v[52:55], v[32:35]
    ds_read_b128 v[48:51], v3 offset:10240
    v_fma_f32 v12, -v68, v60, v12
    v_mfma_f32_16x16x32_bf16 v[28:31], a[88:91], v[52:55], v[28:31]
    s_cmp_ge_i32 s54, 0
    s_cselect_b32 s14, s6, 0
    v_fma_f32 v13, -v68, v61, v13
    v_mfma_f32_16x16x32_bf16 v[24:27], a[84:87], v[52:55], v[24:27]
    s_waitcnt lgkmcnt(3)
    buffer_load_dwordx4 v1, s[8:11], s33 offen offset:1024 sc1 lds
    v_mfma_f32_16x16x32_bf16 v[24:27], a[96:99], v[40:43], v[24:27]
    ds_read_b128 v[52:55], v3 offset:11264
    v_fma_f32 v14, -v68, v62, v14
    v_mfma_f32_16x16x32_bf16 v[28:31], a[100:103], v[40:43], v[28:31]
    s_add_u32 s17, s17, 8192
    ds_read_b64_tr_b16 v[92:93], v39
    v_mfma_f32_16x16x32_bf16 v[32:35], a[104:107], v[40:43], v[32:35]
    s_waitcnt lgkmcnt(3)
    ds_read_b64 v[122:123], v37 offset:2048
    v_mfma_f32_16x16x32_bf16 v[32:35], a[116:119], v[44:47], v[32:35]
    ds_read_b128 v[40:43], v3 offset:12288
    v_fma_f32 v15, -v68, v63, v15
    v_mfma_f32_16x16x32_bf16 v[28:31], a[112:115], v[44:47], v[28:31]
    buffer_load_dwordx4 v1, s[8:11], s33 offen offset:2048 sc1 lds
    v_mfma_f32_16x16x32_bf16 v[24:27], a[108:111], v[44:47], v[24:27]
    s_waitcnt lgkmcnt(4)
    v_mul_f32 v12, v12, v69
    v_mul_f32 v13, v13, v69
    v_mfma_f32_16x16x32_bf16 v[24:27], a[120:123], v[48:51], v[24:27]
    ds_read_b128 v[44:47], v3 offset:13312
    v_mul_f32 v14, v14, v69
    v_mfma_f32_16x16x32_bf16 v[28:31], a[124:127], v[48:51], v[28:31]
    s_waitcnt lgkmcnt(2)
    v_add_f32 v122, v122, v120
    v_add_f32 v123, v123, v121
    v_mfma_f32_16x16x32_bf16 v[32:35], a[128:131], v[48:51], v[32:35]
    v_max_f32 v22, v122, v123
    v_mov_b32 v23, v22
    v_mfma_f32_16x16x32_bf16 v[32:35], a[140:143], v[52:55], v[32:35]
    ds_read_b128 v[48:51], v3 offset:14336
    v_mul_f32 v15, v15, v69
    v_mfma_f32_16x16x32_bf16 v[28:31], a[136:139], v[52:55], v[28:31]
    buffer_load_dwordx4 v1, s[8:11], s33 offen offset:3072 sc1 lds
    v_mfma_f32_16x16x32_bf16 v[24:27], a[132:135], v[52:55], v[24:27]
    s_waitcnt lgkmcnt(2)
    v_permlane16_swap_b32 v22, v23
    v_mfma_f32_16x16x32_bf16 v[24:27], a[144:147], v[40:43], v[24:27]
    ds_read_b128 v[52:55], v3 offset:15360
    v_max_f32 v22, v22, v23
    v_mfma_f32_16x16x32_bf16 v[28:31], a[148:151], v[40:43], v[28:31]
    s_add_u32 m0, s34, 4096
    v_mov_b32 v23, v22
    v_cvt_pk_bf16_f32 v84, v12, v13
    v_mfma_f32_16x16x32_bf16 v[32:35], a[152:155], v[40:43], v[32:35]
    s_waitcnt lgkmcnt(2)
    v_permlane32_swap_b32 v22, v23
    v_mfma_f32_16x16x32_bf16 v[32:35], a[164:167], v[44:47], v[32:35]
    ds_read_b128 v[40:43], v3 offset:16384
    v_max_f32 v22, v22, v23
    v_mfma_f32_16x16x32_bf16 v[28:31], a[160:163], v[44:47], v[28:31]
    s_add_u32 s37, s33, 4096
    v_mul_f32 v22, v124, v22
    v_fma_f32 v122, v122, v124, -v22
    v_mfma_f32_16x16x32_bf16 v[24:27], a[156:159], v[44:47], v[24:27]
    s_waitcnt lgkmcnt(2)
    buffer_load_dwordx4 v1, s[8:11], s37 offen offset:0 sc1 lds
    v_mfma_f32_16x16x32_bf16 v[24:27], a[168:171], v[48:51], v[24:27]
    ds_read_b128 v[44:47], v3 offset:17408
    v_fma_f32 v123, v123, v124, -v22
    v_mfma_f32_16x16x32_bf16 v[28:31], a[172:175], v[48:51], v[28:31]
    v_exp_f32 v122, v122
    v_mfma_f32_16x16x32_bf16 v[32:35], a[176:179], v[48:51], v[32:35]
    s_waitcnt lgkmcnt(2)
    v_exp_f32 v123, v123
    v_mfma_f32_16x16x32_bf16 v[32:35], a[188:191], v[52:55], v[32:35]
    ds_read_b128 v[48:51], v3 offset:18432
    v_add_f32 v22, v122, v123
    v_mfma_f32_16x16x32_bf16 v[28:31], a[184:187], v[52:55], v[28:31]
    buffer_load_dwordx4 v1, s[8:11], s37 offen offset:1024 sc1 lds
    v_mfma_f32_16x16x32_bf16 v[24:27], a[180:183], v[52:55], v[24:27]
    s_waitcnt lgkmcnt(2)
    v_mov_b32 v23, v22
    v_cvt_pk_bf16_f32 v85, v14, v15
    v_mfma_f32_16x16x32_bf16 v[24:27], a[192:195], v[40:43], v[24:27]
    ds_read_b128 v[52:55], v3 offset:19456
    v_fma_f32 v8, -v68, v56, v8
    v_mfma_f32_16x16x32_bf16 v[28:31], a[196:199], v[40:43], v[28:31]
    v_permlane16_swap_b32 v22, v23
    v_mfma_f32_16x16x32_bf16 v[32:35], a[200:203], v[40:43], v[32:35]
    s_waitcnt lgkmcnt(2)
    v_add_f32 v22, v22, v23
    v_mov_b32 v23, v22
    v_mfma_f32_16x16x32_bf16 v[32:35], a[212:215], v[44:47], v[32:35]
    ds_read_b128 v[40:43], v3 offset:20480
    v_fma_f32 v9, -v68, v57, v9
    v_mfma_f32_16x16x32_bf16 v[28:31], a[208:211], v[44:47], v[28:31]
    buffer_load_dwordx4 v1, s[8:11], s37 offen offset:2048 sc1 lds
    v_mfma_f32_16x16x32_bf16 v[24:27], a[204:207], v[44:47], v[24:27]
    s_waitcnt lgkmcnt(2)
    v_permlane32_swap_b32 v22, v23
    v_mfma_f32_16x16x32_bf16 v[24:27], a[216:219], v[48:51], v[24:27]
    ds_read_b128 v[44:47], v3 offset:21504
    v_add_f32 v22, v22, v23
    v_mfma_f32_16x16x32_bf16 v[28:31], a[220:223], v[48:51], v[28:31]
    v_rcp_f32 v22, v22
    v_mfma_f32_16x16x32_bf16 v[32:35], a[224:227], v[48:51], v[32:35]
    s_waitcnt lgkmcnt(2)
    v_mul_f32 v122, v122, v22
    v_mul_f32 v123, v123, v22
    v_mfma_f32_16x16x32_bf16 v[32:35], a[236:239], v[52:55], v[32:35]
    ds_read_b128 v[48:51], v3 offset:22528
    v_cvt_pk_bf16_f32 v23, v122, v123
    v_mfma_f32_16x16x32_bf16 v[28:31], a[232:235], v[52:55], v[28:31]
    buffer_load_dwordx4 v1, s[8:11], s37 offen offset:3072 sc1 lds
    v_mfma_f32_16x16x32_bf16 v[24:27], a[228:231], v[52:55], v[24:27]
    s_waitcnt lgkmcnt(2)
    v_perm_b32 v114, v23, v23, v102
    v_perm_b32 v115, v23, v23, v103
    v_mfma_f32_16x16x32_bf16 v[24:27], a[240:243], v[40:43], v[24:27]
    ds_read_b128 v[52:55], v3 offset:23552
    v_perm_b32 v116, v23, v23, v104
    v_mfma_f32_16x16x32_bf16 v[28:31], a[244:247], v[40:43], v[28:31]
    s_add_u32 m0, s34, 8192
    v_perm_b32 v117, v23, v23, v105
    v_mov_b32 v100, v94
    v_mfma_f32_16x16x32_bf16 v[32:35], a[248:251], v[40:43], v[32:35]
    s_waitcnt lgkmcnt(2)
    v_mov_b32 v101, v95
    v_sub_u32 v76, v3, v20
    v_mfma_f32_16x16x32_bf16 v[32:35], v[132:135], v[44:47], v[32:35]
    ds_read_b128 v[40:43], v3 offset:24576
    v_fma_f32 v10, -v68, v58, v10
    v_mfma_f32_16x16x32_bf16 v[72:75], v[98:101], v[114:117], 0
    s_add_u32 s37, s33, 8192
    ds_read2st64_b64 v[80:83], v76 offset0:66 offset1:67
    v_mfma_f32_16x16x32_bf16 v[28:31], v[128:131], v[44:47], v[28:31]
    buffer_load_dwordx4 v1, s[8:11], s37 offen offset:0 sc1 lds
    v_mfma_f32_16x16x32_bf16 v[24:27], a[252:255], v[44:47], v[24:27]
    s_waitcnt lgkmcnt(3)
    ds_read2st64_b64 v[76:79], v76 offset0:64 offset1:65
    v_mfma_f32_16x16x32_bf16 v[24:27], v[136:139], v[48:51], v[24:27]
    ds_read_b128 v[44:47], v3 offset:25600
    v_cvt_pk_bf16_f32 v114, v72, v73
    v_mfma_f32_16x16x32_bf16 v[28:31], v[140:143], v[48:51], v[28:31]
    s_add_u32 s31, s31, 1
    v_cvt_pk_bf16_f32 v115, v74, v75
    v_cvt_pk_bf16_f32 v116, v72, v73
    v_mfma_f32_16x16x32_bf16 v[32:35], v[144:147], v[48:51], v[32:35]
    s_waitcnt lgkmcnt(4)
    v_cvt_pk_bf16_f32 v117, v74, v75
    v_fma_f32 v11, -v68, v59, v11
    v_mfma_f32_16x16x32_bf16 v[32:35], v[156:159], v[52:55], v[32:35]
    ds_read_b128 v[48:51], v3 offset:26624
    v_cvt_pk_bf16_f32 v88, v8, v9
    v_mfma_f32_16x16x32_bf16 v[28:31], v[152:155], v[52:55], v[28:31]
    s_sub_u32 s32, s31, 29
    v_permlane32_swap_b32 v114, v116
    v_mfma_f32_16x16x32_bf16 v[24:27], v[148:151], v[52:55], v[24:27]
    s_waitcnt lgkmcnt(4)
    v_permlane32_swap_b32 v115, v117
    v_mfma_f32_16x16x32_bf16 v[24:27], v[160:163], v[40:43], v[24:27]
    ds_read_b128 v[52:55], v3 offset:27648
    v_cvt_pk_bf16_f32 v89, v10, v11
    v_mfma_f32_16x16x32_bf16 v[28:31], v[164:167], v[40:43], v[28:31]
    s_min_i32 s32, s32, 32
    v_add_u32 v2, s35, v1
    s_sub_u32 s54, s31, 2
    v_mfma_f32_16x16x32_bf16 v[110:113], v[84:87], v[88:91], 0
    v_mov_b32 v8, v84
    v_mov_b32 v9, v85
    v_mfma_f32_16x16x32_bf16 v[32:35], v[168:171], v[40:43], v[32:35]
    s_waitcnt lgkmcnt(2)
    v_add_f32 v76, v76, v80
    v_add_f32 v77, v77, v81
    v_mfma_f32_16x16x32_bf16 v[32:35], v[180:183], v[44:47], v[32:35]
    ds_read_b128 v[40:43], v3 offset:28672
    v_cndmask_b32 v118, v110, v111, s[44:45]
    v_mfma_f32_16x16x32_bf16 v[28:31], v[176:179], v[44:47], v[28:31]
    v_cndmask_b32 v119, v112, v113, s[44:45]
    v_add_f32 v78, v78, v82
    v_mfma_f32_16x16x32_bf16 v[24:27], v[172:175], v[44:47], v[24:27]
    s_waitcnt lgkmcnt(2)
    v_mov_b32 v10, v92
    v_mov_b32 v11, v93
    v_mfma_f32_16x16x32_bf16 v[24:27], v[184:187], v[48:51], v[24:27]
    ds_read_b128 v[44:47], v3 offset:29696
    v_add_f32 v79, v79, v83
    v_mfma_f32_16x16x32_bf16 v[28:31], v[188:191], v[48:51], v[28:31]
    buffer_store_dwordx4 v[8:11], v1, s[4:7], s40 offen sc1
    v_add_f32 v70, v76, v78
    v_mfma_f32_16x16x32_bf16 v[32:35], v[192:195], v[48:51], v[32:35]
    s_waitcnt lgkmcnt(2)
    v_add_f32 v71, v77, v79
    v_mov_b32 v6, s54
    v_mfma_f32_16x16x32_bf16 v[32:35], v[204:207], v[52:55], v[32:35]
    ds_read_b128 v[48:51], v3 offset:30720
    s_add_u32 s40, s40, 262144
    v_mfma_f32_16x16x32_bf16 v[28:31], v[200:203], v[52:55], v[28:31]
    s_add_u32 s41, s41, 262144
    v_permlane16_swap_b32 v70, v71
    v_mfma_f32_16x16x32_bf16 v[24:27], v[196:199], v[52:55], v[24:27]
    s_waitcnt lgkmcnt(2)
    v_add_f32 v70, v70, v71
    v_mov_b32 v71, v70
    v_mfma_f32_16x16x32_bf16 v[24:27], v[208:211], v[40:43], v[24:27]
    ds_read_b128 v[52:55], v3 offset:31744
    s_min_i32 s39, s32, 31
    v_mfma_f32_16x16x32_bf16 v[28:31], v[212:215], v[40:43], v[28:31]
    buffer_store_dwordx4 v[114:117], v7, s[12:15], s36 offen sc1
    s_add_u32 s36, s36, 32768
    v_mfma_f32_16x16x32_bf16 v[32:35], v[216:219], v[40:43], v[32:35]
    s_waitcnt lgkmcnt(2)
    v_permlane32_swap_b32 v70, v71
    v_mfma_f32_16x16x32_bf16 v[32:35], v[228:231], v[44:47], v[32:35]
    ds_read_b128 v[40:43], v2 offset:0
    v_add_f32 v70, v70, v71
    v_mfma_f32_16x16x32_bf16 v[28:31], v[224:227], v[44:47], v[28:31]
    s_min_u32 s39, s39, 0x1000
    v_mul_f32 v70, 0x3a800000, v70
    v_mov_b32 v71, v70
    v_mfma_f32_16x16x32_bf16 v[24:27], v[220:223], v[44:47], v[24:27]
    s_waitcnt lgkmcnt(2)
    v_permlane16_swap_b32 v70, v71
    v_mfma_f32_16x16x32_bf16 v[24:27], v[232:235], v[48:51], v[24:27]
    ds_read_b128 v[44:47], v2 offset:1024
    v_fma_f32 v71, -v70, v70, v71
    v_mfma_f32_16x16x32_bf16 v[28:31], v[236:239], v[48:51], v[28:31]
    s_lshl_b32 s39, s39, 13
    v_max_f32 v71, 0, v71
    v_add_f32 v71, 0x3727c5ac, v71
    v_mfma_f32_16x16x32_bf16 v[32:35], v[240:243], v[48:51], v[32:35]
    s_waitcnt lgkmcnt(2)
    v_rsq_f32 v71, v71
    v_mfma_f32_16x16x32_bf16 v[32:35], v[252:255], v[52:55], v[32:35]
    ds_read_b128 v[48:51], v2 offset:2048
    s_add_u32 s33, s33, 34816
    v_mfma_f32_16x16x32_bf16 v[28:31], v[248:251], v[52:55], v[28:31]
    s_add_u32 s34, s34, 36864
    s_cmp_ge_u32 s34, 147456
    s_cselect_b32 s38, 147456, 0
    v_mfma_f32_16x16x32_bf16 v[24:27], v[244:247], v[52:55], v[24:27]
    s_sub_u32 s34, s34, s38
    s_branch Lqkv_g00
    .p2align 6
Lqkv_g10:
    s_waitcnt lgkmcnt(2)
    v_mfma_f32_16x16x32_bf16 v[24:27], a[0:3], v[40:43], 0
    ds_read_b128 v[52:55], v3 offset:3072
    s_waitcnt vmcnt(12)
    v_mfma_f32_16x16x32_bf16 v[28:31], a[4:7], v[40:43], 0
    s_add_u32 s35, s35, 36864
    v_cmp_gt_i32 vcc, s32, v5
    v_fma_f32 v12, -v68, v60, v12
    v_mfma_f32_16x16x32_bf16 v[32:35], a[8:11], v[40:43], 0
    s_waitcnt lgkmcnt(2)
    v_fma_f32 v13, -v68, v61, v13
    v_fma_f32 v14, -v68, v62, v14
    v_mfma_f32_16x16x32_bf16 v[32:35], a[20:23], v[44:47], v[32:35]
    ds_read_b128 v[40:43], v3 offset:4096
    v_fma_f32 v15, -v68, v63, v15
    v_mfma_f32_16x16x32_bf16 v[28:31], a[16:19], v[44:47], v[28:31]
    s_and_b64 vcc, vcc, s[18:19]
    s_cbranch_scc1 Lqkv_slowg10
Lqkv_backg10:
    v_mfma_f32_16x16x32_bf16 v[24:27], a[12:15], v[44:47], v[24:27]
    s_waitcnt lgkmcnt(2)
    v_mul_f32 v12, v12, v69
    v_mul_f32 v13, v13, v69
    v_mfma_f32_16x16x32_bf16 v[24:27], a[24:27], v[48:51], v[24:27]
    ds_read_b128 v[44:47], v3 offset:5120
    v_mul_f32 v14, v14, v69
    v_mfma_f32_16x16x32_bf16 v[28:31], a[28:31], v[48:51], v[28:31]
    s_mov_b32 s16, s39
    v_mul_f32 v15, v15, v69
    v_cvt_pk_bf16_f32 v84, v12, v13
    v_mfma_f32_16x16x32_bf16 v[32:35], a[32:35], v[48:51], v[32:35]
    s_waitcnt lgkmcnt(2)
    buffer_load_dword v5, v4, s[4:7], s16 offen sc1
    v_mfma_f32_16x16x32_bf16 v[32:35], a[44:47], v[52:55], v[32:35]
    ds_read_b128 v[48:51], v3 offset:6144
    v_cvt_pk_bf16_f32 v85, v14, v15
    v_mfma_f32_16x16x32_bf16 v[28:31], a[40:43], v[52:55], v[28:31]
    s_add_u32 m0, s34, 0
    v_fma_f32 v16, -v68, v64, v16
    v_fma_f32 v17, -v68, v65, v17
    v_mfma_f32_16x16x32_bf16 v[106:109], v[84:87], v[88:91], 0
    s_cmp_eq_u32 s35, 147456
    s_cselect_b32 s35, 0, s35
    v_fma_f32 v18, -v68, v66, v18
    v_mfma_f32_16x16x32_bf16 v[24:27], a[36:39], v[52:55], v[24:27]
    s_waitcnt lgkmcnt(2)
    v_fma_f32 v19, -v68, v67, v19
    v_mul_f32 v16, v16, v69
    v_mfma_f32_16x16x32_bf16 v[24:27], a[48:51], v[40:43], v[24:27]
    ds_read_b128 v[52:55], v3 offset:7168
    v_cndmask_b32 v106, v106, v107, s[44:45]
    v_mfma_f32_16x16x32_bf16 v[28:31], a[52:55], v[40:43], v[28:31]
    v_cndmask_b32 v108, v108, v109, s[44:45]
    v_cndmask_b32 v120, v106, v118, s[48:49]
    v_mfma_f32_16x16x32_bf16 v[32:35], a[56:59], v[40:43], v[32:35]
    s_waitcnt lgkmcnt(2)
    v_cndmask_b32 v121, v108, v119, s[50:51]
    v_mul_f32 v17, v17, v69
    v_mfma_f32_16x16x32_bf16 v[32:35], a[68:71], v[44:47], v[32:35]
    ds_read_b128 v[40:43], v3 offset:8192
    v_mul_f32 v18, v18, v69
    v_mfma_f32_16x16x32_bf16 v[28:31], a[64:67], v[44:47], v[28:31]
    ds_write_b64 v36, v[120:121] offset:2048
    v_mfma_f32_16x16x32_bf16 v[24:27], a[60:63], v[44:47], v[24:27]
    s_waitcnt vmcnt(1) lgkmcnt(3)
    buffer_store_dword v6, v21, s[12:15], s17 offen sc1
    v_mfma_f32_16x16x32_bf16 v[24:27], a[72:75], v[48:51], v[24:27]
    ds_read_b128 v[44:47], v3 offset:9216
    v_mul_f32 v19, v19, v69
    v_mfma_f32_16x16x32_bf16 v[28:31], a[76:79], v[48:51], v[28:31]
    s_waitcnt lgkmcnt(1)
    s_barrier
    v_mfma_f32_16x16x32_bf16 v[32:35], a[80:83], v[48:51], v[32:35]
    s_cmp_ge_i32 s54, 0
    s_cselect_b32 s14, s6, 0
    v_cvt_pk_bf16_f32 v16, v16, v17
    v_mfma_f32_16x16x32_bf16 v[32:35], a[92:95], v[52:55], v[32:35]
    ds_read_b128 v[48:51], v3 offset:10240
    v_cvt_pk_bf16_f32 v17, v18, v19
    v_mfma_f32_16x16x32_bf16 v[28:31], a[88:91], v[52:55], v[28:31]
    s_add_u32 s17, s17, 8192
    v_mul_f32 v124, s52, v71
    v_fma_f32 v8, -v68, v56, v8
    v_mfma_f32_16x16x32_bf16 v[24:27], a[84:87], v[52:55], v[24:27]
    ds_write_b64 v38, v[16:17]
    v_mfma_f32_16x16x32_bf16 v[24:27], a[96:99], v[40:43], v[24:27]
    ds_read_b128 v[52:55], v3 offset:11264
    v_fma_f32 v9, -v68, v57, v9
    v_mfma_f32_16x16x32_bf16 v[28:31], a[100:103], v[40:43], v[28:31]
    buffer_load_dwordx4 v1, s[8:11], s33 offen offset:0 sc1 lds
    v_mfma_f32_16x16x32_bf16 v[32:35], a[104:107], v[40:43], v[32:35]
    s_waitcnt lgkmcnt(3)
    ds_read_b64_tr_b16 v[92:93], v39
    v_mfma_f32_16x16x32_bf16 v[32:35], a[116:119], v[44:47], v[32:35]
    ds_read_b128 v[40:43], v3 offset:12288
    v_fma_f32 v10, -v68, v58, v10
    v_mfma_f32_16x16x32_bf16 v[28:31], a[112:115], v[44:47], v[28:31]
    ds_read_b64 v[122:123], v37 offset:2048
    v_fma_f32 v11, -v68, v59, v11
    v_mfma_f32_16x16x32_bf16 v[24:27], a[108:111], v[44:47], v[24:27]
    s_waitcnt lgkmcnt(5)
    v_cvt_pk_bf16_f32 v88, v8, v9
    v_cvt_pk_bf16_f32 v89, v10, v11
    v_mfma_f32_16x16x32_bf16 v[24:27], a[120:123], v[48:51], v[24:27]
    ds_read_b128 v[44:47], v3 offset:13312
    v_add_u32 v2, s35, v1
    v_mfma_f32_16x16x32_bf16 v[110:113], v[84:87], v[88:91], 0
    buffer_load_dwordx4 v1, s[8:11], s33 offen offset:1024 sc1 lds
    v_mfma_f32_16x16x32_bf16 v[28:31], a[124:127], v[48:51], v[28:31]
    v_mfma_f32_16x16x32_bf16 v[32:35], a[128:131], v[48:51], v[32:35]
    s_waitcnt lgkmcnt(1)
    v_add_f32 v122, v122, v120
    v_add_f32 v123, v123, v121
    v_mfma_f32_16x16x32_bf16 v[32:35], a[140:143], v[52:55], v[32:35]
    ds_read_b128 v[48:51], v3 offset:14336
    v_max_f32 v22, v122, v123
    v_mfma_f32_16x16x32_bf16 v[28:31], a[136:139], v[52:55], v[28:31]
    v_mov_b32 v23, v22
    v_cndmask_b32 v118, v110, v111, s[44:45]
    v_mfma_f32_16x16x32_bf16 v[24:27], a[132:135], v[52:55], v[24:27]
    buffer_load_dwordx4 v1, s[8:11], s33 offen offset:2048 sc1 lds
    v_mfma_f32_16x16x32_bf16 v[24:27], a[144:147], v[40:43], v[24:27]
    ds_read_b128 v[52:55], v3 offset:15360
    v_cndmask_b32 v119, v112, v113, s[44:45]
    v_mfma_f32_16x16x32_bf16 v[28:31], a[148:151], v[40:43], v[28:31]
    v_permlane16_swap_b32 v22, v23
    v_mfma_f32_16x16x32_bf16 v[32:35], a[152:155], v[40:43], v[32:35]
    s_waitcnt lgkmcnt(2)
    v_max_f32 v22, v22, v23
    v_mov_b32 v23, v22
    v_mfma_f32_16x16x32_bf16 v[32:35], a[164:167], v[44:47], v[32:35]
    ds_read_b128 v[40:43], v3 offset:16384
    v_mfma_f32_16x16x32_bf16 v[28:31], a[160:163], v[44:47], v[28:31]
    buffer_load_dwordx4 v1, s[8:11], s33 offen offset:3072 sc1 lds
    v_mfma_f32_16x16x32_bf16 v[24:27], a[156:159], v[44:47], v[24:27]
    s_waitcnt lgkmcnt(2)
    v_permlane32_swap_b32 v22, v23
    v_mfma_f32_16x16x32_bf16 v[24:27], a[168:171], v[48:51], v[24:27]
    ds_read_b128 v[44:47], v3 offset:17408
    v_max_f32 v22, v22, v23
    v_mfma_f32_16x16x32_bf16 v[28:31], a[172:175], v[48:51], v[28:31]
    s_add_u32 m0, s34, 4096
    v_mul_f32 v22, v124, v22
    v_fma_f32 v122, v122, v124, -v22
    v_mfma_f32_16x16x32_bf16 v[32:35], a[176:179], v[48:51], v[32:35]
    s_waitcnt lgkmcnt(2)
    v_fma_f32 v123, v123, v124, -v22
    s_add_u32 s37, s33, 4096
    v_mfma_f32_16x16x32_bf16 v[32:35], a[188:191], v[52:55], v[32:35]
    ds_read_b128 v[48:51], v3 offset:18432
    v_mfma_f32_16x16x32_bf16 v[28:31], a[184:187], v[52:55], v[28:31]
    buffer_load_dwordx4 v1, s[8:11], s37 offen offset:0 sc1 lds
    v_mfma_f32_16x16x32_bf16 v[24:27], a[180:183], v[52:55], v[24:27]
    s_waitcnt lgkmcnt(2)
    v_exp_f32 v122, v122
    v_mfma_f32_16x16x32_bf16 v[24:27], a[192:195], v[40:43], v[24:27]
    ds_read_b128 v[52:55], v3 offset:19456
    v_mfma_f32_16x16x32_bf16 v[28:31], a[196:199], v[40:43], v[28:31]
    v_exp_f32 v123, v123
    v_mfma_f32_16x16x32_bf16 v[32:35], a[200:203], v[40:43], v[32:35]
    s_waitcnt lgkmcnt(2)
    v_add_f32 v22, v122, v123
    v_mov_b32 v23, v22
    v_mfma_f32_16x16x32_bf16 v[32:35], a[212:215], v[44:47], v[32:35]
    ds_read_b128 v[40:43], v3 offset:20480
    v_mfma_f32_16x16x32_bf16 v[28:31], a[208:211], v[44:47], v[28:31]
    buffer_load_dwordx4 v1, s[8:11], s37 offen offset:1024 sc1 lds
    v_mfma_f32_16x16x32_bf16 v[24:27], a[204:207], v[44:47], v[24:27]
    s_waitcnt lgkmcnt(2)
    v_permlane16_swap_b32 v22, v23
    v_mfma_f32_16x16x32_bf16 v[24:27], a[216:219], v[48:51], v[24:27]
    ds_read_b128 v[44:47], v3 offset:21504
    v_add_f32 v22, v22, v23
    v_mfma_f32_16x16x32_bf16 v[28:31], a[220:223], v[48:51], v[28:31]
    v_mov_b32 v23, v22
    v_sub_u32 v76, v3, v20
    v_mfma_f32_16x16x32_bf16 v[32:35], a[224:227], v[48:51], v[32:35]
    s_waitcnt lgkmcnt(2)
    v_permlane32_swap_b32 v22, v23
    v_mfma_f32_16x16x32_bf16 v[32:35], a[236:239], v[52:55], v[32:35]
    ds_read_b128 v[48:51], v3 offset:22528
    v_add_f32 v22, v22, v23
    v_mfma_f32_16x16x32_bf16 v[28:31], a[232:235], v[52:55], v[28:31]
    buffer_load_dwordx4 v1, s[8:11], s37 offen offset:2048 sc1 lds
    v_mfma_f32_16x16x32_bf16 v[24:27], a[228:231], v[52:55], v[24:27]
    s_waitcnt lgkmcnt(2)
    v_rcp_f32 v22, v22
    v_mfma_f32_16x16x32_bf16 v[24:27], a[240:243], v[40:43], v[24:27]
    ds_read_b128 v[52:55], v3 offset:23552
    v_mul_f32 v122, v122, v22
    v_mfma_f32_16x16x32_bf16 v[28:31], a[244:247], v[40:43], v[28:31]
    ds_read2st64_b64 v[80:83], v76 offset0:66 offset1:67
    v_mul_f32 v123, v123, v22
    v_mfma_f32_16x16x32_bf16 v[32:35], a[248:251], v[40:43], v[32:35]
    s_waitcnt lgkmcnt(3)
    v_cvt_pk_bf16_f32 v23, v122, v123
    v_perm_b32 v114, v23, v23, v102
    v_mfma_f32_16x16x32_bf16 v[32:35], v[132:135], v[44:47], v[32:35]
    ds_read_b128 v[40:43], v3 offset:24576
    v_perm_b32 v115, v23, v23, v103
    v_mfma_f32_16x16x32_bf16 v[28:31], v[128:131], v[44:47], v[28:31]
    buffer_load_dwordx4 v1, s[8:11], s37 offen offset:3072 sc1 lds
    v_mfma_f32_16x16x32_bf16 v[24:27], a[252:255], v[44:47], v[24:27]
    s_waitcnt lgkmcnt(3)
    v_perm_b32 v116, v23, v23, v104
    v_perm_b32 v117, v23, v23, v105
    v_mfma_f32_16x16x32_bf16 v[24:27], v[136:139], v[48:51], v[24:27]
    ds_read_b128 v[44:47], v3 offset:25600
    s_add_u32 m0, s34, 8192
    v_mfma_f32_16x16x32_bf16 v[72:75], v[92:95], v[114:117], 0
    s_add_u32 s37, s33, 8192
    ds_read2st64_b64 v[76:79], v76 offset0:64 offset1:65
    v_mfma_f32_16x16x32_bf16 v[28:31], v[140:143], v[48:51], v[28:31]
    v_mfma_f32_16x16x32_bf16 v[32:35], v[144:147], v[48:51], v[32:35]
    s_waitcnt lgkmcnt(4)
    buffer_load_dwordx4 v1, s[8:11], s37 offen offset:0 sc1 lds
    v_mfma_f32_16x16x32_bf16 v[32:35], v[156:159], v[52:55], v[32:35]
    ds_read_b128 v[48:51], v3 offset:26624
    v_cvt_pk_bf16_f32 v114, v72, v73
    v_mfma_f32_16x16x32_bf16 v[28:31], v[152:155], v[52:55], v[28:31]
    s_add_u32 s31, s31, 1
    v_cvt_pk_bf16_f32 v115, v74, v75
    v_cvt_pk_bf16_f32 v116, v72, v73
    v_mfma_f32_16x16x32_bf16 v[24:27], v[148:151], v[52:55], v[24:27]
    s_waitcnt lgkmcnt(3)
    v_cvt_pk_bf16_f32 v117, v74, v75
    s_sub_u32 s32, s31, 29
    v_mfma_f32_16x16x32_bf16 v[24:27], v[160:163], v[40:43], v[24:27]
    ds_read_b128 v[52:55], v3 offset:27648
    s_min_i32 s32, s32, 32
    v_mfma_f32_16x16x32_bf16 v[28:31], v[164:167], v[40:43], v[28:31]
    s_sub_u32 s54, s31, 2
    v_permlane32_swap_b32 v114, v116
    v_mfma_f32_16x16x32_bf16 v[32:35], v[168:171], v[40:43], v[32:35]
    s_waitcnt lgkmcnt(3)
    v_permlane32_swap_b32 v115, v117
    v_mfma_f32_16x16x32_bf16 v[32:35], v[180:183], v[44:47], v[32:35]
    ds_read_b128 v[40:43], v3 offset:28672
    v_mov_b32 v6, s54
    v_mfma_f32_16x16x32_bf16 v[28:31], v[176:179], v[44:47], v[28:31]
    buffer_store_dwordx4 v[114:117], v7, s[12:15], s36 offen sc1
    s_waitcnt lgkmcnt(3)
    v_mfma_f32_16x16x32_bf16 v[24:27], v[172:175], v[44:47], v[24:27]
    s_waitcnt lgkmcnt(2)
    v_add_f32 v76, v76, v80
    v_add_f32 v77, v77, v81
    v_mfma_f32_16x16x32_bf16 v[24:27], v[184:187], v[48:51], v[24:27]
    ds_read_b128 v[44:47], v3 offset:29696
    v_add_f32 v78, v78, v82
    v_mfma_f32_16x16x32_bf16 v[28:31], v[188:191], v[48:51], v[28:31]
    s_add_u32 s36, s36, 32768
    v_add_f32 v79, v79, v83
    v_add_f32 v70, v76, v78
    v_mfma_f32_16x16x32_bf16 v[32:35], v[192:195], v[48:51], v[32:35]
    s_waitcnt lgkmcnt(2)
    v_add_f32 v71, v77, v79
    s_min_i32 s39, s32, 31
    v_mfma_f32_16x16x32_bf16 v[32:35], v[204:207], v[52:55], v[32:35]
    ds_read_b128 v[48:51], v3 offset:30720
    s_min_u32 s39, s39, 0x1000
    v_mfma_f32_16x16x32_bf16 v[28:31], v[200:203], v[52:55], v[28:31]
    s_lshl_b32 s39, s39, 13
    v_permlane16_swap_b32 v70, v71
    v_mfma_f32_16x16x32_bf16 v[24:27], v[196:199], v[52:55], v[24:27]
    s_waitcnt lgkmcnt(2)
    v_add_f32 v70, v70, v71
    v_mov_b32 v71, v70
    v_mfma_f32_16x16x32_bf16 v[24:27], v[208:211], v[40:43], v[24:27]
    ds_read_b128 v[52:55], v3 offset:31744
    s_add_u32 s33, s33, 34816
    v_mfma_f32_16x16x32_bf16 v[28:31], v[212:215], v[40:43], v[28:31]
    s_add_u32 s34, s34, 36864
    v_permlane32_swap_b32 v70, v71
    v_mfma_f32_16x16x32_bf16 v[32:35], v[216:219], v[40:43], v[32:35]
    s_waitcnt lgkmcnt(2)
    v_add_f32 v70, v70, v71
    v_mul_f32 v70, 0x3a800000, v70
    v_mfma_f32_16x16x32_bf16 v[32:35], v[228:231], v[44:47], v[32:35]
    ds_read_b128 v[40:43], v2 offset:0
    v_mov_b32 v71, v70
    v_mfma_f32_16x16x32_bf16 v[28:31], v[224:227], v[44:47], v[28:31]
    s_cmp_ge_u32 s34, 147456
    s_cselect_b32 s38, 147456, 0
    s_sub_u32 s34, s34, s38
    v_mfma_f32_16x16x32_bf16 v[24:27], v[220:223], v[44:47], v[24:27]
    s_waitcnt lgkmcnt(2)
    v_permlane16_swap_b32 v70, v71
    v_mfma_f32_16x16x32_bf16 v[24:27], v[232:235], v[48:51], v[24:27]
    ds_read_b128 v[44:47], v2 offset:1024
    v_fma_f32 v71, -v70, v70, v71
    v_mfma_f32_16x16x32_bf16 v[28:31], v[236:239], v[48:51], v[28:31]
    v_max_f32 v71, 0, v71
    v_add_f32 v71, 0x3727c5ac, v71
    v_mfma_f32_16x16x32_bf16 v[32:35], v[240:243], v[48:51], v[32:35]
    s_waitcnt lgkmcnt(2)
    v_rsq_f32 v71, v71
    v_mfma_f32_16x16x32_bf16 v[32:35], v[252:255], v[52:55], v[32:35]
    ds_read_b128 v[48:51], v2 offset:2048
    v_mfma_f32_16x16x32_bf16 v[28:31], v[248:251], v[52:55], v[28:31]
    v_mfma_f32_16x16x32_bf16 v[24:27], v[244:247], v[52:55], v[24:27]
    s_cmp_eq_u32 s31, 64
    s_cbranch_scc1 Lqkv_tail
Lqkv_g00:
    s_waitcnt lgkmcnt(2)
    v_mfma_f32_16x16x32_bf16 v[8:11], a[0:3], v[40:43], 0
    ds_read_b128 v[52:55], v2 offset:3072
    s_waitcnt vmcnt(11)
    v_mfma_f32_16x16x32_bf16 v[12:15], a[4:7], v[40:43], 0
    s_add_u32 s35, s35, 36864
    v_cmp_gt_i32 vcc, s32, v5
    v_fma_f32 v28, -v70, v60, v28
    v_mfma_f32_16x16x32_bf16 v[16:19], a[8:11], v[40:43], 0
    s_waitcnt lgkmcnt(2)
    v_fma_f32 v29, -v70, v61, v29
    v_fma_f32 v30, -v70, v62, v30
    v_mfma_f32_16x16x32_bf16 v[16:19], a[20:23], v[44:47], v[16:19]
    ds_read_b128 v[40:43], v2 offset:4096
    v_fma_f32 v31, -v70, v63, v31
    v_mfma_f32_16x16x32_bf16 v[12:15], a[16:19], v[44:47], v[12:15]
    s_and_b64 vcc, vcc, s[18:19]
    s_cbranch_scc1 Lqkv_slowg00
Lqkv_backg00:
    v_mfma_f32_16x16x32_bf16 v[8:11], a[12:15], v[44:47], v[8:11]
    s_waitcnt lgkmcnt(2)
    v_mul_f32 v28, v28, v71
    v_mul_f32 v29, v29, v71
    v_mfma_f32_16x16x32_bf16 v[8:11], a[24:27], v[48:51], v[8:11]
    ds_read_b128 v[44:47], v2 offset:5120
    v_mul_f32 v30, v30, v71
    v_mfma_f32_16x16x32_bf16 v[12:15], a[28:31], v[48:51], v[12:15]
    s_mov_b32 s16, s39
    v_mul_f32 v31, v31, v71
    v_cvt_pk_bf16_f32 v84, v28, v29
    v_mfma_f32_16x16x32_bf16 v[16:19], a[32:35], v[48:51], v[16:19]
    s_waitcnt lgkmcnt(2)
    buffer_load_dword v5, v4, s[4:7], s16 offen sc1
    v_mfma_f32_16x16x32_bf16 v[16:19], a[44:47], v[52:55], v[16:19]
    ds_read_b128 v[48:51], v2 offset:6144
    v_cvt_pk_bf16_f32 v85, v30, v31
    v_mfma_f32_16x16x32_bf16 v[12:15], a[40:43], v[52:55], v[12:15]
    s_cmp_eq_u32 s35, 147456
    s_cselect_b32 s35, 0, s35
    v_fma_f32 v32, -v70, v64, v32
    v_mfma_f32_16x16x32_bf16 v[106:109], v[84:87], v[88:91], 0
    v_fma_f32 v33, -v70, v65, v33
    v_fma_f32 v34, -v70, v66, v34
    v_mfma_f32_16x16x32_bf16 v[8:11], a[36:39], v[52:55], v[8:11]
    s_waitcnt lgkmcnt(2)
    v_fma_f32 v35, -v70, v67, v35
    v_mul_f32 v32, v32, v71
    v_mfma_f32_16x16x32_bf16 v[8:11], a[48:51], v[40:43], v[8:11]
    ds_read_b128 v[52:55], v2 offset:7168
    v_cndmask_b32 v106, v106, v107, s[44:45]
    v_mfma_f32_16x16x32_bf16 v[12:15], a[52:55], v[40:43], v[12:15]
    buffer_load_dwordx4 v[96:99], v1, s[24:27], s41 offen sc1
    v_mfma_f32_16x16x32_bf16 v[16:19], a[56:59], v[40:43], v[16:19]
    s_waitcnt lgkmcnt(2)
    v_cndmask_b32 v108, v108, v109, s[44:45]
    v_cndmask_b32 v120, v106, v118, s[48:49]
    v_mfma_f32_16x16x32_bf16 v[16:19], a[68:71], v[44:47], v[16:19]
    ds_read_b128 v[40:43], v2 offset:8192
    v_cndmask_b32 v121, v108, v119, s[50:51]
    v_mfma_f32_16x16x32_bf16 v[12:15], a[64:67], v[44:47], v[12:15]
    s_add_u32 m0, s34, 0
    v_mul_f32 v33, v33, v71
    v_mul_f32 v34, v34, v71
    v_mfma_f32_16x16x32_bf16 v[8:11], a[60:63], v[44:47], v[8:11]
    s_waitcnt vmcnt(2) lgkmcnt(2)
    buffer_store_dword v6, v21, s[12:15], s17 offen sc1
    v_mfma_f32_16x16x32_bf16 v[8:11], a[72:75], v[48:51], v[8:11]
    ds_read_b128 v[44:47], v2 offset:9216
    v_mul_f32 v35, v35, v71
    v_mfma_f32_16x16x32_bf16 v[12:15], a[76:79], v[48:51], v[12:15]
    s_cmp_ge_i32 s54, 0
    s_cselect_b32 s14, s6, 0
    v_cvt_pk_bf16_f32 v32, v32, v33
    v_mfma_f32_16x16x32_bf16 v[16:19], a[80:83], v[48:51], v[16:19]
    s_waitcnt lgkmcnt(2)
    ds_write_b64 v36, v[120:121] offset:0
    v_mfma_f32_16x16x32_bf16 v[16:19], a[92:95], v[52:55], v[16:19]
    ds_read_b128 v[48:51], v2 offset:10240
    v_cvt_pk_bf16_f32 v33, v34, v35
    v_mfma_f32_16x16x32_bf16 v[12:15], a[88:91], v[52:55], v[12:15]
    s_add_u32 s17, s17, 8192
    v_mul_f32 v124, s52, v69
    v_fma_f32 v24, -v70, v56, v24
    v_mfma_f32_16x16x32_bf16 v[8:11], a[84:87], v[52:55], v[8:11]
    s_waitcnt lgkmcnt(1)
    s_barrier
    v_mfma_f32_16x16x32_bf16 v[8:11], a[96:99], v[40:43], v[8:11]
    ds_read_b128 v[52:55], v2 offset:11264
    v_fma_f32 v25, -v70, v57, v25
    v_mfma_f32_16x16x32_bf16 v[12:15], a[100:103], v[40:43], v[12:15]
    ds_write_b64 v38, v[32:33]
    v_mfma_f32_16x16x32_bf16 v[16:19], a[104:107], v[40:43], v[16:19]
    buffer_load_dwordx4 v1, s[8:11], s33 offen offset:0 sc1 lds
    v_mfma_f32_16x16x32_bf16 v[16:19], a[116:119], v[44:47], v[16:19]
    ds_read_b128 v[40:43], v2 offset:12288
    v_fma_f32 v26, -v70, v58, v26
    v_mfma_f32_16x16x32_bf16 v[12:15], a[112:115], v[44:47], v[12:15]
    ds_read_b64_tr_b16 v[94:95], v39
    v_fma_f32 v27, -v70, v59, v27
    v_mfma_f32_16x16x32_bf16 v[8:11], a[108:111], v[44:47], v[8:11]
    s_waitcnt lgkmcnt(4)
    ds_read_b64 v[122:123], v37 offset:0
    v_mfma_f32_16x16x32_bf16 v[8:11], a[120:123], v[48:51], v[8:11]
    ds_read_b128 v[44:47], v2 offset:13312
    v_cvt_pk_bf16_f32 v88, v24, v25
    v_mfma_f32_16x16x32_bf16 v[12:15], a[124:127], v[48:51], v[12:15]
    buffer_load_dwordx4 v1, s[8:11], s33 offen offset:1024 sc1 lds
    v_mfma_f32_16x16x32_bf16 v[16:19], a[128:131], v[48:51], v[16:19]
    s_waitcnt lgkmcnt(5)
    v_cvt_pk_bf16_f32 v89, v26, v27
    v_add_u32 v3, s35, v1
    v_mfma_f32_16x16x32_bf16 v[16:19], a[140:143], v[52:55], v[16:19]
    ds_read_b128 v[48:51], v2 offset:14336
    v_mfma_f32_16x16x32_bf16 v[110:113], v[84:87], v[88:91], 0
    s_waitcnt lgkmcnt(2)
    v_add_f32 v122, v122, v120
    v_add_f32 v123, v123, v121
    v_mfma_f32_16x16x32_bf16 v[12:15], a[136:139], v[52:55], v[12:15]
    v_max_f32 v22, v122, v123
    v_mov_b32 v23, v22
    v_mfma_f32_16x16x32_bf16 v[8:11], a[132:135], v[52:55], v[8:11]
    buffer_load_dwordx4 v1, s[8:11], s33 offen offset:2048 sc1 lds
    v_mfma_f32_16x16x32_bf16 v[8:11], a[144:147], v[40:43], v[8:11]
    ds_read_b128 v[52:55], v2 offset:15360
    v_cndmask_b32 v118, v110, v111, s[44:45]
    v_mfma_f32_16x16x32_bf16 v[12:15], a[148:151], v[40:43], v[12:15]
    v_permlane16_swap_b32 v22, v23
    v_mfma_f32_16x16x32_bf16 v[16:19], a[152:155], v[40:43], v[16:19]
    s_waitcnt lgkmcnt(2)
    v_max_f32 v22, v22, v23
    v_mov_b32 v23, v22
    v_mfma_f32_16x16x32_bf16 v[16:19], a[164:167], v[44:47], v[16:19]
    ds_read_b128 v[40:43], v2 offset:16384
    v_cndmask_b32 v119, v112, v113, s[44:45]
    v_mfma_f32_16x16x32_bf16 v[12:15], a[160:163], v[44:47], v[12:15]
    buffer_load_dwordx4 v1, s[8:11], s33 offen offset:3072 sc1 lds
    v_mfma_f32_16x16x32_bf16 v[8:11], a[156:159], v[44:47], v[8:11]
    s_waitcnt lgkmcnt(2)
    v_permlane32_swap_b32 v22, v23
    v_mfma_f32_16x16x32_bf16 v[8:11], a[168:171], v[48:51], v[8:11]
    ds_read_b128 v[44:47], v2 offset:17408
    v_max_f32 v22, v22, v23
    v_mfma_f32_16x16x32_bf16 v[12:15], a[172:175], v[48:51], v[12:15]
    s_add_u32 m0, s34, 4096
    v_mul_f32 v22, v124, v22
    v_fma_f32 v122, v122, v124, -v22
    v_mfma_f32_16x16x32_bf16 v[16:19], a[176:179], v[48:51], v[16:19]
    s_waitcnt lgkmcnt(2)
    v_fma_f32 v123, v123, v124, -v22
    s_add_u32 s37, s33, 4096
    v_mfma_f32_16x16x32_bf16 v[16:19], a[188:191], v[52:55], v[16:19]
    ds_read_b128 v[48:51], v2 offset:18432
    v_mfma_f32_16x16x32_bf16 v[12:15], a[184:187], v[52:55], v[12:15]
    buffer_load_dwordx4 v1, s[8:11], s37 offen offset:0 sc1 lds
    v_mfma_f32_16x16x32_bf16 v[8:11], a[180:183], v[52:55], v[8:11]
    s_waitcnt lgkmcnt(2)
    v_exp_f32 v122, v122
    v_mfma_f32_16x16x32_bf16 v[8:11], a[192:195], v[40:43], v[8:11]
    ds_read_b128 v[52:55], v2 offset:19456
    v_mfma_f32_16x16x32_bf16 v[12:15], a[196:199], v[40:43], v[12:15]
    v_exp_f32 v123, v123
    v_mfma_f32_16x16x32_bf16 v[16:19], a[200:203], v[40:43], v[16:19]
    s_waitcnt lgkmcnt(2)
    v_add_f32 v22, v122, v123
    v_mov_b32 v23, v22
    v_mfma_f32_16x16x32_bf16 v[16:19], a[212:215], v[44:47], v[16:19]
    ds_read_b128 v[40:43], v2 offset:20480
    v_mfma_f32_16x16x32_bf16 v[12:15], a[208:211], v[44:47], v[12:15]
    buffer_load_dwordx4 v1, s[8:11], s37 offen offset:1024 sc1 lds
    v_mfma_f32_16x16x32_bf16 v[8:11], a[204:207], v[44:47], v[8:11]
    s_waitcnt lgkmcnt(2)
    v_permlane16_swap_b32 v22, v23
    v_mfma_f32_16x16x32_bf16 v[8:11], a[216:219], v[48:51], v[8:11]
    ds_read_b128 v[44:47], v2 offset:21504
    v_add_f32 v22, v22, v23
    v_mfma_f32_16x16x32_bf16 v[12:15], a[220:223], v[48:51], v[12:15]
    v_mov_b32 v23, v22
    v_sub_u32 v76, v2, v20
    v_mfma_f32_16x16x32_bf16 v[16:19], a[224:227], v[48:51], v[16:19]
    s_waitcnt lgkmcnt(2)
    v_permlane32_swap_b32 v22, v23
    v_mfma_f32_16x16x32_bf16 v[16:19], a[236:239], v[52:55], v[16:19]
    ds_read_b128 v[48:51], v2 offset:22528
    v_add_f32 v22, v22, v23
    v_mfma_f32_16x16x32_bf16 v[12:15], a[232:235], v[52:55], v[12:15]
    buffer_load_dwordx4 v1, s[8:11], s37 offen offset:2048 sc1 lds
    v_mfma_f32_16x16x32_bf16 v[8:11], a[228:231], v[52:55], v[8:11]
    s_waitcnt lgkmcnt(2)
    v_rcp_f32 v22, v22
    v_mfma_f32_16x16x32_bf16 v[8:11], a[240:243], v[40:43], v[8:11]
    ds_read_b128 v[52:55], v2 offset:23552
    v_mul_f32 v122, v122, v22
    v_mfma_f32_16x16x32_bf16 v[12:15], a[244:247], v[40:43], v[12:15]
    ds_read2st64_b64 v[80:83], v76 offset0:66 offset1:67
    v_mul_f32 v123, v123, v22
    v_mfma_f32_16x16x32_bf16 v[16:19], a[248:251], v[40:43], v[16:19]
    s_waitcnt lgkmcnt(3)
    v_cvt_pk_bf16_f32 v23, v122, v123
    v_perm_b32 v116, v23, v23, v102
    v_mfma_f32_16x16x32_bf16 v[16:19], v[132:135], v[44:47], v[16:19]
    ds_read_b128 v[40:43], v2 offset:24576
    v_perm_b32 v117, v23, v23, v103
    v_mfma_f32_16x16x32_bf16 v[12:15], v[128:131], v[44:47], v[12:15]
    buffer_load_dwordx4 v1, s[8:11], s37 offen offset:3072 sc1 lds
    v_mfma_f32_16x16x32_bf16 v[8:11], a[252:255], v[44:47], v[8:11]
    s_waitcnt lgkmcnt(3)
    v_perm_b32 v114, v23, v23, v104
    v_perm_b32 v115, v23, v23, v105
    v_mfma_f32_16x16x32_bf16 v[8:11], v[136:139], v[48:51], v[8:11]
    ds_read_b128 v[44:47], v2 offset:25600
    s_add_u32 m0, s34, 8192
    v_mfma_f32_16x16x32_bf16 v[72:75], v[92:95], v[114:117], 0
    s_add_u32 s37, s33, 8192
    ds_read2st64_b64 v[76:79], v76 offset0:64 offset1:65
    v_mfma_f32_16x16x32_bf16 v[12:15], v[140:143], v[48:51], v[12:15]
    v_mfma_f32_16x16x32_bf16 v[16:19], v[144:147], v[48:51], v[16:19]
    s_waitcnt lgkmcnt(4)
    buffer_load_dwordx4 v1, s[8:11], s37 offen offset:0 sc1 lds
    v_mfma_f32_16x16x32_bf16 v[16:19], v[156:159], v[52:55], v[16:19]
    ds_read_b128 v[48:51], v2 offset:26624
    v_cvt_pk_bf16_f32 v114, v72, v73
    v_mfma_f32_16x16x32_bf16 v[12:15], v[152:155], v[52:55], v[12:15]
    s_add_u32 s31, s31, 1
    v_cvt_pk_bf16_f32 v115, v74, v75
    v_cvt_pk_bf16_f32 v116, v72, v73
    v_mfma_f32_16x16x32_bf16 v[8:11], v[148:151], v[52:55], v[8:11]
    s_waitcnt lgkmcnt(3)
    v_cvt_pk_bf16_f32 v117, v74, v75
    s_sub_u32 s32, s31, 29
    v_mfma_f32_16x16x32_bf16 v[8:11], v[160:163], v[40:43], v[8:11]
    ds_read_b128 v[52:55], v2 offset:27648
    s_min_i32 s32, s32, 32
    v_mfma_f32_16x16x32_bf16 v[12:15], v[164:167], v[40:43], v[12:15]
    s_sub_u32 s54, s31, 2
    v_permlane32_swap_b32 v114, v116
    v_mfma_f32_16x16x32_bf16 v[16:19], v[168:171], v[40:43], v[16:19]
    s_waitcnt lgkmcnt(3)
    v_permlane32_swap_b32 v115, v117
    v_mfma_f32_16x16x32_bf16 v[16:19], v[180:183], v[44:47], v[16:19]
    ds_read_b128 v[40:43], v2 offset:28672
    v_mov_b32 v6, s54
    v_mfma_f32_16x16x32_bf16 v[12:15], v[176:179], v[44:47], v[12:15]
    buffer_store_dwordx4 v[114:117], v7, s[12:15], s36 offen sc1
    s_waitcnt lgkmcnt(3)
    v_mfma_f32_16x16x32_bf16 v[8:11], v[172:175], v[44:47], v[8:11]
    s_waitcnt lgkmcnt(2)
    v_add_f32 v76, v76, v80
    v_add_f32 v77, v77, v81
    v_mfma_f32_16x16x32_bf16 v[8:11], v[184:187], v[48:51], v[8:11]
    ds_read_b128 v[44:47], v2 offset:29696
    v_add_f32 v78, v78, v82
    v_mfma_f32_16x16x32_bf16 v[12:15], v[188:191], v[48:51], v[12:15]
    s_add_u32 s36, s36, 32768
    v_add_f32 v79, v79, v83
    v_add_f32 v68, v76, v78
    v_mfma_f32_16x16x32_bf16 v[16:19], v[192:195], v[48:51], v[16:19]
    s_waitcnt lgkmcnt(2)
    v_add_f32 v69, v77, v79
    s_min_i32 s39, s32, 31
    v_mfma_f32_16x16x32_bf16 v[16:19], v[204:207], v[52:55], v[16:19]
    ds_read_b128 v[48:51], v2 offset:30720
    s_min_u32 s39, s39, 0x1000
    v_mfma_f32_16x16x32_bf16 v[12:15], v[200:203], v[52:55], v[12:15]
    s_lshl_b32 s39, s39, 13
    v_permlane16_swap_b32 v68, v69
    v_mfma_f32_16x16x32_bf16 v[8:11], v[196:199], v[52:55], v[8:11]
    s_waitcnt lgkmcnt(2)
    v_add_f32 v68, v68, v69
    v_mov_b32 v69, v68
    v_mfma_f32_16x16x32_bf16 v[8:11], v[208:211], v[40:43], v[8:11]
    ds_read_b128 v[52:55], v2 offset:31744
    s_add_u32 s33, s33, 34816
    v_mfma_f32_16x16x32_bf16 v[12:15], v[212:215], v[40:43], v[12:15]
    s_add_u32 s34, s34, 36864
    v_permlane32_swap_b32 v68, v69
    v_mfma_f32_16x16x32_bf16 v[16:19], v[216:219], v[40:43], v[16:19]
    s_waitcnt lgkmcnt(2)
    v_add_f32 v68, v68, v69
    v_mul_f32 v68, 0x3a800000, v68
    v_mfma_f32_16x16x32_bf16 v[16:19], v[228:231], v[44:47], v[16:19]
    ds_read_b128 v[40:43], v3 offset:0
    v_mov_b32 v69, v68
    v_mfma_f32_16x16x32_bf16 v[12:15], v[224:227], v[44:47], v[12:15]
    s_cmp_ge_u32 s34, 147456
    s_cselect_b32 s38, 147456, 0
    s_sub_u32 s34, s34, s38
    v_mfma_f32_16x16x32_bf16 v[8:11], v[220:223], v[44:47], v[8:11]
    s_waitcnt lgkmcnt(2)
    v_permlane16_swap_b32 v68, v69
    v_mfma_f32_16x16x32_bf16 v[8:11], v[232:235], v[48:51], v[8:11]
    ds_read_b128 v[44:47], v3 offset:1024
    v_fma_f32 v69, -v68, v68, v69
    v_mfma_f32_16x16x32_bf16 v[12:15], v[236:239], v[48:51], v[12:15]
    v_max_f32 v69, 0, v69
    v_add_f32 v69, 0x3727c5ac, v69
    v_mfma_f32_16x16x32_bf16 v[16:19], v[240:243], v[48:51], v[16:19]
    s_waitcnt lgkmcnt(2)
    v_rsq_f32 v69, v69
    v_mfma_f32_16x16x32_bf16 v[16:19], v[252:255], v[52:55], v[16:19]
    ds_read_b128 v[48:51], v3 offset:2048
    v_mfma_f32_16x16x32_bf16 v[12:15], v[248:251], v[52:55], v[12:15]
    v_mfma_f32_16x16x32_bf16 v[8:11], v[244:247], v[52:55], v[8:11]
    s_and_b32 s37, s31, 30
    s_cbranch_scc1 Lqkv_g10
    s_branch Lqkv_s10
Lqkv_slows10:
Lqkv_spins10:
    buffer_load_dword v5, v4, s[4:7], s16 offen sc1
    s_waitcnt vmcnt(0)
    v_cmp_gt_i32 vcc, s32, v5
    s_sub_u32 s43, s43, 1
    s_cmp_lt_i32 s43, 0
    s_cbranch_scc1 Lqkv_backs10
    s_and_b64 vcc, vcc, s[18:19]
    s_cbranch_scc0 Lqkv_backs10
    s_sleep 8
    s_branch Lqkv_spins10
Lqkv_slowg10:
Lqkv_sping10:
    buffer_load_dword v5, v4, s[4:7], s16 offen sc1
    s_waitcnt vmcnt(0)
    v_cmp_gt_i32 vcc, s32, v5
    s_sub_u32 s43, s43, 1
    s_cmp_lt_i32 s43, 0
    s_cbranch_scc1 Lqkv_backg10
    s_and_b64 vcc, vcc, s[18:19]
    s_cbranch_scc0 Lqkv_backg10
    s_sleep 8
    s_branch Lqkv_sping10
Lqkv_slowg00:
Lqkv_sping00:
    buffer_load_dword v5, v4, s[4:7], s16 offen sc1
    s_waitcnt vmcnt(0)
    v_cmp_gt_i32 vcc, s32, v5
    s_sub_u32 s43, s43, 1
    s_cmp_lt_i32 s43, 0
    s_cbranch_scc1 Lqkv_backg00
    s_and_b64 vcc, vcc, s[18:19]
    s_cbranch_scc0 Lqkv_backg00
    s_sleep 8
    s_branch Lqkv_sping00
Lqkv_tail:
    v_mul_f32 v124, s52, v69
    v_mov_b32 v6, s54
    s_nop 4
    v_fma_f32 v28, -v70, v60, v28
    v_fma_f32 v29, -v70, v61, v29
    v_fma_f32 v30, -v70, v62, v30
    v_fma_f32 v31, -v70, v63, v31
    v_mul_f32 v28, v28, v71
    v_mul_f32 v29, v29, v71
    v_mul_f32 v30, v30, v71
    v_mul_f32 v31, v31, v71
    v_cvt_pk_bf16_f32 v84, v28, v29
    v_cvt_pk_bf16_f32 v85, v30, v31
    v_fma_f32 v32, -v70, v64, v32
    v_fma_f32 v33, -v70, v65, v33
    v_mfma_f32_16x16x32_bf16 v[106:109], v[84:87], v[88:91], 0
    v_fma_f32 v34, -v70, v66, v34
    v_fma_f32 v35, -v70, v67, v35
    v_mul_f32 v32, v32, v71
    v_mul_f32 v33, v33, v71
    v_mul_f32 v34, v34, v71
    v_mul_f32 v35, v35, v71
    v_cvt_pk_bf16_f32 v32, v32, v33
    v_cvt_pk_bf16_f32 v33, v34, v35
    v_cndmask_b32 v106, v106, v107, s[44:45]
    v_cndmask_b32 v108, v108, v109, s[44:45]
    v_cndmask_b32 v120, v106, v118, s[48:49]
    v_cndmask_b32 v121, v108, v119, s[50:51]
    ds_write_b64 v36, v[120:121] offset:0
    ds_write_b64 v38, v[32:33]
    ds_read_b64_tr_b16 v[94:95], v39
    v_fma_f32 v24, -v70, v56, v24
    v_fma_f32 v25, -v70, v57, v25
    v_fma_f32 v26, -v70, v58, v26
    v_fma_f32 v27, -v70, v59, v27
    v_cvt_pk_bf16_f32 v88, v24, v25
    v_cvt_pk_bf16_f32 v89, v26, v27
    s_nop 1
    v_mfma_f32_16x16x32_bf16 v[110:113], v[84:87], v[88:91], 0
    s_nop 7
    v_cndmask_b32 v118, v110, v111, s[44:45]
    v_cndmask_b32 v119, v112, v113, s[44:45]
    s_waitcnt lgkmcnt(2)
    s_barrier
    ds_read_b64 v[122:123], v37 offset:0
    s_waitcnt lgkmcnt(0)
    v_add_f32 v122, v122, v120
    v_add_f32 v123, v123, v121
    v_max_f32 v22, v122, v123
    v_mov_b32 v23, v22
    s_nop 1
    v_permlane16_swap_b32 v22, v23
    v_max_f32 v22, v22, v23
    v_mov_b32 v23, v22
    s_nop 1
    v_permlane32_swap_b32 v22, v23
    v_max_f32 v22, v22, v23
    v_mul_f32 v22, v124, v22
    v_fma_f32 v122, v122, v124, -v22
    v_fma_f32 v123, v123, v124, -v22
    v_exp_f32 v122, v122
    v_exp_f32 v123, v123
    s_nop 0
    v_add_f32 v22, v122, v123
    v_mov_b32 v23, v22
    s_nop 1
    v_permlane16_swap_b32 v22, v23
    v_add_f32 v22, v22, v23
    v_mov_b32 v23, v22
    s_nop 1
    v_permlane32_swap_b32 v22, v23
    v_add_f32 v22, v22, v23
    v_rcp_f32 v22, v22
    s_nop 0
    v_mul_f32 v122, v122, v22
    v_mul_f32 v123, v123, v22
    v_cvt_pk_bf16_f32 v23, v122, v123
    v_perm_b32 v116, v23, v23, v102
    v_perm_b32 v117, v23, v23, v103
    v_perm_b32 v114, v23, v23, v104
    v_perm_b32 v115, v23, v23, v105
    s_nop 1
    v_mfma_f32_16x16x32_bf16 v[72:75], v[92:95], v[114:117], 0
    s_nop 7
    v_cvt_pk_bf16_f32 v114, v72, v73
    v_cvt_pk_bf16_f32 v115, v74, v75
    v_cvt_pk_bf16_f32 v116, v72, v73
    v_cvt_pk_bf16_f32 v117, v74, v75
    s_nop 0
    v_permlane32_swap_b32 v114, v116
    v_permlane32_swap_b32 v115, v117
    s_waitcnt vmcnt(0)
    buffer_store_dword v6, v21, s[12:15], s17 offen sc1
    buffer_store_dwordx4 v[114:117], v7, s[12:15], s36 offen sc1
    s_add_u32 s36, s36, 32768
    v_mov_b32 v106, s42
    v_mov_b32 v107, s42
    v_mov_b32 v108, s42
    v_mov_b32 v109, s42
    v_mul_f32 v124, s52, v71
    s_nop 0
    v_mfma_f32_16x16x32_bf16 v[106:109], v[96:99], v[88:91], v[106:109]
    s_nop 7
    v_cndmask_b32 v106, v106, v107, s[44:45]
    v_cndmask_b32 v108, v108, v109, s[44:45]
    v_cndmask_b32 v120, v106, v118, s[48:49]
    v_cndmask_b32 v121, v108, v119, s[50:51]
    ds_write_b64 v36, v[120:121] offset:2048
    s_waitcnt lgkmcnt(0)
    s_barrier
    ds_read_b64 v[122:123], v37 offset:2048
    s_waitcnt lgkmcnt(0)
    v_add_f32 v122, v122, v120
    v_add_f32 v123, v123, v121
    v_max_f32 v22, v122, v123
    v_mov_b32 v23, v22
    s_nop 1
    v_permlane16_swap_b32 v22, v23
    v_max_f32 v22, v22, v23
    v_mov_b32 v23, v22
    s_nop 1
    v_permlane32_swap_b32 v22, v23
    v_max_f32 v22, v22, v23
    v_mul_f32 v22, v124, v22
    v_fma_f32 v122, v122, v124, -v22
    v_fma_f32 v123, v123, v124, -v22
    v_exp_f32 v122, v122
    v_exp_f32 v123, v123
    s_nop 0
    v_add_f32 v22, v122, v123
    v_mov_b32 v23, v22
    s_nop 1
    v_permlane16_swap_b32 v22, v23
    v_add_f32 v22, v22, v23
    v_mov_b32 v23, v22
    s_nop 1
    v_permlane32_swap_b32 v22, v23
    v_add_f32 v22, v22, v23
    v_rcp_f32 v22, v22
    s_nop 0
    v_mul_f32 v122, v122, v22
    v_mul_f32 v123, v123, v22
    v_cvt_pk_bf16_f32 v23, v122, v123
    v_perm_b32 v114, v23, v23, v102
    v_perm_b32 v115, v23, v23, v103
    v_perm_b32 v116, v23, v23, v104
    v_perm_b32 v117, v23, v23, v105
    v_mov_b32 v100, v94
    v_mov_b32 v101, v95
    s_nop 1
    v_mfma_f32_16x16x32_bf16 v[72:75], v[98:101], v[114:117], 0
    s_nop 7
    v_cvt_pk_bf16_f32 v114, v72, v73
    v_cvt_pk_bf16_f32 v115, v74, v75
    v_cvt_pk_bf16_f32 v116, v72, v73
    v_cvt_pk_bf16_f32 v117, v74, v75
    s_nop 0
    v_permlane32_swap_b32 v114, v116
    v_permlane32_swap_b32 v115, v117
    buffer_store_dwordx4 v[114:117], v7, s[12:15], s36 offen sc1
    s_add_u32 s36, s36, 32768
    v_mov_b32 v8, 63
    s_waitcnt vmcnt(1)
    s_add_u32 s17, s17, 8192
    buffer_store_dword v8, v21, s[12:15], s17 offen sc1
    v_mov_b32 v9, 64
    s_waitcnt vmcnt(1)
    s_add_u32 s17, s17, 8192
    buffer_store_dword v9, v21, s[12:15], s17 offen sc1
    s_branch L_exit
Lwo_start:
    s_mov_b32 s12, s68
    s_mov_b32 s13, s69
    s_mov_b32 s14, 0x200000
    s_mov_b32 s15, 0x00020000
    v_lshrrev_b32 v24, 3, v0
    v_mul_u32_u24 v24, 2048, v24
    v_bfe_u32 v25, v0, 4, 2
    v_lshlrev_b32 v25, 1, v25
    v_and_b32 v26, 7, v0
    v_xor_b32 v25, v25, v26
    v_lshl_add_u32 v40, v25, 4, v24
    v_add_u32 v41, 15360, v40
    s_mul_i32 s86, s29, 0x100
    s_add_u32 s86, s86, 0xfffff000
    s_mul_i32 s37, s30, 32768
    s_add_u32 s86, s86, s37
    s_lshl_b32 s87, s30, 11
    s_add_u32 m0, s87, 0
    s_add_u32 s37, s86, 0
    buffer_load_dwordx4 v40, s[12:15], s37 offen offset:0 lds
    buffer_load_dwordx4 v41, s[12:15], s37 offen offset:1024 lds
    s_add_u32 m0, s87, 8192
    s_add_u32 s37, s86, 128
    buffer_load_dwordx4 v40, s[12:15], s37 offen offset:0 lds
    buffer_load_dwordx4 v41, s[12:15], s37 offen offset:1024 lds
    s_add_u32 m0, s87, 16384
    s_add_u32 s37, s86, 131072
    buffer_load_dwordx4 v40, s[12:15], s37 offen offset:0 lds
    buffer_load_dwordx4 v41, s[12:15], s37 offen offset:1024 lds
    s_add_u32 m0, s87, 24576
    s_add_u32 s37, s86, 131200
    buffer_load_dwordx4 v40, s[12:15], s37 offen offset:0 lds
    buffer_load_dwordx4 v41, s[12:15], s37 offen offset:1024 lds
    s_add_u32 m0, s87, 32768
    s_add_u32 s37, s86, 262144
    buffer_load_dwordx4 v40, s[12:15], s37 offen offset:0 lds
    buffer_load_dwordx4 v41, s[12:15], s37 offen offset:1024 lds
    s_add_u32 m0, s87, 40960
    s_add_u32 s37, s86, 262272
    buffer_load_dwordx4 v40, s[12:15], s37 offen offset:0 lds
    buffer_load_dwordx4 v41, s[12:15], s37 offen offset:1024 lds
    s_add_u32 m0, s87, 49152
    s_add_u32 s37, s86, 393216
    buffer_load_dwordx4 v40, s[12:15], s37 offen offset:0 lds
    buffer_load_dwordx4 v41, s[12:15], s37 offen offset:1024 lds
    s_add_u32 m0, s87, 57344
    s_add_u32 s37, s86, 393344
    buffer_load_dwordx4 v40, s[12:15], s37 offen offset:0 lds
    buffer_load_dwordx4 v41, s[12:15], s37 offen offset:1024 lds
    s_add_u32 m0, s87, 65536
    s_add_u32 s37, s86, 524288
    buffer_load_dwordx4 v40, s[12:15], s37 offen offset:0 lds
    buffer_load_dwordx4 v41, s[12:15], s37 offen offset:1024 lds
    s_add_u32 m0, s87, 73728
    s_add_u32 s37, s86, 524416
    buffer_load_dwordx4 v40, s[12:15], s37 offen offset:0 lds
    buffer_load_dwordx4 v41, s[12:15], s37 offen offset:1024 lds
    s_add_u32 m0, s87, 81920
    s_add_u32 s37, s86, 655360
    buffer_load_dwordx4 v40, s[12:15], s37 offen offset:0 lds
    buffer_load_dwordx4 v41, s[12:15], s37 offen offset:1024 lds
    s_add_u32 m0, s87, 90112
    s_add_u32 s37, s86, 655488
    buffer_load_dwordx4 v40, s[12:15], s37 offen offset:0 lds
    buffer_load_dwordx4 v41, s[12:15], s37 offen offset:1024 lds
    s_add_u32 m0, s87, 98304
    s_add_u32 s37, s86, 786432
    buffer_load_dwordx4 v40, s[12:15], s37 offen offset:0 lds
    buffer_load_dwordx4 v41, s[12:15], s37 offen offset:1024 lds
    s_add_u32 m0, s87, 106496
    s_add_u32 s37, s86, 786560
    buffer_load_dwordx4 v40, s[12:15], s37 offen offset:0 lds
    buffer_load_dwordx4 v41, s[12:15], s37 offen offset:1024 lds
    s_add_u32 m0, s87, 114688
    s_add_u32 s37, s86, 917504
    buffer_load_dwordx4 v40, s[12:15], s37 offen offset:0 lds
    buffer_load_dwordx4 v41, s[12:15], s37 offen offset:1024 lds
    s_add_u32 m0, s87, 122880
    s_add_u32 s37, s86, 917632
    buffer_load_dwordx4 v40, s[12:15], s37 offen offset:0 lds
    buffer_load_dwordx4 v41, s[12:15], s37 offen offset:1024 lds
    s_add_u32 m0, s87, 131072
    s_add_u32 s37, s86, 1048576
    buffer_load_dwordx4 v40, s[12:15], s37 offen offset:0 lds
    buffer_load_dwordx4 v41, s[12:15], s37 offen offset:1024 lds
    s_add_u32 m0, s87, 139264
    s_add_u32 s37, s86, 1048704
    buffer_load_dwordx4 v40, s[12:15], s37 offen offset:0 lds
    buffer_load_dwordx4 v41, s[12:15], s37 offen offset:1024 lds
    v_bfe_u32 v24, v0, 3, 2
    v_and_b32 v25, 3, v0
    v_lshlrev_b32 v25, 3, v25
    v_lshrrev_b32 v26, 2, v0
    v_lshl_add_u32 v26, v26, 7, v25
    v_lshrrev_b32 v27, 5, v0
    v_lshl_add_u32 v27, v27, 10, v26
    s_lshr_b32 s37, s30, 1
    s_and_b32 s38, s30, 1
    s_lshl_b32 s38, s38, 1
    s_add_u32 s38, s38, 0
    s_lshl_b32 s37, s37, 13
    v_xor_b32 v28, s38, v24
    v_lshl_add_u32 v28, v28, 5, s37
    v_add_u32 v42, v28, v26
    v_add_u32 v46, v28, v27
    s_lshr_b32 s37, s30, 1
    s_and_b32 s38, s30, 1
    s_lshl_b32 s38, s38, 1
    s_add_u32 s38, s38, 1
    s_lshl_b32 s37, s37, 13
    v_xor_b32 v28, s38, v24
    v_lshl_add_u32 v28, v28, 5, s37
    v_add_u32 v43, v28, v26
    v_add_u32 v47, v28, v27
    v_mov_b32 v84, 0x3f803f80
    v_mov_b32 v85, 0x3f803f80
    v_mov_b32 v86, 0x3f803f80
    v_mov_b32 v87, 0x3f803f80
    s_mov_b32 s44, 0xaaaaaaaa
    s_mov_b32 s45, 0xaaaaaaaa
    s_mov_b32 s46, 0xcccccccc
    s_mov_b32 s47, 0xcccccccc
    s_mov_b32 s38, 0xf0000f
    s_mov_b32 s39, 0xf0000f00
    v_and_b32 v8, 15, v0
    v_lshlrev_b32 v8, 3, v8
    v_mov_b32 v7, 0x40000000
    v_cndmask_b32 v7, v7, v8, s[38:39]
    s_mul_i32 s37, s29, 0xfffff200
    s_mul_i32 s53, s30, 0xfffffc80
    s_add_u32 s37, s37, s53
    s_add_u32 s37, s37, 0x16000
    v_add_u32 v7, s37, v7
    v_mov_b32 v88, 0
    v_mov_b32 v89, 0
    v_mov_b32 v92, 0
    v_mov_b32 v93, 0
    v_mov_b32 v8, 0x3f80
    v_mov_b32 v9, 0x3f800000
    s_mov_b32 s38, 0x100001
    s_mov_b32 s39, 0x10000100
    v_cndmask_b32 v90, v88, v8, s[38:39]
    s_mov_b32 s38, 0x200002
    s_mov_b32 s39, 0x20000200
    v_cndmask_b32 v90, v90, v9, s[38:39]
    s_mov_b32 s38, 0x400004
    s_mov_b32 s39, 0x40000400
    v_cndmask_b32 v91, v88, v8, s[38:39]
    s_mov_b32 s38, 0x800008
    s_mov_b32 s39, 0x80000800
    v_cndmask_b32 v91, v91, v9, s[38:39]
    s_mul_i32 s37, s28, 0x80000
    s_add_u32 s37, s37, 0x6000000
    v_min_u32 v4, 63, v0
    v_lshl_add_u32 v4, v4, 5, s37
    s_mov_b32 s32, 1
    s_mul_i32 s33, s28, 0x200000
    s_add_u32 s33, s33, 0xa00000
    s_mul_i32 s40, s28, 0x220000
    s_mul_i32 s53, s29, 0x1000
    s_add_u32 s40, s40, s53
    s_mul_i32 s53, s30, 0x400
    s_add_u32 s40, s40, s53
    s_add_u32 s40, s40, 0xffff0000
    s_mul_i32 s36, s28, 0x240000
    s_mul_i32 s53, s29, 0x1000
    s_add_u32 s36, s36, s53
    s_mul_i32 s53, s30, 0x400
    s_add_u32 s36, s36, s53
    s_add_u32 s36, s36, 0x11e7000
    s_mov_b32 s31, -1
    s_mov_b32 s35, 0
    s_mov_b32 s16, 0
    v_mov_b32 v5, 0
    s_mul_i32 s17, s28, 0x80000
    s_mul_i32 s53, s29, 0x80
    s_add_u32 s17, s17, s53
    s_mul_i32 s53, s30, 0x20
    s_add_u32 s17, s17, s53
    s_add_u32 s17, s17, 0x5ffe000
    v_cmp_eq_u32 vcc, 0, v0
    v_mov_b32 v102, 0x40000000
    s_nop 0
    v_cndmask_b32 v102, v102, v0, vcc
    v_mov_b32 v2, v1
    s_mul_i32 s34, s30, 4096
    s_mul_i32 s3, s30, 0x0
    s_add_u32 s3, s3, 0x4000
    s_add_u32 s41, s3, 4096
    s_add_u32 s33, s33, s34
    s_mov_b64 s[18:19], -1
    v_mov_b32 v8, 0x40000000
    v_cndmask_b32 v4, v8, v4, s[18:19]
    v_add_u32 v12, 0, v46
    v_add_u32 v13, 0, v47
    s_waitcnt vmcnt(32) lgkmcnt(0)
    s_barrier
    s_add_u32 m0, s87, 147456
    s_add_u32 s37, s86, 1179648
    buffer_load_dwordx4 v40, s[12:15], s37 offen offset:0 lds
    ds_read_b64_tr_b16 a[0:1], v12 offset:0
    ds_read_b64_tr_b16 a[2:3], v12 offset:1024
    ds_read_b64_tr_b16 a[4:5], v13 offset:0
    buffer_load_dwordx4 v41, s[12:15], s37 offen offset:1024 lds
    ds_read_b64_tr_b16 a[6:7], v13 offset:1024
    ds_read_b64_tr_b16 a[8:9], v12 offset:4096
    ds_read_b64_tr_b16 a[10:11], v12 offset:5120
    s_add_u32 m0, s87, 155648
    s_add_u32 s37, s86, 1179776
    buffer_load_dwordx4 v40, s[12:15], s37 offen offset:0 lds
    ds_read_b64_tr_b16 a[12:13], v13 offset:4096
    ds_read_b64_tr_b16 a[14:15], v13 offset:5120
    v_add_u32 v16, 16384, v46
    buffer_load_dwordx4 v41, s[12:15], s37 offen offset:1024 lds
    v_add_u32 v17, 16384, v47
    s_waitcnt vmcnt(32) lgkmcnt(0)
    s_barrier
    s_add_u32 m0, s87, 0
    s_add_u32 s37, s86, 1310720
    buffer_load_dwordx4 v40, s[12:15], s37 offen offset:0 lds
    ds_read_b64_tr_b16 a[16:17], v16 offset:0
    ds_read_b64_tr_b16 a[18:19], v16 offset:1024
    ds_read_b64_tr_b16 a[20:21], v17 offset:0
    buffer_load_dwordx4 v41, s[12:15], s37 offen offset:1024 lds
    ds_read_b64_tr_b16 a[22:23], v17 offset:1024
    ds_read_b64_tr_b16 a[24:25], v16 offset:4096
    ds_read_b64_tr_b16 a[26:27], v16 offset:5120
    s_add_u32 m0, s87, 8192
    s_add_u32 s37, s86, 1310848
    buffer_load_dwordx4 v40, s[12:15], s37 offen offset:0 lds
    ds_read_b64_tr_b16 a[28:29], v17 offset:4096
    ds_read_b64_tr_b16 a[30:31], v17 offset:5120
    v_add_u32 v12, 32768, v46
    buffer_load_dwordx4 v41, s[12:15], s37 offen offset:1024 lds
    v_add_u32 v13, 32768, v47
    s_waitcnt vmcnt(32) lgkmcnt(0)
    s_barrier
    s_add_u32 m0, s87, 16384
    s_add_u32 s37, s86, 1441792
    buffer_load_dwordx4 v40, s[12:15], s37 offen offset:0 lds
    ds_read_b64_tr_b16 a[32:33], v12 offset:0
    ds_read_b64_tr_b16 a[34:35], v12 offset:1024
    ds_read_b64_tr_b16 a[36:37], v13 offset:0
    buffer_load_dwordx4 v41, s[12:15], s37 offen offset:1024 lds
    ds_read_b64_tr_b16 a[38:39], v13 offset:1024
    ds_read_b64_tr_b16 a[40:41], v12 offset:4096
    ds_read_b64_tr_b16 a[42:43], v12 offset:5120
    s_add_u32 m0, s87, 24576
    s_add_u32 s37, s86, 1441920
    buffer_load_dwordx4 v40, s[12:15], s37 offen offset:0 lds
    ds_read_b64_tr_b16 a[44:45], v13 offset:4096
    ds_read_b64_tr_b16 a[46:47], v13 offset:5120
    v_add_u32 v16, 49152, v46
    buffer_load_dwordx4 v41, s[12:15], s37 offen offset:1024 lds
    v_add_u32 v17, 49152, v47
    s_waitcnt vmcnt(32) lgkmcnt(0)
    s_barrier
    s_add_u32 m0, s87, 32768
    s_add_u32 s37, s86, 1572864
    buffer_load_dwordx4 v40, s[12:15], s37 offen offset:0 lds
    ds_read_b64_tr_b16 a[48:49], v16 offset:0
    ds_read_b64_tr_b16 a[50:51], v16 offset:1024
    ds_read_b64_tr_b16 a[52:53], v17 offset:0
    buffer_load_dwordx4 v41, s[12:15], s37 offen offset:1024 lds
    ds_read_b64_tr_b16 a[54:55], v17 offset:1024
    ds_read_b64_tr_b16 a[56:57], v16 offset:4096
    ds_read_b64_tr_b16 a[58:59], v16 offset:5120
    s_add_u32 m0, s87, 40960
    s_add_u32 s37, s86, 1572992
    buffer_load_dwordx4 v40, s[12:15], s37 offen offset:0 lds
    ds_read_b64_tr_b16 a[60:61], v17 offset:4096
    ds_read_b64_tr_b16 a[62:63], v17 offset:5120
    v_add_u32 v12, 65536, v46
    buffer_load_dwordx4 v41, s[12:15], s37 offen offset:1024 lds
    v_add_u32 v13, 65536, v47
    s_waitcnt vmcnt(32) lgkmcnt(0)
    s_barrier
    s_add_u32 m0, s87, 49152
    s_add_u32 s37, s86, 1703936
    buffer_load_dwordx4 v40, s[12:15], s37 offen offset:0 lds
    ds_read_b64_tr_b16 a[64:65], v12 offset:0
    ds_read_b64_tr_b16 a[66:67], v12 offset:1024
    ds_read_b64_tr_b16 a[68:69], v13 offset:0
    buffer_load_dwordx4 v41, s[12:15], s37 offen offset:1024 lds
    ds_read_b64_tr_b16 a[70:71], v13 offset:1024
    ds_read_b64_tr_b16 a[72:73], v12 offset:4096
    ds_read_b64_tr_b16 a[74:75], v12 offset:5120
    s_add_u32 m0, s87, 57344
    s_add_u32 s37, s86, 1704064
    buffer_load_dwordx4 v40, s[12:15], s37 offen offset:0 lds
    ds_read_b64_tr_b16 a[76:77], v13 offset:4096
    ds_read_b64_tr_b16 a[78:79], v13 offset:5120
    v_add_u32 v16, 81920, v46
    buffer_load_dwordx4 v41, s[12:15], s37 offen offset:1024 lds
    v_add_u32 v17, 81920, v47
    s_waitcnt vmcnt(32) lgkmcnt(0)
    s_barrier
    s_add_u32 m0, s87, 65536
    s_add_u32 s37, s86, 1835008
    buffer_load_dwordx4 v40, s[12:15], s37 offen offset:0 lds
    ds_read_b64_tr_b16 a[80:81], v16 offset:0
    ds_read_b64_tr_b16 a[82:83], v16 offset:1024
    ds_read_b64_tr_b16 a[84:85], v17 offset:0
    buffer_load_dwordx4 v41, s[12:15], s37 offen offset:1024 lds
    ds_read_b64_tr_b16 a[86:87], v17 offset:1024
    ds_read_b64_tr_b16 a[88:89], v16 offset:4096
    ds_read_b64_tr_b16 a[90:91], v16 offset:5120
    s_add_u32 m0, s87, 73728
    s_add_u32 s37, s86, 1835136
    buffer_load_dwordx4 v40, s[12:15], s37 offen offset:0 lds
    ds_read_b64_tr_b16 a[92:93], v17 offset:4096
    ds_read_b64_tr_b16 a[94:95], v17 offset:5120
    v_add_u32 v12, 98304, v46
    buffer_load_dwordx4 v41, s[12:15], s37 offen offset:1024 lds
    v_add_u32 v13, 98304, v47
    s_waitcnt vmcnt(32) lgkmcnt(0)
    s_barrier
    s_add_u32 m0, s87, 81920
    s_add_u32 s37, s86, 1966080
    buffer_load_dwordx4 v40, s[12:15], s37 offen offset:0 lds
    ds_read_b64_tr_b16 a[96:97], v12 offset:0
    ds_read_b64_tr_b16 a[98:99], v12 offset:1024
    ds_read_b64_tr_b16 a[100:101], v13 offset:0
    buffer_load_dwordx4 v41, s[12:15], s37 offen offset:1024 lds
    ds_read_b64_tr_b16 a[102:103], v13 offset:1024
    ds_read_b64_tr_b16 a[104:105], v12 offset:4096
    ds_read_b64_tr_b16 a[106:107], v12 offset:5120
    s_add_u32 m0, s87, 90112
    s_add_u32 s37, s86, 1966208
    buffer_load_dwordx4 v40, s[12:15], s37 offen offset:0 lds
    ds_read_b64_tr_b16 a[108:109], v13 offset:4096
    ds_read_b64_tr_b16 a[110:111], v13 offset:5120
    v_add_u32 v16, 114688, v46
    buffer_load_dwordx4 v41, s[12:15], s37 offen offset:1024 lds
    v_add_u32 v17, 114688, v47
    s_waitcnt vmcnt(32) lgkmcnt(0)
    s_barrier
    ds_read_b64_tr_b16 a[112:113], v16 offset:0
    ds_read_b64_tr_b16 a[114:115], v16 offset:1024
    ds_read_b64_tr_b16 a[116:117], v17 offset:0
    ds_read_b64_tr_b16 a[118:119], v17 offset:1024
    ds_read_b64_tr_b16 a[120:121], v16 offset:4096
    ds_read_b64_tr_b16 a[122:123], v16 offset:5120
    ds_read_b64_tr_b16 a[124:125], v17 offset:4096
    ds_read_b64_tr_b16 a[126:127], v17 offset:5120
    v_add_u32 v12, 131072, v46
    v_add_u32 v13, 131072, v47
    s_waitcnt vmcnt(28) lgkmcnt(0)
    s_barrier
    ds_read_b64_tr_b16 a[128:129], v12 offset:0
    ds_read_b64_tr_b16 a[130:131], v12 offset:1024
    ds_read_b64_tr_b16 a[132:133], v13 offset:0
    ds_read_b64_tr_b16 a[134:135], v13 offset:1024
    ds_read_b64_tr_b16 a[136:137], v12 offset:4096
    ds_read_b64_tr_b16 a[138:139], v12 offset:5120
    ds_read_b64_tr_b16 a[140:141], v13 offset:4096
    ds_read_b64_tr_b16 a[142:143], v13 offset:5120
    v_add_u32 v16, 147456, v46
    v_add_u32 v17, 147456, v47
    s_waitcnt vmcnt(24) lgkmcnt(0)
    s_barrier
    ds_read_b64_tr_b16 a[144:145], v16 offset:0
    ds_read_b64_tr_b16 a[146:147], v16 offset:1024
    ds_read_b64_tr_b16 a[148:149], v17 offset:0
    ds_read_b64_tr_b16 a[150:151], v17 offset:1024
    ds_read_b64_tr_b16 a[152:153], v16 offset:4096
    ds_read_b64_tr_b16 a[154:155], v16 offset:5120
    ds_read_b64_tr_b16 a[156:157], v17 offset:4096
    ds_read_b64_tr_b16 a[158:159], v17 offset:5120
    v_add_u32 v12, 0, v46
    v_add_u32 v13, 0, v47
    s_waitcnt vmcnt(20) lgkmcnt(0)
    s_barrier
    ds_read_b64_tr_b16 a[160:161], v12 offset:0
    ds_read_b64_tr_b16 a[162:163], v12 offset:1024
    ds_read_b64_tr_b16 a[164:165], v13 offset:0
    ds_read_b64_tr_b16 a[166:167], v13 offset:1024
    ds_read_b64_tr_b16 a[168:169], v12 offset:4096
    ds_read_b64_tr_b16 a[170:171], v12 offset:5120
    ds_read_b64_tr_b16 a[172:173], v13 offset:4096
    ds_read_b64_tr_b16 a[174:175], v13 offset:5120
    v_add_u32 v16, 16384, v46
    v_add_u32 v17, 16384, v47
    s_waitcnt vmcnt(16) lgkmcnt(0)
    s_barrier
    ds_read_b64_tr_b16 a[176:177], v16 offset:0
    ds_read_b64_tr_b16 a[178:179], v16 offset:1024
    ds_read_b64_tr_b16 a[180:181], v17 offset:0
    ds_read_b64_tr_b16 a[182:183], v17 offset:1024
    ds_read_b64_tr_b16 a[184:185], v16 offset:4096
    ds_read_b64_tr_b16 a[186:187], v16 offset:5120
    ds_read_b64_tr_b16 a[188:189], v17 offset:4096
    ds_read_b64_tr_b16 a[190:191], v17 offset:5120
    v_add_u32 v12, 32768, v46
    v_add_u32 v13, 32768, v47
    s_waitcnt vmcnt(12) lgkmcnt(0)
    s_barrier
    ds_read_b64_tr_b16 a[192:193], v12 offset:0
    ds_read_b64_tr_b16 a[194:195], v12 offset:1024
    ds_read_b64_tr_b16 a[196:197], v13 offset:0
    ds_read_b64_tr_b16 a[198:199], v13 offset:1024
    ds_read_b64_tr_b16 a[200:201], v12 offset:4096
    ds_read_b64_tr_b16 a[202:203], v12 offset:5120
    ds_read_b64_tr_b16 a[204:205], v13 offset:4096
    ds_read_b64_tr_b16 a[206:207], v13 offset:5120
    v_add_u32 v16, 49152, v46
    v_add_u32 v17, 49152, v47
    s_waitcnt vmcnt(8) lgkmcnt(0)
    s_barrier
    ds_read_b64_tr_b16 a[208:209], v16 offset:0
    ds_read_b64_tr_b16 a[210:211], v16 offset:1024
    ds_read_b64_tr_b16 a[212:213], v17 offset:0
    ds_read_b64_tr_b16 a[214:215], v17 offset:1024
    ds_read_b64_tr_b16 a[216:217], v16 offset:4096
    ds_read_b64_tr_b16 a[218:219], v16 offset:5120
    ds_read_b64_tr_b16 a[220:221], v17 offset:4096
    ds_read_b64_tr_b16 a[222:223], v17 offset:5120
    v_add_u32 v12, 65536, v46
    v_add_u32 v13, 65536, v47
    s_waitcnt vmcnt(4) lgkmcnt(0)
    s_barrier
    ds_read_b64_tr_b16 a[224:225], v12 offset:0
    ds_read_b64_tr_b16 a[226:227], v12 offset:1024
    ds_read_b64_tr_b16 a[228:229], v13 offset:0
    ds_read_b64_tr_b16 a[230:231], v13 offset:1024
    ds_read_b64_tr_b16 a[232:233], v12 offset:4096
    ds_read_b64_tr_b16 a[234:235], v12 offset:5120
    ds_read_b64_tr_b16 a[236:237], v13 offset:4096
    ds_read_b64_tr_b16 a[238:239], v13 offset:5120
    v_add_u32 v16, 81920, v46
    v_add_u32 v17, 81920, v47
    s_waitcnt vmcnt(0) lgkmcnt(0)
    s_barrier
    ds_read_b64_tr_b16 a[240:241], v16 offset:0
    ds_read_b64_tr_b16 a[242:243], v16 offset:1024
    ds_read_b64_tr_b16 a[244:245], v17 offset:0
    ds_read_b64_tr_b16 a[246:247], v17 offset:1024
    ds_read_b64_tr_b16 a[248:249], v16 offset:4096
    ds_read_b64_tr_b16 a[250:251], v16 offset:5120
    ds_read_b64_tr_b16 a[252:253], v17 offset:4096
    ds_read_b64_tr_b16 a[254:255], v17 offset:5120
    s_waitcnt lgkmcnt(0)
    s_mov_b32 s12, s84
    s_mov_b32 s13, s85
    s_mov_b32 s14, 0x6200000
    s_mov_b32 s15, 0x00020000
    s_barrier
    s_mov_b32 s20, s82
    s_mov_b32 s21, s83
    s_mov_b32 s22, 0x100
    s_mov_b32 s23, 0x00020000
    v_and_b32 v8, 15, v0
    v_lshlrev_b32 v8, 4, v8
    buffer_load_dword v9, v8, s[20:23], 0 offen sc1
    s_waitcnt vmcnt(0)
Lwo_wa:
    v_cmp_gt_u32 vcc, 8, v9
    s_sub_u32 s43, s43, 1
    s_cmp_lt_i32 s43, 0
    s_cbranch_scc1 Lwo_all
    s_cbranch_vccz Lwo_all
    s_sleep 2
    buffer_load_dword v9, v8, s[20:23], 0 offen sc1
    s_waitcnt vmcnt(0)
    s_branch Lwo_wa
Lwo_all:
    s_mov_b32 s14, 0
    buffer_load_dwordx4 v[94:97], v1, s[4:7], s40 offen sc1
    s_add_u32 s40, s40, 34816
    s_branch Lwo_spin1
    .p2align 6
Lwo_body00:
    s_waitcnt lgkmcnt(2)
    v_mfma_f32_16x16x32_bf16 v[8:11], a[0:3], v[40:43], 0
    ds_read_b128 v[56:59], v2 offset:4096
    s_add_u32 m0, s34, 0
    v_mfma_f32_16x16x32_bf16 v[8:11], a[8:11], v[44:47], v[8:11]
    s_waitcnt vmcnt(5)
    v_cmp_gt_i32 vcc, s32, v5
    v_cvt_pk_bf16_f32 v72, v24, v25
    v_mfma_f32_16x16x32_bf16 v[12:15], a[12:15], v[44:47], 0
    ds_read_b128 v[60:63], v2 offset:5120
    v_cvt_pk_bf16_f32 v73, v26, v27
    v_mfma_f32_16x16x32_bf16 v[12:15], a[4:7], v[40:43], v[12:15]
    s_waitcnt lgkmcnt(2)
    s_and_b64 vcc, vcc, s[18:19]
    s_cbranch_scc1 Lwo_v01
    v_mfma_f32_16x16x32_bf16 v[12:15], a[20:23], v[48:51], v[12:15]
    ds_read_b128 v[64:67], v2 offset:6144
    v_cvt_pk_bf16_f32 v74, v28, v29
    v_mfma_f32_16x16x32_bf16 v[12:15], a[28:31], v[52:55], v[12:15]
    buffer_load_dwordx4 v1, s[8:11], s33 offen offset:0 sc1 lds
    v_mfma_f32_16x16x32_bf16 v[8:11], a[24:27], v[52:55], v[8:11]
    ds_read_b128 v[68:71], v2 offset:7168
    v_cvt_pk_bf16_f32 v75, v30, v31
    v_mfma_f32_16x16x32_bf16 v[8:11], a[16:19], v[48:51], v[8:11]
    s_waitcnt lgkmcnt(2)
    s_add_u32 s31, s31, 1
    v_mov_b32 v6, s31
    v_mfma_f32_16x16x32_bf16 v[80:83], v[72:75], v[72:75], 0
    s_add_u32 s35, s35, 36864
    s_cmp_eq_u32 s35, 147456
    s_cselect_b32 s35, 0, s35
    v_mfma_f32_16x16x32_bf16 v[76:79], v[84:87], v[72:75], 0
    buffer_store_dwordx4 v[72:75], v1, s[12:15], s36 offen sc1
    v_add_u32 v3, s35, v1
    v_mfma_f32_16x16x32_bf16 v[8:11], a[32:35], v[56:59], v[8:11]
    ds_read_b128 v[40:43], v2 offset:8192
    v_cndmask_b32 v80, v80, v81, s[44:45]
    v_mfma_f32_16x16x32_bf16 v[8:11], a[40:43], v[60:63], v[8:11]
    v_cndmask_b32 v82, v82, v83, s[44:45]
    v_mfma_f32_16x16x32_bf16 v[12:15], a[44:47], v[60:63], v[12:15]
    ds_read_b128 v[44:47], v2 offset:9216
    v_cndmask_b32 v77, v80, v82, s[46:47]
    v_mfma_f32_16x16x32_bf16 v[12:15], a[36:39], v[56:59], v[12:15]
    s_waitcnt lgkmcnt(2)
    buffer_load_dwordx4 v1, s[8:11], s33 offen offset:1024 sc1 lds
    v_mfma_f32_16x16x32_bf16 v[12:15], a[52:55], v[64:67], v[12:15]
    ds_read_b128 v[48:51], v2 offset:10240
    v_mfma_f32_16x16x32_bf16 v[12:15], a[60:63], v[68:71], v[12:15]
    buffer_store_dwordx2 v[76:77], v7, s[12:15], s36 offen offset:0 sc1
    s_add_u32 s36, s36, 36864
    v_mfma_f32_16x16x32_bf16 v[8:11], a[56:59], v[68:71], v[8:11]
    ds_read_b128 v[52:55], v2 offset:11264
    v_mfma_f32_16x16x32_bf16 v[8:11], a[48:51], v[64:67], v[8:11]
    s_waitcnt lgkmcnt(2)
    buffer_load_dwordx4 v1, s[8:11], s33 offen offset:2048 sc1 lds
    v_mfma_f32_16x16x32_bf16 v[8:11], a[64:67], v[40:43], v[8:11]
    ds_read_b128 v[56:59], v2 offset:12288
    v_mfma_f32_16x16x32_bf16 v[8:11], a[72:75], v[44:47], v[8:11]
    v_mfma_f32_16x16x32_bf16 v[12:15], a[76:79], v[44:47], v[12:15]
    ds_read_b128 v[60:63], v2 offset:13312
    v_mfma_f32_16x16x32_bf16 v[12:15], a[68:71], v[40:43], v[12:15]
    s_waitcnt lgkmcnt(2)
    buffer_load_dwordx4 v1, s[8:11], s33 offen offset:3072 sc1 lds
    v_mfma_f32_16x16x32_bf16 v[12:15], a[84:87], v[48:51], v[12:15]
    ds_read_b128 v[64:67], v2 offset:14336
    s_waitcnt vmcnt(7)
    v_mfma_f32_16x16x32_bf16 v[12:15], a[92:95], v[52:55], v[12:15]
    s_barrier
    v_mfma_f32_16x16x32_bf16 v[8:11], a[88:91], v[52:55], v[8:11]
    ds_read_b128 v[68:71], v2 offset:15360
    s_add_u32 s16, s16, 8192
    v_mfma_f32_16x16x32_bf16 v[8:11], a[80:83], v[48:51], v[8:11]
    s_waitcnt lgkmcnt(2)
    s_add_u32 m0, s34, s3
    s_add_u32 s37, s33, s3
    v_mfma_f32_16x16x32_bf16 v[8:11], a[96:99], v[56:59], v[8:11]
    ds_read_b128 v[40:43], v2 offset:16384
    v_mfma_f32_16x16x32_bf16 v[8:11], a[104:107], v[60:63], v[8:11]
    buffer_load_dwordx4 v1, s[8:11], s37 offen offset:0 sc1 lds
    v_mfma_f32_16x16x32_bf16 v[12:15], a[108:111], v[60:63], v[12:15]
    ds_read_b128 v[44:47], v2 offset:17408
    v_mfma_f32_16x16x32_bf16 v[12:15], a[100:103], v[56:59], v[12:15]
    s_waitcnt lgkmcnt(2)
    v_mfma_f32_16x16x32_bf16 v[12:15], a[116:119], v[64:67], v[12:15]
    ds_read_b128 v[48:51], v2 offset:18432
    v_mfma_f32_16x16x32_bf16 v[12:15], a[124:127], v[68:71], v[12:15]
    buffer_load_dword v5, v4, s[4:7], s16 offen sc1
    v_mfma_f32_16x16x32_bf16 v[8:11], a[120:123], v[68:71], v[8:11]
    ds_read_b128 v[52:55], v2 offset:19456
    v_mfma_f32_16x16x32_bf16 v[8:11], a[112:115], v[64:67], v[8:11]
    s_waitcnt lgkmcnt(2)
    v_mfma_f32_16x16x32_bf16 v[8:11], a[128:131], v[40:43], v[8:11]
    ds_read_b128 v[56:59], v2 offset:20480
    v_mfma_f32_16x16x32_bf16 v[8:11], a[136:139], v[44:47], v[8:11]
    buffer_load_dwordx4 v1, s[8:11], s37 offen offset:1024 sc1 lds
    v_mfma_f32_16x16x32_bf16 v[12:15], a[140:143], v[44:47], v[12:15]
    ds_read_b128 v[60:63], v2 offset:21504
    v_mfma_f32_16x16x32_bf16 v[12:15], a[132:135], v[40:43], v[12:15]
    s_waitcnt lgkmcnt(2)
    v_mfma_f32_16x16x32_bf16 v[12:15], a[148:151], v[48:51], v[12:15]
    ds_read_b128 v[64:67], v2 offset:22528
    v_mfma_f32_16x16x32_bf16 v[12:15], a[156:159], v[52:55], v[12:15]
    buffer_load_dwordx4 v1, s[8:11], s37 offen offset:2048 sc1 lds
    v_mfma_f32_16x16x32_bf16 v[8:11], a[152:155], v[52:55], v[8:11]
    ds_read_b128 v[68:71], v2 offset:23552
    v_mfma_f32_16x16x32_bf16 v[8:11], a[144:147], v[48:51], v[8:11]
    s_waitcnt lgkmcnt(2)
    v_mfma_f32_16x16x32_bf16 v[8:11], a[160:163], v[56:59], v[8:11]
    ds_read_b128 v[40:43], v2 offset:24576
    v_mfma_f32_16x16x32_bf16 v[8:11], a[168:171], v[60:63], v[8:11]
    buffer_load_dwordx4 v1, s[8:11], s37 offen offset:3072 sc1 lds
    v_mfma_f32_16x16x32_bf16 v[12:15], a[172:175], v[60:63], v[12:15]
    ds_read_b128 v[44:47], v2 offset:25600
    s_add_u32 s32, s32, 1
    v_mfma_f32_16x16x32_bf16 v[12:15], a[164:167], v[56:59], v[12:15]
    s_waitcnt lgkmcnt(2)
    s_add_u32 s33, s33, 32768
    s_add_u32 s34, s34, 36864
    v_mfma_f32_16x16x32_bf16 v[12:15], a[180:183], v[64:67], v[12:15]
    ds_read_b128 v[48:51], v2 offset:26624
    v_mfma_f32_16x16x32_bf16 v[12:15], a[188:191], v[68:71], v[12:15]
    s_cmp_ge_u32 s34, 147456
    s_cselect_b32 s38, 147456, 0
    s_sub_u32 s34, s34, s38
    v_mfma_f32_16x16x32_bf16 v[8:11], a[184:187], v[68:71], v[8:11]
    ds_read_b128 v[52:55], v2 offset:27648
    v_mfma_f32_16x16x32_bf16 v[8:11], a[176:179], v[64:67], v[8:11]
    s_waitcnt lgkmcnt(2)
    buffer_load_dwordx4 v[98:101], v1, s[4:7], s40 offen sc1
    v_mfma_f32_16x16x32_bf16 v[8:11], a[192:195], v[40:43], v[8:11]
    ds_read_b128 v[56:59], v2 offset:28672
    s_add_u32 s40, s40, 34816
    v_mfma_f32_16x16x32_bf16 v[8:11], a[200:203], v[44:47], v[8:11]
    v_mfma_f32_16x16x32_bf16 v[12:15], a[204:207], v[44:47], v[12:15]
    ds_read_b128 v[60:63], v2 offset:29696
    v_mfma_f32_16x16x32_bf16 v[12:15], a[196:199], v[40:43], v[12:15]
    s_waitcnt lgkmcnt(2)
    v_mfma_f32_16x16x32_bf16 v[12:15], a[212:215], v[48:51], v[12:15]
    ds_read_b128 v[64:67], v2 offset:30720
    v_mfma_f32_16x16x32_bf16 v[12:15], a[220:223], v[52:55], v[12:15]
    s_waitcnt vmcnt(8)
    buffer_store_dword v6, v102, s[12:15], s17 offen sc1
    v_mfma_f32_16x16x32_bf16 v[8:11], a[216:219], v[52:55], v[8:11]
    ds_read_b128 v[68:71], v2 offset:31744
    s_mov_b32 s14, s6
    v_mfma_f32_16x16x32_bf16 v[8:11], a[208:211], v[48:51], v[8:11]
    s_waitcnt vmcnt(7) lgkmcnt(2)
    s_barrier
    v_mfma_f32_16x16x32_bf16 v[8:11], a[224:227], v[56:59], v[8:11]
    s_add_u32 s17, s17, 8192
    v_mfma_f32_16x16x32_bf16 v[8:11], a[232:235], v[60:63], v[8:11]
    v_mfma_f32_16x16x32_bf16 v[12:15], a[236:239], v[60:63], v[12:15]
    ds_read_b128 v[40:43], v3 offset:0
    v_mfma_f32_16x16x32_bf16 v[12:15], a[228:231], v[56:59], v[12:15]
    s_waitcnt lgkmcnt(1)
    v_mfma_f32_16x16x32_bf16 v[12:15], a[244:247], v[64:67], v[12:15]
    ds_read_b128 v[44:47], v3 offset:1024
    v_mfma_f32_16x16x32_bf16 v[12:15], a[252:255], v[68:71], v[12:15]
    v_mfma_f32_16x16x32_bf16 v[8:11], a[248:251], v[68:71], v[8:11]
    ds_read_b128 v[48:51], v3 offset:2048
    v_mfma_f32_16x16x32_bf16 v[8:11], a[240:243], v[64:67], v[8:11]
    v_mfma_f32_16x16x32_bf16 v[8:11], v[90:93], v[94:97], v[8:11]
    ds_read_b128 v[52:55], v3 offset:3072
    v_mfma_f32_16x16x32_bf16 v[12:15], v[88:91], v[94:97], v[12:15]
Lwo_body10:
    s_waitcnt lgkmcnt(2)
    v_mfma_f32_16x16x32_bf16 v[24:27], a[0:3], v[40:43], 0
    ds_read_b128 v[56:59], v3 offset:4096
    s_add_u32 m0, s34, 0
    v_mfma_f32_16x16x32_bf16 v[24:27], a[8:11], v[44:47], v[24:27]
    s_waitcnt vmcnt(5)
    v_cmp_gt_i32 vcc, s32, v5
    v_cvt_pk_bf16_f32 v72, v8, v9
    v_mfma_f32_16x16x32_bf16 v[28:31], a[12:15], v[44:47], 0
    ds_read_b128 v[60:63], v3 offset:5120
    v_cvt_pk_bf16_f32 v73, v10, v11
    v_mfma_f32_16x16x32_bf16 v[28:31], a[4:7], v[40:43], v[28:31]
    s_waitcnt lgkmcnt(2)
    s_and_b64 vcc, vcc, s[18:19]
    s_cbranch_scc1 Lwo_v11
    v_mfma_f32_16x16x32_bf16 v[28:31], a[20:23], v[48:51], v[28:31]
    ds_read_b128 v[64:67], v3 offset:6144
    v_cvt_pk_bf16_f32 v74, v12, v13
    v_mfma_f32_16x16x32_bf16 v[28:31], a[28:31], v[52:55], v[28:31]
    buffer_load_dwordx4 v1, s[8:11], s33 offen offset:0 sc1 lds
    v_mfma_f32_16x16x32_bf16 v[24:27], a[24:27], v[52:55], v[24:27]
    ds_read_b128 v[68:71], v3 offset:7168
    v_cvt_pk_bf16_f32 v75, v14, v15
    v_mfma_f32_16x16x32_bf16 v[24:27], a[16:19], v[48:51], v[24:27]
    s_waitcnt lgkmcnt(2)
    s_add_u32 s31, s31, 1
    v_mov_b32 v6, s31
    v_mfma_f32_16x16x32_bf16 v[80:83], v[72:75], v[72:75], 0
    s_add_u32 s35, s35, 36864
    s_cmp_eq_u32 s35, 147456
    s_cselect_b32 s35, 0, s35
    v_mfma_f32_16x16x32_bf16 v[76:79], v[84:87], v[72:75], 0
    buffer_store_dwordx4 v[72:75], v1, s[12:15], s36 offen sc1
    v_add_u32 v2, s35, v1
    v_mfma_f32_16x16x32_bf16 v[24:27], a[32:35], v[56:59], v[24:27]
    ds_read_b128 v[40:43], v3 offset:8192
    v_cndmask_b32 v80, v80, v81, s[44:45]
    v_mfma_f32_16x16x32_bf16 v[24:27], a[40:43], v[60:63], v[24:27]
    v_cndmask_b32 v82, v82, v83, s[44:45]
    v_mfma_f32_16x16x32_bf16 v[28:31], a[44:47], v[60:63], v[28:31]
    ds_read_b128 v[44:47], v3 offset:9216
    v_cndmask_b32 v77, v80, v82, s[46:47]
    v_mfma_f32_16x16x32_bf16 v[28:31], a[36:39], v[56:59], v[28:31]
    s_waitcnt lgkmcnt(2)
    buffer_load_dwordx4 v1, s[8:11], s33 offen offset:1024 sc1 lds
    v_mfma_f32_16x16x32_bf16 v[28:31], a[52:55], v[64:67], v[28:31]
    ds_read_b128 v[48:51], v3 offset:10240
    v_mfma_f32_16x16x32_bf16 v[28:31], a[60:63], v[68:71], v[28:31]
    buffer_store_dwordx2 v[76:77], v7, s[12:15], s36 offen offset:0 sc1
    s_add_u32 s36, s36, 36864
    v_mfma_f32_16x16x32_bf16 v[24:27], a[56:59], v[68:71], v[24:27]
    ds_read_b128 v[52:55], v3 offset:11264
    v_mfma_f32_16x16x32_bf16 v[24:27], a[48:51], v[64:67], v[24:27]
    s_waitcnt lgkmcnt(2)
    buffer_load_dwordx4 v1, s[8:11], s33 offen offset:2048 sc1 lds
    v_mfma_f32_16x16x32_bf16 v[24:27], a[64:67], v[40:43], v[24:27]
    ds_read_b128 v[56:59], v3 offset:12288
    v_mfma_f32_16x16x32_bf16 v[24:27], a[72:75], v[44:47], v[24:27]
    v_mfma_f32_16x16x32_bf16 v[28:31], a[76:79], v[44:47], v[28:31]
    ds_read_b128 v[60:63], v3 offset:13312
    v_mfma_f32_16x16x32_bf16 v[28:31], a[68:71], v[40:43], v[28:31]
    s_waitcnt lgkmcnt(2)
    buffer_load_dwordx4 v1, s[8:11], s33 offen offset:3072 sc1 lds
    v_mfma_f32_16x16x32_bf16 v[28:31], a[84:87], v[48:51], v[28:31]
    ds_read_b128 v[64:67], v3 offset:14336
    s_waitcnt vmcnt(7)
    v_mfma_f32_16x16x32_bf16 v[28:31], a[92:95], v[52:55], v[28:31]
    s_barrier
    v_mfma_f32_16x16x32_bf16 v[24:27], a[88:91], v[52:55], v[24:27]
    ds_read_b128 v[68:71], v3 offset:15360
    s_add_u32 s16, s16, 8192
    v_mfma_f32_16x16x32_bf16 v[24:27], a[80:83], v[48:51], v[24:27]
    s_waitcnt lgkmcnt(2)
    s_add_u32 m0, s34, s3
    s_add_u32 s37, s33, s3
    v_mfma_f32_16x16x32_bf16 v[24:27], a[96:99], v[56:59], v[24:27]
    ds_read_b128 v[40:43], v3 offset:16384
    v_mfma_f32_16x16x32_bf16 v[24:27], a[104:107], v[60:63], v[24:27]
    buffer_load_dwordx4 v1, s[8:11], s37 offen offset:0 sc1 lds
    v_mfma_f32_16x16x32_bf16 v[28:31], a[108:111], v[60:63], v[28:31]
    ds_read_b128 v[44:47], v3 offset:17408
    v_mfma_f32_16x16x32_bf16 v[28:31], a[100:103], v[56:59], v[28:31]
    s_waitcnt lgkmcnt(2)
    v_mfma_f32_16x16x32_bf16 v[28:31], a[116:119], v[64:67], v[28:31]
    ds_read_b128 v[48:51], v3 offset:18432
    v_mfma_f32_16x16x32_bf16 v[28:31], a[124:127], v[68:71], v[28:31]
    buffer_load_dword v5, v4, s[4:7], s16 offen sc1
    v_mfma_f32_16x16x32_bf16 v[24:27], a[120:123], v[68:71], v[24:27]
    ds_read_b128 v[52:55], v3 offset:19456
    v_mfma_f32_16x16x32_bf16 v[24:27], a[112:115], v[64:67], v[24:27]
    s_waitcnt lgkmcnt(2)
    v_mfma_f32_16x16x32_bf16 v[24:27], a[128:131], v[40:43], v[24:27]
    ds_read_b128 v[56:59], v3 offset:20480
    v_mfma_f32_16x16x32_bf16 v[24:27], a[136:139], v[44:47], v[24:27]
    buffer_load_dwordx4 v1, s[8:11], s37 offen offset:1024 sc1 lds
    v_mfma_f32_16x16x32_bf16 v[28:31], a[140:143], v[44:47], v[28:31]
    ds_read_b128 v[60:63], v3 offset:21504
    v_mfma_f32_16x16x32_bf16 v[28:31], a[132:135], v[40:43], v[28:31]
    s_waitcnt lgkmcnt(2)
    v_mfma_f32_16x16x32_bf16 v[28:31], a[148:151], v[48:51], v[28:31]
    ds_read_b128 v[64:67], v3 offset:22528
    v_mfma_f32_16x16x32_bf16 v[28:31], a[156:159], v[52:55], v[28:31]
    buffer_load_dwordx4 v1, s[8:11], s37 offen offset:2048 sc1 lds
    v_mfma_f32_16x16x32_bf16 v[24:27], a[152:155], v[52:55], v[24:27]
    ds_read_b128 v[68:71], v3 offset:23552
    v_mfma_f32_16x16x32_bf16 v[24:27], a[144:147], v[48:51], v[24:27]
    s_waitcnt lgkmcnt(2)
    v_mfma_f32_16x16x32_bf16 v[24:27], a[160:163], v[56:59], v[24:27]
    ds_read_b128 v[40:43], v3 offset:24576
    v_mfma_f32_16x16x32_bf16 v[24:27], a[168:171], v[60:63], v[24:27]
    buffer_load_dwordx4 v1, s[8:11], s37 offen offset:3072 sc1 lds
    v_mfma_f32_16x16x32_bf16 v[28:31], a[172:175], v[60:63], v[28:31]
    ds_read_b128 v[44:47], v3 offset:25600
    s_add_u32 s32, s32, 1
    v_mfma_f32_16x16x32_bf16 v[28:31], a[164:167], v[56:59], v[28:31]
    s_waitcnt lgkmcnt(2)
    s_add_u32 s33, s33, 32768
    s_add_u32 s34, s34, 36864
    v_mfma_f32_16x16x32_bf16 v[28:31], a[180:183], v[64:67], v[28:31]
    ds_read_b128 v[48:51], v3 offset:26624
    v_mfma_f32_16x16x32_bf16 v[28:31], a[188:191], v[68:71], v[28:31]
    s_cmp_ge_u32 s34, 147456
    s_cselect_b32 s38, 147456, 0
    s_sub_u32 s34, s34, s38
    v_mfma_f32_16x16x32_bf16 v[24:27], a[184:187], v[68:71], v[24:27]
    ds_read_b128 v[52:55], v3 offset:27648
    v_mfma_f32_16x16x32_bf16 v[24:27], a[176:179], v[64:67], v[24:27]
    s_waitcnt lgkmcnt(2)
    buffer_load_dwordx4 v[94:97], v1, s[4:7], s40 offen sc1
    v_mfma_f32_16x16x32_bf16 v[24:27], a[192:195], v[40:43], v[24:27]
    ds_read_b128 v[56:59], v3 offset:28672
    s_add_u32 s40, s40, 34816
    v_mfma_f32_16x16x32_bf16 v[24:27], a[200:203], v[44:47], v[24:27]
    v_mfma_f32_16x16x32_bf16 v[28:31], a[204:207], v[44:47], v[28:31]
    ds_read_b128 v[60:63], v3 offset:29696
    v_mfma_f32_16x16x32_bf16 v[28:31], a[196:199], v[40:43], v[28:31]
    s_waitcnt lgkmcnt(2)
    v_mfma_f32_16x16x32_bf16 v[28:31], a[212:215], v[48:51], v[28:31]
    ds_read_b128 v[64:67], v3 offset:30720
    v_mfma_f32_16x16x32_bf16 v[28:31], a[220:223], v[52:55], v[28:31]
    s_waitcnt vmcnt(8)
    buffer_store_dword v6, v102, s[12:15], s17 offen sc1
    v_mfma_f32_16x16x32_bf16 v[24:27], a[216:219], v[52:55], v[24:27]
    ds_read_b128 v[68:71], v3 offset:31744
    s_mov_b32 s14, s6
    v_mfma_f32_16x16x32_bf16 v[24:27], a[208:211], v[48:51], v[24:27]
    s_waitcnt vmcnt(7) lgkmcnt(2)
    s_barrier
    v_mfma_f32_16x16x32_bf16 v[24:27], a[224:227], v[56:59], v[24:27]
    s_add_u32 s17, s17, 8192
    v_mfma_f32_16x16x32_bf16 v[24:27], a[232:235], v[60:63], v[24:27]
    v_mfma_f32_16x16x32_bf16 v[28:31], a[236:239], v[60:63], v[28:31]
    ds_read_b128 v[40:43], v2 offset:0
    v_mfma_f32_16x16x32_bf16 v[28:31], a[228:231], v[56:59], v[28:31]
    s_waitcnt lgkmcnt(1)
    v_mfma_f32_16x16x32_bf16 v[28:31], a[244:247], v[64:67], v[28:31]
    ds_read_b128 v[44:47], v2 offset:1024
    v_mfma_f32_16x16x32_bf16 v[28:31], a[252:255], v[68:71], v[28:31]
    v_mfma_f32_16x16x32_bf16 v[24:27], a[248:251], v[68:71], v[24:27]
    ds_read_b128 v[48:51], v2 offset:2048
    v_mfma_f32_16x16x32_bf16 v[24:27], a[240:243], v[64:67], v[24:27]
    v_mfma_f32_16x16x32_bf16 v[24:27], v[90:93], v[98:101], v[24:27]
    ds_read_b128 v[52:55], v2 offset:3072
    v_mfma_f32_16x16x32_bf16 v[28:31], v[88:91], v[98:101], v[28:31]
    s_cmp_lt_i32 s31, 63
    s_cbranch_scc1 Lwo_body00
    s_branch L_exit
Lwo_v01:
    v_mfma_f32_16x16x32_bf16 v[12:15], a[20:23], v[48:51], v[12:15]
    ds_read_b128 v[64:67], v2 offset:6144
    v_cvt_pk_bf16_f32 v74, v28, v29
    v_mfma_f32_16x16x32_bf16 v[12:15], a[28:31], v[52:55], v[12:15]
    buffer_load_dword v5, v4, s[4:7], s16 offen sc1
    v_mfma_f32_16x16x32_bf16 v[8:11], a[24:27], v[52:55], v[8:11]
    ds_read_b128 v[68:71], v2 offset:7168
    v_cvt_pk_bf16_f32 v75, v30, v31
    v_mfma_f32_16x16x32_bf16 v[8:11], a[16:19], v[48:51], v[8:11]
    s_waitcnt lgkmcnt(2)
    s_add_u32 s31, s31, 1
    v_mov_b32 v6, s31
    v_mfma_f32_16x16x32_bf16 v[80:83], v[72:75], v[72:75], 0
    s_add_u32 s35, s35, 36864
    s_cmp_eq_u32 s35, 147456
    s_cselect_b32 s35, 0, s35
    v_mfma_f32_16x16x32_bf16 v[76:79], v[84:87], v[72:75], 0
    buffer_store_dwordx4 v[72:75], v1, s[12:15], s36 offen sc1
    v_add_u32 v3, s35, v1
    v_mfma_f32_16x16x32_bf16 v[8:11], a[32:35], v[56:59], v[8:11]
    ds_read_b128 v[40:43], v2 offset:8192
    v_cndmask_b32 v80, v80, v81, s[44:45]
    v_mfma_f32_16x16x32_bf16 v[8:11], a[40:43], v[60:63], v[8:11]
    v_cndmask_b32 v82, v82, v83, s[44:45]
    v_mfma_f32_16x16x32_bf16 v[12:15], a[44:47], v[60:63], v[12:15]
    ds_read_b128 v[44:47], v2 offset:9216
    v_cndmask_b32 v77, v80, v82, s[46:47]
    v_mfma_f32_16x16x32_bf16 v[12:15], a[36:39], v[56:59], v[12:15]
    s_waitcnt lgkmcnt(2)
    buffer_store_dwordx2 v[76:77], v7, s[12:15], s36 offen offset:0 sc1
    v_mfma_f32_16x16x32_bf16 v[12:15], a[52:55], v[64:67], v[12:15]
    ds_read_b128 v[48:51], v2 offset:10240
    s_add_u32 s36, s36, 36864
    v_mfma_f32_16x16x32_bf16 v[12:15], a[60:63], v[68:71], v[12:15]
    v_mfma_f32_16x16x32_bf16 v[8:11], a[56:59], v[68:71], v[8:11]
    ds_read_b128 v[52:55], v2 offset:11264
    v_mfma_f32_16x16x32_bf16 v[8:11], a[48:51], v[64:67], v[8:11]
    s_waitcnt lgkmcnt(2)
    v_mfma_f32_16x16x32_bf16 v[8:11], a[64:67], v[40:43], v[8:11]
    ds_read_b128 v[56:59], v2 offset:12288
    v_mfma_f32_16x16x32_bf16 v[8:11], a[72:75], v[44:47], v[8:11]
    v_mfma_f32_16x16x32_bf16 v[12:15], a[76:79], v[44:47], v[12:15]
    ds_read_b128 v[60:63], v2 offset:13312
    v_mfma_f32_16x16x32_bf16 v[12:15], a[68:71], v[40:43], v[12:15]
    s_waitcnt lgkmcnt(2)
    v_mfma_f32_16x16x32_bf16 v[12:15], a[84:87], v[48:51], v[12:15]
    ds_read_b128 v[64:67], v2 offset:14336
    s_waitcnt vmcnt(4)
    v_mfma_f32_16x16x32_bf16 v[12:15], a[92:95], v[52:55], v[12:15]
    s_barrier
    v_mfma_f32_16x16x32_bf16 v[8:11], a[88:91], v[52:55], v[8:11]
    ds_read_b128 v[68:71], v2 offset:15360
    v_mfma_f32_16x16x32_bf16 v[8:11], a[80:83], v[48:51], v[8:11]
    s_waitcnt lgkmcnt(2)
    v_mfma_f32_16x16x32_bf16 v[8:11], a[96:99], v[56:59], v[8:11]
    ds_read_b128 v[40:43], v2 offset:16384
    v_mfma_f32_16x16x32_bf16 v[8:11], a[104:107], v[60:63], v[8:11]
    s_waitcnt vmcnt(2)
    v_cmp_gt_i32 vcc, s32, v5
    v_mfma_f32_16x16x32_bf16 v[12:15], a[108:111], v[60:63], v[12:15]
    ds_read_b128 v[44:47], v2 offset:17408
    v_mfma_f32_16x16x32_bf16 v[12:15], a[100:103], v[56:59], v[12:15]
    s_waitcnt lgkmcnt(2)
    s_and_b64 vcc, vcc, s[18:19]
    s_cbranch_scc1 Lwo_v02
    v_mfma_f32_16x16x32_bf16 v[12:15], a[116:119], v[64:67], v[12:15]
    ds_read_b128 v[48:51], v2 offset:18432
    v_mfma_f32_16x16x32_bf16 v[12:15], a[124:127], v[68:71], v[12:15]
    buffer_load_dwordx4 v1, s[8:11], s33 offen offset:0 sc1 lds
    v_mfma_f32_16x16x32_bf16 v[8:11], a[120:123], v[68:71], v[8:11]
    ds_read_b128 v[52:55], v2 offset:19456
    v_mfma_f32_16x16x32_bf16 v[8:11], a[112:115], v[64:67], v[8:11]
    s_waitcnt lgkmcnt(2)
    v_mfma_f32_16x16x32_bf16 v[8:11], a[128:131], v[40:43], v[8:11]
    ds_read_b128 v[56:59], v2 offset:20480
    v_mfma_f32_16x16x32_bf16 v[8:11], a[136:139], v[44:47], v[8:11]
    buffer_load_dwordx4 v1, s[8:11], s33 offen offset:1024 sc1 lds
    v_mfma_f32_16x16x32_bf16 v[12:15], a[140:143], v[44:47], v[12:15]
    ds_read_b128 v[60:63], v2 offset:21504
    v_mfma_f32_16x16x32_bf16 v[12:15], a[132:135], v[40:43], v[12:15]
    s_waitcnt lgkmcnt(2)
    v_mfma_f32_16x16x32_bf16 v[12:15], a[148:151], v[48:51], v[12:15]
    ds_read_b128 v[64:67], v2 offset:22528
    v_mfma_f32_16x16x32_bf16 v[12:15], a[156:159], v[52:55], v[12:15]
    buffer_load_dwordx4 v1, s[8:11], s33 offen offset:2048 sc1 lds
    v_mfma_f32_16x16x32_bf16 v[8:11], a[152:155], v[52:55], v[8:11]
    ds_read_b128 v[68:71], v2 offset:23552
    v_mfma_f32_16x16x32_bf16 v[8:11], a[144:147], v[48:51], v[8:11]
    s_waitcnt lgkmcnt(2)
    v_mfma_f32_16x16x32_bf16 v[8:11], a[160:163], v[56:59], v[8:11]
    ds_read_b128 v[40:43], v2 offset:24576
    v_mfma_f32_16x16x32_bf16 v[8:11], a[168:171], v[60:63], v[8:11]
    buffer_load_dwordx4 v1, s[8:11], s33 offen offset:3072 sc1 lds
    v_mfma_f32_16x16x32_bf16 v[12:15], a[172:175], v[60:63], v[12:15]
    ds_read_b128 v[44:47], v2 offset:25600
    s_add_u32 s16, s16, 8192
    v_mfma_f32_16x16x32_bf16 v[12:15], a[164:167], v[56:59], v[12:15]
    s_waitcnt lgkmcnt(2)
    s_add_u32 m0, s34, s3
    s_add_u32 s37, s33, s3
    v_mfma_f32_16x16x32_bf16 v[12:15], a[180:183], v[64:67], v[12:15]
    ds_read_b128 v[48:51], v2 offset:26624
    v_mfma_f32_16x16x32_bf16 v[12:15], a[188:191], v[68:71], v[12:15]
    buffer_load_dword v5, v4, s[4:7], s16 offen sc1
    v_mfma_f32_16x16x32_bf16 v[8:11], a[184:187], v[68:71], v[8:11]
    ds_read_b128 v[52:55], v2 offset:27648
    v_mfma_f32_16x16x32_bf16 v[8:11], a[176:179], v[64:67], v[8:11]
    s_waitcnt lgkmcnt(2)
    v_mfma_f32_16x16x32_bf16 v[8:11], a[192:195], v[40:43], v[8:11]
    ds_read_b128 v[56:59], v2 offset:28672
    v_mfma_f32_16x16x32_bf16 v[8:11], a[200:203], v[44:47], v[8:11]
    buffer_load_dwordx4 v1, s[8:11], s37 offen offset:0 sc1 lds
    v_mfma_f32_16x16x32_bf16 v[12:15], a[204:207], v[44:47], v[12:15]
    ds_read_b128 v[60:63], v2 offset:29696
    v_mfma_f32_16x16x32_bf16 v[12:15], a[196:199], v[40:43], v[12:15]
    s_waitcnt vmcnt(6) lgkmcnt(2)
    buffer_store_dword v6, v102, s[12:15], s17 offen sc1
    v_mfma_f32_16x16x32_bf16 v[12:15], a[212:215], v[48:51], v[12:15]
    ds_read_b128 v[64:67], v2 offset:30720
    s_mov_b32 s14, s6
    v_mfma_f32_16x16x32_bf16 v[12:15], a[220:223], v[52:55], v[12:15]
    buffer_load_dwordx4 v1, s[8:11], s37 offen offset:1024 sc1 lds
    v_mfma_f32_16x16x32_bf16 v[8:11], a[216:219], v[52:55], v[8:11]
    ds_read_b128 v[68:71], v2 offset:31744
    s_add_u32 s17, s17, 8192
    v_mfma_f32_16x16x32_bf16 v[8:11], a[208:211], v[48:51], v[8:11]
    s_waitcnt vmcnt(4) lgkmcnt(2)
    s_barrier
    v_mfma_f32_16x16x32_bf16 v[8:11], a[224:227], v[56:59], v[8:11]
    v_mfma_f32_16x16x32_bf16 v[8:11], a[232:235], v[60:63], v[8:11]
    buffer_load_dwordx4 v1, s[8:11], s37 offen offset:2048 sc1 lds
    v_mfma_f32_16x16x32_bf16 v[12:15], a[236:239], v[60:63], v[12:15]
    ds_read_b128 v[40:43], v3 offset:0
    v_mfma_f32_16x16x32_bf16 v[12:15], a[228:231], v[56:59], v[12:15]
    s_waitcnt lgkmcnt(1)
    v_mfma_f32_16x16x32_bf16 v[12:15], a[244:247], v[64:67], v[12:15]
    ds_read_b128 v[44:47], v3 offset:1024
    v_mfma_f32_16x16x32_bf16 v[12:15], a[252:255], v[68:71], v[12:15]
    buffer_load_dwordx4 v1, s[8:11], s37 offen offset:3072 sc1 lds
    v_mfma_f32_16x16x32_bf16 v[8:11], a[248:251], v[68:71], v[8:11]
    ds_read_b128 v[48:51], v3 offset:2048
    s_add_u32 s32, s32, 1
    v_mfma_f32_16x16x32_bf16 v[8:11], a[240:243], v[64:67], v[8:11]
    s_add_u32 s33, s33, 32768
    s_add_u32 s34, s34, 36864
    v_mfma_f32_16x16x32_bf16 v[8:11], v[90:93], v[94:97], v[8:11]
    ds_read_b128 v[52:55], v3 offset:3072
    v_mfma_f32_16x16x32_bf16 v[12:15], v[88:91], v[94:97], v[12:15]
    s_cmp_ge_u32 s34, 147456
    s_cselect_b32 s38, 147456, 0
    s_sub_u32 s34, s34, s38
    buffer_load_dwordx4 v[98:101], v1, s[4:7], s40 offen sc1
    s_add_u32 s40, s40, 34816
    s_cmp_ge_i32 s31, 63
    s_cbranch_scc1 L_exit
    s_branch Lwo_body10
Lwo_v02:
    v_mfma_f32_16x16x32_bf16 v[12:15], a[116:119], v[64:67], v[12:15]
    ds_read_b128 v[48:51], v2 offset:18432
    v_mfma_f32_16x16x32_bf16 v[12:15], a[124:127], v[68:71], v[12:15]
    v_mfma_f32_16x16x32_bf16 v[8:11], a[120:123], v[68:71], v[8:11]
    ds_read_b128 v[52:55], v2 offset:19456
    v_mfma_f32_16x16x32_bf16 v[8:11], a[112:115], v[64:67], v[8:11]
    s_waitcnt lgkmcnt(2)
    v_mfma_f32_16x16x32_bf16 v[8:11], a[128:131], v[40:43], v[8:11]
    ds_read_b128 v[56:59], v2 offset:20480
    v_mfma_f32_16x16x32_bf16 v[8:11], a[136:139], v[44:47], v[8:11]
    v_mfma_f32_16x16x32_bf16 v[12:15], a[140:143], v[44:47], v[12:15]
    ds_read_b128 v[60:63], v2 offset:21504
    v_mfma_f32_16x16x32_bf16 v[12:15], a[132:135], v[40:43], v[12:15]
    s_waitcnt lgkmcnt(2)
    v_mfma_f32_16x16x32_bf16 v[12:15], a[148:151], v[48:51], v[12:15]
    ds_read_b128 v[64:67], v2 offset:22528
    v_mfma_f32_16x16x32_bf16 v[12:15], a[156:159], v[52:55], v[12:15]
    v_mfma_f32_16x16x32_bf16 v[8:11], a[152:155], v[52:55], v[8:11]
    ds_read_b128 v[68:71], v2 offset:23552
    v_mfma_f32_16x16x32_bf16 v[8:11], a[144:147], v[48:51], v[8:11]
    s_waitcnt lgkmcnt(2)
    buffer_load_dwordx4 v[98:101], v1, s[4:7], s40 offen sc1
    v_mfma_f32_16x16x32_bf16 v[8:11], a[160:163], v[56:59], v[8:11]
    ds_read_b128 v[40:43], v2 offset:24576
    s_add_u32 s40, s40, 34816
    v_mfma_f32_16x16x32_bf16 v[8:11], a[168:171], v[60:63], v[8:11]
    v_mfma_f32_16x16x32_bf16 v[12:15], a[172:175], v[60:63], v[12:15]
    ds_read_b128 v[44:47], v2 offset:25600
    v_mfma_f32_16x16x32_bf16 v[12:15], a[164:167], v[56:59], v[12:15]
    s_waitcnt lgkmcnt(2)
    v_mfma_f32_16x16x32_bf16 v[12:15], a[180:183], v[64:67], v[12:15]
    ds_read_b128 v[48:51], v2 offset:26624
    v_mfma_f32_16x16x32_bf16 v[12:15], a[188:191], v[68:71], v[12:15]
    v_mfma_f32_16x16x32_bf16 v[8:11], a[184:187], v[68:71], v[8:11]
    ds_read_b128 v[52:55], v2 offset:27648
    v_mfma_f32_16x16x32_bf16 v[8:11], a[176:179], v[64:67], v[8:11]
    s_waitcnt lgkmcnt(2)
    v_mfma_f32_16x16x32_bf16 v[8:11], a[192:195], v[40:43], v[8:11]
    ds_read_b128 v[56:59], v2 offset:28672
    v_mfma_f32_16x16x32_bf16 v[8:11], a[200:203], v[44:47], v[8:11]
    v_mfma_f32_16x16x32_bf16 v[12:15], a[204:207], v[44:47], v[12:15]
    ds_read_b128 v[60:63], v2 offset:29696
    v_mfma_f32_16x16x32_bf16 v[12:15], a[196:199], v[40:43], v[12:15]
    s_waitcnt vmcnt(1) lgkmcnt(2)
    buffer_store_dword v6, v102, s[12:15], s17 offen sc1
    v_mfma_f32_16x16x32_bf16 v[12:15], a[212:215], v[48:51], v[12:15]
    ds_read_b128 v[64:67], v2 offset:30720
    s_mov_b32 s14, s6
    v_mfma_f32_16x16x32_bf16 v[12:15], a[220:223], v[52:55], v[12:15]
    buffer_load_dword v5, v4, s[4:7], s16 offen sc1
    v_mfma_f32_16x16x32_bf16 v[8:11], a[216:219], v[52:55], v[8:11]
    ds_read_b128 v[68:71], v2 offset:31744
    s_add_u32 s17, s17, 8192
    v_mfma_f32_16x16x32_bf16 v[8:11], a[208:211], v[48:51], v[8:11]
    s_waitcnt lgkmcnt(2)
    v_mfma_f32_16x16x32_bf16 v[8:11], a[224:227], v[56:59], v[8:11]
    v_mfma_f32_16x16x32_bf16 v[8:11], a[232:235], v[60:63], v[8:11]
    v_mfma_f32_16x16x32_bf16 v[12:15], a[236:239], v[60:63], v[12:15]
    v_mfma_f32_16x16x32_bf16 v[12:15], a[228:231], v[56:59], v[12:15]
    s_waitcnt lgkmcnt(0)
    v_mfma_f32_16x16x32_bf16 v[12:15], a[244:247], v[64:67], v[12:15]
    v_mfma_f32_16x16x32_bf16 v[12:15], a[252:255], v[68:71], v[12:15]
    v_mfma_f32_16x16x32_bf16 v[8:11], a[248:251], v[68:71], v[8:11]
    v_mfma_f32_16x16x32_bf16 v[8:11], a[240:243], v[64:67], v[8:11]
    v_mfma_f32_16x16x32_bf16 v[8:11], v[90:93], v[94:97], v[8:11]
    v_mfma_f32_16x16x32_bf16 v[12:15], v[88:91], v[94:97], v[12:15]
    s_nop 6
    v_cvt_pk_bf16_f32 v72, v8, v9
    v_cvt_pk_bf16_f32 v73, v10, v11
    v_cvt_pk_bf16_f32 v74, v12, v13
    v_cvt_pk_bf16_f32 v75, v14, v15
    s_nop 1
    v_mfma_f32_16x16x32_bf16 v[80:83], v[72:75], v[72:75], 0
    v_mfma_f32_16x16x32_bf16 v[76:79], v[84:87], v[72:75], 0
    buffer_store_dwordx4 v[72:75], v1, s[12:15], s36 offen sc1
    s_nop 5
    v_cndmask_b32 v80, v80, v81, s[44:45]
    v_cndmask_b32 v82, v82, v83, s[44:45]
    v_cndmask_b32 v77, v80, v82, s[46:47]
    buffer_store_dwordx2 v[76:77], v7, s[12:15], s36 offen offset:0 sc1
    s_add_u32 s54, s31, 1
    v_mov_b32 v6, s54
    s_waitcnt vmcnt(2)
    s_cmp_ge_i32 s31, 63
    s_cbranch_scc1 Lwo_late0
    v_cmp_gt_i32 vcc, s32, v5
    s_sub_u32 s43, s43, 1
    s_cmp_lt_i32 s43, 0
    s_cbranch_scc1 Lwo_rdy0
    s_and_b64 vcc, vcc, s[18:19]
    s_cbranch_scc0 Lwo_rdy0
Lwo_late0:
    buffer_load_dword v5, v4, s[4:7], s16 offen sc1
    s_waitcnt vmcnt(1)
    buffer_store_dword v6, v102, s[12:15], s17 offen sc1
    s_mov_b32 s14, 0
    s_cmp_ge_i32 s31, 63
    s_cbranch_scc1 L_exit
    s_waitcnt vmcnt(1)
    v_cmp_gt_i32 vcc, s32, v5
    s_sub_u32 s43, s43, 1
    s_cmp_lt_i32 s43, 0
    s_cbranch_scc1 Lwo_rdy0
    s_and_b64 vcc, vcc, s[18:19]
    s_cbranch_scc0 Lwo_rdy0
Lwo_spin0:
    buffer_load_dword v5, v4, s[4:7], s16 offen sc1
    s_waitcnt vmcnt(0)
    v_cmp_gt_i32 vcc, s32, v5
    s_sub_u32 s43, s43, 1
    s_cmp_lt_i32 s43, 0
    s_cbranch_scc1 Lwo_rdy0
    s_and_b64 vcc, vcc, s[18:19]
    s_cbranch_scc0 Lwo_rdy0
    s_sleep 8
    s_branch Lwo_spin0
Lwo_rdy0:
    s_add_u32 m0, s34, 0
    s_nop 0
    buffer_load_dwordx4 v1, s[8:11], s33 offen offset:0 sc1 lds
    buffer_load_dwordx4 v1, s[8:11], s33 offen offset:1024 sc1 lds
    buffer_load_dwordx4 v1, s[8:11], s33 offen offset:2048 sc1 lds
    buffer_load_dwordx4 v1, s[8:11], s33 offen offset:3072 sc1 lds
    s_add_u32 s16, s16, 8192
    buffer_load_dword v5, v4, s[4:7], s16 offen sc1
    s_add_u32 m0, s34, s3
    s_add_u32 s37, s33, s3
    buffer_load_dwordx4 v1, s[8:11], s37 offen offset:0 sc1 lds
    buffer_load_dwordx4 v1, s[8:11], s37 offen offset:1024 sc1 lds
    buffer_load_dwordx4 v1, s[8:11], s37 offen offset:2048 sc1 lds
    buffer_load_dwordx4 v1, s[8:11], s37 offen offset:3072 sc1 lds
    s_add_u32 s32, s32, 1
    s_add_u32 s33, s33, 32768
    s_add_u32 s34, s34, 36864
    s_cmp_ge_u32 s34, 147456
    s_cselect_b32 s38, 147456, 0
    s_sub_u32 s34, s34, s38
    s_waitcnt vmcnt(5)
    buffer_store_dword v6, v102, s[12:15], s17 offen sc1
Lwo_go0:
    s_mov_b32 s14, 0
    s_barrier
    ds_read_b128 v[40:43], v3 offset:0
    ds_read_b128 v[44:47], v3 offset:1024
    ds_read_b128 v[48:51], v3 offset:2048
    ds_read_b128 v[52:55], v3 offset:3072
    s_branch Lwo_body10
Lwo_v11:
    v_mfma_f32_16x16x32_bf16 v[28:31], a[20:23], v[48:51], v[28:31]
    ds_read_b128 v[64:67], v3 offset:6144
    v_cvt_pk_bf16_f32 v74, v12, v13
    v_mfma_f32_16x16x32_bf16 v[28:31], a[28:31], v[52:55], v[28:31]
    buffer_load_dword v5, v4, s[4:7], s16 offen sc1
    v_mfma_f32_16x16x32_bf16 v[24:27], a[24:27], v[52:55], v[24:27]
    ds_read_b128 v[68:71], v3 offset:7168
    v_cvt_pk_bf16_f32 v75, v14, v15
    v_mfma_f32_16x16x32_bf16 v[24:27], a[16:19], v[48:51], v[24:27]
    s_waitcnt lgkmcnt(2)
    s_add_u32 s31, s31, 1
    v_mov_b32 v6, s31
    v_mfma_f32_16x16x32_bf16 v[80:83], v[72:75], v[72:75], 0
    s_add_u32 s35, s35, 36864
    s_cmp_eq_u32 s35, 147456
    s_cselect_b32 s35, 0, s35
    v_mfma_f32_16x16x32_bf16 v[76:79], v[84:87], v[72:75], 0
    buffer_store_dwordx4 v[72:75], v1, s[12:15], s36 offen sc1
    v_add_u32 v2, s35, v1
    v_mfma_f32_16x16x32_bf16 v[24:27], a[32:35], v[56:59], v[24:27]
    ds_read_b128 v[40:43], v3 offset:8192
    v_cndmask_b32 v80, v80, v81, s[44:45]
    v_mfma_f32_16x16x32_bf16 v[24:27], a[40:43], v[60:63], v[24:27]
    v_cndmask_b32 v82, v82, v83, s[44:45]
    v_mfma_f32_16x16x32_bf16 v[28:31], a[44:47], v[60:63], v[28:31]
    ds_read_b128 v[44:47], v3 offset:9216
    v_cndmask_b32 v77, v80, v82, s[46:47]
    v_mfma_f32_16x16x32_bf16 v[28:31], a[36:39], v[56:59], v[28:31]
    s_waitcnt lgkmcnt(2)
    buffer_store_dwordx2 v[76:77], v7, s[12:15], s36 offen offset:0 sc1
    v_mfma_f32_16x16x32_bf16 v[28:31], a[52:55], v[64:67], v[28:31]
    ds_read_b128 v[48:51], v3 offset:10240
    s_add_u32 s36, s36, 36864
    v_mfma_f32_16x16x32_bf16 v[28:31], a[60:63], v[68:71], v[28:31]
    v_mfma_f32_16x16x32_bf16 v[24:27], a[56:59], v[68:71], v[24:27]
    ds_read_b128 v[52:55], v3 offset:11264
    v_mfma_f32_16x16x32_bf16 v[24:27], a[48:51], v[64:67], v[24:27]
    s_waitcnt lgkmcnt(2)
    v_mfma_f32_16x16x32_bf16 v[24:27], a[64:67], v[40:43], v[24:27]
    ds_read_b128 v[56:59], v3 offset:12288
    v_mfma_f32_16x16x32_bf16 v[24:27], a[72:75], v[44:47], v[24:27]
    v_mfma_f32_16x16x32_bf16 v[28:31], a[76:79], v[44:47], v[28:31]
    ds_read_b128 v[60:63], v3 offset:13312
    v_mfma_f32_16x16x32_bf16 v[28:31], a[68:71], v[40:43], v[28:31]
    s_waitcnt lgkmcnt(2)
    v_mfma_f32_16x16x32_bf16 v[28:31], a[84:87], v[48:51], v[28:31]
    ds_read_b128 v[64:67], v3 offset:14336
    s_waitcnt vmcnt(4)
    v_mfma_f32_16x16x32_bf16 v[28:31], a[92:95], v[52:55], v[28:31]
    s_barrier
    v_mfma_f32_16x16x32_bf16 v[24:27], a[88:91], v[52:55], v[24:27]
    ds_read_b128 v[68:71], v3 offset:15360
    v_mfma_f32_16x16x32_bf16 v[24:27], a[80:83], v[48:51], v[24:27]
    s_waitcnt lgkmcnt(2)
    v_mfma_f32_16x16x32_bf16 v[24:27], a[96:99], v[56:59], v[24:27]
    ds_read_b128 v[40:43], v3 offset:16384
    v_mfma_f32_16x16x32_bf16 v[24:27], a[104:107], v[60:63], v[24:27]
    s_waitcnt vmcnt(2)
    v_cmp_gt_i32 vcc, s32, v5
    v_mfma_f32_16x16x32_bf16 v[28:31], a[108:111], v[60:63], v[28:31]
    ds_read_b128 v[44:47], v3 offset:17408
    v_mfma_f32_16x16x32_bf16 v[28:31], a[100:103], v[56:59], v[28:31]
    s_waitcnt lgkmcnt(2)
    s_and_b64 vcc, vcc, s[18:19]
    s_cbranch_scc1 Lwo_v12
    v_mfma_f32_16x16x32_bf16 v[28:31], a[116:119], v[64:67], v[28:31]
    ds_read_b128 v[48:51], v3 offset:18432
    v_mfma_f32_16x16x32_bf16 v[28:31], a[124:127], v[68:71], v[28:31]
    buffer_load_dwordx4 v1, s[8:11], s33 offen offset:0 sc1 lds
    v_mfma_f32_16x16x32_bf16 v[24:27], a[120:123], v[68:71], v[24:27]
    ds_read_b128 v[52:55], v3 offset:19456
    v_mfma_f32_16x16x32_bf16 v[24:27], a[112:115], v[64:67], v[24:27]
    s_waitcnt lgkmcnt(2)
    v_mfma_f32_16x16x32_bf16 v[24:27], a[128:131], v[40:43], v[24:27]
    ds_read_b128 v[56:59], v3 offset:20480
    v_mfma_f32_16x16x32_bf16 v[24:27], a[136:139], v[44:47], v[24:27]
    buffer_load_dwordx4 v1, s[8:11], s33 offen offset:1024 sc1 lds
    v_mfma_f32_16x16x32_bf16 v[28:31], a[140:143], v[44:47], v[28:31]
    ds_read_b128 v[60:63], v3 offset:21504
    v_mfma_f32_16x16x32_bf16 v[28:31], a[132:135], v[40:43], v[28:31]
    s_waitcnt lgkmcnt(2)
    v_mfma_f32_16x16x32_bf16 v[28:31], a[148:151], v[48:51], v[28:31]
    ds_read_b128 v[64:67], v3 offset:22528
    v_mfma_f32_16x16x32_bf16 v[28:31], a[156:159], v[52:55], v[28:31]
    buffer_load_dwordx4 v1, s[8:11], s33 offen offset:2048 sc1 lds
    v_mfma_f32_16x16x32_bf16 v[24:27], a[152:155], v[52:55], v[24:27]
    ds_read_b128 v[68:71], v3 offset:23552
    v_mfma_f32_16x16x32_bf16 v[24:27], a[144:147], v[48:51], v[24:27]
    s_waitcnt lgkmcnt(2)
    v_mfma_f32_16x16x32_bf16 v[24:27], a[160:163], v[56:59], v[24:27]
    ds_read_b128 v[40:43], v3 offset:24576
    v_mfma_f32_16x16x32_bf16 v[24:27], a[168:171], v[60:63], v[24:27]
    buffer_load_dwordx4 v1, s[8:11], s33 offen offset:3072 sc1 lds
    v_mfma_f32_16x16x32_bf16 v[28:31], a[172:175], v[60:63], v[28:31]
    ds_read_b128 v[44:47], v3 offset:25600
    s_add_u32 s16, s16, 8192
    v_mfma_f32_16x16x32_bf16 v[28:31], a[164:167], v[56:59], v[28:31]
    s_waitcnt lgkmcnt(2)
    s_add_u32 m0, s34, s3
    s_add_u32 s37, s33, s3
    v_mfma_f32_16x16x32_bf16 v[28:31], a[180:183], v[64:67], v[28:31]
    ds_read_b128 v[48:51], v3 offset:26624
    v_mfma_f32_16x16x32_bf16 v[28:31], a[188:191], v[68:71], v[28:31]
    buffer_load_dword v5, v4, s[4:7], s16 offen sc1
    v_mfma_f32_16x16x32_bf16 v[24:27], a[184:187], v[68:71], v[24:27]
    ds_read_b128 v[52:55], v3 offset:27648
    v_mfma_f32_16x16x32_bf16 v[24:27], a[176:179], v[64:67], v[24:27]
    s_waitcnt lgkmcnt(2)
    v_mfma_f32_16x16x32_bf16 v[24:27], a[192:195], v[40:43], v[24:27]
    ds_read_b128 v[56:59], v3 offset:28672
    v_mfma_f32_16x16x32_bf16 v[24:27], a[200:203], v[44:47], v[24:27]
    buffer_load_dwordx4 v1, s[8:11], s37 offen offset:0 sc1 lds
    v_mfma_f32_16x16x32_bf16 v[28:31], a[204:207], v[44:47], v[28:31]
    ds_read_b128 v[60:63], v3 offset:29696
    v_mfma_f32_16x16x32_bf16 v[28:31], a[196:199], v[40:43], v[28:31]
    s_waitcnt vmcnt(6) lgkmcnt(2)
    buffer_store_dword v6, v102, s[12:15], s17 offen sc1
    v_mfma_f32_16x16x32_bf16 v[28:31], a[212:215], v[48:51], v[28:31]
    ds_read_b128 v[64:67], v3 offset:30720
    s_mov_b32 s14, s6
    v_mfma_f32_16x16x32_bf16 v[28:31], a[220:223], v[52:55], v[28:31]
    buffer_load_dwordx4 v1, s[8:11], s37 offen offset:1024 sc1 lds
    v_mfma_f32_16x16x32_bf16 v[24:27], a[216:219], v[52:55], v[24:27]
    ds_read_b128 v[68:71], v3 offset:31744
    s_add_u32 s17, s17, 8192
    v_mfma_f32_16x16x32_bf16 v[24:27], a[208:211], v[48:51], v[24:27]
    s_waitcnt vmcnt(4) lgkmcnt(2)
    s_barrier
    v_mfma_f32_16x16x32_bf16 v[24:27], a[224:227], v[56:59], v[24:27]
    v_mfma_f32_16x16x32_bf16 v[24:27], a[232:235], v[60:63], v[24:27]
    buffer_load_dwordx4 v1, s[8:11], s37 offen offset:2048 sc1 lds
    v_mfma_f32_16x16x32_bf16 v[28:31], a[236:239], v[60:63], v[28:31]
    ds_read_b128 v[40:43], v2 offset:0
    v_mfma_f32_16x16x32_bf16 v[28:31], a[228:231], v[56:59], v[28:31]
    s_waitcnt lgkmcnt(1)
    v_mfma_f32_16x16x32_bf16 v[28:31], a[244:247], v[64:67], v[28:31]
    ds_read_b128 v[44:47], v2 offset:1024
    v_mfma_f32_16x16x32_bf16 v[28:31], a[252:255], v[68:71], v[28:31]
    buffer_load_dwordx4 v1, s[8:11], s37 offen offset:3072 sc1 lds
    v_mfma_f32_16x16x32_bf16 v[24:27], a[248:251], v[68:71], v[24:27]
    ds_read_b128 v[48:51], v2 offset:2048
    s_add_u32 s32, s32, 1
    v_mfma_f32_16x16x32_bf16 v[24:27], a[240:243], v[64:67], v[24:27]
    s_add_u32 s33, s33, 32768
    s_add_u32 s34, s34, 36864
    v_mfma_f32_16x16x32_bf16 v[24:27], v[90:93], v[98:101], v[24:27]
    ds_read_b128 v[52:55], v2 offset:3072
    v_mfma_f32_16x16x32_bf16 v[28:31], v[88:91], v[98:101], v[28:31]
    s_cmp_ge_u32 s34, 147456
    s_cselect_b32 s38, 147456, 0
    s_sub_u32 s34, s34, s38
    buffer_load_dwordx4 v[94:97], v1, s[4:7], s40 offen sc1
    s_add_u32 s40, s40, 34816
    s_cmp_ge_i32 s31, 63
    s_cbranch_scc1 L_exit
    s_branch Lwo_body00
Lwo_v12:
    v_mfma_f32_16x16x32_bf16 v[28:31], a[116:119], v[64:67], v[28:31]
    ds_read_b128 v[48:51], v3 offset:18432
    v_mfma_f32_16x16x32_bf16 v[28:31], a[124:127], v[68:71], v[28:31]
    v_mfma_f32_16x16x32_bf16 v[24:27], a[120:123], v[68:71], v[24:27]
    ds_read_b128 v[52:55], v3 offset:19456
    v_mfma_f32_16x16x32_bf16 v[24:27], a[112:115], v[64:67], v[24:27]
    s_waitcnt lgkmcnt(2)
    v_mfma_f32_16x16x32_bf16 v[24:27], a[128:131], v[40:43], v[24:27]
    ds_read_b128 v[56:59], v3 offset:20480
    v_mfma_f32_16x16x32_bf16 v[24:27], a[136:139], v[44:47], v[24:27]
    v_mfma_f32_16x16x32_bf16 v[28:31], a[140:143], v[44:47], v[28:31]
    ds_read_b128 v[60:63], v3 offset:21504
    v_mfma_f32_16x16x32_bf16 v[28:31], a[132:135], v[40:43], v[28:31]
    s_waitcnt lgkmcnt(2)
    v_mfma_f32_16x16x32_bf16 v[28:31], a[148:151], v[48:51], v[28:31]
    ds_read_b128 v[64:67], v3 offset:22528
    v_mfma_f32_16x16x32_bf16 v[28:31], a[156:159], v[52:55], v[28:31]
    v_mfma_f32_16x16x32_bf16 v[24:27], a[152:155], v[52:55], v[24:27]
    ds_read_b128 v[68:71], v3 offset:23552
    v_mfma_f32_16x16x32_bf16 v[24:27], a[144:147], v[48:51], v[24:27]
    s_waitcnt lgkmcnt(2)
    buffer_load_dwordx4 v[94:97], v1, s[4:7], s40 offen sc1
    v_mfma_f32_16x16x32_bf16 v[24:27], a[160:163], v[56:59], v[24:27]
    ds_read_b128 v[40:43], v3 offset:24576
    s_add_u32 s40, s40, 34816
    v_mfma_f32_16x16x32_bf16 v[24:27], a[168:171], v[60:63], v[24:27]
    v_mfma_f32_16x16x32_bf16 v[28:31], a[172:175], v[60:63], v[28:31]
    ds_read_b128 v[44:47], v3 offset:25600
    v_mfma_f32_16x16x32_bf16 v[28:31], a[164:167], v[56:59], v[28:31]
    s_waitcnt lgkmcnt(2)
    v_mfma_f32_16x16x32_bf16 v[28:31], a[180:183], v[64:67], v[28:31]
    ds_read_b128 v[48:51], v3 offset:26624
    v_mfma_f32_16x16x32_bf16 v[28:31], a[188:191], v[68:71], v[28:31]
    v_mfma_f32_16x16x32_bf16 v[24:27], a[184:187], v[68:71], v[24:27]
    ds_read_b128 v[52:55], v3 offset:27648
    v_mfma_f32_16x16x32_bf16 v[24:27], a[176:179], v[64:67], v[24:27]
    s_waitcnt lgkmcnt(2)
    v_mfma_f32_16x16x32_bf16 v[24:27], a[192:195], v[40:43], v[24:27]
    ds_read_b128 v[56:59], v3 offset:28672
    v_mfma_f32_16x16x32_bf16 v[24:27], a[200:203], v[44:47], v[24:27]
    v_mfma_f32_16x16x32_bf16 v[28:31], a[204:207], v[44:47], v[28:31]
    ds_read_b128 v[60:63], v3 offset:29696
    v_mfma_f32_16x16x32_bf16 v[28:31], a[196:199], v[40:43], v[28:31]
    s_waitcnt vmcnt(1) lgkmcnt(2)
    buffer_store_dword v6, v102, s[12:15], s17 offen sc1
    v_mfma_f32_16x16x32_bf16 v[28:31], a[212:215], v[48:51], v[28:31]
    ds_read_b128 v[64:67], v3 offset:30720
    s_mov_b32 s14, s6
    v_mfma_f32_16x16x32_bf16 v[28:31], a[220:223], v[52:55], v[28:31]
    buffer_load_dword v5, v4, s[4:7], s16 offen sc1
    v_mfma_f32_16x16x32_bf16 v[24:27], a[216:219], v[52:55], v[24:27]
    ds_read_b128 v[68:71], v3 offset:31744
    s_add_u32 s17, s17, 8192
    v_mfma_f32_16x16x32_bf16 v[24:27], a[208:211], v[48:51], v[24:27]
    s_waitcnt lgkmcnt(2)
    v_mfma_f32_16x16x32_bf16 v[24:27], a[224:227], v[56:59], v[24:27]
    v_mfma_f32_16x16x32_bf16 v[24:27], a[232:235], v[60:63], v[24:27]
    v_mfma_f32_16x16x32_bf16 v[28:31], a[236:239], v[60:63], v[28:31]
    v_mfma_f32_16x16x32_bf16 v[28:31], a[228:231], v[56:59], v[28:31]
    s_waitcnt lgkmcnt(0)
    v_mfma_f32_16x16x32_bf16 v[28:31], a[244:247], v[64:67], v[28:31]
    v_mfma_f32_16x16x32_bf16 v[28:31], a[252:255], v[68:71], v[28:31]
    v_mfma_f32_16x16x32_bf16 v[24:27], a[248:251], v[68:71], v[24:27]
    v_mfma_f32_16x16x32_bf16 v[24:27], a[240:243], v[64:67], v[24:27]
    v_mfma_f32_16x16x32_bf16 v[24:27], v[90:93], v[98:101], v[24:27]
    v_mfma_f32_16x16x32_bf16 v[28:31], v[88:91], v[98:101], v[28:31]
    s_nop 6
    v_cvt_pk_bf16_f32 v72, v24, v25
    v_cvt_pk_bf16_f32 v73, v26, v27
    v_cvt_pk_bf16_f32 v74, v28, v29
    v_cvt_pk_bf16_f32 v75, v30, v31
    s_nop 1
    v_mfma_f32_16x16x32_bf16 v[80:83], v[72:75], v[72:75], 0
    v_mfma_f32_16x16x32_bf16 v[76:79], v[84:87], v[72:75], 0
    buffer_store_dwordx4 v[72:75], v1, s[12:15], s36 offen sc1
    s_nop 5
    v_cndmask_b32 v80, v80, v81, s[44:45]
    v_cndmask_b32 v82, v82, v83, s[44:45]
    v_cndmask_b32 v77, v80, v82, s[46:47]
    buffer_store_dwordx2 v[76:77], v7, s[12:15], s36 offen offset:0 sc1
    s_add_u32 s54, s31, 1
    v_mov_b32 v6, s54
    s_waitcnt vmcnt(2)
    s_cmp_ge_i32 s31, 63
    s_cbranch_scc1 Lwo_late1
    v_cmp_gt_i32 vcc, s32, v5
    s_sub_u32 s43, s43, 1
    s_cmp_lt_i32 s43, 0
    s_cbranch_scc1 Lwo_rdy1
    s_and_b64 vcc, vcc, s[18:19]
    s_cbranch_scc0 Lwo_rdy1
Lwo_late1:
    buffer_load_dword v5, v4, s[4:7], s16 offen sc1
    s_waitcnt vmcnt(1)
    buffer_store_dword v6, v102, s[12:15], s17 offen sc1
    s_mov_b32 s14, 0
    s_cmp_ge_i32 s31, 63
    s_cbranch_scc1 L_exit
    s_waitcnt vmcnt(1)
    v_cmp_gt_i32 vcc, s32, v5
    s_sub_u32 s43, s43, 1
    s_cmp_lt_i32 s43, 0
    s_cbranch_scc1 Lwo_rdy1
    s_and_b64 vcc, vcc, s[18:19]
    s_cbranch_scc0 Lwo_rdy1
Lwo_spin1:
    buffer_load_dword v5, v4, s[4:7], s16 offen sc1
    s_waitcnt vmcnt(0)
    v_cmp_gt_i32 vcc, s32, v5
    s_sub_u32 s43, s43, 1
    s_cmp_lt_i32 s43, 0
    s_cbranch_scc1 Lwo_rdy1
    s_and_b64 vcc, vcc, s[18:19]
    s_cbranch_scc0 Lwo_rdy1
    s_sleep 8
    s_branch Lwo_spin1
Lwo_rdy1:
    s_add_u32 m0, s34, 0
    s_nop 0
    buffer_load_dwordx4 v1, s[8:11], s33 offen offset:0 sc1 lds
    buffer_load_dwordx4 v1, s[8:11], s33 offen offset:1024 sc1 lds
    buffer_load_dwordx4 v1, s[8:11], s33 offen offset:2048 sc1 lds
    buffer_load_dwordx4 v1, s[8:11], s33 offen offset:3072 sc1 lds
    s_add_u32 s16, s16, 8192
    buffer_load_dword v5, v4, s[4:7], s16 offen sc1
    s_add_u32 m0, s34, s3
    s_add_u32 s37, s33, s3
    buffer_load_dwordx4 v1, s[8:11], s37 offen offset:0 sc1 lds
    buffer_load_dwordx4 v1, s[8:11], s37 offen offset:1024 sc1 lds
    buffer_load_dwordx4 v1, s[8:11], s37 offen offset:2048 sc1 lds
    buffer_load_dwordx4 v1, s[8:11], s37 offen offset:3072 sc1 lds
    s_add_u32 s32, s32, 1
    s_add_u32 s33, s33, 32768
    s_add_u32 s34, s34, 36864
    s_cmp_ge_u32 s34, 147456
    s_cselect_b32 s38, 147456, 0
    s_sub_u32 s34, s34, s38
    s_waitcnt vmcnt(5)
    buffer_store_dword v6, v102, s[12:15], s17 offen sc1
Lwo_go1:
    s_mov_b32 s14, 0
    s_barrier
    ds_read_b128 v[40:43], v2 offset:0
    ds_read_b128 v[44:47], v2 offset:1024
    ds_read_b128 v[48:51], v2 offset:2048
    ds_read_b128 v[52:55], v2 offset:3072
    s_branch Lwo_body00
Lffa_start:
    s_mov_b32 s12, s72
    s_mov_b32 s13, s73
    s_mov_b32 s14, 0x700000
    s_mov_b32 s15, 0x00020000
    v_lshrrev_b32 v24, 3, v0
    v_mul_u32_u24 v24, 7168, v24
    v_bfe_u32 v25, v0, 4, 2
    v_lshlrev_b32 v25, 1, v25
    v_and_b32 v26, 7, v0
    v_xor_b32 v25, v25, v26
    v_lshl_add_u32 v40, v25, 4, v24
    v_add_u32 v41, 56320, v40
    s_mul_i32 s86, s29, 0x180
    s_add_u32 s86, s86, 0xffffdc00
    s_mul_i32 s37, s30, 114688
    s_add_u32 s86, s86, s37
    s_lshl_b32 s87, s30, 11
    s_add_u32 m0, s87, 0
    s_add_u32 s37, s86, 0
    buffer_load_dwordx4 v40, s[12:15], s37 offen offset:0 lds
    buffer_load_dwordx4 v41, s[12:15], s37 offen offset:1024 lds
    s_add_u32 m0, s87, 8192
    s_add_u32 s37, s86, 128
    buffer_load_dwordx4 v40, s[12:15], s37 offen offset:0 lds
    buffer_load_dwordx4 v41, s[12:15], s37 offen offset:1024 lds
    s_add_u32 m0, s87, 16384
    s_add_u32 s37, s86, 256
    buffer_load_dwordx4 v40, s[12:15], s37 offen offset:0 lds
    buffer_load_dwordx4 v41, s[12:15], s37 offen offset:1024 lds
    s_add_u32 m0, s87, 24576
    s_add_u32 s37, s86, 458752
    buffer_load_dwordx4 v40, s[12:15], s37 offen offset:0 lds
    buffer_load_dwordx4 v41, s[12:15], s37 offen offset:1024 lds
    s_add_u32 m0, s87, 32768
    s_add_u32 s37, s86, 458880
    buffer_load_dwordx4 v40, s[12:15], s37 offen offset:0 lds
    buffer_load_dwordx4 v41, s[12:15], s37 offen offset:1024 lds
    s_add_u32 m0, s87, 40960
    s_add_u32 s37, s86, 459008
    buffer_load_dwordx4 v40, s[12:15], s37 offen offset:0 lds
    buffer_load_dwordx4 v41, s[12:15], s37 offen offset:1024 lds
    s_add_u32 m0, s87, 49152
    s_add_u32 s37, s86, 917504
    buffer_load_dwordx4 v40, s[12:15], s37 offen offset:0 lds
    buffer_load_dwordx4 v41, s[12:15], s37 offen offset:1024 lds
    s_add_u32 m0, s87, 57344
    s_add_u32 s37, s86, 917632
    buffer_load_dwordx4 v40, s[12:15], s37 offen offset:0 lds
    buffer_load_dwordx4 v41, s[12:15], s37 offen offset:1024 lds
    s_add_u32 m0, s87, 65536
    s_add_u32 s37, s86, 917760
    buffer_load_dwordx4 v40, s[12:15], s37 offen offset:0 lds
    buffer_load_dwordx4 v41, s[12:15], s37 offen offset:1024 lds
    s_add_u32 m0, s87, 73728
    s_add_u32 s37, s86, 1376256
    buffer_load_dwordx4 v40, s[12:15], s37 offen offset:0 lds
    buffer_load_dwordx4 v41, s[12:15], s37 offen offset:1024 lds
    s_add_u32 m0, s87, 81920
    s_add_u32 s37, s86, 1376384
    buffer_load_dwordx4 v40, s[12:15], s37 offen offset:0 lds
    buffer_load_dwordx4 v41, s[12:15], s37 offen offset:1024 lds
    s_add_u32 m0, s87, 90112
    s_add_u32 s37, s86, 1376512
    buffer_load_dwordx4 v40, s[12:15], s37 offen offset:0 lds
    buffer_load_dwordx4 v41, s[12:15], s37 offen offset:1024 lds
    s_add_u32 m0, s87, 98304
    s_add_u32 s37, s86, 1835008
    buffer_load_dwordx4 v40, s[12:15], s37 offen offset:0 lds
    buffer_load_dwordx4 v41, s[12:15], s37 offen offset:1024 lds
    s_add_u32 m0, s87, 106496
    s_add_u32 s37, s86, 1835136
    buffer_load_dwordx4 v40, s[12:15], s37 offen offset:0 lds
    buffer_load_dwordx4 v41, s[12:15], s37 offen offset:1024 lds
    s_add_u32 m0, s87, 114688
    s_add_u32 s37, s86, 1835264
    buffer_load_dwordx4 v40, s[12:15], s37 offen offset:0 lds
    buffer_load_dwordx4 v41, s[12:15], s37 offen offset:1024 lds
    v_bfe_u32 v24, v0, 3, 2
    v_and_b32 v25, 3, v0
    v_lshlrev_b32 v25, 3, v25
    v_lshrrev_b32 v26, 2, v0
    v_lshl_add_u32 v26, v26, 7, v25
    v_lshrrev_b32 v27, 5, v0
    v_lshl_add_u32 v27, v27, 10, v26
    s_lshr_b32 s37, s30, 1
    s_and_b32 s38, s30, 1
    s_lshl_b32 s38, s38, 1
    s_add_u32 s38, s38, 0
    s_lshl_b32 s37, s37, 13
    v_xor_b32 v28, s38, v24
    v_lshl_add_u32 v28, v28, 5, s37
    v_add_u32 v42, v28, v26
    v_add_u32 v46, v28, v27
    s_lshr_b32 s37, s30, 1
    s_and_b32 s38, s30, 1
    s_lshl_b32 s38, s38, 1
    s_add_u32 s38, s38, 1
    s_lshl_b32 s37, s37, 13
    v_xor_b32 v28, s38, v24
    v_lshl_add_u32 v28, v28, 5, s37
    v_add_u32 v43, v28, v26
    v_add_u32 v47, v28, v27
    s_mov_b32 s37, 2
    s_mov_b32 s38, s30
    s_lshl_b32 s37, s37, 13
    v_xor_b32 v28, s38, v24
    v_lshl_add_u32 v28, v28, 5, s37
    v_add_u32 v44, v28, v26
    v_add_u32 v48, v28, v27
    v_mov_b32 v28, 0x3f803f80
    v_mov_b32 v29, 0x3f803f80
    v_mov_b32 v30, 0x3f803f80
    v_mov_b32 v31, 0x3f803f80
    s_mov_b32 s20, s74
    s_mov_b32 s21, s75
    s_mov_b32 s22, 0x1c00
    s_mov_b32 s23, 0x00020000
    v_lshrrev_b32 v8, 4, v0
    v_lshlrev_b32 v8, 3, v8
    s_mul_i32 s37, s29, 0x180
    s_mul_i32 s53, s30, 0x40
    s_add_u32 s37, s37, s53
    s_add_u32 s37, s37, 0xffffdc00
    buffer_load_dwordx2 v[10:11], v8, s[20:23], s37 offen
    s_mul_i32 s37, s29, 0x180
    s_mul_i32 s53, s30, 0x40
    s_add_u32 s37, s37, s53
    s_add_u32 s37, s37, 0xffffdc20
    buffer_load_dwordx2 v[12:13], v8, s[20:23], s37 offen
    s_mul_i32 s37, s29, 0x180
    s_mul_i32 s53, s30, 0x20
    s_add_u32 s37, s37, s53
    s_add_u32 s37, s37, 0xffffdd00
    buffer_load_dwordx2 v[14:15], v8, s[20:23], s37 offen
    s_waitcnt vmcnt(0)
    v_lshlrev_b32 v68, 16, v10
    v_and_b32 v69, 0xffff0000, v10
    v_lshlrev_b32 v70, 16, v11
    v_and_b32 v71, 0xffff0000, v11
    v_lshlrev_b32 v72, 16, v12
    v_and_b32 v73, 0xffff0000, v12
    v_lshlrev_b32 v74, 16, v13
    v_and_b32 v75, 0xffff0000, v13
    v_lshlrev_b32 v76, 16, v14
    v_and_b32 v77, 0xffff0000, v14
    v_lshlrev_b32 v78, 16, v15
    v_and_b32 v79, 0xffff0000, v15
    s_mul_i32 s37, s28, 0x80000
    s_add_u32 s37, s37, 0x6000800
    v_min_u32 v4, 31, v0
    v_lshl_add_u32 v4, v4, 5, s37
    s_mov_b32 s32, 1
    s_mul_i32 s33, s28, 0x240000
    s_add_u32 s33, s33, 0x1200000
    s_mul_i32 s36, s28, 0x720000
    s_mul_i32 s53, s29, 0x1800
    s_add_u32 s36, s36, s53
    s_mul_i32 s53, s30, 0x400
    s_add_u32 s36, s36, s53
    s_add_u32 s36, s36, 0x1fbf800
    s_lshr_b32 s37, s30, 1
    s_sub_u32 s37, s37, s30
    s_add_u32 s37, s37, 4
    s_lshl_b32 s37, s37, 10
    s_and_b32 s38, s30, 1
    v_lshrrev_b32 v8, 5, v0
    v_cmp_eq_u32 vcc, s38, v8
    v_add_u32 v8, s37, v1
    v_mov_b32 v7, 0x40000000
    v_cndmask_b32 v7, v7, v8, vcc
    s_mov_b32 s31, -1
    s_mov_b32 s35, 0
    s_mov_b32 s16, 0
    v_mov_b32 v5, 0
    s_mul_i32 s17, s28, 0x80000
    s_mul_i32 s53, s29, 0x80
    s_add_u32 s17, s17, s53
    s_mul_i32 s53, s30, 0x20
    s_add_u32 s17, s17, s53
    s_add_u32 s17, s17, 0x5ffe000
    v_cmp_eq_u32 vcc, 0, v0
    v_mov_b32 v22, 0x40000000
    s_nop 0
    v_cndmask_b32 v22, v22, v0, vcc
    v_mov_b32 v2, v1
    s_mul_i32 s34, s30, 4096
    s_mul_i32 s3, s30, 0x400
    s_add_u32 s3, s3, 0x4000
    s_add_u32 s41, s3, 4096
    s_add_u32 s33, s33, s34
    v_lshlrev_b32 v20, 3, v0
    s_mov_b64 s[18:19], 0xffffffff
    s_mov_b32 s19, 0
    v_mov_b32 v8, 0x40000000
    v_cndmask_b32 v4, v8, v4, s[18:19]
    v_add_u32 v12, 0, v42
    v_add_u32 v13, 0, v43
    v_add_u32 v14, 0, v44
    s_waitcnt vmcnt(24) lgkmcnt(0)
    s_barrier
    s_add_u32 m0, s87, 122880
    s_add_u32 s37, s86, 2293760
    buffer_load_dwordx4 v40, s[12:15], s37 offen offset:0 lds
    ds_read_b64_tr_b16 a[0:1], v12 offset:0
    ds_read_b64_tr_b16 a[2:3], v12 offset:2048
    ds_read_b64_tr_b16 a[4:5], v13 offset:0
    buffer_load_dwordx4 v41, s[12:15], s37 offen offset:1024 lds
    ds_read_b64_tr_b16 a[6:7], v13 offset:2048
    ds_read_b64_tr_b16 a[8:9], v14 offset:0
    ds_read_b64_tr_b16 a[10:11], v14 offset:2048
    s_add_u32 m0, s87, 131072
    s_add_u32 s37, s86, 2293888
    buffer_load_dwordx4 v40, s[12:15], s37 offen offset:0 lds
    ds_read_b64_tr_b16 a[12:13], v12 offset:4096
    ds_read_b64_tr_b16 a[14:15], v12 offset:6144
    ds_read_b64_tr_b16 a[16:17], v13 offset:4096
    buffer_load_dwordx4 v41, s[12:15], s37 offen offset:1024 lds
    ds_read_b64_tr_b16 a[18:19], v13 offset:6144
    ds_read_b64_tr_b16 a[20:21], v14 offset:4096
    ds_read_b64_tr_b16 a[22:23], v14 offset:6144
    s_add_u32 m0, s87, 139264
    s_add_u32 s37, s86, 2294016
    buffer_load_dwordx4 v40, s[12:15], s37 offen offset:0 lds
    v_add_u32 v16, 24576, v42
    v_add_u32 v17, 24576, v43
    v_add_u32 v18, 24576, v44
    buffer_load_dwordx4 v41, s[12:15], s37 offen offset:1024 lds
    s_waitcnt vmcnt(24) lgkmcnt(0)
    s_barrier
    s_add_u32 m0, s87, 0
    s_add_u32 s37, s86, 2752512
    buffer_load_dwordx4 v40, s[12:15], s37 offen offset:0 lds
    ds_read_b64_tr_b16 a[24:25], v16 offset:0
    ds_read_b64_tr_b16 a[26:27], v16 offset:2048
    ds_read_b64_tr_b16 a[28:29], v17 offset:0
    ds_read_b64_tr_b16 a[30:31], v17 offset:2048
    buffer_load_dwordx4 v41, s[12:15], s37 offen offset:1024 lds
    ds_read_b64_tr_b16 a[32:33], v18 offset:0
    ds_read_b64_tr_b16 a[34:35], v18 offset:2048
    ds_read_b64_tr_b16 a[36:37], v16 offset:4096
    ds_read_b64_tr_b16 a[38:39], v16 offset:6144
    s_add_u32 m0, s87, 8192
    s_add_u32 s37, s86, 2752640
    buffer_load_dwordx4 v40, s[12:15], s37 offen offset:0 lds
    ds_read_b64_tr_b16 a[40:41], v17 offset:4096
    ds_read_b64_tr_b16 a[42:43], v17 offset:6144
    ds_read_b64_tr_b16 a[44:45], v18 offset:4096
    ds_read_b64_tr_b16 a[46:47], v18 offset:6144
    buffer_load_dwordx4 v41, s[12:15], s37 offen offset:1024 lds
    v_mfma_f32_16x16x32_bf16 v[56:59], a[0:3], v[28:31], 0
    v_mfma_f32_16x16x32_bf16 v[60:63], a[4:7], v[28:31], 0
    v_mfma_f32_16x16x32_bf16 v[64:67], a[8:11], v[28:31], 0
    v_mfma_f32_16x16x32_bf16 v[56:59], a[12:15], v[28:31], v[56:59]
    s_add_u32 m0, s87, 16384
    s_add_u32 s37, s86, 2752768
    buffer_load_dwordx4 v40, s[12:15], s37 offen offset:0 lds
    v_mfma_f32_16x16x32_bf16 v[60:63], a[16:19], v[28:31], v[60:63]
    v_mfma_f32_16x16x32_bf16 v[64:67], a[20:23], v[28:31], v[64:67]
    v_add_u32 v12, 49152, v42
    v_add_u32 v13, 49152, v43
    buffer_load_dwordx4 v41, s[12:15], s37 offen offset:1024 lds
    v_add_u32 v14, 49152, v44
    s_waitcnt vmcnt(24) lgkmcnt(0)
    s_barrier
    s_add_u32 m0, s87, 24576
    s_add_u32 s37, s86, 3211264
    buffer_load_dwordx4 v40, s[12:15], s37 offen offset:0 lds
    ds_read_b64_tr_b16 a[48:49], v12 offset:0
    ds_read_b64_tr_b16 a[50:51], v12 offset:2048
    ds_read_b64_tr_b16 a[52:53], v13 offset:0
    ds_read_b64_tr_b16 a[54:55], v13 offset:2048
    buffer_load_dwordx4 v41, s[12:15], s37 offen offset:1024 lds
    ds_read_b64_tr_b16 a[56:57], v14 offset:0
    ds_read_b64_tr_b16 a[58:59], v14 offset:2048
    ds_read_b64_tr_b16 a[60:61], v12 offset:4096
    ds_read_b64_tr_b16 a[62:63], v12 offset:6144
    s_add_u32 m0, s87, 32768
    s_add_u32 s37, s86, 3211392
    buffer_load_dwordx4 v40, s[12:15], s37 offen offset:0 lds
    ds_read_b64_tr_b16 a[64:65], v13 offset:4096
    ds_read_b64_tr_b16 a[66:67], v13 offset:6144
    ds_read_b64_tr_b16 a[68:69], v14 offset:4096
    ds_read_b64_tr_b16 a[70:71], v14 offset:6144
    buffer_load_dwordx4 v41, s[12:15], s37 offen offset:1024 lds
    v_mfma_f32_16x16x32_bf16 v[56:59], a[24:27], v[28:31], v[56:59]
    v_mfma_f32_16x16x32_bf16 v[60:63], a[28:31], v[28:31], v[60:63]
    v_mfma_f32_16x16x32_bf16 v[64:67], a[32:35], v[28:31], v[64:67]
    v_mfma_f32_16x16x32_bf16 v[56:59], a[36:39], v[28:31], v[56:59]
    s_add_u32 m0, s87, 40960
    s_add_u32 s37, s86, 3211520
    buffer_load_dwordx4 v40, s[12:15], s37 offen offset:0 lds
    v_mfma_f32_16x16x32_bf16 v[60:63], a[40:43], v[28:31], v[60:63]
    v_mfma_f32_16x16x32_bf16 v[64:67], a[44:47], v[28:31], v[64:67]
    v_add_u32 v16, 73728, v42
    v_add_u32 v17, 73728, v43
    buffer_load_dwordx4 v41, s[12:15], s37 offen offset:1024 lds
    v_add_u32 v18, 73728, v44
    s_waitcnt vmcnt(24) lgkmcnt(0)
    s_barrier
    s_add_u32 m0, s87, 49152
    s_add_u32 s37, s86, 3670016
    buffer_load_dwordx4 v40, s[12:15], s37 offen offset:0 lds
    ds_read_b64_tr_b16 a[72:73], v16 offset:0
    ds_read_b64_tr_b16 a[74:75], v16 offset:2048
    ds_read_b64_tr_b16 a[76:77], v17 offset:0
    ds_read_b64_tr_b16 a[78:79], v17 offset:2048
    buffer_load_dwordx4 v41, s[12:15], s37 offen offset:1024 lds
    ds_read_b64_tr_b16 a[80:81], v18 offset:0
    ds_read_b64_tr_b16 a[82:83], v18 offset:2048
    ds_read_b64_tr_b16 a[84:85], v16 offset:4096
    ds_read_b64_tr_b16 a[86:87], v16 offset:6144
    s_add_u32 m0, s87, 57344
    s_add_u32 s37, s86, 3670144
    buffer_load_dwordx4 v40, s[12:15], s37 offen offset:0 lds
    ds_read_b64_tr_b16 a[88:89], v17 offset:4096
    ds_read_b64_tr_b16 a[90:91], v17 offset:6144
    ds_read_b64_tr_b16 a[92:93], v18 offset:4096
    ds_read_b64_tr_b16 a[94:95], v18 offset:6144
    buffer_load_dwordx4 v41, s[12:15], s37 offen offset:1024 lds
    v_mfma_f32_16x16x32_bf16 v[56:59], a[48:51], v[28:31], v[56:59]
    v_mfma_f32_16x16x32_bf16 v[60:63], a[52:55], v[28:31], v[60:63]
    v_mfma_f32_16x16x32_bf16 v[64:67], a[56:59], v[28:31], v[64:67]
    v_mfma_f32_16x16x32_bf16 v[56:59], a[60:63], v[28:31], v[56:59]
    s_add_u32 m0, s87, 65536
    s_add_u32 s37, s86, 3670272
    buffer_load_dwordx4 v40, s[12:15], s37 offen offset:0 lds
    v_mfma_f32_16x16x32_bf16 v[60:63], a[64:67], v[28:31], v[60:63]
    v_mfma_f32_16x16x32_bf16 v[64:67], a[68:71], v[28:31], v[64:67]
    v_add_u32 v12, 98304, v42
    v_add_u32 v13, 98304, v43
    buffer_load_dwordx4 v41, s[12:15], s37 offen offset:1024 lds
    v_add_u32 v14, 98304, v44
    s_waitcnt vmcnt(24) lgkmcnt(0)
    s_barrier
    s_add_u32 m0, s87, 73728
    s_add_u32 s37, s86, 4128768
    buffer_load_dwordx4 v40, s[12:15], s37 offen offset:0 lds
    ds_read_b64_tr_b16 a[96:97], v12 offset:0
    ds_read_b64_tr_b16 a[98:99], v12 offset:2048
    ds_read_b64_tr_b16 a[100:101], v13 offset:0
    ds_read_b64_tr_b16 a[102:103], v13 offset:2048
    buffer_load_dwordx4 v41, s[12:15], s37 offen offset:1024 lds
    ds_read_b64_tr_b16 a[104:105], v14 offset:0
    ds_read_b64_tr_b16 a[106:107], v14 offset:2048
    ds_read_b64_tr_b16 a[108:109], v12 offset:4096
    ds_read_b64_tr_b16 a[110:111], v12 offset:6144
    s_add_u32 m0, s87, 81920
    s_add_u32 s37, s86, 4128896
    buffer_load_dwordx4 v40, s[12:15], s37 offen offset:0 lds
    ds_read_b64_tr_b16 a[112:113], v13 offset:4096
    ds_read_b64_tr_b16 a[114:115], v13 offset:6144
    ds_read_b64_tr_b16 a[116:117], v14 offset:4096
    ds_read_b64_tr_b16 a[118:119], v14 offset:6144
    buffer_load_dwordx4 v41, s[12:15], s37 offen offset:1024 lds
    v_mfma_f32_16x16x32_bf16 v[56:59], a[72:75], v[28:31], v[56:59]
    v_mfma_f32_16x16x32_bf16 v[60:63], a[76:79], v[28:31], v[60:63]
    v_mfma_f32_16x16x32_bf16 v[64:67], a[80:83], v[28:31], v[64:67]
    v_mfma_f32_16x16x32_bf16 v[56:59], a[84:87], v[28:31], v[56:59]
    s_add_u32 m0, s87, 90112
    s_add_u32 s37, s86, 4129024
    buffer_load_dwordx4 v40, s[12:15], s37 offen offset:0 lds
    v_mfma_f32_16x16x32_bf16 v[60:63], a[88:91], v[28:31], v[60:63]
    v_mfma_f32_16x16x32_bf16 v[64:67], a[92:95], v[28:31], v[64:67]
    v_add_u32 v16, 122880, v42
    v_add_u32 v17, 122880, v43
    buffer_load_dwordx4 v41, s[12:15], s37 offen offset:1024 lds
    v_add_u32 v18, 122880, v44
    s_waitcnt vmcnt(24) lgkmcnt(0)
    s_barrier
    s_add_u32 m0, s87, 98304
    s_add_u32 s37, s86, 4587520
    buffer_load_dwordx4 v40, s[12:15], s37 offen offset:0 lds
    ds_read_b64_tr_b16 a[120:121], v16 offset:0
    ds_read_b64_tr_b16 a[122:123], v16 offset:2048
    ds_read_b64_tr_b16 a[124:125], v17 offset:0
    ds_read_b64_tr_b16 a[126:127], v17 offset:2048
    buffer_load_dwordx4 v41, s[12:15], s37 offen offset:1024 lds
    ds_read_b64_tr_b16 a[128:129], v18 offset:0
    ds_read_b64_tr_b16 a[130:131], v18 offset:2048
    ds_read_b64_tr_b16 a[132:133], v16 offset:4096
    ds_read_b64_tr_b16 a[134:135], v16 offset:6144
    s_add_u32 m0, s87, 106496
    s_add_u32 s37, s86, 4587648
    buffer_load_dwordx4 v40, s[12:15], s37 offen offset:0 lds
    ds_read_b64_tr_b16 a[136:137], v17 offset:4096
    ds_read_b64_tr_b16 a[138:139], v17 offset:6144
    ds_read_b64_tr_b16 a[140:141], v18 offset:4096
    ds_read_b64_tr_b16 a[142:143], v18 offset:6144
    buffer_load_dwordx4 v41, s[12:15], s37 offen offset:1024 lds
    v_mfma_f32_16x16x32_bf16 v[56:59], a[96:99], v[28:31], v[56:59]
    v_mfma_f32_16x16x32_bf16 v[60:63], a[100:103], v[28:31], v[60:63]
    v_mfma_f32_16x16x32_bf16 v[64:67], a[104:107], v[28:31], v[64:67]
    v_mfma_f32_16x16x32_bf16 v[56:59], a[108:111], v[28:31], v[56:59]
    s_add_u32 m0, s87, 114688
    s_add_u32 s37, s86, 4587776
    buffer_load_dwordx4 v40, s[12:15], s37 offen offset:0 lds
    v_mfma_f32_16x16x32_bf16 v[60:63], a[112:115], v[28:31], v[60:63]
    v_mfma_f32_16x16x32_bf16 v[64:67], a[116:119], v[28:31], v[64:67]
    v_add_u32 v12, 0, v42
    v_add_u32 v13, 0, v43
    buffer_load_dwordx4 v41, s[12:15], s37 offen offset:1024 lds
    v_add_u32 v14, 0, v44
    s_waitcnt vmcnt(24) lgkmcnt(0)
    s_barrier
    s_add_u32 m0, s87, 122880
    s_add_u32 s37, s86, 5046272
    buffer_load_dwordx4 v40, s[12:15], s37 offen offset:0 lds
    ds_read_b64_tr_b16 a[144:145], v12 offset:0
    ds_read_b64_tr_b16 a[146:147], v12 offset:2048
    ds_read_b64_tr_b16 a[148:149], v13 offset:0
    ds_read_b64_tr_b16 a[150:151], v13 offset:2048
    buffer_load_dwordx4 v41, s[12:15], s37 offen offset:1024 lds
    ds_read_b64_tr_b16 a[152:153], v14 offset:0
    ds_read_b64_tr_b16 a[154:155], v14 offset:2048
    ds_read_b64_tr_b16 a[156:157], v12 offset:4096
    ds_read_b64_tr_b16 a[158:159], v12 offset:6144
    s_add_u32 m0, s87, 131072
    s_add_u32 s37, s86, 5046400
    buffer_load_dwordx4 v40, s[12:15], s37 offen offset:0 lds
    ds_read_b64_tr_b16 a[160:161], v13 offset:4096
    ds_read_b64_tr_b16 a[162:163], v13 offset:6144
    ds_read_b64_tr_b16 a[164:165], v14 offset:4096
    ds_read_b64_tr_b16 a[166:167], v14 offset:6144
    buffer_load_dwordx4 v41, s[12:15], s37 offen offset:1024 lds
    v_mfma_f32_16x16x32_bf16 v[56:59], a[120:123], v[28:31], v[56:59]
    v_mfma_f32_16x16x32_bf16 v[60:63], a[124:127], v[28:31], v[60:63]
    v_mfma_f32_16x16x32_bf16 v[64:67], a[128:131], v[28:31], v[64:67]
    v_mfma_f32_16x16x32_bf16 v[56:59], a[132:135], v[28:31], v[56:59]
    s_add_u32 m0, s87, 139264
    s_add_u32 s37, s86, 5046528
    buffer_load_dwordx4 v40, s[12:15], s37 offen offset:0 lds
    v_mfma_f32_16x16x32_bf16 v[60:63], a[136:139], v[28:31], v[60:63]
    v_mfma_f32_16x16x32_bf16 v[64:67], a[140:143], v[28:31], v[64:67]
    v_add_u32 v16, 24576, v42
    v_add_u32 v17, 24576, v43
    buffer_load_dwordx4 v41, s[12:15], s37 offen offset:1024 lds
    v_add_u32 v18, 24576, v44
    s_waitcnt vmcnt(24) lgkmcnt(0)
    s_barrier
    s_add_u32 m0, s87, 0
    s_add_u32 s37, s86, 5505024
    buffer_load_dwordx4 v40, s[12:15], s37 offen offset:0 lds
    ds_read_b64_tr_b16 a[168:169], v16 offset:0
    ds_read_b64_tr_b16 a[170:171], v16 offset:2048
    ds_read_b64_tr_b16 a[172:173], v17 offset:0
    ds_read_b64_tr_b16 a[174:175], v17 offset:2048
    buffer_load_dwordx4 v41, s[12:15], s37 offen offset:1024 lds
    ds_read_b64_tr_b16 a[176:177], v18 offset:0
    ds_read_b64_tr_b16 a[178:179], v18 offset:2048
    ds_read_b64_tr_b16 a[180:181], v16 offset:4096
    ds_read_b64_tr_b16 a[182:183], v16 offset:6144
    s_add_u32 m0, s87, 8192
    s_add_u32 s37, s86, 5505152
    buffer_load_dwordx4 v40, s[12:15], s37 offen offset:0 lds
    ds_read_b64_tr_b16 a[184:185], v17 offset:4096
    ds_read_b64_tr_b16 a[186:187], v17 offset:6144
    ds_read_b64_tr_b16 a[188:189], v18 offset:4096
    ds_read_b64_tr_b16 a[190:191], v18 offset:6144
    buffer_load_dwordx4 v41, s[12:15], s37 offen offset:1024 lds
    v_mfma_f32_16x16x32_bf16 v[56:59], a[144:147], v[28:31], v[56:59]
    v_mfma_f32_16x16x32_bf16 v[60:63], a[148:151], v[28:31], v[60:63]
    v_mfma_f32_16x16x32_bf16 v[64:67], a[152:155], v[28:31], v[64:67]
    v_mfma_f32_16x16x32_bf16 v[56:59], a[156:159], v[28:31], v[56:59]
    s_add_u32 m0, s87, 16384
    s_add_u32 s37, s86, 5505280
    buffer_load_dwordx4 v40, s[12:15], s37 offen offset:0 lds
    v_mfma_f32_16x16x32_bf16 v[60:63], a[160:163], v[28:31], v[60:63]
    v_mfma_f32_16x16x32_bf16 v[64:67], a[164:167], v[28:31], v[64:67]
    v_add_u32 v12, 49152, v42
    v_add_u32 v13, 49152, v43
    buffer_load_dwordx4 v41, s[12:15], s37 offen offset:1024 lds
    v_add_u32 v14, 49152, v44
    s_waitcnt vmcnt(24) lgkmcnt(0)
    s_barrier
    s_add_u32 m0, s87, 24576
    s_add_u32 s37, s86, 5963776
    buffer_load_dwordx4 v40, s[12:15], s37 offen offset:0 lds
    ds_read_b64_tr_b16 a[192:193], v12 offset:0
    ds_read_b64_tr_b16 a[194:195], v12 offset:2048
    ds_read_b64_tr_b16 a[196:197], v13 offset:0
    ds_read_b64_tr_b16 a[198:199], v13 offset:2048
    buffer_load_dwordx4 v41, s[12:15], s37 offen offset:1024 lds
    ds_read_b64_tr_b16 a[200:201], v14 offset:0
    ds_read_b64_tr_b16 a[202:203], v14 offset:2048
    ds_read_b64_tr_b16 a[204:205], v12 offset:4096
    ds_read_b64_tr_b16 a[206:207], v12 offset:6144
    s_add_u32 m0, s87, 32768
    s_add_u32 s37, s86, 5963904
    buffer_load_dwordx4 v40, s[12:15], s37 offen offset:0 lds
    ds_read_b64_tr_b16 a[208:209], v13 offset:4096
    ds_read_b64_tr_b16 a[210:211], v13 offset:6144
    ds_read_b64_tr_b16 a[212:213], v14 offset:4096
    ds_read_b64_tr_b16 a[214:215], v14 offset:6144
    buffer_load_dwordx4 v41, s[12:15], s37 offen offset:1024 lds
    v_mfma_f32_16x16x32_bf16 v[56:59], a[168:171], v[28:31], v[56:59]
    v_mfma_f32_16x16x32_bf16 v[60:63], a[172:175], v[28:31], v[60:63]
    v_mfma_f32_16x16x32_bf16 v[64:67], a[176:179], v[28:31], v[64:67]
    v_mfma_f32_16x16x32_bf16 v[56:59], a[180:183], v[28:31], v[56:59]
    s_add_u32 m0, s87, 40960
    s_add_u32 s37, s86, 5964032
    buffer_load_dwordx4 v40, s[12:15], s37 offen offset:0 lds
    v_mfma_f32_16x16x32_bf16 v[60:63], a[184:187], v[28:31], v[60:63]
    v_mfma_f32_16x16x32_bf16 v[64:67], a[188:191], v[28:31], v[64:67]
    v_add_u32 v16, 73728, v42
    v_add_u32 v17, 73728, v43
    buffer_load_dwordx4 v41, s[12:15], s37 offen offset:1024 lds
    v_add_u32 v18, 73728, v44
    s_waitcnt vmcnt(24) lgkmcnt(0)
    s_barrier
    s_add_u32 m0, s87, 49152
    s_add_u32 s37, s86, 6422528
    buffer_load_dwordx4 v40, s[12:15], s37 offen offset:0 lds
    ds_read_b64_tr_b16 a[216:217], v16 offset:0
    ds_read_b64_tr_b16 a[218:219], v16 offset:2048
    ds_read_b64_tr_b16 a[220:221], v17 offset:0
    ds_read_b64_tr_b16 a[222:223], v17 offset:2048
    buffer_load_dwordx4 v41, s[12:15], s37 offen offset:1024 lds
    ds_read_b64_tr_b16 a[224:225], v18 offset:0
    ds_read_b64_tr_b16 a[226:227], v18 offset:2048
    ds_read_b64_tr_b16 a[228:229], v16 offset:4096
    ds_read_b64_tr_b16 a[230:231], v16 offset:6144
    s_add_u32 m0, s87, 57344
    s_add_u32 s37, s86, 6422656
    buffer_load_dwordx4 v40, s[12:15], s37 offen offset:0 lds
    ds_read_b64_tr_b16 a[232:233], v17 offset:4096
    ds_read_b64_tr_b16 a[234:235], v17 offset:6144
    ds_read_b64_tr_b16 a[236:237], v18 offset:4096
    ds_read_b64_tr_b16 a[238:239], v18 offset:6144
    buffer_load_dwordx4 v41, s[12:15], s37 offen offset:1024 lds
    v_mfma_f32_16x16x32_bf16 v[56:59], a[192:195], v[28:31], v[56:59]
    v_mfma_f32_16x16x32_bf16 v[60:63], a[196:199], v[28:31], v[60:63]
    v_mfma_f32_16x16x32_bf16 v[64:67], a[200:203], v[28:31], v[64:67]
    v_mfma_f32_16x16x32_bf16 v[56:59], a[204:207], v[28:31], v[56:59]
    s_add_u32 m0, s87, 65536
    s_add_u32 s37, s86, 6422784
    buffer_load_dwordx4 v40, s[12:15], s37 offen offset:0 lds
    v_mfma_f32_16x16x32_bf16 v[60:63], a[208:211], v[28:31], v[60:63]
    v_mfma_f32_16x16x32_bf16 v[64:67], a[212:215], v[28:31], v[64:67]
    v_add_u32 v12, 98304, v42
    v_add_u32 v13, 98304, v43
    buffer_load_dwordx4 v41, s[12:15], s37 offen offset:1024 lds
    v_add_u32 v14, 98304, v44
    s_waitcnt vmcnt(24) lgkmcnt(0)
    s_barrier
    s_add_u32 m0, s87, 73728
    s_add_u32 s37, s86, 6881280
    buffer_load_dwordx4 v40, s[12:15], s37 offen offset:0 lds
    ds_read_b64_tr_b16 a[240:241], v12 offset:0
    ds_read_b64_tr_b16 a[242:243], v12 offset:2048
    ds_read_b64_tr_b16 a[244:245], v13 offset:0
    ds_read_b64_tr_b16 a[246:247], v13 offset:2048
    buffer_load_dwordx4 v41, s[12:15], s37 offen offset:1024 lds
    ds_read_b64_tr_b16 a[248:249], v14 offset:0
    ds_read_b64_tr_b16 a[250:251], v14 offset:2048
    ds_read_b64_tr_b16 a[252:253], v12 offset:4096
    ds_read_b64_tr_b16 a[254:255], v12 offset:6144
    s_add_u32 m0, s87, 81920
    s_add_u32 s37, s86, 6881408
    buffer_load_dwordx4 v40, s[12:15], s37 offen offset:0 lds
    ds_read_b64_tr_b16 v[128:129], v13 offset:4096
    ds_read_b64_tr_b16 v[130:131], v13 offset:6144
    ds_read_b64_tr_b16 v[132:133], v14 offset:4096
    ds_read_b64_tr_b16 v[134:135], v14 offset:6144
    buffer_load_dwordx4 v41, s[12:15], s37 offen offset:1024 lds
    v_mfma_f32_16x16x32_bf16 v[56:59], a[216:219], v[28:31], v[56:59]
    v_mfma_f32_16x16x32_bf16 v[60:63], a[220:223], v[28:31], v[60:63]
    v_mfma_f32_16x16x32_bf16 v[64:67], a[224:227], v[28:31], v[64:67]
    v_mfma_f32_16x16x32_bf16 v[56:59], a[228:231], v[28:31], v[56:59]
    s_add_u32 m0, s87, 90112
    s_add_u32 s37, s86, 6881536
    buffer_load_dwordx4 v40, s[12:15], s37 offen offset:0 lds
    v_mfma_f32_16x16x32_bf16 v[60:63], a[232:235], v[28:31], v[60:63]
    v_mfma_f32_16x16x32_bf16 v[64:67], a[236:239], v[28:31], v[64:67]
    v_add_u32 v16, 122880, v42
    v_add_u32 v17, 122880, v43
    buffer_load_dwordx4 v41, s[12:15], s37 offen offset:1024 lds
    v_add_u32 v18, 122880, v44
    s_waitcnt vmcnt(24) lgkmcnt(0)
    s_barrier
    ds_read_b64_tr_b16 v[136:137], v16 offset:0
    ds_read_b64_tr_b16 v[138:139], v16 offset:2048
    ds_read_b64_tr_b16 v[140:141], v17 offset:0
    ds_read_b64_tr_b16 v[142:143], v17 offset:2048
    ds_read_b64_tr_b16 v[144:145], v18 offset:0
    ds_read_b64_tr_b16 v[146:147], v18 offset:2048
    ds_read_b64_tr_b16 v[148:149], v16 offset:4096
    ds_read_b64_tr_b16 v[150:151], v16 offset:6144
    ds_read_b64_tr_b16 v[152:153], v17 offset:4096
    ds_read_b64_tr_b16 v[154:155], v17 offset:6144
    ds_read_b64_tr_b16 v[156:157], v18 offset:4096
    ds_read_b64_tr_b16 v[158:159], v18 offset:6144
    v_mfma_f32_16x16x32_bf16 v[56:59], a[240:243], v[28:31], v[56:59]
    v_mfma_f32_16x16x32_bf16 v[60:63], a[244:247], v[28:31], v[60:63]
    v_mfma_f32_16x16x32_bf16 v[64:67], a[248:251], v[28:31], v[64:67]
    v_mfma_f32_16x16x32_bf16 v[56:59], a[252:255], v[28:31], v[56:59]
    v_mfma_f32_16x16x32_bf16 v[60:63], v[128:131], v[28:31], v[60:63]
    v_mfma_f32_16x16x32_bf16 v[64:67], v[132:135], v[28:31], v[64:67]
    v_add_u32 v12, 0, v42
    v_add_u32 v13, 0, v43
    v_add_u32 v14, 0, v44
    s_waitcnt vmcnt(18) lgkmcnt(0)
    s_barrier
    ds_read_b64_tr_b16 v[160:161], v12 offset:0
    ds_read_b64_tr_b16 v[162:163], v12 offset:2048
    ds_read_b64_tr_b16 v[164:165], v13 offset:0
    ds_read_b64_tr_b16 v[166:167], v13 offset:2048
    ds_read_b64_tr_b16 v[168:169], v14 offset:0
    ds_read_b64_tr_b16 v[170:171], v14 offset:2048
    ds_read_b64_tr_b16 v[172:173], v12 offset:4096
    ds_read_b64_tr_b16 v[174:175], v12 offset:6144
    ds_read_b64_tr_b16 v[176:177], v13 offset:4096
    ds_read_b64_tr_b16 v[178:179], v13 offset:6144
    ds_read_b64_tr_b16 v[180:181], v14 offset:4096
    ds_read_b64_tr_b16 v[182:183], v14 offset:6144
    v_mfma_f32_16x16x32_bf16 v[56:59], v[136:139], v[28:31], v[56:59]
    v_mfma_f32_16x16x32_bf16 v[60:63], v[140:143], v[28:31], v[60:63]
    v_mfma_f32_16x16x32_bf16 v[64:67], v[144:147], v[28:31], v[64:67]
    v_mfma_f32_16x16x32_bf16 v[56:59], v[148:151], v[28:31], v[56:59]
    v_mfma_f32_16x16x32_bf16 v[60:63], v[152:155], v[28:31], v[60:63]
    v_mfma_f32_16x16x32_bf16 v[64:67], v[156:159], v[28:31], v[64:67]
    v_add_u32 v16, 24576, v42
    v_add_u32 v17, 24576, v43
    v_add_u32 v18, 24576, v44
    s_waitcnt vmcnt(12) lgkmcnt(0)
    s_barrier
    ds_read_b64_tr_b16 v[184:185], v16 offset:0
    ds_read_b64_tr_b16 v[186:187], v16 offset:2048
    ds_read_b64_tr_b16 v[188:189], v17 offset:0
    ds_read_b64_tr_b16 v[190:191], v17 offset:2048
    ds_read_b64_tr_b16 v[192:193], v18 offset:0
    ds_read_b64_tr_b16 v[194:195], v18 offset:2048
    ds_read_b64_tr_b16 v[196:197], v16 offset:4096
    ds_read_b64_tr_b16 v[198:199], v16 offset:6144
    ds_read_b64_tr_b16 v[200:201], v17 offset:4096
    ds_read_b64_tr_b16 v[202:203], v17 offset:6144
    ds_read_b64_tr_b16 v[204:205], v18 offset:4096
    ds_read_b64_tr_b16 v[206:207], v18 offset:6144
    v_mfma_f32_16x16x32_bf16 v[56:59], v[160:163], v[28:31], v[56:59]
    v_mfma_f32_16x16x32_bf16 v[60:63], v[164:167], v[28:31], v[60:63]
    v_mfma_f32_16x16x32_bf16 v[64:67], v[168:171], v[28:31], v[64:67]
    v_mfma_f32_16x16x32_bf16 v[56:59], v[172:175], v[28:31], v[56:59]
    v_mfma_f32_16x16x32_bf16 v[60:63], v[176:179], v[28:31], v[60:63]
    v_mfma_f32_16x16x32_bf16 v[64:67], v[180:183], v[28:31], v[64:67]
    v_add_u32 v12, 49152, v42
    v_add_u32 v13, 49152, v43
    v_add_u32 v14, 49152, v44
    s_waitcnt vmcnt(6) lgkmcnt(0)
    s_barrier
    ds_read_b64_tr_b16 v[208:209], v12 offset:0
    ds_read_b64_tr_b16 v[210:211], v12 offset:2048
    ds_read_b64_tr_b16 v[212:213], v13 offset:0
    ds_read_b64_tr_b16 v[214:215], v13 offset:2048
    ds_read_b64_tr_b16 v[216:217], v14 offset:0
    ds_read_b64_tr_b16 v[218:219], v14 offset:2048
    ds_read_b64_tr_b16 v[220:221], v12 offset:4096
    ds_read_b64_tr_b16 v[222:223], v12 offset:6144
    ds_read_b64_tr_b16 v[224:225], v13 offset:4096
    ds_read_b64_tr_b16 v[226:227], v13 offset:6144
    ds_read_b64_tr_b16 v[228:229], v14 offset:4096
    ds_read_b64_tr_b16 v[230:231], v14 offset:6144
    v_mfma_f32_16x16x32_bf16 v[56:59], v[184:187], v[28:31], v[56:59]
    v_mfma_f32_16x16x32_bf16 v[60:63], v[188:191], v[28:31], v[60:63]
    v_mfma_f32_16x16x32_bf16 v[64:67], v[192:195], v[28:31], v[64:67]
    v_mfma_f32_16x16x32_bf16 v[56:59], v[196:199], v[28:31], v[56:59]
    v_mfma_f32_16x16x32_bf16 v[60:63], v[200:203], v[28:31], v[60:63]
    v_mfma_f32_16x16x32_bf16 v[64:67], v[204:207], v[28:31], v[64:67]
    v_add_u32 v16, 73728, v42
    v_add_u32 v17, 73728, v43
    v_add_u32 v18, 73728, v44
    s_waitcnt vmcnt(0) lgkmcnt(0)
    s_barrier
    ds_read_b64_tr_b16 v[232:233], v16 offset:0
    ds_read_b64_tr_b16 v[234:235], v16 offset:2048
    ds_read_b64_tr_b16 v[236:237], v17 offset:0
    ds_read_b64_tr_b16 v[238:239], v17 offset:2048
    ds_read_b64_tr_b16 v[240:241], v18 offset:0
    ds_read_b64_tr_b16 v[242:243], v18 offset:2048
    ds_read_b64_tr_b16 v[244:245], v16 offset:4096
    ds_read_b64_tr_b16 v[246:247], v16 offset:6144
    ds_read_b64_tr_b16 v[248:249], v17 offset:4096
    ds_read_b64_tr_b16 v[250:251], v17 offset:6144
    ds_read_b64_tr_b16 v[252:253], v18 offset:4096
    ds_read_b64_tr_b16 v[254:255], v18 offset:6144
    v_mfma_f32_16x16x32_bf16 v[56:59], v[208:211], v[28:31], v[56:59]
    v_mfma_f32_16x16x32_bf16 v[60:63], v[212:215], v[28:31], v[60:63]
    v_mfma_f32_16x16x32_bf16 v[64:67], v[216:219], v[28:31], v[64:67]
    v_mfma_f32_16x16x32_bf16 v[56:59], v[220:223], v[28:31], v[56:59]
    v_mfma_f32_16x16x32_bf16 v[60:63], v[224:227], v[28:31], v[60:63]
    v_mfma_f32_16x16x32_bf16 v[64:67], v[228:231], v[28:31], v[64:67]
    s_waitcnt lgkmcnt(0)
    v_mfma_f32_16x16x32_bf16 v[56:59], v[232:235], v[28:31], v[56:59]
    v_mfma_f32_16x16x32_bf16 v[60:63], v[236:239], v[28:31], v[60:63]
    v_mfma_f32_16x16x32_bf16 v[64:67], v[240:243], v[28:31], v[64:67]
    v_mfma_f32_16x16x32_bf16 v[56:59], v[244:247], v[28:31], v[56:59]
    v_mfma_f32_16x16x32_bf16 v[60:63], v[248:251], v[28:31], v[60:63]
    v_mfma_f32_16x16x32_bf16 v[64:67], v[252:255], v[28:31], v[64:67]
    s_mov_b32 s12, s84
    s_mov_b32 s13, s85
    s_mov_b32 s14, 0x6200000
    s_mov_b32 s15, 0x00020000
    s_barrier
    s_mov_b32 s20, s82
    s_mov_b32 s21, s83
    s_mov_b32 s22, 0x100
    s_mov_b32 s23, 0x00020000
    v_and_b32 v8, 15, v0
    v_lshlrev_b32 v8, 4, v8
    buffer_load_dword v9, v8, s[20:23], 0 offen sc1
    s_waitcnt vmcnt(0)
Lffa_wa:
    v_cmp_gt_u32 vcc, 8, v9
    s_sub_u32 s43, s43, 1
    s_cmp_lt_i32 s43, 0
    s_cbranch_scc1 Lffa_all
    s_cbranch_vccz Lffa_all
    s_sleep 2
    buffer_load_dword v9, v8, s[20:23], 0 offen sc1
    s_waitcnt vmcnt(0)
    s_branch Lffa_wa
Lffa_all:
    s_mov_b32 s14, 0
    s_branch Lffa_spin1
    .p2align 6
Lffa_body03:
    s_waitcnt lgkmcnt(2)
    v_mfma_f32_16x16x32_bf16 v[8:11], a[0:3], v[40:43], 0
    ds_read_b128 v[52:55], v2 offset:3072
    s_add_u32 m0, s34, 0
    v_mfma_f32_16x16x32_bf16 v[12:15], a[4:7], v[40:43], 0
    s_add_u32 s31, s31, 1
    v_mov_b32 v6, s31
    v_fma_f32 v124, v32, v21, v88
    v_mfma_f32_16x16x32_bf16 v[16:19], a[8:11], v[40:43], 0
    s_waitcnt lgkmcnt(2)
    v_fma_f32 v125, v33, v21, v89
    v_fma_f32 v126, v34, v21, v90
    v_mfma_f32_16x16x32_bf16 v[16:19], a[20:23], v[44:47], v[16:19]
    ds_read_b128 v[40:43], v2 offset:4096
    v_fma_f32 v127, v35, v21, v91
    v_mfma_f32_16x16x32_bf16 v[12:15], a[16:19], v[44:47], v[12:15]
    s_add_u32 s35, s35, 36864
    v_mul_f32 v124, v124, |v124|
    v_mul_f32 v125, v125, |v125|
    v_mfma_f32_16x16x32_bf16 v[8:11], a[12:15], v[44:47], v[8:11]
    s_waitcnt lgkmcnt(2)
    v_mul_f32 v126, v126, |v126|
    v_mul_f32 v127, v127, |v127|
    v_mfma_f32_16x16x32_bf16 v[8:11], a[24:27], v[48:51], v[8:11]
    ds_read_b128 v[44:47], v2 offset:5120
    v_cvt_pk_bf16_f32 v124, v124, v125
    v_mfma_f32_16x16x32_bf16 v[12:15], a[28:31], v[48:51], v[12:15]
    s_cmp_eq_u32 s35, 147456
    s_cselect_b32 s35, 0, s35
    v_cvt_pk_bf16_f32 v126, v126, v127
    v_mfma_f32_16x16x32_bf16 v[16:19], a[32:35], v[48:51], v[16:19]
    s_waitcnt vmcnt(1) lgkmcnt(2)
    v_cmp_gt_i32 vcc, s32, v5
    v_pk_max_i16 v96, v124, 0
    v_mfma_f32_16x16x32_bf16 v[16:19], a[44:47], v[52:55], v[16:19]
    ds_read_b128 v[48:51], v2 offset:6144
    v_pk_max_i16 v97, v126, 0
    v_mfma_f32_16x16x32_bf16 v[12:15], a[40:43], v[52:55], v[12:15]
    s_and_b64 vcc, vcc, s[18:19]
    s_cbranch_scc1 Lffa_v01
    v_mfma_f32_16x16x32_bf16 v[8:11], a[36:39], v[52:55], v[8:11]
    s_waitcnt lgkmcnt(2)
    buffer_load_dwordx4 v1, s[8:11], s33 offen offset:0 sc1 lds
    v_mfma_f32_16x16x32_bf16 v[8:11], a[48:51], v[40:43], v[8:11]
    ds_read_b128 v[52:55], v2 offset:7168
    v_pk_max_i16 v98, v124, 0
    v_mfma_f32_16x16x32_bf16 v[12:15], a[52:55], v[40:43], v[12:15]
    v_pk_max_i16 v99, v126, 0
    v_fma_f32 v116, v24, v21, v80
    v_mfma_f32_16x16x32_bf16 v[16:19], a[56:59], v[40:43], v[16:19]
    s_waitcnt lgkmcnt(2)
    v_permlane32_swap_b32 v96, v98
    v_mfma_f32_16x16x32_bf16 v[16:19], a[68:71], v[44:47], v[16:19]
    ds_read_b128 v[40:43], v2 offset:8192
    v_fma_f32 v117, v25, v21, v81
    v_mfma_f32_16x16x32_bf16 v[12:15], a[64:67], v[44:47], v[12:15]
    buffer_load_dwordx4 v1, s[8:11], s33 offen offset:1024 sc1 lds
    v_mfma_f32_16x16x32_bf16 v[8:11], a[60:63], v[44:47], v[8:11]
    s_waitcnt lgkmcnt(2)
    v_permlane32_swap_b32 v97, v99
    v_mfma_f32_16x16x32_bf16 v[8:11], a[72:75], v[48:51], v[8:11]
    ds_read_b128 v[44:47], v2 offset:9216
    v_fma_f32 v118, v26, v21, v82
    v_mfma_f32_16x16x32_bf16 v[12:15], a[76:79], v[48:51], v[12:15]
    v_fma_f32 v119, v27, v21, v83
    v_fma_f32 v120, v28, v21, v84
    v_mfma_f32_16x16x32_bf16 v[16:19], a[80:83], v[48:51], v[16:19]
    s_waitcnt lgkmcnt(2)
    buffer_store_dwordx4 v[96:99], v7, s[12:15], s36 offen sc1
    v_fma_f32 v121, v29, v21, v85
    v_mfma_f32_16x16x32_bf16 v[16:19], a[92:95], v[52:55], v[16:19]
    ds_read_b128 v[48:51], v2 offset:10240
    v_fma_f32 v122, v30, v21, v86
    v_mfma_f32_16x16x32_bf16 v[12:15], a[88:91], v[52:55], v[12:15]
    v_fma_f32 v123, v31, v21, v87
    v_mul_f32 v116, v116, |v116|
    v_mfma_f32_16x16x32_bf16 v[8:11], a[84:87], v[52:55], v[8:11]
    s_waitcnt lgkmcnt(2)
    v_mul_f32 v117, v117, |v117|
    v_mul_f32 v118, v118, |v118|
    v_mfma_f32_16x16x32_bf16 v[8:11], a[96:99], v[40:43], v[8:11]
    ds_read_b128 v[52:55], v2 offset:11264
    v_mul_f32 v119, v119, |v119|
    v_mfma_f32_16x16x32_bf16 v[12:15], a[100:103], v[40:43], v[12:15]
    buffer_load_dwordx4 v1, s[8:11], s33 offen offset:2048 sc1 lds
    v_mfma_f32_16x16x32_bf16 v[16:19], a[104:107], v[40:43], v[16:19]
    s_waitcnt lgkmcnt(2)
    v_mul_f32 v120, v120, |v120|
    v_mul_f32 v121, v121, |v121|
    v_mfma_f32_16x16x32_bf16 v[16:19], a[116:119], v[44:47], v[16:19]
    ds_read_b128 v[40:43], v2 offset:12288
    v_mul_f32 v122, v122, |v122|
    v_mfma_f32_16x16x32_bf16 v[12:15], a[112:115], v[44:47], v[12:15]
    v_mul_f32 v123, v123, |v123|
    v_cvt_pk_bf16_f32 v116, v116, v117
    v_mfma_f32_16x16x32_bf16 v[8:11], a[108:111], v[44:47], v[8:11]
    s_waitcnt lgkmcnt(2)
    buffer_load_dwordx4 v1, s[8:11], s33 offen offset:3072 sc1 lds
    v_mfma_f32_16x16x32_bf16 v[8:11], a[120:123], v[48:51], v[8:11]
    ds_read_b128 v[44:47], v2 offset:13312
    s_add_u32 s16, s16, 8192
    v_mfma_f32_16x16x32_bf16 v[12:15], a[124:127], v[48:51], v[12:15]
    s_waitcnt vmcnt(5)
    s_barrier
    v_mfma_f32_16x16x32_bf16 v[16:19], a[128:131], v[48:51], v[16:19]
    s_waitcnt lgkmcnt(2)
    s_add_u32 m0, s34, s3
    s_add_u32 s37, s33, s3
    v_mfma_f32_16x16x32_bf16 v[16:19], a[140:143], v[52:55], v[16:19]
    ds_read_b128 v[48:51], v2 offset:14336
    v_cvt_pk_bf16_f32 v118, v118, v119
    v_mfma_f32_16x16x32_bf16 v[12:15], a[136:139], v[52:55], v[12:15]
    buffer_load_dwordx4 v1, s[8:11], s37 offen offset:0 sc1 lds
    v_mfma_f32_16x16x32_bf16 v[8:11], a[132:135], v[52:55], v[8:11]
    s_waitcnt lgkmcnt(2)
    v_cvt_pk_bf16_f32 v120, v120, v121
    v_cvt_pk_bf16_f32 v122, v122, v123
    v_mfma_f32_16x16x32_bf16 v[8:11], a[144:147], v[40:43], v[8:11]
    ds_read_b128 v[52:55], v2 offset:15360
    v_pk_max_i16 v92, v116, 0
    v_mfma_f32_16x16x32_bf16 v[12:15], a[148:151], v[40:43], v[12:15]
    v_pk_max_i16 v93, v118, 0
    v_pk_max_i16 v94, v120, 0
    v_mfma_f32_16x16x32_bf16 v[16:19], a[152:155], v[40:43], v[16:19]
    s_waitcnt lgkmcnt(2)
    buffer_load_dwordx4 v1, s[8:11], s37 offen offset:1024 sc1 lds
    v_mfma_f32_16x16x32_bf16 v[16:19], a[164:167], v[44:47], v[16:19]
    ds_read_b128 v[40:43], v2 offset:16384
    v_pk_max_i16 v95, v122, 0
    v_mfma_f32_16x16x32_bf16 v[12:15], a[160:163], v[44:47], v[12:15]
    v_add_u32 v3, s35, v1
    v_sub_u32 v100, v2, v20
    v_mfma_f32_16x16x32_bf16 v[8:11], a[156:159], v[44:47], v[8:11]
    s_waitcnt lgkmcnt(2)
    ds_read2st64_b64 v[112:115], v100 offset0:70 offset1:71
    v_mfma_f32_16x16x32_bf16 v[8:11], a[168:171], v[48:51], v[8:11]
    ds_read_b128 v[44:47], v2 offset:17408
    v_mfma_f32_16x16x32_bf16 v[12:15], a[172:175], v[48:51], v[12:15]
    buffer_store_dwordx4 v[92:95], v1, s[12:15], s36 offen sc1
    s_add_u32 s36, s36, 116736
    v_mfma_f32_16x16x32_bf16 v[16:19], a[176:179], v[48:51], v[16:19]
    s_waitcnt lgkmcnt(3)
    ds_read2st64_b64 v[108:111], v100 offset0:68 offset1:69
    v_mfma_f32_16x16x32_bf16 v[16:19], a[188:191], v[52:55], v[16:19]
    ds_read_b128 v[48:51], v2 offset:18432
    v_mfma_f32_16x16x32_bf16 v[12:15], a[184:187], v[52:55], v[12:15]
    ds_read2st64_b64 v[104:107], v100 offset0:66 offset1:67
    v_mfma_f32_16x16x32_bf16 v[8:11], a[180:183], v[52:55], v[8:11]
    s_waitcnt lgkmcnt(5)
    buffer_load_dwordx4 v1, s[8:11], s37 offen offset:2048 sc1 lds
    v_mfma_f32_16x16x32_bf16 v[8:11], a[192:195], v[40:43], v[8:11]
    ds_read_b128 v[52:55], v2 offset:19456
    v_mfma_f32_16x16x32_bf16 v[12:15], a[196:199], v[40:43], v[12:15]
    ds_read2st64_b64 v[100:103], v100 offset0:64 offset1:65
    v_mfma_f32_16x16x32_bf16 v[16:19], a[200:203], v[40:43], v[16:19]
    s_waitcnt lgkmcnt(5)
    v_mfma_f32_16x16x32_bf16 v[16:19], a[212:215], v[44:47], v[16:19]
    ds_read_b128 v[40:43], v2 offset:20480
    v_mfma_f32_16x16x32_bf16 v[12:15], a[208:211], v[44:47], v[12:15]
    buffer_load_dwordx4 v1, s[8:11], s37 offen offset:3072 sc1 lds
    v_mfma_f32_16x16x32_bf16 v[8:11], a[204:207], v[44:47], v[8:11]
    s_waitcnt lgkmcnt(4)
    s_add_u32 m0, s34, s41
    s_add_u32 s37, s33, s41
    v_mfma_f32_16x16x32_bf16 v[8:11], a[216:219], v[48:51], v[8:11]
    ds_read_b128 v[44:47], v2 offset:21504
    v_mfma_f32_16x16x32_bf16 v[12:15], a[220:223], v[48:51], v[12:15]
    v_mfma_f32_16x16x32_bf16 v[16:19], a[224:227], v[48:51], v[16:19]
    s_waitcnt lgkmcnt(3)
    buffer_load_dwordx4 v1, s[8:11], s37 offen offset:0 sc1 lds
    v_mfma_f32_16x16x32_bf16 v[16:19], a[236:239], v[52:55], v[16:19]
    ds_read_b128 v[48:51], v2 offset:22528
    s_add_u32 s32, s32, 1
    v_mfma_f32_16x16x32_bf16 v[12:15], a[232:235], v[52:55], v[12:15]
    s_add_u32 s33, s33, 36864
    s_add_u32 s34, s34, 36864
    s_waitcnt lgkmcnt(3)
    v_mfma_f32_16x16x32_bf16 v[8:11], a[228:231], v[52:55], v[8:11]
    s_waitcnt lgkmcnt(2)
    s_cmp_ge_u32 s34, 147456
    s_cselect_b32 s38, 147456, 0
    v_mfma_f32_16x16x32_bf16 v[8:11], a[240:243], v[40:43], v[8:11]
    ds_read_b128 v[52:55], v2 offset:23552
    s_sub_u32 s34, s34, s38
    v_mfma_f32_16x16x32_bf16 v[12:15], a[244:247], v[40:43], v[12:15]
    buffer_load_dword v5, v4, s[4:7], s16 offen sc1
    v_mfma_f32_16x16x32_bf16 v[16:19], a[248:251], v[40:43], v[16:19]
    s_waitcnt lgkmcnt(2)
    v_add_f32 v100, v100, v108
    v_add_f32 v101, v101, v109
    v_mfma_f32_16x16x32_bf16 v[16:19], v[132:135], v[44:47], v[16:19]
    ds_read_b128 v[40:43], v2 offset:24576
    v_add_f32 v102, v102, v110
    v_mfma_f32_16x16x32_bf16 v[12:15], v[128:131], v[44:47], v[12:15]
    v_add_f32 v103, v103, v111
    v_add_f32 v104, v104, v112
    v_mfma_f32_16x16x32_bf16 v[8:11], a[252:255], v[44:47], v[8:11]
    s_waitcnt lgkmcnt(2)
    v_add_f32 v105, v105, v113
    v_add_f32 v106, v106, v114
    v_mfma_f32_16x16x32_bf16 v[8:11], v[136:139], v[48:51], v[8:11]
    ds_read_b128 v[44:47], v2 offset:25600
    v_add_f32 v107, v107, v115
    v_mfma_f32_16x16x32_bf16 v[12:15], v[140:143], v[48:51], v[12:15]
    v_add_f32 v100, v100, v104
    v_add_f32 v101, v101, v105
    v_mfma_f32_16x16x32_bf16 v[16:19], v[144:147], v[48:51], v[16:19]
    s_waitcnt lgkmcnt(2)
    v_add_f32 v102, v102, v106
    v_add_f32 v103, v103, v107
    v_mfma_f32_16x16x32_bf16 v[16:19], v[156:159], v[52:55], v[16:19]
    ds_read_b128 v[48:51], v2 offset:26624
    v_add_f32 v100, v100, v102
    v_mfma_f32_16x16x32_bf16 v[12:15], v[152:155], v[52:55], v[12:15]
    v_add_f32 v101, v101, v103
    v_mfma_f32_16x16x32_bf16 v[8:11], v[148:151], v[52:55], v[8:11]
    s_waitcnt lgkmcnt(2)
    v_permlane16_swap_b32 v100, v101
    v_mfma_f32_16x16x32_bf16 v[8:11], v[160:163], v[40:43], v[8:11]
    ds_read_b128 v[52:55], v2 offset:27648
    v_add_f32 v100, v100, v101
    v_mfma_f32_16x16x32_bf16 v[12:15], v[164:167], v[40:43], v[12:15]
    v_mov_b32 v101, v100
    v_mfma_f32_16x16x32_bf16 v[16:19], v[168:171], v[40:43], v[16:19]
    s_waitcnt lgkmcnt(2)
    v_permlane32_swap_b32 v100, v101
    v_mfma_f32_16x16x32_bf16 v[16:19], v[180:183], v[44:47], v[16:19]
    ds_read_b128 v[40:43], v2 offset:28672
    v_add_f32 v100, v100, v101
    v_mfma_f32_16x16x32_bf16 v[12:15], v[176:179], v[44:47], v[12:15]
    v_mul_f32 v100, 0x3a800000, v100
    v_mov_b32 v101, v100
    v_mfma_f32_16x16x32_bf16 v[8:11], v[172:175], v[44:47], v[8:11]
    s_waitcnt lgkmcnt(2)
    v_permlane16_swap_b32 v100, v101
    v_mfma_f32_16x16x32_bf16 v[8:11], v[184:187], v[48:51], v[8:11]
    ds_read_b128 v[44:47], v2 offset:29696
    v_fma_f32 v101, -v100, v100, v101
    v_mfma_f32_16x16x32_bf16 v[12:15], v[188:191], v[48:51], v[12:15]
    s_waitcnt vmcnt(7)
    s_barrier
    v_mfma_f32_16x16x32_bf16 v[16:19], v[192:195], v[48:51], v[16:19]
    s_waitcnt lgkmcnt(2)
    v_max_f32 v101, 0, v101
    v_add_f32 v101, 0x3727c5ac, v101
    v_mfma_f32_16x16x32_bf16 v[16:19], v[204:207], v[52:55], v[16:19]
    ds_read_b128 v[48:51], v2 offset:30720
    v_mfma_f32_16x16x32_bf16 v[12:15], v[200:203], v[52:55], v[12:15]
    v_rsq_f32 v21, v101
    v_mfma_f32_16x16x32_bf16 v[8:11], v[196:199], v[52:55], v[8:11]
    s_waitcnt lgkmcnt(2)
    v_mul_f32 v100, v100, v21
    v_fma_f32 v80, -v100, v56, v68
    v_mfma_f32_16x16x32_bf16 v[8:11], v[208:211], v[40:43], v[8:11]
    ds_read_b128 v[52:55], v2 offset:31744
    v_fma_f32 v81, -v100, v57, v69
    v_mfma_f32_16x16x32_bf16 v[12:15], v[212:215], v[40:43], v[12:15]
    s_waitcnt vmcnt(4)
    buffer_store_dword v6, v22, s[12:15], s17 offen sc1
    v_mfma_f32_16x16x32_bf16 v[16:19], v[216:219], v[40:43], v[16:19]
    s_waitcnt lgkmcnt(2)
    v_fma_f32 v82, -v100, v58, v70
    v_fma_f32 v83, -v100, v59, v71
    v_mfma_f32_16x16x32_bf16 v[16:19], v[228:231], v[44:47], v[16:19]
    ds_read_b128 v[40:43], v3 offset:0
    v_fma_f32 v84, -v100, v60, v72
    v_mfma_f32_16x16x32_bf16 v[12:15], v[224:227], v[44:47], v[12:15]
    s_mov_b32 s14, s6
    v_fma_f32 v85, -v100, v61, v73
    v_fma_f32 v86, -v100, v62, v74
    v_mfma_f32_16x16x32_bf16 v[8:11], v[220:223], v[44:47], v[8:11]
    s_waitcnt lgkmcnt(2)
    v_fma_f32 v87, -v100, v63, v75
    v_fma_f32 v88, -v100, v64, v76
    v_mfma_f32_16x16x32_bf16 v[8:11], v[232:235], v[48:51], v[8:11]
    ds_read_b128 v[44:47], v3 offset:1024
    v_fma_f32 v89, -v100, v65, v77
    v_mfma_f32_16x16x32_bf16 v[12:15], v[236:239], v[48:51], v[12:15]
    s_add_u32 s17, s17, 8192
    v_fma_f32 v90, -v100, v66, v78
    v_fma_f32 v91, -v100, v67, v79
    v_mfma_f32_16x16x32_bf16 v[16:19], v[240:243], v[48:51], v[16:19]
    s_waitcnt lgkmcnt(2)
    v_mfma_f32_16x16x32_bf16 v[16:19], v[252:255], v[52:55], v[16:19]
    ds_read_b128 v[48:51], v3 offset:2048
    v_mfma_f32_16x16x32_bf16 v[12:15], v[248:251], v[52:55], v[12:15]
    v_mfma_f32_16x16x32_bf16 v[8:11], v[244:247], v[52:55], v[8:11]
Lffa_body13:
    s_waitcnt lgkmcnt(2)
    v_mfma_f32_16x16x32_bf16 v[24:27], a[0:3], v[40:43], 0
    ds_read_b128 v[52:55], v3 offset:3072
    s_add_u32 m0, s34, 0
    v_mfma_f32_16x16x32_bf16 v[28:31], a[4:7], v[40:43], 0
    s_add_u32 s31, s31, 1
    v_mov_b32 v6, s31
    v_fma_f32 v124, v16, v21, v88
    v_mfma_f32_16x16x32_bf16 v[32:35], a[8:11], v[40:43], 0
    s_waitcnt lgkmcnt(2)
    v_fma_f32 v125, v17, v21, v89
    v_fma_f32 v126, v18, v21, v90
    v_mfma_f32_16x16x32_bf16 v[32:35], a[20:23], v[44:47], v[32:35]
    ds_read_b128 v[40:43], v3 offset:4096
    v_fma_f32 v127, v19, v21, v91
    v_mfma_f32_16x16x32_bf16 v[28:31], a[16:19], v[44:47], v[28:31]
    s_add_u32 s35, s35, 36864
    v_mul_f32 v124, v124, |v124|
    v_mul_f32 v125, v125, |v125|
    v_mfma_f32_16x16x32_bf16 v[24:27], a[12:15], v[44:47], v[24:27]
    s_waitcnt lgkmcnt(2)
    v_mul_f32 v126, v126, |v126|
    v_mul_f32 v127, v127, |v127|
    v_mfma_f32_16x16x32_bf16 v[24:27], a[24:27], v[48:51], v[24:27]
    ds_read_b128 v[44:47], v3 offset:5120
    v_cvt_pk_bf16_f32 v124, v124, v125
    v_mfma_f32_16x16x32_bf16 v[28:31], a[28:31], v[48:51], v[28:31]
    s_cmp_eq_u32 s35, 147456
    s_cselect_b32 s35, 0, s35
    v_cvt_pk_bf16_f32 v126, v126, v127
    v_mfma_f32_16x16x32_bf16 v[32:35], a[32:35], v[48:51], v[32:35]
    s_waitcnt vmcnt(1) lgkmcnt(2)
    v_cmp_gt_i32 vcc, s32, v5
    v_pk_max_i16 v96, v124, 0
    v_mfma_f32_16x16x32_bf16 v[32:35], a[44:47], v[52:55], v[32:35]
    ds_read_b128 v[48:51], v3 offset:6144
    v_pk_max_i16 v97, v126, 0
    v_mfma_f32_16x16x32_bf16 v[28:31], a[40:43], v[52:55], v[28:31]
    s_and_b64 vcc, vcc, s[18:19]
    s_cbranch_scc1 Lffa_v11
    v_mfma_f32_16x16x32_bf16 v[24:27], a[36:39], v[52:55], v[24:27]
    s_waitcnt lgkmcnt(2)
    buffer_load_dwordx4 v1, s[8:11], s33 offen offset:0 sc1 lds
    v_mfma_f32_16x16x32_bf16 v[24:27], a[48:51], v[40:43], v[24:27]
    ds_read_b128 v[52:55], v3 offset:7168
    v_pk_max_i16 v98, v124, 0
    v_mfma_f32_16x16x32_bf16 v[28:31], a[52:55], v[40:43], v[28:31]
    v_pk_max_i16 v99, v126, 0
    v_fma_f32 v116, v8, v21, v80
    v_mfma_f32_16x16x32_bf16 v[32:35], a[56:59], v[40:43], v[32:35]
    s_waitcnt lgkmcnt(2)
    v_permlane32_swap_b32 v96, v98
    v_mfma_f32_16x16x32_bf16 v[32:35], a[68:71], v[44:47], v[32:35]
    ds_read_b128 v[40:43], v3 offset:8192
    v_fma_f32 v117, v9, v21, v81
    v_mfma_f32_16x16x32_bf16 v[28:31], a[64:67], v[44:47], v[28:31]
    buffer_load_dwordx4 v1, s[8:11], s33 offen offset:1024 sc1 lds
    v_mfma_f32_16x16x32_bf16 v[24:27], a[60:63], v[44:47], v[24:27]
    s_waitcnt lgkmcnt(2)
    v_permlane32_swap_b32 v97, v99
    v_mfma_f32_16x16x32_bf16 v[24:27], a[72:75], v[48:51], v[24:27]
    ds_read_b128 v[44:47], v3 offset:9216
    v_fma_f32 v118, v10, v21, v82
    v_mfma_f32_16x16x32_bf16 v[28:31], a[76:79], v[48:51], v[28:31]
    v_fma_f32 v119, v11, v21, v83
    v_fma_f32 v120, v12, v21, v84
    v_mfma_f32_16x16x32_bf16 v[32:35], a[80:83], v[48:51], v[32:35]
    s_waitcnt lgkmcnt(2)
    buffer_store_dwordx4 v[96:99], v7, s[12:15], s36 offen sc1
    v_fma_f32 v121, v13, v21, v85
    v_mfma_f32_16x16x32_bf16 v[32:35], a[92:95], v[52:55], v[32:35]
    ds_read_b128 v[48:51], v3 offset:10240
    v_fma_f32 v122, v14, v21, v86
    v_mfma_f32_16x16x32_bf16 v[28:31], a[88:91], v[52:55], v[28:31]
    v_fma_f32 v123, v15, v21, v87
    v_mul_f32 v116, v116, |v116|
    v_mfma_f32_16x16x32_bf16 v[24:27], a[84:87], v[52:55], v[24:27]
    s_waitcnt lgkmcnt(2)
    v_mul_f32 v117, v117, |v117|
    v_mul_f32 v118, v118, |v118|
    v_mfma_f32_16x16x32_bf16 v[24:27], a[96:99], v[40:43], v[24:27]
    ds_read_b128 v[52:55], v3 offset:11264
    v_mul_f32 v119, v119, |v119|
    v_mfma_f32_16x16x32_bf16 v[28:31], a[100:103], v[40:43], v[28:31]
    buffer_load_dwordx4 v1, s[8:11], s33 offen offset:2048 sc1 lds
    v_mfma_f32_16x16x32_bf16 v[32:35], a[104:107], v[40:43], v[32:35]
    s_waitcnt lgkmcnt(2)
    v_mul_f32 v120, v120, |v120|
    v_mul_f32 v121, v121, |v121|
    v_mfma_f32_16x16x32_bf16 v[32:35], a[116:119], v[44:47], v[32:35]
    ds_read_b128 v[40:43], v3 offset:12288
    v_mul_f32 v122, v122, |v122|
    v_mfma_f32_16x16x32_bf16 v[28:31], a[112:115], v[44:47], v[28:31]
    v_mul_f32 v123, v123, |v123|
    v_cvt_pk_bf16_f32 v116, v116, v117
    v_mfma_f32_16x16x32_bf16 v[24:27], a[108:111], v[44:47], v[24:27]
    s_waitcnt lgkmcnt(2)
    buffer_load_dwordx4 v1, s[8:11], s33 offen offset:3072 sc1 lds
    v_mfma_f32_16x16x32_bf16 v[24:27], a[120:123], v[48:51], v[24:27]
    ds_read_b128 v[44:47], v3 offset:13312
    s_add_u32 s16, s16, 8192
    v_mfma_f32_16x16x32_bf16 v[28:31], a[124:127], v[48:51], v[28:31]
    s_waitcnt vmcnt(5)
    s_barrier
    v_mfma_f32_16x16x32_bf16 v[32:35], a[128:131], v[48:51], v[32:35]
    s_waitcnt lgkmcnt(2)
    s_add_u32 m0, s34, s3
    s_add_u32 s37, s33, s3
    v_mfma_f32_16x16x32_bf16 v[32:35], a[140:143], v[52:55], v[32:35]
    ds_read_b128 v[48:51], v3 offset:14336
    v_cvt_pk_bf16_f32 v118, v118, v119
    v_mfma_f32_16x16x32_bf16 v[28:31], a[136:139], v[52:55], v[28:31]
    buffer_load_dwordx4 v1, s[8:11], s37 offen offset:0 sc1 lds
    v_mfma_f32_16x16x32_bf16 v[24:27], a[132:135], v[52:55], v[24:27]
    s_waitcnt lgkmcnt(2)
    v_cvt_pk_bf16_f32 v120, v120, v121
    v_cvt_pk_bf16_f32 v122, v122, v123
    v_mfma_f32_16x16x32_bf16 v[24:27], a[144:147], v[40:43], v[24:27]
    ds_read_b128 v[52:55], v3 offset:15360
    v_pk_max_i16 v92, v116, 0
    v_mfma_f32_16x16x32_bf16 v[28:31], a[148:151], v[40:43], v[28:31]
    v_pk_max_i16 v93, v118, 0
    v_pk_max_i16 v94, v120, 0
    v_mfma_f32_16x16x32_bf16 v[32:35], a[152:155], v[40:43], v[32:35]
    s_waitcnt lgkmcnt(2)
    buffer_load_dwordx4 v1, s[8:11], s37 offen offset:1024 sc1 lds
    v_mfma_f32_16x16x32_bf16 v[32:35], a[164:167], v[44:47], v[32:35]
    ds_read_b128 v[40:43], v3 offset:16384
    v_pk_max_i16 v95, v122, 0
    v_mfma_f32_16x16x32_bf16 v[28:31], a[160:163], v[44:47], v[28:31]
    v_add_u32 v2, s35, v1
    v_sub_u32 v100, v3, v20
    v_mfma_f32_16x16x32_bf16 v[24:27], a[156:159], v[44:47], v[24:27]
    s_waitcnt lgkmcnt(2)
    ds_read2st64_b64 v[112:115], v100 offset0:70 offset1:71
    v_mfma_f32_16x16x32_bf16 v[24:27], a[168:171], v[48:51], v[24:27]
    ds_read_b128 v[44:47], v3 offset:17408
    v_mfma_f32_16x16x32_bf16 v[28:31], a[172:175], v[48:51], v[28:31]
    buffer_store_dwordx4 v[92:95], v1, s[12:15], s36 offen sc1
    s_add_u32 s36, s36, 116736
    v_mfma_f32_16x16x32_bf16 v[32:35], a[176:179], v[48:51], v[32:35]
    s_waitcnt lgkmcnt(3)
    ds_read2st64_b64 v[108:111], v100 offset0:68 offset1:69
    v_mfma_f32_16x16x32_bf16 v[32:35], a[188:191], v[52:55], v[32:35]
    ds_read_b128 v[48:51], v3 offset:18432
    v_mfma_f32_16x16x32_bf16 v[28:31], a[184:187], v[52:55], v[28:31]
    ds_read2st64_b64 v[104:107], v100 offset0:66 offset1:67
    v_mfma_f32_16x16x32_bf16 v[24:27], a[180:183], v[52:55], v[24:27]
    s_waitcnt lgkmcnt(5)
    buffer_load_dwordx4 v1, s[8:11], s37 offen offset:2048 sc1 lds
    v_mfma_f32_16x16x32_bf16 v[24:27], a[192:195], v[40:43], v[24:27]
    ds_read_b128 v[52:55], v3 offset:19456
    v_mfma_f32_16x16x32_bf16 v[28:31], a[196:199], v[40:43], v[28:31]
    ds_read2st64_b64 v[100:103], v100 offset0:64 offset1:65
    v_mfma_f32_16x16x32_bf16 v[32:35], a[200:203], v[40:43], v[32:35]
    s_waitcnt lgkmcnt(5)
    v_mfma_f32_16x16x32_bf16 v[32:35], a[212:215], v[44:47], v[32:35]
    ds_read_b128 v[40:43], v3 offset:20480
    v_mfma_f32_16x16x32_bf16 v[28:31], a[208:211], v[44:47], v[28:31]
    buffer_load_dwordx4 v1, s[8:11], s37 offen offset:3072 sc1 lds
    v_mfma_f32_16x16x32_bf16 v[24:27], a[204:207], v[44:47], v[24:27]
    s_waitcnt lgkmcnt(4)
    s_add_u32 m0, s34, s41
    s_add_u32 s37, s33, s41
    v_mfma_f32_16x16x32_bf16 v[24:27], a[216:219], v[48:51], v[24:27]
    ds_read_b128 v[44:47], v3 offset:21504
    v_mfma_f32_16x16x32_bf16 v[28:31], a[220:223], v[48:51], v[28:31]
    v_mfma_f32_16x16x32_bf16 v[32:35], a[224:227], v[48:51], v[32:35]
    s_waitcnt lgkmcnt(3)
    buffer_load_dwordx4 v1, s[8:11], s37 offen offset:0 sc1 lds
    v_mfma_f32_16x16x32_bf16 v[32:35], a[236:239], v[52:55], v[32:35]
    ds_read_b128 v[48:51], v3 offset:22528
    s_add_u32 s32, s32, 1
    v_mfma_f32_16x16x32_bf16 v[28:31], a[232:235], v[52:55], v[28:31]
    s_add_u32 s33, s33, 36864
    s_add_u32 s34, s34, 36864
    s_waitcnt lgkmcnt(3)
    v_mfma_f32_16x16x32_bf16 v[24:27], a[228:231], v[52:55], v[24:27]
    s_waitcnt lgkmcnt(2)
    s_cmp_ge_u32 s34, 147456
    s_cselect_b32 s38, 147456, 0
    v_mfma_f32_16x16x32_bf16 v[24:27], a[240:243], v[40:43], v[24:27]
    ds_read_b128 v[52:55], v3 offset:23552
    s_sub_u32 s34, s34, s38
    v_mfma_f32_16x16x32_bf16 v[28:31], a[244:247], v[40:43], v[28:31]
    buffer_load_dword v5, v4, s[4:7], s16 offen sc1
    v_mfma_f32_16x16x32_bf16 v[32:35], a[248:251], v[40:43], v[32:35]
    s_waitcnt lgkmcnt(2)
    v_add_f32 v100, v100, v108
    v_add_f32 v101, v101, v109
    v_mfma_f32_16x16x32_bf16 v[32:35], v[132:135], v[44:47], v[32:35]
    ds_read_b128 v[40:43], v3 offset:24576
    v_add_f32 v102, v102, v110
    v_mfma_f32_16x16x32_bf16 v[28:31], v[128:131], v[44:47], v[28:31]
    v_add_f32 v103, v103, v111
    v_add_f32 v104, v104, v112
    v_mfma_f32_16x16x32_bf16 v[24:27], a[252:255], v[44:47], v[24:27]
    s_waitcnt lgkmcnt(2)
    v_add_f32 v105, v105, v113
    v_add_f32 v106, v106, v114
    v_mfma_f32_16x16x32_bf16 v[24:27], v[136:139], v[48:51], v[24:27]
    ds_read_b128 v[44:47], v3 offset:25600
    v_add_f32 v107, v107, v115
    v_mfma_f32_16x16x32_bf16 v[28:31], v[140:143], v[48:51], v[28:31]
    v_add_f32 v100, v100, v104
    v_add_f32 v101, v101, v105
    v_mfma_f32_16x16x32_bf16 v[32:35], v[144:147], v[48:51], v[32:35]
    s_waitcnt lgkmcnt(2)
    v_add_f32 v102, v102, v106
    v_add_f32 v103, v103, v107
    v_mfma_f32_16x16x32_bf16 v[32:35], v[156:159], v[52:55], v[32:35]
    ds_read_b128 v[48:51], v3 offset:26624
    v_add_f32 v100, v100, v102
    v_mfma_f32_16x16x32_bf16 v[28:31], v[152:155], v[52:55], v[28:31]
    v_add_f32 v101, v101, v103
    v_mfma_f32_16x16x32_bf16 v[24:27], v[148:151], v[52:55], v[24:27]
    s_waitcnt lgkmcnt(2)
    v_permlane16_swap_b32 v100, v101
    v_mfma_f32_16x16x32_bf16 v[24:27], v[160:163], v[40:43], v[24:27]
    ds_read_b128 v[52:55], v3 offset:27648
    v_add_f32 v100, v100, v101
    v_mfma_f32_16x16x32_bf16 v[28:31], v[164:167], v[40:43], v[28:31]
    v_mov_b32 v101, v100
    v_mfma_f32_16x16x32_bf16 v[32:35], v[168:171], v[40:43], v[32:35]
    s_waitcnt lgkmcnt(2)
    v_permlane32_swap_b32 v100, v101
    v_mfma_f32_16x16x32_bf16 v[32:35], v[180:183], v[44:47], v[32:35]
    ds_read_b128 v[40:43], v3 offset:28672
    v_add_f32 v100, v100, v101
    v_mfma_f32_16x16x32_bf16 v[28:31], v[176:179], v[44:47], v[28:31]
    v_mul_f32 v100, 0x3a800000, v100
    v_mov_b32 v101, v100
    v_mfma_f32_16x16x32_bf16 v[24:27], v[172:175], v[44:47], v[24:27]
    s_waitcnt lgkmcnt(2)
    v_permlane16_swap_b32 v100, v101
    v_mfma_f32_16x16x32_bf16 v[24:27], v[184:187], v[48:51], v[24:27]
    ds_read_b128 v[44:47], v3 offset:29696
    v_fma_f32 v101, -v100, v100, v101
    v_mfma_f32_16x16x32_bf16 v[28:31], v[188:191], v[48:51], v[28:31]
    s_waitcnt vmcnt(7)
    s_barrier
    v_mfma_f32_16x16x32_bf16 v[32:35], v[192:195], v[48:51], v[32:35]
    s_waitcnt lgkmcnt(2)
    v_max_f32 v101, 0, v101
    v_add_f32 v101, 0x3727c5ac, v101
    v_mfma_f32_16x16x32_bf16 v[32:35], v[204:207], v[52:55], v[32:35]
    ds_read_b128 v[48:51], v3 offset:30720
    v_mfma_f32_16x16x32_bf16 v[28:31], v[200:203], v[52:55], v[28:31]
    v_rsq_f32 v21, v101
    v_mfma_f32_16x16x32_bf16 v[24:27], v[196:199], v[52:55], v[24:27]
    s_waitcnt lgkmcnt(2)
    v_mul_f32 v100, v100, v21
    v_fma_f32 v80, -v100, v56, v68
    v_mfma_f32_16x16x32_bf16 v[24:27], v[208:211], v[40:43], v[24:27]
    ds_read_b128 v[52:55], v3 offset:31744
    v_fma_f32 v81, -v100, v57, v69
    v_mfma_f32_16x16x32_bf16 v[28:31], v[212:215], v[40:43], v[28:31]
    s_waitcnt vmcnt(4)
    buffer_store_dword v6, v22, s[12:15], s17 offen sc1
    v_mfma_f32_16x16x32_bf16 v[32:35], v[216:219], v[40:43], v[32:35]
    s_waitcnt lgkmcnt(2)
    v_fma_f32 v82, -v100, v58, v70
    v_fma_f32 v83, -v100, v59, v71
    v_mfma_f32_16x16x32_bf16 v[32:35], v[228:231], v[44:47], v[32:35]
    ds_read_b128 v[40:43], v2 offset:0
    v_fma_f32 v84, -v100, v60, v72
    v_mfma_f32_16x16x32_bf16 v[28:31], v[224:227], v[44:47], v[28:31]
    s_mov_b32 s14, s6
    v_fma_f32 v85, -v100, v61, v73
    v_fma_f32 v86, -v100, v62, v74
    v_mfma_f32_16x16x32_bf16 v[24:27], v[220:223], v[44:47], v[24:27]
    s_waitcnt lgkmcnt(2)
    v_fma_f32 v87, -v100, v63, v75
    v_fma_f32 v88, -v100, v64, v76
    v_mfma_f32_16x16x32_bf16 v[24:27], v[232:235], v[48:51], v[24:27]
    ds_read_b128 v[44:47], v2 offset:1024
    v_fma_f32 v89, -v100, v65, v77
    v_mfma_f32_16x16x32_bf16 v[28:31], v[236:239], v[48:51], v[28:31]
    s_add_u32 s17, s17, 8192
    v_fma_f32 v90, -v100, v66, v78
    v_fma_f32 v91, -v100, v67, v79
    v_mfma_f32_16x16x32_bf16 v[32:35], v[240:243], v[48:51], v[32:35]
    s_waitcnt lgkmcnt(2)
    v_mfma_f32_16x16x32_bf16 v[32:35], v[252:255], v[52:55], v[32:35]
    ds_read_b128 v[48:51], v2 offset:2048
    v_mfma_f32_16x16x32_bf16 v[28:31], v[248:251], v[52:55], v[28:31]
    v_mfma_f32_16x16x32_bf16 v[24:27], v[244:247], v[52:55], v[24:27]
    s_cmp_lt_i32 s31, 63
    s_cbranch_scc1 Lffa_body03
    s_branch L_exit
    .p2align 6
Lffa_body02:
    s_waitcnt lgkmcnt(2)
    v_mfma_f32_16x16x32_bf16 v[8:11], a[0:3], v[40:43], 0
    ds_read_b128 v[52:55], v2 offset:3072
    s_add_u32 m0, s34, 0
    v_mfma_f32_16x16x32_bf16 v[12:15], a[4:7], v[40:43], 0
    s_add_u32 s31, s31, 1
    v_mov_b32 v6, s31
    v_fma_f32 v124, v32, v21, v88
    v_mfma_f32_16x16x32_bf16 v[16:19], a[8:11], v[40:43], 0
    s_waitcnt lgkmcnt(2)
    v_fma_f32 v125, v33, v21, v89
    v_fma_f32 v126, v34, v21, v90
    v_mfma_f32_16x16x32_bf16 v[16:19], a[20:23], v[44:47], v[16:19]
    ds_read_b128 v[40:43], v2 offset:4096
    v_fma_f32 v127, v35, v21, v91
    v_mfma_f32_16x16x32_bf16 v[12:15], a[16:19], v[44:47], v[12:15]
    s_add_u32 s35, s35, 36864
    v_mul_f32 v124, v124, |v124|
    v_mul_f32 v125, v125, |v125|
    v_mfma_f32_16x16x32_bf16 v[8:11], a[12:15], v[44:47], v[8:11]
    s_waitcnt lgkmcnt(2)
    v_mul_f32 v126, v126, |v126|
    v_mul_f32 v127, v127, |v127|
    v_mfma_f32_16x16x32_bf16 v[8:11], a[24:27], v[48:51], v[8:11]
    ds_read_b128 v[44:47], v2 offset:5120
    v_cvt_pk_bf16_f32 v124, v124, v125
    v_mfma_f32_16x16x32_bf16 v[12:15], a[28:31], v[48:51], v[12:15]
    s_cmp_eq_u32 s35, 147456
    s_cselect_b32 s35, 0, s35
    v_cvt_pk_bf16_f32 v126, v126, v127
    v_mfma_f32_16x16x32_bf16 v[16:19], a[32:35], v[48:51], v[16:19]
    s_waitcnt vmcnt(1) lgkmcnt(2)
    v_cmp_gt_i32 vcc, s32, v5
    v_pk_max_i16 v96, v124, 0
    v_mfma_f32_16x16x32_bf16 v[16:19], a[44:47], v[52:55], v[16:19]
    ds_read_b128 v[48:51], v2 offset:6144
    v_pk_max_i16 v97, v126, 0
    v_mfma_f32_16x16x32_bf16 v[12:15], a[40:43], v[52:55], v[12:15]
    s_and_b64 vcc, vcc, s[18:19]
    s_cbranch_scc1 Lffa_v01
    v_mfma_f32_16x16x32_bf16 v[8:11], a[36:39], v[52:55], v[8:11]
    s_waitcnt lgkmcnt(2)
    buffer_load_dwordx4 v1, s[8:11], s33 offen offset:0 sc1 lds
    v_mfma_f32_16x16x32_bf16 v[8:11], a[48:51], v[40:43], v[8:11]
    ds_read_b128 v[52:55], v2 offset:7168
    v_pk_max_i16 v98, v124, 0
    v_mfma_f32_16x16x32_bf16 v[12:15], a[52:55], v[40:43], v[12:15]
    v_pk_max_i16 v99, v126, 0
    v_fma_f32 v116, v24, v21, v80
    v_mfma_f32_16x16x32_bf16 v[16:19], a[56:59], v[40:43], v[16:19]
    s_waitcnt lgkmcnt(2)
    v_permlane32_swap_b32 v96, v98
    v_mfma_f32_16x16x32_bf16 v[16:19], a[68:71], v[44:47], v[16:19]
    ds_read_b128 v[40:43], v2 offset:8192
    v_fma_f32 v117, v25, v21, v81
    v_mfma_f32_16x16x32_bf16 v[12:15], a[64:67], v[44:47], v[12:15]
    buffer_load_dwordx4 v1, s[8:11], s33 offen offset:1024 sc1 lds
    v_mfma_f32_16x16x32_bf16 v[8:11], a[60:63], v[44:47], v[8:11]
    s_waitcnt lgkmcnt(2)
    v_permlane32_swap_b32 v97, v99
    v_mfma_f32_16x16x32_bf16 v[8:11], a[72:75], v[48:51], v[8:11]
    ds_read_b128 v[44:47], v2 offset:9216
    v_fma_f32 v118, v26, v21, v82
    v_mfma_f32_16x16x32_bf16 v[12:15], a[76:79], v[48:51], v[12:15]
    v_fma_f32 v119, v27, v21, v83
    v_fma_f32 v120, v28, v21, v84
    v_mfma_f32_16x16x32_bf16 v[16:19], a[80:83], v[48:51], v[16:19]
    s_waitcnt lgkmcnt(2)
    buffer_store_dwordx4 v[96:99], v7, s[12:15], s36 offen sc1
    v_fma_f32 v121, v29, v21, v85
    v_mfma_f32_16x16x32_bf16 v[16:19], a[92:95], v[52:55], v[16:19]
    ds_read_b128 v[48:51], v2 offset:10240
    v_fma_f32 v122, v30, v21, v86
    v_mfma_f32_16x16x32_bf16 v[12:15], a[88:91], v[52:55], v[12:15]
    v_fma_f32 v123, v31, v21, v87
    v_mul_f32 v116, v116, |v116|
    v_mfma_f32_16x16x32_bf16 v[8:11], a[84:87], v[52:55], v[8:11]
    s_waitcnt lgkmcnt(2)
    v_mul_f32 v117, v117, |v117|
    v_mul_f32 v118, v118, |v118|
    v_mfma_f32_16x16x32_bf16 v[8:11], a[96:99], v[40:43], v[8:11]
    ds_read_b128 v[52:55], v2 offset:11264
    v_mul_f32 v119, v119, |v119|
    v_mfma_f32_16x16x32_bf16 v[12:15], a[100:103], v[40:43], v[12:15]
    buffer_load_dwordx4 v1, s[8:11], s33 offen offset:2048 sc1 lds
    v_mfma_f32_16x16x32_bf16 v[16:19], a[104:107], v[40:43], v[16:19]
    s_waitcnt lgkmcnt(2)
    v_mul_f32 v120, v120, |v120|
    v_mul_f32 v121, v121, |v121|
    v_mfma_f32_16x16x32_bf16 v[16:19], a[116:119], v[44:47], v[16:19]
    ds_read_b128 v[40:43], v2 offset:12288
    v_mul_f32 v122, v122, |v122|
    v_mfma_f32_16x16x32_bf16 v[12:15], a[112:115], v[44:47], v[12:15]
    v_mul_f32 v123, v123, |v123|
    v_cvt_pk_bf16_f32 v116, v116, v117
    v_mfma_f32_16x16x32_bf16 v[8:11], a[108:111], v[44:47], v[8:11]
    s_waitcnt lgkmcnt(2)
    buffer_load_dwordx4 v1, s[8:11], s33 offen offset:3072 sc1 lds
    v_mfma_f32_16x16x32_bf16 v[8:11], a[120:123], v[48:51], v[8:11]
    ds_read_b128 v[44:47], v2 offset:13312
    s_add_u32 s16, s16, 8192
    v_mfma_f32_16x16x32_bf16 v[12:15], a[124:127], v[48:51], v[12:15]
    s_add_u32 m0, s34, s3
    s_add_u32 s37, s33, s3
    v_cvt_pk_bf16_f32 v118, v118, v119
    v_mfma_f32_16x16x32_bf16 v[16:19], a[128:131], v[48:51], v[16:19]
    s_waitcnt vmcnt(5) lgkmcnt(2)
    s_barrier
    v_mfma_f32_16x16x32_bf16 v[16:19], a[140:143], v[52:55], v[16:19]
    ds_read_b128 v[48:51], v2 offset:14336
    v_cvt_pk_bf16_f32 v120, v120, v121
    v_mfma_f32_16x16x32_bf16 v[12:15], a[136:139], v[52:55], v[12:15]
    buffer_load_dwordx4 v1, s[8:11], s37 offen offset:0 sc1 lds
    v_mfma_f32_16x16x32_bf16 v[8:11], a[132:135], v[52:55], v[8:11]
    s_waitcnt lgkmcnt(2)
    v_cvt_pk_bf16_f32 v122, v122, v123
    v_pk_max_i16 v92, v116, 0
    v_mfma_f32_16x16x32_bf16 v[8:11], a[144:147], v[40:43], v[8:11]
    ds_read_b128 v[52:55], v2 offset:15360
    v_pk_max_i16 v93, v118, 0
    v_mfma_f32_16x16x32_bf16 v[12:15], a[148:151], v[40:43], v[12:15]
    v_pk_max_i16 v94, v120, 0
    v_pk_max_i16 v95, v122, 0
    v_mfma_f32_16x16x32_bf16 v[16:19], a[152:155], v[40:43], v[16:19]
    s_waitcnt lgkmcnt(2)
    buffer_store_dwordx4 v[92:95], v1, s[12:15], s36 offen sc1
    v_add_u32 v3, s35, v1
    v_mfma_f32_16x16x32_bf16 v[16:19], a[164:167], v[44:47], v[16:19]
    ds_read_b128 v[40:43], v2 offset:16384
    v_sub_u32 v100, v2, v20
    v_mfma_f32_16x16x32_bf16 v[12:15], a[160:163], v[44:47], v[12:15]
    s_add_u32 s36, s36, 116736
    ds_read2st64_b64 v[112:115], v100 offset0:70 offset1:71
    v_mfma_f32_16x16x32_bf16 v[8:11], a[156:159], v[44:47], v[8:11]
    s_waitcnt lgkmcnt(3)
    ds_read2st64_b64 v[108:111], v100 offset0:68 offset1:69
    v_mfma_f32_16x16x32_bf16 v[8:11], a[168:171], v[48:51], v[8:11]
    ds_read_b128 v[44:47], v2 offset:17408
    v_mfma_f32_16x16x32_bf16 v[12:15], a[172:175], v[48:51], v[12:15]
    buffer_load_dwordx4 v1, s[8:11], s37 offen offset:1024 sc1 lds
    v_mfma_f32_16x16x32_bf16 v[16:19], a[176:179], v[48:51], v[16:19]
    s_waitcnt lgkmcnt(4)
    ds_read2st64_b64 v[104:107], v100 offset0:66 offset1:67
    v_mfma_f32_16x16x32_bf16 v[16:19], a[188:191], v[52:55], v[16:19]
    ds_read_b128 v[48:51], v2 offset:18432
    v_mfma_f32_16x16x32_bf16 v[12:15], a[184:187], v[52:55], v[12:15]
    ds_read2st64_b64 v[100:103], v100 offset0:64 offset1:65
    v_mfma_f32_16x16x32_bf16 v[8:11], a[180:183], v[52:55], v[8:11]
    s_waitcnt lgkmcnt(6)
    buffer_load_dwordx4 v1, s[8:11], s37 offen offset:2048 sc1 lds
    v_mfma_f32_16x16x32_bf16 v[8:11], a[192:195], v[40:43], v[8:11]
    ds_read_b128 v[52:55], v2 offset:19456
    v_mfma_f32_16x16x32_bf16 v[12:15], a[196:199], v[40:43], v[12:15]
    v_mfma_f32_16x16x32_bf16 v[16:19], a[200:203], v[40:43], v[16:19]
    s_waitcnt lgkmcnt(4)
    v_mfma_f32_16x16x32_bf16 v[16:19], a[212:215], v[44:47], v[16:19]
    ds_read_b128 v[40:43], v2 offset:20480
    v_mfma_f32_16x16x32_bf16 v[12:15], a[208:211], v[44:47], v[12:15]
    buffer_load_dwordx4 v1, s[8:11], s37 offen offset:3072 sc1 lds
    v_mfma_f32_16x16x32_bf16 v[8:11], a[204:207], v[44:47], v[8:11]
    s_waitcnt lgkmcnt(3)
    s_add_u32 m0, s34, s41
    s_add_u32 s37, s33, s41
    v_mfma_f32_16x16x32_bf16 v[8:11], a[216:219], v[48:51], v[8:11]
    ds_read_b128 v[44:47], v2 offset:21504
    s_waitcnt lgkmcnt(3)
    v_mfma_f32_16x16x32_bf16 v[12:15], a[220:223], v[48:51], v[12:15]
    v_add_f32 v100, v100, v108
    v_add_f32 v101, v101, v109
    v_mfma_f32_16x16x32_bf16 v[16:19], a[224:227], v[48:51], v[16:19]
    s_waitcnt lgkmcnt(2)
    buffer_load_dwordx4 v1, s[8:11], s37 offen offset:0 sc1 lds
    v_mfma_f32_16x16x32_bf16 v[16:19], a[236:239], v[52:55], v[16:19]
    ds_read_b128 v[48:51], v2 offset:22528
    s_add_u32 s32, s32, 1
    v_mfma_f32_16x16x32_bf16 v[12:15], a[232:235], v[52:55], v[12:15]
    s_add_u32 s33, s33, 36864
    s_add_u32 s34, s34, 36864
    v_add_f32 v102, v102, v110
    v_mfma_f32_16x16x32_bf16 v[8:11], a[228:231], v[52:55], v[8:11]
    s_waitcnt lgkmcnt(2)
    s_cmp_ge_u32 s34, 147456
    s_cselect_b32 s38, 147456, 0
    v_mfma_f32_16x16x32_bf16 v[8:11], a[240:243], v[40:43], v[8:11]
    ds_read_b128 v[52:55], v2 offset:23552
    s_sub_u32 s34, s34, s38
    v_mfma_f32_16x16x32_bf16 v[12:15], a[244:247], v[40:43], v[12:15]
    buffer_load_dword v5, v4, s[4:7], s16 offen sc1
    v_mfma_f32_16x16x32_bf16 v[16:19], a[248:251], v[40:43], v[16:19]
    s_waitcnt lgkmcnt(2)
    v_add_f32 v103, v103, v111
    v_add_f32 v104, v104, v112
    v_mfma_f32_16x16x32_bf16 v[16:19], v[132:135], v[44:47], v[16:19]
    ds_read_b128 v[40:43], v2 offset:24576
    v_add_f32 v105, v105, v113
    v_mfma_f32_16x16x32_bf16 v[12:15], v[128:131], v[44:47], v[12:15]
    v_add_f32 v106, v106, v114
    v_add_f32 v107, v107, v115
    v_mfma_f32_16x16x32_bf16 v[8:11], a[252:255], v[44:47], v[8:11]
    s_waitcnt lgkmcnt(2)
    v_add_f32 v100, v100, v104
    v_add_f32 v101, v101, v105
    v_mfma_f32_16x16x32_bf16 v[8:11], v[136:139], v[48:51], v[8:11]
    ds_read_b128 v[44:47], v2 offset:25600
    v_add_f32 v102, v102, v106
    v_mfma_f32_16x16x32_bf16 v[12:15], v[140:143], v[48:51], v[12:15]
    v_add_f32 v103, v103, v107
    v_add_f32 v100, v100, v102
    v_mfma_f32_16x16x32_bf16 v[16:19], v[144:147], v[48:51], v[16:19]
    s_waitcnt lgkmcnt(2)
    v_add_f32 v101, v101, v103
    v_mfma_f32_16x16x32_bf16 v[16:19], v[156:159], v[52:55], v[16:19]
    ds_read_b128 v[48:51], v2 offset:26624
    v_mfma_f32_16x16x32_bf16 v[12:15], v[152:155], v[52:55], v[12:15]
    v_permlane16_swap_b32 v100, v101
    v_mfma_f32_16x16x32_bf16 v[8:11], v[148:151], v[52:55], v[8:11]
    s_waitcnt lgkmcnt(2)
    v_add_f32 v100, v100, v101
    v_mov_b32 v101, v100
    v_mfma_f32_16x16x32_bf16 v[8:11], v[160:163], v[40:43], v[8:11]
    ds_read_b128 v[52:55], v2 offset:27648
    v_mfma_f32_16x16x32_bf16 v[12:15], v[164:167], v[40:43], v[12:15]
    v_permlane32_swap_b32 v100, v101
    v_mfma_f32_16x16x32_bf16 v[16:19], v[168:171], v[40:43], v[16:19]
    s_waitcnt lgkmcnt(2)
    v_add_f32 v100, v100, v101
    v_mul_f32 v100, 0x3a800000, v100
    v_mfma_f32_16x16x32_bf16 v[16:19], v[180:183], v[44:47], v[16:19]
    ds_read_b128 v[40:43], v2 offset:28672
    v_mov_b32 v101, v100
    v_mfma_f32_16x16x32_bf16 v[12:15], v[176:179], v[44:47], v[12:15]
    v_mfma_f32_16x16x32_bf16 v[8:11], v[172:175], v[44:47], v[8:11]
    s_waitcnt lgkmcnt(2)
    v_permlane16_swap_b32 v100, v101
    v_mfma_f32_16x16x32_bf16 v[8:11], v[184:187], v[48:51], v[8:11]
    ds_read_b128 v[44:47], v2 offset:29696
    v_fma_f32 v101, -v100, v100, v101
    v_mfma_f32_16x16x32_bf16 v[12:15], v[188:191], v[48:51], v[12:15]
    v_max_f32 v101, 0, v101
    v_add_f32 v101, 0x3727c5ac, v101
    v_mfma_f32_16x16x32_bf16 v[16:19], v[192:195], v[48:51], v[16:19]
    s_waitcnt vmcnt(7) lgkmcnt(2)
    s_barrier
    v_mfma_f32_16x16x32_bf16 v[16:19], v[204:207], v[52:55], v[16:19]
    ds_read_b128 v[48:51], v2 offset:30720
    s_waitcnt vmcnt(5)
    v_mfma_f32_16x16x32_bf16 v[12:15], v[200:203], v[52:55], v[12:15]
    buffer_store_dword v6, v22, s[12:15], s17 offen sc1
    s_mov_b32 s14, s6
    v_mfma_f32_16x16x32_bf16 v[8:11], v[196:199], v[52:55], v[8:11]
    s_waitcnt lgkmcnt(2)
    v_rsq_f32 v21, v101
    v_mfma_f32_16x16x32_bf16 v[8:11], v[208:211], v[40:43], v[8:11]
    ds_read_b128 v[52:55], v2 offset:31744
    v_mul_f32 v100, v100, v21
    v_mfma_f32_16x16x32_bf16 v[12:15], v[212:215], v[40:43], v[12:15]
    s_add_u32 s17, s17, 8192
    v_fma_f32 v80, -v100, v56, v68
    v_fma_f32 v81, -v100, v57, v69
    v_mfma_f32_16x16x32_bf16 v[16:19], v[216:219], v[40:43], v[16:19]
    s_waitcnt lgkmcnt(2)
    v_fma_f32 v82, -v100, v58, v70
    v_fma_f32 v83, -v100, v59, v71
    v_mfma_f32_16x16x32_bf16 v[16:19], v[228:231], v[44:47], v[16:19]
    ds_read_b128 v[40:43], v3 offset:0
    v_fma_f32 v84, -v100, v60, v72
    v_mfma_f32_16x16x32_bf16 v[12:15], v[224:227], v[44:47], v[12:15]
    v_fma_f32 v85, -v100, v61, v73
    v_fma_f32 v86, -v100, v62, v74
    v_mfma_f32_16x16x32_bf16 v[8:11], v[220:223], v[44:47], v[8:11]
    s_waitcnt lgkmcnt(2)
    v_fma_f32 v87, -v100, v63, v75
    v_fma_f32 v88, -v100, v64, v76
    v_mfma_f32_16x16x32_bf16 v[8:11], v[232:235], v[48:51], v[8:11]
    ds_read_b128 v[44:47], v3 offset:1024
    v_fma_f32 v89, -v100, v65, v77
    v_mfma_f32_16x16x32_bf16 v[12:15], v[236:239], v[48:51], v[12:15]
    v_fma_f32 v90, -v100, v66, v78
    v_fma_f32 v91, -v100, v67, v79
    v_mfma_f32_16x16x32_bf16 v[16:19], v[240:243], v[48:51], v[16:19]
    s_waitcnt lgkmcnt(2)
    v_mfma_f32_16x16x32_bf16 v[16:19], v[252:255], v[52:55], v[16:19]
    ds_read_b128 v[48:51], v3 offset:2048
    v_mfma_f32_16x16x32_bf16 v[12:15], v[248:251], v[52:55], v[12:15]
    v_mfma_f32_16x16x32_bf16 v[8:11], v[244:247], v[52:55], v[8:11]
Lffa_body12:
    s_waitcnt lgkmcnt(2)
    v_mfma_f32_16x16x32_bf16 v[24:27], a[0:3], v[40:43], 0
    ds_read_b128 v[52:55], v3 offset:3072
    s_add_u32 m0, s34, 0
    v_mfma_f32_16x16x32_bf16 v[28:31], a[4:7], v[40:43], 0
    s_add_u32 s31, s31, 1
    v_mov_b32 v6, s31
    v_fma_f32 v124, v16, v21, v88
    v_mfma_f32_16x16x32_bf16 v[32:35], a[8:11], v[40:43], 0
    s_waitcnt lgkmcnt(2)
    v_fma_f32 v125, v17, v21, v89
    v_fma_f32 v126, v18, v21, v90
    v_mfma_f32_16x16x32_bf16 v[32:35], a[20:23], v[44:47], v[32:35]
    ds_read_b128 v[40:43], v3 offset:4096
    v_fma_f32 v127, v19, v21, v91
    v_mfma_f32_16x16x32_bf16 v[28:31], a[16:19], v[44:47], v[28:31]
    s_add_u32 s35, s35, 36864
    v_mul_f32 v124, v124, |v124|
    v_mul_f32 v125, v125, |v125|
    v_mfma_f32_16x16x32_bf16 v[24:27], a[12:15], v[44:47], v[24:27]
    s_waitcnt lgkmcnt(2)
    v_mul_f32 v126, v126, |v126|
    v_mul_f32 v127, v127, |v127|
    v_mfma_f32_16x16x32_bf16 v[24:27], a[24:27], v[48:51], v[24:27]
    ds_read_b128 v[44:47], v3 offset:5120
    v_cvt_pk_bf16_f32 v124, v124, v125
    v_mfma_f32_16x16x32_bf16 v[28:31], a[28:31], v[48:51], v[28:31]
    s_cmp_eq_u32 s35, 147456
    s_cselect_b32 s35, 0, s35
    v_cvt_pk_bf16_f32 v126, v126, v127
    v_mfma_f32_16x16x32_bf16 v[32:35], a[32:35], v[48:51], v[32:35]
    s_waitcnt vmcnt(1) lgkmcnt(2)
    v_cmp_gt_i32 vcc, s32, v5
    v_pk_max_i16 v96, v124, 0
    v_mfma_f32_16x16x32_bf16 v[32:35], a[44:47], v[52:55], v[32:35]
    ds_read_b128 v[48:51], v3 offset:6144
    v_pk_max_i16 v97, v126, 0
    v_mfma_f32_16x16x32_bf16 v[28:31], a[40:43], v[52:55], v[28:31]
    s_and_b64 vcc, vcc, s[18:19]
    s_cbranch_scc1 Lffa_v11
    v_mfma_f32_16x16x32_bf16 v[24:27], a[36:39], v[52:55], v[24:27]
    s_waitcnt lgkmcnt(2)
    buffer_load_dwordx4 v1, s[8:11], s33 offen offset:0 sc1 lds
    v_mfma_f32_16x16x32_bf16 v[24:27], a[48:51], v[40:43], v[24:27]
    ds_read_b128 v[52:55], v3 offset:7168
    v_pk_max_i16 v98, v124, 0
    v_mfma_f32_16x16x32_bf16 v[28:31], a[52:55], v[40:43], v[28:31]
    v_pk_max_i16 v99, v126, 0
    v_fma_f32 v116, v8, v21, v80
    v_mfma_f32_16x16x32_bf16 v[32:35], a[56:59], v[40:43], v[32:35]
    s_waitcnt lgkmcnt(2)
    v_permlane32_swap_b32 v96, v98
    v_mfma_f32_16x16x32_bf16 v[32:35], a[68:71], v[44:47], v[32:35]
    ds_read_b128 v[40:43], v3 offset:8192
    v_fma_f32 v117, v9, v21, v81
    v_mfma_f32_16x16x32_bf16 v[28:31], a[64:67], v[44:47], v[28:31]
    buffer_load_dwordx4 v1, s[8:11], s33 offen offset:1024 sc1 lds
    v_mfma_f32_16x16x32_bf16 v[24:27], a[60:63], v[44:47], v[24:27]
    s_waitcnt lgkmcnt(2)
    v_permlane32_swap_b32 v97, v99
    v_mfma_f32_16x16x32_bf16 v[24:27], a[72:75], v[48:51], v[24:27]
    ds_read_b128 v[44:47], v3 offset:9216
    v_fma_f32 v118, v10, v21, v82
    v_mfma_f32_16x16x32_bf16 v[28:31], a[76:79], v[48:51], v[28:31]
    v_fma_f32 v119, v11, v21, v83
    v_fma_f32 v120, v12, v21, v84
    v_mfma_f32_16x16x32_bf16 v[32:35], a[80:83], v[48:51], v[32:35]
    s_waitcnt lgkmcnt(2)
    buffer_store_dwordx4 v[96:99], v7, s[12:15], s36 offen sc1
    v_fma_f32 v121, v13, v21, v85
    v_mfma_f32_16x16x32_bf16 v[32:35], a[92:95], v[52:55], v[32:35]
    ds_read_b128 v[48:51], v3 offset:10240
    v_fma_f32 v122, v14, v21, v86
    v_mfma_f32_16x16x32_bf16 v[28:31], a[88:91], v[52:55], v[28:31]
    v_fma_f32 v123, v15, v21, v87
    v_mul_f32 v116, v116, |v116|
    v_mfma_f32_16x16x32_bf16 v[24:27], a[84:87], v[52:55], v[24:27]
    s_waitcnt lgkmcnt(2)
    v_mul_f32 v117, v117, |v117|
    v_mul_f32 v118, v118, |v118|
    v_mfma_f32_16x16x32_bf16 v[24:27], a[96:99], v[40:43], v[24:27]
    ds_read_b128 v[52:55], v3 offset:11264
    v_mul_f32 v119, v119, |v119|
    v_mfma_f32_16x16x32_bf16 v[28:31], a[100:103], v[40:43], v[28:31]
    buffer_load_dwordx4 v1, s[8:11], s33 offen offset:2048 sc1 lds
    v_mfma_f32_16x16x32_bf16 v[32:35], a[104:107], v[40:43], v[32:35]
    s_waitcnt lgkmcnt(2)
    v_mul_f32 v120, v120, |v120|
    v_mul_f32 v121, v121, |v121|
    v_mfma_f32_16x16x32_bf16 v[32:35], a[116:119], v[44:47], v[32:35]
    ds_read_b128 v[40:43], v3 offset:12288
    v_mul_f32 v122, v122, |v122|
    v_mfma_f32_16x16x32_bf16 v[28:31], a[112:115], v[44:47], v[28:31]
    v_mul_f32 v123, v123, |v123|
    v_cvt_pk_bf16_f32 v116, v116, v117
    v_mfma_f32_16x16x32_bf16 v[24:27], a[108:111], v[44:47], v[24:27]
    s_waitcnt lgkmcnt(2)
    buffer_load_dwordx4 v1, s[8:11], s33 offen offset:3072 sc1 lds
    v_mfma_f32_16x16x32_bf16 v[24:27], a[120:123], v[48:51], v[24:27]
    ds_read_b128 v[44:47], v3 offset:13312
    s_add_u32 s16, s16, 8192
    v_mfma_f32_16x16x32_bf16 v[28:31], a[124:127], v[48:51], v[28:31]
    s_add_u32 m0, s34, s3
    s_add_u32 s37, s33, s3
    v_cvt_pk_bf16_f32 v118, v118, v119
    v_mfma_f32_16x16x32_bf16 v[32:35], a[128:131], v[48:51], v[32:35]
    s_waitcnt vmcnt(5) lgkmcnt(2)
    s_barrier
    v_mfma_f32_16x16x32_bf16 v[32:35], a[140:143], v[52:55], v[32:35]
    ds_read_b128 v[48:51], v3 offset:14336
    v_cvt_pk_bf16_f32 v120, v120, v121
    v_mfma_f32_16x16x32_bf16 v[28:31], a[136:139], v[52:55], v[28:31]
    buffer_load_dwordx4 v1, s[8:11], s37 offen offset:0 sc1 lds
    v_mfma_f32_16x16x32_bf16 v[24:27], a[132:135], v[52:55], v[24:27]
    s_waitcnt lgkmcnt(2)
    v_cvt_pk_bf16_f32 v122, v122, v123
    v_pk_max_i16 v92, v116, 0
    v_mfma_f32_16x16x32_bf16 v[24:27], a[144:147], v[40:43], v[24:27]
    ds_read_b128 v[52:55], v3 offset:15360
    v_pk_max_i16 v93, v118, 0
    v_mfma_f32_16x16x32_bf16 v[28:31], a[148:151], v[40:43], v[28:31]
    v_pk_max_i16 v94, v120, 0
    v_pk_max_i16 v95, v122, 0
    v_mfma_f32_16x16x32_bf16 v[32:35], a[152:155], v[40:43], v[32:35]
    s_waitcnt lgkmcnt(2)
    buffer_store_dwordx4 v[92:95], v1, s[12:15], s36 offen sc1
    v_add_u32 v2, s35, v1
    v_mfma_f32_16x16x32_bf16 v[32:35], a[164:167], v[44:47], v[32:35]
    ds_read_b128 v[40:43], v3 offset:16384
    v_sub_u32 v100, v3, v20
    v_mfma_f32_16x16x32_bf16 v[28:31], a[160:163], v[44:47], v[28:31]
    s_add_u32 s36, s36, 116736
    ds_read2st64_b64 v[112:115], v100 offset0:70 offset1:71
    v_mfma_f32_16x16x32_bf16 v[24:27], a[156:159], v[44:47], v[24:27]
    s_waitcnt lgkmcnt(3)
    ds_read2st64_b64 v[108:111], v100 offset0:68 offset1:69
    v_mfma_f32_16x16x32_bf16 v[24:27], a[168:171], v[48:51], v[24:27]
    ds_read_b128 v[44:47], v3 offset:17408
    v_mfma_f32_16x16x32_bf16 v[28:31], a[172:175], v[48:51], v[28:31]
    buffer_load_dwordx4 v1, s[8:11], s37 offen offset:1024 sc1 lds
    v_mfma_f32_16x16x32_bf16 v[32:35], a[176:179], v[48:51], v[32:35]
    s_waitcnt lgkmcnt(4)
    ds_read2st64_b64 v[104:107], v100 offset0:66 offset1:67
    v_mfma_f32_16x16x32_bf16 v[32:35], a[188:191], v[52:55], v[32:35]
    ds_read_b128 v[48:51], v3 offset:18432
    v_mfma_f32_16x16x32_bf16 v[28:31], a[184:187], v[52:55], v[28:31]
    ds_read2st64_b64 v[100:103], v100 offset0:64 offset1:65
    v_mfma_f32_16x16x32_bf16 v[24:27], a[180:183], v[52:55], v[24:27]
    s_waitcnt lgkmcnt(6)
    buffer_load_dwordx4 v1, s[8:11], s37 offen offset:2048 sc1 lds
    v_mfma_f32_16x16x32_bf16 v[24:27], a[192:195], v[40:43], v[24:27]
    ds_read_b128 v[52:55], v3 offset:19456
    v_mfma_f32_16x16x32_bf16 v[28:31], a[196:199], v[40:43], v[28:31]
    v_mfma_f32_16x16x32_bf16 v[32:35], a[200:203], v[40:43], v[32:35]
    s_waitcnt lgkmcnt(4)
    v_mfma_f32_16x16x32_bf16 v[32:35], a[212:215], v[44:47], v[32:35]
    ds_read_b128 v[40:43], v3 offset:20480
    v_mfma_f32_16x16x32_bf16 v[28:31], a[208:211], v[44:47], v[28:31]
    buffer_load_dwordx4 v1, s[8:11], s37 offen offset:3072 sc1 lds
    v_mfma_f32_16x16x32_bf16 v[24:27], a[204:207], v[44:47], v[24:27]
    s_waitcnt lgkmcnt(3)
    s_add_u32 m0, s34, s41
    s_add_u32 s37, s33, s41
    v_mfma_f32_16x16x32_bf16 v[24:27], a[216:219], v[48:51], v[24:27]
    ds_read_b128 v[44:47], v3 offset:21504
    s_waitcnt lgkmcnt(3)
    v_mfma_f32_16x16x32_bf16 v[28:31], a[220:223], v[48:51], v[28:31]
    v_add_f32 v100, v100, v108
    v_add_f32 v101, v101, v109
    v_mfma_f32_16x16x32_bf16 v[32:35], a[224:227], v[48:51], v[32:35]
    s_waitcnt lgkmcnt(2)
    buffer_load_dwordx4 v1, s[8:11], s37 offen offset:0 sc1 lds
    v_mfma_f32_16x16x32_bf16 v[32:35], a[236:239], v[52:55], v[32:35]
    ds_read_b128 v[48:51], v3 offset:22528
    s_add_u32 s32, s32, 1
    v_mfma_f32_16x16x32_bf16 v[28:31], a[232:235], v[52:55], v[28:31]
    s_add_u32 s33, s33, 36864
    s_add_u32 s34, s34, 36864
    v_add_f32 v102, v102, v110
    v_mfma_f32_16x16x32_bf16 v[24:27], a[228:231], v[52:55], v[24:27]
    s_waitcnt lgkmcnt(2)
    s_cmp_ge_u32 s34, 147456
    s_cselect_b32 s38, 147456, 0
    v_mfma_f32_16x16x32_bf16 v[24:27], a[240:243], v[40:43], v[24:27]
    ds_read_b128 v[52:55], v3 offset:23552
    s_sub_u32 s34, s34, s38
    v_mfma_f32_16x16x32_bf16 v[28:31], a[244:247], v[40:43], v[28:31]
    buffer_load_dword v5, v4, s[4:7], s16 offen sc1
    v_mfma_f32_16x16x32_bf16 v[32:35], a[248:251], v[40:43], v[32:35]
    s_waitcnt lgkmcnt(2)
    v_add_f32 v103, v103, v111
    v_add_f32 v104, v104, v112
    v_mfma_f32_16x16x32_bf16 v[32:35], v[132:135], v[44:47], v[32:35]
    ds_read_b128 v[40:43], v3 offset:24576
    v_add_f32 v105, v105, v113
    v_mfma_f32_16x16x32_bf16 v[28:31], v[128:131], v[44:47], v[28:31]
    v_add_f32 v106, v106, v114
    v_add_f32 v107, v107, v115
    v_mfma_f32_16x16x32_bf16 v[24:27], a[252:255], v[44:47], v[24:27]
    s_waitcnt lgkmcnt(2)
    v_add_f32 v100, v100, v104
    v_add_f32 v101, v101, v105
    v_mfma_f32_16x16x32_bf16 v[24:27], v[136:139], v[48:51], v[24:27]
    ds_read_b128 v[44:47], v3 offset:25600
    v_add_f32 v102, v102, v106
    v_mfma_f32_16x16x32_bf16 v[28:31], v[140:143], v[48:51], v[28:31]
    v_add_f32 v103, v103, v107
    v_add_f32 v100, v100, v102
    v_mfma_f32_16x16x32_bf16 v[32:35], v[144:147], v[48:51], v[32:35]
    s_waitcnt lgkmcnt(2)
    v_add_f32 v101, v101, v103
    v_mfma_f32_16x16x32_bf16 v[32:35], v[156:159], v[52:55], v[32:35]
    ds_read_b128 v[48:51], v3 offset:26624
    v_mfma_f32_16x16x32_bf16 v[28:31], v[152:155], v[52:55], v[28:31]
    v_permlane16_swap_b32 v100, v101
    v_mfma_f32_16x16x32_bf16 v[24:27], v[148:151], v[52:55], v[24:27]
    s_waitcnt lgkmcnt(2)
    v_add_f32 v100, v100, v101
    v_mov_b32 v101, v100
    v_mfma_f32_16x16x32_bf16 v[24:27], v[160:163], v[40:43], v[24:27]
    ds_read_b128 v[52:55], v3 offset:27648
    v_mfma_f32_16x16x32_bf16 v[28:31], v[164:167], v[40:43], v[28:31]
    v_permlane32_swap_b32 v100, v101
    v_mfma_f32_16x16x32_bf16 v[32:35], v[168:171], v[40:43], v[32:35]
    s_waitcnt lgkmcnt(2)
    v_add_f32 v100, v100, v101
    v_mul_f32 v100, 0x3a800000, v100
    v_mfma_f32_16x16x32_bf16 v[32:35], v[180:183], v[44:47], v[32:35]
    ds_read_b128 v[40:43], v3 offset:28672
    v_mov_b32 v101, v100
    v_mfma_f32_16x16x32_bf16 v[28:31], v[176:179], v[44:47], v[28:31]
    v_mfma_f32_16x16x32_bf16 v[24:27], v[172:175], v[44:47], v[24:27]
    s_waitcnt lgkmcnt(2)
    v_permlane16_swap_b32 v100, v101
    v_mfma_f32_16x16x32_bf16 v[24:27], v[184:187], v[48:51], v[24:27]
    ds_read_b128 v[44:47], v3 offset:29696
    v_fma_f32 v101, -v100, v100, v101
    v_mfma_f32_16x16x32_bf16 v[28:31], v[188:191], v[48:51], v[28:31]
    v_max_f32 v101, 0, v101
    v_add_f32 v101, 0x3727c5ac, v101
    v_mfma_f32_16x16x32_bf16 v[32:35], v[192:195], v[48:51], v[32:35]
    s_waitcnt vmcnt(7) lgkmcnt(2)
    s_barrier
    v_mfma_f32_16x16x32_bf16 v[32:35], v[204:207], v[52:55], v[32:35]
    ds_read_b128 v[48:51], v3 offset:30720
    s_waitcnt vmcnt(5)
    v_mfma_f32_16x16x32_bf16 v[28:31], v[200:203], v[52:55], v[28:31]
    buffer_store_dword v6, v22, s[12:15], s17 offen sc1
    s_mov_b32 s14, s6
    v_mfma_f32_16x16x32_bf16 v[24:27], v[196:199], v[52:55], v[24:27]
    s_waitcnt lgkmcnt(2)
    v_rsq_f32 v21, v101
    v_mfma_f32_16x16x32_bf16 v[24:27], v[208:211], v[40:43], v[24:27]
    ds_read_b128 v[52:55], v3 offset:31744
    v_mul_f32 v100, v100, v21
    v_mfma_f32_16x16x32_bf16 v[28:31], v[212:215], v[40:43], v[28:31]
    s_add_u32 s17, s17, 8192
    v_fma_f32 v80, -v100, v56, v68
    v_fma_f32 v81, -v100, v57, v69
    v_mfma_f32_16x16x32_bf16 v[32:35], v[216:219], v[40:43], v[32:35]
    s_waitcnt lgkmcnt(2)
    v_fma_f32 v82, -v100, v58, v70
    v_fma_f32 v83, -v100, v59, v71
    v_mfma_f32_16x16x32_bf16 v[32:35], v[228:231], v[44:47], v[32:35]
    ds_read_b128 v[40:43], v2 offset:0
    v_fma_f32 v84, -v100, v60, v72
    v_mfma_f32_16x16x32_bf16 v[28:31], v[224:227], v[44:47], v[28:31]
    v_fma_f32 v85, -v100, v61, v73
    v_fma_f32 v86, -v100, v62, v74
    v_mfma_f32_16x16x32_bf16 v[24:27], v[220:223], v[44:47], v[24:27]
    s_waitcnt lgkmcnt(2)
    v_fma_f32 v87, -v100, v63, v75
    v_fma_f32 v88, -v100, v64, v76
    v_mfma_f32_16x16x32_bf16 v[24:27], v[232:235], v[48:51], v[24:27]
    ds_read_b128 v[44:47], v2 offset:1024
    v_fma_f32 v89, -v100, v65, v77
    v_mfma_f32_16x16x32_bf16 v[28:31], v[236:239], v[48:51], v[28:31]
    v_fma_f32 v90, -v100, v66, v78
    v_fma_f32 v91, -v100, v67, v79
    v_mfma_f32_16x16x32_bf16 v[32:35], v[240:243], v[48:51], v[32:35]
    s_waitcnt lgkmcnt(2)
    v_mfma_f32_16x16x32_bf16 v[32:35], v[252:255], v[52:55], v[32:35]
    ds_read_b128 v[48:51], v2 offset:2048
    v_mfma_f32_16x16x32_bf16 v[28:31], v[248:251], v[52:55], v[28:31]
    v_mfma_f32_16x16x32_bf16 v[24:27], v[244:247], v[52:55], v[24:27]
    s_cmp_lt_i32 s31, 63
    s_cbranch_scc1 Lffa_body02
    s_branch L_exit
    .p2align 6
Lffa_body01:
    s_waitcnt lgkmcnt(2)
    v_mfma_f32_16x16x32_bf16 v[8:11], a[0:3], v[40:43], 0
    ds_read_b128 v[52:55], v2 offset:3072
    s_add_u32 m0, s34, 0
    v_mfma_f32_16x16x32_bf16 v[12:15], a[4:7], v[40:43], 0
    s_add_u32 s31, s31, 1
    v_mov_b32 v6, s31
    v_fma_f32 v124, v32, v21, v88
    v_mfma_f32_16x16x32_bf16 v[16:19], a[8:11], v[40:43], 0
    s_waitcnt lgkmcnt(2)
    v_fma_f32 v125, v33, v21, v89
    v_fma_f32 v126, v34, v21, v90
    v_mfma_f32_16x16x32_bf16 v[16:19], a[20:23], v[44:47], v[16:19]
    ds_read_b128 v[40:43], v2 offset:4096
    v_fma_f32 v127, v35, v21, v91
    v_mfma_f32_16x16x32_bf16 v[12:15], a[16:19], v[44:47], v[12:15]
    s_add_u32 s35, s35, 36864
    v_mul_f32 v124, v124, |v124|
    v_mul_f32 v125, v125, |v125|
    v_mfma_f32_16x16x32_bf16 v[8:11], a[12:15], v[44:47], v[8:11]
    s_waitcnt lgkmcnt(2)
    v_mul_f32 v126, v126, |v126|
    v_mul_f32 v127, v127, |v127|
    v_mfma_f32_16x16x32_bf16 v[8:11], a[24:27], v[48:51], v[8:11]
    ds_read_b128 v[44:47], v2 offset:5120
    v_cvt_pk_bf16_f32 v124, v124, v125
    v_mfma_f32_16x16x32_bf16 v[12:15], a[28:31], v[48:51], v[12:15]
    s_cmp_eq_u32 s35, 147456
    s_cselect_b32 s35, 0, s35
    v_cvt_pk_bf16_f32 v126, v126, v127
    v_mfma_f32_16x16x32_bf16 v[16:19], a[32:35], v[48:51], v[16:19]
    s_waitcnt vmcnt(1) lgkmcnt(2)
    v_cmp_gt_i32 vcc, s32, v5
    v_pk_max_i16 v96, v124, 0
    v_mfma_f32_16x16x32_bf16 v[16:19], a[44:47], v[52:55], v[16:19]
    ds_read_b128 v[48:51], v2 offset:6144
    v_pk_max_i16 v97, v126, 0
    v_mfma_f32_16x16x32_bf16 v[12:15], a[40:43], v[52:55], v[12:15]
    s_and_b64 vcc, vcc, s[18:19]
    s_cbranch_scc1 Lffa_v01
    v_mfma_f32_16x16x32_bf16 v[8:11], a[36:39], v[52:55], v[8:11]
    s_waitcnt lgkmcnt(2)
    buffer_load_dwordx4 v1, s[8:11], s33 offen offset:0 sc1 lds
    v_mfma_f32_16x16x32_bf16 v[8:11], a[48:51], v[40:43], v[8:11]
    ds_read_b128 v[52:55], v2 offset:7168
    v_pk_max_i16 v98, v124, 0
    v_mfma_f32_16x16x32_bf16 v[12:15], a[52:55], v[40:43], v[12:15]
    v_pk_max_i16 v99, v126, 0
    v_fma_f32 v116, v24, v21, v80
    v_mfma_f32_16x16x32_bf16 v[16:19], a[56:59], v[40:43], v[16:19]
    s_waitcnt lgkmcnt(2)
    v_permlane32_swap_b32 v96, v98
    v_mfma_f32_16x16x32_bf16 v[16:19], a[68:71], v[44:47], v[16:19]
    ds_read_b128 v[40:43], v2 offset:8192
    v_fma_f32 v117, v25, v21, v81
    v_mfma_f32_16x16x32_bf16 v[12:15], a[64:67], v[44:47], v[12:15]
    buffer_load_dwordx4 v1, s[8:11], s33 offen offset:1024 sc1 lds
    v_mfma_f32_16x16x32_bf16 v[8:11], a[60:63], v[44:47], v[8:11]
    s_waitcnt lgkmcnt(2)
    v_permlane32_swap_b32 v97, v99
    v_mfma_f32_16x16x32_bf16 v[8:11], a[72:75], v[48:51], v[8:11]
    ds_read_b128 v[44:47], v2 offset:9216
    v_fma_f32 v118, v26, v21, v82
    v_mfma_f32_16x16x32_bf16 v[12:15], a[76:79], v[48:51], v[12:15]
    v_fma_f32 v119, v27, v21, v83
    v_fma_f32 v120, v28, v21, v84
    v_mfma_f32_16x16x32_bf16 v[16:19], a[80:83], v[48:51], v[16:19]
    s_waitcnt lgkmcnt(2)
    buffer_store_dwordx4 v[96:99], v7, s[12:15], s36 offen sc1
    v_fma_f32 v121, v29, v21, v85
    v_mfma_f32_16x16x32_bf16 v[16:19], a[92:95], v[52:55], v[16:19]
    ds_read_b128 v[48:51], v2 offset:10240
    v_fma_f32 v122, v30, v21, v86
    v_mfma_f32_16x16x32_bf16 v[12:15], a[88:91], v[52:55], v[12:15]
    v_fma_f32 v123, v31, v21, v87
    v_mul_f32 v116, v116, |v116|
    v_mfma_f32_16x16x32_bf16 v[8:11], a[84:87], v[52:55], v[8:11]
    s_waitcnt lgkmcnt(2)
    v_mul_f32 v117, v117, |v117|
    v_mul_f32 v118, v118, |v118|
    v_mfma_f32_16x16x32_bf16 v[8:11], a[96:99], v[40:43], v[8:11]
    ds_read_b128 v[52:55], v2 offset:11264
    v_mul_f32 v119, v119, |v119|
    v_mfma_f32_16x16x32_bf16 v[12:15], a[100:103], v[40:43], v[12:15]
    buffer_load_dwordx4 v1, s[8:11], s33 offen offset:2048 sc1 lds
    v_mfma_f32_16x16x32_bf16 v[16:19], a[104:107], v[40:43], v[16:19]
    s_waitcnt lgkmcnt(2)
    v_mul_f32 v120, v120, |v120|
    v_mul_f32 v121, v121, |v121|
    v_mfma_f32_16x16x32_bf16 v[16:19], a[116:119], v[44:47], v[16:19]
    ds_read_b128 v[40:43], v2 offset:12288
    v_mul_f32 v122, v122, |v122|
    v_mfma_f32_16x16x32_bf16 v[12:15], a[112:115], v[44:47], v[12:15]
    v_mul_f32 v123, v123, |v123|
    v_cvt_pk_bf16_f32 v116, v116, v117
    v_mfma_f32_16x16x32_bf16 v[8:11], a[108:111], v[44:47], v[8:11]
    s_waitcnt lgkmcnt(2)
    buffer_load_dwordx4 v1, s[8:11], s33 offen offset:3072 sc1 lds
    v_mfma_f32_16x16x32_bf16 v[8:11], a[120:123], v[48:51], v[8:11]
    ds_read_b128 v[44:47], v2 offset:13312
    s_add_u32 s16, s16, 8192
    v_mfma_f32_16x16x32_bf16 v[12:15], a[124:127], v[48:51], v[12:15]
    s_add_u32 m0, s34, s3
    s_add_u32 s37, s33, s3
    v_cvt_pk_bf16_f32 v118, v118, v119
    v_mfma_f32_16x16x32_bf16 v[16:19], a[128:131], v[48:51], v[16:19]
    s_waitcnt lgkmcnt(2)
    v_cvt_pk_bf16_f32 v120, v120, v121
    v_cvt_pk_bf16_f32 v122, v122, v123
    v_mfma_f32_16x16x32_bf16 v[16:19], a[140:143], v[52:55], v[16:19]
    ds_read_b128 v[48:51], v2 offset:14336
    v_pk_max_i16 v92, v116, 0
    v_mfma_f32_16x16x32_bf16 v[12:15], a[136:139], v[52:55], v[12:15]
    s_waitcnt vmcnt(5)
    s_barrier
    v_mfma_f32_16x16x32_bf16 v[8:11], a[132:135], v[52:55], v[8:11]
    s_waitcnt lgkmcnt(2)
    buffer_load_dwordx4 v1, s[8:11], s37 offen offset:0 sc1 lds
    v_mfma_f32_16x16x32_bf16 v[8:11], a[144:147], v[40:43], v[8:11]
    ds_read_b128 v[52:55], v2 offset:15360
    v_pk_max_i16 v93, v118, 0
    v_mfma_f32_16x16x32_bf16 v[12:15], a[148:151], v[40:43], v[12:15]
    v_pk_max_i16 v94, v120, 0
    v_pk_max_i16 v95, v122, 0
    v_mfma_f32_16x16x32_bf16 v[16:19], a[152:155], v[40:43], v[16:19]
    s_waitcnt lgkmcnt(2)
    v_add_u32 v3, s35, v1
    v_sub_u32 v100, v2, v20
    v_mfma_f32_16x16x32_bf16 v[16:19], a[164:167], v[44:47], v[16:19]
    ds_read_b128 v[40:43], v2 offset:16384
    v_mfma_f32_16x16x32_bf16 v[12:15], a[160:163], v[44:47], v[12:15]
    buffer_store_dwordx4 v[92:95], v1, s[12:15], s36 offen sc1
    s_add_u32 s36, s36, 116736
    v_mfma_f32_16x16x32_bf16 v[8:11], a[156:159], v[44:47], v[8:11]
    s_waitcnt lgkmcnt(2)
    ds_read2st64_b64 v[112:115], v100 offset0:70 offset1:71
    v_mfma_f32_16x16x32_bf16 v[8:11], a[168:171], v[48:51], v[8:11]
    ds_read_b128 v[44:47], v2 offset:17408
    v_mfma_f32_16x16x32_bf16 v[12:15], a[172:175], v[48:51], v[12:15]
    ds_read2st64_b64 v[108:111], v100 offset0:68 offset1:69
    v_mfma_f32_16x16x32_bf16 v[16:19], a[176:179], v[48:51], v[16:19]
    s_waitcnt lgkmcnt(4)
    buffer_load_dwordx4 v1, s[8:11], s37 offen offset:1024 sc1 lds
    v_mfma_f32_16x16x32_bf16 v[16:19], a[188:191], v[52:55], v[16:19]
    ds_read_b128 v[48:51], v2 offset:18432
    v_mfma_f32_16x16x32_bf16 v[12:15], a[184:187], v[52:55], v[12:15]
    ds_read2st64_b64 v[104:107], v100 offset0:66 offset1:67
    v_mfma_f32_16x16x32_bf16 v[8:11], a[180:183], v[52:55], v[8:11]
    s_waitcnt lgkmcnt(5)
    ds_read2st64_b64 v[100:103], v100 offset0:64 offset1:65
    v_mfma_f32_16x16x32_bf16 v[8:11], a[192:195], v[40:43], v[8:11]
    ds_read_b128 v[52:55], v2 offset:19456
    v_mfma_f32_16x16x32_bf16 v[12:15], a[196:199], v[40:43], v[12:15]
    buffer_load_dwordx4 v1, s[8:11], s37 offen offset:2048 sc1 lds
    v_mfma_f32_16x16x32_bf16 v[16:19], a[200:203], v[40:43], v[16:19]
    s_waitcnt lgkmcnt(5)
    v_mfma_f32_16x16x32_bf16 v[16:19], a[212:215], v[44:47], v[16:19]
    ds_read_b128 v[40:43], v2 offset:20480
    v_mfma_f32_16x16x32_bf16 v[12:15], a[208:211], v[44:47], v[12:15]
    v_mfma_f32_16x16x32_bf16 v[8:11], a[204:207], v[44:47], v[8:11]
    s_waitcnt lgkmcnt(4)
    buffer_load_dwordx4 v1, s[8:11], s37 offen offset:3072 sc1 lds
    v_mfma_f32_16x16x32_bf16 v[8:11], a[216:219], v[48:51], v[8:11]
    ds_read_b128 v[44:47], v2 offset:21504
    s_add_u32 m0, s34, s41
    v_mfma_f32_16x16x32_bf16 v[12:15], a[220:223], v[48:51], v[12:15]
    s_add_u32 s37, s33, s41
    s_waitcnt lgkmcnt(3)
    v_add_f32 v100, v100, v108
    v_mfma_f32_16x16x32_bf16 v[16:19], a[224:227], v[48:51], v[16:19]
    s_waitcnt lgkmcnt(2)
    v_add_f32 v101, v101, v109
    v_add_f32 v102, v102, v110
    v_mfma_f32_16x16x32_bf16 v[16:19], a[236:239], v[52:55], v[16:19]
    ds_read_b128 v[48:51], v2 offset:22528
    v_add_f32 v103, v103, v111
    v_mfma_f32_16x16x32_bf16 v[12:15], a[232:235], v[52:55], v[12:15]
    buffer_load_dword v5, v4, s[4:7], s16 offen sc1
    v_mfma_f32_16x16x32_bf16 v[8:11], a[228:231], v[52:55], v[8:11]
    s_waitcnt lgkmcnt(2)
    v_add_f32 v104, v104, v112
    v_add_f32 v105, v105, v113
    v_mfma_f32_16x16x32_bf16 v[8:11], a[240:243], v[40:43], v[8:11]
    ds_read_b128 v[52:55], v2 offset:23552
    v_add_f32 v106, v106, v114
    v_mfma_f32_16x16x32_bf16 v[12:15], a[244:247], v[40:43], v[12:15]
    v_add_f32 v107, v107, v115
    v_add_f32 v100, v100, v104
    v_mfma_f32_16x16x32_bf16 v[16:19], a[248:251], v[40:43], v[16:19]
    s_waitcnt lgkmcnt(2)
    buffer_load_dwordx4 v1, s[8:11], s37 offen offset:0 sc1 lds
    v_mfma_f32_16x16x32_bf16 v[16:19], v[132:135], v[44:47], v[16:19]
    ds_read_b128 v[40:43], v2 offset:24576
    s_add_u32 s32, s32, 1
    v_mfma_f32_16x16x32_bf16 v[12:15], v[128:131], v[44:47], v[12:15]
    s_add_u32 s33, s33, 36864
    s_add_u32 s34, s34, 36864
    v_add_f32 v101, v101, v105
    v_mfma_f32_16x16x32_bf16 v[8:11], a[252:255], v[44:47], v[8:11]
    s_waitcnt lgkmcnt(2)
    s_cmp_ge_u32 s34, 147456
    s_cselect_b32 s38, 147456, 0
    v_mfma_f32_16x16x32_bf16 v[8:11], v[136:139], v[48:51], v[8:11]
    ds_read_b128 v[44:47], v2 offset:25600
    s_sub_u32 s34, s34, s38
    v_mfma_f32_16x16x32_bf16 v[12:15], v[140:143], v[48:51], v[12:15]
    v_add_f32 v102, v102, v106
    v_add_f32 v103, v103, v107
    v_mfma_f32_16x16x32_bf16 v[16:19], v[144:147], v[48:51], v[16:19]
    s_waitcnt lgkmcnt(2)
    v_add_f32 v100, v100, v102
    v_add_f32 v101, v101, v103
    v_mfma_f32_16x16x32_bf16 v[16:19], v[156:159], v[52:55], v[16:19]
    ds_read_b128 v[48:51], v2 offset:26624
    v_mfma_f32_16x16x32_bf16 v[12:15], v[152:155], v[52:55], v[12:15]
    v_permlane16_swap_b32 v100, v101
    v_mfma_f32_16x16x32_bf16 v[8:11], v[148:151], v[52:55], v[8:11]
    s_waitcnt lgkmcnt(2)
    v_add_f32 v100, v100, v101
    v_mov_b32 v101, v100
    v_mfma_f32_16x16x32_bf16 v[8:11], v[160:163], v[40:43], v[8:11]
    ds_read_b128 v[52:55], v2 offset:27648
    v_mfma_f32_16x16x32_bf16 v[12:15], v[164:167], v[40:43], v[12:15]
    v_permlane32_swap_b32 v100, v101
    v_mfma_f32_16x16x32_bf16 v[16:19], v[168:171], v[40:43], v[16:19]
    s_waitcnt lgkmcnt(2)
    v_add_f32 v100, v100, v101
    v_mul_f32 v100, 0x3a800000, v100
    v_mfma_f32_16x16x32_bf16 v[16:19], v[180:183], v[44:47], v[16:19]
    ds_read_b128 v[40:43], v2 offset:28672
    v_mov_b32 v101, v100
    v_mfma_f32_16x16x32_bf16 v[12:15], v[176:179], v[44:47], v[12:15]
    v_mfma_f32_16x16x32_bf16 v[8:11], v[172:175], v[44:47], v[8:11]
    s_waitcnt lgkmcnt(2)
    v_permlane16_swap_b32 v100, v101
    v_mfma_f32_16x16x32_bf16 v[8:11], v[184:187], v[48:51], v[8:11]
    ds_read_b128 v[44:47], v2 offset:29696
    v_fma_f32 v101, -v100, v100, v101
    v_mfma_f32_16x16x32_bf16 v[12:15], v[188:191], v[48:51], v[12:15]
    v_max_f32 v101, 0, v101
    v_add_f32 v101, 0x3727c5ac, v101
    v_mfma_f32_16x16x32_bf16 v[16:19], v[192:195], v[48:51], v[16:19]
    s_waitcnt lgkmcnt(2)
    v_rsq_f32 v21, v101
    v_mfma_f32_16x16x32_bf16 v[16:19], v[204:207], v[52:55], v[16:19]
    ds_read_b128 v[48:51], v2 offset:30720
    v_mul_f32 v100, v100, v21
    v_mfma_f32_16x16x32_bf16 v[12:15], v[200:203], v[52:55], v[12:15]
    s_waitcnt vmcnt(7)
    s_barrier
    v_mfma_f32_16x16x32_bf16 v[8:11], v[196:199], v[52:55], v[8:11]
    s_waitcnt vmcnt(5) lgkmcnt(2)
    buffer_store_dword v6, v22, s[12:15], s17 offen sc1
    v_mfma_f32_16x16x32_bf16 v[8:11], v[208:211], v[40:43], v[8:11]
    ds_read_b128 v[52:55], v2 offset:31744
    v_fma_f32 v80, -v100, v56, v68
    v_mfma_f32_16x16x32_bf16 v[12:15], v[212:215], v[40:43], v[12:15]
    s_mov_b32 s14, s6
    v_fma_f32 v81, -v100, v57, v69
    v_fma_f32 v82, -v100, v58, v70
    v_mfma_f32_16x16x32_bf16 v[16:19], v[216:219], v[40:43], v[16:19]
    s_waitcnt lgkmcnt(2)
    v_fma_f32 v83, -v100, v59, v71
    v_fma_f32 v84, -v100, v60, v72
    v_mfma_f32_16x16x32_bf16 v[16:19], v[228:231], v[44:47], v[16:19]
    ds_read_b128 v[40:43], v3 offset:0
    v_fma_f32 v85, -v100, v61, v73
    v_mfma_f32_16x16x32_bf16 v[12:15], v[224:227], v[44:47], v[12:15]
    s_add_u32 s17, s17, 8192
    v_fma_f32 v86, -v100, v62, v74
    v_fma_f32 v87, -v100, v63, v75
    v_mfma_f32_16x16x32_bf16 v[8:11], v[220:223], v[44:47], v[8:11]
    s_waitcnt lgkmcnt(2)
    v_fma_f32 v88, -v100, v64, v76
    v_fma_f32 v89, -v100, v65, v77
    v_mfma_f32_16x16x32_bf16 v[8:11], v[232:235], v[48:51], v[8:11]
    ds_read_b128 v[44:47], v3 offset:1024
    v_fma_f32 v90, -v100, v66, v78
    v_mfma_f32_16x16x32_bf16 v[12:15], v[236:239], v[48:51], v[12:15]
    v_fma_f32 v91, -v100, v67, v79
    v_mfma_f32_16x16x32_bf16 v[16:19], v[240:243], v[48:51], v[16:19]
    s_waitcnt lgkmcnt(2)
    v_mfma_f32_16x16x32_bf16 v[16:19], v[252:255], v[52:55], v[16:19]
    ds_read_b128 v[48:51], v3 offset:2048
    v_mfma_f32_16x16x32_bf16 v[12:15], v[248:251], v[52:55], v[12:15]
    v_mfma_f32_16x16x32_bf16 v[8:11], v[244:247], v[52:55], v[8:11]
Lffa_body11:
    s_waitcnt lgkmcnt(2)
    v_mfma_f32_16x16x32_bf16 v[24:27], a[0:3], v[40:43], 0
    ds_read_b128 v[52:55], v3 offset:3072
    s_add_u32 m0, s34, 0
    v_mfma_f32_16x16x32_bf16 v[28:31], a[4:7], v[40:43], 0
    s_add_u32 s31, s31, 1
    v_mov_b32 v6, s31
    v_fma_f32 v124, v16, v21, v88
    v_mfma_f32_16x16x32_bf16 v[32:35], a[8:11], v[40:43], 0
    s_waitcnt lgkmcnt(2)
    v_fma_f32 v125, v17, v21, v89
    v_fma_f32 v126, v18, v21, v90
    v_mfma_f32_16x16x32_bf16 v[32:35], a[20:23], v[44:47], v[32:35]
    ds_read_b128 v[40:43], v3 offset:4096
    v_fma_f32 v127, v19, v21, v91
    v_mfma_f32_16x16x32_bf16 v[28:31], a[16:19], v[44:47], v[28:31]
    s_add_u32 s35, s35, 36864
    v_mul_f32 v124, v124, |v124|
    v_mul_f32 v125, v125, |v125|
    v_mfma_f32_16x16x32_bf16 v[24:27], a[12:15], v[44:47], v[24:27]
    s_waitcnt lgkmcnt(2)
    v_mul_f32 v126, v126, |v126|
    v_mul_f32 v127, v127, |v127|
    v_mfma_f32_16x16x32_bf16 v[24:27], a[24:27], v[48:51], v[24:27]
    ds_read_b128 v[44:47], v3 offset:5120
    v_cvt_pk_bf16_f32 v124, v124, v125
    v_mfma_f32_16x16x32_bf16 v[28:31], a[28:31], v[48:51], v[28:31]
    s_cmp_eq_u32 s35, 147456
    s_cselect_b32 s35, 0, s35
    v_cvt_pk_bf16_f32 v126, v126, v127
    v_mfma_f32_16x16x32_bf16 v[32:35], a[32:35], v[48:51], v[32:35]
    s_waitcnt vmcnt(1) lgkmcnt(2)
    v_cmp_gt_i32 vcc, s32, v5
    v_pk_max_i16 v96, v124, 0
    v_mfma_f32_16x16x32_bf16 v[32:35], a[44:47], v[52:55], v[32:35]
    ds_read_b128 v[48:51], v3 offset:6144
    v_pk_max_i16 v97, v126, 0
    v_mfma_f32_16x16x32_bf16 v[28:31], a[40:43], v[52:55], v[28:31]
    s_and_b64 vcc, vcc, s[18:19]
    s_cbranch_scc1 Lffa_v11
    v_mfma_f32_16x16x32_bf16 v[24:27], a[36:39], v[52:55], v[24:27]
    s_waitcnt lgkmcnt(2)
    buffer_load_dwordx4 v1, s[8:11], s33 offen offset:0 sc1 lds
    v_mfma_f32_16x16x32_bf16 v[24:27], a[48:51], v[40:43], v[24:27]
    ds_read_b128 v[52:55], v3 offset:7168
    v_pk_max_i16 v98, v124, 0
    v_mfma_f32_16x16x32_bf16 v[28:31], a[52:55], v[40:43], v[28:31]
    v_pk_max_i16 v99, v126, 0
    v_fma_f32 v116, v8, v21, v80
    v_mfma_f32_16x16x32_bf16 v[32:35], a[56:59], v[40:43], v[32:35]
    s_waitcnt lgkmcnt(2)
    v_permlane32_swap_b32 v96, v98
    v_mfma_f32_16x16x32_bf16 v[32:35], a[68:71], v[44:47], v[32:35]
    ds_read_b128 v[40:43], v3 offset:8192
    v_fma_f32 v117, v9, v21, v81
    v_mfma_f32_16x16x32_bf16 v[28:31], a[64:67], v[44:47], v[28:31]
    buffer_load_dwordx4 v1, s[8:11], s33 offen offset:1024 sc1 lds
    v_mfma_f32_16x16x32_bf16 v[24:27], a[60:63], v[44:47], v[24:27]
    s_waitcnt lgkmcnt(2)
    v_permlane32_swap_b32 v97, v99
    v_mfma_f32_16x16x32_bf16 v[24:27], a[72:75], v[48:51], v[24:27]
    ds_read_b128 v[44:47], v3 offset:9216
    v_fma_f32 v118, v10, v21, v82
    v_mfma_f32_16x16x32_bf16 v[28:31], a[76:79], v[48:51], v[28:31]
    v_fma_f32 v119, v11, v21, v83
    v_fma_f32 v120, v12, v21, v84
    v_mfma_f32_16x16x32_bf16 v[32:35], a[80:83], v[48:51], v[32:35]
    s_waitcnt lgkmcnt(2)
    buffer_store_dwordx4 v[96:99], v7, s[12:15], s36 offen sc1
    v_fma_f32 v121, v13, v21, v85
    v_mfma_f32_16x16x32_bf16 v[32:35], a[92:95], v[52:55], v[32:35]
    ds_read_b128 v[48:51], v3 offset:10240
    v_fma_f32 v122, v14, v21, v86
    v_mfma_f32_16x16x32_bf16 v[28:31], a[88:91], v[52:55], v[28:31]
    v_fma_f32 v123, v15, v21, v87
    v_mul_f32 v116, v116, |v116|
    v_mfma_f32_16x16x32_bf16 v[24:27], a[84:87], v[52:55], v[24:27]
    s_waitcnt lgkmcnt(2)
    v_mul_f32 v117, v117, |v117|
    v_mul_f32 v118, v118, |v118|
    v_mfma_f32_16x16x32_bf16 v[24:27], a[96:99], v[40:43], v[24:27]
    ds_read_b128 v[52:55], v3 offset:11264
    v_mul_f32 v119, v119, |v119|
    v_mfma_f32_16x16x32_bf16 v[28:31], a[100:103], v[40:43], v[28:31]
    buffer_load_dwordx4 v1, s[8:11], s33 offen offset:2048 sc1 lds
    v_mfma_f32_16x16x32_bf16 v[32:35], a[104:107], v[40:43], v[32:35]
    s_waitcnt lgkmcnt(2)
    v_mul_f32 v120, v120, |v120|
    v_mul_f32 v121, v121, |v121|
    v_mfma_f32_16x16x32_bf16 v[32:35], a[116:119], v[44:47], v[32:35]
    ds_read_b128 v[40:43], v3 offset:12288
    v_mul_f32 v122, v122, |v122|
    v_mfma_f32_16x16x32_bf16 v[28:31], a[112:115], v[44:47], v[28:31]
    v_mul_f32 v123, v123, |v123|
    v_cvt_pk_bf16_f32 v116, v116, v117
    v_mfma_f32_16x16x32_bf16 v[24:27], a[108:111], v[44:47], v[24:27]
    s_waitcnt lgkmcnt(2)
    buffer_load_dwordx4 v1, s[8:11], s33 offen offset:3072 sc1 lds
    v_mfma_f32_16x16x32_bf16 v[24:27], a[120:123], v[48:51], v[24:27]
    ds_read_b128 v[44:47], v3 offset:13312
    s_add_u32 s16, s16, 8192
    v_mfma_f32_16x16x32_bf16 v[28:31], a[124:127], v[48:51], v[28:31]
    s_add_u32 m0, s34, s3
    s_add_u32 s37, s33, s3
    v_cvt_pk_bf16_f32 v118, v118, v119
    v_mfma_f32_16x16x32_bf16 v[32:35], a[128:131], v[48:51], v[32:35]
    s_waitcnt lgkmcnt(2)
    v_cvt_pk_bf16_f32 v120, v120, v121
    v_cvt_pk_bf16_f32 v122, v122, v123
    v_mfma_f32_16x16x32_bf16 v[32:35], a[140:143], v[52:55], v[32:35]
    ds_read_b128 v[48:51], v3 offset:14336
    v_pk_max_i16 v92, v116, 0
    v_mfma_f32_16x16x32_bf16 v[28:31], a[136:139], v[52:55], v[28:31]
    s_waitcnt vmcnt(5)
    s_barrier
    v_mfma_f32_16x16x32_bf16 v[24:27], a[132:135], v[52:55], v[24:27]
    s_waitcnt lgkmcnt(2)
    buffer_load_dwordx4 v1, s[8:11], s37 offen offset:0 sc1 lds
    v_mfma_f32_16x16x32_bf16 v[24:27], a[144:147], v[40:43], v[24:27]
    ds_read_b128 v[52:55], v3 offset:15360
    v_pk_max_i16 v93, v118, 0
    v_mfma_f32_16x16x32_bf16 v[28:31], a[148:151], v[40:43], v[28:31]
    v_pk_max_i16 v94, v120, 0
    v_pk_max_i16 v95, v122, 0
    v_mfma_f32_16x16x32_bf16 v[32:35], a[152:155], v[40:43], v[32:35]
    s_waitcnt lgkmcnt(2)
    v_add_u32 v2, s35, v1
    v_sub_u32 v100, v3, v20
    v_mfma_f32_16x16x32_bf16 v[32:35], a[164:167], v[44:47], v[32:35]
    ds_read_b128 v[40:43], v3 offset:16384
    v_mfma_f32_16x16x32_bf16 v[28:31], a[160:163], v[44:47], v[28:31]
    buffer_store_dwordx4 v[92:95], v1, s[12:15], s36 offen sc1
    s_add_u32 s36, s36, 116736
    v_mfma_f32_16x16x32_bf16 v[24:27], a[156:159], v[44:47], v[24:27]
    s_waitcnt lgkmcnt(2)
    ds_read2st64_b64 v[112:115], v100 offset0:70 offset1:71
    v_mfma_f32_16x16x32_bf16 v[24:27], a[168:171], v[48:51], v[24:27]
    ds_read_b128 v[44:47], v3 offset:17408
    v_mfma_f32_16x16x32_bf16 v[28:31], a[172:175], v[48:51], v[28:31]
    ds_read2st64_b64 v[108:111], v100 offset0:68 offset1:69
    v_mfma_f32_16x16x32_bf16 v[32:35], a[176:179], v[48:51], v[32:35]
    s_waitcnt lgkmcnt(4)
    buffer_load_dwordx4 v1, s[8:11], s37 offen offset:1024 sc1 lds
    v_mfma_f32_16x16x32_bf16 v[32:35], a[188:191], v[52:55], v[32:35]
    ds_read_b128 v[48:51], v3 offset:18432
    v_mfma_f32_16x16x32_bf16 v[28:31], a[184:187], v[52:55], v[28:31]
    ds_read2st64_b64 v[104:107], v100 offset0:66 offset1:67
    v_mfma_f32_16x16x32_bf16 v[24:27], a[180:183], v[52:55], v[24:27]
    s_waitcnt lgkmcnt(5)
    ds_read2st64_b64 v[100:103], v100 offset0:64 offset1:65
    v_mfma_f32_16x16x32_bf16 v[24:27], a[192:195], v[40:43], v[24:27]
    ds_read_b128 v[52:55], v3 offset:19456
    v_mfma_f32_16x16x32_bf16 v[28:31], a[196:199], v[40:43], v[28:31]
    buffer_load_dwordx4 v1, s[8:11], s37 offen offset:2048 sc1 lds
    v_mfma_f32_16x16x32_bf16 v[32:35], a[200:203], v[40:43], v[32:35]
    s_waitcnt lgkmcnt(5)
    v_mfma_f32_16x16x32_bf16 v[32:35], a[212:215], v[44:47], v[32:35]
    ds_read_b128 v[40:43], v3 offset:20480
    v_mfma_f32_16x16x32_bf16 v[28:31], a[208:211], v[44:47], v[28:31]
    v_mfma_f32_16x16x32_bf16 v[24:27], a[204:207], v[44:47], v[24:27]
    s_waitcnt lgkmcnt(4)
    buffer_load_dwordx4 v1, s[8:11], s37 offen offset:3072 sc1 lds
    v_mfma_f32_16x16x32_bf16 v[24:27], a[216:219], v[48:51], v[24:27]
    ds_read_b128 v[44:47], v3 offset:21504
    s_add_u32 m0, s34, s41
    v_mfma_f32_16x16x32_bf16 v[28:31], a[220:223], v[48:51], v[28:31]
    s_add_u32 s37, s33, s41
    s_waitcnt lgkmcnt(3)
    v_add_f32 v100, v100, v108
    v_mfma_f32_16x16x32_bf16 v[32:35], a[224:227], v[48:51], v[32:35]
    s_waitcnt lgkmcnt(2)
    v_add_f32 v101, v101, v109
    v_add_f32 v102, v102, v110
    v_mfma_f32_16x16x32_bf16 v[32:35], a[236:239], v[52:55], v[32:35]
    ds_read_b128 v[48:51], v3 offset:22528
    v_add_f32 v103, v103, v111
    v_mfma_f32_16x16x32_bf16 v[28:31], a[232:235], v[52:55], v[28:31]
    buffer_load_dword v5, v4, s[4:7], s16 offen sc1
    v_mfma_f32_16x16x32_bf16 v[24:27], a[228:231], v[52:55], v[24:27]
    s_waitcnt lgkmcnt(2)
    v_add_f32 v104, v104, v112
    v_add_f32 v105, v105, v113
    v_mfma_f32_16x16x32_bf16 v[24:27], a[240:243], v[40:43], v[24:27]
    ds_read_b128 v[52:55], v3 offset:23552
    v_add_f32 v106, v106, v114
    v_mfma_f32_16x16x32_bf16 v[28:31], a[244:247], v[40:43], v[28:31]
    v_add_f32 v107, v107, v115
    v_add_f32 v100, v100, v104
    v_mfma_f32_16x16x32_bf16 v[32:35], a[248:251], v[40:43], v[32:35]
    s_waitcnt lgkmcnt(2)
    buffer_load_dwordx4 v1, s[8:11], s37 offen offset:0 sc1 lds
    v_mfma_f32_16x16x32_bf16 v[32:35], v[132:135], v[44:47], v[32:35]
    ds_read_b128 v[40:43], v3 offset:24576
    s_add_u32 s32, s32, 1
    v_mfma_f32_16x16x32_bf16 v[28:31], v[128:131], v[44:47], v[28:31]
    s_add_u32 s33, s33, 36864
    s_add_u32 s34, s34, 36864
    v_add_f32 v101, v101, v105
    v_mfma_f32_16x16x32_bf16 v[24:27], a[252:255], v[44:47], v[24:27]
    s_waitcnt lgkmcnt(2)
    s_cmp_ge_u32 s34, 147456
    s_cselect_b32 s38, 147456, 0
    v_mfma_f32_16x16x32_bf16 v[24:27], v[136:139], v[48:51], v[24:27]
    ds_read_b128 v[44:47], v3 offset:25600
    s_sub_u32 s34, s34, s38
    v_mfma_f32_16x16x32_bf16 v[28:31], v[140:143], v[48:51], v[28:31]
    v_add_f32 v102, v102, v106
    v_add_f32 v103, v103, v107
    v_mfma_f32_16x16x32_bf16 v[32:35], v[144:147], v[48:51], v[32:35]
    s_waitcnt lgkmcnt(2)
    v_add_f32 v100, v100, v102
    v_add_f32 v101, v101, v103
    v_mfma_f32_16x16x32_bf16 v[32:35], v[156:159], v[52:55], v[32:35]
    ds_read_b128 v[48:51], v3 offset:26624
    v_mfma_f32_16x16x32_bf16 v[28:31], v[152:155], v[52:55], v[28:31]
    v_permlane16_swap_b32 v100, v101
    v_mfma_f32_16x16x32_bf16 v[24:27], v[148:151], v[52:55], v[24:27]
    s_waitcnt lgkmcnt(2)
    v_add_f32 v100, v100, v101
    v_mov_b32 v101, v100
    v_mfma_f32_16x16x32_bf16 v[24:27], v[160:163], v[40:43], v[24:27]
    ds_read_b128 v[52:55], v3 offset:27648
    v_mfma_f32_16x16x32_bf16 v[28:31], v[164:167], v[40:43], v[28:31]
    v_permlane32_swap_b32 v100, v101
    v_mfma_f32_16x16x32_bf16 v[32:35], v[168:171], v[40:43], v[32:35]
    s_waitcnt lgkmcnt(2)
    v_add_f32 v100, v100, v101
    v_mul_f32 v100, 0x3a800000, v100
    v_mfma_f32_16x16x32_bf16 v[32:35], v[180:183], v[44:47], v[32:35]
    ds_read_b128 v[40:43], v3 offset:28672
    v_mov_b32 v101, v100
    v_mfma_f32_16x16x32_bf16 v[28:31], v[176:179], v[44:47], v[28:31]
    v_mfma_f32_16x16x32_bf16 v[24:27], v[172:175], v[44:47], v[24:27]
    s_waitcnt lgkmcnt(2)
    v_permlane16_swap_b32 v100, v101
    v_mfma_f32_16x16x32_bf16 v[24:27], v[184:187], v[48:51], v[24:27]
    ds_read_b128 v[44:47], v3 offset:29696
    v_fma_f32 v101, -v100, v100, v101
    v_mfma_f32_16x16x32_bf16 v[28:31], v[188:191], v[48:51], v[28:31]
    v_max_f32 v101, 0, v101
    v_add_f32 v101, 0x3727c5ac, v101
    v_mfma_f32_16x16x32_bf16 v[32:35], v[192:195], v[48:51], v[32:35]
    s_waitcnt lgkmcnt(2)
    v_rsq_f32 v21, v101
    v_mfma_f32_16x16x32_bf16 v[32:35], v[204:207], v[52:55], v[32:35]
    ds_read_b128 v[48:51], v3 offset:30720
    v_mul_f32 v100, v100, v21
    v_mfma_f32_16x16x32_bf16 v[28:31], v[200:203], v[52:55], v[28:31]
    s_waitcnt vmcnt(7)
    s_barrier
    v_mfma_f32_16x16x32_bf16 v[24:27], v[196:199], v[52:55], v[24:27]
    s_waitcnt vmcnt(5) lgkmcnt(2)
    buffer_store_dword v6, v22, s[12:15], s17 offen sc1
    v_mfma_f32_16x16x32_bf16 v[24:27], v[208:211], v[40:43], v[24:27]
    ds_read_b128 v[52:55], v3 offset:31744
    v_fma_f32 v80, -v100, v56, v68
    v_mfma_f32_16x16x32_bf16 v[28:31], v[212:215], v[40:43], v[28:31]
    s_mov_b32 s14, s6
    v_fma_f32 v81, -v100, v57, v69
    v_fma_f32 v82, -v100, v58, v70
    v_mfma_f32_16x16x32_bf16 v[32:35], v[216:219], v[40:43], v[32:35]
    s_waitcnt lgkmcnt(2)
    v_fma_f32 v83, -v100, v59, v71
    v_fma_f32 v84, -v100, v60, v72
    v_mfma_f32_16x16x32_bf16 v[32:35], v[228:231], v[44:47], v[32:35]
    ds_read_b128 v[40:43], v2 offset:0
    v_fma_f32 v85, -v100, v61, v73
    v_mfma_f32_16x16x32_bf16 v[28:31], v[224:227], v[44:47], v[28:31]
    s_add_u32 s17, s17, 8192
    v_fma_f32 v86, -v100, v62, v74
    v_fma_f32 v87, -v100, v63, v75
    v_mfma_f32_16x16x32_bf16 v[24:27], v[220:223], v[44:47], v[24:27]
    s_waitcnt lgkmcnt(2)
    v_fma_f32 v88, -v100, v64, v76
    v_fma_f32 v89, -v100, v65, v77
    v_mfma_f32_16x16x32_bf16 v[24:27], v[232:235], v[48:51], v[24:27]
    ds_read_b128 v[44:47], v2 offset:1024
    v_fma_f32 v90, -v100, v66, v78
    v_mfma_f32_16x16x32_bf16 v[28:31], v[236:239], v[48:51], v[28:31]
    v_fma_f32 v91, -v100, v67, v79
    v_mfma_f32_16x16x32_bf16 v[32:35], v[240:243], v[48:51], v[32:35]
    s_waitcnt lgkmcnt(2)
    v_mfma_f32_16x16x32_bf16 v[32:35], v[252:255], v[52:55], v[32:35]
    ds_read_b128 v[48:51], v2 offset:2048
    v_mfma_f32_16x16x32_bf16 v[28:31], v[248:251], v[52:55], v[28:31]
    v_mfma_f32_16x16x32_bf16 v[24:27], v[244:247], v[52:55], v[24:27]
    s_cmp_lt_i32 s31, 63
    s_cbranch_scc1 Lffa_body01
    s_branch L_exit
    .p2align 6
Lffa_body00:
    s_waitcnt lgkmcnt(2)
    v_mfma_f32_16x16x32_bf16 v[8:11], a[0:3], v[40:43], 0
    ds_read_b128 v[52:55], v2 offset:3072
    s_add_u32 m0, s34, 0
    v_mfma_f32_16x16x32_bf16 v[12:15], a[4:7], v[40:43], 0
    s_add_u32 s31, s31, 1
    v_mov_b32 v6, s31
    v_fma_f32 v124, v32, v21, v88
    v_mfma_f32_16x16x32_bf16 v[16:19], a[8:11], v[40:43], 0
    s_waitcnt lgkmcnt(2)
    v_fma_f32 v125, v33, v21, v89
    v_fma_f32 v126, v34, v21, v90
    v_mfma_f32_16x16x32_bf16 v[16:19], a[20:23], v[44:47], v[16:19]
    ds_read_b128 v[40:43], v2 offset:4096
    v_fma_f32 v127, v35, v21, v91
    v_mfma_f32_16x16x32_bf16 v[12:15], a[16:19], v[44:47], v[12:15]
    s_add_u32 s35, s35, 36864
    v_mul_f32 v124, v124, |v124|
    v_mul_f32 v125, v125, |v125|
    v_mfma_f32_16x16x32_bf16 v[8:11], a[12:15], v[44:47], v[8:11]
    s_waitcnt lgkmcnt(2)
    v_mul_f32 v126, v126, |v126|
    v_mul_f32 v127, v127, |v127|
    v_mfma_f32_16x16x32_bf16 v[8:11], a[24:27], v[48:51], v[8:11]
    ds_read_b128 v[44:47], v2 offset:5120
    v_cvt_pk_bf16_f32 v124, v124, v125
    v_mfma_f32_16x16x32_bf16 v[12:15], a[28:31], v[48:51], v[12:15]
    s_cmp_eq_u32 s35, 147456
    s_cselect_b32 s35, 0, s35
    v_cvt_pk_bf16_f32 v126, v126, v127
    v_mfma_f32_16x16x32_bf16 v[16:19], a[32:35], v[48:51], v[16:19]
    s_waitcnt vmcnt(1) lgkmcnt(2)
    v_cmp_gt_i32 vcc, s32, v5
    v_pk_max_i16 v96, v124, 0
    v_mfma_f32_16x16x32_bf16 v[16:19], a[44:47], v[52:55], v[16:19]
    ds_read_b128 v[48:51], v2 offset:6144
    v_pk_max_i16 v97, v126, 0
    v_mfma_f32_16x16x32_bf16 v[12:15], a[40:43], v[52:55], v[12:15]
    s_and_b64 vcc, vcc, s[18:19]
    s_cbranch_scc1 Lffa_v01
    v_mfma_f32_16x16x32_bf16 v[8:11], a[36:39], v[52:55], v[8:11]
    s_waitcnt lgkmcnt(2)
    buffer_load_dwordx4 v1, s[8:11], s33 offen offset:0 sc1 lds
    v_mfma_f32_16x16x32_bf16 v[8:11], a[48:51], v[40:43], v[8:11]
    ds_read_b128 v[52:55], v2 offset:7168
    v_pk_max_i16 v98, v124, 0
    v_mfma_f32_16x16x32_bf16 v[12:15], a[52:55], v[40:43], v[12:15]
    v_pk_max_i16 v99, v126, 0
    v_fma_f32 v116, v24, v21, v80
    v_mfma_f32_16x16x32_bf16 v[16:19], a[56:59], v[40:43], v[16:19]
    s_waitcnt lgkmcnt(2)
    v_permlane32_swap_b32 v96, v98
    v_mfma_f32_16x16x32_bf16 v[16:19], a[68:71], v[44:47], v[16:19]
    ds_read_b128 v[40:43], v2 offset:8192
    v_fma_f32 v117, v25, v21, v81
    v_mfma_f32_16x16x32_bf16 v[12:15], a[64:67], v[44:47], v[12:15]
    buffer_load_dwordx4 v1, s[8:11], s33 offen offset:1024 sc1 lds
    v_mfma_f32_16x16x32_bf16 v[8:11], a[60:63], v[44:47], v[8:11]
    s_waitcnt lgkmcnt(2)
    v_permlane32_swap_b32 v97, v99
    v_mfma_f32_16x16x32_bf16 v[8:11], a[72:75], v[48:51], v[8:11]
    ds_read_b128 v[44:47], v2 offset:9216
    v_fma_f32 v118, v26, v21, v82
    v_mfma_f32_16x16x32_bf16 v[12:15], a[76:79], v[48:51], v[12:15]
    v_fma_f32 v119, v27, v21, v83
    v_fma_f32 v120, v28, v21, v84
    v_mfma_f32_16x16x32_bf16 v[16:19], a[80:83], v[48:51], v[16:19]
    s_waitcnt lgkmcnt(2)
    buffer_store_dwordx4 v[96:99], v7, s[12:15], s36 offen sc1
    v_fma_f32 v121, v29, v21, v85
    v_mfma_f32_16x16x32_bf16 v[16:19], a[92:95], v[52:55], v[16:19]
    ds_read_b128 v[48:51], v2 offset:10240
    v_fma_f32 v122, v30, v21, v86
    v_mfma_f32_16x16x32_bf16 v[12:15], a[88:91], v[52:55], v[12:15]
    v_fma_f32 v123, v31, v21, v87
    v_mul_f32 v116, v116, |v116|
    v_mfma_f32_16x16x32_bf16 v[8:11], a[84:87], v[52:55], v[8:11]
    s_waitcnt lgkmcnt(2)
    v_mul_f32 v117, v117, |v117|
    v_mul_f32 v118, v118, |v118|
    v_mfma_f32_16x16x32_bf16 v[8:11], a[96:99], v[40:43], v[8:11]
    ds_read_b128 v[52:55], v2 offset:11264
    v_mul_f32 v119, v119, |v119|
    v_mfma_f32_16x16x32_bf16 v[12:15], a[100:103], v[40:43], v[12:15]
    buffer_load_dwordx4 v1, s[8:11], s33 offen offset:2048 sc1 lds
    v_mfma_f32_16x16x32_bf16 v[16:19], a[104:107], v[40:43], v[16:19]
    s_waitcnt lgkmcnt(2)
    v_mul_f32 v120, v120, |v120|
    v_mul_f32 v121, v121, |v121|
    v_mfma_f32_16x16x32_bf16 v[16:19], a[116:119], v[44:47], v[16:19]
    ds_read_b128 v[40:43], v2 offset:12288
    v_mul_f32 v122, v122, |v122|
    v_mfma_f32_16x16x32_bf16 v[12:15], a[112:115], v[44:47], v[12:15]
    v_mul_f32 v123, v123, |v123|
    v_cvt_pk_bf16_f32 v116, v116, v117
    v_mfma_f32_16x16x32_bf16 v[8:11], a[108:111], v[44:47], v[8:11]
    s_waitcnt lgkmcnt(2)
    buffer_load_dwordx4 v1, s[8:11], s33 offen offset:3072 sc1 lds
    v_mfma_f32_16x16x32_bf16 v[8:11], a[120:123], v[48:51], v[8:11]
    ds_read_b128 v[44:47], v2 offset:13312
    s_add_u32 s16, s16, 8192
    v_mfma_f32_16x16x32_bf16 v[12:15], a[124:127], v[48:51], v[12:15]
    s_add_u32 m0, s34, s3
    s_add_u32 s37, s33, s3
    v_cvt_pk_bf16_f32 v118, v118, v119
    v_mfma_f32_16x16x32_bf16 v[16:19], a[128:131], v[48:51], v[16:19]
    s_waitcnt lgkmcnt(2)
    v_cvt_pk_bf16_f32 v120, v120, v121
    v_cvt_pk_bf16_f32 v122, v122, v123
    v_mfma_f32_16x16x32_bf16 v[16:19], a[140:143], v[52:55], v[16:19]
    ds_read_b128 v[48:51], v2 offset:14336
    v_pk_max_i16 v92, v116, 0
    v_mfma_f32_16x16x32_bf16 v[12:15], a[136:139], v[52:55], v[12:15]
    buffer_load_dwordx4 v1, s[8:11], s37 offen offset:0 sc1 lds
    v_mfma_f32_16x16x32_bf16 v[8:11], a[132:135], v[52:55], v[8:11]
    s_waitcnt vmcnt(6) lgkmcnt(2)
    s_barrier
    v_mfma_f32_16x16x32_bf16 v[8:11], a[144:147], v[40:43], v[8:11]
    ds_read_b128 v[52:55], v2 offset:15360
    v_pk_max_i16 v93, v118, 0
    v_mfma_f32_16x16x32_bf16 v[12:15], a[148:151], v[40:43], v[12:15]
    v_pk_max_i16 v94, v120, 0
    v_pk_max_i16 v95, v122, 0
    v_mfma_f32_16x16x32_bf16 v[16:19], a[152:155], v[40:43], v[16:19]
    s_waitcnt lgkmcnt(2)
    buffer_store_dwordx4 v[92:95], v1, s[12:15], s36 offen sc1
    v_add_u32 v3, s35, v1
    v_mfma_f32_16x16x32_bf16 v[16:19], a[164:167], v[44:47], v[16:19]
    ds_read_b128 v[40:43], v2 offset:16384
    v_sub_u32 v100, v2, v20
    v_mfma_f32_16x16x32_bf16 v[12:15], a[160:163], v[44:47], v[12:15]
    s_add_u32 s36, s36, 116736
    ds_read2st64_b64 v[112:115], v100 offset0:70 offset1:71
    v_mfma_f32_16x16x32_bf16 v[8:11], a[156:159], v[44:47], v[8:11]
    s_waitcnt lgkmcnt(3)
    ds_read2st64_b64 v[108:111], v100 offset0:68 offset1:69
    v_mfma_f32_16x16x32_bf16 v[8:11], a[168:171], v[48:51], v[8:11]
    ds_read_b128 v[44:47], v2 offset:17408
    v_mfma_f32_16x16x32_bf16 v[12:15], a[172:175], v[48:51], v[12:15]
    buffer_load_dwordx4 v1, s[8:11], s37 offen offset:1024 sc1 lds
    v_mfma_f32_16x16x32_bf16 v[16:19], a[176:179], v[48:51], v[16:19]
    s_waitcnt lgkmcnt(4)
    ds_read2st64_b64 v[104:107], v100 offset0:66 offset1:67
    v_mfma_f32_16x16x32_bf16 v[16:19], a[188:191], v[52:55], v[16:19]
    ds_read_b128 v[48:51], v2 offset:18432
    v_mfma_f32_16x16x32_bf16 v[12:15], a[184:187], v[52:55], v[12:15]
    ds_read2st64_b64 v[100:103], v100 offset0:64 offset1:65
    v_mfma_f32_16x16x32_bf16 v[8:11], a[180:183], v[52:55], v[8:11]
    s_waitcnt lgkmcnt(6)
    buffer_load_dwordx4 v1, s[8:11], s37 offen offset:2048 sc1 lds
    v_mfma_f32_16x16x32_bf16 v[8:11], a[192:195], v[40:43], v[8:11]
    ds_read_b128 v[52:55], v2 offset:19456
    v_mfma_f32_16x16x32_bf16 v[12:15], a[196:199], v[40:43], v[12:15]
    v_mfma_f32_16x16x32_bf16 v[16:19], a[200:203], v[40:43], v[16:19]
    s_waitcnt lgkmcnt(4)
    v_mfma_f32_16x16x32_bf16 v[16:19], a[212:215], v[44:47], v[16:19]
    ds_read_b128 v[40:43], v2 offset:20480
    v_mfma_f32_16x16x32_bf16 v[12:15], a[208:211], v[44:47], v[12:15]
    buffer_load_dwordx4 v1, s[8:11], s37 offen offset:3072 sc1 lds
    v_mfma_f32_16x16x32_bf16 v[8:11], a[204:207], v[44:47], v[8:11]
    s_waitcnt lgkmcnt(3)
    s_add_u32 m0, s34, s41
    s_add_u32 s37, s33, s41
    v_mfma_f32_16x16x32_bf16 v[8:11], a[216:219], v[48:51], v[8:11]
    ds_read_b128 v[44:47], v2 offset:21504
    s_waitcnt lgkmcnt(3)
    v_mfma_f32_16x16x32_bf16 v[12:15], a[220:223], v[48:51], v[12:15]
    v_add_f32 v100, v100, v108
    v_add_f32 v101, v101, v109
    v_mfma_f32_16x16x32_bf16 v[16:19], a[224:227], v[48:51], v[16:19]
    s_waitcnt lgkmcnt(2)
    buffer_load_dwordx4 v1, s[8:11], s37 offen offset:0 sc1 lds
    v_mfma_f32_16x16x32_bf16 v[16:19], a[236:239], v[52:55], v[16:19]
    ds_read_b128 v[48:51], v2 offset:22528
    s_add_u32 s32, s32, 1
    v_mfma_f32_16x16x32_bf16 v[12:15], a[232:235], v[52:55], v[12:15]
    s_add_u32 s33, s33, 36864
    s_add_u32 s34, s34, 36864
    v_add_f32 v102, v102, v110
    v_mfma_f32_16x16x32_bf16 v[8:11], a[228:231], v[52:55], v[8:11]
    s_waitcnt lgkmcnt(2)
    s_cmp_ge_u32 s34, 147456
    s_cselect_b32 s38, 147456, 0
    v_mfma_f32_16x16x32_bf16 v[8:11], a[240:243], v[40:43], v[8:11]
    ds_read_b128 v[52:55], v2 offset:23552
    s_sub_u32 s34, s34, s38
    v_mfma_f32_16x16x32_bf16 v[12:15], a[244:247], v[40:43], v[12:15]
    buffer_load_dword v5, v4, s[4:7], s16 offen sc1
    v_mfma_f32_16x16x32_bf16 v[16:19], a[248:251], v[40:43], v[16:19]
    s_waitcnt lgkmcnt(2)
    v_add_f32 v103, v103, v111
    v_add_f32 v104, v104, v112
    v_mfma_f32_16x16x32_bf16 v[16:19], v[132:135], v[44:47], v[16:19]
    ds_read_b128 v[40:43], v2 offset:24576
    v_add_f32 v105, v105, v113
    v_mfma_f32_16x16x32_bf16 v[12:15], v[128:131], v[44:47], v[12:15]
    v_add_f32 v106, v106, v114
    v_add_f32 v107, v107, v115
    v_mfma_f32_16x16x32_bf16 v[8:11], a[252:255], v[44:47], v[8:11]
    s_waitcnt lgkmcnt(2)
    v_add_f32 v100, v100, v104
    v_add_f32 v101, v101, v105
    v_mfma_f32_16x16x32_bf16 v[8:11], v[136:139], v[48:51], v[8:11]
    ds_read_b128 v[44:47], v2 offset:25600
    v_add_f32 v102, v102, v106
    v_mfma_f32_16x16x32_bf16 v[12:15], v[140:143], v[48:51], v[12:15]
    v_add_f32 v103, v103, v107
    v_add_f32 v100, v100, v102
    v_mfma_f32_16x16x32_bf16 v[16:19], v[144:147], v[48:51], v[16:19]
    s_waitcnt lgkmcnt(2)
    v_add_f32 v101, v101, v103
    v_mfma_f32_16x16x32_bf16 v[16:19], v[156:159], v[52:55], v[16:19]
    ds_read_b128 v[48:51], v2 offset:26624
    v_mfma_f32_16x16x32_bf16 v[12:15], v[152:155], v[52:55], v[12:15]
    v_permlane16_swap_b32 v100, v101
    v_mfma_f32_16x16x32_bf16 v[8:11], v[148:151], v[52:55], v[8:11]
    s_waitcnt lgkmcnt(2)
    v_add_f32 v100, v100, v101
    v_mov_b32 v101, v100
    v_mfma_f32_16x16x32_bf16 v[8:11], v[160:163], v[40:43], v[8:11]
    ds_read_b128 v[52:55], v2 offset:27648
    v_mfma_f32_16x16x32_bf16 v[12:15], v[164:167], v[40:43], v[12:15]
    v_permlane32_swap_b32 v100, v101
    v_mfma_f32_16x16x32_bf16 v[16:19], v[168:171], v[40:43], v[16:19]
    s_waitcnt lgkmcnt(2)
    v_add_f32 v100, v100, v101
    v_mul_f32 v100, 0x3a800000, v100
    v_mfma_f32_16x16x32_bf16 v[16:19], v[180:183], v[44:47], v[16:19]
    ds_read_b128 v[40:43], v2 offset:28672
    v_mov_b32 v101, v100
    v_mfma_f32_16x16x32_bf16 v[12:15], v[176:179], v[44:47], v[12:15]
    v_mfma_f32_16x16x32_bf16 v[8:11], v[172:175], v[44:47], v[8:11]
    s_waitcnt lgkmcnt(2)
    v_permlane16_swap_b32 v100, v101
    v_mfma_f32_16x16x32_bf16 v[8:11], v[184:187], v[48:51], v[8:11]
    ds_read_b128 v[44:47], v2 offset:29696
    v_fma_f32 v101, -v100, v100, v101
    v_mfma_f32_16x16x32_bf16 v[12:15], v[188:191], v[48:51], v[12:15]
    v_max_f32 v101, 0, v101
    v_add_f32 v101, 0x3727c5ac, v101
    v_mfma_f32_16x16x32_bf16 v[16:19], v[192:195], v[48:51], v[16:19]
    s_waitcnt vmcnt(5) lgkmcnt(2)
    buffer_store_dword v6, v22, s[12:15], s17 offen sc1
    v_mfma_f32_16x16x32_bf16 v[16:19], v[204:207], v[52:55], v[16:19]
    ds_read_b128 v[48:51], v2 offset:30720
    s_mov_b32 s14, s6
    v_mfma_f32_16x16x32_bf16 v[12:15], v[200:203], v[52:55], v[12:15]
    s_add_u32 s17, s17, 8192
    v_rsq_f32 v21, v101
    v_mfma_f32_16x16x32_bf16 v[8:11], v[196:199], v[52:55], v[8:11]
    s_waitcnt lgkmcnt(2)
    s_barrier
    v_mfma_f32_16x16x32_bf16 v[8:11], v[208:211], v[40:43], v[8:11]
    ds_read_b128 v[52:55], v2 offset:31744
    v_mul_f32 v100, v100, v21
    v_mfma_f32_16x16x32_bf16 v[12:15], v[212:215], v[40:43], v[12:15]
    v_fma_f32 v80, -v100, v56, v68
    v_fma_f32 v81, -v100, v57, v69
    v_mfma_f32_16x16x32_bf16 v[16:19], v[216:219], v[40:43], v[16:19]
    s_waitcnt lgkmcnt(2)
    v_fma_f32 v82, -v100, v58, v70
    v_fma_f32 v83, -v100, v59, v71
    v_mfma_f32_16x16x32_bf16 v[16:19], v[228:231], v[44:47], v[16:19]
    ds_read_b128 v[40:43], v3 offset:0
    v_fma_f32 v84, -v100, v60, v72
    v_mfma_f32_16x16x32_bf16 v[12:15], v[224:227], v[44:47], v[12:15]
    v_fma_f32 v85, -v100, v61, v73
    v_fma_f32 v86, -v100, v62, v74
    v_mfma_f32_16x16x32_bf16 v[8:11], v[220:223], v[44:47], v[8:11]
    s_waitcnt lgkmcnt(2)
    v_fma_f32 v87, -v100, v63, v75
    v_fma_f32 v88, -v100, v64, v76
    v_mfma_f32_16x16x32_bf16 v[8:11], v[232:235], v[48:51], v[8:11]
    ds_read_b128 v[44:47], v3 offset:1024
    v_fma_f32 v89, -v100, v65, v77
    v_mfma_f32_16x16x32_bf16 v[12:15], v[236:239], v[48:51], v[12:15]
    v_fma_f32 v90, -v100, v66, v78
    v_fma_f32 v91, -v100, v67, v79
    v_mfma_f32_16x16x32_bf16 v[16:19], v[240:243], v[48:51], v[16:19]
    s_waitcnt lgkmcnt(2)
    v_mfma_f32_16x16x32_bf16 v[16:19], v[252:255], v[52:55], v[16:19]
    ds_read_b128 v[48:51], v3 offset:2048
    v_mfma_f32_16x16x32_bf16 v[12:15], v[248:251], v[52:55], v[12:15]
    v_mfma_f32_16x16x32_bf16 v[8:11], v[244:247], v[52:55], v[8:11]
Lffa_body10:
    s_waitcnt lgkmcnt(2)
    v_mfma_f32_16x16x32_bf16 v[24:27], a[0:3], v[40:43], 0
    ds_read_b128 v[52:55], v3 offset:3072
    s_add_u32 m0, s34, 0
    v_mfma_f32_16x16x32_bf16 v[28:31], a[4:7], v[40:43], 0
    s_add_u32 s31, s31, 1
    v_mov_b32 v6, s31
    v_fma_f32 v124, v16, v21, v88
    v_mfma_f32_16x16x32_bf16 v[32:35], a[8:11], v[40:43], 0
    s_waitcnt lgkmcnt(2)
    v_fma_f32 v125, v17, v21, v89
    v_fma_f32 v126, v18, v21, v90
    v_mfma_f32_16x16x32_bf16 v[32:35], a[20:23], v[44:47], v[32:35]
    ds_read_b128 v[40:43], v3 offset:4096
    v_fma_f32 v127, v19, v21, v91
    v_mfma_f32_16x16x32_bf16 v[28:31], a[16:19], v[44:47], v[28:31]
    s_add_u32 s35, s35, 36864
    v_mul_f32 v124, v124, |v124|
    v_mul_f32 v125, v125, |v125|
    v_mfma_f32_16x16x32_bf16 v[24:27], a[12:15], v[44:47], v[24:27]
    s_waitcnt lgkmcnt(2)
    v_mul_f32 v126, v126, |v126|
    v_mul_f32 v127, v127, |v127|
    v_mfma_f32_16x16x32_bf16 v[24:27], a[24:27], v[48:51], v[24:27]
    ds_read_b128 v[44:47], v3 offset:5120
    v_cvt_pk_bf16_f32 v124, v124, v125
    v_mfma_f32_16x16x32_bf16 v[28:31], a[28:31], v[48:51], v[28:31]
    s_cmp_eq_u32 s35, 147456
    s_cselect_b32 s35, 0, s35
    v_cvt_pk_bf16_f32 v126, v126, v127
    v_mfma_f32_16x16x32_bf16 v[32:35], a[32:35], v[48:51], v[32:35]
    s_waitcnt vmcnt(1) lgkmcnt(2)
    v_cmp_gt_i32 vcc, s32, v5
    v_pk_max_i16 v96, v124, 0
    v_mfma_f32_16x16x32_bf16 v[32:35], a[44:47], v[52:55], v[32:35]
    ds_read_b128 v[48:51], v3 offset:6144
    v_pk_max_i16 v97, v126, 0
    v_mfma_f32_16x16x32_bf16 v[28:31], a[40:43], v[52:55], v[28:31]
    s_and_b64 vcc, vcc, s[18:19]
    s_cbranch_scc1 Lffa_v11
    v_mfma_f32_16x16x32_bf16 v[24:27], a[36:39], v[52:55], v[24:27]
    s_waitcnt lgkmcnt(2)
    buffer_load_dwordx4 v1, s[8:11], s33 offen offset:0 sc1 lds
    v_mfma_f32_16x16x32_bf16 v[24:27], a[48:51], v[40:43], v[24:27]
    ds_read_b128 v[52:55], v3 offset:7168
    v_pk_max_i16 v98, v124, 0
    v_mfma_f32_16x16x32_bf16 v[28:31], a[52:55], v[40:43], v[28:31]
    v_pk_max_i16 v99, v126, 0
    v_fma_f32 v116, v8, v21, v80
    v_mfma_f32_16x16x32_bf16 v[32:35], a[56:59], v[40:43], v[32:35]
    s_waitcnt lgkmcnt(2)
    v_permlane32_swap_b32 v96, v98
    v_mfma_f32_16x16x32_bf16 v[32:35], a[68:71], v[44:47], v[32:35]
    ds_read_b128 v[40:43], v3 offset:8192
    v_fma_f32 v117, v9, v21, v81
    v_mfma_f32_16x16x32_bf16 v[28:31], a[64:67], v[44:47], v[28:31]
    buffer_load_dwordx4 v1, s[8:11], s33 offen offset:1024 sc1 lds
    v_mfma_f32_16x16x32_bf16 v[24:27], a[60:63], v[44:47], v[24:27]
    s_waitcnt lgkmcnt(2)
    v_permlane32_swap_b32 v97, v99
    v_mfma_f32_16x16x32_bf16 v[24:27], a[72:75], v[48:51], v[24:27]
    ds_read_b128 v[44:47], v3 offset:9216
    v_fma_f32 v118, v10, v21, v82
    v_mfma_f32_16x16x32_bf16 v[28:31], a[76:79], v[48:51], v[28:31]
    v_fma_f32 v119, v11, v21, v83
    v_fma_f32 v120, v12, v21, v84
    v_mfma_f32_16x16x32_bf16 v[32:35], a[80:83], v[48:51], v[32:35]
    s_waitcnt lgkmcnt(2)
    buffer_store_dwordx4 v[96:99], v7, s[12:15], s36 offen sc1
    v_fma_f32 v121, v13, v21, v85
    v_mfma_f32_16x16x32_bf16 v[32:35], a[92:95], v[52:55], v[32:35]
    ds_read_b128 v[48:51], v3 offset:10240
    v_fma_f32 v122, v14, v21, v86
    v_mfma_f32_16x16x32_bf16 v[28:31], a[88:91], v[52:55], v[28:31]
    v_fma_f32 v123, v15, v21, v87
    v_mul_f32 v116, v116, |v116|
    v_mfma_f32_16x16x32_bf16 v[24:27], a[84:87], v[52:55], v[24:27]
    s_waitcnt lgkmcnt(2)
    v_mul_f32 v117, v117, |v117|
    v_mul_f32 v118, v118, |v118|
    v_mfma_f32_16x16x32_bf16 v[24:27], a[96:99], v[40:43], v[24:27]
    ds_read_b128 v[52:55], v3 offset:11264
    v_mul_f32 v119, v119, |v119|
    v_mfma_f32_16x16x32_bf16 v[28:31], a[100:103], v[40:43], v[28:31]
    buffer_load_dwordx4 v1, s[8:11], s33 offen offset:2048 sc1 lds
    v_mfma_f32_16x16x32_bf16 v[32:35], a[104:107], v[40:43], v[32:35]
    s_waitcnt lgkmcnt(2)
    v_mul_f32 v120, v120, |v120|
    v_mul_f32 v121, v121, |v121|
    v_mfma_f32_16x16x32_bf16 v[32:35], a[116:119], v[44:47], v[32:35]
    ds_read_b128 v[40:43], v3 offset:12288
    v_mul_f32 v122, v122, |v122|
    v_mfma_f32_16x16x32_bf16 v[28:31], a[112:115], v[44:47], v[28:31]
    v_mul_f32 v123, v123, |v123|
    v_cvt_pk_bf16_f32 v116, v116, v117
    v_mfma_f32_16x16x32_bf16 v[24:27], a[108:111], v[44:47], v[24:27]
    s_waitcnt lgkmcnt(2)
    buffer_load_dwordx4 v1, s[8:11], s33 offen offset:3072 sc1 lds
    v_mfma_f32_16x16x32_bf16 v[24:27], a[120:123], v[48:51], v[24:27]
    ds_read_b128 v[44:47], v3 offset:13312
    s_add_u32 s16, s16, 8192
    v_mfma_f32_16x16x32_bf16 v[28:31], a[124:127], v[48:51], v[28:31]
    s_add_u32 m0, s34, s3
    s_add_u32 s37, s33, s3
    v_cvt_pk_bf16_f32 v118, v118, v119
    v_mfma_f32_16x16x32_bf16 v[32:35], a[128:131], v[48:51], v[32:35]
    s_waitcnt lgkmcnt(2)
    v_cvt_pk_bf16_f32 v120, v120, v121
    v_cvt_pk_bf16_f32 v122, v122, v123
    v_mfma_f32_16x16x32_bf16 v[32:35], a[140:143], v[52:55], v[32:35]
    ds_read_b128 v[48:51], v3 offset:14336
    v_pk_max_i16 v92, v116, 0
    v_mfma_f32_16x16x32_bf16 v[28:31], a[136:139], v[52:55], v[28:31]
    buffer_load_dwordx4 v1, s[8:11], s37 offen offset:0 sc1 lds
    v_mfma_f32_16x16x32_bf16 v[24:27], a[132:135], v[52:55], v[24:27]
    s_waitcnt vmcnt(6) lgkmcnt(2)
    s_barrier
    v_mfma_f32_16x16x32_bf16 v[24:27], a[144:147], v[40:43], v[24:27]
    ds_read_b128 v[52:55], v3 offset:15360
    v_pk_max_i16 v93, v118, 0
    v_mfma_f32_16x16x32_bf16 v[28:31], a[148:151], v[40:43], v[28:31]
    v_pk_max_i16 v94, v120, 0
    v_pk_max_i16 v95, v122, 0
    v_mfma_f32_16x16x32_bf16 v[32:35], a[152:155], v[40:43], v[32:35]
    s_waitcnt lgkmcnt(2)
    buffer_store_dwordx4 v[92:95], v1, s[12:15], s36 offen sc1
    v_add_u32 v2, s35, v1
    v_mfma_f32_16x16x32_bf16 v[32:35], a[164:167], v[44:47], v[32:35]
    ds_read_b128 v[40:43], v3 offset:16384
    v_sub_u32 v100, v3, v20
    v_mfma_f32_16x16x32_bf16 v[28:31], a[160:163], v[44:47], v[28:31]
    s_add_u32 s36, s36, 116736
    ds_read2st64_b64 v[112:115], v100 offset0:70 offset1:71
    v_mfma_f32_16x16x32_bf16 v[24:27], a[156:159], v[44:47], v[24:27]
    s_waitcnt lgkmcnt(3)
    ds_read2st64_b64 v[108:111], v100 offset0:68 offset1:69
    v_mfma_f32_16x16x32_bf16 v[24:27], a[168:171], v[48:51], v[24:27]
    ds_read_b128 v[44:47], v3 offset:17408
    v_mfma_f32_16x16x32_bf16 v[28:31], a[172:175], v[48:51], v[28:31]
    buffer_load_dwordx4 v1, s[8:11], s37 offen offset:1024 sc1 lds
    v_mfma_f32_16x16x32_bf16 v[32:35], a[176:179], v[48:51], v[32:35]
    s_waitcnt lgkmcnt(4)
    ds_read2st64_b64 v[104:107], v100 offset0:66 offset1:67
    v_mfma_f32_16x16x32_bf16 v[32:35], a[188:191], v[52:55], v[32:35]
    ds_read_b128 v[48:51], v3 offset:18432
    v_mfma_f32_16x16x32_bf16 v[28:31], a[184:187], v[52:55], v[28:31]
    ds_read2st64_b64 v[100:103], v100 offset0:64 offset1:65
    v_mfma_f32_16x16x32_bf16 v[24:27], a[180:183], v[52:55], v[24:27]
    s_waitcnt lgkmcnt(6)
    buffer_load_dwordx4 v1, s[8:11], s37 offen offset:2048 sc1 lds
    v_mfma_f32_16x16x32_bf16 v[24:27], a[192:195], v[40:43], v[24:27]
    ds_read_b128 v[52:55], v3 offset:19456
    v_mfma_f32_16x16x32_bf16 v[28:31], a[196:199], v[40:43], v[28:31]
    v_mfma_f32_16x16x32_bf16 v[32:35], a[200:203], v[40:43], v[32:35]
    s_waitcnt lgkmcnt(4)
    v_mfma_f32_16x16x32_bf16 v[32:35], a[212:215], v[44:47], v[32:35]
    ds_read_b128 v[40:43], v3 offset:20480
    v_mfma_f32_16x16x32_bf16 v[28:31], a[208:211], v[44:47], v[28:31]
    buffer_load_dwordx4 v1, s[8:11], s37 offen offset:3072 sc1 lds
    v_mfma_f32_16x16x32_bf16 v[24:27], a[204:207], v[44:47], v[24:27]
    s_waitcnt lgkmcnt(3)
    s_add_u32 m0, s34, s41
    s_add_u32 s37, s33, s41
    v_mfma_f32_16x16x32_bf16 v[24:27], a[216:219], v[48:51], v[24:27]
    ds_read_b128 v[44:47], v3 offset:21504
    s_waitcnt lgkmcnt(3)
    v_mfma_f32_16x16x32_bf16 v[28:31], a[220:223], v[48:51], v[28:31]
    v_add_f32 v100, v100, v108
    v_add_f32 v101, v101, v109
    v_mfma_f32_16x16x32_bf16 v[32:35], a[224:227], v[48:51], v[32:35]
    s_waitcnt lgkmcnt(2)
    buffer_load_dwordx4 v1, s[8:11], s37 offen offset:0 sc1 lds
    v_mfma_f32_16x16x32_bf16 v[32:35], a[236:239], v[52:55], v[32:35]
    ds_read_b128 v[48:51], v3 offset:22528
    s_add_u32 s32, s32, 1
    v_mfma_f32_16x16x32_bf16 v[28:31], a[232:235], v[52:55], v[28:31]
    s_add_u32 s33, s33, 36864
    s_add_u32 s34, s34, 36864
    v_add_f32 v102, v102, v110
    v_mfma_f32_16x16x32_bf16 v[24:27], a[228:231], v[52:55], v[24:27]
    s_waitcnt lgkmcnt(2)
    s_cmp_ge_u32 s34, 147456
    s_cselect_b32 s38, 147456, 0
    v_mfma_f32_16x16x32_bf16 v[24:27], a[240:243], v[40:43], v[24:27]
    ds_read_b128 v[52:55], v3 offset:23552
    s_sub_u32 s34, s34, s38
    v_mfma_f32_16x16x32_bf16 v[28:31], a[244:247], v[40:43], v[28:31]
    buffer_load_dword v5, v4, s[4:7], s16 offen sc1
    v_mfma_f32_16x16x32_bf16 v[32:35], a[248:251], v[40:43], v[32:35]
    s_waitcnt lgkmcnt(2)
    v_add_f32 v103, v103, v111
    v_add_f32 v104, v104, v112
    v_mfma_f32_16x16x32_bf16 v[32:35], v[132:135], v[44:47], v[32:35]
    ds_read_b128 v[40:43], v3 offset:24576
    v_add_f32 v105, v105, v113
    v_mfma_f32_16x16x32_bf16 v[28:31], v[128:131], v[44:47], v[28:31]
    v_add_f32 v106, v106, v114
    v_add_f32 v107, v107, v115
    v_mfma_f32_16x16x32_bf16 v[24:27], a[252:255], v[44:47], v[24:27]
    s_waitcnt lgkmcnt(2)
    v_add_f32 v100, v100, v104
    v_add_f32 v101, v101, v105
    v_mfma_f32_16x16x32_bf16 v[24:27], v[136:139], v[48:51], v[24:27]
    ds_read_b128 v[44:47], v3 offset:25600
    v_add_f32 v102, v102, v106
    v_mfma_f32_16x16x32_bf16 v[28:31], v[140:143], v[48:51], v[28:31]
    v_add_f32 v103, v103, v107
    v_add_f32 v100, v100, v102
    v_mfma_f32_16x16x32_bf16 v[32:35], v[144:147], v[48:51], v[32:35]
    s_waitcnt lgkmcnt(2)
    v_add_f32 v101, v101, v103
    v_mfma_f32_16x16x32_bf16 v[32:35], v[156:159], v[52:55], v[32:35]
    ds_read_b128 v[48:51], v3 offset:26624
    v_mfma_f32_16x16x32_bf16 v[28:31], v[152:155], v[52:55], v[28:31]
    v_permlane16_swap_b32 v100, v101
    v_mfma_f32_16x16x32_bf16 v[24:27], v[148:151], v[52:55], v[24:27]
    s_waitcnt lgkmcnt(2)
    v_add_f32 v100, v100, v101
    v_mov_b32 v101, v100
    v_mfma_f32_16x16x32_bf16 v[24:27], v[160:163], v[40:43], v[24:27]
    ds_read_b128 v[52:55], v3 offset:27648
    v_mfma_f32_16x16x32_bf16 v[28:31], v[164:167], v[40:43], v[28:31]
    v_permlane32_swap_b32 v100, v101
    v_mfma_f32_16x16x32_bf16 v[32:35], v[168:171], v[40:43], v[32:35]
    s_waitcnt lgkmcnt(2)
    v_add_f32 v100, v100, v101
    v_mul_f32 v100, 0x3a800000, v100
    v_mfma_f32_16x16x32_bf16 v[32:35], v[180:183], v[44:47], v[32:35]
    ds_read_b128 v[40:43], v3 offset:28672
    v_mov_b32 v101, v100
    v_mfma_f32_16x16x32_bf16 v[28:31], v[176:179], v[44:47], v[28:31]
    v_mfma_f32_16x16x32_bf16 v[24:27], v[172:175], v[44:47], v[24:27]
    s_waitcnt lgkmcnt(2)
    v_permlane16_swap_b32 v100, v101
    v_mfma_f32_16x16x32_bf16 v[24:27], v[184:187], v[48:51], v[24:27]
    ds_read_b128 v[44:47], v3 offset:29696
    v_fma_f32 v101, -v100, v100, v101
    v_mfma_f32_16x16x32_bf16 v[28:31], v[188:191], v[48:51], v[28:31]
    v_max_f32 v101, 0, v101
    v_add_f32 v101, 0x3727c5ac, v101
    v_mfma_f32_16x16x32_bf16 v[32:35], v[192:195], v[48:51], v[32:35]
    s_waitcnt vmcnt(5) lgkmcnt(2)
    buffer_store_dword v6, v22, s[12:15], s17 offen sc1
    v_mfma_f32_16x16x32_bf16 v[32:35], v[204:207], v[52:55], v[32:35]
    ds_read_b128 v[48:51], v3 offset:30720
    s_mov_b32 s14, s6
    v_mfma_f32_16x16x32_bf16 v[28:31], v[200:203], v[52:55], v[28:31]
    s_add_u32 s17, s17, 8192
    v_rsq_f32 v21, v101
    v_mfma_f32_16x16x32_bf16 v[24:27], v[196:199], v[52:55], v[24:27]
    s_waitcnt lgkmcnt(2)
    s_barrier
    v_mfma_f32_16x16x32_bf16 v[24:27], v[208:211], v[40:43], v[24:27]
    ds_read_b128 v[52:55], v3 offset:31744
    v_mul_f32 v100, v100, v21
    v_mfma_f32_16x16x32_bf16 v[28:31], v[212:215], v[40:43], v[28:31]
    v_fma_f32 v80, -v100, v56, v68
    v_fma_f32 v81, -v100, v57, v69
    v_mfma_f32_16x16x32_bf16 v[32:35], v[216:219], v[40:43], v[32:35]
    s_waitcnt lgkmcnt(2)
    v_fma_f32 v82, -v100, v58, v70
    v_fma_f32 v83, -v100, v59, v71
    v_mfma_f32_16x16x32_bf16 v[32:35], v[228:231], v[44:47], v[32:35]
    ds_read_b128 v[40:43], v2 offset:0
    v_fma_f32 v84, -v100, v60, v72
    v_mfma_f32_16x16x32_bf16 v[28:31], v[224:227], v[44:47], v[28:31]
    v_fma_f32 v85, -v100, v61, v73
    v_fma_f32 v86, -v100, v62, v74
    v_mfma_f32_16x16x32_bf16 v[24:27], v[220:223], v[44:47], v[24:27]
    s_waitcnt lgkmcnt(2)
    v_fma_f32 v87, -v100, v63, v75
    v_fma_f32 v88, -v100, v64, v76
    v_mfma_f32_16x16x32_bf16 v[24:27], v[232:235], v[48:51], v[24:27]
    ds_read_b128 v[44:47], v2 offset:1024
    v_fma_f32 v89, -v100, v65, v77
    v_mfma_f32_16x16x32_bf16 v[28:31], v[236:239], v[48:51], v[28:31]
    v_fma_f32 v90, -v100, v66, v78
    v_fma_f32 v91, -v100, v67, v79
    v_mfma_f32_16x16x32_bf16 v[32:35], v[240:243], v[48:51], v[32:35]
    s_waitcnt lgkmcnt(2)
    v_mfma_f32_16x16x32_bf16 v[32:35], v[252:255], v[52:55], v[32:35]
    ds_read_b128 v[48:51], v2 offset:2048
    v_mfma_f32_16x16x32_bf16 v[28:31], v[248:251], v[52:55], v[28:31]
    v_mfma_f32_16x16x32_bf16 v[24:27], v[244:247], v[52:55], v[24:27]
    s_cmp_lt_i32 s31, 63
    s_cbranch_scc1 Lffa_body00
    s_branch L_exit
Lffa_v01:
    v_mfma_f32_16x16x32_bf16 v[8:11], a[36:39], v[52:55], v[8:11]
    s_waitcnt lgkmcnt(2)
    buffer_load_dword v5, v4, s[4:7], s16 offen sc1
    v_mfma_f32_16x16x32_bf16 v[8:11], a[48:51], v[40:43], v[8:11]
    ds_read_b128 v[52:55], v2 offset:7168
    v_pk_max_i16 v98, v124, 0
    v_mfma_f32_16x16x32_bf16 v[12:15], a[52:55], v[40:43], v[12:15]
    v_pk_max_i16 v99, v126, 0
    v_fma_f32 v116, v24, v21, v80
    v_mfma_f32_16x16x32_bf16 v[16:19], a[56:59], v[40:43], v[16:19]
    s_waitcnt lgkmcnt(2)
    v_permlane32_swap_b32 v96, v98
    v_mfma_f32_16x16x32_bf16 v[16:19], a[68:71], v[44:47], v[16:19]
    ds_read_b128 v[40:43], v2 offset:8192
    v_fma_f32 v117, v25, v21, v81
    v_mfma_f32_16x16x32_bf16 v[12:15], a[64:67], v[44:47], v[12:15]
    v_permlane32_swap_b32 v97, v99
    v_mfma_f32_16x16x32_bf16 v[8:11], a[60:63], v[44:47], v[8:11]
    s_waitcnt lgkmcnt(2)
    buffer_store_dwordx4 v[96:99], v7, s[12:15], s36 offen sc1
    v_fma_f32 v118, v26, v21, v82
    v_mfma_f32_16x16x32_bf16 v[8:11], a[72:75], v[48:51], v[8:11]
    ds_read_b128 v[44:47], v2 offset:9216
    v_fma_f32 v119, v27, v21, v83
    v_mfma_f32_16x16x32_bf16 v[12:15], a[76:79], v[48:51], v[12:15]
    v_fma_f32 v120, v28, v21, v84
    v_fma_f32 v121, v29, v21, v85
    v_mfma_f32_16x16x32_bf16 v[16:19], a[80:83], v[48:51], v[16:19]
    s_waitcnt lgkmcnt(2)
    v_fma_f32 v122, v30, v21, v86
    v_fma_f32 v123, v31, v21, v87
    v_mfma_f32_16x16x32_bf16 v[16:19], a[92:95], v[52:55], v[16:19]
    ds_read_b128 v[48:51], v2 offset:10240
    v_mul_f32 v116, v116, |v116|
    v_mfma_f32_16x16x32_bf16 v[12:15], a[88:91], v[52:55], v[12:15]
    v_mul_f32 v117, v117, |v117|
    v_mul_f32 v118, v118, |v118|
    v_mfma_f32_16x16x32_bf16 v[8:11], a[84:87], v[52:55], v[8:11]
    s_waitcnt lgkmcnt(2)
    v_mul_f32 v119, v119, |v119|
    v_mul_f32 v120, v120, |v120|
    v_mfma_f32_16x16x32_bf16 v[8:11], a[96:99], v[40:43], v[8:11]
    ds_read_b128 v[52:55], v2 offset:11264
    v_mul_f32 v121, v121, |v121|
    v_mfma_f32_16x16x32_bf16 v[12:15], a[100:103], v[40:43], v[12:15]
    v_mul_f32 v122, v122, |v122|
    v_mul_f32 v123, v123, |v123|
    v_mfma_f32_16x16x32_bf16 v[16:19], a[104:107], v[40:43], v[16:19]
    s_waitcnt lgkmcnt(2)
    v_cvt_pk_bf16_f32 v116, v116, v117
    v_cvt_pk_bf16_f32 v118, v118, v119
    v_mfma_f32_16x16x32_bf16 v[16:19], a[116:119], v[44:47], v[16:19]
    ds_read_b128 v[40:43], v2 offset:12288
    v_cvt_pk_bf16_f32 v120, v120, v121
    v_mfma_f32_16x16x32_bf16 v[12:15], a[112:115], v[44:47], v[12:15]
    v_cvt_pk_bf16_f32 v122, v122, v123
    v_pk_max_i16 v92, v116, 0
    v_mfma_f32_16x16x32_bf16 v[8:11], a[108:111], v[44:47], v[8:11]
    s_waitcnt lgkmcnt(2)
    v_pk_max_i16 v93, v118, 0
    v_pk_max_i16 v94, v120, 0
    v_mfma_f32_16x16x32_bf16 v[8:11], a[120:123], v[48:51], v[8:11]
    ds_read_b128 v[44:47], v2 offset:13312
    v_pk_max_i16 v95, v122, 0
    v_mfma_f32_16x16x32_bf16 v[12:15], a[124:127], v[48:51], v[12:15]
    s_waitcnt vmcnt(1)
    v_cmp_gt_i32 vcc, s32, v5
    v_add_u32 v3, s35, v1
    v_mfma_f32_16x16x32_bf16 v[16:19], a[128:131], v[48:51], v[16:19]
    s_waitcnt lgkmcnt(2)
    buffer_store_dwordx4 v[92:95], v1, s[12:15], s36 offen sc1
    v_sub_u32 v100, v2, v20
    v_mfma_f32_16x16x32_bf16 v[16:19], a[140:143], v[52:55], v[16:19]
    ds_read_b128 v[48:51], v2 offset:14336
    s_add_u32 s36, s36, 116736
    v_mfma_f32_16x16x32_bf16 v[12:15], a[136:139], v[52:55], v[12:15]
    s_and_b64 vcc, vcc, s[18:19]
    s_cbranch_scc1 Lffa_v02
    v_mfma_f32_16x16x32_bf16 v[8:11], a[132:135], v[52:55], v[8:11]
    s_waitcnt lgkmcnt(2)
    s_barrier
    v_mfma_f32_16x16x32_bf16 v[8:11], a[144:147], v[40:43], v[8:11]
    ds_read_b128 v[52:55], v2 offset:15360
    v_mfma_f32_16x16x32_bf16 v[12:15], a[148:151], v[40:43], v[12:15]
    buffer_load_dwordx4 v1, s[8:11], s33 offen offset:0 sc1 lds
    v_mfma_f32_16x16x32_bf16 v[16:19], a[152:155], v[40:43], v[16:19]
    s_waitcnt lgkmcnt(2)
    ds_read2st64_b64 v[112:115], v100 offset0:70 offset1:71
    v_mfma_f32_16x16x32_bf16 v[16:19], a[164:167], v[44:47], v[16:19]
    ds_read_b128 v[40:43], v2 offset:16384
    v_mfma_f32_16x16x32_bf16 v[12:15], a[160:163], v[44:47], v[12:15]
    ds_read2st64_b64 v[108:111], v100 offset0:68 offset1:69
    v_mfma_f32_16x16x32_bf16 v[8:11], a[156:159], v[44:47], v[8:11]
    s_waitcnt lgkmcnt(4)
    buffer_load_dwordx4 v1, s[8:11], s33 offen offset:1024 sc1 lds
    v_mfma_f32_16x16x32_bf16 v[8:11], a[168:171], v[48:51], v[8:11]
    ds_read_b128 v[44:47], v2 offset:17408
    v_mfma_f32_16x16x32_bf16 v[12:15], a[172:175], v[48:51], v[12:15]
    ds_read2st64_b64 v[104:107], v100 offset0:66 offset1:67
    v_mfma_f32_16x16x32_bf16 v[16:19], a[176:179], v[48:51], v[16:19]
    s_waitcnt lgkmcnt(5)
    ds_read2st64_b64 v[100:103], v100 offset0:64 offset1:65
    v_mfma_f32_16x16x32_bf16 v[16:19], a[188:191], v[52:55], v[16:19]
    ds_read_b128 v[48:51], v2 offset:18432
    v_mfma_f32_16x16x32_bf16 v[12:15], a[184:187], v[52:55], v[12:15]
    buffer_load_dwordx4 v1, s[8:11], s33 offen offset:2048 sc1 lds
    v_mfma_f32_16x16x32_bf16 v[8:11], a[180:183], v[52:55], v[8:11]
    s_waitcnt lgkmcnt(5)
    v_mfma_f32_16x16x32_bf16 v[8:11], a[192:195], v[40:43], v[8:11]
    ds_read_b128 v[52:55], v2 offset:19456
    v_mfma_f32_16x16x32_bf16 v[12:15], a[196:199], v[40:43], v[12:15]
    v_mfma_f32_16x16x32_bf16 v[16:19], a[200:203], v[40:43], v[16:19]
    s_waitcnt lgkmcnt(4)
    buffer_load_dwordx4 v1, s[8:11], s33 offen offset:3072 sc1 lds
    v_mfma_f32_16x16x32_bf16 v[16:19], a[212:215], v[44:47], v[16:19]
    ds_read_b128 v[40:43], v2 offset:20480
    s_add_u32 s16, s16, 8192
    v_mfma_f32_16x16x32_bf16 v[12:15], a[208:211], v[44:47], v[12:15]
    s_add_u32 m0, s34, s3
    s_add_u32 s37, s33, s3
    s_waitcnt lgkmcnt(3)
    v_mfma_f32_16x16x32_bf16 v[8:11], a[204:207], v[44:47], v[8:11]
    s_waitcnt lgkmcnt(2)
    v_add_f32 v100, v100, v108
    v_add_f32 v101, v101, v109
    v_mfma_f32_16x16x32_bf16 v[8:11], a[216:219], v[48:51], v[8:11]
    ds_read_b128 v[44:47], v2 offset:21504
    v_add_f32 v102, v102, v110
    v_mfma_f32_16x16x32_bf16 v[12:15], a[220:223], v[48:51], v[12:15]
    buffer_load_dwordx4 v1, s[8:11], s37 offen offset:0 sc1 lds
    v_mfma_f32_16x16x32_bf16 v[16:19], a[224:227], v[48:51], v[16:19]
    s_waitcnt lgkmcnt(2)
    v_add_f32 v103, v103, v111
    v_add_f32 v104, v104, v112
    v_mfma_f32_16x16x32_bf16 v[16:19], a[236:239], v[52:55], v[16:19]
    ds_read_b128 v[48:51], v2 offset:22528
    v_add_f32 v105, v105, v113
    v_mfma_f32_16x16x32_bf16 v[12:15], a[232:235], v[52:55], v[12:15]
    v_add_f32 v106, v106, v114
    v_add_f32 v107, v107, v115
    v_mfma_f32_16x16x32_bf16 v[8:11], a[228:231], v[52:55], v[8:11]
    s_waitcnt lgkmcnt(2)
    buffer_load_dword v5, v4, s[4:7], s16 offen sc1
    v_mfma_f32_16x16x32_bf16 v[8:11], a[240:243], v[40:43], v[8:11]
    ds_read_b128 v[52:55], v2 offset:23552
    v_add_f32 v100, v100, v104
    v_mfma_f32_16x16x32_bf16 v[12:15], a[244:247], v[40:43], v[12:15]
    v_add_f32 v101, v101, v105
    v_add_f32 v102, v102, v106
    v_mfma_f32_16x16x32_bf16 v[16:19], a[248:251], v[40:43], v[16:19]
    s_waitcnt lgkmcnt(2)
    v_add_f32 v103, v103, v107
    v_add_f32 v100, v100, v102
    v_mfma_f32_16x16x32_bf16 v[16:19], v[132:135], v[44:47], v[16:19]
    ds_read_b128 v[40:43], v2 offset:24576
    v_add_f32 v101, v101, v103
    v_mfma_f32_16x16x32_bf16 v[12:15], v[128:131], v[44:47], v[12:15]
    buffer_load_dwordx4 v1, s[8:11], s37 offen offset:1024 sc1 lds
    v_mfma_f32_16x16x32_bf16 v[8:11], a[252:255], v[44:47], v[8:11]
    s_waitcnt lgkmcnt(2)
    v_permlane16_swap_b32 v100, v101
    v_mfma_f32_16x16x32_bf16 v[8:11], v[136:139], v[48:51], v[8:11]
    ds_read_b128 v[44:47], v2 offset:25600
    v_add_f32 v100, v100, v101
    v_mfma_f32_16x16x32_bf16 v[12:15], v[140:143], v[48:51], v[12:15]
    v_mov_b32 v101, v100
    v_mfma_f32_16x16x32_bf16 v[16:19], v[144:147], v[48:51], v[16:19]
    s_waitcnt lgkmcnt(2)
    buffer_load_dwordx4 v1, s[8:11], s37 offen offset:2048 sc1 lds
    v_mfma_f32_16x16x32_bf16 v[16:19], v[156:159], v[52:55], v[16:19]
    ds_read_b128 v[48:51], v2 offset:26624
    v_mfma_f32_16x16x32_bf16 v[12:15], v[152:155], v[52:55], v[12:15]
    v_permlane32_swap_b32 v100, v101
    v_mfma_f32_16x16x32_bf16 v[8:11], v[148:151], v[52:55], v[8:11]
    s_waitcnt lgkmcnt(2)
    v_add_f32 v100, v100, v101
    v_mul_f32 v100, 0x3a800000, v100
    v_mfma_f32_16x16x32_bf16 v[8:11], v[160:163], v[40:43], v[8:11]
    ds_read_b128 v[52:55], v2 offset:27648
    v_mov_b32 v101, v100
    v_mfma_f32_16x16x32_bf16 v[12:15], v[164:167], v[40:43], v[12:15]
    buffer_load_dwordx4 v1, s[8:11], s37 offen offset:3072 sc1 lds
    v_mfma_f32_16x16x32_bf16 v[16:19], v[168:171], v[40:43], v[16:19]
    s_waitcnt lgkmcnt(2)
    s_add_u32 m0, s34, s41
    s_add_u32 s37, s33, s41
    v_mfma_f32_16x16x32_bf16 v[16:19], v[180:183], v[44:47], v[16:19]
    ds_read_b128 v[40:43], v2 offset:28672
    s_waitcnt vmcnt(9)
    v_mfma_f32_16x16x32_bf16 v[12:15], v[176:179], v[44:47], v[12:15]
    buffer_store_dword v6, v22, s[12:15], s17 offen sc1
    s_mov_b32 s14, s6
    v_mfma_f32_16x16x32_bf16 v[8:11], v[172:175], v[44:47], v[8:11]
    s_waitcnt lgkmcnt(2)
    buffer_load_dwordx4 v1, s[8:11], s37 offen offset:0 sc1 lds
    v_mfma_f32_16x16x32_bf16 v[8:11], v[184:187], v[48:51], v[8:11]
    ds_read_b128 v[44:47], v2 offset:29696
    s_add_u32 s32, s32, 1
    v_mfma_f32_16x16x32_bf16 v[12:15], v[188:191], v[48:51], v[12:15]
    s_add_u32 s33, s33, 36864
    s_add_u32 s34, s34, 36864
    s_add_u32 s17, s17, 8192
    v_mfma_f32_16x16x32_bf16 v[16:19], v[192:195], v[48:51], v[16:19]
    s_waitcnt lgkmcnt(2)
    s_cmp_ge_u32 s34, 147456
    s_cselect_b32 s38, 147456, 0
    v_mfma_f32_16x16x32_bf16 v[16:19], v[204:207], v[52:55], v[16:19]
    ds_read_b128 v[48:51], v2 offset:30720
    s_sub_u32 s34, s34, s38
    v_mfma_f32_16x16x32_bf16 v[12:15], v[200:203], v[52:55], v[12:15]
    v_permlane16_swap_b32 v100, v101
    v_mfma_f32_16x16x32_bf16 v[8:11], v[196:199], v[52:55], v[8:11]
    s_waitcnt vmcnt(7) lgkmcnt(2)
    s_barrier
    v_mfma_f32_16x16x32_bf16 v[8:11], v[208:211], v[40:43], v[8:11]
    ds_read_b128 v[52:55], v2 offset:31744
    v_fma_f32 v101, -v100, v100, v101
    v_mfma_f32_16x16x32_bf16 v[12:15], v[212:215], v[40:43], v[12:15]
    v_max_f32 v101, 0, v101
    v_add_f32 v101, 0x3727c5ac, v101
    v_mfma_f32_16x16x32_bf16 v[16:19], v[216:219], v[40:43], v[16:19]
    s_waitcnt lgkmcnt(2)
    v_rsq_f32 v21, v101
    v_mfma_f32_16x16x32_bf16 v[16:19], v[228:231], v[44:47], v[16:19]
    ds_read_b128 v[40:43], v3 offset:0
    v_mul_f32 v100, v100, v21
    v_mfma_f32_16x16x32_bf16 v[12:15], v[224:227], v[44:47], v[12:15]
    v_fma_f32 v80, -v100, v56, v68
    v_fma_f32 v81, -v100, v57, v69
    v_mfma_f32_16x16x32_bf16 v[8:11], v[220:223], v[44:47], v[8:11]
    s_waitcnt lgkmcnt(2)
    v_fma_f32 v82, -v100, v58, v70
    v_fma_f32 v83, -v100, v59, v71
    v_mfma_f32_16x16x32_bf16 v[8:11], v[232:235], v[48:51], v[8:11]
    ds_read_b128 v[44:47], v3 offset:1024
    v_fma_f32 v84, -v100, v60, v72
    v_mfma_f32_16x16x32_bf16 v[12:15], v[236:239], v[48:51], v[12:15]
    v_fma_f32 v85, -v100, v61, v73
    v_fma_f32 v86, -v100, v62, v74
    v_mfma_f32_16x16x32_bf16 v[16:19], v[240:243], v[48:51], v[16:19]
    s_waitcnt lgkmcnt(2)
    v_fma_f32 v87, -v100, v63, v75
    v_fma_f32 v88, -v100, v64, v76
    v_mfma_f32_16x16x32_bf16 v[16:19], v[252:255], v[52:55], v[16:19]
    ds_read_b128 v[48:51], v3 offset:2048
    v_fma_f32 v89, -v100, v65, v77
    v_mfma_f32_16x16x32_bf16 v[12:15], v[248:251], v[52:55], v[12:15]
    v_fma_f32 v90, -v100, v66, v78
    v_fma_f32 v91, -v100, v67, v79
    v_mfma_f32_16x16x32_bf16 v[8:11], v[244:247], v[52:55], v[8:11]
    s_cmp_ge_i32 s31, 63
    s_cbranch_scc1 L_exit
    s_cmp_eq_u32 s30, 1
    s_cbranch_scc1 Lffa_body11
    s_cmp_eq_u32 s30, 2
    s_cbranch_scc1 Lffa_body12
    s_cmp_eq_u32 s30, 3
    s_cbranch_scc1 Lffa_body13
    s_branch Lffa_body10
Lffa_v02:
    v_mfma_f32_16x16x32_bf16 v[8:11], a[132:135], v[52:55], v[8:11]
    s_waitcnt lgkmcnt(2)
    s_barrier
    v_mfma_f32_16x16x32_bf16 v[8:11], a[144:147], v[40:43], v[8:11]
    ds_read_b128 v[52:55], v2 offset:15360
    v_mfma_f32_16x16x32_bf16 v[12:15], a[148:151], v[40:43], v[12:15]
    buffer_load_dword v5, v4, s[4:7], s16 offen sc1
    v_mfma_f32_16x16x32_bf16 v[16:19], a[152:155], v[40:43], v[16:19]
    s_waitcnt lgkmcnt(2)
    ds_read2st64_b64 v[112:115], v100 offset0:70 offset1:71
    v_mfma_f32_16x16x32_bf16 v[16:19], a[164:167], v[44:47], v[16:19]
    ds_read_b128 v[40:43], v2 offset:16384
    v_mfma_f32_16x16x32_bf16 v[12:15], a[160:163], v[44:47], v[12:15]
    ds_read2st64_b64 v[108:111], v100 offset0:68 offset1:69
    v_mfma_f32_16x16x32_bf16 v[8:11], a[156:159], v[44:47], v[8:11]
    s_waitcnt lgkmcnt(4)
    ds_read2st64_b64 v[104:107], v100 offset0:66 offset1:67
    v_mfma_f32_16x16x32_bf16 v[8:11], a[168:171], v[48:51], v[8:11]
    ds_read_b128 v[44:47], v2 offset:17408
    v_mfma_f32_16x16x32_bf16 v[12:15], a[172:175], v[48:51], v[12:15]
    ds_read2st64_b64 v[100:103], v100 offset0:64 offset1:65
    v_mfma_f32_16x16x32_bf16 v[16:19], a[176:179], v[48:51], v[16:19]
    s_waitcnt lgkmcnt(6)
    v_mfma_f32_16x16x32_bf16 v[16:19], a[188:191], v[52:55], v[16:19]
    ds_read_b128 v[48:51], v2 offset:18432
    v_mfma_f32_16x16x32_bf16 v[12:15], a[184:187], v[52:55], v[12:15]
    v_mfma_f32_16x16x32_bf16 v[8:11], a[180:183], v[52:55], v[8:11]
    s_waitcnt lgkmcnt(5)
    v_mfma_f32_16x16x32_bf16 v[8:11], a[192:195], v[40:43], v[8:11]
    ds_read_b128 v[52:55], v2 offset:19456
    v_mfma_f32_16x16x32_bf16 v[12:15], a[196:199], v[40:43], v[12:15]
    v_mfma_f32_16x16x32_bf16 v[16:19], a[200:203], v[40:43], v[16:19]
    s_waitcnt lgkmcnt(2)
    v_add_f32 v100, v100, v108
    v_add_f32 v101, v101, v109
    v_mfma_f32_16x16x32_bf16 v[16:19], a[212:215], v[44:47], v[16:19]
    ds_read_b128 v[40:43], v2 offset:20480
    v_add_f32 v102, v102, v110
    v_mfma_f32_16x16x32_bf16 v[12:15], a[208:211], v[44:47], v[12:15]
    v_add_f32 v103, v103, v111
    v_add_f32 v104, v104, v112
    v_mfma_f32_16x16x32_bf16 v[8:11], a[204:207], v[44:47], v[8:11]
    s_waitcnt lgkmcnt(2)
    v_add_f32 v105, v105, v113
    v_add_f32 v106, v106, v114
    v_mfma_f32_16x16x32_bf16 v[8:11], a[216:219], v[48:51], v[8:11]
    ds_read_b128 v[44:47], v2 offset:21504
    v_add_f32 v107, v107, v115
    v_mfma_f32_16x16x32_bf16 v[12:15], a[220:223], v[48:51], v[12:15]
    v_add_f32 v100, v100, v104
    v_add_f32 v101, v101, v105
    v_mfma_f32_16x16x32_bf16 v[16:19], a[224:227], v[48:51], v[16:19]
    s_waitcnt lgkmcnt(2)
    v_add_f32 v102, v102, v106
    v_add_f32 v103, v103, v107
    v_mfma_f32_16x16x32_bf16 v[16:19], a[236:239], v[52:55], v[16:19]
    ds_read_b128 v[48:51], v2 offset:22528
    s_waitcnt vmcnt(0)
    v_mfma_f32_16x16x32_bf16 v[12:15], a[232:235], v[52:55], v[12:15]
    v_cmp_gt_i32 vcc, s32, v5
    v_add_f32 v100, v100, v102
    v_mfma_f32_16x16x32_bf16 v[8:11], a[228:231], v[52:55], v[8:11]
    s_waitcnt lgkmcnt(2)
    v_add_f32 v101, v101, v103
    v_mfma_f32_16x16x32_bf16 v[8:11], a[240:243], v[40:43], v[8:11]
    ds_read_b128 v[52:55], v2 offset:23552
    v_mfma_f32_16x16x32_bf16 v[12:15], a[244:247], v[40:43], v[12:15]
    s_and_b64 vcc, vcc, s[18:19]
    s_cbranch_scc1 Lffa_v03
    v_mfma_f32_16x16x32_bf16 v[16:19], a[248:251], v[40:43], v[16:19]
    s_waitcnt lgkmcnt(2)
    buffer_load_dwordx4 v1, s[8:11], s33 offen offset:0 sc1 lds
    v_mfma_f32_16x16x32_bf16 v[16:19], v[132:135], v[44:47], v[16:19]
    ds_read_b128 v[40:43], v2 offset:24576
    v_mfma_f32_16x16x32_bf16 v[12:15], v[128:131], v[44:47], v[12:15]
    v_permlane16_swap_b32 v100, v101
    v_mfma_f32_16x16x32_bf16 v[8:11], a[252:255], v[44:47], v[8:11]
    s_waitcnt lgkmcnt(2)
    v_add_f32 v100, v100, v101
    v_mov_b32 v101, v100
    v_mfma_f32_16x16x32_bf16 v[8:11], v[136:139], v[48:51], v[8:11]
    ds_read_b128 v[44:47], v2 offset:25600
    v_mfma_f32_16x16x32_bf16 v[12:15], v[140:143], v[48:51], v[12:15]
    buffer_load_dwordx4 v1, s[8:11], s33 offen offset:1024 sc1 lds
    v_mfma_f32_16x16x32_bf16 v[16:19], v[144:147], v[48:51], v[16:19]
    s_waitcnt lgkmcnt(2)
    v_permlane32_swap_b32 v100, v101
    v_mfma_f32_16x16x32_bf16 v[16:19], v[156:159], v[52:55], v[16:19]
    ds_read_b128 v[48:51], v2 offset:26624
    v_add_f32 v100, v100, v101
    v_mfma_f32_16x16x32_bf16 v[12:15], v[152:155], v[52:55], v[12:15]
    v_mul_f32 v100, 0x3a800000, v100
    v_mov_b32 v101, v100
    v_mfma_f32_16x16x32_bf16 v[8:11], v[148:151], v[52:55], v[8:11]
    s_waitcnt lgkmcnt(2)
    buffer_load_dwordx4 v1, s[8:11], s33 offen offset:2048 sc1 lds
    v_mfma_f32_16x16x32_bf16 v[8:11], v[160:163], v[40:43], v[8:11]
    ds_read_b128 v[52:55], v2 offset:27648
    v_mfma_f32_16x16x32_bf16 v[12:15], v[164:167], v[40:43], v[12:15]
    v_permlane16_swap_b32 v100, v101
    v_mfma_f32_16x16x32_bf16 v[16:19], v[168:171], v[40:43], v[16:19]
    s_waitcnt lgkmcnt(2)
    buffer_store_dword v6, v22, s[12:15], s17 offen sc1
    v_mfma_f32_16x16x32_bf16 v[16:19], v[180:183], v[44:47], v[16:19]
    ds_read_b128 v[40:43], v2 offset:28672
    v_fma_f32 v101, -v100, v100, v101
    v_mfma_f32_16x16x32_bf16 v[12:15], v[176:179], v[44:47], v[12:15]
    buffer_load_dwordx4 v1, s[8:11], s33 offen offset:3072 sc1 lds
    v_mfma_f32_16x16x32_bf16 v[8:11], v[172:175], v[44:47], v[8:11]
    s_waitcnt lgkmcnt(2)
    s_add_u32 s16, s16, 8192
    s_add_u32 m0, s34, s3
    v_mfma_f32_16x16x32_bf16 v[8:11], v[184:187], v[48:51], v[8:11]
    ds_read_b128 v[44:47], v2 offset:29696
    s_add_u32 s37, s33, s3
    v_mfma_f32_16x16x32_bf16 v[12:15], v[188:191], v[48:51], v[12:15]
    s_mov_b32 s14, s6
    v_max_f32 v101, 0, v101
    v_add_f32 v101, 0x3727c5ac, v101
    v_mfma_f32_16x16x32_bf16 v[16:19], v[192:195], v[48:51], v[16:19]
    s_waitcnt lgkmcnt(2)
    buffer_load_dword v5, v4, s[4:7], s16 offen sc1
    v_mfma_f32_16x16x32_bf16 v[16:19], v[204:207], v[52:55], v[16:19]
    ds_read_b128 v[48:51], v2 offset:30720
    s_add_u32 s17, s17, 8192
    v_mfma_f32_16x16x32_bf16 v[12:15], v[200:203], v[52:55], v[12:15]
    v_rsq_f32 v21, v101
    v_mfma_f32_16x16x32_bf16 v[8:11], v[196:199], v[52:55], v[8:11]
    s_waitcnt vmcnt(1) lgkmcnt(2)
    s_barrier
    v_mfma_f32_16x16x32_bf16 v[8:11], v[208:211], v[40:43], v[8:11]
    ds_read_b128 v[52:55], v2 offset:31744
    v_mul_f32 v100, v100, v21
    v_mfma_f32_16x16x32_bf16 v[12:15], v[212:215], v[40:43], v[12:15]
    buffer_load_dwordx4 v1, s[8:11], s37 offen offset:0 sc1 lds
    v_mfma_f32_16x16x32_bf16 v[16:19], v[216:219], v[40:43], v[16:19]
    s_waitcnt lgkmcnt(2)
    v_fma_f32 v80, -v100, v56, v68
    v_fma_f32 v81, -v100, v57, v69
    v_mfma_f32_16x16x32_bf16 v[16:19], v[228:231], v[44:47], v[16:19]
    ds_read_b128 v[40:43], v3 offset:0
    v_fma_f32 v82, -v100, v58, v70
    v_mfma_f32_16x16x32_bf16 v[12:15], v[224:227], v[44:47], v[12:15]
    v_fma_f32 v83, -v100, v59, v71
    v_fma_f32 v84, -v100, v60, v72
    v_mfma_f32_16x16x32_bf16 v[8:11], v[220:223], v[44:47], v[8:11]
    s_waitcnt lgkmcnt(2)
    buffer_load_dwordx4 v1, s[8:11], s37 offen offset:1024 sc1 lds
    v_mfma_f32_16x16x32_bf16 v[8:11], v[232:235], v[48:51], v[8:11]
    ds_read_b128 v[44:47], v3 offset:1024
    v_fma_f32 v85, -v100, v61, v73
    v_mfma_f32_16x16x32_bf16 v[12:15], v[236:239], v[48:51], v[12:15]
    v_fma_f32 v86, -v100, v62, v74
    v_fma_f32 v87, -v100, v63, v75
    v_mfma_f32_16x16x32_bf16 v[16:19], v[240:243], v[48:51], v[16:19]
    s_waitcnt lgkmcnt(2)
    v_fma_f32 v88, -v100, v64, v76
    v_fma_f32 v89, -v100, v65, v77
    v_mfma_f32_16x16x32_bf16 v[16:19], v[252:255], v[52:55], v[16:19]
    ds_read_b128 v[48:51], v3 offset:2048
    v_fma_f32 v90, -v100, v66, v78
    v_mfma_f32_16x16x32_bf16 v[12:15], v[248:251], v[52:55], v[12:15]
    buffer_load_dwordx4 v1, s[8:11], s37 offen offset:2048 sc1 lds
    v_mfma_f32_16x16x32_bf16 v[8:11], v[244:247], v[52:55], v[8:11]
    buffer_load_dwordx4 v1, s[8:11], s37 offen offset:3072 sc1 lds
    s_add_u32 m0, s34, s41
    s_add_u32 s37, s33, s41
    v_fma_f32 v91, -v100, v67, v79
    buffer_load_dwordx4 v1, s[8:11], s37 offen offset:0 sc1 lds
    s_add_u32 s32, s32, 1
    s_add_u32 s33, s33, 36864
    s_add_u32 s34, s34, 36864
    s_cmp_ge_u32 s34, 147456
    s_cselect_b32 s38, 147456, 0
    s_sub_u32 s34, s34, s38
    s_cmp_ge_i32 s31, 63
    s_cbranch_scc1 L_exit
    s_cmp_eq_u32 s30, 1
    s_cbranch_scc1 Lffa_body11
    s_cmp_eq_u32 s30, 2
    s_cbranch_scc1 Lffa_body12
    s_cmp_eq_u32 s30, 3
    s_cbranch_scc1 Lffa_body13
    s_branch Lffa_body10
Lffa_v03:
    v_mfma_f32_16x16x32_bf16 v[16:19], a[248:251], v[40:43], v[16:19]
    s_waitcnt lgkmcnt(2)
    v_permlane16_swap_b32 v100, v101
    v_mfma_f32_16x16x32_bf16 v[16:19], v[132:135], v[44:47], v[16:19]
    ds_read_b128 v[40:43], v2 offset:24576
    v_add_f32 v100, v100, v101
    v_mfma_f32_16x16x32_bf16 v[12:15], v[128:131], v[44:47], v[12:15]
    v_mov_b32 v101, v100
    v_mfma_f32_16x16x32_bf16 v[8:11], a[252:255], v[44:47], v[8:11]
    s_waitcnt lgkmcnt(2)
    v_permlane32_swap_b32 v100, v101
    v_mfma_f32_16x16x32_bf16 v[8:11], v[136:139], v[48:51], v[8:11]
    ds_read_b128 v[44:47], v2 offset:25600
    v_add_f32 v100, v100, v101
    v_mfma_f32_16x16x32_bf16 v[12:15], v[140:143], v[48:51], v[12:15]
    v_mul_f32 v100, 0x3a800000, v100
    v_mov_b32 v101, v100
    v_mfma_f32_16x16x32_bf16 v[16:19], v[144:147], v[48:51], v[16:19]
    s_waitcnt lgkmcnt(2)
    v_permlane16_swap_b32 v100, v101
    v_mfma_f32_16x16x32_bf16 v[16:19], v[156:159], v[52:55], v[16:19]
    ds_read_b128 v[48:51], v2 offset:26624
    v_fma_f32 v101, -v100, v100, v101
    v_mfma_f32_16x16x32_bf16 v[12:15], v[152:155], v[52:55], v[12:15]
    v_max_f32 v101, 0, v101
    v_add_f32 v101, 0x3727c5ac, v101
    v_mfma_f32_16x16x32_bf16 v[8:11], v[148:151], v[52:55], v[8:11]
    s_waitcnt lgkmcnt(2)
    v_rsq_f32 v21, v101
    v_mfma_f32_16x16x32_bf16 v[8:11], v[160:163], v[40:43], v[8:11]
    ds_read_b128 v[52:55], v2 offset:27648
    v_mul_f32 v100, v100, v21
    v_mfma_f32_16x16x32_bf16 v[12:15], v[164:167], v[40:43], v[12:15]
    v_fma_f32 v80, -v100, v56, v68
    v_fma_f32 v81, -v100, v57, v69
    v_mfma_f32_16x16x32_bf16 v[16:19], v[168:171], v[40:43], v[16:19]
    s_waitcnt lgkmcnt(2)
    buffer_store_dword v6, v22, s[12:15], s17 offen sc1
    v_mfma_f32_16x16x32_bf16 v[16:19], v[180:183], v[44:47], v[16:19]
    ds_read_b128 v[40:43], v2 offset:28672
    v_fma_f32 v82, -v100, v58, v70
    v_mfma_f32_16x16x32_bf16 v[12:15], v[176:179], v[44:47], v[12:15]
    s_mov_b32 s14, s6
    v_fma_f32 v83, -v100, v59, v71
    v_fma_f32 v84, -v100, v60, v72
    v_mfma_f32_16x16x32_bf16 v[8:11], v[172:175], v[44:47], v[8:11]
    s_waitcnt lgkmcnt(2)
    v_fma_f32 v85, -v100, v61, v73
    v_fma_f32 v86, -v100, v62, v74
    v_mfma_f32_16x16x32_bf16 v[8:11], v[184:187], v[48:51], v[8:11]
    ds_read_b128 v[44:47], v2 offset:29696
    v_fma_f32 v87, -v100, v63, v75
    v_mfma_f32_16x16x32_bf16 v[12:15], v[188:191], v[48:51], v[12:15]
    s_add_u32 s17, s17, 8192
    v_fma_f32 v88, -v100, v64, v76
    v_fma_f32 v89, -v100, v65, v77
    v_mfma_f32_16x16x32_bf16 v[16:19], v[192:195], v[48:51], v[16:19]
    s_waitcnt lgkmcnt(2)
    v_fma_f32 v90, -v100, v66, v78
    v_fma_f32 v91, -v100, v67, v79
    v_mfma_f32_16x16x32_bf16 v[16:19], v[204:207], v[52:55], v[16:19]
    ds_read_b128 v[48:51], v2 offset:30720
    v_mfma_f32_16x16x32_bf16 v[12:15], v[200:203], v[52:55], v[12:15]
    buffer_load_dword v5, v4, s[4:7], s16 offen sc1
    v_mfma_f32_16x16x32_bf16 v[8:11], v[196:199], v[52:55], v[8:11]
    s_waitcnt lgkmcnt(2)
    v_mfma_f32_16x16x32_bf16 v[8:11], v[208:211], v[40:43], v[8:11]
    ds_read_b128 v[52:55], v2 offset:31744
    v_mfma_f32_16x16x32_bf16 v[12:15], v[212:215], v[40:43], v[12:15]
    v_mfma_f32_16x16x32_bf16 v[16:19], v[216:219], v[40:43], v[16:19]
    s_waitcnt lgkmcnt(2)
    v_mfma_f32_16x16x32_bf16 v[16:19], v[228:231], v[44:47], v[16:19]
    v_mfma_f32_16x16x32_bf16 v[12:15], v[224:227], v[44:47], v[12:15]
    v_mfma_f32_16x16x32_bf16 v[8:11], v[220:223], v[44:47], v[8:11]
    s_waitcnt lgkmcnt(1)
    v_mfma_f32_16x16x32_bf16 v[8:11], v[232:235], v[48:51], v[8:11]
    v_mfma_f32_16x16x32_bf16 v[12:15], v[236:239], v[48:51], v[12:15]
    v_mfma_f32_16x16x32_bf16 v[16:19], v[240:243], v[48:51], v[16:19]
    s_waitcnt lgkmcnt(0)
    v_mfma_f32_16x16x32_bf16 v[16:19], v[252:255], v[52:55], v[16:19]
    v_mfma_f32_16x16x32_bf16 v[12:15], v[248:251], v[52:55], v[12:15]
    v_mfma_f32_16x16x32_bf16 v[8:11], v[244:247], v[52:55], v[8:11]
    s_nop 5
    v_fma_f32 v124, v16, v21, v88
    v_fma_f32 v125, v17, v21, v89
    v_fma_f32 v126, v18, v21, v90
    v_fma_f32 v127, v19, v21, v91
    v_mul_f32 v124, v124, |v124|
    v_mul_f32 v125, v125, |v125|
    v_mul_f32 v126, v126, |v126|
    v_mul_f32 v127, v127, |v127|
    v_cvt_pk_bf16_f32 v124, v124, v125
    v_cvt_pk_bf16_f32 v126, v126, v127
    v_pk_max_i16 v96, v124, 0
    v_pk_max_i16 v97, v126, 0
    v_pk_max_i16 v98, v124, 0
    v_pk_max_i16 v99, v126, 0
    v_fma_f32 v116, v8, v21, v80
    v_permlane32_swap_b32 v96, v98
    v_permlane32_swap_b32 v97, v99
    buffer_store_dwordx4 v[96:99], v7, s[12:15], s36 offen sc1
    v_fma_f32 v117, v9, v21, v81
    v_fma_f32 v118, v10, v21, v82
    v_fma_f32 v119, v11, v21, v83
    v_fma_f32 v120, v12, v21, v84
    v_fma_f32 v121, v13, v21, v85
    v_fma_f32 v122, v14, v21, v86
    v_fma_f32 v123, v15, v21, v87
    v_mul_f32 v116, v116, |v116|
    v_mul_f32 v117, v117, |v117|
    v_mul_f32 v118, v118, |v118|
    v_mul_f32 v119, v119, |v119|
    v_mul_f32 v120, v120, |v120|
    v_mul_f32 v121, v121, |v121|
    v_mul_f32 v122, v122, |v122|
    v_mul_f32 v123, v123, |v123|
    v_cvt_pk_bf16_f32 v116, v116, v117
    v_cvt_pk_bf16_f32 v118, v118, v119
    v_cvt_pk_bf16_f32 v120, v120, v121
    v_cvt_pk_bf16_f32 v122, v122, v123
    v_pk_max_i16 v92, v116, 0
    v_pk_max_i16 v93, v118, 0
    v_pk_max_i16 v94, v120, 0
    v_pk_max_i16 v95, v122, 0
    buffer_store_dwordx4 v[92:95], v1, s[12:15], s36 offen sc1
    s_add_u32 s54, s31, 1
    v_mov_b32 v6, s54
    s_waitcnt vmcnt(2)
    s_cmp_ge_i32 s31, 63
    s_cbranch_scc1 Lffa_late0
    v_cmp_gt_i32 vcc, s32, v5
    s_sub_u32 s43, s43, 1
    s_cmp_lt_i32 s43, 0
    s_cbranch_scc1 Lffa_rdy0
    s_and_b64 vcc, vcc, s[18:19]
    s_cbranch_scc0 Lffa_rdy0
Lffa_late0:
    buffer_load_dword v5, v4, s[4:7], s16 offen sc1
    s_waitcnt vmcnt(1)
    buffer_store_dword v6, v22, s[12:15], s17 offen sc1
    s_mov_b32 s14, 0
    s_cmp_ge_i32 s31, 63
    s_cbranch_scc1 L_exit
    s_waitcnt vmcnt(1)
    v_cmp_gt_i32 vcc, s32, v5
    s_sub_u32 s43, s43, 1
    s_cmp_lt_i32 s43, 0
    s_cbranch_scc1 Lffa_rdy0
    s_and_b64 vcc, vcc, s[18:19]
    s_cbranch_scc0 Lffa_rdy0
Lffa_spin0:
    buffer_load_dword v5, v4, s[4:7], s16 offen sc1
    s_waitcnt vmcnt(0)
    v_cmp_gt_i32 vcc, s32, v5
    s_sub_u32 s43, s43, 1
    s_cmp_lt_i32 s43, 0
    s_cbranch_scc1 Lffa_rdy0
    s_and_b64 vcc, vcc, s[18:19]
    s_cbranch_scc0 Lffa_rdy0
    s_sleep 8
    s_branch Lffa_spin0
Lffa_rdy0:
    s_add_u32 m0, s34, 0
    s_nop 0
    buffer_load_dwordx4 v1, s[8:11], s33 offen offset:0 sc1 lds
    buffer_load_dwordx4 v1, s[8:11], s33 offen offset:1024 sc1 lds
    buffer_load_dwordx4 v1, s[8:11], s33 offen offset:2048 sc1 lds
    buffer_load_dwordx4 v1, s[8:11], s33 offen offset:3072 sc1 lds
    s_add_u32 s16, s16, 8192
    buffer_load_dword v5, v4, s[4:7], s16 offen sc1
    s_add_u32 m0, s34, s3
    s_add_u32 s37, s33, s3
    buffer_load_dwordx4 v1, s[8:11], s37 offen offset:0 sc1 lds
    buffer_load_dwordx4 v1, s[8:11], s37 offen offset:1024 sc1 lds
    buffer_load_dwordx4 v1, s[8:11], s37 offen offset:2048 sc1 lds
    buffer_load_dwordx4 v1, s[8:11], s37 offen offset:3072 sc1 lds
    s_add_u32 m0, s34, s41
    s_add_u32 s37, s33, s41
    buffer_load_dwordx4 v1, s[8:11], s37 offen offset:0 sc1 lds
    s_add_u32 s32, s32, 1
    s_add_u32 s33, s33, 36864
    s_add_u32 s34, s34, 36864
    s_cmp_ge_u32 s34, 147456
    s_cselect_b32 s38, 147456, 0
    s_sub_u32 s34, s34, s38
    s_waitcnt vmcnt(6)
    buffer_store_dword v6, v22, s[12:15], s17 offen sc1
Lffa_go0:
    s_mov_b32 s14, 0
    s_barrier
    ds_read_b128 v[40:43], v3 offset:0
    ds_read_b128 v[44:47], v3 offset:1024
    ds_read_b128 v[48:51], v3 offset:2048
    s_cmp_eq_u32 s30, 1
    s_cbranch_scc1 Lffa_body11
    s_cmp_eq_u32 s30, 2
    s_cbranch_scc1 Lffa_body12
    s_cmp_eq_u32 s30, 3
    s_cbranch_scc1 Lffa_body13
    s_branch Lffa_body10
Lffa_v11:
    v_mfma_f32_16x16x32_bf16 v[24:27], a[36:39], v[52:55], v[24:27]
    s_waitcnt lgkmcnt(2)
    buffer_load_dword v5, v4, s[4:7], s16 offen sc1
    v_mfma_f32_16x16x32_bf16 v[24:27], a[48:51], v[40:43], v[24:27]
    ds_read_b128 v[52:55], v3 offset:7168
    v_pk_max_i16 v98, v124, 0
    v_mfma_f32_16x16x32_bf16 v[28:31], a[52:55], v[40:43], v[28:31]
    v_pk_max_i16 v99, v126, 0
    v_fma_f32 v116, v8, v21, v80
    v_mfma_f32_16x16x32_bf16 v[32:35], a[56:59], v[40:43], v[32:35]
    s_waitcnt lgkmcnt(2)
    v_permlane32_swap_b32 v96, v98
    v_mfma_f32_16x16x32_bf16 v[32:35], a[68:71], v[44:47], v[32:35]
    ds_read_b128 v[40:43], v3 offset:8192
    v_fma_f32 v117, v9, v21, v81
    v_mfma_f32_16x16x32_bf16 v[28:31], a[64:67], v[44:47], v[28:31]
    v_permlane32_swap_b32 v97, v99
    v_mfma_f32_16x16x32_bf16 v[24:27], a[60:63], v[44:47], v[24:27]
    s_waitcnt lgkmcnt(2)
    buffer_store_dwordx4 v[96:99], v7, s[12:15], s36 offen sc1
    v_fma_f32 v118, v10, v21, v82
    v_mfma_f32_16x16x32_bf16 v[24:27], a[72:75], v[48:51], v[24:27]
    ds_read_b128 v[44:47], v3 offset:9216
    v_fma_f32 v119, v11, v21, v83
    v_mfma_f32_16x16x32_bf16 v[28:31], a[76:79], v[48:51], v[28:31]
    v_fma_f32 v120, v12, v21, v84
    v_fma_f32 v121, v13, v21, v85
    v_mfma_f32_16x16x32_bf16 v[32:35], a[80:83], v[48:51], v[32:35]
    s_waitcnt lgkmcnt(2)
    v_fma_f32 v122, v14, v21, v86
    v_fma_f32 v123, v15, v21, v87
    v_mfma_f32_16x16x32_bf16 v[32:35], a[92:95], v[52:55], v[32:35]
    ds_read_b128 v[48:51], v3 offset:10240
    v_mul_f32 v116, v116, |v116|
    v_mfma_f32_16x16x32_bf16 v[28:31], a[88:91], v[52:55], v[28:31]
    v_mul_f32 v117, v117, |v117|
    v_mul_f32 v118, v118, |v118|
    v_mfma_f32_16x16x32_bf16 v[24:27], a[84:87], v[52:55], v[24:27]
    s_waitcnt lgkmcnt(2)
    v_mul_f32 v119, v119, |v119|
    v_mul_f32 v120, v120, |v120|
    v_mfma_f32_16x16x32_bf16 v[24:27], a[96:99], v[40:43], v[24:27]
    ds_read_b128 v[52:55], v3 offset:11264
    v_mul_f32 v121, v121, |v121|
    v_mfma_f32_16x16x32_bf16 v[28:31], a[100:103], v[40:43], v[28:31]
    v_mul_f32 v122, v122, |v122|
    v_mul_f32 v123, v123, |v123|
    v_mfma_f32_16x16x32_bf16 v[32:35], a[104:107], v[40:43], v[32:35]
    s_waitcnt lgkmcnt(2)
    v_cvt_pk_bf16_f32 v116, v116, v117
    v_cvt_pk_bf16_f32 v118, v118, v119
    v_mfma_f32_16x16x32_bf16 v[32:35], a[116:119], v[44:47], v[32:35]
    ds_read_b128 v[40:43], v3 offset:12288
    v_cvt_pk_bf16_f32 v120, v120, v121
    v_mfma_f32_16x16x32_bf16 v[28:31], a[112:115], v[44:47], v[28:31]
    v_cvt_pk_bf16_f32 v122, v122, v123
    v_pk_max_i16 v92, v116, 0
    v_mfma_f32_16x16x32_bf16 v[24:27], a[108:111], v[44:47], v[24:27]
    s_waitcnt lgkmcnt(2)
    v_pk_max_i16 v93, v118, 0
    v_pk_max_i16 v94, v120, 0
    v_mfma_f32_16x16x32_bf16 v[24:27], a[120:123], v[48:51], v[24:27]
    ds_read_b128 v[44:47], v3 offset:13312
    v_pk_max_i16 v95, v122, 0
    v_mfma_f32_16x16x32_bf16 v[28:31], a[124:127], v[48:51], v[28:31]
    s_waitcnt vmcnt(1)
    v_cmp_gt_i32 vcc, s32, v5
    v_add_u32 v2, s35, v1
    v_mfma_f32_16x16x32_bf16 v[32:35], a[128:131], v[48:51], v[32:35]
    s_waitcnt lgkmcnt(2)
    buffer_store_dwordx4 v[92:95], v1, s[12:15], s36 offen sc1
    v_sub_u32 v100, v3, v20
    v_mfma_f32_16x16x32_bf16 v[32:35], a[140:143], v[52:55], v[32:35]
    ds_read_b128 v[48:51], v3 offset:14336
    s_add_u32 s36, s36, 116736
    v_mfma_f32_16x16x32_bf16 v[28:31], a[136:139], v[52:55], v[28:31]
    s_and_b64 vcc, vcc, s[18:19]
    s_cbranch_scc1 Lffa_v12
    v_mfma_f32_16x16x32_bf16 v[24:27], a[132:135], v[52:55], v[24:27]
    s_waitcnt lgkmcnt(2)
    s_barrier
    v_mfma_f32_16x16x32_bf16 v[24:27], a[144:147], v[40:43], v[24:27]
    ds_read_b128 v[52:55], v3 offset:15360
    v_mfma_f32_16x16x32_bf16 v[28:31], a[148:151], v[40:43], v[28:31]
    buffer_load_dwordx4 v1, s[8:11], s33 offen offset:0 sc1 lds
    v_mfma_f32_16x16x32_bf16 v[32:35], a[152:155], v[40:43], v[32:35]
    s_waitcnt lgkmcnt(2)
    ds_read2st64_b64 v[112:115], v100 offset0:70 offset1:71
    v_mfma_f32_16x16x32_bf16 v[32:35], a[164:167], v[44:47], v[32:35]
    ds_read_b128 v[40:43], v3 offset:16384
    v_mfma_f32_16x16x32_bf16 v[28:31], a[160:163], v[44:47], v[28:31]
    ds_read2st64_b64 v[108:111], v100 offset0:68 offset1:69
    v_mfma_f32_16x16x32_bf16 v[24:27], a[156:159], v[44:47], v[24:27]
    s_waitcnt lgkmcnt(4)
    buffer_load_dwordx4 v1, s[8:11], s33 offen offset:1024 sc1 lds
    v_mfma_f32_16x16x32_bf16 v[24:27], a[168:171], v[48:51], v[24:27]
    ds_read_b128 v[44:47], v3 offset:17408
    v_mfma_f32_16x16x32_bf16 v[28:31], a[172:175], v[48:51], v[28:31]
    ds_read2st64_b64 v[104:107], v100 offset0:66 offset1:67
    v_mfma_f32_16x16x32_bf16 v[32:35], a[176:179], v[48:51], v[32:35]
    s_waitcnt lgkmcnt(5)
    ds_read2st64_b64 v[100:103], v100 offset0:64 offset1:65
    v_mfma_f32_16x16x32_bf16 v[32:35], a[188:191], v[52:55], v[32:35]
    ds_read_b128 v[48:51], v3 offset:18432
    v_mfma_f32_16x16x32_bf16 v[28:31], a[184:187], v[52:55], v[28:31]
    buffer_load_dwordx4 v1, s[8:11], s33 offen offset:2048 sc1 lds
    v_mfma_f32_16x16x32_bf16 v[24:27], a[180:183], v[52:55], v[24:27]
    s_waitcnt lgkmcnt(5)
    v_mfma_f32_16x16x32_bf16 v[24:27], a[192:195], v[40:43], v[24:27]
    ds_read_b128 v[52:55], v3 offset:19456
    v_mfma_f32_16x16x32_bf16 v[28:31], a[196:199], v[40:43], v[28:31]
    v_mfma_f32_16x16x32_bf16 v[32:35], a[200:203], v[40:43], v[32:35]
    s_waitcnt lgkmcnt(4)
    buffer_load_dwordx4 v1, s[8:11], s33 offen offset:3072 sc1 lds
    v_mfma_f32_16x16x32_bf16 v[32:35], a[212:215], v[44:47], v[32:35]
    ds_read_b128 v[40:43], v3 offset:20480
    s_add_u32 s16, s16, 8192
    v_mfma_f32_16x16x32_bf16 v[28:31], a[208:211], v[44:47], v[28:31]
    s_add_u32 m0, s34, s3
    s_add_u32 s37, s33, s3
    s_waitcnt lgkmcnt(3)
    v_mfma_f32_16x16x32_bf16 v[24:27], a[204:207], v[44:47], v[24:27]
    s_waitcnt lgkmcnt(2)
    v_add_f32 v100, v100, v108
    v_add_f32 v101, v101, v109
    v_mfma_f32_16x16x32_bf16 v[24:27], a[216:219], v[48:51], v[24:27]
    ds_read_b128 v[44:47], v3 offset:21504
    v_add_f32 v102, v102, v110
    v_mfma_f32_16x16x32_bf16 v[28:31], a[220:223], v[48:51], v[28:31]
    buffer_load_dwordx4 v1, s[8:11], s37 offen offset:0 sc1 lds
    v_mfma_f32_16x16x32_bf16 v[32:35], a[224:227], v[48:51], v[32:35]
    s_waitcnt lgkmcnt(2)
    v_add_f32 v103, v103, v111
    v_add_f32 v104, v104, v112
    v_mfma_f32_16x16x32_bf16 v[32:35], a[236:239], v[52:55], v[32:35]
    ds_read_b128 v[48:51], v3 offset:22528
    v_add_f32 v105, v105, v113
    v_mfma_f32_16x16x32_bf16 v[28:31], a[232:235], v[52:55], v[28:31]
    v_add_f32 v106, v106, v114
    v_add_f32 v107, v107, v115
    v_mfma_f32_16x16x32_bf16 v[24:27], a[228:231], v[52:55], v[24:27]
    s_waitcnt lgkmcnt(2)
    buffer_load_dword v5, v4, s[4:7], s16 offen sc1
    v_mfma_f32_16x16x32_bf16 v[24:27], a[240:243], v[40:43], v[24:27]
    ds_read_b128 v[52:55], v3 offset:23552
    v_add_f32 v100, v100, v104
    v_mfma_f32_16x16x32_bf16 v[28:31], a[244:247], v[40:43], v[28:31]
    v_add_f32 v101, v101, v105
    v_add_f32 v102, v102, v106
    v_mfma_f32_16x16x32_bf16 v[32:35], a[248:251], v[40:43], v[32:35]
    s_waitcnt lgkmcnt(2)
    v_add_f32 v103, v103, v107
    v_add_f32 v100, v100, v102
    v_mfma_f32_16x16x32_bf16 v[32:35], v[132:135], v[44:47], v[32:35]
    ds_read_b128 v[40:43], v3 offset:24576
    v_add_f32 v101, v101, v103
    v_mfma_f32_16x16x32_bf16 v[28:31], v[128:131], v[44:47], v[28:31]
    buffer_load_dwordx4 v1, s[8:11], s37 offen offset:1024 sc1 lds
    v_mfma_f32_16x16x32_bf16 v[24:27], a[252:255], v[44:47], v[24:27]
    s_waitcnt lgkmcnt(2)
    v_permlane16_swap_b32 v100, v101
    v_mfma_f32_16x16x32_bf16 v[24:27], v[136:139], v[48:51], v[24:27]
    ds_read_b128 v[44:47], v3 offset:25600
    v_add_f32 v100, v100, v101
    v_mfma_f32_16x16x32_bf16 v[28:31], v[140:143], v[48:51], v[28:31]
    v_mov_b32 v101, v100
    v_mfma_f32_16x16x32_bf16 v[32:35], v[144:147], v[48:51], v[32:35]
    s_waitcnt lgkmcnt(2)
    buffer_load_dwordx4 v1, s[8:11], s37 offen offset:2048 sc1 lds
    v_mfma_f32_16x16x32_bf16 v[32:35], v[156:159], v[52:55], v[32:35]
    ds_read_b128 v[48:51], v3 offset:26624
    v_mfma_f32_16x16x32_bf16 v[28:31], v[152:155], v[52:55], v[28:31]
    v_permlane32_swap_b32 v100, v101
    v_mfma_f32_16x16x32_bf16 v[24:27], v[148:151], v[52:55], v[24:27]
    s_waitcnt lgkmcnt(2)
    v_add_f32 v100, v100, v101
    v_mul_f32 v100, 0x3a800000, v100
    v_mfma_f32_16x16x32_bf16 v[24:27], v[160:163], v[40:43], v[24:27]
    ds_read_b128 v[52:55], v3 offset:27648
    v_mov_b32 v101, v100
    v_mfma_f32_16x16x32_bf16 v[28:31], v[164:167], v[40:43], v[28:31]
    buffer_load_dwordx4 v1, s[8:11], s37 offen offset:3072 sc1 lds
    v_mfma_f32_16x16x32_bf16 v[32:35], v[168:171], v[40:43], v[32:35]
    s_waitcnt lgkmcnt(2)
    s_add_u32 m0, s34, s41
    s_add_u32 s37, s33, s41
    v_mfma_f32_16x16x32_bf16 v[32:35], v[180:183], v[44:47], v[32:35]
    ds_read_b128 v[40:43], v3 offset:28672
    s_waitcnt vmcnt(9)
    v_mfma_f32_16x16x32_bf16 v[28:31], v[176:179], v[44:47], v[28:31]
    buffer_store_dword v6, v22, s[12:15], s17 offen sc1
    s_mov_b32 s14, s6
    v_mfma_f32_16x16x32_bf16 v[24:27], v[172:175], v[44:47], v[24:27]
    s_waitcnt lgkmcnt(2)
    buffer_load_dwordx4 v1, s[8:11], s37 offen offset:0 sc1 lds
    v_mfma_f32_16x16x32_bf16 v[24:27], v[184:187], v[48:51], v[24:27]
    ds_read_b128 v[44:47], v3 offset:29696
    s_add_u32 s32, s32, 1
    v_mfma_f32_16x16x32_bf16 v[28:31], v[188:191], v[48:51], v[28:31]
    s_add_u32 s33, s33, 36864
    s_add_u32 s34, s34, 36864
    s_add_u32 s17, s17, 8192
    v_mfma_f32_16x16x32_bf16 v[32:35], v[192:195], v[48:51], v[32:35]
    s_waitcnt lgkmcnt(2)
    s_cmp_ge_u32 s34, 147456
    s_cselect_b32 s38, 147456, 0
    v_mfma_f32_16x16x32_bf16 v[32:35], v[204:207], v[52:55], v[32:35]
    ds_read_b128 v[48:51], v3 offset:30720
    s_sub_u32 s34, s34, s38
    v_mfma_f32_16x16x32_bf16 v[28:31], v[200:203], v[52:55], v[28:31]
    v_permlane16_swap_b32 v100, v101
    v_mfma_f32_16x16x32_bf16 v[24:27], v[196:199], v[52:55], v[24:27]
    s_waitcnt vmcnt(7) lgkmcnt(2)
    s_barrier
    v_mfma_f32_16x16x32_bf16 v[24:27], v[208:211], v[40:43], v[24:27]
    ds_read_b128 v[52:55], v3 offset:31744
    v_fma_f32 v101, -v100, v100, v101
    v_mfma_f32_16x16x32_bf16 v[28:31], v[212:215], v[40:43], v[28:31]
    v_max_f32 v101, 0, v101
    v_add_f32 v101, 0x3727c5ac, v101
    v_mfma_f32_16x16x32_bf16 v[32:35], v[216:219], v[40:43], v[32:35]
    s_waitcnt lgkmcnt(2)
    v_rsq_f32 v21, v101
    v_mfma_f32_16x16x32_bf16 v[32:35], v[228:231], v[44:47], v[32:35]
    ds_read_b128 v[40:43], v2 offset:0
    v_mul_f32 v100, v100, v21
    v_mfma_f32_16x16x32_bf16 v[28:31], v[224:227], v[44:47], v[28:31]
    v_fma_f32 v80, -v100, v56, v68
    v_fma_f32 v81, -v100, v57, v69
    v_mfma_f32_16x16x32_bf16 v[24:27], v[220:223], v[44:47], v[24:27]
    s_waitcnt lgkmcnt(2)
    v_fma_f32 v82, -v100, v58, v70
    v_fma_f32 v83, -v100, v59, v71
    v_mfma_f32_16x16x32_bf16 v[24:27], v[232:235], v[48:51], v[24:27]
    ds_read_b128 v[44:47], v2 offset:1024
    v_fma_f32 v84, -v100, v60, v72
    v_mfma_f32_16x16x32_bf16 v[28:31], v[236:239], v[48:51], v[28:31]
    v_fma_f32 v85, -v100, v61, v73
    v_fma_f32 v86, -v100, v62, v74
    v_mfma_f32_16x16x32_bf16 v[32:35], v[240:243], v[48:51], v[32:35]
    s_waitcnt lgkmcnt(2)
    v_fma_f32 v87, -v100, v63, v75
    v_fma_f32 v88, -v100, v64, v76
    v_mfma_f32_16x16x32_bf16 v[32:35], v[252:255], v[52:55], v[32:35]
    ds_read_b128 v[48:51], v2 offset:2048
    v_fma_f32 v89, -v100, v65, v77
    v_mfma_f32_16x16x32_bf16 v[28:31], v[248:251], v[52:55], v[28:31]
    v_fma_f32 v90, -v100, v66, v78
    v_fma_f32 v91, -v100, v67, v79
    v_mfma_f32_16x16x32_bf16 v[24:27], v[244:247], v[52:55], v[24:27]
    s_cmp_ge_i32 s31, 63
    s_cbranch_scc1 L_exit
    s_cmp_eq_u32 s30, 1
    s_cbranch_scc1 Lffa_body01
    s_cmp_eq_u32 s30, 2
    s_cbranch_scc1 Lffa_body02
    s_cmp_eq_u32 s30, 3
    s_cbranch_scc1 Lffa_body03
    s_branch Lffa_body00
Lffa_v12:
    v_mfma_f32_16x16x32_bf16 v[24:27], a[132:135], v[52:55], v[24:27]
    s_waitcnt lgkmcnt(2)
    s_barrier
    v_mfma_f32_16x16x32_bf16 v[24:27], a[144:147], v[40:43], v[24:27]
    ds_read_b128 v[52:55], v3 offset:15360
    v_mfma_f32_16x16x32_bf16 v[28:31], a[148:151], v[40:43], v[28:31]
    buffer_load_dword v5, v4, s[4:7], s16 offen sc1
    v_mfma_f32_16x16x32_bf16 v[32:35], a[152:155], v[40:43], v[32:35]
    s_waitcnt lgkmcnt(2)
    ds_read2st64_b64 v[112:115], v100 offset0:70 offset1:71
    v_mfma_f32_16x16x32_bf16 v[32:35], a[164:167], v[44:47], v[32:35]
    ds_read_b128 v[40:43], v3 offset:16384
    v_mfma_f32_16x16x32_bf16 v[28:31], a[160:163], v[44:47], v[28:31]
    ds_read2st64_b64 v[108:111], v100 offset0:68 offset1:69
    v_mfma_f32_16x16x32_bf16 v[24:27], a[156:159], v[44:47], v[24:27]
    s_waitcnt lgkmcnt(4)
    ds_read2st64_b64 v[104:107], v100 offset0:66 offset1:67
    v_mfma_f32_16x16x32_bf16 v[24:27], a[168:171], v[48:51], v[24:27]
    ds_read_b128 v[44:47], v3 offset:17408
    v_mfma_f32_16x16x32_bf16 v[28:31], a[172:175], v[48:51], v[28:31]
    ds_read2st64_b64 v[100:103], v100 offset0:64 offset1:65
    v_mfma_f32_16x16x32_bf16 v[32:35], a[176:179], v[48:51], v[32:35]
    s_waitcnt lgkmcnt(6)
    v_mfma_f32_16x16x32_bf16 v[32:35], a[188:191], v[52:55], v[32:35]
    ds_read_b128 v[48:51], v3 offset:18432
    v_mfma_f32_16x16x32_bf16 v[28:31], a[184:187], v[52:55], v[28:31]
    v_mfma_f32_16x16x32_bf16 v[24:27], a[180:183], v[52:55], v[24:27]
    s_waitcnt lgkmcnt(5)
    v_mfma_f32_16x16x32_bf16 v[24:27], a[192:195], v[40:43], v[24:27]
    ds_read_b128 v[52:55], v3 offset:19456
    v_mfma_f32_16x16x32_bf16 v[28:31], a[196:199], v[40:43], v[28:31]
    v_mfma_f32_16x16x32_bf16 v[32:35], a[200:203], v[40:43], v[32:35]
    s_waitcnt lgkmcnt(2)
    v_add_f32 v100, v100, v108
    v_add_f32 v101, v101, v109
    v_mfma_f32_16x16x32_bf16 v[32:35], a[212:215], v[44:47], v[32:35]
    ds_read_b128 v[40:43], v3 offset:20480
    v_add_f32 v102, v102, v110
    v_mfma_f32_16x16x32_bf16 v[28:31], a[208:211], v[44:47], v[28:31]
    v_add_f32 v103, v103, v111
    v_add_f32 v104, v104, v112
    v_mfma_f32_16x16x32_bf16 v[24:27], a[204:207], v[44:47], v[24:27]
    s_waitcnt lgkmcnt(2)
    v_add_f32 v105, v105, v113
    v_add_f32 v106, v106, v114
    v_mfma_f32_16x16x32_bf16 v[24:27], a[216:219], v[48:51], v[24:27]
    ds_read_b128 v[44:47], v3 offset:21504
    v_add_f32 v107, v107, v115
    v_mfma_f32_16x16x32_bf16 v[28:31], a[220:223], v[48:51], v[28:31]
    v_add_f32 v100, v100, v104
    v_add_f32 v101, v101, v105
    v_mfma_f32_16x16x32_bf16 v[32:35], a[224:227], v[48:51], v[32:35]
    s_waitcnt lgkmcnt(2)
    v_add_f32 v102, v102, v106
    v_add_f32 v103, v103, v107
    v_mfma_f32_16x16x32_bf16 v[32:35], a[236:239], v[52:55], v[32:35]
    ds_read_b128 v[48:51], v3 offset:22528
    s_waitcnt vmcnt(0)
    v_mfma_f32_16x16x32_bf16 v[28:31], a[232:235], v[52:55], v[28:31]
    v_cmp_gt_i32 vcc, s32, v5
    v_add_f32 v100, v100, v102
    v_mfma_f32_16x16x32_bf16 v[24:27], a[228:231], v[52:55], v[24:27]
    s_waitcnt lgkmcnt(2)
    v_add_f32 v101, v101, v103
    v_mfma_f32_16x16x32_bf16 v[24:27], a[240:243], v[40:43], v[24:27]
    ds_read_b128 v[52:55], v3 offset:23552
    v_mfma_f32_16x16x32_bf16 v[28:31], a[244:247], v[40:43], v[28:31]
    s_and_b64 vcc, vcc, s[18:19]
    s_cbranch_scc1 Lffa_v13
    v_mfma_f32_16x16x32_bf16 v[32:35], a[248:251], v[40:43], v[32:35]
    s_waitcnt lgkmcnt(2)
    buffer_load_dwordx4 v1, s[8:11], s33 offen offset:0 sc1 lds
    v_mfma_f32_16x16x32_bf16 v[32:35], v[132:135], v[44:47], v[32:35]
    ds_read_b128 v[40:43], v3 offset:24576
    v_mfma_f32_16x16x32_bf16 v[28:31], v[128:131], v[44:47], v[28:31]
    v_permlane16_swap_b32 v100, v101
    v_mfma_f32_16x16x32_bf16 v[24:27], a[252:255], v[44:47], v[24:27]
    s_waitcnt lgkmcnt(2)
    v_add_f32 v100, v100, v101
    v_mov_b32 v101, v100
    v_mfma_f32_16x16x32_bf16 v[24:27], v[136:139], v[48:51], v[24:27]
    ds_read_b128 v[44:47], v3 offset:25600
    v_mfma_f32_16x16x32_bf16 v[28:31], v[140:143], v[48:51], v[28:31]
    buffer_load_dwordx4 v1, s[8:11], s33 offen offset:1024 sc1 lds
    v_mfma_f32_16x16x32_bf16 v[32:35], v[144:147], v[48:51], v[32:35]
    s_waitcnt lgkmcnt(2)
    v_permlane32_swap_b32 v100, v101
    v_mfma_f32_16x16x32_bf16 v[32:35], v[156:159], v[52:55], v[32:35]
    ds_read_b128 v[48:51], v3 offset:26624
    v_add_f32 v100, v100, v101
    v_mfma_f32_16x16x32_bf16 v[28:31], v[152:155], v[52:55], v[28:31]
    v_mul_f32 v100, 0x3a800000, v100
    v_mov_b32 v101, v100
    v_mfma_f32_16x16x32_bf16 v[24:27], v[148:151], v[52:55], v[24:27]
    s_waitcnt lgkmcnt(2)
    buffer_load_dwordx4 v1, s[8:11], s33 offen offset:2048 sc1 lds
    v_mfma_f32_16x16x32_bf16 v[24:27], v[160:163], v[40:43], v[24:27]
    ds_read_b128 v[52:55], v3 offset:27648
    v_mfma_f32_16x16x32_bf16 v[28:31], v[164:167], v[40:43], v[28:31]
    v_permlane16_swap_b32 v100, v101
    v_mfma_f32_16x16x32_bf16 v[32:35], v[168:171], v[40:43], v[32:35]
    s_waitcnt lgkmcnt(2)
    buffer_store_dword v6, v22, s[12:15], s17 offen sc1
    v_mfma_f32_16x16x32_bf16 v[32:35], v[180:183], v[44:47], v[32:35]
    ds_read_b128 v[40:43], v3 offset:28672
    v_fma_f32 v101, -v100, v100, v101
    v_mfma_f32_16x16x32_bf16 v[28:31], v[176:179], v[44:47], v[28:31]
    buffer_load_dwordx4 v1, s[8:11], s33 offen offset:3072 sc1 lds
    v_mfma_f32_16x16x32_bf16 v[24:27], v[172:175], v[44:47], v[24:27]
    s_waitcnt lgkmcnt(2)
    s_add_u32 s16, s16, 8192
    s_add_u32 m0, s34, s3
    v_mfma_f32_16x16x32_bf16 v[24:27], v[184:187], v[48:51], v[24:27]
    ds_read_b128 v[44:47], v3 offset:29696
    s_add_u32 s37, s33, s3
    v_mfma_f32_16x16x32_bf16 v[28:31], v[188:191], v[48:51], v[28:31]
    s_mov_b32 s14, s6
    v_max_f32 v101, 0, v101
    v_add_f32 v101, 0x3727c5ac, v101
    v_mfma_f32_16x16x32_bf16 v[32:35], v[192:195], v[48:51], v[32:35]
    s_waitcnt lgkmcnt(2)
    buffer_load_dword v5, v4, s[4:7], s16 offen sc1
    v_mfma_f32_16x16x32_bf16 v[32:35], v[204:207], v[52:55], v[32:35]
    ds_read_b128 v[48:51], v3 offset:30720
    s_add_u32 s17, s17, 8192
    v_mfma_f32_16x16x32_bf16 v[28:31], v[200:203], v[52:55], v[28:31]
    v_rsq_f32 v21, v101
    v_mfma_f32_16x16x32_bf16 v[24:27], v[196:199], v[52:55], v[24:27]
    s_waitcnt vmcnt(1) lgkmcnt(2)
    s_barrier
    v_mfma_f32_16x16x32_bf16 v[24:27], v[208:211], v[40:43], v[24:27]
    ds_read_b128 v[52:55], v3 offset:31744
    v_mul_f32 v100, v100, v21
    v_mfma_f32_16x16x32_bf16 v[28:31], v[212:215], v[40:43], v[28:31]
    buffer_load_dwordx4 v1, s[8:11], s37 offen offset:0 sc1 lds
    v_mfma_f32_16x16x32_bf16 v[32:35], v[216:219], v[40:43], v[32:35]
    s_waitcnt lgkmcnt(2)
    v_fma_f32 v80, -v100, v56, v68
    v_fma_f32 v81, -v100, v57, v69
    v_mfma_f32_16x16x32_bf16 v[32:35], v[228:231], v[44:47], v[32:35]
    ds_read_b128 v[40:43], v2 offset:0
    v_fma_f32 v82, -v100, v58, v70
    v_mfma_f32_16x16x32_bf16 v[28:31], v[224:227], v[44:47], v[28:31]
    v_fma_f32 v83, -v100, v59, v71
    v_fma_f32 v84, -v100, v60, v72
    v_mfma_f32_16x16x32_bf16 v[24:27], v[220:223], v[44:47], v[24:27]
    s_waitcnt lgkmcnt(2)
    buffer_load_dwordx4 v1, s[8:11], s37 offen offset:1024 sc1 lds
    v_mfma_f32_16x16x32_bf16 v[24:27], v[232:235], v[48:51], v[24:27]
    ds_read_b128 v[44:47], v2 offset:1024
    v_fma_f32 v85, -v100, v61, v73
    v_mfma_f32_16x16x32_bf16 v[28:31], v[236:239], v[48:51], v[28:31]
    v_fma_f32 v86, -v100, v62, v74
    v_fma_f32 v87, -v100, v63, v75
    v_mfma_f32_16x16x32_bf16 v[32:35], v[240:243], v[48:51], v[32:35]
    s_waitcnt lgkmcnt(2)
    v_fma_f32 v88, -v100, v64, v76
    v_fma_f32 v89, -v100, v65, v77
    v_mfma_f32_16x16x32_bf16 v[32:35], v[252:255], v[52:55], v[32:35]
    ds_read_b128 v[48:51], v2 offset:2048
    v_fma_f32 v90, -v100, v66, v78
    v_mfma_f32_16x16x32_bf16 v[28:31], v[248:251], v[52:55], v[28:31]
    buffer_load_dwordx4 v1, s[8:11], s37 offen offset:2048 sc1 lds
    v_mfma_f32_16x16x32_bf16 v[24:27], v[244:247], v[52:55], v[24:27]
    buffer_load_dwordx4 v1, s[8:11], s37 offen offset:3072 sc1 lds
    s_add_u32 m0, s34, s41
    s_add_u32 s37, s33, s41
    v_fma_f32 v91, -v100, v67, v79
    buffer_load_dwordx4 v1, s[8:11], s37 offen offset:0 sc1 lds
    s_add_u32 s32, s32, 1
    s_add_u32 s33, s33, 36864
    s_add_u32 s34, s34, 36864
    s_cmp_ge_u32 s34, 147456
    s_cselect_b32 s38, 147456, 0
    s_sub_u32 s34, s34, s38
    s_cmp_ge_i32 s31, 63
    s_cbranch_scc1 L_exit
    s_cmp_eq_u32 s30, 1
    s_cbranch_scc1 Lffa_body01
    s_cmp_eq_u32 s30, 2
    s_cbranch_scc1 Lffa_body02
    s_cmp_eq_u32 s30, 3
    s_cbranch_scc1 Lffa_body03
    s_branch Lffa_body00
Lffa_v13:
    v_mfma_f32_16x16x32_bf16 v[32:35], a[248:251], v[40:43], v[32:35]
    s_waitcnt lgkmcnt(2)
    v_permlane16_swap_b32 v100, v101
    v_mfma_f32_16x16x32_bf16 v[32:35], v[132:135], v[44:47], v[32:35]
    ds_read_b128 v[40:43], v3 offset:24576
    v_add_f32 v100, v100, v101
    v_mfma_f32_16x16x32_bf16 v[28:31], v[128:131], v[44:47], v[28:31]
    v_mov_b32 v101, v100
    v_mfma_f32_16x16x32_bf16 v[24:27], a[252:255], v[44:47], v[24:27]
    s_waitcnt lgkmcnt(2)
    v_permlane32_swap_b32 v100, v101
    v_mfma_f32_16x16x32_bf16 v[24:27], v[136:139], v[48:51], v[24:27]
    ds_read_b128 v[44:47], v3 offset:25600
    v_add_f32 v100, v100, v101
    v_mfma_f32_16x16x32_bf16 v[28:31], v[140:143], v[48:51], v[28:31]
    v_mul_f32 v100, 0x3a800000, v100
    v_mov_b32 v101, v100
    v_mfma_f32_16x16x32_bf16 v[32:35], v[144:147], v[48:51], v[32:35]
    s_waitcnt lgkmcnt(2)
    v_permlane16_swap_b32 v100, v101
    v_mfma_f32_16x16x32_bf16 v[32:35], v[156:159], v[52:55], v[32:35]
    ds_read_b128 v[48:51], v3 offset:26624
    v_fma_f32 v101, -v100, v100, v101
    v_mfma_f32_16x16x32_bf16 v[28:31], v[152:155], v[52:55], v[28:31]
    v_max_f32 v101, 0, v101
    v_add_f32 v101, 0x3727c5ac, v101
    v_mfma_f32_16x16x32_bf16 v[24:27], v[148:151], v[52:55], v[24:27]
    s_waitcnt lgkmcnt(2)
    v_rsq_f32 v21, v101
    v_mfma_f32_16x16x32_bf16 v[24:27], v[160:163], v[40:43], v[24:27]
    ds_read_b128 v[52:55], v3 offset:27648
    v_mul_f32 v100, v100, v21
    v_mfma_f32_16x16x32_bf16 v[28:31], v[164:167], v[40:43], v[28:31]
    v_fma_f32 v80, -v100, v56, v68
    v_fma_f32 v81, -v100, v57, v69
    v_mfma_f32_16x16x32_bf16 v[32:35], v[168:171], v[40:43], v[32:35]
    s_waitcnt lgkmcnt(2)
    buffer_store_dword v6, v22, s[12:15], s17 offen sc1
    v_mfma_f32_16x16x32_bf16 v[32:35], v[180:183], v[44:47], v[32:35]
    ds_read_b128 v[40:43], v3 offset:28672
    v_fma_f32 v82, -v100, v58, v70
    v_mfma_f32_16x16x32_bf16 v[28:31], v[176:179], v[44:47], v[28:31]
    s_mov_b32 s14, s6
    v_fma_f32 v83, -v100, v59, v71
    v_fma_f32 v84, -v100, v60, v72
    v_mfma_f32_16x16x32_bf16 v[24:27], v[172:175], v[44:47], v[24:27]
    s_waitcnt lgkmcnt(2)
    v_fma_f32 v85, -v100, v61, v73
    v_fma_f32 v86, -v100, v62, v74
    v_mfma_f32_16x16x32_bf16 v[24:27], v[184:187], v[48:51], v[24:27]
    ds_read_b128 v[44:47], v3 offset:29696
    v_fma_f32 v87, -v100, v63, v75
    v_mfma_f32_16x16x32_bf16 v[28:31], v[188:191], v[48:51], v[28:31]
    s_add_u32 s17, s17, 8192
    v_fma_f32 v88, -v100, v64, v76
    v_fma_f32 v89, -v100, v65, v77
    v_mfma_f32_16x16x32_bf16 v[32:35], v[192:195], v[48:51], v[32:35]
    s_waitcnt lgkmcnt(2)
    v_fma_f32 v90, -v100, v66, v78
    v_fma_f32 v91, -v100, v67, v79
    v_mfma_f32_16x16x32_bf16 v[32:35], v[204:207], v[52:55], v[32:35]
    ds_read_b128 v[48:51], v3 offset:30720
    v_mfma_f32_16x16x32_bf16 v[28:31], v[200:203], v[52:55], v[28:31]
    buffer_load_dword v5, v4, s[4:7], s16 offen sc1
    v_mfma_f32_16x16x32_bf16 v[24:27], v[196:199], v[52:55], v[24:27]
    s_waitcnt lgkmcnt(2)
    v_mfma_f32_16x16x32_bf16 v[24:27], v[208:211], v[40:43], v[24:27]
    ds_read_b128 v[52:55], v3 offset:31744
    v_mfma_f32_16x16x32_bf16 v[28:31], v[212:215], v[40:43], v[28:31]
    v_mfma_f32_16x16x32_bf16 v[32:35], v[216:219], v[40:43], v[32:35]
    s_waitcnt lgkmcnt(2)
    v_mfma_f32_16x16x32_bf16 v[32:35], v[228:231], v[44:47], v[32:35]
    v_mfma_f32_16x16x32_bf16 v[28:31], v[224:227], v[44:47], v[28:31]
    v_mfma_f32_16x16x32_bf16 v[24:27], v[220:223], v[44:47], v[24:27]
    s_waitcnt lgkmcnt(1)
    v_mfma_f32_16x16x32_bf16 v[24:27], v[232:235], v[48:51], v[24:27]
    v_mfma_f32_16x16x32_bf16 v[28:31], v[236:239], v[48:51], v[28:31]
    v_mfma_f32_16x16x32_bf16 v[32:35], v[240:243], v[48:51], v[32:35]
    s_waitcnt lgkmcnt(0)
    v_mfma_f32_16x16x32_bf16 v[32:35], v[252:255], v[52:55], v[32:35]
    v_mfma_f32_16x16x32_bf16 v[28:31], v[248:251], v[52:55], v[28:31]
    v_mfma_f32_16x16x32_bf16 v[24:27], v[244:247], v[52:55], v[24:27]
    s_nop 5
    v_fma_f32 v124, v32, v21, v88
    v_fma_f32 v125, v33, v21, v89
    v_fma_f32 v126, v34, v21, v90
    v_fma_f32 v127, v35, v21, v91
    v_mul_f32 v124, v124, |v124|
    v_mul_f32 v125, v125, |v125|
    v_mul_f32 v126, v126, |v126|
    v_mul_f32 v127, v127, |v127|
    v_cvt_pk_bf16_f32 v124, v124, v125
    v_cvt_pk_bf16_f32 v126, v126, v127
    v_pk_max_i16 v96, v124, 0
    v_pk_max_i16 v97, v126, 0
    v_pk_max_i16 v98, v124, 0
    v_pk_max_i16 v99, v126, 0
    v_fma_f32 v116, v24, v21, v80
    v_permlane32_swap_b32 v96, v98
    v_permlane32_swap_b32 v97, v99
    buffer_store_dwordx4 v[96:99], v7, s[12:15], s36 offen sc1
    v_fma_f32 v117, v25, v21, v81
    v_fma_f32 v118, v26, v21, v82
    v_fma_f32 v119, v27, v21, v83
    v_fma_f32 v120, v28, v21, v84
    v_fma_f32 v121, v29, v21, v85
    v_fma_f32 v122, v30, v21, v86
    v_fma_f32 v123, v31, v21, v87
    v_mul_f32 v116, v116, |v116|
    v_mul_f32 v117, v117, |v117|
    v_mul_f32 v118, v118, |v118|
    v_mul_f32 v119, v119, |v119|
    v_mul_f32 v120, v120, |v120|
    v_mul_f32 v121, v121, |v121|
    v_mul_f32 v122, v122, |v122|
    v_mul_f32 v123, v123, |v123|
    v_cvt_pk_bf16_f32 v116, v116, v117
    v_cvt_pk_bf16_f32 v118, v118, v119
    v_cvt_pk_bf16_f32 v120, v120, v121
    v_cvt_pk_bf16_f32 v122, v122, v123
    v_pk_max_i16 v92, v116, 0
    v_pk_max_i16 v93, v118, 0
    v_pk_max_i16 v94, v120, 0
    v_pk_max_i16 v95, v122, 0
    buffer_store_dwordx4 v[92:95], v1, s[12:15], s36 offen sc1
    s_add_u32 s54, s31, 1
    v_mov_b32 v6, s54
    s_waitcnt vmcnt(2)
    s_cmp_ge_i32 s31, 63
    s_cbranch_scc1 Lffa_late1
    v_cmp_gt_i32 vcc, s32, v5
    s_sub_u32 s43, s43, 1
    s_cmp_lt_i32 s43, 0
    s_cbranch_scc1 Lffa_rdy1
    s_and_b64 vcc, vcc, s[18:19]
    s_cbranch_scc0 Lffa_rdy1
Lffa_late1:
    buffer_load_dword v5, v4, s[4:7], s16 offen sc1
    s_waitcnt vmcnt(1)
    buffer_store_dword v6, v22, s[12:15], s17 offen sc1
    s_mov_b32 s14, 0
    s_cmp_ge_i32 s31, 63
    s_cbranch_scc1 L_exit
    s_waitcnt vmcnt(1)
    v_cmp_gt_i32 vcc, s32, v5
    s_sub_u32 s43, s43, 1
    s_cmp_lt_i32 s43, 0
    s_cbranch_scc1 Lffa_rdy1
    s_and_b64 vcc, vcc, s[18:19]
    s_cbranch_scc0 Lffa_rdy1
Lffa_spin1:
    buffer_load_dword v5, v4, s[4:7], s16 offen sc1
    s_waitcnt vmcnt(0)
    v_cmp_gt_i32 vcc, s32, v5
    s_sub_u32 s43, s43, 1
    s_cmp_lt_i32 s43, 0
    s_cbranch_scc1 Lffa_rdy1
    s_and_b64 vcc, vcc, s[18:19]
    s_cbranch_scc0 Lffa_rdy1
    s_sleep 8
    s_branch Lffa_spin1
Lffa_rdy1:
    s_add_u32 m0, s34, 0
    s_nop 0
    buffer_load_dwordx4 v1, s[8:11], s33 offen offset:0 sc1 lds
    buffer_load_dwordx4 v1, s[8:11], s33 offen offset:1024 sc1 lds
    buffer_load_dwordx4 v1, s[8:11], s33 offen offset:2048 sc1 lds
    buffer_load_dwordx4 v1, s[8:11], s33 offen offset:3072 sc1 lds
    s_add_u32 s16, s16, 8192
    buffer_load_dword v5, v4, s[4:7], s16 offen sc1
    s_add_u32 m0, s34, s3
    s_add_u32 s37, s33, s3
    buffer_load_dwordx4 v1, s[8:11], s37 offen offset:0 sc1 lds
    buffer_load_dwordx4 v1, s[8:11], s37 offen offset:1024 sc1 lds
    buffer_load_dwordx4 v1, s[8:11], s37 offen offset:2048 sc1 lds
    buffer_load_dwordx4 v1, s[8:11], s37 offen offset:3072 sc1 lds
    s_add_u32 m0, s34, s41
    s_add_u32 s37, s33, s41
    buffer_load_dwordx4 v1, s[8:11], s37 offen offset:0 sc1 lds
    s_add_u32 s32, s32, 1
    s_add_u32 s33, s33, 36864
    s_add_u32 s34, s34, 36864
    s_cmp_ge_u32 s34, 147456
    s_cselect_b32 s38, 147456, 0
    s_sub_u32 s34, s34, s38
    s_waitcnt vmcnt(6)
    buffer_store_dword v6, v22, s[12:15], s17 offen sc1
Lffa_go1:
    s_mov_b32 s14, 0
    s_barrier
    ds_read_b128 v[40:43], v2 offset:0
    ds_read_b128 v[44:47], v2 offset:1024
    ds_read_b128 v[48:51], v2 offset:2048
    s_cmp_eq_u32 s30, 1
    s_cbranch_scc1 Lffa_body01
    s_cmp_eq_u32 s30, 2
    s_cbranch_scc1 Lffa_body02
    s_cmp_eq_u32 s30, 3
    s_cbranch_scc1 Lffa_body03
    s_branch Lffa_body00
Lffb_start:
    s_mov_b32 s12, s76
    s_mov_b32 s13, s77
    s_mov_b32 s14, 0x700000
    s_mov_b32 s15, 0x00020000
    v_lshrrev_b32 v24, 3, v0
    v_mul_u32_u24 v24, 2048, v24
    v_bfe_u32 v25, v0, 4, 2
    v_lshlrev_b32 v25, 1, v25
    v_and_b32 v26, 7, v0
    v_xor_b32 v25, v25, v26
    v_lshl_add_u32 v40, v25, 4, v24
    v_add_u32 v41, 15360, v40
    s_sub_u32 s38, s29, 44
    s_and_b32 s39, s38, 3
    s_lshr_b32 s38, s38, 2
    s_mul_i32 s86, s38, 0x180000
    s_mul_i32 s53, s39, 0x200
    s_add_u32 s86, s86, s53
    s_mul_i32 s37, s30, 32768
    s_add_u32 s86, s86, s37
    s_lshl_b32 s87, s30, 11
    s_add_u32 m0, s87, 0
    s_add_u32 s37, s86, 0
    buffer_load_dwordx4 v40, s[12:15], s37 offen offset:0 lds
    buffer_load_dwordx4 v41, s[12:15], s37 offen offset:1024 lds
    s_add_u32 m0, s87, 8192
    s_add_u32 s37, s86, 128
    buffer_load_dwordx4 v40, s[12:15], s37 offen offset:0 lds
    buffer_load_dwordx4 v41, s[12:15], s37 offen offset:1024 lds
    s_add_u32 m0, s87, 16384
    s_add_u32 s37, s86, 256
    buffer_load_dwordx4 v40, s[12:15], s37 offen offset:0 lds
    buffer_load_dwordx4 v41, s[12:15], s37 offen offset:1024 lds
    s_add_u32 m0, s87, 24576
    s_add_u32 s37, s86, 384
    buffer_load_dwordx4 v40, s[12:15], s37 offen offset:0 lds
    buffer_load_dwordx4 v41, s[12:15], s37 offen offset:1024 lds
    s_add_u32 m0, s87, 32768
    s_add_u32 s37, s86, 131072
    buffer_load_dwordx4 v40, s[12:15], s37 offen offset:0 lds
    buffer_load_dwordx4 v41, s[12:15], s37 offen offset:1024 lds
    s_add_u32 m0, s87, 40960
    s_add_u32 s37, s86, 131200
    buffer_load_dwordx4 v40, s[12:15], s37 offen offset:0 lds
    buffer_load_dwordx4 v41, s[12:15], s37 offen offset:1024 lds
    s_add_u32 m0, s87, 49152
    s_add_u32 s37, s86, 131328
    buffer_load_dwordx4 v40, s[12:15], s37 offen offset:0 lds
    buffer_load_dwordx4 v41, s[12:15], s37 offen offset:1024 lds
    s_add_u32 m0, s87, 57344
    s_add_u32 s37, s86, 131456
    buffer_load_dwordx4 v40, s[12:15], s37 offen offset:0 lds
    buffer_load_dwordx4 v41, s[12:15], s37 offen offset:1024 lds
    s_add_u32 m0, s87, 65536
    s_add_u32 s37, s86, 262144
    buffer_load_dwordx4 v40, s[12:15], s37 offen offset:0 lds
    buffer_load_dwordx4 v41, s[12:15], s37 offen offset:1024 lds
    s_add_u32 m0, s87, 73728
    s_add_u32 s37, s86, 262272
    buffer_load_dwordx4 v40, s[12:15], s37 offen offset:0 lds
    buffer_load_dwordx4 v41, s[12:15], s37 offen offset:1024 lds
    s_add_u32 m0, s87, 81920
    s_add_u32 s37, s86, 262400
    buffer_load_dwordx4 v40, s[12:15], s37 offen offset:0 lds
    buffer_load_dwordx4 v41, s[12:15], s37 offen offset:1024 lds
    s_add_u32 m0, s87, 90112
    s_add_u32 s37, s86, 262528
    buffer_load_dwordx4 v40, s[12:15], s37 offen offset:0 lds
    buffer_load_dwordx4 v41, s[12:15], s37 offen offset:1024 lds
    s_add_u32 m0, s87, 98304
    s_add_u32 s37, s86, 393216
    buffer_load_dwordx4 v40, s[12:15], s37 offen offset:0 lds
    buffer_load_dwordx4 v41, s[12:15], s37 offen offset:1024 lds
    s_add_u32 m0, s87, 106496
    s_add_u32 s37, s86, 393344
    buffer_load_dwordx4 v40, s[12:15], s37 offen offset:0 lds
    buffer_load_dwordx4 v41, s[12:15], s37 offen offset:1024 lds
    s_add_u32 m0, s87, 114688
    s_add_u32 s37, s86, 393472
    buffer_load_dwordx4 v40, s[12:15], s37 offen offset:0 lds
    buffer_load_dwordx4 v41, s[12:15], s37 offen offset:1024 lds
    s_add_u32 m0, s87, 122880
    s_add_u32 s37, s86, 393600
    buffer_load_dwordx4 v40, s[12:15], s37 offen offset:0 lds
    buffer_load_dwordx4 v41, s[12:15], s37 offen offset:1024 lds
    v_bfe_u32 v24, v0, 3, 2
    v_and_b32 v25, 3, v0
    v_lshlrev_b32 v25, 3, v25
    v_lshrrev_b32 v26, 2, v0
    v_lshl_add_u32 v26, v26, 7, v25
    v_lshrrev_b32 v27, 5, v0
    v_lshl_add_u32 v27, v27, 10, v26
    s_mov_b32 s37, s30
    s_mov_b32 s38, 0
    s_lshl_b32 s37, s37, 13
    v_xor_b32 v28, s38, v24
    v_lshl_add_u32 v28, v28, 5, s37
    v_add_u32 v42, v28, v26
    v_add_u32 v46, v28, v27
    s_mov_b32 s37, s30
    s_mov_b32 s38, 1
    s_lshl_b32 s37, s37, 13
    v_xor_b32 v28, s38, v24
    v_lshl_add_u32 v28, v28, 5, s37
    v_add_u32 v43, v28, v26
    v_add_u32 v47, v28, v27
    s_mov_b32 s37, s30
    s_mov_b32 s38, 2
    s_lshl_b32 s37, s37, 13
    v_xor_b32 v28, s38, v24
    v_lshl_add_u32 v28, v28, 5, s37
    v_add_u32 v44, v28, v26
    v_add_u32 v48, v28, v27
    s_mov_b32 s37, s30
    s_mov_b32 s38, 3
    s_lshl_b32 s37, s37, 13
    v_xor_b32 v28, s38, v24
    v_lshl_add_u32 v28, v28, 5, s37
    v_add_u32 v45, v28, v26
    v_add_u32 v49, v28, v27
    s_sub_u32 s38, s29, 44
    s_and_b32 s39, s38, 3
    s_lshr_b32 s38, s38, 2
    s_mul_i32 s37, s28, 0x80000
    s_mul_i32 s53, s38, 0x200
    s_add_u32 s37, s37, s53
    s_add_u32 s37, s37, 0x6000c00
    v_min_u32 v4, 15, v0
    v_lshl_add_u32 v4, v4, 5, s37
    s_mov_b32 s32, 1
    s_mul_i32 s33, s28, 0x720000
    s_mul_i32 s53, s38, 0x6000
    s_add_u32 s33, s33, s53
    s_add_u32 s33, s33, 0x2000000
    s_mul_i32 s36, s28, 0x800000
    s_mul_i32 s53, s38, 0x8000
    s_add_u32 s36, s36, s53
    s_mul_i32 s53, s39, 0x2000
    s_add_u32 s36, s36, s53
    s_mul_i32 s53, s30, 0x800
    s_add_u32 s36, s36, s53
    s_add_u32 s36, s36, 0x3fe0000
    s_mov_b32 s31, -1
    s_mov_b32 s35, 0
    s_mov_b32 s16, 0
    v_mov_b32 v5, 0
    s_mul_i32 s17, s28, 0x80000
    s_mul_i32 s53, s29, 0x80
    s_add_u32 s17, s17, s53
    s_mul_i32 s53, s30, 0x20
    s_add_u32 s17, s17, s53
    s_add_u32 s17, s17, 0x5ffe000
    v_cmp_eq_u32 vcc, 0, v0
    v_mov_b32 v80, 0x40000000
    s_nop 0
    v_cndmask_b32 v80, v80, v0, vcc
    v_mov_b32 v2, v1
    s_mul_i32 s34, s30, 3072
    s_mul_i32 s3, s30, 0x0
    s_add_u32 s3, s3, 0x3000
    s_add_u32 s41, s3, 4096
    s_add_u32 s33, s33, s34
    s_mov_b64 s[18:19], 0xffff
    v_mov_b32 v8, 0x40000000
    v_cndmask_b32 v4, v8, v4, s[18:19]
    v_add_u32 v12, 0, v42
    v_add_u32 v13, 0, v43
    v_add_u32 v14, 0, v44
    v_add_u32 v15, 0, v45
    s_waitcnt vmcnt(24) lgkmcnt(0)
    s_barrier
    s_add_u32 m0, s87, 131072
    s_add_u32 s37, s86, 524288
    buffer_load_dwordx4 v40, s[12:15], s37 offen offset:0 lds
    ds_read_b64_tr_b16 a[0:1], v12 offset:0
    ds_read_b64_tr_b16 a[2:3], v12 offset:2048
    ds_read_b64_tr_b16 a[4:5], v13 offset:0
    buffer_load_dwordx4 v41, s[12:15], s37 offen offset:1024 lds
    ds_read_b64_tr_b16 a[6:7], v13 offset:2048
    ds_read_b64_tr_b16 a[8:9], v14 offset:0
    ds_read_b64_tr_b16 a[10:11], v14 offset:2048
    s_add_u32 m0, s87, 139264
    s_add_u32 s37, s86, 524416
    buffer_load_dwordx4 v40, s[12:15], s37 offen offset:0 lds
    ds_read_b64_tr_b16 a[12:13], v15 offset:0
    ds_read_b64_tr_b16 a[14:15], v15 offset:2048
    ds_read_b64_tr_b16 a[16:17], v12 offset:4096
    buffer_load_dwordx4 v41, s[12:15], s37 offen offset:1024 lds
    ds_read_b64_tr_b16 a[18:19], v12 offset:6144
    ds_read_b64_tr_b16 a[20:21], v13 offset:4096
    ds_read_b64_tr_b16 a[22:23], v13 offset:6144
    s_add_u32 m0, s87, 147456
    s_add_u32 s37, s86, 524544
    buffer_load_dwordx4 v40, s[12:15], s37 offen offset:0 lds
    ds_read_b64_tr_b16 a[24:25], v14 offset:4096
    ds_read_b64_tr_b16 a[26:27], v14 offset:6144
    ds_read_b64_tr_b16 a[28:29], v15 offset:4096
    buffer_load_dwordx4 v41, s[12:15], s37 offen offset:1024 lds
    ds_read_b64_tr_b16 a[30:31], v15 offset:6144
    v_add_u32 v16, 32768, v42
    v_add_u32 v17, 32768, v43
    s_add_u32 m0, s87, 155648
    s_add_u32 s37, s86, 524672
    buffer_load_dwordx4 v40, s[12:15], s37 offen offset:0 lds
    v_add_u32 v18, 32768, v44
    v_add_u32 v19, 32768, v45
    buffer_load_dwordx4 v41, s[12:15], s37 offen offset:1024 lds
    s_waitcnt vmcnt(24) lgkmcnt(0)
    s_barrier
    s_add_u32 m0, s87, 0
    s_add_u32 s37, s86, 655360
    buffer_load_dwordx4 v40, s[12:15], s37 offen offset:0 lds
    ds_read_b64_tr_b16 a[32:33], v16 offset:0
    ds_read_b64_tr_b16 a[34:35], v16 offset:2048
    ds_read_b64_tr_b16 a[36:37], v17 offset:0
    buffer_load_dwordx4 v41, s[12:15], s37 offen offset:1024 lds
    ds_read_b64_tr_b16 a[38:39], v17 offset:2048
    ds_read_b64_tr_b16 a[40:41], v18 offset:0
    ds_read_b64_tr_b16 a[42:43], v18 offset:2048
    s_add_u32 m0, s87, 8192
    s_add_u32 s37, s86, 655488
    buffer_load_dwordx4 v40, s[12:15], s37 offen offset:0 lds
    ds_read_b64_tr_b16 a[44:45], v19 offset:0
    ds_read_b64_tr_b16 a[46:47], v19 offset:2048
    ds_read_b64_tr_b16 a[48:49], v16 offset:4096
    buffer_load_dwordx4 v41, s[12:15], s37 offen offset:1024 lds
    ds_read_b64_tr_b16 a[50:51], v16 offset:6144
    ds_read_b64_tr_b16 a[52:53], v17 offset:4096
    ds_read_b64_tr_b16 a[54:55], v17 offset:6144
    s_add_u32 m0, s87, 16384
    s_add_u32 s37, s86, 655616
    buffer_load_dwordx4 v40, s[12:15], s37 offen offset:0 lds
    ds_read_b64_tr_b16 a[56:57], v18 offset:4096
    ds_read_b64_tr_b16 a[58:59], v18 offset:6144
    ds_read_b64_tr_b16 a[60:61], v19 offset:4096
    buffer_load_dwordx4 v41, s[12:15], s37 offen offset:1024 lds
    ds_read_b64_tr_b16 a[62:63], v19 offset:6144
    v_add_u32 v12, 65536, v46
    v_add_u32 v13, 65536, v47
    s_add_u32 m0, s87, 24576
    s_add_u32 s37, s86, 655744
    buffer_load_dwordx4 v40, s[12:15], s37 offen offset:0 lds
    v_add_u32 v14, 65536, v48
    v_add_u32 v15, 65536, v49
    buffer_load_dwordx4 v41, s[12:15], s37 offen offset:1024 lds
    s_waitcnt vmcnt(24) lgkmcnt(0)
    s_barrier
    s_add_u32 m0, s87, 32768
    s_add_u32 s37, s86, 786432
    buffer_load_dwordx4 v40, s[12:15], s37 offen offset:0 lds
    ds_read_b64_tr_b16 a[64:65], v12 offset:0
    ds_read_b64_tr_b16 a[66:67], v12 offset:1024
    ds_read_b64_tr_b16 a[68:69], v13 offset:0
    buffer_load_dwordx4 v41, s[12:15], s37 offen offset:1024 lds
    ds_read_b64_tr_b16 a[70:71], v13 offset:1024
    ds_read_b64_tr_b16 a[72:73], v14 offset:0
    ds_read_b64_tr_b16 a[74:75], v14 offset:1024
    s_add_u32 m0, s87, 40960
    s_add_u32 s37, s86, 786560
    buffer_load_dwordx4 v40, s[12:15], s37 offen offset:0 lds
    ds_read_b64_tr_b16 a[76:77], v15 offset:0
    ds_read_b64_tr_b16 a[78:79], v15 offset:1024
    ds_read_b64_tr_b16 a[80:81], v12 offset:4096
    buffer_load_dwordx4 v41, s[12:15], s37 offen offset:1024 lds
    ds_read_b64_tr_b16 a[82:83], v12 offset:5120
    ds_read_b64_tr_b16 a[84:85], v13 offset:4096
    ds_read_b64_tr_b16 a[86:87], v13 offset:5120
    s_add_u32 m0, s87, 49152
    s_add_u32 s37, s86, 786688
    buffer_load_dwordx4 v40, s[12:15], s37 offen offset:0 lds
    ds_read_b64_tr_b16 a[88:89], v14 offset:4096
    ds_read_b64_tr_b16 a[90:91], v14 offset:5120
    ds_read_b64_tr_b16 a[92:93], v15 offset:4096
    buffer_load_dwordx4 v41, s[12:15], s37 offen offset:1024 lds
    ds_read_b64_tr_b16 a[94:95], v15 offset:5120
    v_add_u32 v16, 98304, v42
    v_add_u32 v17, 98304, v43
    s_add_u32 m0, s87, 57344
    s_add_u32 s37, s86, 786816
    buffer_load_dwordx4 v40, s[12:15], s37 offen offset:0 lds
    v_add_u32 v18, 98304, v44
    v_add_u32 v19, 98304, v45
    buffer_load_dwordx4 v41, s[12:15], s37 offen offset:1024 lds
    s_waitcnt vmcnt(24) lgkmcnt(0)
    s_barrier
    s_add_u32 m0, s87, 65536
    s_add_u32 s37, s86, 917504
    buffer_load_dwordx4 v40, s[12:15], s37 offen offset:0 lds
    ds_read_b64_tr_b16 a[96:97], v16 offset:0
    ds_read_b64_tr_b16 a[98:99], v16 offset:2048
    ds_read_b64_tr_b16 a[100:101], v17 offset:0
    buffer_load_dwordx4 v41, s[12:15], s37 offen offset:1024 lds
    ds_read_b64_tr_b16 a[102:103], v17 offset:2048
    ds_read_b64_tr_b16 a[104:105], v18 offset:0
    ds_read_b64_tr_b16 a[106:107], v18 offset:2048
    s_add_u32 m0, s87, 73728
    s_add_u32 s37, s86, 917632
    buffer_load_dwordx4 v40, s[12:15], s37 offen offset:0 lds
    ds_read_b64_tr_b16 a[108:109], v19 offset:0
    ds_read_b64_tr_b16 a[110:111], v19 offset:2048
    ds_read_b64_tr_b16 a[112:113], v16 offset:4096
    buffer_load_dwordx4 v41, s[12:15], s37 offen offset:1024 lds
    ds_read_b64_tr_b16 a[114:115], v16 offset:6144
    ds_read_b64_tr_b16 a[116:117], v17 offset:4096
    ds_read_b64_tr_b16 a[118:119], v17 offset:6144
    s_add_u32 m0, s87, 81920
    s_add_u32 s37, s86, 917760
    buffer_load_dwordx4 v40, s[12:15], s37 offen offset:0 lds
    ds_read_b64_tr_b16 a[120:121], v18 offset:4096
    ds_read_b64_tr_b16 a[122:123], v18 offset:6144
    ds_read_b64_tr_b16 a[124:125], v19 offset:4096
    buffer_load_dwordx4 v41, s[12:15], s37 offen offset:1024 lds
    ds_read_b64_tr_b16 a[126:127], v19 offset:6144
    v_add_u32 v12, 131072, v42
    v_add_u32 v13, 131072, v43
    s_add_u32 m0, s87, 90112
    s_add_u32 s37, s86, 917888
    buffer_load_dwordx4 v40, s[12:15], s37 offen offset:0 lds
    v_add_u32 v14, 131072, v44
    v_add_u32 v15, 131072, v45
    buffer_load_dwordx4 v41, s[12:15], s37 offen offset:1024 lds
    s_waitcnt vmcnt(24) lgkmcnt(0)
    s_barrier
    s_add_u32 m0, s87, 98304
    s_add_u32 s37, s86, 1048576
    buffer_load_dwordx4 v40, s[12:15], s37 offen offset:0 lds
    ds_read_b64_tr_b16 a[128:129], v12 offset:0
    ds_read_b64_tr_b16 a[130:131], v12 offset:2048
    ds_read_b64_tr_b16 a[132:133], v13 offset:0
    buffer_load_dwordx4 v41, s[12:15], s37 offen offset:1024 lds
    ds_read_b64_tr_b16 a[134:135], v13 offset:2048
    ds_read_b64_tr_b16 a[136:137], v14 offset:0
    ds_read_b64_tr_b16 a[138:139], v14 offset:2048
    s_add_u32 m0, s87, 106496
    s_add_u32 s37, s86, 1048704
    buffer_load_dwordx4 v40, s[12:15], s37 offen offset:0 lds
    ds_read_b64_tr_b16 a[140:141], v15 offset:0
    ds_read_b64_tr_b16 a[142:143], v15 offset:2048
    ds_read_b64_tr_b16 a[144:145], v12 offset:4096
    buffer_load_dwordx4 v41, s[12:15], s37 offen offset:1024 lds
    ds_read_b64_tr_b16 a[146:147], v12 offset:6144
    ds_read_b64_tr_b16 a[148:149], v13 offset:4096
    ds_read_b64_tr_b16 a[150:151], v13 offset:6144
    s_add_u32 m0, s87, 114688
    s_add_u32 s37, s86, 1048832
    buffer_load_dwordx4 v40, s[12:15], s37 offen offset:0 lds
    ds_read_b64_tr_b16 a[152:153], v14 offset:4096
    ds_read_b64_tr_b16 a[154:155], v14 offset:6144
    ds_read_b64_tr_b16 a[156:157], v15 offset:4096
    buffer_load_dwordx4 v41, s[12:15], s37 offen offset:1024 lds
    ds_read_b64_tr_b16 a[158:159], v15 offset:6144
    v_add_u32 v16, 0, v46
    v_add_u32 v17, 0, v47
    s_add_u32 m0, s87, 122880
    s_add_u32 s37, s86, 1048960
    buffer_load_dwordx4 v40, s[12:15], s37 offen offset:0 lds
    v_add_u32 v18, 0, v48
    v_add_u32 v19, 0, v49
    buffer_load_dwordx4 v41, s[12:15], s37 offen offset:1024 lds
    s_waitcnt vmcnt(24) lgkmcnt(0)
    s_barrier
    s_add_u32 m0, s87, 131072
    s_add_u32 s37, s86, 1179648
    buffer_load_dwordx4 v40, s[12:15], s37 offen offset:0 lds
    ds_read_b64_tr_b16 a[160:161], v16 offset:0
    ds_read_b64_tr_b16 a[162:163], v16 offset:1024
    ds_read_b64_tr_b16 a[164:165], v17 offset:0
    buffer_load_dwordx4 v41, s[12:15], s37 offen offset:1024 lds
    ds_read_b64_tr_b16 a[166:167], v17 offset:1024
    ds_read_b64_tr_b16 a[168:169], v18 offset:0
    ds_read_b64_tr_b16 a[170:171], v18 offset:1024
    s_add_u32 m0, s87, 139264
    s_add_u32 s37, s86, 1179776
    buffer_load_dwordx4 v40, s[12:15], s37 offen offset:0 lds
    ds_read_b64_tr_b16 a[172:173], v19 offset:0
    ds_read_b64_tr_b16 a[174:175], v19 offset:1024
    ds_read_b64_tr_b16 a[176:177], v16 offset:4096
    buffer_load_dwordx4 v41, s[12:15], s37 offen offset:1024 lds
    ds_read_b64_tr_b16 a[178:179], v16 offset:5120
    ds_read_b64_tr_b16 a[180:181], v17 offset:4096
    ds_read_b64_tr_b16 a[182:183], v17 offset:5120
    s_add_u32 m0, s87, 147456
    s_add_u32 s37, s86, 1179904
    buffer_load_dwordx4 v40, s[12:15], s37 offen offset:0 lds
    ds_read_b64_tr_b16 a[184:185], v18 offset:4096
    ds_read_b64_tr_b16 a[186:187], v18 offset:5120
    ds_read_b64_tr_b16 a[188:189], v19 offset:4096
    buffer_load_dwordx4 v41, s[12:15], s37 offen offset:1024 lds
    ds_read_b64_tr_b16 a[190:191], v19 offset:5120
    v_add_u32 v12, 32768, v42
    v_add_u32 v13, 32768, v43
    s_add_u32 m0, s87, 155648
    s_add_u32 s37, s86, 1180032
    buffer_load_dwordx4 v40, s[12:15], s37 offen offset:0 lds
    v_add_u32 v14, 32768, v44
    v_add_u32 v15, 32768, v45
    buffer_load_dwordx4 v41, s[12:15], s37 offen offset:1024 lds
    s_waitcnt vmcnt(24) lgkmcnt(0)
    s_barrier
    s_add_u32 m0, s87, 0
    s_add_u32 s37, s86, 1310720
    buffer_load_dwordx4 v40, s[12:15], s37 offen offset:0 lds
    ds_read_b64_tr_b16 a[192:193], v12 offset:0
    ds_read_b64_tr_b16 a[194:195], v12 offset:2048
    ds_read_b64_tr_b16 a[196:197], v13 offset:0
    buffer_load_dwordx4 v41, s[12:15], s37 offen offset:1024 lds
    ds_read_b64_tr_b16 a[198:199], v13 offset:2048
    ds_read_b64_tr_b16 a[200:201], v14 offset:0
    ds_read_b64_tr_b16 a[202:203], v14 offset:2048
    s_add_u32 m0, s87, 8192
    s_add_u32 s37, s86, 1310848
    buffer_load_dwordx4 v40, s[12:15], s37 offen offset:0 lds
    ds_read_b64_tr_b16 a[204:205], v15 offset:0
    ds_read_b64_tr_b16 a[206:207], v15 offset:2048
    ds_read_b64_tr_b16 a[208:209], v12 offset:4096
    buffer_load_dwordx4 v41, s[12:15], s37 offen offset:1024 lds
    ds_read_b64_tr_b16 a[210:211], v12 offset:6144
    ds_read_b64_tr_b16 a[212:213], v13 offset:4096
    ds_read_b64_tr_b16 a[214:215], v13 offset:6144
    s_add_u32 m0, s87, 16384
    s_add_u32 s37, s86, 1310976
    buffer_load_dwordx4 v40, s[12:15], s37 offen offset:0 lds
    ds_read_b64_tr_b16 a[216:217], v14 offset:4096
    ds_read_b64_tr_b16 a[218:219], v14 offset:6144
    ds_read_b64_tr_b16 a[220:221], v15 offset:4096
    buffer_load_dwordx4 v41, s[12:15], s37 offen offset:1024 lds
    ds_read_b64_tr_b16 a[222:223], v15 offset:6144
    v_add_u32 v16, 65536, v42
    v_add_u32 v17, 65536, v43
    s_add_u32 m0, s87, 24576
    s_add_u32 s37, s86, 1311104
    buffer_load_dwordx4 v40, s[12:15], s37 offen offset:0 lds
    v_add_u32 v18, 65536, v44
    v_add_u32 v19, 65536, v45
    buffer_load_dwordx4 v41, s[12:15], s37 offen offset:1024 lds
    s_waitcnt vmcnt(24) lgkmcnt(0)
    s_barrier
    s_add_u32 m0, s87, 32768
    s_add_u32 s37, s86, 1441792
    buffer_load_dwordx4 v40, s[12:15], s37 offen offset:0 lds
    ds_read_b64_tr_b16 a[224:225], v16 offset:0
    ds_read_b64_tr_b16 a[226:227], v16 offset:2048
    ds_read_b64_tr_b16 a[228:229], v17 offset:0
    buffer_load_dwordx4 v41, s[12:15], s37 offen offset:1024 lds
    ds_read_b64_tr_b16 a[230:231], v17 offset:2048
    ds_read_b64_tr_b16 a[232:233], v18 offset:0
    ds_read_b64_tr_b16 a[234:235], v18 offset:2048
    s_add_u32 m0, s87, 40960
    s_add_u32 s37, s86, 1441920
    buffer_load_dwordx4 v40, s[12:15], s37 offen offset:0 lds
    ds_read_b64_tr_b16 a[236:237], v19 offset:0
    ds_read_b64_tr_b16 a[238:239], v19 offset:2048
    ds_read_b64_tr_b16 a[240:241], v16 offset:4096
    buffer_load_dwordx4 v41, s[12:15], s37 offen offset:1024 lds
    ds_read_b64_tr_b16 a[242:243], v16 offset:6144
    ds_read_b64_tr_b16 a[244:245], v17 offset:4096
    ds_read_b64_tr_b16 a[246:247], v17 offset:6144
    s_add_u32 m0, s87, 49152
    s_add_u32 s37, s86, 1442048
    buffer_load_dwordx4 v40, s[12:15], s37 offen offset:0 lds
    ds_read_b64_tr_b16 a[248:249], v18 offset:4096
    ds_read_b64_tr_b16 a[250:251], v18 offset:6144
    ds_read_b64_tr_b16 a[252:253], v19 offset:4096
    buffer_load_dwordx4 v41, s[12:15], s37 offen offset:1024 lds
    ds_read_b64_tr_b16 a[254:255], v19 offset:6144
    v_add_u32 v12, 98304, v46
    v_add_u32 v13, 98304, v47
    s_add_u32 m0, s87, 57344
    s_add_u32 s37, s86, 1442176
    buffer_load_dwordx4 v40, s[12:15], s37 offen offset:0 lds
    v_add_u32 v14, 98304, v48
    v_add_u32 v15, 98304, v49
    buffer_load_dwordx4 v41, s[12:15], s37 offen offset:1024 lds
    s_waitcnt vmcnt(24) lgkmcnt(0)
    s_barrier
    ds_read_b64_tr_b16 v[128:129], v12 offset:0
    ds_read_b64_tr_b16 v[130:131], v12 offset:1024
    ds_read_b64_tr_b16 v[132:133], v13 offset:0
    ds_read_b64_tr_b16 v[134:135], v13 offset:1024
    ds_read_b64_tr_b16 v[136:137], v14 offset:0
    ds_read_b64_tr_b16 v[138:139], v14 offset:1024
    ds_read_b64_tr_b16 v[140:141], v15 offset:0
    ds_read_b64_tr_b16 v[142:143], v15 offset:1024
    ds_read_b64_tr_b16 v[144:145], v12 offset:4096
    ds_read_b64_tr_b16 v[146:147], v12 offset:5120
    ds_read_b64_tr_b16 v[148:149], v13 offset:4096
    ds_read_b64_tr_b16 v[150:151], v13 offset:5120
    ds_read_b64_tr_b16 v[152:153], v14 offset:4096
    ds_read_b64_tr_b16 v[154:155], v14 offset:5120
    ds_read_b64_tr_b16 v[156:157], v15 offset:4096
    ds_read_b64_tr_b16 v[158:159], v15 offset:5120
    v_add_u32 v16, 131072, v42
    v_add_u32 v17, 131072, v43
    v_add_u32 v18, 131072, v44
    v_add_u32 v19, 131072, v45
    s_waitcnt vmcnt(16) lgkmcnt(0)
    s_barrier
    ds_read_b64_tr_b16 v[160:161], v16 offset:0
    ds_read_b64_tr_b16 v[162:163], v16 offset:2048
    ds_read_b64_tr_b16 v[164:165], v17 offset:0
    ds_read_b64_tr_b16 v[166:167], v17 offset:2048
    ds_read_b64_tr_b16 v[168:169], v18 offset:0
    ds_read_b64_tr_b16 v[170:171], v18 offset:2048
    ds_read_b64_tr_b16 v[172:173], v19 offset:0
    ds_read_b64_tr_b16 v[174:175], v19 offset:2048
    ds_read_b64_tr_b16 v[176:177], v16 offset:4096
    ds_read_b64_tr_b16 v[178:179], v16 offset:6144
    ds_read_b64_tr_b16 v[180:181], v17 offset:4096
    ds_read_b64_tr_b16 v[182:183], v17 offset:6144
    ds_read_b64_tr_b16 v[184:185], v18 offset:4096
    ds_read_b64_tr_b16 v[186:187], v18 offset:6144
    ds_read_b64_tr_b16 v[188:189], v19 offset:4096
    ds_read_b64_tr_b16 v[190:191], v19 offset:6144
    v_add_u32 v12, 0, v42
    v_add_u32 v13, 0, v43
    v_add_u32 v14, 0, v44
    v_add_u32 v15, 0, v45
    s_waitcnt vmcnt(8) lgkmcnt(0)
    s_barrier
    ds_read_b64_tr_b16 v[192:193], v12 offset:0
    ds_read_b64_tr_b16 v[194:195], v12 offset:2048
    ds_read_b64_tr_b16 v[196:197], v13 offset:0
    ds_read_b64_tr_b16 v[198:199], v13 offset:2048
    ds_read_b64_tr_b16 v[200:201], v14 offset:0
    ds_read_b64_tr_b16 v[202:203], v14 offset:2048
    ds_read_b64_tr_b16 v[204:205], v15 offset:0
    ds_read_b64_tr_b16 v[206:207], v15 offset:2048
    ds_read_b64_tr_b16 v[208:209], v12 offset:4096
    ds_read_b64_tr_b16 v[210:211], v12 offset:6144
    ds_read_b64_tr_b16 v[212:213], v13 offset:4096
    ds_read_b64_tr_b16 v[214:215], v13 offset:6144
    ds_read_b64_tr_b16 v[216:217], v14 offset:4096
    ds_read_b64_tr_b16 v[218:219], v14 offset:6144
    ds_read_b64_tr_b16 v[220:221], v15 offset:4096
    ds_read_b64_tr_b16 v[222:223], v15 offset:6144
    v_add_u32 v16, 32768, v46
    v_add_u32 v17, 32768, v47
    v_add_u32 v18, 32768, v48
    v_add_u32 v19, 32768, v49
    s_waitcnt vmcnt(0) lgkmcnt(0)
    s_barrier
    ds_read_b64_tr_b16 v[224:225], v16 offset:0
    ds_read_b64_tr_b16 v[226:227], v16 offset:1024
    ds_read_b64_tr_b16 v[228:229], v17 offset:0
    ds_read_b64_tr_b16 v[230:231], v17 offset:1024
    ds_read_b64_tr_b16 v[232:233], v18 offset:0
    ds_read_b64_tr_b16 v[234:235], v18 offset:1024
    ds_read_b64_tr_b16 v[236:237], v19 offset:0
    ds_read_b64_tr_b16 v[238:239], v19 offset:1024
    ds_read_b64_tr_b16 v[240:241], v16 offset:4096
    ds_read_b64_tr_b16 v[242:243], v16 offset:5120
    ds_read_b64_tr_b16 v[244:245], v17 offset:4096
    ds_read_b64_tr_b16 v[246:247], v17 offset:5120
    ds_read_b64_tr_b16 v[248:249], v18 offset:4096
    ds_read_b64_tr_b16 v[250:251], v18 offset:5120
    ds_read_b64_tr_b16 v[252:253], v19 offset:4096
    ds_read_b64_tr_b16 v[254:255], v19 offset:5120
    s_waitcnt lgkmcnt(0)
    s_mov_b32 s12, s84
    s_mov_b32 s13, s85
    s_mov_b32 s14, 0x6200000
    s_mov_b32 s15, 0x00020000
    s_barrier
    s_mov_b32 s20, s82
    s_mov_b32 s21, s83
    s_mov_b32 s22, 0x100
    s_mov_b32 s23, 0x00020000
    v_and_b32 v8, 15, v0
    v_lshlrev_b32 v8, 4, v8
    buffer_load_dword v9, v8, s[20:23], 0 offen sc1
    s_waitcnt vmcnt(0)
Lffb_wa:
    v_cmp_gt_u32 vcc, 8, v9
    s_sub_u32 s43, s43, 1
    s_cmp_lt_i32 s43, 0
    s_cbranch_scc1 Lffb_all
    s_cbranch_vccz Lffb_all
    s_sleep 2
    buffer_load_dword v9, v8, s[20:23], 0 offen sc1
    s_waitcnt vmcnt(0)
    s_branch Lffb_wa
Lffb_all:
    s_mov_b32 s14, 0
    s_branch Lffb_spin1
    .p2align 6
Lffb_body00:
    s_waitcnt lgkmcnt(0)
    v_mfma_f32_16x16x32_bf16 v[8:11], a[0:3], v[40:43], 0
    ds_read_b128 v[48:51], v2 offset:2048
    s_add_u32 m0, s34, 0
    v_mfma_f32_16x16x32_bf16 v[8:11], a[16:19], v[44:47], v[8:11]
    s_add_u32 s31, s31, 1
    v_mov_b32 v6, s31
    s_add_u32 s35, s35, 36864
    v_mfma_f32_16x16x32_bf16 v[12:15], a[20:23], v[44:47], 0
    s_cmp_eq_u32 s35, 147456
    s_cselect_b32 s35, 0, s35
    v_cvt_pk_bf16_f32 v72, v24, v25
    v_mfma_f32_16x16x32_bf16 v[12:15], a[4:7], v[40:43], v[12:15]
    v_cvt_pk_bf16_f32 v73, v26, v27
    v_cvt_pk_bf16_f32 v74, v28, v29
    v_mfma_f32_16x16x32_bf16 v[16:19], a[8:11], v[40:43], 0
    ds_read_b128 v[52:55], v2 offset:3072
    v_cvt_pk_bf16_f32 v75, v30, v31
    v_mfma_f32_16x16x32_bf16 v[16:19], a[24:27], v[44:47], v[16:19]
    buffer_store_dwordx4 v[72:75], v1, s[12:15], s36 offen offset:0 sc1
    v_cvt_pk_bf16_f32 v76, v32, v33
    v_mfma_f32_16x16x32_bf16 v[20:23], a[28:31], v[44:47], 0
    v_cvt_pk_bf16_f32 v77, v34, v35
    v_cvt_pk_bf16_f32 v78, v36, v37
    v_mfma_f32_16x16x32_bf16 v[20:23], a[12:15], v[40:43], v[20:23]
    s_waitcnt lgkmcnt(0)
    v_cvt_pk_bf16_f32 v79, v38, v39
    v_add_u32 v3, s35, v1
    v_mfma_f32_16x16x32_bf16 v[20:23], a[44:47], v[48:51], v[20:23]
    ds_read_b128 v[56:59], v2 offset:4096
    v_mfma_f32_16x16x32_bf16 v[20:23], a[60:63], v[52:55], v[20:23]
    buffer_store_dwordx4 v[76:79], v1, s[12:15], s36 offen offset:1024 sc1
    s_add_u32 s36, s36, 131072
    v_mfma_f32_16x16x32_bf16 v[16:19], a[56:59], v[52:55], v[16:19]
    v_mfma_f32_16x16x32_bf16 v[16:19], a[40:43], v[48:51], v[16:19]
    v_mfma_f32_16x16x32_bf16 v[12:15], a[36:39], v[48:51], v[12:15]
    ds_read_b128 v[60:63], v2 offset:5120
    v_mfma_f32_16x16x32_bf16 v[12:15], a[52:55], v[52:55], v[12:15]
    v_mfma_f32_16x16x32_bf16 v[8:11], a[48:51], v[52:55], v[8:11]
    v_mfma_f32_16x16x32_bf16 v[8:11], a[32:35], v[48:51], v[8:11]
    s_waitcnt lgkmcnt(0)
    v_mfma_f32_16x16x32_bf16 v[8:11], a[64:67], v[56:59], v[8:11]
    ds_read_b128 v[64:67], v2 offset:6144
    v_mfma_f32_16x16x32_bf16 v[8:11], a[80:83], v[60:63], v[8:11]
    v_mfma_f32_16x16x32_bf16 v[12:15], a[84:87], v[60:63], v[12:15]
    v_mfma_f32_16x16x32_bf16 v[12:15], a[68:71], v[56:59], v[12:15]
    v_mfma_f32_16x16x32_bf16 v[16:19], a[72:75], v[56:59], v[16:19]
    ds_read_b128 v[68:71], v2 offset:7168
    v_mfma_f32_16x16x32_bf16 v[16:19], a[88:91], v[60:63], v[16:19]
    v_mfma_f32_16x16x32_bf16 v[20:23], a[92:95], v[60:63], v[20:23]
    v_mfma_f32_16x16x32_bf16 v[20:23], a[76:79], v[56:59], v[20:23]
    s_waitcnt lgkmcnt(0)
    v_mfma_f32_16x16x32_bf16 v[20:23], a[108:111], v[64:67], v[20:23]
    ds_read_b128 v[40:43], v2 offset:8192
    v_mfma_f32_16x16x32_bf16 v[20:23], a[124:127], v[68:71], v[20:23]
    v_mfma_f32_16x16x32_bf16 v[16:19], a[120:123], v[68:71], v[16:19]
    s_waitcnt vmcnt(2)
    v_cmp_gt_i32 vcc, s32, v5
    v_mfma_f32_16x16x32_bf16 v[16:19], a[104:107], v[64:67], v[16:19]
    v_mfma_f32_16x16x32_bf16 v[12:15], a[100:103], v[64:67], v[12:15]
    ds_read_b128 v[44:47], v2 offset:9216
    v_mfma_f32_16x16x32_bf16 v[12:15], a[116:119], v[68:71], v[12:15]
    s_and_b64 vcc, vcc, s[18:19]
    s_cbranch_scc1 Lffb_v01
    v_mfma_f32_16x16x32_bf16 v[8:11], a[112:115], v[68:71], v[8:11]
    buffer_load_dwordx4 v1, s[8:11], s33 offen offset:0 sc1 lds
    v_mfma_f32_16x16x32_bf16 v[8:11], a[96:99], v[64:67], v[8:11]
    s_waitcnt lgkmcnt(0)
    v_mfma_f32_16x16x32_bf16 v[8:11], a[128:131], v[40:43], v[8:11]
    ds_read_b128 v[48:51], v2 offset:10240
    v_mfma_f32_16x16x32_bf16 v[8:11], a[144:147], v[44:47], v[8:11]
    v_mfma_f32_16x16x32_bf16 v[12:15], a[148:151], v[44:47], v[12:15]
    buffer_load_dwordx4 v1, s[8:11], s33 offen offset:1024 sc1 lds
    v_mfma_f32_16x16x32_bf16 v[12:15], a[132:135], v[40:43], v[12:15]
    v_mfma_f32_16x16x32_bf16 v[16:19], a[136:139], v[40:43], v[16:19]
    ds_read_b128 v[52:55], v2 offset:11264
    v_mfma_f32_16x16x32_bf16 v[16:19], a[152:155], v[44:47], v[16:19]
    s_barrier
    v_mfma_f32_16x16x32_bf16 v[20:23], a[156:159], v[44:47], v[20:23]
    buffer_load_dwordx4 v1, s[8:11], s33 offen offset:2048 sc1 lds
    v_mfma_f32_16x16x32_bf16 v[20:23], a[140:143], v[40:43], v[20:23]
    s_waitcnt lgkmcnt(0)
    s_add_u32 s16, s16, 8192
    s_add_u32 m0, s34, s3
    v_mfma_f32_16x16x32_bf16 v[20:23], a[172:175], v[48:51], v[20:23]
    ds_read_b128 v[56:59], v2 offset:12288
    s_add_u32 s37, s33, s3
    v_mfma_f32_16x16x32_bf16 v[20:23], a[188:191], v[52:55], v[20:23]
    v_mfma_f32_16x16x32_bf16 v[16:19], a[184:187], v[52:55], v[16:19]
    buffer_load_dwordx4 v1, s[8:11], s37 offen offset:0 sc1 lds
    v_mfma_f32_16x16x32_bf16 v[16:19], a[168:171], v[48:51], v[16:19]
    v_mfma_f32_16x16x32_bf16 v[12:15], a[164:167], v[48:51], v[12:15]
    ds_read_b128 v[60:63], v2 offset:13312
    v_mfma_f32_16x16x32_bf16 v[12:15], a[180:183], v[52:55], v[12:15]
    v_mfma_f32_16x16x32_bf16 v[8:11], a[176:179], v[52:55], v[8:11]
    buffer_load_dwordx4 v1, s[8:11], s37 offen offset:1024 sc1 lds
    v_mfma_f32_16x16x32_bf16 v[8:11], a[160:163], v[48:51], v[8:11]
    s_waitcnt lgkmcnt(0)
    v_mfma_f32_16x16x32_bf16 v[8:11], a[192:195], v[56:59], v[8:11]
    ds_read_b128 v[64:67], v2 offset:14336
    v_mfma_f32_16x16x32_bf16 v[8:11], a[208:211], v[60:63], v[8:11]
    v_mfma_f32_16x16x32_bf16 v[12:15], a[212:215], v[60:63], v[12:15]
    buffer_load_dwordx4 v1, s[8:11], s37 offen offset:2048 sc1 lds
    v_mfma_f32_16x16x32_bf16 v[12:15], a[196:199], v[56:59], v[12:15]
    s_add_u32 s32, s32, 1
    s_add_u32 s33, s33, 116736
    s_add_u32 s34, s34, 36864
    v_mfma_f32_16x16x32_bf16 v[16:19], a[200:203], v[56:59], v[16:19]
    ds_read_b128 v[68:71], v2 offset:15360
    s_waitcnt vmcnt(6)
    v_mfma_f32_16x16x32_bf16 v[16:19], a[216:219], v[60:63], v[16:19]
    s_cmp_ge_u32 s34, 147456
    s_cselect_b32 s38, 147456, 0
    s_sub_u32 s34, s34, s38
    v_mfma_f32_16x16x32_bf16 v[20:23], a[220:223], v[60:63], v[20:23]
    buffer_store_dword v6, v80, s[12:15], s17 offen sc1
    s_mov_b32 s14, s6
    v_mfma_f32_16x16x32_bf16 v[20:23], a[204:207], v[56:59], v[20:23]
    s_waitcnt lgkmcnt(0)
    s_add_u32 s17, s17, 8192
    v_mfma_f32_16x16x32_bf16 v[20:23], a[236:239], v[64:67], v[20:23]
    ds_read_b128 v[40:43], v2 offset:16384
    v_mfma_f32_16x16x32_bf16 v[20:23], a[252:255], v[68:71], v[20:23]
    v_mfma_f32_16x16x32_bf16 v[16:19], a[248:251], v[68:71], v[16:19]
    v_mfma_f32_16x16x32_bf16 v[16:19], a[232:235], v[64:67], v[16:19]
    v_mfma_f32_16x16x32_bf16 v[12:15], a[228:231], v[64:67], v[12:15]
    ds_read_b128 v[44:47], v2 offset:17408
    v_mfma_f32_16x16x32_bf16 v[12:15], a[244:247], v[68:71], v[12:15]
    v_mfma_f32_16x16x32_bf16 v[8:11], a[240:243], v[68:71], v[8:11]
    v_mfma_f32_16x16x32_bf16 v[8:11], a[224:227], v[64:67], v[8:11]
    s_waitcnt lgkmcnt(0)
    v_mfma_f32_16x16x32_bf16 v[8:11], v[128:131], v[40:43], v[8:11]
    ds_read_b128 v[48:51], v2 offset:18432
    v_mfma_f32_16x16x32_bf16 v[8:11], v[144:147], v[44:47], v[8:11]
    v_mfma_f32_16x16x32_bf16 v[12:15], v[148:151], v[44:47], v[12:15]
    v_mfma_f32_16x16x32_bf16 v[12:15], v[132:135], v[40:43], v[12:15]
    v_mfma_f32_16x16x32_bf16 v[16:19], v[136:139], v[40:43], v[16:19]
    ds_read_b128 v[52:55], v2 offset:19456
    v_mfma_f32_16x16x32_bf16 v[16:19], v[152:155], v[44:47], v[16:19]
    v_mfma_f32_16x16x32_bf16 v[20:23], v[156:159], v[44:47], v[20:23]
    v_mfma_f32_16x16x32_bf16 v[20:23], v[140:143], v[40:43], v[20:23]
    s_waitcnt lgkmcnt(0)
    v_mfma_f32_16x16x32_bf16 v[20:23], v[172:175], v[48:51], v[20:23]
    ds_read_b128 v[56:59], v2 offset:20480
    v_mfma_f32_16x16x32_bf16 v[20:23], v[188:191], v[52:55], v[20:23]
    v_mfma_f32_16x16x32_bf16 v[16:19], v[184:187], v[52:55], v[16:19]
    v_mfma_f32_16x16x32_bf16 v[16:19], v[168:171], v[48:51], v[16:19]
    v_mfma_f32_16x16x32_bf16 v[12:15], v[164:167], v[48:51], v[12:15]
    ds_read_b128 v[60:63], v2 offset:21504
    v_mfma_f32_16x16x32_bf16 v[12:15], v[180:183], v[52:55], v[12:15]
    v_mfma_f32_16x16x32_bf16 v[8:11], v[176:179], v[52:55], v[8:11]
    v_mfma_f32_16x16x32_bf16 v[8:11], v[160:163], v[48:51], v[8:11]
    s_waitcnt lgkmcnt(0)
    v_mfma_f32_16x16x32_bf16 v[8:11], v[192:195], v[56:59], v[8:11]
    ds_read_b128 v[64:67], v2 offset:22528
    v_mfma_f32_16x16x32_bf16 v[8:11], v[208:211], v[60:63], v[8:11]
    buffer_load_dword v5, v4, s[4:7], s16 offen sc1
    v_mfma_f32_16x16x32_bf16 v[12:15], v[212:215], v[60:63], v[12:15]
    v_mfma_f32_16x16x32_bf16 v[12:15], v[196:199], v[56:59], v[12:15]
    v_mfma_f32_16x16x32_bf16 v[16:19], v[200:203], v[56:59], v[16:19]
    ds_read_b128 v[68:71], v2 offset:23552
    v_mfma_f32_16x16x32_bf16 v[16:19], v[216:219], v[60:63], v[16:19]
    s_waitcnt vmcnt(5)
    s_barrier
    v_mfma_f32_16x16x32_bf16 v[20:23], v[220:223], v[60:63], v[20:23]
    v_mfma_f32_16x16x32_bf16 v[20:23], v[204:207], v[56:59], v[20:23]
    s_waitcnt lgkmcnt(0)
    v_mfma_f32_16x16x32_bf16 v[20:23], v[236:239], v[64:67], v[20:23]
    ds_read_b128 v[40:43], v3 offset:0
    v_mfma_f32_16x16x32_bf16 v[20:23], v[252:255], v[68:71], v[20:23]
    v_mfma_f32_16x16x32_bf16 v[16:19], v[248:251], v[68:71], v[16:19]
    v_mfma_f32_16x16x32_bf16 v[16:19], v[232:235], v[64:67], v[16:19]
    v_mfma_f32_16x16x32_bf16 v[12:15], v[228:231], v[64:67], v[12:15]
    ds_read_b128 v[44:47], v3 offset:1024
    v_mfma_f32_16x16x32_bf16 v[12:15], v[244:247], v[68:71], v[12:15]
    v_mfma_f32_16x16x32_bf16 v[8:11], v[240:243], v[68:71], v[8:11]
    v_mfma_f32_16x16x32_bf16 v[8:11], v[224:227], v[64:67], v[8:11]
Lffb_body10:
    s_waitcnt lgkmcnt(0)
    v_mfma_f32_16x16x32_bf16 v[24:27], a[0:3], v[40:43], 0
    ds_read_b128 v[48:51], v3 offset:2048
    s_add_u32 m0, s34, 0
    v_mfma_f32_16x16x32_bf16 v[24:27], a[16:19], v[44:47], v[24:27]
    s_add_u32 s31, s31, 1
    v_mov_b32 v6, s31
    s_add_u32 s35, s35, 36864
    v_mfma_f32_16x16x32_bf16 v[28:31], a[20:23], v[44:47], 0
    s_cmp_eq_u32 s35, 147456
    s_cselect_b32 s35, 0, s35
    v_cvt_pk_bf16_f32 v72, v8, v9
    v_mfma_f32_16x16x32_bf16 v[28:31], a[4:7], v[40:43], v[28:31]
    v_cvt_pk_bf16_f32 v73, v10, v11
    v_cvt_pk_bf16_f32 v74, v12, v13
    v_mfma_f32_16x16x32_bf16 v[32:35], a[8:11], v[40:43], 0
    ds_read_b128 v[52:55], v3 offset:3072
    v_cvt_pk_bf16_f32 v75, v14, v15
    v_mfma_f32_16x16x32_bf16 v[32:35], a[24:27], v[44:47], v[32:35]
    buffer_store_dwordx4 v[72:75], v1, s[12:15], s36 offen offset:0 sc1
    v_cvt_pk_bf16_f32 v76, v16, v17
    v_mfma_f32_16x16x32_bf16 v[36:39], a[28:31], v[44:47], 0
    v_cvt_pk_bf16_f32 v77, v18, v19
    v_cvt_pk_bf16_f32 v78, v20, v21
    v_mfma_f32_16x16x32_bf16 v[36:39], a[12:15], v[40:43], v[36:39]
    s_waitcnt lgkmcnt(0)
    v_cvt_pk_bf16_f32 v79, v22, v23
    v_add_u32 v2, s35, v1
    v_mfma_f32_16x16x32_bf16 v[36:39], a[44:47], v[48:51], v[36:39]
    ds_read_b128 v[56:59], v3 offset:4096
    v_mfma_f32_16x16x32_bf16 v[36:39], a[60:63], v[52:55], v[36:39]
    buffer_store_dwordx4 v[76:79], v1, s[12:15], s36 offen offset:1024 sc1
    s_add_u32 s36, s36, 131072
    v_mfma_f32_16x16x32_bf16 v[32:35], a[56:59], v[52:55], v[32:35]
    v_mfma_f32_16x16x32_bf16 v[32:35], a[40:43], v[48:51], v[32:35]
    v_mfma_f32_16x16x32_bf16 v[28:31], a[36:39], v[48:51], v[28:31]
    ds_read_b128 v[60:63], v3 offset:5120
    v_mfma_f32_16x16x32_bf16 v[28:31], a[52:55], v[52:55], v[28:31]
    v_mfma_f32_16x16x32_bf16 v[24:27], a[48:51], v[52:55], v[24:27]
    v_mfma_f32_16x16x32_bf16 v[24:27], a[32:35], v[48:51], v[24:27]
    s_waitcnt lgkmcnt(0)
    v_mfma_f32_16x16x32_bf16 v[24:27], a[64:67], v[56:59], v[24:27]
    ds_read_b128 v[64:67], v3 offset:6144
    v_mfma_f32_16x16x32_bf16 v[24:27], a[80:83], v[60:63], v[24:27]
    v_mfma_f32_16x16x32_bf16 v[28:31], a[84:87], v[60:63], v[28:31]
    v_mfma_f32_16x16x32_bf16 v[28:31], a[68:71], v[56:59], v[28:31]
    v_mfma_f32_16x16x32_bf16 v[32:35], a[72:75], v[56:59], v[32:35]
    ds_read_b128 v[68:71], v3 offset:7168
    v_mfma_f32_16x16x32_bf16 v[32:35], a[88:91], v[60:63], v[32:35]
    v_mfma_f32_16x16x32_bf16 v[36:39], a[92:95], v[60:63], v[36:39]
    v_mfma_f32_16x16x32_bf16 v[36:39], a[76:79], v[56:59], v[36:39]
    s_waitcnt lgkmcnt(0)
    v_mfma_f32_16x16x32_bf16 v[36:39], a[108:111], v[64:67], v[36:39]
    ds_read_b128 v[40:43], v3 offset:8192
    v_mfma_f32_16x16x32_bf16 v[36:39], a[124:127], v[68:71], v[36:39]
    v_mfma_f32_16x16x32_bf16 v[32:35], a[120:123], v[68:71], v[32:35]
    s_waitcnt vmcnt(2)
    v_cmp_gt_i32 vcc, s32, v5
    v_mfma_f32_16x16x32_bf16 v[32:35], a[104:107], v[64:67], v[32:35]
    v_mfma_f32_16x16x32_bf16 v[28:31], a[100:103], v[64:67], v[28:31]
    ds_read_b128 v[44:47], v3 offset:9216
    v_mfma_f32_16x16x32_bf16 v[28:31], a[116:119], v[68:71], v[28:31]
    s_and_b64 vcc, vcc, s[18:19]
    s_cbranch_scc1 Lffb_v11
    v_mfma_f32_16x16x32_bf16 v[24:27], a[112:115], v[68:71], v[24:27]
    buffer_load_dwordx4 v1, s[8:11], s33 offen offset:0 sc1 lds
    v_mfma_f32_16x16x32_bf16 v[24:27], a[96:99], v[64:67], v[24:27]
    s_waitcnt lgkmcnt(0)
    v_mfma_f32_16x16x32_bf16 v[24:27], a[128:131], v[40:43], v[24:27]
    ds_read_b128 v[48:51], v3 offset:10240
    v_mfma_f32_16x16x32_bf16 v[24:27], a[144:147], v[44:47], v[24:27]
    v_mfma_f32_16x16x32_bf16 v[28:31], a[148:151], v[44:47], v[28:31]
    buffer_load_dwordx4 v1, s[8:11], s33 offen offset:1024 sc1 lds
    v_mfma_f32_16x16x32_bf16 v[28:31], a[132:135], v[40:43], v[28:31]
    v_mfma_f32_16x16x32_bf16 v[32:35], a[136:139], v[40:43], v[32:35]
    ds_read_b128 v[52:55], v3 offset:11264
    v_mfma_f32_16x16x32_bf16 v[32:35], a[152:155], v[44:47], v[32:35]
    s_barrier
    v_mfma_f32_16x16x32_bf16 v[36:39], a[156:159], v[44:47], v[36:39]
    buffer_load_dwordx4 v1, s[8:11], s33 offen offset:2048 sc1 lds
    v_mfma_f32_16x16x32_bf16 v[36:39], a[140:143], v[40:43], v[36:39]
    s_waitcnt lgkmcnt(0)
    s_add_u32 s16, s16, 8192
    s_add_u32 m0, s34, s3
    v_mfma_f32_16x16x32_bf16 v[36:39], a[172:175], v[48:51], v[36:39]
    ds_read_b128 v[56:59], v3 offset:12288
    s_add_u32 s37, s33, s3
    v_mfma_f32_16x16x32_bf16 v[36:39], a[188:191], v[52:55], v[36:39]
    v_mfma_f32_16x16x32_bf16 v[32:35], a[184:187], v[52:55], v[32:35]
    buffer_load_dwordx4 v1, s[8:11], s37 offen offset:0 sc1 lds
    v_mfma_f32_16x16x32_bf16 v[32:35], a[168:171], v[48:51], v[32:35]
    v_mfma_f32_16x16x32_bf16 v[28:31], a[164:167], v[48:51], v[28:31]
    ds_read_b128 v[60:63], v3 offset:13312
    v_mfma_f32_16x16x32_bf16 v[28:31], a[180:183], v[52:55], v[28:31]
    v_mfma_f32_16x16x32_bf16 v[24:27], a[176:179], v[52:55], v[24:27]
    buffer_load_dwordx4 v1, s[8:11], s37 offen offset:1024 sc1 lds
    v_mfma_f32_16x16x32_bf16 v[24:27], a[160:163], v[48:51], v[24:27]
    s_waitcnt lgkmcnt(0)
    v_mfma_f32_16x16x32_bf16 v[24:27], a[192:195], v[56:59], v[24:27]
    ds_read_b128 v[64:67], v3 offset:14336
    v_mfma_f32_16x16x32_bf16 v[24:27], a[208:211], v[60:63], v[24:27]
    v_mfma_f32_16x16x32_bf16 v[28:31], a[212:215], v[60:63], v[28:31]
    buffer_load_dwordx4 v1, s[8:11], s37 offen offset:2048 sc1 lds
    v_mfma_f32_16x16x32_bf16 v[28:31], a[196:199], v[56:59], v[28:31]
    s_add_u32 s32, s32, 1
    s_add_u32 s33, s33, 116736
    s_add_u32 s34, s34, 36864
    v_mfma_f32_16x16x32_bf16 v[32:35], a[200:203], v[56:59], v[32:35]
    ds_read_b128 v[68:71], v3 offset:15360
    s_waitcnt vmcnt(6)
    v_mfma_f32_16x16x32_bf16 v[32:35], a[216:219], v[60:63], v[32:35]
    s_cmp_ge_u32 s34, 147456
    s_cselect_b32 s38, 147456, 0
    s_sub_u32 s34, s34, s38
    v_mfma_f32_16x16x32_bf16 v[36:39], a[220:223], v[60:63], v[36:39]
    buffer_store_dword v6, v80, s[12:15], s17 offen sc1
    s_mov_b32 s14, s6
    v_mfma_f32_16x16x32_bf16 v[36:39], a[204:207], v[56:59], v[36:39]
    s_waitcnt lgkmcnt(0)
    s_add_u32 s17, s17, 8192
    v_mfma_f32_16x16x32_bf16 v[36:39], a[236:239], v[64:67], v[36:39]
    ds_read_b128 v[40:43], v3 offset:16384
    v_mfma_f32_16x16x32_bf16 v[36:39], a[252:255], v[68:71], v[36:39]
    v_mfma_f32_16x16x32_bf16 v[32:35], a[248:251], v[68:71], v[32:35]
    v_mfma_f32_16x16x32_bf16 v[32:35], a[232:235], v[64:67], v[32:35]
    v_mfma_f32_16x16x32_bf16 v[28:31], a[228:231], v[64:67], v[28:31]
    ds_read_b128 v[44:47], v3 offset:17408
    v_mfma_f32_16x16x32_bf16 v[28:31], a[244:247], v[68:71], v[28:31]
    v_mfma_f32_16x16x32_bf16 v[24:27], a[240:243], v[68:71], v[24:27]
    v_mfma_f32_16x16x32_bf16 v[24:27], a[224:227], v[64:67], v[24:27]
    s_waitcnt lgkmcnt(0)
    v_mfma_f32_16x16x32_bf16 v[24:27], v[128:131], v[40:43], v[24:27]
    ds_read_b128 v[48:51], v3 offset:18432
    v_mfma_f32_16x16x32_bf16 v[24:27], v[144:147], v[44:47], v[24:27]
    v_mfma_f32_16x16x32_bf16 v[28:31], v[148:151], v[44:47], v[28:31]
    v_mfma_f32_16x16x32_bf16 v[28:31], v[132:135], v[40:43], v[28:31]
    v_mfma_f32_16x16x32_bf16 v[32:35], v[136:139], v[40:43], v[32:35]
    ds_read_b128 v[52:55], v3 offset:19456
    v_mfma_f32_16x16x32_bf16 v[32:35], v[152:155], v[44:47], v[32:35]
    v_mfma_f32_16x16x32_bf16 v[36:39], v[156:159], v[44:47], v[36:39]
    v_mfma_f32_16x16x32_bf16 v[36:39], v[140:143], v[40:43], v[36:39]
    s_waitcnt lgkmcnt(0)
    v_mfma_f32_16x16x32_bf16 v[36:39], v[172:175], v[48:51], v[36:39]
    ds_read_b128 v[56:59], v3 offset:20480
    v_mfma_f32_16x16x32_bf16 v[36:39], v[188:191], v[52:55], v[36:39]
    v_mfma_f32_16x16x32_bf16 v[32:35], v[184:187], v[52:55], v[32:35]
    v_mfma_f32_16x16x32_bf16 v[32:35], v[168:171], v[48:51], v[32:35]
    v_mfma_f32_16x16x32_bf16 v[28:31], v[164:167], v[48:51], v[28:31]
    ds_read_b128 v[60:63], v3 offset:21504
    v_mfma_f32_16x16x32_bf16 v[28:31], v[180:183], v[52:55], v[28:31]
    v_mfma_f32_16x16x32_bf16 v[24:27], v[176:179], v[52:55], v[24:27]
    v_mfma_f32_16x16x32_bf16 v[24:27], v[160:163], v[48:51], v[24:27]
    s_waitcnt lgkmcnt(0)
    v_mfma_f32_16x16x32_bf16 v[24:27], v[192:195], v[56:59], v[24:27]
    ds_read_b128 v[64:67], v3 offset:22528
    v_mfma_f32_16x16x32_bf16 v[24:27], v[208:211], v[60:63], v[24:27]
    buffer_load_dword v5, v4, s[4:7], s16 offen sc1
    v_mfma_f32_16x16x32_bf16 v[28:31], v[212:215], v[60:63], v[28:31]
    v_mfma_f32_16x16x32_bf16 v[28:31], v[196:199], v[56:59], v[28:31]
    v_mfma_f32_16x16x32_bf16 v[32:35], v[200:203], v[56:59], v[32:35]
    ds_read_b128 v[68:71], v3 offset:23552
    v_mfma_f32_16x16x32_bf16 v[32:35], v[216:219], v[60:63], v[32:35]
    s_waitcnt vmcnt(5)
    s_barrier
    v_mfma_f32_16x16x32_bf16 v[36:39], v[220:223], v[60:63], v[36:39]
    v_mfma_f32_16x16x32_bf16 v[36:39], v[204:207], v[56:59], v[36:39]
    s_waitcnt lgkmcnt(0)
    v_mfma_f32_16x16x32_bf16 v[36:39], v[236:239], v[64:67], v[36:39]
    ds_read_b128 v[40:43], v2 offset:0
    v_mfma_f32_16x16x32_bf16 v[36:39], v[252:255], v[68:71], v[36:39]
    v_mfma_f32_16x16x32_bf16 v[32:35], v[248:251], v[68:71], v[32:35]
    v_mfma_f32_16x16x32_bf16 v[32:35], v[232:235], v[64:67], v[32:35]
    v_mfma_f32_16x16x32_bf16 v[28:31], v[228:231], v[64:67], v[28:31]
    ds_read_b128 v[44:47], v2 offset:1024
    v_mfma_f32_16x16x32_bf16 v[28:31], v[244:247], v[68:71], v[28:31]
    v_mfma_f32_16x16x32_bf16 v[24:27], v[240:243], v[68:71], v[24:27]
    v_mfma_f32_16x16x32_bf16 v[24:27], v[224:227], v[64:67], v[24:27]
    s_cmp_lt_i32 s31, 63
    s_cbranch_scc1 Lffb_body00
    s_branch L_exit
Lffb_v01:
    v_mfma_f32_16x16x32_bf16 v[8:11], a[112:115], v[68:71], v[8:11]
    buffer_load_dword v5, v4, s[4:7], s16 offen sc1
    v_mfma_f32_16x16x32_bf16 v[8:11], a[96:99], v[64:67], v[8:11]
    s_waitcnt lgkmcnt(0)
    v_mfma_f32_16x16x32_bf16 v[8:11], a[128:131], v[40:43], v[8:11]
    ds_read_b128 v[48:51], v2 offset:10240
    v_mfma_f32_16x16x32_bf16 v[8:11], a[144:147], v[44:47], v[8:11]
    v_mfma_f32_16x16x32_bf16 v[12:15], a[148:151], v[44:47], v[12:15]
    v_mfma_f32_16x16x32_bf16 v[12:15], a[132:135], v[40:43], v[12:15]
    v_mfma_f32_16x16x32_bf16 v[16:19], a[136:139], v[40:43], v[16:19]
    ds_read_b128 v[52:55], v2 offset:11264
    v_mfma_f32_16x16x32_bf16 v[16:19], a[152:155], v[44:47], v[16:19]
    s_barrier
    v_mfma_f32_16x16x32_bf16 v[20:23], a[156:159], v[44:47], v[20:23]
    v_mfma_f32_16x16x32_bf16 v[20:23], a[140:143], v[40:43], v[20:23]
    s_waitcnt lgkmcnt(0)
    v_mfma_f32_16x16x32_bf16 v[20:23], a[172:175], v[48:51], v[20:23]
    ds_read_b128 v[56:59], v2 offset:12288
    v_mfma_f32_16x16x32_bf16 v[20:23], a[188:191], v[52:55], v[20:23]
    v_mfma_f32_16x16x32_bf16 v[16:19], a[184:187], v[52:55], v[16:19]
    v_mfma_f32_16x16x32_bf16 v[16:19], a[168:171], v[48:51], v[16:19]
    v_mfma_f32_16x16x32_bf16 v[12:15], a[164:167], v[48:51], v[12:15]
    ds_read_b128 v[60:63], v2 offset:13312
    v_mfma_f32_16x16x32_bf16 v[12:15], a[180:183], v[52:55], v[12:15]
    v_mfma_f32_16x16x32_bf16 v[8:11], a[176:179], v[52:55], v[8:11]
    v_mfma_f32_16x16x32_bf16 v[8:11], a[160:163], v[48:51], v[8:11]
    s_waitcnt lgkmcnt(0)
    v_mfma_f32_16x16x32_bf16 v[8:11], a[192:195], v[56:59], v[8:11]
    ds_read_b128 v[64:67], v2 offset:14336
    v_mfma_f32_16x16x32_bf16 v[8:11], a[208:211], v[60:63], v[8:11]
    v_mfma_f32_16x16x32_bf16 v[12:15], a[212:215], v[60:63], v[12:15]
    s_waitcnt vmcnt(0)
    v_cmp_gt_i32 vcc, s32, v5
    v_mfma_f32_16x16x32_bf16 v[12:15], a[196:199], v[56:59], v[12:15]
    buffer_store_dword v6, v80, s[12:15], s17 offen sc1
    s_mov_b32 s14, s6
    v_mfma_f32_16x16x32_bf16 v[16:19], a[200:203], v[56:59], v[16:19]
    ds_read_b128 v[68:71], v2 offset:15360
    s_add_u32 s17, s17, 8192
    v_mfma_f32_16x16x32_bf16 v[16:19], a[216:219], v[60:63], v[16:19]
    s_and_b64 vcc, vcc, s[18:19]
    s_cbranch_scc1 Lffb_v02
    v_mfma_f32_16x16x32_bf16 v[20:23], a[220:223], v[60:63], v[20:23]
    buffer_load_dwordx4 v1, s[8:11], s33 offen offset:0 sc1 lds
    v_mfma_f32_16x16x32_bf16 v[20:23], a[204:207], v[56:59], v[20:23]
    s_waitcnt lgkmcnt(0)
    v_mfma_f32_16x16x32_bf16 v[20:23], a[236:239], v[64:67], v[20:23]
    ds_read_b128 v[40:43], v2 offset:16384
    v_mfma_f32_16x16x32_bf16 v[20:23], a[252:255], v[68:71], v[20:23]
    v_mfma_f32_16x16x32_bf16 v[16:19], a[248:251], v[68:71], v[16:19]
    buffer_load_dwordx4 v1, s[8:11], s33 offen offset:1024 sc1 lds
    v_mfma_f32_16x16x32_bf16 v[16:19], a[232:235], v[64:67], v[16:19]
    v_mfma_f32_16x16x32_bf16 v[12:15], a[228:231], v[64:67], v[12:15]
    ds_read_b128 v[44:47], v2 offset:17408
    v_mfma_f32_16x16x32_bf16 v[12:15], a[244:247], v[68:71], v[12:15]
    v_mfma_f32_16x16x32_bf16 v[8:11], a[240:243], v[68:71], v[8:11]
    buffer_load_dwordx4 v1, s[8:11], s33 offen offset:2048 sc1 lds
    v_mfma_f32_16x16x32_bf16 v[8:11], a[224:227], v[64:67], v[8:11]
    s_waitcnt lgkmcnt(0)
    s_add_u32 s16, s16, 8192
    s_add_u32 m0, s34, s3
    v_mfma_f32_16x16x32_bf16 v[8:11], v[128:131], v[40:43], v[8:11]
    ds_read_b128 v[48:51], v2 offset:18432
    s_add_u32 s37, s33, s3
    v_mfma_f32_16x16x32_bf16 v[8:11], v[144:147], v[44:47], v[8:11]
    v_mfma_f32_16x16x32_bf16 v[12:15], v[148:151], v[44:47], v[12:15]
    buffer_load_dwordx4 v1, s[8:11], s37 offen offset:0 sc1 lds
    v_mfma_f32_16x16x32_bf16 v[12:15], v[132:135], v[40:43], v[12:15]
    v_mfma_f32_16x16x32_bf16 v[16:19], v[136:139], v[40:43], v[16:19]
    ds_read_b128 v[52:55], v2 offset:19456
    v_mfma_f32_16x16x32_bf16 v[16:19], v[152:155], v[44:47], v[16:19]
    v_mfma_f32_16x16x32_bf16 v[20:23], v[156:159], v[44:47], v[20:23]
    buffer_load_dwordx4 v1, s[8:11], s37 offen offset:1024 sc1 lds
    v_mfma_f32_16x16x32_bf16 v[20:23], v[140:143], v[40:43], v[20:23]
    s_waitcnt lgkmcnt(0)
    v_mfma_f32_16x16x32_bf16 v[20:23], v[172:175], v[48:51], v[20:23]
    ds_read_b128 v[56:59], v2 offset:20480
    v_mfma_f32_16x16x32_bf16 v[20:23], v[188:191], v[52:55], v[20:23]
    v_mfma_f32_16x16x32_bf16 v[16:19], v[184:187], v[52:55], v[16:19]
    buffer_load_dwordx4 v1, s[8:11], s37 offen offset:2048 sc1 lds
    v_mfma_f32_16x16x32_bf16 v[16:19], v[168:171], v[48:51], v[16:19]
    s_add_u32 s32, s32, 1
    s_add_u32 s33, s33, 116736
    s_add_u32 s34, s34, 36864
    v_mfma_f32_16x16x32_bf16 v[12:15], v[164:167], v[48:51], v[12:15]
    ds_read_b128 v[60:63], v2 offset:21504
    v_mfma_f32_16x16x32_bf16 v[12:15], v[180:183], v[52:55], v[12:15]
    s_cmp_ge_u32 s34, 147456
    s_cselect_b32 s38, 147456, 0
    s_sub_u32 s34, s34, s38
    v_mfma_f32_16x16x32_bf16 v[8:11], v[176:179], v[52:55], v[8:11]
    v_mfma_f32_16x16x32_bf16 v[8:11], v[160:163], v[48:51], v[8:11]
    s_waitcnt lgkmcnt(0)
    v_mfma_f32_16x16x32_bf16 v[8:11], v[192:195], v[56:59], v[8:11]
    ds_read_b128 v[64:67], v2 offset:22528
    v_mfma_f32_16x16x32_bf16 v[8:11], v[208:211], v[60:63], v[8:11]
    buffer_load_dword v5, v4, s[4:7], s16 offen sc1
    v_mfma_f32_16x16x32_bf16 v[12:15], v[212:215], v[60:63], v[12:15]
    v_mfma_f32_16x16x32_bf16 v[12:15], v[196:199], v[56:59], v[12:15]
    v_mfma_f32_16x16x32_bf16 v[16:19], v[200:203], v[56:59], v[16:19]
    ds_read_b128 v[68:71], v2 offset:23552
    v_mfma_f32_16x16x32_bf16 v[16:19], v[216:219], v[60:63], v[16:19]
    s_waitcnt vmcnt(4)
    s_barrier
    v_mfma_f32_16x16x32_bf16 v[20:23], v[220:223], v[60:63], v[20:23]
    v_mfma_f32_16x16x32_bf16 v[20:23], v[204:207], v[56:59], v[20:23]
    s_waitcnt lgkmcnt(0)
    v_mfma_f32_16x16x32_bf16 v[20:23], v[236:239], v[64:67], v[20:23]
    ds_read_b128 v[40:43], v3 offset:0
    v_mfma_f32_16x16x32_bf16 v[20:23], v[252:255], v[68:71], v[20:23]
    v_mfma_f32_16x16x32_bf16 v[16:19], v[248:251], v[68:71], v[16:19]
    v_mfma_f32_16x16x32_bf16 v[16:19], v[232:235], v[64:67], v[16:19]
    v_mfma_f32_16x16x32_bf16 v[12:15], v[228:231], v[64:67], v[12:15]
    ds_read_b128 v[44:47], v3 offset:1024
    v_mfma_f32_16x16x32_bf16 v[12:15], v[244:247], v[68:71], v[12:15]
    v_mfma_f32_16x16x32_bf16 v[8:11], v[240:243], v[68:71], v[8:11]
    v_mfma_f32_16x16x32_bf16 v[8:11], v[224:227], v[64:67], v[8:11]
    s_cmp_ge_i32 s31, 63
    s_cbranch_scc1 L_exit
    s_branch Lffb_body10
Lffb_v02:
    v_mfma_f32_16x16x32_bf16 v[20:23], a[220:223], v[60:63], v[20:23]
    buffer_load_dword v5, v4, s[4:7], s16 offen sc1
    v_mfma_f32_16x16x32_bf16 v[20:23], a[204:207], v[56:59], v[20:23]
    s_waitcnt lgkmcnt(0)
    v_mfma_f32_16x16x32_bf16 v[20:23], a[236:239], v[64:67], v[20:23]
    ds_read_b128 v[40:43], v2 offset:16384
    v_mfma_f32_16x16x32_bf16 v[20:23], a[252:255], v[68:71], v[20:23]
    v_mfma_f32_16x16x32_bf16 v[16:19], a[248:251], v[68:71], v[16:19]
    v_mfma_f32_16x16x32_bf16 v[16:19], a[232:235], v[64:67], v[16:19]
    v_mfma_f32_16x16x32_bf16 v[12:15], a[228:231], v[64:67], v[12:15]
    ds_read_b128 v[44:47], v2 offset:17408
    v_mfma_f32_16x16x32_bf16 v[12:15], a[244:247], v[68:71], v[12:15]
    v_mfma_f32_16x16x32_bf16 v[8:11], a[240:243], v[68:71], v[8:11]
    v_mfma_f32_16x16x32_bf16 v[8:11], a[224:227], v[64:67], v[8:11]
    s_waitcnt lgkmcnt(0)
    v_mfma_f32_16x16x32_bf16 v[8:11], v[128:131], v[40:43], v[8:11]
    ds_read_b128 v[48:51], v2 offset:18432
    v_mfma_f32_16x16x32_bf16 v[8:11], v[144:147], v[44:47], v[8:11]
    v_mfma_f32_16x16x32_bf16 v[12:15], v[148:151], v[44:47], v[12:15]
    v_mfma_f32_16x16x32_bf16 v[12:15], v[132:135], v[40:43], v[12:15]
    v_mfma_f32_16x16x32_bf16 v[16:19], v[136:139], v[40:43], v[16:19]
    ds_read_b128 v[52:55], v2 offset:19456
    v_mfma_f32_16x16x32_bf16 v[16:19], v[152:155], v[44:47], v[16:19]
    v_mfma_f32_16x16x32_bf16 v[20:23], v[156:159], v[44:47], v[20:23]
    v_mfma_f32_16x16x32_bf16 v[20:23], v[140:143], v[40:43], v[20:23]
    s_waitcnt lgkmcnt(0)
    v_mfma_f32_16x16x32_bf16 v[20:23], v[172:175], v[48:51], v[20:23]
    ds_read_b128 v[56:59], v2 offset:20480
    v_mfma_f32_16x16x32_bf16 v[20:23], v[188:191], v[52:55], v[20:23]
    v_mfma_f32_16x16x32_bf16 v[16:19], v[184:187], v[52:55], v[16:19]
    s_waitcnt vmcnt(0)
    v_cmp_gt_i32 vcc, s32, v5
    v_mfma_f32_16x16x32_bf16 v[16:19], v[168:171], v[48:51], v[16:19]
    v_mfma_f32_16x16x32_bf16 v[12:15], v[164:167], v[48:51], v[12:15]
    ds_read_b128 v[60:63], v2 offset:21504
    v_mfma_f32_16x16x32_bf16 v[12:15], v[180:183], v[52:55], v[12:15]
    s_and_b64 vcc, vcc, s[18:19]
    s_cbranch_scc1 Lffb_v03
    v_mfma_f32_16x16x32_bf16 v[8:11], v[176:179], v[52:55], v[8:11]
    buffer_load_dwordx4 v1, s[8:11], s33 offen offset:0 sc1 lds
    v_mfma_f32_16x16x32_bf16 v[8:11], v[160:163], v[48:51], v[8:11]
    s_waitcnt lgkmcnt(0)
    v_mfma_f32_16x16x32_bf16 v[8:11], v[192:195], v[56:59], v[8:11]
    ds_read_b128 v[64:67], v2 offset:22528
    v_mfma_f32_16x16x32_bf16 v[8:11], v[208:211], v[60:63], v[8:11]
    v_mfma_f32_16x16x32_bf16 v[12:15], v[212:215], v[60:63], v[12:15]
    buffer_load_dwordx4 v1, s[8:11], s33 offen offset:1024 sc1 lds
    v_mfma_f32_16x16x32_bf16 v[12:15], v[196:199], v[56:59], v[12:15]
    v_mfma_f32_16x16x32_bf16 v[16:19], v[200:203], v[56:59], v[16:19]
    ds_read_b128 v[68:71], v2 offset:23552
    v_mfma_f32_16x16x32_bf16 v[16:19], v[216:219], v[60:63], v[16:19]
    v_mfma_f32_16x16x32_bf16 v[20:23], v[220:223], v[60:63], v[20:23]
    buffer_load_dwordx4 v1, s[8:11], s33 offen offset:2048 sc1 lds
    v_mfma_f32_16x16x32_bf16 v[20:23], v[204:207], v[56:59], v[20:23]
    s_waitcnt vmcnt(0) lgkmcnt(0)
    s_barrier
    v_mfma_f32_16x16x32_bf16 v[20:23], v[236:239], v[64:67], v[20:23]
    ds_read_b128 v[40:43], v3 offset:0
    s_add_u32 s16, s16, 8192
    v_mfma_f32_16x16x32_bf16 v[20:23], v[252:255], v[68:71], v[20:23]
    s_add_u32 m0, s34, s3
    s_add_u32 s37, s33, s3
    v_mfma_f32_16x16x32_bf16 v[16:19], v[248:251], v[68:71], v[16:19]
    buffer_load_dword v5, v4, s[4:7], s16 offen sc1
    v_mfma_f32_16x16x32_bf16 v[16:19], v[232:235], v[64:67], v[16:19]
    v_mfma_f32_16x16x32_bf16 v[12:15], v[228:231], v[64:67], v[12:15]
    ds_read_b128 v[44:47], v3 offset:1024
    v_mfma_f32_16x16x32_bf16 v[12:15], v[244:247], v[68:71], v[12:15]
    v_mfma_f32_16x16x32_bf16 v[8:11], v[240:243], v[68:71], v[8:11]
    buffer_load_dwordx4 v1, s[8:11], s37 offen offset:0 sc1 lds
    v_mfma_f32_16x16x32_bf16 v[8:11], v[224:227], v[64:67], v[8:11]
    buffer_load_dwordx4 v1, s[8:11], s37 offen offset:1024 sc1 lds
    buffer_load_dwordx4 v1, s[8:11], s37 offen offset:2048 sc1 lds
    s_add_u32 s32, s32, 1
    s_add_u32 s33, s33, 116736
    s_add_u32 s34, s34, 36864
    s_cmp_ge_u32 s34, 147456
    s_cselect_b32 s38, 147456, 0
    s_sub_u32 s34, s34, s38
    s_cmp_ge_i32 s31, 63
    s_cbranch_scc1 L_exit
    s_branch Lffb_body10
Lffb_v03:
    v_mfma_f32_16x16x32_bf16 v[8:11], v[176:179], v[52:55], v[8:11]
    v_mfma_f32_16x16x32_bf16 v[8:11], v[160:163], v[48:51], v[8:11]
    s_waitcnt lgkmcnt(0)
    v_mfma_f32_16x16x32_bf16 v[8:11], v[192:195], v[56:59], v[8:11]
    ds_read_b128 v[64:67], v2 offset:22528
    v_mfma_f32_16x16x32_bf16 v[8:11], v[208:211], v[60:63], v[8:11]
    v_mfma_f32_16x16x32_bf16 v[12:15], v[212:215], v[60:63], v[12:15]
    buffer_load_dword v5, v4, s[4:7], s16 offen sc1
    v_mfma_f32_16x16x32_bf16 v[12:15], v[196:199], v[56:59], v[12:15]
    v_mfma_f32_16x16x32_bf16 v[16:19], v[200:203], v[56:59], v[16:19]
    ds_read_b128 v[68:71], v2 offset:23552
    v_mfma_f32_16x16x32_bf16 v[16:19], v[216:219], v[60:63], v[16:19]
    v_mfma_f32_16x16x32_bf16 v[20:23], v[220:223], v[60:63], v[20:23]
    v_mfma_f32_16x16x32_bf16 v[20:23], v[204:207], v[56:59], v[20:23]
    s_waitcnt lgkmcnt(0)
    v_mfma_f32_16x16x32_bf16 v[20:23], v[236:239], v[64:67], v[20:23]
    v_mfma_f32_16x16x32_bf16 v[20:23], v[252:255], v[68:71], v[20:23]
    v_mfma_f32_16x16x32_bf16 v[16:19], v[248:251], v[68:71], v[16:19]
    v_mfma_f32_16x16x32_bf16 v[16:19], v[232:235], v[64:67], v[16:19]
    v_mfma_f32_16x16x32_bf16 v[12:15], v[228:231], v[64:67], v[12:15]
    v_mfma_f32_16x16x32_bf16 v[12:15], v[244:247], v[68:71], v[12:15]
    v_mfma_f32_16x16x32_bf16 v[8:11], v[240:243], v[68:71], v[8:11]
    v_mfma_f32_16x16x32_bf16 v[8:11], v[224:227], v[64:67], v[8:11]
    s_nop 7
    v_cvt_pk_bf16_f32 v72, v8, v9
    v_cvt_pk_bf16_f32 v73, v10, v11
    v_cvt_pk_bf16_f32 v74, v12, v13
    v_cvt_pk_bf16_f32 v75, v14, v15
    buffer_store_dwordx4 v[72:75], v1, s[12:15], s36 offen offset:0 sc1
    v_cvt_pk_bf16_f32 v76, v16, v17
    v_cvt_pk_bf16_f32 v77, v18, v19
    v_cvt_pk_bf16_f32 v78, v20, v21
    v_cvt_pk_bf16_f32 v79, v22, v23
    buffer_store_dwordx4 v[76:79], v1, s[12:15], s36 offen offset:1024 sc1
    s_add_u32 s54, s31, 1
    v_mov_b32 v6, s54
    s_waitcnt vmcnt(2)
    s_cmp_ge_i32 s31, 63
    s_cbranch_scc1 Lffb_late0
    v_cmp_gt_i32 vcc, s32, v5
    s_sub_u32 s43, s43, 1
    s_cmp_lt_i32 s43, 0
    s_cbranch_scc1 Lffb_rdy0
    s_and_b64 vcc, vcc, s[18:19]
    s_cbranch_scc0 Lffb_rdy0
Lffb_late0:
    buffer_load_dword v5, v4, s[4:7], s16 offen sc1
    s_waitcnt vmcnt(1)
    buffer_store_dword v6, v80, s[12:15], s17 offen sc1
    s_mov_b32 s14, 0
    s_cmp_ge_i32 s31, 63
    s_cbranch_scc1 L_exit
    s_waitcnt vmcnt(1)
    v_cmp_gt_i32 vcc, s32, v5
    s_sub_u32 s43, s43, 1
    s_cmp_lt_i32 s43, 0
    s_cbranch_scc1 Lffb_rdy0
    s_and_b64 vcc, vcc, s[18:19]
    s_cbranch_scc0 Lffb_rdy0
Lffb_spin0:
    buffer_load_dword v5, v4, s[4:7], s16 offen sc1
    s_waitcnt vmcnt(0)
    v_cmp_gt_i32 vcc, s32, v5
    s_sub_u32 s43, s43, 1
    s_cmp_lt_i32 s43, 0
    s_cbranch_scc1 Lffb_rdy0
    s_and_b64 vcc, vcc, s[18:19]
    s_cbranch_scc0 Lffb_rdy0
    s_sleep 8
    s_branch Lffb_spin0
Lffb_rdy0:
    s_add_u32 m0, s34, 0
    s_nop 0
    buffer_load_dwordx4 v1, s[8:11], s33 offen offset:0 sc1 lds
    buffer_load_dwordx4 v1, s[8:11], s33 offen offset:1024 sc1 lds
    buffer_load_dwordx4 v1, s[8:11], s33 offen offset:2048 sc1 lds
    s_add_u32 s16, s16, 8192
    buffer_load_dword v5, v4, s[4:7], s16 offen sc1
    s_add_u32 m0, s34, s3
    s_add_u32 s37, s33, s3
    buffer_load_dwordx4 v1, s[8:11], s37 offen offset:0 sc1 lds
    buffer_load_dwordx4 v1, s[8:11], s37 offen offset:1024 sc1 lds
    buffer_load_dwordx4 v1, s[8:11], s37 offen offset:2048 sc1 lds
    s_add_u32 s32, s32, 1
    s_add_u32 s33, s33, 116736
    s_add_u32 s34, s34, 36864
    s_cmp_ge_u32 s34, 147456
    s_cselect_b32 s38, 147456, 0
    s_sub_u32 s34, s34, s38
    s_waitcnt vmcnt(4)
    buffer_store_dword v6, v80, s[12:15], s17 offen sc1
Lffb_go0:
    s_mov_b32 s14, 0
    s_barrier
    ds_read_b128 v[40:43], v3 offset:0
    ds_read_b128 v[44:47], v3 offset:1024
    s_branch Lffb_body10
Lffb_v11:
    v_mfma_f32_16x16x32_bf16 v[24:27], a[112:115], v[68:71], v[24:27]
    buffer_load_dword v5, v4, s[4:7], s16 offen sc1
    v_mfma_f32_16x16x32_bf16 v[24:27], a[96:99], v[64:67], v[24:27]
    s_waitcnt lgkmcnt(0)
    v_mfma_f32_16x16x32_bf16 v[24:27], a[128:131], v[40:43], v[24:27]
    ds_read_b128 v[48:51], v3 offset:10240
    v_mfma_f32_16x16x32_bf16 v[24:27], a[144:147], v[44:47], v[24:27]
    v_mfma_f32_16x16x32_bf16 v[28:31], a[148:151], v[44:47], v[28:31]
    v_mfma_f32_16x16x32_bf16 v[28:31], a[132:135], v[40:43], v[28:31]
    v_mfma_f32_16x16x32_bf16 v[32:35], a[136:139], v[40:43], v[32:35]
    ds_read_b128 v[52:55], v3 offset:11264
    v_mfma_f32_16x16x32_bf16 v[32:35], a[152:155], v[44:47], v[32:35]
    s_barrier
    v_mfma_f32_16x16x32_bf16 v[36:39], a[156:159], v[44:47], v[36:39]
    v_mfma_f32_16x16x32_bf16 v[36:39], a[140:143], v[40:43], v[36:39]
    s_waitcnt lgkmcnt(0)
    v_mfma_f32_16x16x32_bf16 v[36:39], a[172:175], v[48:51], v[36:39]
    ds_read_b128 v[56:59], v3 offset:12288
    v_mfma_f32_16x16x32_bf16 v[36:39], a[188:191], v[52:55], v[36:39]
    v_mfma_f32_16x16x32_bf16 v[32:35], a[184:187], v[52:55], v[32:35]
    v_mfma_f32_16x16x32_bf16 v[32:35], a[168:171], v[48:51], v[32:35]
    v_mfma_f32_16x16x32_bf16 v[28:31], a[164:167], v[48:51], v[28:31]
    ds_read_b128 v[60:63], v3 offset:13312
    v_mfma_f32_16x16x32_bf16 v[28:31], a[180:183], v[52:55], v[28:31]
    v_mfma_f32_16x16x32_bf16 v[24:27], a[176:179], v[52:55], v[24:27]
    v_mfma_f32_16x16x32_bf16 v[24:27], a[160:163], v[48:51], v[24:27]
    s_waitcnt lgkmcnt(0)
    v_mfma_f32_16x16x32_bf16 v[24:27], a[192:195], v[56:59], v[24:27]
    ds_read_b128 v[64:67], v3 offset:14336
    v_mfma_f32_16x16x32_bf16 v[24:27], a[208:211], v[60:63], v[24:27]
    v_mfma_f32_16x16x32_bf16 v[28:31], a[212:215], v[60:63], v[28:31]
    s_waitcnt vmcnt(0)
    v_cmp_gt_i32 vcc, s32, v5
    v_mfma_f32_16x16x32_bf16 v[28:31], a[196:199], v[56:59], v[28:31]
    buffer_store_dword v6, v80, s[12:15], s17 offen sc1
    s_mov_b32 s14, s6
    v_mfma_f32_16x16x32_bf16 v[32:35], a[200:203], v[56:59], v[32:35]
    ds_read_b128 v[68:71], v3 offset:15360
    s_add_u32 s17, s17, 8192
    v_mfma_f32_16x16x32_bf16 v[32:35], a[216:219], v[60:63], v[32:35]
    s_and_b64 vcc, vcc, s[18:19]
    s_cbranch_scc1 Lffb_v12
    v_mfma_f32_16x16x32_bf16 v[36:39], a[220:223], v[60:63], v[36:39]
    buffer_load_dwordx4 v1, s[8:11], s33 offen offset:0 sc1 lds
    v_mfma_f32_16x16x32_bf16 v[36:39], a[204:207], v[56:59], v[36:39]
    s_waitcnt lgkmcnt(0)
    v_mfma_f32_16x16x32_bf16 v[36:39], a[236:239], v[64:67], v[36:39]
    ds_read_b128 v[40:43], v3 offset:16384
    v_mfma_f32_16x16x32_bf16 v[36:39], a[252:255], v[68:71], v[36:39]
    v_mfma_f32_16x16x32_bf16 v[32:35], a[248:251], v[68:71], v[32:35]
    buffer_load_dwordx4 v1, s[8:11], s33 offen offset:1024 sc1 lds
    v_mfma_f32_16x16x32_bf16 v[32:35], a[232:235], v[64:67], v[32:35]
    v_mfma_f32_16x16x32_bf16 v[28:31], a[228:231], v[64:67], v[28:31]
    ds_read_b128 v[44:47], v3 offset:17408
    v_mfma_f32_16x16x32_bf16 v[28:31], a[244:247], v[68:71], v[28:31]
    v_mfma_f32_16x16x32_bf16 v[24:27], a[240:243], v[68:71], v[24:27]
    buffer_load_dwordx4 v1, s[8:11], s33 offen offset:2048 sc1 lds
    v_mfma_f32_16x16x32_bf16 v[24:27], a[224:227], v[64:67], v[24:27]
    s_waitcnt lgkmcnt(0)
    s_add_u32 s16, s16, 8192
    s_add_u32 m0, s34, s3
    v_mfma_f32_16x16x32_bf16 v[24:27], v[128:131], v[40:43], v[24:27]
    ds_read_b128 v[48:51], v3 offset:18432
    s_add_u32 s37, s33, s3
    v_mfma_f32_16x16x32_bf16 v[24:27], v[144:147], v[44:47], v[24:27]
    v_mfma_f32_16x16x32_bf16 v[28:31], v[148:151], v[44:47], v[28:31]
    buffer_load_dwordx4 v1, s[8:11], s37 offen offset:0 sc1 lds
    v_mfma_f32_16x16x32_bf16 v[28:31], v[132:135], v[40:43], v[28:31]
    v_mfma_f32_16x16x32_bf16 v[32:35], v[136:139], v[40:43], v[32:35]
    ds_read_b128 v[52:55], v3 offset:19456
    v_mfma_f32_16x16x32_bf16 v[32:35], v[152:155], v[44:47], v[32:35]
    v_mfma_f32_16x16x32_bf16 v[36:39], v[156:159], v[44:47], v[36:39]
    buffer_load_dwordx4 v1, s[8:11], s37 offen offset:1024 sc1 lds
    v_mfma_f32_16x16x32_bf16 v[36:39], v[140:143], v[40:43], v[36:39]
    s_waitcnt lgkmcnt(0)
    v_mfma_f32_16x16x32_bf16 v[36:39], v[172:175], v[48:51], v[36:39]
    ds_read_b128 v[56:59], v3 offset:20480
    v_mfma_f32_16x16x32_bf16 v[36:39], v[188:191], v[52:55], v[36:39]
    v_mfma_f32_16x16x32_bf16 v[32:35], v[184:187], v[52:55], v[32:35]
    buffer_load_dwordx4 v1, s[8:11], s37 offen offset:2048 sc1 lds
    v_mfma_f32_16x16x32_bf16 v[32:35], v[168:171], v[48:51], v[32:35]
    s_add_u32 s32, s32, 1
    s_add_u32 s33, s33, 116736
    s_add_u32 s34, s34, 36864
    v_mfma_f32_16x16x32_bf16 v[28:31], v[164:167], v[48:51], v[28:31]
    ds_read_b128 v[60:63], v3 offset:21504
    v_mfma_f32_16x16x32_bf16 v[28:31], v[180:183], v[52:55], v[28:31]
    s_cmp_ge_u32 s34, 147456
    s_cselect_b32 s38, 147456, 0
    s_sub_u32 s34, s34, s38
    v_mfma_f32_16x16x32_bf16 v[24:27], v[176:179], v[52:55], v[24:27]
    v_mfma_f32_16x16x32_bf16 v[24:27], v[160:163], v[48:51], v[24:27]
    s_waitcnt lgkmcnt(0)
    v_mfma_f32_16x16x32_bf16 v[24:27], v[192:195], v[56:59], v[24:27]
    ds_read_b128 v[64:67], v3 offset:22528
    v_mfma_f32_16x16x32_bf16 v[24:27], v[208:211], v[60:63], v[24:27]
    buffer_load_dword v5, v4, s[4:7], s16 offen sc1
    v_mfma_f32_16x16x32_bf16 v[28:31], v[212:215], v[60:63], v[28:31]
    v_mfma_f32_16x16x32_bf16 v[28:31], v[196:199], v[56:59], v[28:31]
    v_mfma_f32_16x16x32_bf16 v[32:35], v[200:203], v[56:59], v[32:35]
    ds_read_b128 v[68:71], v3 offset:23552
    v_mfma_f32_16x16x32_bf16 v[32:35], v[216:219], v[60:63], v[32:35]
    s_waitcnt vmcnt(4)
    s_barrier
    v_mfma_f32_16x16x32_bf16 v[36:39], v[220:223], v[60:63], v[36:39]
    v_mfma_f32_16x16x32_bf16 v[36:39], v[204:207], v[56:59], v[36:39]
    s_waitcnt lgkmcnt(0)
    v_mfma_f32_16x16x32_bf16 v[36:39], v[236:239], v[64:67], v[36:39]
    ds_read_b128 v[40:43], v2 offset:0
    v_mfma_f32_16x16x32_bf16 v[36:39], v[252:255], v[68:71], v[36:39]
    v_mfma_f32_16x16x32_bf16 v[32:35], v[248:251], v[68:71], v[32:35]
    v_mfma_f32_16x16x32_bf16 v[32:35], v[232:235], v[64:67], v[32:35]
    v_mfma_f32_16x16x32_bf16 v[28:31], v[228:231], v[64:67], v[28:31]
    ds_read_b128 v[44:47], v2 offset:1024
    v_mfma_f32_16x16x32_bf16 v[28:31], v[244:247], v[68:71], v[28:31]
    v_mfma_f32_16x16x32_bf16 v[24:27], v[240:243], v[68:71], v[24:27]
    v_mfma_f32_16x16x32_bf16 v[24:27], v[224:227], v[64:67], v[24:27]
    s_cmp_ge_i32 s31, 63
    s_cbranch_scc1 L_exit
    s_branch Lffb_body00
Lffb_v12:
    v_mfma_f32_16x16x32_bf16 v[36:39], a[220:223], v[60:63], v[36:39]
    buffer_load_dword v5, v4, s[4:7], s16 offen sc1
    v_mfma_f32_16x16x32_bf16 v[36:39], a[204:207], v[56:59], v[36:39]
    s_waitcnt lgkmcnt(0)
    v_mfma_f32_16x16x32_bf16 v[36:39], a[236:239], v[64:67], v[36:39]
    ds_read_b128 v[40:43], v3 offset:16384
    v_mfma_f32_16x16x32_bf16 v[36:39], a[252:255], v[68:71], v[36:39]
    v_mfma_f32_16x16x32_bf16 v[32:35], a[248:251], v[68:71], v[32:35]
    v_mfma_f32_16x16x32_bf16 v[32:35], a[232:235], v[64:67], v[32:35]
    v_mfma_f32_16x16x32_bf16 v[28:31], a[228:231], v[64:67], v[28:31]
    ds_read_b128 v[44:47], v3 offset:17408
    v_mfma_f32_16x16x32_bf16 v[28:31], a[244:247], v[68:71], v[28:31]
    v_mfma_f32_16x16x32_bf16 v[24:27], a[240:243], v[68:71], v[24:27]
    v_mfma_f32_16x16x32_bf16 v[24:27], a[224:227], v[64:67], v[24:27]
    s_waitcnt lgkmcnt(0)
    v_mfma_f32_16x16x32_bf16 v[24:27], v[128:131], v[40:43], v[24:27]
    ds_read_b128 v[48:51], v3 offset:18432
    v_mfma_f32_16x16x32_bf16 v[24:27], v[144:147], v[44:47], v[24:27]
    v_mfma_f32_16x16x32_bf16 v[28:31], v[148:151], v[44:47], v[28:31]
    v_mfma_f32_16x16x32_bf16 v[28:31], v[132:135], v[40:43], v[28:31]
    v_mfma_f32_16x16x32_bf16 v[32:35], v[136:139], v[40:43], v[32:35]
    ds_read_b128 v[52:55], v3 offset:19456
    v_mfma_f32_16x16x32_bf16 v[32:35], v[152:155], v[44:47], v[32:35]
    v_mfma_f32_16x16x32_bf16 v[36:39], v[156:159], v[44:47], v[36:39]
    v_mfma_f32_16x16x32_bf16 v[36:39], v[140:143], v[40:43], v[36:39]
    s_waitcnt lgkmcnt(0)
    v_mfma_f32_16x16x32_bf16 v[36:39], v[172:175], v[48:51], v[36:39]
    ds_read_b128 v[56:59], v3 offset:20480
    v_mfma_f32_16x16x32_bf16 v[36:39], v[188:191], v[52:55], v[36:39]
    v_mfma_f32_16x16x32_bf16 v[32:35], v[184:187], v[52:55], v[32:35]
    s_waitcnt vmcnt(0)
    v_cmp_gt_i32 vcc, s32, v5
    v_mfma_f32_16x16x32_bf16 v[32:35], v[168:171], v[48:51], v[32:35]
    v_mfma_f32_16x16x32_bf16 v[28:31], v[164:167], v[48:51], v[28:31]
    ds_read_b128 v[60:63], v3 offset:21504
    v_mfma_f32_16x16x32_bf16 v[28:31], v[180:183], v[52:55], v[28:31]
    s_and_b64 vcc, vcc, s[18:19]
    s_cbranch_scc1 Lffb_v13
    v_mfma_f32_16x16x32_bf16 v[24:27], v[176:179], v[52:55], v[24:27]
    buffer_load_dwordx4 v1, s[8:11], s33 offen offset:0 sc1 lds
    v_mfma_f32_16x16x32_bf16 v[24:27], v[160:163], v[48:51], v[24:27]
    s_waitcnt lgkmcnt(0)
    v_mfma_f32_16x16x32_bf16 v[24:27], v[192:195], v[56:59], v[24:27]
    ds_read_b128 v[64:67], v3 offset:22528
    v_mfma_f32_16x16x32_bf16 v[24:27], v[208:211], v[60:63], v[24:27]
    v_mfma_f32_16x16x32_bf16 v[28:31], v[212:215], v[60:63], v[28:31]
    buffer_load_dwordx4 v1, s[8:11], s33 offen offset:1024 sc1 lds
    v_mfma_f32_16x16x32_bf16 v[28:31], v[196:199], v[56:59], v[28:31]
    v_mfma_f32_16x16x32_bf16 v[32:35], v[200:203], v[56:59], v[32:35]
    ds_read_b128 v[68:71], v3 offset:23552
    v_mfma_f32_16x16x32_bf16 v[32:35], v[216:219], v[60:63], v[32:35]
    v_mfma_f32_16x16x32_bf16 v[36:39], v[220:223], v[60:63], v[36:39]
    buffer_load_dwordx4 v1, s[8:11], s33 offen offset:2048 sc1 lds
    v_mfma_f32_16x16x32_bf16 v[36:39], v[204:207], v[56:59], v[36:39]
    s_waitcnt vmcnt(0) lgkmcnt(0)
    s_barrier
    v_mfma_f32_16x16x32_bf16 v[36:39], v[236:239], v[64:67], v[36:39]
    ds_read_b128 v[40:43], v2 offset:0
    s_add_u32 s16, s16, 8192
    v_mfma_f32_16x16x32_bf16 v[36:39], v[252:255], v[68:71], v[36:39]
    s_add_u32 m0, s34, s3
    s_add_u32 s37, s33, s3
    v_mfma_f32_16x16x32_bf16 v[32:35], v[248:251], v[68:71], v[32:35]
    buffer_load_dword v5, v4, s[4:7], s16 offen sc1
    v_mfma_f32_16x16x32_bf16 v[32:35], v[232:235], v[64:67], v[32:35]
    v_mfma_f32_16x16x32_bf16 v[28:31], v[228:231], v[64:67], v[28:31]
    ds_read_b128 v[44:47], v2 offset:1024
    v_mfma_f32_16x16x32_bf16 v[28:31], v[244:247], v[68:71], v[28:31]
    v_mfma_f32_16x16x32_bf16 v[24:27], v[240:243], v[68:71], v[24:27]
    buffer_load_dwordx4 v1, s[8:11], s37 offen offset:0 sc1 lds
    v_mfma_f32_16x16x32_bf16 v[24:27], v[224:227], v[64:67], v[24:27]
    buffer_load_dwordx4 v1, s[8:11], s37 offen offset:1024 sc1 lds
    buffer_load_dwordx4 v1, s[8:11], s37 offen offset:2048 sc1 lds
    s_add_u32 s32, s32, 1
    s_add_u32 s33, s33, 116736
    s_add_u32 s34, s34, 36864
    s_cmp_ge_u32 s34, 147456
    s_cselect_b32 s38, 147456, 0
    s_sub_u32 s34, s34, s38
    s_cmp_ge_i32 s31, 63
    s_cbranch_scc1 L_exit
    s_branch Lffb_body00
Lffb_v13:
    v_mfma_f32_16x16x32_bf16 v[24:27], v[176:179], v[52:55], v[24:27]
    v_mfma_f32_16x16x32_bf16 v[24:27], v[160:163], v[48:51], v[24:27]
    s_waitcnt lgkmcnt(0)
    v_mfma_f32_16x16x32_bf16 v[24:27], v[192:195], v[56:59], v[24:27]
    ds_read_b128 v[64:67], v3 offset:22528
    v_mfma_f32_16x16x32_bf16 v[24:27], v[208:211], v[60:63], v[24:27]
    v_mfma_f32_16x16x32_bf16 v[28:31], v[212:215], v[60:63], v[28:31]
    buffer_load_dword v5, v4, s[4:7], s16 offen sc1
    v_mfma_f32_16x16x32_bf16 v[28:31], v[196:199], v[56:59], v[28:31]
    v_mfma_f32_16x16x32_bf16 v[32:35], v[200:203], v[56:59], v[32:35]
    ds_read_b128 v[68:71], v3 offset:23552
    v_mfma_f32_16x16x32_bf16 v[32:35], v[216:219], v[60:63], v[32:35]
    v_mfma_f32_16x16x32_bf16 v[36:39], v[220:223], v[60:63], v[36:39]
    v_mfma_f32_16x16x32_bf16 v[36:39], v[204:207], v[56:59], v[36:39]
    s_waitcnt lgkmcnt(0)
    v_mfma_f32_16x16x32_bf16 v[36:39], v[236:239], v[64:67], v[36:39]
    v_mfma_f32_16x16x32_bf16 v[36:39], v[252:255], v[68:71], v[36:39]
    v_mfma_f32_16x16x32_bf16 v[32:35], v[248:251], v[68:71], v[32:35]
    v_mfma_f32_16x16x32_bf16 v[32:35], v[232:235], v[64:67], v[32:35]
    v_mfma_f32_16x16x32_bf16 v[28:31], v[228:231], v[64:67], v[28:31]
    v_mfma_f32_16x16x32_bf16 v[28:31], v[244:247], v[68:71], v[28:31]
    v_mfma_f32_16x16x32_bf16 v[24:27], v[240:243], v[68:71], v[24:27]
    v_mfma_f32_16x16x32_bf16 v[24:27], v[224:227], v[64:67], v[24:27]
    s_nop 7
    v_cvt_pk_bf16_f32 v72, v24, v25
    v_cvt_pk_bf16_f32 v73, v26, v27
    v_cvt_pk_bf16_f32 v74, v28, v29
    v_cvt_pk_bf16_f32 v75, v30, v31
    buffer_store_dwordx4 v[72:75], v1, s[12:15], s36 offen offset:0 sc1
    v_cvt_pk_bf16_f32 v76, v32, v33
    v_cvt_pk_bf16_f32 v77, v34, v35
    v_cvt_pk_bf16_f32 v78, v36, v37
    v_cvt_pk_bf16_f32 v79, v38, v39
    buffer_store_dwordx4 v[76:79], v1, s[12:15], s36 offen offset:1024 sc1
    s_add_u32 s54, s31, 1
    v_mov_b32 v6, s54
    s_waitcnt vmcnt(2)
    s_cmp_ge_i32 s31, 63
    s_cbranch_scc1 Lffb_late1
    v_cmp_gt_i32 vcc, s32, v5
    s_sub_u32 s43, s43, 1
    s_cmp_lt_i32 s43, 0
    s_cbranch_scc1 Lffb_rdy1
    s_and_b64 vcc, vcc, s[18:19]
    s_cbranch_scc0 Lffb_rdy1
Lffb_late1:
    buffer_load_dword v5, v4, s[4:7], s16 offen sc1
    s_waitcnt vmcnt(1)
    buffer_store_dword v6, v80, s[12:15], s17 offen sc1
    s_mov_b32 s14, 0
    s_cmp_ge_i32 s31, 63
    s_cbranch_scc1 L_exit
    s_waitcnt vmcnt(1)
    v_cmp_gt_i32 vcc, s32, v5
    s_sub_u32 s43, s43, 1
    s_cmp_lt_i32 s43, 0
    s_cbranch_scc1 Lffb_rdy1
    s_and_b64 vcc, vcc, s[18:19]
    s_cbranch_scc0 Lffb_rdy1
Lffb_spin1:
    buffer_load_dword v5, v4, s[4:7], s16 offen sc1
    s_waitcnt vmcnt(0)
    v_cmp_gt_i32 vcc, s32, v5
    s_sub_u32 s43, s43, 1
    s_cmp_lt_i32 s43, 0
    s_cbranch_scc1 Lffb_rdy1
    s_and_b64 vcc, vcc, s[18:19]
    s_cbranch_scc0 Lffb_rdy1
    s_sleep 8
    s_branch Lffb_spin1
Lffb_rdy1:
    s_add_u32 m0, s34, 0
    s_nop 0
    buffer_load_dwordx4 v1, s[8:11], s33 offen offset:0 sc1 lds
    buffer_load_dwordx4 v1, s[8:11], s33 offen offset:1024 sc1 lds
    buffer_load_dwordx4 v1, s[8:11], s33 offen offset:2048 sc1 lds
    s_add_u32 s16, s16, 8192
    buffer_load_dword v5, v4, s[4:7], s16 offen sc1
    s_add_u32 m0, s34, s3
    s_add_u32 s37, s33, s3
    buffer_load_dwordx4 v1, s[8:11], s37 offen offset:0 sc1 lds
    buffer_load_dwordx4 v1, s[8:11], s37 offen offset:1024 sc1 lds
    buffer_load_dwordx4 v1, s[8:11], s37 offen offset:2048 sc1 lds
    s_add_u32 s32, s32, 1
    s_add_u32 s33, s33, 116736
    s_add_u32 s34, s34, 36864
    s_cmp_ge_u32 s34, 147456
    s_cselect_b32 s38, 147456, 0
    s_sub_u32 s34, s34, s38
    s_waitcnt vmcnt(4)
    buffer_store_dword v6, v80, s[12:15], s17 offen sc1
Lffb_go1:
    s_mov_b32 s14, 0
    s_barrier
    ds_read_b128 v[40:43], v2 offset:0
    ds_read_b128 v[44:47], v2 offset:1024
    s_branch Lffb_body00
L_exit:
L_end:
    s_endpgm
.section .rodata,"a"
.p2align 6
.amdhsa_kernel interleave_layers__sliding_local_dilated__dense_activation_squared_relu__prompt_kernel
  .amdhsa_next_free_vgpr 512
  .amdhsa_next_free_sgpr 102
  .amdhsa_accum_offset 256
  .amdhsa_group_segment_fixed_size 0
  .amdhsa_kernarg_size 88
  .amdhsa_user_sgpr_count 2
  .amdhsa_user_sgpr_kernarg_segment_ptr 1
  .amdhsa_system_sgpr_workgroup_id_x 1
.end_amdhsa_kernel
```

```asm
; @launch grid=(256,1,1) block=(256,1,1) lds=163840
.amdgcn_target "amdgcn-amd-amdhsa--gfx950"
.text
.globl interleave_layers__sliding_local_dilated__dense_activation_squared_relu__prompt_kernel
.p2align 8
.type interleave_layers__sliding_local_dilated__dense_activation_squared_relu__prompt_kernel,@function
interleave_layers__sliding_local_dilated__dense_activation_squared_relu__prompt_kernel:
    s_load_dwordx16 s[64:79], s[0:1], 0x0
    s_load_dwordx4 s[80:83], s[0:1], 0x40
    s_load_dwordx2 s[84:85], s[0:1], 0x50
    s_cmp_ge_u32 s2, 256
    s_cbranch_scc1 L_end
    v_lshrrev_b32 v1, 6, v0
    s_nop 0
    v_readfirstlane_b32 s30, v1
    v_and_b32 v0, 63, v0
    v_lshlrev_b32 v1, 4, v0
    s_lshr_b32 s53, s2, 4
    s_cmp_lt_u32 s53, 8
    s_mov_b32 s38, 0x2c281b1a
    s_mov_b32 s39, 0x3c31302d
    s_cselect_b32 s38, 0x3020100, s38
    s_cselect_b32 s39, 0x19181110, s39
    s_lshl_b32 s37, s53, 3
    s_lshr_b64 s[38:39], s[38:39], s37
    s_and_b32 s29, s38, 63
    s_mov_b32 s38, 0x11221111
    s_mov_b32 s39, 0x43333011
    s_lshl_b32 s37, s53, 2
    s_lshr_b64 s[38:39], s[38:39], s37
    s_and_b32 s53, s38, 7
    s_mov_b32 s38, 0xc8403210
    s_mov_b32 s39, 0xa8206420
    s_cmp_eq_u32 s53, 4
    s_cselect_b32 s38, 0x1302, s38
    s_mov_b32 s3, s2
    s_and_b32 s37, s3, 3
    s_lshl_b32 s28, s53, 2
    s_add_u32 s37, s37, s28
    s_lshl_b32 s37, s37, 2
    s_lshr_b64 s[38:39], s[38:39], s37
    s_and_b32 s38, s38, 15
    s_add_u32 s29, s29, s38
    s_bfe_u32 s28, s3, 0x20002
    s_cmp_ge_u32 s53, 2
    s_cselect_b32 s37, 1, 0
    s_xor_b32 s28, s28, s37
    s_mov_b32 s43, 0x40000
    s_mov_b32 s55, 0
    s_waitcnt lgkmcnt(0)
    s_mov_b32 s4, s84
    s_mov_b32 s5, s85
    s_mov_b32 s6, 0x6200000
    s_mov_b32 s7, 0x00020000
    s_mov_b32 s8, s84
    s_mov_b32 s9, s85
    s_mov_b32 s10, 0x6200000
    s_mov_b32 s11, 0x00020000
    s_cmp_lt_u32 s29, 16
    s_cbranch_scc1 Lqkv_start
    s_cmp_ge_u32 s2, 128
    s_cbranch_scc1 L_prep
    s_cmp_ge_u32 s2, 112
    s_cbranch_scc1 L_touch
    s_bfe_u32 s33, s2, 0x20002
    s_xor_b32 s33, s33, 1
    s_bfe_u32 s34, s2, 0x20004
    s_and_b32 s35, s2, 3
    s_mov_b32 s24, s64
    s_mov_b32 s25, s65
    s_mov_b32 s26, 0x400000
    s_mov_b32 s27, 0x00020000
    v_bfe_u32 v8, v0, 4, 1
    v_lshlrev_b32 v8, 5, v8
    v_lshrrev_b32 v10, 5, v0
    v_lshl_add_u32 v8, v10, 4, v8
    v_and_b32 v10, 15, v0
    v_lshl_add_u32 v8, v10, 11, v8
    s_mul_i32 s37, s33, 0x100000
    s_mul_i32 s53, s34, 0xffff8000
    s_add_u32 s37, s37, s53
    s_mul_i32 s53, s35, 0x200
    s_add_u32 s37, s37, s53
    s_mul_i32 s53, s30, 0x80
    s_add_u32 s37, s37, s53
    s_add_u32 s37, s37, 0xf8000
    buffer_load_dwordx4 v[16:19], v8, s[24:27], s37 offen offset:0
    buffer_load_dwordx4 v[20:23], v8, s[24:27], s37 offen offset:64
    v_mov_b32 v56, 0x3f803f80
    v_mov_b32 v57, 0x3f803f80
    v_mov_b32 v58, 0x3f803f80
    v_mov_b32 v59, 0x3f803f80
    s_mov_b32 s44, 0xaaaaaaaa
    s_mov_b32 s45, 0xaaaaaaaa
    s_mov_b32 s46, 0xcccccccc
    s_mov_b32 s47, 0xcccccccc
    s_mov_b32 s38, 0xf0000f
    s_mov_b32 s39, 0xf0000f00
    v_and_b32 v10, 15, v0
    v_lshlrev_b32 v10, 3, v10
    v_mov_b32 v9, 0x40000000
    v_cndmask_b32 v9, v9, v10, s[38:39]
    s_mul_i32 s36, s33, 0x220000
    s_mul_i32 s53, s34, 0x8800
    s_add_u32 s36, s36, s53
    s_mul_i32 s53, s35, 0x2000
    s_add_u32 s36, s36, s53
    s_mul_i32 s53, s30, 0x800
    s_add_u32 s36, s36, s53
    s_mul_i32 s40, s33, 0x220000
    s_mul_i32 s53, s34, 0x8800
    s_add_u32 s40, s40, s53
    s_mul_i32 s53, s35, 0x200
    s_add_u32 s40, s40, s53
    s_mul_i32 s53, s30, 0x80
    s_add_u32 s40, s40, s53
    s_add_u32 s40, s40, 0x8000
    s_lshr_b32 s38, s2, 3
    s_mov_b32 s24, s66
    s_mov_b32 s25, s67
    s_mov_b32 s26, 0x600000
    s_mov_b32 s27, 0x00020000
    v_min_u32 v12, 59, v0
    v_lshrrev_b32 v14, 2, v12
    v_lshlrev_b32 v14, 11, v14
    v_and_b32 v12, 3, v12
    v_lshl_add_u32 v12, v12, 7, v14
    s_and_b32 s41, s2, 3
    s_mul_i32 s37, s38, 0x1e000
    s_mul_i32 s53, s30, 0x7800
    s_add_u32 s37, s37, s53
    s_mul_i32 s53, s41, 0x200
    s_add_u32 s37, s37, s53
    s_add_u32 s37, s37, 0xfff10000
    buffer_load_dword v13, v12, s[24:27], s37 offen
    s_mul_i32 s37, s38, 0x1e000
    s_mul_i32 s53, s30, 0x7800
    s_add_u32 s37, s37, s53
    s_mul_i32 s53, s41, 0x200
    s_add_u32 s37, s37, s53
    buffer_load_dword v14, v12, s[24:27], s37 offen
    s_waitcnt vmcnt(2)
    v_permlane16_swap_b32 v16, v18
    v_permlane16_swap_b32 v17, v19
    buffer_store_dwordx4 v[16:19], v1, s[4:7], s36 offen offset:0 sc1
    v_permlane16_swap_b32 v20, v22
    v_permlane16_swap_b32 v21, v23
    buffer_store_dwordx4 v[20:23], v1, s[4:7], s36 offen offset:1024 sc1
    v_mfma_f32_16x16x32_bf16 v[68:71], v[16:19], v[16:19], 0
    v_mfma_f32_16x16x32_bf16 v[64:67], v[56:59], v[16:19], 0
    v_mfma_f32_16x16x32_bf16 v[68:71], v[20:23], v[20:23], v[68:71]
    v_mfma_f32_16x16x32_bf16 v[64:67], v[56:59], v[20:23], v[64:67]
    s_nop 6
    v_cndmask_b32 v68, v68, v69, s[44:45]
    v_cndmask_b32 v70, v70, v71, s[44:45]
    v_cndmask_b32 v65, v68, v70, s[46:47]
    buffer_store_dwordx2 v[64:65], v9, s[4:7], s40 offen offset:0 sc1
    s_lshr_b32 s38, s2, 3
    s_mov_b32 s24, s66
    s_mov_b32 s25, s67
    s_mov_b32 s26, 0x600000
    s_mov_b32 s27, 0x00020000
    v_min_u32 v12, 59, v0
    v_lshrrev_b32 v14, 2, v12
    v_lshlrev_b32 v14, 11, v14
    v_and_b32 v12, 3, v12
    v_lshl_add_u32 v12, v12, 7, v14
    s_and_b32 s41, s2, 3
    s_mul_i32 s37, s38, 0x1e000
    s_mul_i32 s53, s30, 0x7800
    s_add_u32 s37, s37, s53
    s_mul_i32 s53, s41, 0x200
    s_add_u32 s37, s37, s53
    s_add_u32 s37, s37, 0x2d0000
    buffer_load_dword v15, v12, s[24:27], s37 offen
    s_getpc_b64 s[24:25]
L_pc169:
    s_sub_u32 s24, s24, L_pc169-interleave_layers__sliding_local_dilated__dense_activation_squared_relu__prompt_kernel
    s_subb_u32 s25, s25, 0
    s_mov_b32 s26, L_end-interleave_layers__sliding_local_dilated__dense_activation_squared_relu__prompt_kernel
    s_mov_b32 s27, 0x00020000
    s_mul_i32 s37, s38, 0x200
    s_mul_i32 s53, s30, 0x80
    s_add_u32 s37, s37, s53
    s_add_u32 s37, s37, 0xfffff000
    v_min_u32 v12, 11, v0
    v_mul_u32_u24 v12, 12288, v12
    buffer_load_dword v55, v12, s[24:27], s37 offen
    s_waitcnt vmcnt(2)
    s_barrier
    s_mov_b32 s20, s82
    s_mov_b32 s21, s83
    s_mov_b32 s22, 0x100
    s_mov_b32 s23, 0x00020000
    s_cmp_eq_u32 s30, 0
    s_cselect_b32 s22, 256, 0
    s_mul_i32 s37, s33, 0x40
    s_add_u32 s37, s37, 0x4
    v_mov_b32 v6, 1
    v_lshlrev_b32 v5, 8, v0
    buffer_atomic_add v6, v5, s[20:23], s37 offen
    s_branch L_p2
L_touch:
    s_lshr_b32 s38, s2, 3
    s_mov_b32 s24, s66
    s_mov_b32 s25, s67
    s_mov_b32 s26, 0x600000
    s_mov_b32 s27, 0x00020000
    v_min_u32 v12, 59, v0
    v_lshrrev_b32 v14, 2, v12
    v_lshlrev_b32 v14, 11, v14
    v_and_b32 v12, 3, v12
    v_lshl_add_u32 v12, v12, 7, v14
    s_and_b32 s41, s2, 3
    s_mul_i32 s37, s38, 0x1e000
    s_mul_i32 s53, s30, 0x7800
    s_add_u32 s37, s37, s53
    s_mul_i32 s53, s41, 0x200
    s_add_u32 s37, s37, s53
    s_add_u32 s37, s37, 0xfff10000
    buffer_load_dword v13, v12, s[24:27], s37 offen
    s_mul_i32 s37, s38, 0x1e000
    s_mul_i32 s53, s30, 0x7800
    s_add_u32 s37, s37, s53
    s_mul_i32 s53, s41, 0x200
    s_add_u32 s37, s37, s53
    buffer_load_dword v14, v12, s[24:27], s37 offen
    s_mul_i32 s37, s38, 0x1e000
    s_mul_i32 s53, s30, 0x7800
    s_add_u32 s37, s37, s53
    s_mul_i32 s53, s41, 0x200
    s_add_u32 s37, s37, s53
    s_add_u32 s37, s37, 0x2d0000
    buffer_load_dword v15, v12, s[24:27], s37 offen
    s_getpc_b64 s[24:25]
L_pc228:
    s_sub_u32 s24, s24, L_pc228-interleave_layers__sliding_local_dilated__dense_activation_squared_relu__prompt_kernel
    s_subb_u32 s25, s25, 0
    s_mov_b32 s26, L_end-interleave_layers__sliding_local_dilated__dense_activation_squared_relu__prompt_kernel
    s_mov_b32 s27, 0x00020000
    s_mul_i32 s37, s38, 0x200
    s_mul_i32 s53, s30, 0x80
    s_add_u32 s37, s37, s53
    s_add_u32 s37, s37, 0xfffff000
    v_min_u32 v12, 11, v0
    v_mul_u32_u24 v12, 12288, v12
    buffer_load_dword v55, v12, s[24:27], s37 offen
    s_waitcnt vmcnt(1)
    s_branch L_noprep
L_prep:
    s_bfe_u32 s33, s2, 0x20002
    s_xor_b32 s33, s33, 1
    s_bfe_u32 s34, s2, 0x30004
    s_lshl_b32 s34, s34, 2
    s_and_b32 s37, s2, 3
    s_add_u32 s34, s34, s37
    s_mul_i32 s37, s33, 0x80000
    s_mul_i32 s53, s34, 0x2000
    s_add_u32 s37, s37, s53
    s_mul_i32 s53, s30, 0x800
    s_add_u32 s37, s37, s53
    s_add_u32 s37, s37, 0x6000000
    s_add_u32 s38, s37, 262144
    v_mov_b32 v60, 0
    v_mov_b32 v61, 0
    v_mov_b32 v62, 0
    v_mov_b32 v63, 0
    buffer_store_dwordx4 v[60:63], v1, s[4:7], s37 offen offset:0 sc1
    buffer_store_dwordx4 v[60:63], v1, s[4:7], s37 offen offset:1024 sc1
    buffer_store_dwordx4 v[60:63], v1, s[4:7], s38 offen offset:0 sc1
    buffer_store_dwordx4 v[60:63], v1, s[4:7], s38 offen offset:1024 sc1
    s_mov_b32 s24, s64
    s_mov_b32 s25, s65
    s_mov_b32 s26, 0x400000
    s_mov_b32 s27, 0x00020000
    v_bfe_u32 v8, v0, 4, 1
    v_lshlrev_b32 v8, 5, v8
    v_lshrrev_b32 v10, 5, v0
    v_lshl_add_u32 v8, v10, 4, v8
    v_and_b32 v10, 15, v0
    v_lshl_add_u32 v8, v10, 11, v8
    s_mul_i32 s37, s33, 0x100000
    s_mul_i32 s53, s34, 0xffff8000
    s_add_u32 s37, s37, s53
    s_mul_i32 s53, s30, 0x200
    s_add_u32 s37, s37, s53
    s_add_u32 s37, s37, 0xf8000
    buffer_load_dwordx4 v[16:19], v8, s[24:27], s37 offen offset:0
    buffer_load_dwordx4 v[20:23], v8, s[24:27], s37 offen offset:64
    buffer_load_dwordx4 v[24:27], v8, s[24:27], s37 offen offset:128
    buffer_load_dwordx4 v[28:31], v8, s[24:27], s37 offen offset:192
    buffer_load_dwordx4 v[32:35], v8, s[24:27], s37 offen offset:256
    buffer_load_dwordx4 v[36:39], v8, s[24:27], s37 offen offset:320
    buffer_load_dwordx4 v[40:43], v8, s[24:27], s37 offen offset:384
    buffer_load_dwordx4 v[44:47], v8, s[24:27], s37 offen offset:448
    s_lshr_b32 s38, s2, 3
    s_mov_b32 s24, s66
    s_mov_b32 s25, s67
    s_mov_b32 s26, 0x600000
    s_mov_b32 s27, 0x00020000
    v_min_u32 v12, 59, v0
    v_lshrrev_b32 v14, 2, v12
    v_lshlrev_b32 v14, 11, v14
    v_and_b32 v12, 3, v12
    v_lshl_add_u32 v12, v12, 7, v14
    s_and_b32 s41, s2, 3
    s_mul_i32 s37, s38, 0x1e000
    s_mul_i32 s53, s30, 0x7800
    s_add_u32 s37, s37, s53
    s_mul_i32 s53, s41, 0x200
    s_add_u32 s37, s37, s53
    buffer_load_dword v13, v12, s[24:27], s37 offen
    s_mul_i32 s37, s38, 0x1e000
    s_mul_i32 s53, s30, 0x7800
    s_add_u32 s37, s37, s53
    s_mul_i32 s53, s41, 0x200
    s_add_u32 s37, s37, s53
    s_add_u32 s37, s37, 0x2d0000
    buffer_load_dword v14, v12, s[24:27], s37 offen
    v_mov_b32 v56, 0x3f803f80
    v_mov_b32 v57, 0x3f803f80
    v_mov_b32 v58, 0x3f803f80
    v_mov_b32 v59, 0x3f803f80
    s_mov_b32 s44, 0xaaaaaaaa
    s_mov_b32 s45, 0xaaaaaaaa
    s_mov_b32 s46, 0xcccccccc
    s_mov_b32 s47, 0xcccccccc
    s_mov_b32 s38, 0xf0000f
    s_mov_b32 s39, 0xf0000f00
    v_and_b32 v10, 15, v0
    v_lshlrev_b32 v10, 3, v10
    v_mov_b32 v9, 0x40000000
    v_cndmask_b32 v9, v9, v10, s[38:39]
    s_mul_i32 s36, s33, 0x220000
    s_mul_i32 s53, s34, 0x8800
    s_add_u32 s36, s36, s53
    s_mul_i32 s53, s30, 0x2000
    s_add_u32 s36, s36, s53
    s_add_u32 s42, s36, 4096
    s_mul_i32 s40, s33, 0x220000
    s_mul_i32 s53, s34, 0x8800
    s_add_u32 s40, s40, s53
    s_mul_i32 s53, s30, 0x200
    s_add_u32 s40, s40, s53
    s_add_u32 s40, s40, 0x8000
    s_mul_i32 s17, s33, 0x80000
    s_mul_i32 s53, s34, 0x2000
    s_add_u32 s17, s17, s53
    s_mul_i32 s53, s30, 0x80
    s_add_u32 s17, s17, s53
    s_add_u32 s17, s17, 0x6041e00
    s_waitcnt vmcnt(10)
    s_barrier
    s_mov_b32 s20, s82
    s_mov_b32 s21, s83
    s_mov_b32 s22, 0x100
    s_mov_b32 s23, 0x00020000
    s_cmp_eq_u32 s30, 0
    s_cselect_b32 s22, 256, 0
    s_and_b32 s37, s2, 15
    s_lshl_b32 s37, s37, 4
    v_mov_b32 v6, 1
    v_lshlrev_b32 v5, 8, v0
    buffer_atomic_add v6, v5, s[20:23], s37 offen
    s_cmp_lt_u32 s34, 3
    s_cselect_b32 s10, 0, s10
    s_waitcnt vmcnt(3)
    v_permlane16_swap_b32 v16, v18
    v_permlane16_swap_b32 v17, v19
    buffer_store_dwordx4 v[16:19], v1, s[8:11], s36 offen offset:0 sc1
    v_permlane16_swap_b32 v20, v22
    v_permlane16_swap_b32 v21, v23
    buffer_store_dwordx4 v[20:23], v1, s[8:11], s36 offen offset:1024 sc1
    v_permlane16_swap_b32 v24, v26
    v_permlane16_swap_b32 v25, v27
    buffer_store_dwordx4 v[24:27], v1, s[8:11], s36 offen offset:2048 sc1
    v_permlane16_swap_b32 v28, v30
    v_permlane16_swap_b32 v29, v31
    buffer_store_dwordx4 v[28:31], v1, s[8:11], s36 offen offset:3072 sc1
    v_permlane16_swap_b32 v32, v34
    v_permlane16_swap_b32 v33, v35
    buffer_store_dwordx4 v[32:35], v1, s[8:11], s42 offen offset:0 sc1
    v_permlane16_swap_b32 v36, v38
    v_permlane16_swap_b32 v37, v39
    buffer_store_dwordx4 v[36:39], v1, s[8:11], s42 offen offset:1024 sc1
    v_permlane16_swap_b32 v40, v42
    v_permlane16_swap_b32 v41, v43
    buffer_store_dwordx4 v[40:43], v1, s[8:11], s42 offen offset:2048 sc1
    v_permlane16_swap_b32 v44, v46
    v_permlane16_swap_b32 v45, v47
    buffer_store_dwordx4 v[44:47], v1, s[8:11], s42 offen offset:3072 sc1
    v_mfma_f32_16x16x32_bf16 v[68:71], v[16:19], v[16:19], 0
    v_mfma_f32_16x16x32_bf16 v[76:79], v[24:27], v[24:27], 0
    v_mfma_f32_16x16x32_bf16 v[84:87], v[32:35], v[32:35], 0
    v_mfma_f32_16x16x32_bf16 v[92:95], v[40:43], v[40:43], 0
    v_mfma_f32_16x16x32_bf16 v[64:67], v[56:59], v[16:19], 0
    v_mfma_f32_16x16x32_bf16 v[72:75], v[56:59], v[24:27], 0
    v_mfma_f32_16x16x32_bf16 v[80:83], v[56:59], v[32:35], 0
    v_mfma_f32_16x16x32_bf16 v[88:91], v[56:59], v[40:43], 0
    v_mfma_f32_16x16x32_bf16 v[68:71], v[20:23], v[20:23], v[68:71]
    v_mfma_f32_16x16x32_bf16 v[76:79], v[28:31], v[28:31], v[76:79]
    v_mfma_f32_16x16x32_bf16 v[84:87], v[36:39], v[36:39], v[84:87]
    v_mfma_f32_16x16x32_bf16 v[92:95], v[44:47], v[44:47], v[92:95]
    v_mfma_f32_16x16x32_bf16 v[64:67], v[56:59], v[20:23], v[64:67]
    v_mfma_f32_16x16x32_bf16 v[72:75], v[56:59], v[28:31], v[72:75]
    v_mfma_f32_16x16x32_bf16 v[80:83], v[56:59], v[36:39], v[80:83]
    v_mfma_f32_16x16x32_bf16 v[88:91], v[56:59], v[44:47], v[88:91]
    s_nop 0
    v_cndmask_b32 v68, v68, v69, s[44:45]
    v_cndmask_b32 v76, v76, v77, s[44:45]
    v_cndmask_b32 v84, v84, v85, s[44:45]
    v_cndmask_b32 v92, v92, v93, s[44:45]
    v_cndmask_b32 v70, v70, v71, s[44:45]
    v_cndmask_b32 v78, v78, v79, s[44:45]
    v_cndmask_b32 v86, v86, v87, s[44:45]
    v_cndmask_b32 v94, v94, v95, s[44:45]
    v_cndmask_b32 v65, v68, v70, s[46:47]
    v_cndmask_b32 v73, v76, v78, s[46:47]
    v_cndmask_b32 v81, v84, v86, s[46:47]
    v_cndmask_b32 v89, v92, v94, s[46:47]
    buffer_store_dwordx2 v[64:65], v9, s[8:11], s40 offen offset:0 sc1
    buffer_store_dwordx2 v[72:73], v9, s[8:11], s40 offen offset:128 sc1
    buffer_store_dwordx2 v[80:81], v9, s[8:11], s40 offen offset:256 sc1
    buffer_store_dwordx2 v[88:89], v9, s[8:11], s40 offen offset:384 sc1
    s_lshr_b32 s38, s2, 3
    s_getpc_b64 s[24:25]
L_pc419:
    s_sub_u32 s24, s24, L_pc419-interleave_layers__sliding_local_dilated__dense_activation_squared_relu__prompt_kernel
    s_subb_u32 s25, s25, 0
    s_mov_b32 s26, L_end-interleave_layers__sliding_local_dilated__dense_activation_squared_relu__prompt_kernel
    s_mov_b32 s27, 0x00020000
    s_mul_i32 s37, s38, 0x200
    s_mul_i32 s53, s30, 0x80
    s_add_u32 s37, s37, s53
    s_add_u32 s37, s37, 0xfffff000
    v_min_u32 v12, 11, v0
    v_mul_u32_u24 v12, 12288, v12
    buffer_load_dword v55, v12, s[24:27], s37 offen
    v_and_b32 v10, 3, v0
    v_lshlrev_b32 v10, 5, v10
    s_waitcnt vmcnt(1)
    s_mov_b64 exec, 15
    buffer_store_dword v6, v10, s[4:7], s17 offen sc1
    s_mov_b64 exec, -1
    s_mov_b32 s10, s6
L_p2:
    s_waitcnt vmcnt(2)
L_noprep:
    s_cmp_lt_u32 s2, 176
    s_cbranch_scc1 L_nompf
    s_mul_i32 s38, s2, 0x4
    s_mul_i32 s53, s30, 0x1
    s_add_u32 s38, s38, s53
    s_add_u32 s38, s38, 0xfffffd40
    v_lshlrev_b32 v12, 7, v0
    s_mov_b32 s24, s68
    s_mov_b32 s25, s69
    s_mov_b32 s26, 0x200000
    s_mov_b32 s27, 0x00020000
    s_mul_i32 s37, s38, 0x2000
    buffer_load_dword v13, v12, s[24:27], s37 offen
    s_waitcnt vmcnt(0)
    s_mov_b32 s24, s72
    s_mov_b32 s25, s73
    s_mov_b32 s26, 0x700000
    s_mov_b32 s27, 0x00020000
    s_mul_i32 s37, s38, 0x2000
    buffer_load_dword v14, v12, s[24:27], s37 offen
    s_waitcnt vmcnt(0)
    s_mul_i32 s37, s38, 0x2000
    s_add_u32 s37, s37, 0x280000
    buffer_load_dword v15, v12, s[24:27], s37 offen
    s_waitcnt vmcnt(0)
    s_mul_i32 s37, s38, 0x2000
    s_add_u32 s37, s37, 0x500000
    buffer_load_dword v16, v12, s[24:27], s37 offen
    s_waitcnt vmcnt(0)
    s_mov_b32 s24, s76
    s_mov_b32 s25, s77
    s_mov_b32 s26, 0x700000
    s_mov_b32 s27, 0x00020000
    s_mul_i32 s37, s38, 0x2000
    buffer_load_dword v17, v12, s[24:27], s37 offen
    s_waitcnt vmcnt(0)
    s_mul_i32 s37, s38, 0x2000
    s_add_u32 s37, s37, 0x280000
    buffer_load_dword v18, v12, s[24:27], s37 offen
    s_waitcnt vmcnt(0)
    s_mul_i32 s37, s38, 0x2000
    s_add_u32 s37, s37, 0x500000
    buffer_load_dword v19, v12, s[24:27], s37 offen
    s_waitcnt vmcnt(0)
    s_waitcnt vmcnt(0)
L_nompf:
    s_cmp_lt_u32 s29, 24
    s_cbranch_scc1 Lwo_start
    s_cmp_lt_u32 s29, 43
    s_cbranch_scc1 Lffa_start
    s_cmp_lt_u32 s29, 44
    s_cbranch_scc1 L_end
    s_cmp_lt_u32 s29, 60
    s_cbranch_scc1 Lffb_start
Lred_start:
    s_mov_b32 s12, s76
    s_mov_b32 s13, s77
    s_mov_b32 s14, 0x700000
    s_mov_b32 s15, 0x00020000
    v_lshrrev_b32 v24, 3, v0
    v_mul_u32_u24 v24, 2048, v24
    v_bfe_u32 v25, v0, 4, 2
    v_lshlrev_b32 v25, 1, v25
    v_and_b32 v26, 7, v0
    v_xor_b32 v25, v25, v26
    v_lshl_add_u32 v40, v25, 4, v24
    v_add_u32 v41, 15360, v40
    s_sub_u32 s38, s29, 44
    s_and_b32 s39, s38, 3
    s_lshr_b32 s38, s38, 2
    s_mul_i32 s86, s38, 0x180000
    s_mul_i32 s53, s39, 0x200
    s_add_u32 s86, s86, s53
    s_mul_i32 s37, s30, 32768
    s_add_u32 s86, s86, s37
    s_lshl_b32 s87, s30, 11
    s_add_u32 m0, s87, 0
    s_add_u32 s37, s86, 0
    buffer_load_dwordx4 v40, s[12:15], s37 offen offset:0 lds
    buffer_load_dwordx4 v41, s[12:15], s37 offen offset:1024 lds
    s_add_u32 m0, s87, 8192
    s_add_u32 s37, s86, 128
    buffer_load_dwordx4 v40, s[12:15], s37 offen offset:0 lds
    buffer_load_dwordx4 v41, s[12:15], s37 offen offset:1024 lds
    s_add_u32 m0, s87, 16384
    s_add_u32 s37, s86, 256
    buffer_load_dwordx4 v40, s[12:15], s37 offen offset:0 lds
    buffer_load_dwordx4 v41, s[12:15], s37 offen offset:1024 lds
    s_add_u32 m0, s87, 24576
    s_add_u32 s37, s86, 384
    buffer_load_dwordx4 v40, s[12:15], s37 offen offset:0 lds
    buffer_load_dwordx4 v41, s[12:15], s37 offen offset:1024 lds
    s_add_u32 m0, s87, 32768
    s_add_u32 s37, s86, 131072
    buffer_load_dwordx4 v40, s[12:15], s37 offen offset:0 lds
    buffer_load_dwordx4 v41, s[12:15], s37 offen offset:1024 lds
    s_add_u32 m0, s87, 40960
    s_add_u32 s37, s86, 131200
    buffer_load_dwordx4 v40, s[12:15], s37 offen offset:0 lds
    buffer_load_dwordx4 v41, s[12:15], s37 offen offset:1024 lds
    s_add_u32 m0, s87, 49152
    s_add_u32 s37, s86, 131328
    buffer_load_dwordx4 v40, s[12:15], s37 offen offset:0 lds
    buffer_load_dwordx4 v41, s[12:15], s37 offen offset:1024 lds
    s_add_u32 m0, s87, 57344
    s_add_u32 s37, s86, 131456
    buffer_load_dwordx4 v40, s[12:15], s37 offen offset:0 lds
    buffer_load_dwordx4 v41, s[12:15], s37 offen offset:1024 lds
    s_add_u32 m0, s87, 65536
    s_add_u32 s37, s86, 262144
    buffer_load_dwordx4 v40, s[12:15], s37 offen offset:0 lds
    buffer_load_dwordx4 v41, s[12:15], s37 offen offset:1024 lds
    s_add_u32 m0, s87, 73728
    s_add_u32 s37, s86, 262272
    buffer_load_dwordx4 v40, s[12:15], s37 offen offset:0 lds
    buffer_load_dwordx4 v41, s[12:15], s37 offen offset:1024 lds
    s_add_u32 m0, s87, 81920
    s_add_u32 s37, s86, 262400
    buffer_load_dwordx4 v40, s[12:15], s37 offen offset:0 lds
    buffer_load_dwordx4 v41, s[12:15], s37 offen offset:1024 lds
    s_add_u32 m0, s87, 90112
    s_add_u32 s37, s86, 262528
    buffer_load_dwordx4 v40, s[12:15], s37 offen offset:0 lds
    buffer_load_dwordx4 v41, s[12:15], s37 offen offset:1024 lds
    s_add_u32 m0, s87, 98304
    s_add_u32 s37, s86, 393216
    buffer_load_dwordx4 v40, s[12:15], s37 offen offset:0 lds
    buffer_load_dwordx4 v41, s[12:15], s37 offen offset:1024 lds
    s_add_u32 m0, s87, 106496
    s_add_u32 s37, s86, 393344
    buffer_load_dwordx4 v40, s[12:15], s37 offen offset:0 lds
    buffer_load_dwordx4 v41, s[12:15], s37 offen offset:1024 lds
    s_add_u32 m0, s87, 114688
    s_add_u32 s37, s86, 393472
    buffer_load_dwordx4 v40, s[12:15], s37 offen offset:0 lds
    buffer_load_dwordx4 v41, s[12:15], s37 offen offset:1024 lds
    s_add_u32 m0, s87, 122880
    s_add_u32 s37, s86, 393600
    buffer_load_dwordx4 v40, s[12:15], s37 offen offset:0 lds
    buffer_load_dwordx4 v41, s[12:15], s37 offen offset:1024 lds
    v_bfe_u32 v24, v0, 3, 2
    v_and_b32 v25, 3, v0
    v_lshlrev_b32 v25, 3, v25
    v_lshrrev_b32 v26, 2, v0
    v_lshl_add_u32 v26, v26, 7, v25
    v_lshrrev_b32 v27, 5, v0
    v_lshl_add_u32 v27, v27, 10, v26
    s_mov_b32 s37, s30
    s_mov_b32 s38, 0
    s_lshl_b32 s37, s37, 13
    v_xor_b32 v28, s38, v24
    v_lshl_add_u32 v28, v28, 5, s37
    v_add_u32 v42, v28, v26
    v_add_u32 v46, v28, v27
    s_mov_b32 s37, s30
    s_mov_b32 s38, 1
    s_lshl_b32 s37, s37, 13
    v_xor_b32 v28, s38, v24
    v_lshl_add_u32 v28, v28, 5, s37
    v_add_u32 v43, v28, v26
    v_add_u32 v47, v28, v27
    s_mov_b32 s37, s30
    s_mov_b32 s38, 2
    s_lshl_b32 s37, s37, 13
    v_xor_b32 v28, s38, v24
    v_lshl_add_u32 v28, v28, 5, s37
    v_add_u32 v44, v28, v26
    v_add_u32 v48, v28, v27
    s_mov_b32 s37, s30
    s_mov_b32 s38, 3
    s_lshl_b32 s37, s37, 13
    v_xor_b32 v28, s38, v24
    v_lshl_add_u32 v28, v28, 5, s37
    v_add_u32 v45, v28, v26
    v_add_u32 v49, v28, v27
    s_mov_b32 s20, s78
    s_mov_b32 s21, s79
    s_mov_b32 s22, 0x800
    s_mov_b32 s23, 0x00020000
    v_lshrrev_b32 v8, 4, v0
    v_lshlrev_b32 v8, 3, v8
    s_mul_i32 s37, s29, 0x200
    s_mul_i32 s53, s30, 0x80
    s_add_u32 s37, s37, s53
    s_add_u32 s37, s37, 0xffff8800
    buffer_load_dwordx2 v[10:11], v8, s[20:23], s37 offen
    s_mul_i32 s37, s29, 0x200
    s_mul_i32 s53, s30, 0x80
    s_add_u32 s37, s37, s53
    s_add_u32 s37, s37, 0xffff8820
    buffer_load_dwordx2 v[12:13], v8, s[20:23], s37 offen
    s_mul_i32 s37, s29, 0x200
    s_mul_i32 s53, s30, 0x80
    s_add_u32 s37, s37, s53
    s_add_u32 s37, s37, 0xffff8840
    buffer_load_dwordx2 v[14:15], v8, s[20:23], s37 offen
    s_mul_i32 s37, s29, 0x200
    s_mul_i32 s53, s30, 0x80
    s_add_u32 s37, s37, s53
    s_add_u32 s37, s37, 0xffff8860
    buffer_load_dwordx2 v[16:17], v8, s[20:23], s37 offen
    s_waitcnt vmcnt(0)
    v_lshlrev_b32 v100, 16, v10
    v_and_b32 v101, 0xffff0000, v10
    v_lshlrev_b32 v102, 16, v11
    v_and_b32 v103, 0xffff0000, v11
    v_lshlrev_b32 v104, 16, v12
    v_and_b32 v105, 0xffff0000, v12
    v_lshlrev_b32 v106, 16, v13
    v_and_b32 v107, 0xffff0000, v13
    v_lshlrev_b32 v108, 16, v14
    v_and_b32 v109, 0xffff0000, v14
    v_lshlrev_b32 v110, 16, v15
    v_and_b32 v111, 0xffff0000, v15
    v_lshlrev_b32 v112, 16, v16
    v_and_b32 v113, 0xffff0000, v16
    v_lshlrev_b32 v114, 16, v17
    v_and_b32 v115, 0xffff0000, v17
    v_mov_b32 v90, 0x3f803f80
    v_mov_b32 v91, 0x3f803f80
    v_mov_b32 v92, 0x3f803f80
    v_mov_b32 v93, 0x3f803f80
    s_mov_b32 s44, 0xaaaaaaaa
    s_mov_b32 s45, 0xaaaaaaaa
    s_mov_b32 s46, 0xcccccccc
    s_mov_b32 s47, 0xcccccccc
    s_mov_b32 s38, 0xf0000f
    s_mov_b32 s39, 0xf0000f00
    v_and_b32 v8, 15, v0
    v_lshlrev_b32 v8, 3, v8
    v_mov_b32 v7, 0x40000000
    v_cndmask_b32 v7, v7, v8, s[38:39]
    s_mul_i32 s37, s29, 0xffffe200
    s_mul_i32 s53, s30, 0xfffff880
    s_add_u32 s37, s37, s53
    s_add_u32 s37, s37, 0x78800
    v_add_u32 v7, s37, v7
    v_mov_b32 v94, 0
    v_mov_b32 v95, 0
    v_mov_b32 v98, 0
    v_mov_b32 v99, 0
    v_mov_b32 v8, 0x3f80
    v_mov_b32 v9, 0x3f800000
    s_mov_b32 s38, 0x100001
    s_mov_b32 s39, 0x10000100
    v_cndmask_b32 v96, v94, v8, s[38:39]
    s_mov_b32 s38, 0x200002
    s_mov_b32 s39, 0x20000200
    v_cndmask_b32 v96, v96, v9, s[38:39]
    s_mov_b32 s38, 0x400004
    s_mov_b32 s39, 0x40000400
    v_cndmask_b32 v97, v94, v8, s[38:39]
    s_mov_b32 s38, 0x800008
    s_mov_b32 s39, 0x80000800
    v_cndmask_b32 v97, v97, v9, s[38:39]
    s_mul_i32 s37, s30, 0x800
    s_add_u32 s37, s37, 0x24000
    v_add_u32 v222, s37, v1
    v_and_b32 v8, 15, v0
    v_lshl_add_u32 v9, v8, 7, s37
    v_bfe_u32 v10, v0, 4, 1
    v_lshl_add_u32 v9, v10, 3, v9
    v_lshrrev_b32 v10, 5, v0
    v_and_b32 v8, 7, v0
    v_xor_b32 v10, v10, v8
    v_add_u32 v210, 0, v222
    v_xor_b32 v11, 0, v10
    v_lshl_add_u32 v216, v11, 4, v9
    v_add_u32 v211, 8, v222
    v_xor_b32 v11, 2, v10
    v_lshl_add_u32 v217, v11, 4, v9
    v_add_u32 v212, 1024, v222
    v_xor_b32 v11, 4, v10
    v_lshl_add_u32 v218, v11, 4, v9
    v_add_u32 v213, 1032, v222
    v_xor_b32 v11, 6, v10
    v_lshl_add_u32 v219, v11, 4, v9
    v_lshrrev_b32 v9, 3, v0
    v_xor_b32 v8, v8, v9
    v_lshlrev_b32 v8, 4, v8
    v_add_u32 v214, 0, v1
    v_add_u32 v215, 1024, v1
    v_lshl_add_u32 v220, v9, 11, v8
    v_add_u32 v221, 16384, v220
    v_mov_b32 v204, v210
    v_mov_b32 v205, v211
    v_mov_b32 v206, v212
    v_mov_b32 v207, v213
    v_mov_b32 v208, v214
    v_mov_b32 v209, v215
    s_mul_i32 s37, s28, 0x80000
    s_add_u32 s37, s37, 0x6005200
    v_min_u32 v4, 27, v0
    v_lshl_add_u32 v4, v4, 5, s37
    s_mul_i32 s37, s28, 0x80000
    s_mul_i32 s53, s29, 0x80
    s_add_u32 s37, s37, s53
    s_add_u32 s37, s37, 0x5fff800
    v_lshrrev_b32 v8, 2, v0
    v_lshl_add_u32 v8, v8, 9, s37
    v_and_b32 v9, 3, v0
    v_lshl_add_u32 v8, v9, 5, v8
    v_cmp_gt_u32 vcc, 16, v0
    s_nop 1
    v_cndmask_b32 v4, v4, v8, vcc
    v_subrev_u32 v4, 16384, v4
    s_mov_b32 s32, 1
    s_mul_i32 s33, s28, 0x720000
    s_add_u32 s33, s33, 0x2018000
    s_mul_i32 s40, s28, 0x800000
    s_mul_i32 s53, s29, 0x2000
    s_add_u32 s40, s40, s53
    s_mul_i32 s53, s30, 0x800
    s_add_u32 s40, s40, s53
    s_add_u32 s40, s40, 0x3f88000
    s_mul_i32 s41, s28, 0x240000
    s_mul_i32 s53, s29, 0x2000
    s_add_u32 s41, s41, s53
    s_mul_i32 s53, s30, 0x800
    s_add_u32 s41, s41, s53
    s_add_u32 s41, s41, 0x1188000
    s_mul_i32 s36, s28, 0x220000
    s_mul_i32 s53, s29, 0x2000
    s_add_u32 s36, s36, s53
    s_mul_i32 s53, s30, 0x800
    s_add_u32 s36, s36, s53
    s_add_u32 s36, s36, 0x8f800
    s_mul_i32 s42, s28, 0x100000
    s_mul_i32 s53, s29, 0x200
    s_add_u32 s42, s42, s53
    s_mul_i32 s53, s30, 0x80
    s_add_u32 s42, s42, s53
    s_add_u32 s42, s42, 0x1f8800
    s_mov_b32 s24, s84
    s_mov_b32 s25, s85
    s_mov_b32 s26, 0x0
    s_mov_b32 s27, 0x00020000
    s_mov_b32 s54, 0
    s_mov_b32 s31, -1
    s_mov_b32 s35, 0
    s_mov_b32 s16, 0
    v_mov_b32 v5, 0
    s_mul_i32 s17, s28, 0x80000
    s_mul_i32 s53, s29, 0x80
    s_add_u32 s17, s17, s53
    s_mul_i32 s53, s30, 0x20
    s_add_u32 s17, s17, s53
    s_add_u32 s17, s17, 0x5ffc000
    v_cmp_eq_u32 vcc, 0, v0
    v_mov_b32 v80, 0x40000000
    s_nop 0
    v_cndmask_b32 v80, v80, v0, vcc
    v_mov_b32 v2, v1
    s_mul_i32 s34, s30, 4096
    s_add_u32 s33, s33, s34
    s_mov_b64 s[18:19], 0xfffffff
    v_mov_b32 v8, 0x40000000
    v_cndmask_b32 v4, v8, v4, s[18:19]
    v_add_u32 v12, 0, v42
    v_add_u32 v13, 0, v43
    v_add_u32 v14, 0, v44
    v_add_u32 v15, 0, v45
    s_waitcnt vmcnt(24) lgkmcnt(0)
    s_barrier
    s_add_u32 m0, s87, 131072
    s_add_u32 s37, s86, 524288
    buffer_load_dwordx4 v40, s[12:15], s37 offen offset:0 lds
    ds_read_b64_tr_b16 a[0:1], v12 offset:0
    ds_read_b64_tr_b16 a[2:3], v12 offset:2048
    ds_read_b64_tr_b16 a[4:5], v13 offset:0
    buffer_load_dwordx4 v41, s[12:15], s37 offen offset:1024 lds
    ds_read_b64_tr_b16 a[6:7], v13 offset:2048
    ds_read_b64_tr_b16 a[8:9], v14 offset:0
    ds_read_b64_tr_b16 a[10:11], v14 offset:2048
    s_add_u32 m0, s87, 139264
    s_add_u32 s37, s86, 524416
    buffer_load_dwordx4 v40, s[12:15], s37 offen offset:0 lds
    ds_read_b64_tr_b16 a[12:13], v15 offset:0
    ds_read_b64_tr_b16 a[14:15], v15 offset:2048
    ds_read_b64_tr_b16 a[16:17], v12 offset:4096
    buffer_load_dwordx4 v41, s[12:15], s37 offen offset:1024 lds
    ds_read_b64_tr_b16 a[18:19], v12 offset:6144
    ds_read_b64_tr_b16 a[20:21], v13 offset:4096
    ds_read_b64_tr_b16 a[22:23], v13 offset:6144
    s_add_u32 m0, s87, 147456
    s_add_u32 s37, s86, 524544
    buffer_load_dwordx4 v40, s[12:15], s37 offen offset:0 lds
    ds_read_b64_tr_b16 a[24:25], v14 offset:4096
    ds_read_b64_tr_b16 a[26:27], v14 offset:6144
    ds_read_b64_tr_b16 a[28:29], v15 offset:4096
    buffer_load_dwordx4 v41, s[12:15], s37 offen offset:1024 lds
    ds_read_b64_tr_b16 a[30:31], v15 offset:6144
    v_add_u32 v16, 32768, v42
    v_add_u32 v17, 32768, v43
    s_add_u32 m0, s87, 155648
    s_add_u32 s37, s86, 524672
    buffer_load_dwordx4 v40, s[12:15], s37 offen offset:0 lds
    v_add_u32 v18, 32768, v44
    v_add_u32 v19, 32768, v45
    buffer_load_dwordx4 v41, s[12:15], s37 offen offset:1024 lds
    s_waitcnt vmcnt(24) lgkmcnt(0)
    s_barrier
    s_add_u32 m0, s87, 0
    s_add_u32 s37, s86, 655360
    buffer_load_dwordx4 v40, s[12:15], s37 offen offset:0 lds
    ds_read_b64_tr_b16 a[32:33], v16 offset:0
    ds_read_b64_tr_b16 a[34:35], v16 offset:2048
    ds_read_b64_tr_b16 a[36:37], v17 offset:0
    buffer_load_dwordx4 v41, s[12:15], s37 offen offset:1024 lds
    ds_read_b64_tr_b16 a[38:39], v17 offset:2048
    ds_read_b64_tr_b16 a[40:41], v18 offset:0
    ds_read_b64_tr_b16 a[42:43], v18 offset:2048
    s_add_u32 m0, s87, 8192
    s_add_u32 s37, s86, 655488
    buffer_load_dwordx4 v40, s[12:15], s37 offen offset:0 lds
    ds_read_b64_tr_b16 a[44:45], v19 offset:0
    ds_read_b64_tr_b16 a[46:47], v19 offset:2048
    ds_read_b64_tr_b16 a[48:49], v16 offset:4096
    buffer_load_dwordx4 v41, s[12:15], s37 offen offset:1024 lds
    ds_read_b64_tr_b16 a[50:51], v16 offset:6144
    ds_read_b64_tr_b16 a[52:53], v17 offset:4096
    ds_read_b64_tr_b16 a[54:55], v17 offset:6144
    s_add_u32 m0, s87, 16384
    s_add_u32 s37, s86, 655616
    buffer_load_dwordx4 v40, s[12:15], s37 offen offset:0 lds
    ds_read_b64_tr_b16 a[56:57], v18 offset:4096
    ds_read_b64_tr_b16 a[58:59], v18 offset:6144
    ds_read_b64_tr_b16 a[60:61], v19 offset:4096
    buffer_load_dwordx4 v41, s[12:15], s37 offen offset:1024 lds
    ds_read_b64_tr_b16 a[62:63], v19 offset:6144
    v_add_u32 v12, 65536, v46
    v_add_u32 v13, 65536, v47
    s_add_u32 m0, s87, 24576
    s_add_u32 s37, s86, 655744
    buffer_load_dwordx4 v40, s[12:15], s37 offen offset:0 lds
    v_add_u32 v14, 65536, v48
    v_add_u32 v15, 65536, v49
    buffer_load_dwordx4 v41, s[12:15], s37 offen offset:1024 lds
    s_waitcnt vmcnt(24) lgkmcnt(0)
    s_barrier
    s_add_u32 m0, s87, 32768
    s_add_u32 s37, s86, 786432
    buffer_load_dwordx4 v40, s[12:15], s37 offen offset:0 lds
    ds_read_b64_tr_b16 a[64:65], v12 offset:0
    ds_read_b64_tr_b16 a[66:67], v12 offset:1024
    ds_read_b64_tr_b16 a[68:69], v13 offset:0
    buffer_load_dwordx4 v41, s[12:15], s37 offen offset:1024 lds
    ds_read_b64_tr_b16 a[70:71], v13 offset:1024
    ds_read_b64_tr_b16 a[72:73], v14 offset:0
    ds_read_b64_tr_b16 a[74:75], v14 offset:1024
    s_add_u32 m0, s87, 40960
    s_add_u32 s37, s86, 786560
    buffer_load_dwordx4 v40, s[12:15], s37 offen offset:0 lds
    ds_read_b64_tr_b16 a[76:77], v15 offset:0
    ds_read_b64_tr_b16 a[78:79], v15 offset:1024
    ds_read_b64_tr_b16 a[80:81], v12 offset:4096
    buffer_load_dwordx4 v41, s[12:15], s37 offen offset:1024 lds
    ds_read_b64_tr_b16 a[82:83], v12 offset:5120
    ds_read_b64_tr_b16 a[84:85], v13 offset:4096
    ds_read_b64_tr_b16 a[86:87], v13 offset:5120
    s_add_u32 m0, s87, 49152
    s_add_u32 s37, s86, 786688
    buffer_load_dwordx4 v40, s[12:15], s37 offen offset:0 lds
    ds_read_b64_tr_b16 a[88:89], v14 offset:4096
    ds_read_b64_tr_b16 a[90:91], v14 offset:5120
    ds_read_b64_tr_b16 a[92:93], v15 offset:4096
    buffer_load_dwordx4 v41, s[12:15], s37 offen offset:1024 lds
    ds_read_b64_tr_b16 a[94:95], v15 offset:5120
    v_add_u32 v16, 98304, v42
    v_add_u32 v17, 98304, v43
    s_add_u32 m0, s87, 57344
    s_add_u32 s37, s86, 786816
    buffer_load_dwordx4 v40, s[12:15], s37 offen offset:0 lds
    v_add_u32 v18, 98304, v44
    v_add_u32 v19, 98304, v45
    buffer_load_dwordx4 v41, s[12:15], s37 offen offset:1024 lds
    s_waitcnt vmcnt(24) lgkmcnt(0)
    s_barrier
    s_add_u32 m0, s87, 65536
    s_add_u32 s37, s86, 917504
    buffer_load_dwordx4 v40, s[12:15], s37 offen offset:0 lds
    ds_read_b64_tr_b16 a[96:97], v16 offset:0
    ds_read_b64_tr_b16 a[98:99], v16 offset:2048
    ds_read_b64_tr_b16 a[100:101], v17 offset:0
    buffer_load_dwordx4 v41, s[12:15], s37 offen offset:1024 lds
    ds_read_b64_tr_b16 a[102:103], v17 offset:2048
    ds_read_b64_tr_b16 a[104:105], v18 offset:0
    ds_read_b64_tr_b16 a[106:107], v18 offset:2048
    s_add_u32 m0, s87, 73728
    s_add_u32 s37, s86, 917632
    buffer_load_dwordx4 v40, s[12:15], s37 offen offset:0 lds
    ds_read_b64_tr_b16 a[108:109], v19 offset:0
    ds_read_b64_tr_b16 a[110:111], v19 offset:2048
    ds_read_b64_tr_b16 a[112:113], v16 offset:4096
    buffer_load_dwordx4 v41, s[12:15], s37 offen offset:1024 lds
    ds_read_b64_tr_b16 a[114:115], v16 offset:6144
    ds_read_b64_tr_b16 a[116:117], v17 offset:4096
    ds_read_b64_tr_b16 a[118:119], v17 offset:6144
    s_add_u32 m0, s87, 81920
    s_add_u32 s37, s86, 917760
    buffer_load_dwordx4 v40, s[12:15], s37 offen offset:0 lds
    ds_read_b64_tr_b16 a[120:121], v18 offset:4096
    ds_read_b64_tr_b16 a[122:123], v18 offset:6144
    ds_read_b64_tr_b16 a[124:125], v19 offset:4096
    buffer_load_dwordx4 v41, s[12:15], s37 offen offset:1024 lds
    ds_read_b64_tr_b16 a[126:127], v19 offset:6144
    v_add_u32 v12, 131072, v42
    v_add_u32 v13, 131072, v43
    s_add_u32 m0, s87, 90112
    s_add_u32 s37, s86, 917888
    buffer_load_dwordx4 v40, s[12:15], s37 offen offset:0 lds
    v_add_u32 v14, 131072, v44
    v_add_u32 v15, 131072, v45
    buffer_load_dwordx4 v41, s[12:15], s37 offen offset:1024 lds
    s_waitcnt vmcnt(24) lgkmcnt(0)
    s_barrier
    ds_read_b64_tr_b16 a[128:129], v12 offset:0
    ds_read_b64_tr_b16 a[130:131], v12 offset:2048
    ds_read_b64_tr_b16 a[132:133], v13 offset:0
    ds_read_b64_tr_b16 a[134:135], v13 offset:2048
    ds_read_b64_tr_b16 a[136:137], v14 offset:0
    ds_read_b64_tr_b16 a[138:139], v14 offset:2048
    ds_read_b64_tr_b16 a[140:141], v15 offset:0
    ds_read_b64_tr_b16 a[142:143], v15 offset:2048
    ds_read_b64_tr_b16 a[144:145], v12 offset:4096
    ds_read_b64_tr_b16 a[146:147], v12 offset:6144
    ds_read_b64_tr_b16 a[148:149], v13 offset:4096
    ds_read_b64_tr_b16 a[150:151], v13 offset:6144
    ds_read_b64_tr_b16 a[152:153], v14 offset:4096
    ds_read_b64_tr_b16 a[154:155], v14 offset:6144
    ds_read_b64_tr_b16 a[156:157], v15 offset:4096
    ds_read_b64_tr_b16 a[158:159], v15 offset:6144
    v_add_u32 v16, 0, v46
    v_add_u32 v17, 0, v47
    v_add_u32 v18, 0, v48
    v_add_u32 v19, 0, v49
    s_waitcnt vmcnt(16) lgkmcnt(0)
    s_barrier
    ds_read_b64_tr_b16 a[160:161], v16 offset:0
    ds_read_b64_tr_b16 a[162:163], v16 offset:1024
    ds_read_b64_tr_b16 a[164:165], v17 offset:0
    ds_read_b64_tr_b16 a[166:167], v17 offset:1024
    ds_read_b64_tr_b16 a[168:169], v18 offset:0
    ds_read_b64_tr_b16 a[170:171], v18 offset:1024
    ds_read_b64_tr_b16 a[172:173], v19 offset:0
    ds_read_b64_tr_b16 a[174:175], v19 offset:1024
    ds_read_b64_tr_b16 a[176:177], v16 offset:4096
    ds_read_b64_tr_b16 a[178:179], v16 offset:5120
    ds_read_b64_tr_b16 a[180:181], v17 offset:4096
    ds_read_b64_tr_b16 a[182:183], v17 offset:5120
    ds_read_b64_tr_b16 a[184:185], v18 offset:4096
    ds_read_b64_tr_b16 a[186:187], v18 offset:5120
    ds_read_b64_tr_b16 a[188:189], v19 offset:4096
    ds_read_b64_tr_b16 a[190:191], v19 offset:5120
    v_add_u32 v12, 32768, v42
    v_add_u32 v13, 32768, v43
    v_add_u32 v14, 32768, v44
    v_add_u32 v15, 32768, v45
    s_waitcnt vmcnt(8) lgkmcnt(0)
    s_barrier
    ds_read_b64_tr_b16 a[192:193], v12 offset:0
    ds_read_b64_tr_b16 a[194:195], v12 offset:2048
    ds_read_b64_tr_b16 a[196:197], v13 offset:0
    ds_read_b64_tr_b16 a[198:199], v13 offset:2048
    ds_read_b64_tr_b16 a[200:201], v14 offset:0
    ds_read_b64_tr_b16 a[202:203], v14 offset:2048
    ds_read_b64_tr_b16 a[204:205], v15 offset:0
    ds_read_b64_tr_b16 a[206:207], v15 offset:2048
    ds_read_b64_tr_b16 a[208:209], v12 offset:4096
    ds_read_b64_tr_b16 a[210:211], v12 offset:6144
    ds_read_b64_tr_b16 a[212:213], v13 offset:4096
    ds_read_b64_tr_b16 a[214:215], v13 offset:6144
    ds_read_b64_tr_b16 a[216:217], v14 offset:4096
    ds_read_b64_tr_b16 a[218:219], v14 offset:6144
    ds_read_b64_tr_b16 a[220:221], v15 offset:4096
    ds_read_b64_tr_b16 a[222:223], v15 offset:6144
    v_add_u32 v16, 65536, v42
    v_add_u32 v17, 65536, v43
    v_add_u32 v18, 65536, v44
    v_add_u32 v19, 65536, v45
    s_waitcnt vmcnt(0) lgkmcnt(0)
    s_barrier
    ds_read_b64_tr_b16 a[224:225], v16 offset:0
    ds_read_b64_tr_b16 a[226:227], v16 offset:2048
    ds_read_b64_tr_b16 a[228:229], v17 offset:0
    ds_read_b64_tr_b16 a[230:231], v17 offset:2048
    ds_read_b64_tr_b16 a[232:233], v18 offset:0
    ds_read_b64_tr_b16 a[234:235], v18 offset:2048
    ds_read_b64_tr_b16 a[236:237], v19 offset:0
    ds_read_b64_tr_b16 a[238:239], v19 offset:2048
    ds_read_b64_tr_b16 a[240:241], v16 offset:4096
    ds_read_b64_tr_b16 a[242:243], v16 offset:6144
    ds_read_b64_tr_b16 a[244:245], v17 offset:4096
    ds_read_b64_tr_b16 a[246:247], v17 offset:6144
    ds_read_b64_tr_b16 a[248:249], v18 offset:4096
    ds_read_b64_tr_b16 a[250:251], v18 offset:6144
    ds_read_b64_tr_b16 a[252:253], v19 offset:4096
    ds_read_b64_tr_b16 a[254:255], v19 offset:6144
    s_waitcnt lgkmcnt(0)
    s_mov_b32 s12, s84
    s_mov_b32 s13, s85
    s_mov_b32 s14, 0x6200000
    s_mov_b32 s15, 0x00020000
    s_barrier
    s_mov_b32 s20, s82
    s_mov_b32 s21, s83
    s_mov_b32 s22, 0x100
    s_mov_b32 s23, 0x00020000
    v_and_b32 v8, 15, v0
    v_lshlrev_b32 v8, 4, v8
    v_mov_b32 v10, 8
    buffer_load_dword v9, v8, s[20:23], 0 offen sc1
    s_waitcnt vmcnt(0)
Lred_wa:
    v_cmp_gt_u32 vcc, v10, v9
    s_sub_u32 s43, s43, 1
    s_cmp_lt_i32 s43, 0
    s_cbranch_scc1 Lred_all
    s_cbranch_vccz Lred_all
    s_sleep 2
    buffer_load_dword v9, v8, s[20:23], 0 offen sc1
    s_waitcnt vmcnt(0)
    s_branch Lred_wa
Lred_all:
    s_mov_b32 s18, 0xfff0000
    s_mov_b32 s14, 0
    s_mov_b32 s20, s84
    s_mov_b32 s21, s85
    s_mov_b32 s22, 0x0
    s_mov_b32 s23, 0x00020000
    s_cmp_lg_u32 s30, 0
    s_cbranch_scc1 Lred_f0ok
Lred_f0spin:
    buffer_load_dword v5, v4, s[4:7], s16 offen sc1
    s_waitcnt vmcnt(0)
    v_cmp_gt_i32 vcc, s32, v5
    s_sub_u32 s43, s43, 1
    s_cmp_lt_i32 s43, 0
    s_cbranch_scc1 Lred_f0ok
    s_and_b64 vcc, vcc, s[18:19]
    s_cbranch_scc0 Lred_f0ok
    s_sleep 8
    s_branch Lred_f0spin
Lred_f0ok:
    s_barrier
    s_mov_b32 s10, s6
    s_add_u32 m0, s34, 0
    s_nop 0
    buffer_load_dwordx4 v1, s[8:11], s33 offen offset:0 sc1 lds
    buffer_load_dwordx4 v1, s[8:11], s33 offen offset:1024 sc1 lds
    buffer_load_dwordx4 v1, s[8:11], s33 offen offset:2048 sc1 lds
    buffer_load_dwordx4 v1, s[8:11], s33 offen offset:3072 sc1 lds
    s_add_u32 s33, s33, 116736
    s_add_u32 s34, s34, 36864
    s_cmp_ge_u32 s34, 147456
    s_cselect_b32 s38, 147456, 0
    s_sub_u32 s34, s34, s38
    buffer_load_dwordx4 v[180:183], v1, s[4:7], s41 offen offset:0 sc1
    buffer_load_dwordx4 v[184:187], v1, s[4:7], s41 offen offset:1024 sc1
    s_add_u32 s41, s41, 36864
    s_add_u32 s16, s16, 8192
    s_cmp_lg_u32 s30, 0
    s_cbranch_scc1 Lred_f1ok
Lred_f1spin:
    buffer_load_dword v5, v4, s[4:7], s16 offen sc1
    s_waitcnt vmcnt(0)
    v_cmp_gt_i32 vcc, s32, v5
    s_sub_u32 s43, s43, 1
    s_cmp_lt_i32 s43, 0
    s_cbranch_scc1 Lred_f1ok
    s_and_b64 vcc, vcc, s[18:19]
    s_cbranch_scc0 Lred_f1ok
    s_sleep 8
    s_branch Lred_f1spin
Lred_f1ok:
    s_barrier
    s_mov_b32 s10, s6
    s_add_u32 m0, s34, 0
    s_nop 0
    buffer_load_dwordx4 v1, s[8:11], s33 offen offset:0 sc1 lds
    buffer_load_dwordx4 v1, s[8:11], s33 offen offset:1024 sc1 lds
    buffer_load_dwordx4 v1, s[8:11], s33 offen offset:2048 sc1 lds
    buffer_load_dwordx4 v1, s[8:11], s33 offen offset:3072 sc1 lds
    s_add_u32 s33, s33, 116736
    s_add_u32 s34, s34, 36864
    s_cmp_ge_u32 s34, 147456
    s_cselect_b32 s38, 147456, 0
    s_sub_u32 s34, s34, s38
    s_add_u32 s16, s16, 8192
    s_mov_b32 s18, 0xfffffff
    s_mov_b32 s31, -2
    v_mov_b32 v5, 0
    s_waitcnt vmcnt(0)
    s_branch Lred_top1
    .p2align 6
Lred_run0:
    s_waitcnt vmcnt(17)
    v_mfma_f32_16x16x32_bf16 v[20:23], v[94:97], v[120:123], v[20:23]
    s_barrier
    v_mfma_f32_16x16x32_bf16 v[16:19], v[96:99], v[120:123], v[16:19]
    s_waitcnt vmcnt(9)
    v_add_u32 v3, s35, v1
    v_cmp_gt_i32 vcc, s32, v5
    v_mfma_f32_16x16x32_bf16 v[12:15], v[94:97], v[116:119], v[12:15]
    v_mfma_f32_16x16x32_bf16 v[8:11], v[96:99], v[116:119], v[8:11]
    s_and_b64 vcc, vcc, s[18:19]
    s_cbranch_scc1 Lred_v01
    v_mfma_f32_16x16x32_bf16 v[8:11], v[96:99], v[124:127], v[8:11]
    s_add_u32 s16, s16, 8192
    v_mfma_f32_16x16x32_bf16 v[12:15], v[94:97], v[124:127], v[12:15]
    buffer_load_dwordx4 v[148:151], v1, s[4:7], s40 offen offset:0 sc1
    v_mfma_f32_16x16x32_bf16 v[16:19], v[96:99], v[128:131], v[16:19]
    ds_read_b128 v[40:43], v3 offset:0
    s_add_u32 s31, s31, 1
    v_mfma_f32_16x16x32_bf16 v[20:23], v[94:97], v[128:131], v[20:23]
    v_mov_b32 v6, s31
    v_mfma_f32_16x16x32_bf16 v[20:23], v[94:97], v[136:139], v[20:23]
    ds_read_b128 v[44:47], v3 offset:1024
    s_waitcnt vmcnt(7)
    v_mfma_f32_16x16x32_bf16 v[16:19], v[96:99], v[136:139], v[16:19]
    buffer_load_dwordx4 v[152:155], v1, s[4:7], s40 offen offset:1024 sc1
    v_mfma_f32_16x16x32_bf16 v[12:15], v[94:97], v[132:135], v[12:15]
    ds_read_b128 v[48:51], v3 offset:2048
    s_add_u32 s37, s40, 32768
    v_mfma_f32_16x16x32_bf16 v[8:11], v[96:99], v[132:135], v[8:11]
    buffer_store_dword v6, v80, s[20:23], s17 offen sc1
    s_add_u32 s17, s17, 8192
    v_mfma_f32_16x16x32_bf16 v[8:11], v[96:99], v[140:143], v[8:11]
    ds_read_b128 v[52:55], v3 offset:3072
    v_mfma_f32_16x16x32_bf16 v[12:15], v[94:97], v[140:143], v[12:15]
    buffer_load_dwordx4 v[156:159], v1, s[4:7], s37 offen offset:0 sc1
    v_mfma_f32_16x16x32_bf16 v[16:19], v[96:99], v[144:147], v[16:19]
    v_mfma_f32_16x16x32_bf16 v[20:23], v[94:97], v[144:147], v[20:23]
    s_waitcnt lgkmcnt(2)
    v_mfma_f32_16x16x32_bf16 v[24:27], a[0:3], v[40:43], v[100:103]
    ds_read_b128 v[56:59], v3 offset:4096
    v_cvt_pk_bf16_f32 v72, v8, v9
    v_mfma_f32_16x16x32_bf16 v[24:27], a[16:19], v[44:47], v[24:27]
    buffer_load_dwordx4 v[160:163], v1, s[4:7], s37 offen offset:1024 sc1
    v_mfma_f32_16x16x32_bf16 v[28:31], a[20:23], v[44:47], v[104:107]
    s_add_u32 s37, s40, 65536
    v_cvt_pk_bf16_f32 v73, v10, v11
    v_mfma_f32_16x16x32_bf16 v[28:31], a[4:7], v[40:43], v[28:31]
    ds_write_b64 v204, v[72:73]
    v_mfma_f32_16x16x32_bf16 v[32:35], a[8:11], v[40:43], v[108:111]
    ds_read_b128 v[60:63], v3 offset:5120
    v_cvt_pk_bf16_f32 v74, v12, v13
    v_mfma_f32_16x16x32_bf16 v[32:35], a[24:27], v[44:47], v[32:35]
    buffer_load_dwordx4 v[164:167], v1, s[4:7], s37 offen offset:0 sc1
    v_mfma_f32_16x16x32_bf16 v[36:39], a[28:31], v[44:47], v[112:115]
    v_cvt_pk_bf16_f32 v75, v14, v15
    v_mfma_f32_16x16x32_bf16 v[36:39], a[12:15], v[40:43], v[36:39]
    s_waitcnt lgkmcnt(3)
    ds_write_b64 v205, v[74:75]
    v_mfma_f32_16x16x32_bf16 v[36:39], a[44:47], v[48:51], v[36:39]
    ds_read_b128 v[64:67], v3 offset:6144
    v_cvt_pk_bf16_f32 v76, v16, v17
    v_mfma_f32_16x16x32_bf16 v[36:39], a[60:63], v[52:55], v[36:39]
    buffer_load_dwordx4 v[168:171], v1, s[4:7], s37 offen offset:1024 sc1
    v_mfma_f32_16x16x32_bf16 v[32:35], a[56:59], v[52:55], v[32:35]
    s_add_u32 s37, s40, 98304
    v_cvt_pk_bf16_f32 v77, v18, v19
    v_mfma_f32_16x16x32_bf16 v[32:35], a[40:43], v[48:51], v[32:35]
    ds_write_b64 v206, v[76:77]
    v_mfma_f32_16x16x32_bf16 v[28:31], a[36:39], v[48:51], v[28:31]
    ds_read_b128 v[68:71], v3 offset:7168
    v_cvt_pk_bf16_f32 v78, v20, v21
    v_mfma_f32_16x16x32_bf16 v[28:31], a[52:55], v[52:55], v[28:31]
    buffer_load_dwordx4 v[172:175], v1, s[4:7], s37 offen offset:0 sc1
    v_mfma_f32_16x16x32_bf16 v[24:27], a[48:51], v[52:55], v[24:27]
    v_cvt_pk_bf16_f32 v79, v22, v23
    v_mfma_f32_16x16x32_bf16 v[24:27], a[32:35], v[48:51], v[24:27]
    s_waitcnt lgkmcnt(4)
    ds_write_b64 v207, v[78:79]
    v_mfma_f32_16x16x32_bf16 v[24:27], a[64:67], v[56:59], v[24:27]
    ds_read_b128 v[40:43], v3 offset:8192
    v_mfma_f32_16x16x32_bf16 v[24:27], a[80:83], v[60:63], v[24:27]
    buffer_load_dwordx4 v[176:179], v1, s[4:7], s37 offen offset:1024 sc1
    v_mfma_f32_16x16x32_bf16 v[28:31], a[84:87], v[60:63], v[28:31]
    s_add_u32 m0, s34, 0
    ds_read_b128 v[196:199], v222 offset:0
    v_mfma_f32_16x16x32_bf16 v[28:31], a[68:71], v[56:59], v[28:31]
    ds_read_b128 v[200:203], v222 offset:1024
    v_mfma_f32_16x16x32_bf16 v[86:89], v[72:75], v[72:75], 0
    v_mfma_f32_16x16x32_bf16 v[82:85], v[90:93], v[72:75], 0
    buffer_load_dword v5, v4, s[4:7], s16 offen sc1
    v_mfma_f32_16x16x32_bf16 v[86:89], v[76:79], v[76:79], v[86:89]
    v_mfma_f32_16x16x32_bf16 v[82:85], v[90:93], v[76:79], v[82:85]
    s_waitcnt lgkmcnt(1)
    v_mfma_f32_16x16x32_bf16 v[32:35], a[72:75], v[56:59], v[32:35]
    ds_read_b128 v[44:47], v3 offset:9216
    v_mfma_f32_16x16x32_bf16 v[32:35], a[88:91], v[60:63], v[32:35]
    buffer_store_dwordx4 v[196:199], v208, s[24:27], s54 offen sc1
    s_waitcnt lgkmcnt(1)
    v_mfma_f32_16x16x32_bf16 v[36:39], a[92:95], v[60:63], v[36:39]
    v_mfma_f32_16x16x32_bf16 v[36:39], a[76:79], v[56:59], v[36:39]
    v_mfma_f32_16x16x32_bf16 v[36:39], a[108:111], v[64:67], v[36:39]
    ds_read_b128 v[48:51], v3 offset:10240
    v_mfma_f32_16x16x32_bf16 v[36:39], a[124:127], v[68:71], v[36:39]
    buffer_store_dwordx4 v[200:203], v209, s[24:27], s54 offen sc1
    v_cndmask_b32 v86, v86, v87, s[44:45]
    v_mfma_f32_16x16x32_bf16 v[32:35], a[120:123], v[68:71], v[32:35]
    v_cndmask_b32 v88, v88, v89, s[44:45]
    v_cndmask_b32 v83, v86, v88, s[46:47]
    v_mfma_f32_16x16x32_bf16 v[32:35], a[104:107], v[64:67], v[32:35]
    buffer_store_dwordx2 v[82:83], v7, s[12:15], s36 offen offset:0 sc1
    s_mov_b32 s22, s14
    v_mfma_f32_16x16x32_bf16 v[28:31], a[100:103], v[64:67], v[28:31]
    ds_read_b128 v[52:55], v3 offset:11264
    s_add_u32 s36, s36, 34816
    v_mfma_f32_16x16x32_bf16 v[28:31], a[116:119], v[68:71], v[28:31]
    buffer_load_dwordx4 v1, s[8:11], s33 offen offset:0 sc1 lds
    v_mfma_f32_16x16x32_bf16 v[24:27], a[112:115], v[68:71], v[24:27]
    s_sub_u32 s42, s42, 32768
    v_mfma_f32_16x16x32_bf16 v[24:27], a[96:99], v[64:67], v[24:27]
    s_waitcnt lgkmcnt(2)
    v_mfma_f32_16x16x32_bf16 v[24:27], a[128:131], v[40:43], v[24:27]
    ds_read_b128 v[56:59], v3 offset:12288
    v_mfma_f32_16x16x32_bf16 v[24:27], a[144:147], v[44:47], v[24:27]
    buffer_load_dwordx4 v1, s[8:11], s33 offen offset:1024 sc1 lds
    v_mfma_f32_16x16x32_bf16 v[28:31], a[148:151], v[44:47], v[28:31]
    s_cmp_lt_i32 s31, 31
    s_cselect_b32 s14, s6, 0
    s_cselect_b32 s54, s36, s42
    v_mfma_f32_16x16x32_bf16 v[28:31], a[132:135], v[40:43], v[28:31]
    s_cmp_lt_i32 s31, 31
    s_cselect_b64 s[24:25], s[4:5], s[80:81]
    s_cselect_b32 s26, s6, 0x400000
    v_mfma_f32_16x16x32_bf16 v[32:35], a[136:139], v[40:43], v[32:35]
    ds_read_b128 v[60:63], v3 offset:13312
    v_mfma_f32_16x16x32_bf16 v[32:35], a[152:155], v[44:47], v[32:35]
    buffer_load_dwordx4 v1, s[8:11], s33 offen offset:2048 sc1 lds
    v_mfma_f32_16x16x32_bf16 v[36:39], a[156:159], v[44:47], v[36:39]
    s_cmp_lt_i32 s31, 31
    s_cselect_b64 s[48:49], 0, -1
    v_cndmask_b32 v204, v210, v216, s[48:49]
    v_mfma_f32_16x16x32_bf16 v[36:39], a[140:143], v[40:43], v[36:39]
    s_waitcnt lgkmcnt(2)
    v_cndmask_b32 v205, v211, v217, s[48:49]
    v_cndmask_b32 v206, v212, v218, s[48:49]
    v_mfma_f32_16x16x32_bf16 v[36:39], a[172:175], v[48:51], v[36:39]
    ds_read_b128 v[64:67], v3 offset:14336
    v_cndmask_b32 v207, v213, v219, s[48:49]
    v_mfma_f32_16x16x32_bf16 v[36:39], a[188:191], v[52:55], v[36:39]
    buffer_load_dwordx4 v1, s[8:11], s33 offen offset:3072 sc1 lds
    v_mfma_f32_16x16x32_bf16 v[32:35], a[184:187], v[52:55], v[32:35]
    s_add_u32 s32, s32, 1
    s_add_u32 s40, s40, 131072
    s_add_u32 s33, s33, 116736
    v_mfma_f32_16x16x32_bf16 v[32:35], a[168:171], v[48:51], v[32:35]
    s_add_u32 s34, s34, 36864
    s_cmp_ge_u32 s34, 147456
    s_cselect_b32 s38, 147456, 0
    v_mfma_f32_16x16x32_bf16 v[28:31], a[164:167], v[48:51], v[28:31]
    ds_read_b128 v[68:71], v3 offset:15360
    s_sub_u32 s34, s34, s38
    v_mfma_f32_16x16x32_bf16 v[28:31], a[180:183], v[52:55], v[28:31]
    s_cmp_ge_i32 s32, 63
    s_cselect_b32 s18, 0xffff, s18
    v_cndmask_b32 v208, v214, v220, s[48:49]
    v_mfma_f32_16x16x32_bf16 v[24:27], a[176:179], v[52:55], v[24:27]
    buffer_load_dwordx4 v[180:183], v1, s[4:7], s41 offen offset:0 sc1
    v_mfma_f32_16x16x32_bf16 v[24:27], a[160:163], v[48:51], v[24:27]
    s_waitcnt lgkmcnt(2)
    v_cndmask_b32 v209, v215, v221, s[48:49]
    s_add_u32 s35, s35, 36864
    v_mfma_f32_16x16x32_bf16 v[24:27], a[192:195], v[56:59], v[24:27]
    s_cmp_eq_u32 s35, 147456
    s_cselect_b32 s35, 0, s35
    v_mfma_f32_16x16x32_bf16 v[24:27], a[208:211], v[60:63], v[24:27]
    v_mfma_f32_16x16x32_bf16 v[28:31], a[212:215], v[60:63], v[28:31]
    buffer_load_dwordx4 v[184:187], v1, s[4:7], s41 offen offset:1024 sc1
    v_mfma_f32_16x16x32_bf16 v[28:31], a[196:199], v[56:59], v[28:31]
    s_add_u32 s41, s41, 36864
    v_mfma_f32_16x16x32_bf16 v[32:35], a[200:203], v[56:59], v[32:35]
    v_mfma_f32_16x16x32_bf16 v[32:35], a[216:219], v[60:63], v[32:35]
    v_mfma_f32_16x16x32_bf16 v[36:39], a[220:223], v[60:63], v[36:39]
    v_mfma_f32_16x16x32_bf16 v[36:39], a[204:207], v[56:59], v[36:39]
    s_waitcnt lgkmcnt(0)
    v_mfma_f32_16x16x32_bf16 v[36:39], a[236:239], v[64:67], v[36:39]
    v_mfma_f32_16x16x32_bf16 v[36:39], a[252:255], v[68:71], v[36:39]
    v_mfma_f32_16x16x32_bf16 v[32:35], a[248:251], v[68:71], v[32:35]
    v_mfma_f32_16x16x32_bf16 v[32:35], a[232:235], v[64:67], v[32:35]
    v_mfma_f32_16x16x32_bf16 v[28:31], a[228:231], v[64:67], v[28:31]
    v_mfma_f32_16x16x32_bf16 v[28:31], a[244:247], v[68:71], v[28:31]
    v_mfma_f32_16x16x32_bf16 v[24:27], a[240:243], v[68:71], v[24:27]
    v_mfma_f32_16x16x32_bf16 v[24:27], a[224:227], v[64:67], v[24:27]
    s_waitcnt vmcnt(19)
    v_mfma_f32_16x16x32_bf16 v[24:27], v[96:99], v[188:191], v[24:27]
    v_mfma_f32_16x16x32_bf16 v[28:31], v[94:97], v[188:191], v[28:31]
    v_mfma_f32_16x16x32_bf16 v[32:35], v[96:99], v[192:195], v[32:35]
    v_mfma_f32_16x16x32_bf16 v[36:39], v[94:97], v[192:195], v[36:39]
    s_cmp_lt_i32 s31, 63
    s_cbranch_scc1 Lred_run1
    s_branch L_exit
Lred_run1:
    s_waitcnt vmcnt(17)
    v_mfma_f32_16x16x32_bf16 v[36:39], v[94:97], v[152:155], v[36:39]
    s_barrier
    v_mfma_f32_16x16x32_bf16 v[32:35], v[96:99], v[152:155], v[32:35]
    s_waitcnt vmcnt(9)
    v_add_u32 v2, s35, v1
    v_cmp_gt_i32 vcc, s32, v5
    v_mfma_f32_16x16x32_bf16 v[28:31], v[94:97], v[148:151], v[28:31]
    v_mfma_f32_16x16x32_bf16 v[24:27], v[96:99], v[148:151], v[24:27]
    s_and_b64 vcc, vcc, s[18:19]
    s_cbranch_scc1 Lred_v11
    v_mfma_f32_16x16x32_bf16 v[24:27], v[96:99], v[156:159], v[24:27]
    s_add_u32 s16, s16, 8192
    v_mfma_f32_16x16x32_bf16 v[28:31], v[94:97], v[156:159], v[28:31]
    buffer_load_dwordx4 v[116:119], v1, s[4:7], s40 offen offset:0 sc1
    v_mfma_f32_16x16x32_bf16 v[32:35], v[96:99], v[160:163], v[32:35]
    ds_read_b128 v[40:43], v2 offset:0
    s_add_u32 s31, s31, 1
    v_mfma_f32_16x16x32_bf16 v[36:39], v[94:97], v[160:163], v[36:39]
    v_mov_b32 v6, s31
    v_mfma_f32_16x16x32_bf16 v[36:39], v[94:97], v[168:171], v[36:39]
    ds_read_b128 v[44:47], v2 offset:1024
    s_waitcnt vmcnt(7)
    v_mfma_f32_16x16x32_bf16 v[32:35], v[96:99], v[168:171], v[32:35]
    buffer_load_dwordx4 v[120:123], v1, s[4:7], s40 offen offset:1024 sc1
    v_mfma_f32_16x16x32_bf16 v[28:31], v[94:97], v[164:167], v[28:31]
    ds_read_b128 v[48:51], v2 offset:2048
    s_add_u32 s37, s40, 32768
    v_mfma_f32_16x16x32_bf16 v[24:27], v[96:99], v[164:167], v[24:27]
    buffer_store_dword v6, v80, s[20:23], s17 offen sc1
    s_add_u32 s17, s17, 8192
    v_mfma_f32_16x16x32_bf16 v[24:27], v[96:99], v[172:175], v[24:27]
    ds_read_b128 v[52:55], v2 offset:3072
    v_mfma_f32_16x16x32_bf16 v[28:31], v[94:97], v[172:175], v[28:31]
    buffer_load_dwordx4 v[124:127], v1, s[4:7], s37 offen offset:0 sc1
    v_mfma_f32_16x16x32_bf16 v[32:35], v[96:99], v[176:179], v[32:35]
    v_mfma_f32_16x16x32_bf16 v[36:39], v[94:97], v[176:179], v[36:39]
    s_waitcnt lgkmcnt(2)
    v_mfma_f32_16x16x32_bf16 v[8:11], a[0:3], v[40:43], v[100:103]
    ds_read_b128 v[56:59], v2 offset:4096
    v_cvt_pk_bf16_f32 v72, v24, v25
    v_mfma_f32_16x16x32_bf16 v[8:11], a[16:19], v[44:47], v[8:11]
    buffer_load_dwordx4 v[128:131], v1, s[4:7], s37 offen offset:1024 sc1
    v_mfma_f32_16x16x32_bf16 v[12:15], a[20:23], v[44:47], v[104:107]
    s_add_u32 s37, s40, 65536
    v_cvt_pk_bf16_f32 v73, v26, v27
    v_mfma_f32_16x16x32_bf16 v[12:15], a[4:7], v[40:43], v[12:15]
    ds_write_b64 v204, v[72:73]
    v_mfma_f32_16x16x32_bf16 v[16:19], a[8:11], v[40:43], v[108:111]
    ds_read_b128 v[60:63], v2 offset:5120
    v_cvt_pk_bf16_f32 v74, v28, v29
    v_mfma_f32_16x16x32_bf16 v[16:19], a[24:27], v[44:47], v[16:19]
    buffer_load_dwordx4 v[132:135], v1, s[4:7], s37 offen offset:0 sc1
    v_mfma_f32_16x16x32_bf16 v[20:23], a[28:31], v[44:47], v[112:115]
    v_cvt_pk_bf16_f32 v75, v30, v31
    v_mfma_f32_16x16x32_bf16 v[20:23], a[12:15], v[40:43], v[20:23]
    s_waitcnt lgkmcnt(3)
    ds_write_b64 v205, v[74:75]
    v_mfma_f32_16x16x32_bf16 v[20:23], a[44:47], v[48:51], v[20:23]
    ds_read_b128 v[64:67], v2 offset:6144
    v_cvt_pk_bf16_f32 v76, v32, v33
    v_mfma_f32_16x16x32_bf16 v[20:23], a[60:63], v[52:55], v[20:23]
    buffer_load_dwordx4 v[136:139], v1, s[4:7], s37 offen offset:1024 sc1
    v_mfma_f32_16x16x32_bf16 v[16:19], a[56:59], v[52:55], v[16:19]
    s_add_u32 s37, s40, 98304
    v_cvt_pk_bf16_f32 v77, v34, v35
    v_mfma_f32_16x16x32_bf16 v[16:19], a[40:43], v[48:51], v[16:19]
    ds_write_b64 v206, v[76:77]
    v_mfma_f32_16x16x32_bf16 v[12:15], a[36:39], v[48:51], v[12:15]
    ds_read_b128 v[68:71], v2 offset:7168
    v_cvt_pk_bf16_f32 v78, v36, v37
    v_mfma_f32_16x16x32_bf16 v[12:15], a[52:55], v[52:55], v[12:15]
    buffer_load_dwordx4 v[140:143], v1, s[4:7], s37 offen offset:0 sc1
    v_mfma_f32_16x16x32_bf16 v[8:11], a[48:51], v[52:55], v[8:11]
    v_cvt_pk_bf16_f32 v79, v38, v39
    v_mfma_f32_16x16x32_bf16 v[8:11], a[32:35], v[48:51], v[8:11]
    s_waitcnt lgkmcnt(4)
    ds_write_b64 v207, v[78:79]
    v_mfma_f32_16x16x32_bf16 v[8:11], a[64:67], v[56:59], v[8:11]
    ds_read_b128 v[40:43], v2 offset:8192
    v_mfma_f32_16x16x32_bf16 v[8:11], a[80:83], v[60:63], v[8:11]
    buffer_load_dwordx4 v[144:147], v1, s[4:7], s37 offen offset:1024 sc1
    v_mfma_f32_16x16x32_bf16 v[12:15], a[84:87], v[60:63], v[12:15]
    s_add_u32 m0, s34, 0
    ds_read_b128 v[196:199], v222 offset:0
    v_mfma_f32_16x16x32_bf16 v[12:15], a[68:71], v[56:59], v[12:15]
    ds_read_b128 v[200:203], v222 offset:1024
    v_mfma_f32_16x16x32_bf16 v[86:89], v[72:75], v[72:75], 0
    v_mfma_f32_16x16x32_bf16 v[82:85], v[90:93], v[72:75], 0
    buffer_load_dword v5, v4, s[4:7], s16 offen sc1
    v_mfma_f32_16x16x32_bf16 v[86:89], v[76:79], v[76:79], v[86:89]
    v_mfma_f32_16x16x32_bf16 v[82:85], v[90:93], v[76:79], v[82:85]
    s_waitcnt lgkmcnt(1)
    v_mfma_f32_16x16x32_bf16 v[16:19], a[72:75], v[56:59], v[16:19]
    ds_read_b128 v[44:47], v2 offset:9216
    v_mfma_f32_16x16x32_bf16 v[16:19], a[88:91], v[60:63], v[16:19]
    buffer_store_dwordx4 v[196:199], v208, s[24:27], s54 offen sc1
    s_waitcnt lgkmcnt(1)
    v_mfma_f32_16x16x32_bf16 v[20:23], a[92:95], v[60:63], v[20:23]
    v_mfma_f32_16x16x32_bf16 v[20:23], a[76:79], v[56:59], v[20:23]
    v_mfma_f32_16x16x32_bf16 v[20:23], a[108:111], v[64:67], v[20:23]
    ds_read_b128 v[48:51], v2 offset:10240
    v_mfma_f32_16x16x32_bf16 v[20:23], a[124:127], v[68:71], v[20:23]
    buffer_store_dwordx4 v[200:203], v209, s[24:27], s54 offen sc1
    v_cndmask_b32 v86, v86, v87, s[44:45]
    v_mfma_f32_16x16x32_bf16 v[16:19], a[120:123], v[68:71], v[16:19]
    v_cndmask_b32 v88, v88, v89, s[44:45]
    v_cndmask_b32 v83, v86, v88, s[46:47]
    v_mfma_f32_16x16x32_bf16 v[16:19], a[104:107], v[64:67], v[16:19]
    buffer_store_dwordx2 v[82:83], v7, s[12:15], s36 offen offset:0 sc1
    s_mov_b32 s22, s14
    v_mfma_f32_16x16x32_bf16 v[12:15], a[100:103], v[64:67], v[12:15]
    ds_read_b128 v[52:55], v2 offset:11264
    s_add_u32 s36, s36, 34816
    v_mfma_f32_16x16x32_bf16 v[12:15], a[116:119], v[68:71], v[12:15]
    buffer_load_dwordx4 v1, s[8:11], s33 offen offset:0 sc1 lds
    v_mfma_f32_16x16x32_bf16 v[8:11], a[112:115], v[68:71], v[8:11]
    s_sub_u32 s42, s42, 32768
    v_mfma_f32_16x16x32_bf16 v[8:11], a[96:99], v[64:67], v[8:11]
    s_waitcnt lgkmcnt(2)
    v_mfma_f32_16x16x32_bf16 v[8:11], a[128:131], v[40:43], v[8:11]
    ds_read_b128 v[56:59], v2 offset:12288
    v_mfma_f32_16x16x32_bf16 v[8:11], a[144:147], v[44:47], v[8:11]
    buffer_load_dwordx4 v1, s[8:11], s33 offen offset:1024 sc1 lds
    v_mfma_f32_16x16x32_bf16 v[12:15], a[148:151], v[44:47], v[12:15]
    s_cmp_lt_i32 s31, 31
    s_cselect_b32 s14, s6, 0
    s_cselect_b32 s54, s36, s42
    v_mfma_f32_16x16x32_bf16 v[12:15], a[132:135], v[40:43], v[12:15]
    s_cmp_lt_i32 s31, 31
    s_cselect_b64 s[24:25], s[4:5], s[80:81]
    s_cselect_b32 s26, s6, 0x400000
    v_mfma_f32_16x16x32_bf16 v[16:19], a[136:139], v[40:43], v[16:19]
    ds_read_b128 v[60:63], v2 offset:13312
    v_mfma_f32_16x16x32_bf16 v[16:19], a[152:155], v[44:47], v[16:19]
    buffer_load_dwordx4 v1, s[8:11], s33 offen offset:2048 sc1 lds
    v_mfma_f32_16x16x32_bf16 v[20:23], a[156:159], v[44:47], v[20:23]
    s_cmp_lt_i32 s31, 31
    s_cselect_b64 s[48:49], 0, -1
    v_cndmask_b32 v204, v210, v216, s[48:49]
    v_mfma_f32_16x16x32_bf16 v[20:23], a[140:143], v[40:43], v[20:23]
    s_waitcnt lgkmcnt(2)
    v_cndmask_b32 v205, v211, v217, s[48:49]
    v_cndmask_b32 v206, v212, v218, s[48:49]
    v_mfma_f32_16x16x32_bf16 v[20:23], a[172:175], v[48:51], v[20:23]
    ds_read_b128 v[64:67], v2 offset:14336
    v_cndmask_b32 v207, v213, v219, s[48:49]
    v_mfma_f32_16x16x32_bf16 v[20:23], a[188:191], v[52:55], v[20:23]
    buffer_load_dwordx4 v1, s[8:11], s33 offen offset:3072 sc1 lds
    v_mfma_f32_16x16x32_bf16 v[16:19], a[184:187], v[52:55], v[16:19]
    s_add_u32 s32, s32, 1
    s_add_u32 s40, s40, 131072
    s_add_u32 s33, s33, 116736
    v_mfma_f32_16x16x32_bf16 v[16:19], a[168:171], v[48:51], v[16:19]
    s_add_u32 s34, s34, 36864
    s_cmp_ge_u32 s34, 147456
    s_cselect_b32 s38, 147456, 0
    v_mfma_f32_16x16x32_bf16 v[12:15], a[164:167], v[48:51], v[12:15]
    ds_read_b128 v[68:71], v2 offset:15360
    s_sub_u32 s34, s34, s38
    v_mfma_f32_16x16x32_bf16 v[12:15], a[180:183], v[52:55], v[12:15]
    s_cmp_ge_i32 s32, 63
    s_cselect_b32 s18, 0xffff, s18
    v_cndmask_b32 v208, v214, v220, s[48:49]
    v_mfma_f32_16x16x32_bf16 v[8:11], a[176:179], v[52:55], v[8:11]
    buffer_load_dwordx4 v[188:191], v1, s[4:7], s41 offen offset:0 sc1
    v_mfma_f32_16x16x32_bf16 v[8:11], a[160:163], v[48:51], v[8:11]
    s_waitcnt lgkmcnt(2)
    v_cndmask_b32 v209, v215, v221, s[48:49]
    s_add_u32 s35, s35, 36864
    v_mfma_f32_16x16x32_bf16 v[8:11], a[192:195], v[56:59], v[8:11]
    s_cmp_eq_u32 s35, 147456
    s_cselect_b32 s35, 0, s35
    v_mfma_f32_16x16x32_bf16 v[8:11], a[208:211], v[60:63], v[8:11]
    v_mfma_f32_16x16x32_bf16 v[12:15], a[212:215], v[60:63], v[12:15]
    buffer_load_dwordx4 v[192:195], v1, s[4:7], s41 offen offset:1024 sc1
    v_mfma_f32_16x16x32_bf16 v[12:15], a[196:199], v[56:59], v[12:15]
    s_add_u32 s41, s41, 36864
    v_mfma_f32_16x16x32_bf16 v[16:19], a[200:203], v[56:59], v[16:19]
    v_mfma_f32_16x16x32_bf16 v[16:19], a[216:219], v[60:63], v[16:19]
    v_mfma_f32_16x16x32_bf16 v[20:23], a[220:223], v[60:63], v[20:23]
    v_mfma_f32_16x16x32_bf16 v[20:23], a[204:207], v[56:59], v[20:23]
    s_waitcnt lgkmcnt(0)
    v_mfma_f32_16x16x32_bf16 v[20:23], a[236:239], v[64:67], v[20:23]
    v_mfma_f32_16x16x32_bf16 v[20:23], a[252:255], v[68:71], v[20:23]
    v_mfma_f32_16x16x32_bf16 v[16:19], a[248:251], v[68:71], v[16:19]
    v_mfma_f32_16x16x32_bf16 v[16:19], a[232:235], v[64:67], v[16:19]
    v_mfma_f32_16x16x32_bf16 v[12:15], a[228:231], v[64:67], v[12:15]
    v_mfma_f32_16x16x32_bf16 v[12:15], a[244:247], v[68:71], v[12:15]
    v_mfma_f32_16x16x32_bf16 v[8:11], a[240:243], v[68:71], v[8:11]
    v_mfma_f32_16x16x32_bf16 v[8:11], a[224:227], v[64:67], v[8:11]
    s_waitcnt vmcnt(19)
    v_mfma_f32_16x16x32_bf16 v[8:11], v[96:99], v[180:183], v[8:11]
    v_mfma_f32_16x16x32_bf16 v[12:15], v[94:97], v[180:183], v[12:15]
    v_mfma_f32_16x16x32_bf16 v[16:19], v[96:99], v[184:187], v[16:19]
    v_mfma_f32_16x16x32_bf16 v[20:23], v[94:97], v[184:187], v[20:23]
    s_cmp_lt_i32 s31, 63
    s_cbranch_scc1 Lred_run0
    s_branch L_exit
Lred_top0:
    s_waitcnt vmcnt(10)
    v_mfma_f32_16x16x32_bf16 v[20:23], v[94:97], v[120:123], v[20:23]
    s_barrier
    v_mfma_f32_16x16x32_bf16 v[16:19], v[96:99], v[120:123], v[16:19]
    s_waitcnt vmcnt(9)
    v_add_u32 v3, s35, v1
    v_cmp_gt_i32 vcc, s32, v5
    v_mfma_f32_16x16x32_bf16 v[12:15], v[94:97], v[116:119], v[12:15]
    v_mfma_f32_16x16x32_bf16 v[8:11], v[96:99], v[116:119], v[8:11]
    s_waitcnt vmcnt(8)
    s_and_b64 vcc, vcc, s[18:19]
    s_cbranch_scc1 Lred_v01
    v_mfma_f32_16x16x32_bf16 v[8:11], v[96:99], v[124:127], v[8:11]
    s_add_u32 s16, s16, 8192
    v_mfma_f32_16x16x32_bf16 v[12:15], v[94:97], v[124:127], v[12:15]
    buffer_load_dwordx4 v[148:151], v1, s[4:7], s40 offen offset:0 sc1
    v_mfma_f32_16x16x32_bf16 v[16:19], v[96:99], v[128:131], v[16:19]
    ds_read_b128 v[40:43], v3 offset:0
    s_add_u32 s31, s31, 1
    v_mfma_f32_16x16x32_bf16 v[20:23], v[94:97], v[128:131], v[20:23]
    s_waitcnt vmcnt(7)
    v_mov_b32 v6, s31
    v_mfma_f32_16x16x32_bf16 v[20:23], v[94:97], v[136:139], v[20:23]
    ds_read_b128 v[44:47], v3 offset:1024
    v_mfma_f32_16x16x32_bf16 v[16:19], v[96:99], v[136:139], v[16:19]
    buffer_load_dwordx4 v[152:155], v1, s[4:7], s40 offen offset:1024 sc1
    v_mfma_f32_16x16x32_bf16 v[12:15], v[94:97], v[132:135], v[12:15]
    ds_read_b128 v[48:51], v3 offset:2048
    s_add_u32 s37, s40, 32768
    v_mfma_f32_16x16x32_bf16 v[8:11], v[96:99], v[132:135], v[8:11]
    s_waitcnt vmcnt(6)
    buffer_store_dword v6, v80, s[20:23], s17 offen sc1
    v_mfma_f32_16x16x32_bf16 v[8:11], v[96:99], v[140:143], v[8:11]
    ds_read_b128 v[52:55], v3 offset:3072
    s_add_u32 s17, s17, 8192
    v_mfma_f32_16x16x32_bf16 v[12:15], v[94:97], v[140:143], v[12:15]
    buffer_load_dwordx4 v[156:159], v1, s[4:7], s37 offen offset:0 sc1
    v_mfma_f32_16x16x32_bf16 v[16:19], v[96:99], v[144:147], v[16:19]
    v_mfma_f32_16x16x32_bf16 v[20:23], v[94:97], v[144:147], v[20:23]
    s_waitcnt lgkmcnt(2)
    v_mfma_f32_16x16x32_bf16 v[24:27], a[0:3], v[40:43], v[100:103]
    ds_read_b128 v[56:59], v3 offset:4096
    v_cvt_pk_bf16_f32 v72, v8, v9
    v_mfma_f32_16x16x32_bf16 v[24:27], a[16:19], v[44:47], v[24:27]
    buffer_load_dwordx4 v[160:163], v1, s[4:7], s37 offen offset:1024 sc1
    v_mfma_f32_16x16x32_bf16 v[28:31], a[20:23], v[44:47], v[104:107]
    s_add_u32 s37, s40, 65536
    v_cvt_pk_bf16_f32 v73, v10, v11
    v_mfma_f32_16x16x32_bf16 v[28:31], a[4:7], v[40:43], v[28:31]
    ds_write_b64 v204, v[72:73]
    v_mfma_f32_16x16x32_bf16 v[32:35], a[8:11], v[40:43], v[108:111]
    ds_read_b128 v[60:63], v3 offset:5120
    v_cvt_pk_bf16_f32 v74, v12, v13
    v_mfma_f32_16x16x32_bf16 v[32:35], a[24:27], v[44:47], v[32:35]
    buffer_load_dwordx4 v[164:167], v1, s[4:7], s37 offen offset:0 sc1
    v_mfma_f32_16x16x32_bf16 v[36:39], a[28:31], v[44:47], v[112:115]
    v_cvt_pk_bf16_f32 v75, v14, v15
    v_mfma_f32_16x16x32_bf16 v[36:39], a[12:15], v[40:43], v[36:39]
    s_waitcnt lgkmcnt(3)
    ds_write_b64 v205, v[74:75]
    v_mfma_f32_16x16x32_bf16 v[36:39], a[44:47], v[48:51], v[36:39]
    ds_read_b128 v[64:67], v3 offset:6144
    v_cvt_pk_bf16_f32 v76, v16, v17
    v_mfma_f32_16x16x32_bf16 v[36:39], a[60:63], v[52:55], v[36:39]
    buffer_load_dwordx4 v[168:171], v1, s[4:7], s37 offen offset:1024 sc1
    v_mfma_f32_16x16x32_bf16 v[32:35], a[56:59], v[52:55], v[32:35]
    s_add_u32 s37, s40, 98304
    v_cvt_pk_bf16_f32 v77, v18, v19
    v_mfma_f32_16x16x32_bf16 v[32:35], a[40:43], v[48:51], v[32:35]
    ds_write_b64 v206, v[76:77]
    v_mfma_f32_16x16x32_bf16 v[28:31], a[36:39], v[48:51], v[28:31]
    ds_read_b128 v[68:71], v3 offset:7168
    v_cvt_pk_bf16_f32 v78, v20, v21
    v_mfma_f32_16x16x32_bf16 v[28:31], a[52:55], v[52:55], v[28:31]
    buffer_load_dwordx4 v[172:175], v1, s[4:7], s37 offen offset:0 sc1
    v_mfma_f32_16x16x32_bf16 v[24:27], a[48:51], v[52:55], v[24:27]
    v_cvt_pk_bf16_f32 v79, v22, v23
    v_mfma_f32_16x16x32_bf16 v[24:27], a[32:35], v[48:51], v[24:27]
    s_waitcnt lgkmcnt(4)
    ds_write_b64 v207, v[78:79]
    v_mfma_f32_16x16x32_bf16 v[24:27], a[64:67], v[56:59], v[24:27]
    ds_read_b128 v[40:43], v3 offset:8192
    v_mfma_f32_16x16x32_bf16 v[24:27], a[80:83], v[60:63], v[24:27]
    buffer_load_dwordx4 v[176:179], v1, s[4:7], s37 offen offset:1024 sc1
    v_mfma_f32_16x16x32_bf16 v[28:31], a[84:87], v[60:63], v[28:31]
    s_add_u32 m0, s34, 0
    ds_read_b128 v[196:199], v222 offset:0
    v_mfma_f32_16x16x32_bf16 v[28:31], a[68:71], v[56:59], v[28:31]
    ds_read_b128 v[200:203], v222 offset:1024
    v_mfma_f32_16x16x32_bf16 v[86:89], v[72:75], v[72:75], 0
    v_mfma_f32_16x16x32_bf16 v[82:85], v[90:93], v[72:75], 0
    buffer_load_dword v5, v4, s[4:7], s16 offen sc1
    v_mfma_f32_16x16x32_bf16 v[86:89], v[76:79], v[76:79], v[86:89]
    v_mfma_f32_16x16x32_bf16 v[82:85], v[90:93], v[76:79], v[82:85]
    s_waitcnt lgkmcnt(1)
    v_mfma_f32_16x16x32_bf16 v[32:35], a[72:75], v[56:59], v[32:35]
    ds_read_b128 v[44:47], v3 offset:9216
    v_mfma_f32_16x16x32_bf16 v[32:35], a[88:91], v[60:63], v[32:35]
    buffer_store_dwordx4 v[196:199], v208, s[24:27], s54 offen sc1
    s_waitcnt lgkmcnt(1)
    v_mfma_f32_16x16x32_bf16 v[36:39], a[92:95], v[60:63], v[36:39]
    v_mfma_f32_16x16x32_bf16 v[36:39], a[76:79], v[56:59], v[36:39]
    v_mfma_f32_16x16x32_bf16 v[36:39], a[108:111], v[64:67], v[36:39]
    ds_read_b128 v[48:51], v3 offset:10240
    v_mfma_f32_16x16x32_bf16 v[36:39], a[124:127], v[68:71], v[36:39]
    buffer_store_dwordx4 v[200:203], v209, s[24:27], s54 offen sc1
    v_cndmask_b32 v86, v86, v87, s[44:45]
    v_mfma_f32_16x16x32_bf16 v[32:35], a[120:123], v[68:71], v[32:35]
    v_cndmask_b32 v88, v88, v89, s[44:45]
    v_cndmask_b32 v83, v86, v88, s[46:47]
    v_mfma_f32_16x16x32_bf16 v[32:35], a[104:107], v[64:67], v[32:35]
    buffer_store_dwordx2 v[82:83], v7, s[12:15], s36 offen offset:0 sc1
    s_mov_b32 s22, s14
    v_mfma_f32_16x16x32_bf16 v[28:31], a[100:103], v[64:67], v[28:31]
    ds_read_b128 v[52:55], v3 offset:11264
    s_add_u32 s36, s36, 34816
    v_mfma_f32_16x16x32_bf16 v[28:31], a[116:119], v[68:71], v[28:31]
    buffer_load_dwordx4 v1, s[8:11], s33 offen offset:0 sc1 lds
    v_mfma_f32_16x16x32_bf16 v[24:27], a[112:115], v[68:71], v[24:27]
    s_sub_u32 s42, s42, 32768
    v_mfma_f32_16x16x32_bf16 v[24:27], a[96:99], v[64:67], v[24:27]
    s_waitcnt lgkmcnt(2)
    v_mfma_f32_16x16x32_bf16 v[24:27], a[128:131], v[40:43], v[24:27]
    ds_read_b128 v[56:59], v3 offset:12288
    v_mfma_f32_16x16x32_bf16 v[24:27], a[144:147], v[44:47], v[24:27]
    buffer_load_dwordx4 v1, s[8:11], s33 offen offset:1024 sc1 lds
    v_mfma_f32_16x16x32_bf16 v[28:31], a[148:151], v[44:47], v[28:31]
    s_cmp_lt_i32 s31, 31
    s_cselect_b32 s14, s6, 0
    s_cselect_b32 s54, s36, s42
    v_mfma_f32_16x16x32_bf16 v[28:31], a[132:135], v[40:43], v[28:31]
    s_cmp_lt_i32 s31, 31
    s_cselect_b64 s[24:25], s[4:5], s[80:81]
    s_cselect_b32 s26, s6, 0x400000
    v_mfma_f32_16x16x32_bf16 v[32:35], a[136:139], v[40:43], v[32:35]
    ds_read_b128 v[60:63], v3 offset:13312
    v_mfma_f32_16x16x32_bf16 v[32:35], a[152:155], v[44:47], v[32:35]
    buffer_load_dwordx4 v1, s[8:11], s33 offen offset:2048 sc1 lds
    v_mfma_f32_16x16x32_bf16 v[36:39], a[156:159], v[44:47], v[36:39]
    s_cmp_lt_i32 s31, 31
    s_cselect_b64 s[48:49], 0, -1
    v_cndmask_b32 v204, v210, v216, s[48:49]
    v_mfma_f32_16x16x32_bf16 v[36:39], a[140:143], v[40:43], v[36:39]
    s_waitcnt lgkmcnt(2)
    v_cndmask_b32 v205, v211, v217, s[48:49]
    v_cndmask_b32 v206, v212, v218, s[48:49]
    v_mfma_f32_16x16x32_bf16 v[36:39], a[172:175], v[48:51], v[36:39]
    ds_read_b128 v[64:67], v3 offset:14336
    v_cndmask_b32 v207, v213, v219, s[48:49]
    v_mfma_f32_16x16x32_bf16 v[36:39], a[188:191], v[52:55], v[36:39]
    buffer_load_dwordx4 v1, s[8:11], s33 offen offset:3072 sc1 lds
    v_mfma_f32_16x16x32_bf16 v[32:35], a[184:187], v[52:55], v[32:35]
    s_add_u32 s32, s32, 1
    s_add_u32 s40, s40, 131072
    s_add_u32 s33, s33, 116736
    v_mfma_f32_16x16x32_bf16 v[32:35], a[168:171], v[48:51], v[32:35]
    s_add_u32 s34, s34, 36864
    s_cmp_ge_u32 s34, 147456
    s_cselect_b32 s38, 147456, 0
    v_mfma_f32_16x16x32_bf16 v[28:31], a[164:167], v[48:51], v[28:31]
    ds_read_b128 v[68:71], v3 offset:15360
    s_sub_u32 s34, s34, s38
    v_mfma_f32_16x16x32_bf16 v[28:31], a[180:183], v[52:55], v[28:31]
    s_cmp_ge_i32 s32, 63
    s_cselect_b32 s18, 0xffff, s18
    v_cndmask_b32 v208, v214, v220, s[48:49]
    v_mfma_f32_16x16x32_bf16 v[24:27], a[176:179], v[52:55], v[24:27]
    buffer_load_dwordx4 v[180:183], v1, s[4:7], s41 offen offset:0 sc1
    v_mfma_f32_16x16x32_bf16 v[24:27], a[160:163], v[48:51], v[24:27]
    s_waitcnt lgkmcnt(2)
    v_cndmask_b32 v209, v215, v221, s[48:49]
    s_add_u32 s35, s35, 36864
    v_mfma_f32_16x16x32_bf16 v[24:27], a[192:195], v[56:59], v[24:27]
    s_cmp_eq_u32 s35, 147456
    s_cselect_b32 s35, 0, s35
    v_mfma_f32_16x16x32_bf16 v[24:27], a[208:211], v[60:63], v[24:27]
    v_mfma_f32_16x16x32_bf16 v[28:31], a[212:215], v[60:63], v[28:31]
    buffer_load_dwordx4 v[184:187], v1, s[4:7], s41 offen offset:1024 sc1
    v_mfma_f32_16x16x32_bf16 v[28:31], a[196:199], v[56:59], v[28:31]
    s_add_u32 s41, s41, 36864
    v_mfma_f32_16x16x32_bf16 v[32:35], a[200:203], v[56:59], v[32:35]
    v_mfma_f32_16x16x32_bf16 v[32:35], a[216:219], v[60:63], v[32:35]
    v_mfma_f32_16x16x32_bf16 v[36:39], a[220:223], v[60:63], v[36:39]
    v_mfma_f32_16x16x32_bf16 v[36:39], a[204:207], v[56:59], v[36:39]
    s_waitcnt lgkmcnt(0)
    v_mfma_f32_16x16x32_bf16 v[36:39], a[236:239], v[64:67], v[36:39]
    v_mfma_f32_16x16x32_bf16 v[36:39], a[252:255], v[68:71], v[36:39]
    v_mfma_f32_16x16x32_bf16 v[32:35], a[248:251], v[68:71], v[32:35]
    v_mfma_f32_16x16x32_bf16 v[32:35], a[232:235], v[64:67], v[32:35]
    v_mfma_f32_16x16x32_bf16 v[28:31], a[228:231], v[64:67], v[28:31]
    v_mfma_f32_16x16x32_bf16 v[28:31], a[244:247], v[68:71], v[28:31]
    v_mfma_f32_16x16x32_bf16 v[24:27], a[240:243], v[68:71], v[24:27]
    v_mfma_f32_16x16x32_bf16 v[24:27], a[224:227], v[64:67], v[24:27]
    s_waitcnt vmcnt(19)
    v_mfma_f32_16x16x32_bf16 v[24:27], v[96:99], v[188:191], v[24:27]
    v_mfma_f32_16x16x32_bf16 v[28:31], v[94:97], v[188:191], v[28:31]
    v_mfma_f32_16x16x32_bf16 v[32:35], v[96:99], v[192:195], v[32:35]
    v_mfma_f32_16x16x32_bf16 v[36:39], v[94:97], v[192:195], v[36:39]
    s_cmp_lt_i32 s31, 63
    s_cbranch_scc1 Lred_run1
    s_branch L_exit
Lred_v01:
    s_nop 1
    s_waitcnt vmcnt(8)
    v_mfma_f32_16x16x32_bf16 v[8:11], v[96:99], v[124:127], v[8:11]
    buffer_load_dword v5, v4, s[4:7], s16 offen sc1
    v_mfma_f32_16x16x32_bf16 v[12:15], v[94:97], v[124:127], v[12:15]
    s_add_u32 s31, s31, 1
    v_mov_b32 v6, s31
    v_mfma_f32_16x16x32_bf16 v[16:19], v[96:99], v[128:131], v[16:19]
    ds_read_b128 v[40:43], v3 offset:0
    v_mfma_f32_16x16x32_bf16 v[20:23], v[94:97], v[128:131], v[20:23]
    s_waitcnt vmcnt(7)
    v_mfma_f32_16x16x32_bf16 v[20:23], v[94:97], v[136:139], v[20:23]
    ds_read_b128 v[44:47], v3 offset:1024
    v_mfma_f32_16x16x32_bf16 v[16:19], v[96:99], v[136:139], v[16:19]
    buffer_store_dword v6, v80, s[20:23], s17 offen sc1
    s_add_u32 s17, s17, 8192
    v_mfma_f32_16x16x32_bf16 v[12:15], v[94:97], v[132:135], v[12:15]
    ds_read_b128 v[48:51], v3 offset:2048
    v_mfma_f32_16x16x32_bf16 v[8:11], v[96:99], v[132:135], v[8:11]
    s_waitcnt vmcnt(6)
    v_mfma_f32_16x16x32_bf16 v[8:11], v[96:99], v[140:143], v[8:11]
    ds_read_b128 v[52:55], v3 offset:3072
    v_mfma_f32_16x16x32_bf16 v[12:15], v[94:97], v[140:143], v[12:15]
    v_mfma_f32_16x16x32_bf16 v[16:19], v[96:99], v[144:147], v[16:19]
    v_mfma_f32_16x16x32_bf16 v[20:23], v[94:97], v[144:147], v[20:23]
    s_waitcnt lgkmcnt(2)
    v_mfma_f32_16x16x32_bf16 v[24:27], a[0:3], v[40:43], v[100:103]
    ds_read_b128 v[56:59], v3 offset:4096
    v_mfma_f32_16x16x32_bf16 v[24:27], a[16:19], v[44:47], v[24:27]
    v_cvt_pk_bf16_f32 v72, v8, v9
    v_cvt_pk_bf16_f32 v73, v10, v11
    v_mfma_f32_16x16x32_bf16 v[28:31], a[20:23], v[44:47], v[104:107]
    ds_write_b64 v204, v[72:73]
    v_mfma_f32_16x16x32_bf16 v[28:31], a[4:7], v[40:43], v[28:31]
    v_cvt_pk_bf16_f32 v74, v12, v13
    v_cvt_pk_bf16_f32 v75, v14, v15
    v_mfma_f32_16x16x32_bf16 v[32:35], a[8:11], v[40:43], v[108:111]
    ds_read_b128 v[60:63], v3 offset:5120
    v_mfma_f32_16x16x32_bf16 v[32:35], a[24:27], v[44:47], v[32:35]
    ds_write_b64 v205, v[74:75]
    v_mfma_f32_16x16x32_bf16 v[36:39], a[28:31], v[44:47], v[112:115]
    s_waitcnt vmcnt(1)
    v_cmp_gt_i32 vcc, s32, v5
    v_cvt_pk_bf16_f32 v76, v16, v17
    v_mfma_f32_16x16x32_bf16 v[36:39], a[12:15], v[40:43], v[36:39]
    s_waitcnt lgkmcnt(4)
    v_cvt_pk_bf16_f32 v77, v18, v19
    v_mfma_f32_16x16x32_bf16 v[36:39], a[44:47], v[48:51], v[36:39]
    ds_read_b128 v[64:67], v3 offset:6144
    v_mfma_f32_16x16x32_bf16 v[36:39], a[60:63], v[52:55], v[36:39]
    s_and_b64 vcc, vcc, s[18:19]
    s_cbranch_scc1 Lred_v02
    v_mfma_f32_16x16x32_bf16 v[32:35], a[56:59], v[52:55], v[32:35]
    s_add_u32 s16, s16, 8192
    v_mfma_f32_16x16x32_bf16 v[32:35], a[40:43], v[48:51], v[32:35]
    buffer_load_dwordx4 v[148:151], v1, s[4:7], s40 offen offset:0 sc1
    v_mfma_f32_16x16x32_bf16 v[28:31], a[36:39], v[48:51], v[28:31]
    ds_read_b128 v[68:71], v3 offset:7168
    v_mfma_f32_16x16x32_bf16 v[28:31], a[52:55], v[52:55], v[28:31]
    ds_write_b64 v206, v[76:77]
    v_mfma_f32_16x16x32_bf16 v[24:27], a[48:51], v[52:55], v[24:27]
    v_cvt_pk_bf16_f32 v78, v20, v21
    v_cvt_pk_bf16_f32 v79, v22, v23
    v_mfma_f32_16x16x32_bf16 v[24:27], a[32:35], v[48:51], v[24:27]
    s_waitcnt lgkmcnt(4)
    buffer_load_dwordx4 v[152:155], v1, s[4:7], s40 offen offset:1024 sc1
    v_mfma_f32_16x16x32_bf16 v[24:27], a[64:67], v[56:59], v[24:27]
    ds_read_b128 v[40:43], v3 offset:8192
    s_add_u32 s37, s40, 32768
    v_mfma_f32_16x16x32_bf16 v[24:27], a[80:83], v[60:63], v[24:27]
    ds_write_b64 v207, v[78:79]
    v_mfma_f32_16x16x32_bf16 v[28:31], a[84:87], v[60:63], v[28:31]
    ds_read_b128 v[196:199], v222 offset:0
    v_mfma_f32_16x16x32_bf16 v[28:31], a[68:71], v[56:59], v[28:31]
    buffer_load_dword v5, v4, s[4:7], s16 offen sc1
    v_mfma_f32_16x16x32_bf16 v[32:35], a[72:75], v[56:59], v[32:35]
    ds_read_b128 v[44:47], v3 offset:9216
    v_mfma_f32_16x16x32_bf16 v[32:35], a[88:91], v[60:63], v[32:35]
    ds_read_b128 v[200:203], v222 offset:1024
    v_mfma_f32_16x16x32_bf16 v[86:89], v[72:75], v[72:75], 0
    v_mfma_f32_16x16x32_bf16 v[82:85], v[90:93], v[72:75], 0
    buffer_load_dwordx4 v[156:159], v1, s[4:7], s37 offen offset:0 sc1
    v_mfma_f32_16x16x32_bf16 v[86:89], v[76:79], v[76:79], v[86:89]
    v_mfma_f32_16x16x32_bf16 v[82:85], v[90:93], v[76:79], v[82:85]
    s_waitcnt lgkmcnt(2)
    v_mfma_f32_16x16x32_bf16 v[36:39], a[92:95], v[60:63], v[36:39]
    v_mfma_f32_16x16x32_bf16 v[36:39], a[76:79], v[56:59], v[36:39]
    buffer_store_dwordx4 v[196:199], v208, s[24:27], s54 offen sc1
    s_waitcnt lgkmcnt(0)
    v_mfma_f32_16x16x32_bf16 v[36:39], a[108:111], v[64:67], v[36:39]
    ds_read_b128 v[48:51], v3 offset:10240
    v_mfma_f32_16x16x32_bf16 v[36:39], a[124:127], v[68:71], v[36:39]
    v_mfma_f32_16x16x32_bf16 v[32:35], a[120:123], v[68:71], v[32:35]
    v_mfma_f32_16x16x32_bf16 v[32:35], a[104:107], v[64:67], v[32:35]
    buffer_store_dwordx4 v[200:203], v209, s[24:27], s54 offen sc1
    v_cndmask_b32 v86, v86, v87, s[44:45]
    v_mfma_f32_16x16x32_bf16 v[28:31], a[100:103], v[64:67], v[28:31]
    ds_read_b128 v[52:55], v3 offset:11264
    v_cndmask_b32 v88, v88, v89, s[44:45]
    v_mfma_f32_16x16x32_bf16 v[28:31], a[116:119], v[68:71], v[28:31]
    v_cndmask_b32 v83, v86, v88, s[46:47]
    v_mfma_f32_16x16x32_bf16 v[24:27], a[112:115], v[68:71], v[24:27]
    buffer_store_dwordx2 v[82:83], v7, s[12:15], s36 offen offset:0 sc1
    s_mov_b32 s22, s14
    v_mfma_f32_16x16x32_bf16 v[24:27], a[96:99], v[64:67], v[24:27]
    buffer_load_dwordx4 v[160:163], v1, s[4:7], s37 offen offset:1024 sc1
    v_mfma_f32_16x16x32_bf16 v[24:27], a[128:131], v[40:43], v[24:27]
    ds_read_b128 v[56:59], v3 offset:12288
    s_add_u32 s37, s40, 65536
    v_mfma_f32_16x16x32_bf16 v[24:27], a[144:147], v[44:47], v[24:27]
    s_add_u32 s36, s36, 34816
    s_sub_u32 s42, s42, 32768
    v_mfma_f32_16x16x32_bf16 v[28:31], a[148:151], v[44:47], v[28:31]
    s_cmp_lt_i32 s31, 31
    s_cselect_b32 s14, s6, 0
    s_cselect_b32 s54, s36, s42
    v_mfma_f32_16x16x32_bf16 v[28:31], a[132:135], v[40:43], v[28:31]
    buffer_load_dwordx4 v[164:167], v1, s[4:7], s37 offen offset:0 sc1
    v_mfma_f32_16x16x32_bf16 v[32:35], a[136:139], v[40:43], v[32:35]
    ds_read_b128 v[60:63], v3 offset:13312
    v_mfma_f32_16x16x32_bf16 v[32:35], a[152:155], v[44:47], v[32:35]
    s_cmp_lt_i32 s31, 31
    s_cselect_b64 s[24:25], s[4:5], s[80:81]
    s_cselect_b32 s26, s6, 0x400000
    v_mfma_f32_16x16x32_bf16 v[36:39], a[156:159], v[44:47], v[36:39]
    s_cmp_lt_i32 s31, 31
    s_cselect_b64 s[48:49], 0, -1
    v_cndmask_b32 v204, v210, v216, s[48:49]
    v_mfma_f32_16x16x32_bf16 v[36:39], a[140:143], v[40:43], v[36:39]
    s_waitcnt lgkmcnt(2)
    buffer_load_dwordx4 v[168:171], v1, s[4:7], s37 offen offset:1024 sc1
    v_mfma_f32_16x16x32_bf16 v[36:39], a[172:175], v[48:51], v[36:39]
    ds_read_b128 v[64:67], v3 offset:14336
    s_add_u32 s37, s40, 98304
    v_mfma_f32_16x16x32_bf16 v[36:39], a[188:191], v[52:55], v[36:39]
    v_cndmask_b32 v205, v211, v217, s[48:49]
    v_cndmask_b32 v206, v212, v218, s[48:49]
    v_mfma_f32_16x16x32_bf16 v[32:35], a[184:187], v[52:55], v[32:35]
    v_cndmask_b32 v207, v213, v219, s[48:49]
    v_cndmask_b32 v208, v214, v220, s[48:49]
    v_mfma_f32_16x16x32_bf16 v[32:35], a[168:171], v[48:51], v[32:35]
    buffer_load_dwordx4 v[172:175], v1, s[4:7], s37 offen offset:0 sc1
    v_mfma_f32_16x16x32_bf16 v[28:31], a[164:167], v[48:51], v[28:31]
    ds_read_b128 v[68:71], v3 offset:15360
    v_cndmask_b32 v209, v215, v221, s[48:49]
    v_mfma_f32_16x16x32_bf16 v[28:31], a[180:183], v[52:55], v[28:31]
    s_add_u32 s35, s35, 36864
    s_cmp_eq_u32 s35, 147456
    s_cselect_b32 s35, 0, s35
    v_mfma_f32_16x16x32_bf16 v[24:27], a[176:179], v[52:55], v[24:27]
    v_mfma_f32_16x16x32_bf16 v[24:27], a[160:163], v[48:51], v[24:27]
    s_waitcnt lgkmcnt(2)
    buffer_load_dwordx4 v[176:179], v1, s[4:7], s37 offen offset:1024 sc1
    v_mfma_f32_16x16x32_bf16 v[24:27], a[192:195], v[56:59], v[24:27]
    s_add_u32 m0, s34, 0
    v_mfma_f32_16x16x32_bf16 v[24:27], a[208:211], v[60:63], v[24:27]
    v_mfma_f32_16x16x32_bf16 v[28:31], a[212:215], v[60:63], v[28:31]
    v_mfma_f32_16x16x32_bf16 v[28:31], a[196:199], v[56:59], v[28:31]
    buffer_load_dwordx4 v1, s[8:11], s33 offen offset:0 sc1 lds
    v_mfma_f32_16x16x32_bf16 v[32:35], a[200:203], v[56:59], v[32:35]
    v_mfma_f32_16x16x32_bf16 v[32:35], a[216:219], v[60:63], v[32:35]
    v_mfma_f32_16x16x32_bf16 v[36:39], a[220:223], v[60:63], v[36:39]
    v_mfma_f32_16x16x32_bf16 v[36:39], a[204:207], v[56:59], v[36:39]
    s_waitcnt lgkmcnt(0)
    buffer_load_dwordx4 v1, s[8:11], s33 offen offset:1024 sc1 lds
    v_mfma_f32_16x16x32_bf16 v[36:39], a[236:239], v[64:67], v[36:39]
    v_mfma_f32_16x16x32_bf16 v[36:39], a[252:255], v[68:71], v[36:39]
    v_mfma_f32_16x16x32_bf16 v[32:35], a[248:251], v[68:71], v[32:35]
    v_mfma_f32_16x16x32_bf16 v[32:35], a[232:235], v[64:67], v[32:35]
    buffer_load_dwordx4 v1, s[8:11], s33 offen offset:2048 sc1 lds
    v_mfma_f32_16x16x32_bf16 v[28:31], a[228:231], v[64:67], v[28:31]
    v_mfma_f32_16x16x32_bf16 v[28:31], a[244:247], v[68:71], v[28:31]
    v_mfma_f32_16x16x32_bf16 v[24:27], a[240:243], v[68:71], v[24:27]
    v_mfma_f32_16x16x32_bf16 v[24:27], a[224:227], v[64:67], v[24:27]
    buffer_load_dwordx4 v1, s[8:11], s33 offen offset:3072 sc1 lds
    v_mfma_f32_16x16x32_bf16 v[24:27], v[96:99], v[188:191], v[24:27]
    s_add_u32 s32, s32, 1
    s_add_u32 s40, s40, 131072
    s_add_u32 s33, s33, 116736
    v_mfma_f32_16x16x32_bf16 v[28:31], v[94:97], v[188:191], v[28:31]
    s_add_u32 s34, s34, 36864
    s_cmp_ge_u32 s34, 147456
    s_cselect_b32 s38, 147456, 0
    v_mfma_f32_16x16x32_bf16 v[32:35], v[96:99], v[192:195], v[32:35]
    s_sub_u32 s34, s34, s38
    s_cmp_ge_i32 s32, 63
    s_cselect_b32 s18, 0xffff, s18
    v_mfma_f32_16x16x32_bf16 v[36:39], v[94:97], v[192:195], v[36:39]
    buffer_load_dwordx4 v[180:183], v1, s[4:7], s41 offen offset:0 sc1
    buffer_load_dwordx4 v[184:187], v1, s[4:7], s41 offen offset:1024 sc1
    s_add_u32 s41, s41, 36864
    s_cmp_lt_i32 s31, 63
    s_cbranch_scc1 Lred_top1
    s_branch L_exit
Lred_v02:
    v_mfma_f32_16x16x32_bf16 v[32:35], a[56:59], v[52:55], v[32:35]
    buffer_load_dword v5, v4, s[4:7], s16 offen sc1
    v_mfma_f32_16x16x32_bf16 v[32:35], a[40:43], v[48:51], v[32:35]
    ds_write_b64 v206, v[76:77]
    v_mfma_f32_16x16x32_bf16 v[28:31], a[36:39], v[48:51], v[28:31]
    ds_read_b128 v[68:71], v3 offset:7168
    v_cvt_pk_bf16_f32 v78, v20, v21
    v_mfma_f32_16x16x32_bf16 v[28:31], a[52:55], v[52:55], v[28:31]
    v_cvt_pk_bf16_f32 v79, v22, v23
    v_mfma_f32_16x16x32_bf16 v[24:27], a[48:51], v[52:55], v[24:27]
    ds_write_b64 v207, v[78:79]
    v_mfma_f32_16x16x32_bf16 v[24:27], a[32:35], v[48:51], v[24:27]
    s_waitcnt lgkmcnt(5)
    ds_read_b128 v[196:199], v222 offset:0
    v_mfma_f32_16x16x32_bf16 v[24:27], a[64:67], v[56:59], v[24:27]
    ds_read_b128 v[40:43], v3 offset:8192
    v_mfma_f32_16x16x32_bf16 v[24:27], a[80:83], v[60:63], v[24:27]
    ds_read_b128 v[200:203], v222 offset:1024
    v_mfma_f32_16x16x32_bf16 v[86:89], v[72:75], v[72:75], 0
    buffer_load_dwordx4 v[180:183], v1, s[4:7], s41 offen offset:0 sc1
    v_mfma_f32_16x16x32_bf16 v[82:85], v[90:93], v[72:75], 0
    v_mfma_f32_16x16x32_bf16 v[86:89], v[76:79], v[76:79], v[86:89]
    v_mfma_f32_16x16x32_bf16 v[82:85], v[90:93], v[76:79], v[82:85]
    s_waitcnt lgkmcnt(2)
    v_mfma_f32_16x16x32_bf16 v[28:31], a[84:87], v[60:63], v[28:31]
    buffer_store_dwordx4 v[196:199], v208, s[24:27], s54 offen sc1
    s_waitcnt lgkmcnt(0)
    v_mfma_f32_16x16x32_bf16 v[28:31], a[68:71], v[56:59], v[28:31]
    v_mfma_f32_16x16x32_bf16 v[32:35], a[72:75], v[56:59], v[32:35]
    ds_read_b128 v[44:47], v3 offset:9216
    v_mfma_f32_16x16x32_bf16 v[32:35], a[88:91], v[60:63], v[32:35]
    v_mfma_f32_16x16x32_bf16 v[36:39], a[92:95], v[60:63], v[36:39]
    buffer_store_dwordx4 v[200:203], v209, s[24:27], s54 offen sc1
    v_cndmask_b32 v86, v86, v87, s[44:45]
    v_mfma_f32_16x16x32_bf16 v[36:39], a[76:79], v[56:59], v[36:39]
    v_cndmask_b32 v88, v88, v89, s[44:45]
    v_cndmask_b32 v83, v86, v88, s[46:47]
    v_mfma_f32_16x16x32_bf16 v[36:39], a[108:111], v[64:67], v[36:39]
    ds_read_b128 v[48:51], v3 offset:10240
    s_waitcnt vmcnt(3)
    v_mfma_f32_16x16x32_bf16 v[36:39], a[124:127], v[68:71], v[36:39]
    buffer_store_dwordx2 v[82:83], v7, s[12:15], s36 offen offset:0 sc1
    v_cmp_gt_i32 vcc, s32, v5
    v_mfma_f32_16x16x32_bf16 v[32:35], a[120:123], v[68:71], v[32:35]
    s_mov_b32 s22, s14
    s_add_u32 s36, s36, 34816
    s_sub_u32 s42, s42, 32768
    v_mfma_f32_16x16x32_bf16 v[32:35], a[104:107], v[64:67], v[32:35]
    s_and_b64 vcc, vcc, s[18:19]
    s_cbranch_scc1 Lred_v03
    v_mfma_f32_16x16x32_bf16 v[28:31], a[100:103], v[64:67], v[28:31]
    ds_read_b128 v[52:55], v3 offset:11264
    s_add_u32 s16, s16, 8192
    v_mfma_f32_16x16x32_bf16 v[28:31], a[116:119], v[68:71], v[28:31]
    buffer_load_dword v5, v4, s[4:7], s16 offen sc1
    v_mfma_f32_16x16x32_bf16 v[24:27], a[112:115], v[68:71], v[24:27]
    s_cmp_lt_i32 s31, 31
    s_cselect_b32 s14, s6, 0
    s_cselect_b32 s54, s36, s42
    v_mfma_f32_16x16x32_bf16 v[24:27], a[96:99], v[64:67], v[24:27]
    s_waitcnt lgkmcnt(2)
    v_mfma_f32_16x16x32_bf16 v[24:27], a[128:131], v[40:43], v[24:27]
    ds_read_b128 v[56:59], v3 offset:12288
    v_mfma_f32_16x16x32_bf16 v[24:27], a[144:147], v[44:47], v[24:27]
    buffer_load_dwordx4 v[148:151], v1, s[4:7], s40 offen offset:0 sc1
    v_mfma_f32_16x16x32_bf16 v[28:31], a[148:151], v[44:47], v[28:31]
    s_cmp_lt_i32 s31, 31
    s_cselect_b64 s[24:25], s[4:5], s[80:81]
    s_cselect_b32 s26, s6, 0x400000
    v_mfma_f32_16x16x32_bf16 v[28:31], a[132:135], v[40:43], v[28:31]
    s_cmp_lt_i32 s31, 31
    s_cselect_b64 s[48:49], 0, -1
    v_cndmask_b32 v204, v210, v216, s[48:49]
    v_mfma_f32_16x16x32_bf16 v[32:35], a[136:139], v[40:43], v[32:35]
    ds_read_b128 v[60:63], v3 offset:13312
    v_cndmask_b32 v205, v211, v217, s[48:49]
    v_mfma_f32_16x16x32_bf16 v[32:35], a[152:155], v[44:47], v[32:35]
    buffer_load_dwordx4 v[152:155], v1, s[4:7], s40 offen offset:1024 sc1
    v_mfma_f32_16x16x32_bf16 v[36:39], a[156:159], v[44:47], v[36:39]
    s_add_u32 s37, s40, 32768
    v_cndmask_b32 v206, v212, v218, s[48:49]
    v_cndmask_b32 v207, v213, v219, s[48:49]
    v_mfma_f32_16x16x32_bf16 v[36:39], a[140:143], v[40:43], v[36:39]
    s_waitcnt lgkmcnt(2)
    v_cndmask_b32 v208, v214, v220, s[48:49]
    v_cndmask_b32 v209, v215, v221, s[48:49]
    v_mfma_f32_16x16x32_bf16 v[36:39], a[172:175], v[48:51], v[36:39]
    ds_read_b128 v[64:67], v3 offset:14336
    s_add_u32 s35, s35, 36864
    v_mfma_f32_16x16x32_bf16 v[36:39], a[188:191], v[52:55], v[36:39]
    buffer_load_dwordx4 v[156:159], v1, s[4:7], s37 offen offset:0 sc1
    v_mfma_f32_16x16x32_bf16 v[32:35], a[184:187], v[52:55], v[32:35]
    s_cmp_eq_u32 s35, 147456
    s_cselect_b32 s35, 0, s35
    v_mfma_f32_16x16x32_bf16 v[32:35], a[168:171], v[48:51], v[32:35]
    v_mfma_f32_16x16x32_bf16 v[28:31], a[164:167], v[48:51], v[28:31]
    ds_read_b128 v[68:71], v3 offset:15360
    v_mfma_f32_16x16x32_bf16 v[28:31], a[180:183], v[52:55], v[28:31]
    buffer_load_dwordx4 v[160:163], v1, s[4:7], s37 offen offset:1024 sc1
    v_mfma_f32_16x16x32_bf16 v[24:27], a[176:179], v[52:55], v[24:27]
    s_add_u32 s37, s40, 65536
    v_mfma_f32_16x16x32_bf16 v[24:27], a[160:163], v[48:51], v[24:27]
    s_waitcnt lgkmcnt(2)
    v_mfma_f32_16x16x32_bf16 v[24:27], a[192:195], v[56:59], v[24:27]
    v_mfma_f32_16x16x32_bf16 v[24:27], a[208:211], v[60:63], v[24:27]
    buffer_load_dwordx4 v[164:167], v1, s[4:7], s37 offen offset:0 sc1
    v_mfma_f32_16x16x32_bf16 v[28:31], a[212:215], v[60:63], v[28:31]
    v_mfma_f32_16x16x32_bf16 v[28:31], a[196:199], v[56:59], v[28:31]
    v_mfma_f32_16x16x32_bf16 v[32:35], a[200:203], v[56:59], v[32:35]
    v_mfma_f32_16x16x32_bf16 v[32:35], a[216:219], v[60:63], v[32:35]
    buffer_load_dwordx4 v[168:171], v1, s[4:7], s37 offen offset:1024 sc1
    v_mfma_f32_16x16x32_bf16 v[36:39], a[220:223], v[60:63], v[36:39]
    s_add_u32 s37, s40, 98304
    v_mfma_f32_16x16x32_bf16 v[36:39], a[204:207], v[56:59], v[36:39]
    s_waitcnt lgkmcnt(0)
    v_mfma_f32_16x16x32_bf16 v[36:39], a[236:239], v[64:67], v[36:39]
    v_mfma_f32_16x16x32_bf16 v[36:39], a[252:255], v[68:71], v[36:39]
    buffer_load_dwordx4 v[172:175], v1, s[4:7], s37 offen offset:0 sc1
    v_mfma_f32_16x16x32_bf16 v[32:35], a[248:251], v[68:71], v[32:35]
    v_mfma_f32_16x16x32_bf16 v[32:35], a[232:235], v[64:67], v[32:35]
    v_mfma_f32_16x16x32_bf16 v[28:31], a[228:231], v[64:67], v[28:31]
    v_mfma_f32_16x16x32_bf16 v[28:31], a[244:247], v[68:71], v[28:31]
    buffer_load_dwordx4 v[176:179], v1, s[4:7], s37 offen offset:1024 sc1
    v_mfma_f32_16x16x32_bf16 v[24:27], a[240:243], v[68:71], v[24:27]
    s_add_u32 m0, s34, 0
    v_mfma_f32_16x16x32_bf16 v[24:27], a[224:227], v[64:67], v[24:27]
    v_mfma_f32_16x16x32_bf16 v[24:27], v[96:99], v[188:191], v[24:27]
    v_mfma_f32_16x16x32_bf16 v[28:31], v[94:97], v[188:191], v[28:31]
    buffer_load_dwordx4 v1, s[8:11], s33 offen offset:0 sc1 lds
    v_mfma_f32_16x16x32_bf16 v[32:35], v[96:99], v[192:195], v[32:35]
    v_mfma_f32_16x16x32_bf16 v[36:39], v[94:97], v[192:195], v[36:39]
    buffer_load_dwordx4 v1, s[8:11], s33 offen offset:1024 sc1 lds
    buffer_load_dwordx4 v1, s[8:11], s33 offen offset:2048 sc1 lds
    buffer_load_dwordx4 v1, s[8:11], s33 offen offset:3072 sc1 lds
    s_add_u32 s32, s32, 1
    s_add_u32 s40, s40, 131072
    s_add_u32 s33, s33, 116736
    s_add_u32 s34, s34, 36864
    s_cmp_ge_u32 s34, 147456
    s_cselect_b32 s38, 147456, 0
    s_sub_u32 s34, s34, s38
    s_cmp_ge_i32 s32, 63
    s_cselect_b32 s18, 0xffff, s18
    buffer_load_dwordx4 v[184:187], v1, s[4:7], s41 offen offset:1024 sc1
    s_add_u32 s41, s41, 36864
    s_cmp_lt_i32 s31, 63
    s_cbranch_scc1 Lred_top1
    s_branch L_exit
Lred_v03:
    v_mfma_f32_16x16x32_bf16 v[28:31], a[100:103], v[64:67], v[28:31]
    ds_read_b128 v[52:55], v3 offset:11264
    v_mfma_f32_16x16x32_bf16 v[28:31], a[116:119], v[68:71], v[28:31]
    buffer_load_dword v5, v4, s[4:7], s16 offen sc1
    v_mfma_f32_16x16x32_bf16 v[24:27], a[112:115], v[68:71], v[24:27]
    s_cmp_lt_i32 s31, 31
    s_cselect_b32 s14, s6, 0
    s_cselect_b32 s54, s36, s42
    v_mfma_f32_16x16x32_bf16 v[24:27], a[96:99], v[64:67], v[24:27]
    s_waitcnt lgkmcnt(2)
    v_mfma_f32_16x16x32_bf16 v[24:27], a[128:131], v[40:43], v[24:27]
    ds_read_b128 v[56:59], v3 offset:12288
    v_mfma_f32_16x16x32_bf16 v[24:27], a[144:147], v[44:47], v[24:27]
    s_cmp_lt_i32 s31, 31
    s_cselect_b64 s[24:25], s[4:5], s[80:81]
    s_cselect_b32 s26, s6, 0x400000
    v_mfma_f32_16x16x32_bf16 v[28:31], a[148:151], v[44:47], v[28:31]
    s_cmp_lt_i32 s31, 31
    s_cselect_b64 s[48:49], 0, -1
    v_cndmask_b32 v204, v210, v216, s[48:49]
    v_mfma_f32_16x16x32_bf16 v[28:31], a[132:135], v[40:43], v[28:31]
    buffer_load_dwordx4 v[184:187], v1, s[4:7], s41 offen offset:1024 sc1
    v_mfma_f32_16x16x32_bf16 v[32:35], a[136:139], v[40:43], v[32:35]
    ds_read_b128 v[60:63], v3 offset:13312
    v_cndmask_b32 v205, v211, v217, s[48:49]
    v_mfma_f32_16x16x32_bf16 v[32:35], a[152:155], v[44:47], v[32:35]
    s_add_u32 s41, s41, 36864
    v_cndmask_b32 v206, v212, v218, s[48:49]
    v_cndmask_b32 v207, v213, v219, s[48:49]
    v_mfma_f32_16x16x32_bf16 v[36:39], a[156:159], v[44:47], v[36:39]
    v_cndmask_b32 v208, v214, v220, s[48:49]
    v_cndmask_b32 v209, v215, v221, s[48:49]
    v_mfma_f32_16x16x32_bf16 v[36:39], a[140:143], v[40:43], v[36:39]
    s_waitcnt lgkmcnt(2)
    s_add_u32 s35, s35, 36864
    v_mfma_f32_16x16x32_bf16 v[36:39], a[172:175], v[48:51], v[36:39]
    ds_read_b128 v[64:67], v3 offset:14336
    v_mfma_f32_16x16x32_bf16 v[36:39], a[188:191], v[52:55], v[36:39]
    s_cmp_eq_u32 s35, 147456
    s_cselect_b32 s35, 0, s35
    v_mfma_f32_16x16x32_bf16 v[32:35], a[184:187], v[52:55], v[32:35]
    v_mfma_f32_16x16x32_bf16 v[32:35], a[168:171], v[48:51], v[32:35]
    v_mfma_f32_16x16x32_bf16 v[28:31], a[164:167], v[48:51], v[28:31]
    ds_read_b128 v[68:71], v3 offset:15360
    v_mfma_f32_16x16x32_bf16 v[28:31], a[180:183], v[52:55], v[28:31]
    v_mfma_f32_16x16x32_bf16 v[24:27], a[176:179], v[52:55], v[24:27]
    v_mfma_f32_16x16x32_bf16 v[24:27], a[160:163], v[48:51], v[24:27]
    s_waitcnt vmcnt(1) lgkmcnt(2)
    v_cmp_gt_i32 vcc, s32, v5
    v_mfma_f32_16x16x32_bf16 v[24:27], a[192:195], v[56:59], v[24:27]
    v_mfma_f32_16x16x32_bf16 v[24:27], a[208:211], v[60:63], v[24:27]
    s_and_b64 vcc, vcc, s[18:19]
    s_cbranch_scc1 Lred_v04
    v_mfma_f32_16x16x32_bf16 v[28:31], a[212:215], v[60:63], v[28:31]
    s_add_u32 s16, s16, 8192
    v_mfma_f32_16x16x32_bf16 v[28:31], a[196:199], v[56:59], v[28:31]
    buffer_load_dword v5, v4, s[4:7], s16 offen sc1
    v_mfma_f32_16x16x32_bf16 v[32:35], a[200:203], v[56:59], v[32:35]
    v_mfma_f32_16x16x32_bf16 v[32:35], a[216:219], v[60:63], v[32:35]
    v_mfma_f32_16x16x32_bf16 v[36:39], a[220:223], v[60:63], v[36:39]
    v_mfma_f32_16x16x32_bf16 v[36:39], a[204:207], v[56:59], v[36:39]
    s_waitcnt lgkmcnt(0)
    buffer_load_dwordx4 v[148:151], v1, s[4:7], s40 offen offset:0 sc1
    v_mfma_f32_16x16x32_bf16 v[36:39], a[236:239], v[64:67], v[36:39]
    v_mfma_f32_16x16x32_bf16 v[36:39], a[252:255], v[68:71], v[36:39]
    v_mfma_f32_16x16x32_bf16 v[32:35], a[248:251], v[68:71], v[32:35]
    v_mfma_f32_16x16x32_bf16 v[32:35], a[232:235], v[64:67], v[32:35]
    buffer_load_dwordx4 v[152:155], v1, s[4:7], s40 offen offset:1024 sc1
    v_mfma_f32_16x16x32_bf16 v[28:31], a[228:231], v[64:67], v[28:31]
    s_add_u32 s37, s40, 32768
    v_mfma_f32_16x16x32_bf16 v[28:31], a[244:247], v[68:71], v[28:31]
    v_mfma_f32_16x16x32_bf16 v[24:27], a[240:243], v[68:71], v[24:27]
    v_mfma_f32_16x16x32_bf16 v[24:27], a[224:227], v[64:67], v[24:27]
    buffer_load_dwordx4 v[156:159], v1, s[4:7], s37 offen offset:0 sc1
    v_mfma_f32_16x16x32_bf16 v[24:27], v[96:99], v[188:191], v[24:27]
    v_mfma_f32_16x16x32_bf16 v[28:31], v[94:97], v[188:191], v[28:31]
    v_mfma_f32_16x16x32_bf16 v[32:35], v[96:99], v[192:195], v[32:35]
    v_mfma_f32_16x16x32_bf16 v[36:39], v[94:97], v[192:195], v[36:39]
    buffer_load_dwordx4 v[160:163], v1, s[4:7], s37 offen offset:1024 sc1
    s_add_u32 s37, s40, 65536
    buffer_load_dwordx4 v[164:167], v1, s[4:7], s37 offen offset:0 sc1
    buffer_load_dwordx4 v[168:171], v1, s[4:7], s37 offen offset:1024 sc1
    s_add_u32 s37, s40, 98304
    buffer_load_dwordx4 v[172:175], v1, s[4:7], s37 offen offset:0 sc1
    buffer_load_dwordx4 v[176:179], v1, s[4:7], s37 offen offset:1024 sc1
    s_add_u32 m0, s34, 0
    s_nop 0
    buffer_load_dwordx4 v1, s[8:11], s33 offen offset:0 sc1 lds
    buffer_load_dwordx4 v1, s[8:11], s33 offen offset:1024 sc1 lds
    buffer_load_dwordx4 v1, s[8:11], s33 offen offset:2048 sc1 lds
    buffer_load_dwordx4 v1, s[8:11], s33 offen offset:3072 sc1 lds
    s_add_u32 s32, s32, 1
    s_add_u32 s40, s40, 131072
    s_add_u32 s33, s33, 116736
    s_add_u32 s34, s34, 36864
    s_cmp_ge_u32 s34, 147456
    s_cselect_b32 s38, 147456, 0
    s_sub_u32 s34, s34, s38
    s_cmp_ge_i32 s32, 63
    s_cselect_b32 s18, 0xffff, s18
    s_cmp_lt_i32 s31, 63
    s_cbranch_scc1 Lred_top1
    s_branch L_exit
Lred_v04:
    v_mfma_f32_16x16x32_bf16 v[28:31], a[212:215], v[60:63], v[28:31]
    buffer_load_dword v5, v4, s[4:7], s16 offen sc1
    v_mfma_f32_16x16x32_bf16 v[28:31], a[196:199], v[56:59], v[28:31]
    v_mfma_f32_16x16x32_bf16 v[32:35], a[200:203], v[56:59], v[32:35]
    v_mfma_f32_16x16x32_bf16 v[32:35], a[216:219], v[60:63], v[32:35]
    v_mfma_f32_16x16x32_bf16 v[36:39], a[220:223], v[60:63], v[36:39]
    v_mfma_f32_16x16x32_bf16 v[36:39], a[204:207], v[56:59], v[36:39]
    s_waitcnt lgkmcnt(0)
    v_mfma_f32_16x16x32_bf16 v[36:39], a[236:239], v[64:67], v[36:39]
    v_mfma_f32_16x16x32_bf16 v[36:39], a[252:255], v[68:71], v[36:39]
    v_mfma_f32_16x16x32_bf16 v[32:35], a[248:251], v[68:71], v[32:35]
    v_mfma_f32_16x16x32_bf16 v[32:35], a[232:235], v[64:67], v[32:35]
    v_mfma_f32_16x16x32_bf16 v[28:31], a[228:231], v[64:67], v[28:31]
    v_mfma_f32_16x16x32_bf16 v[28:31], a[244:247], v[68:71], v[28:31]
    v_mfma_f32_16x16x32_bf16 v[24:27], a[240:243], v[68:71], v[24:27]
    v_mfma_f32_16x16x32_bf16 v[24:27], a[224:227], v[64:67], v[24:27]
    v_mfma_f32_16x16x32_bf16 v[24:27], v[96:99], v[188:191], v[24:27]
    v_mfma_f32_16x16x32_bf16 v[28:31], v[94:97], v[188:191], v[28:31]
    v_mfma_f32_16x16x32_bf16 v[32:35], v[96:99], v[192:195], v[32:35]
    v_mfma_f32_16x16x32_bf16 v[36:39], v[94:97], v[192:195], v[36:39]
    s_waitcnt vmcnt(0)
    v_cmp_gt_i32 vcc, s32, v5
    s_sub_u32 s43, s43, 1
    s_cmp_lt_i32 s43, 0
    s_cbranch_scc1 Lred_rdy0x
    s_and_b64 vcc, vcc, s[18:19]
    s_cbranch_scc0 Lred_rdy0x
Lred_spin0x:
    buffer_load_dword v5, v4, s[4:7], s16 offen sc1
    s_waitcnt vmcnt(0)
    v_cmp_gt_i32 vcc, s32, v5
    s_sub_u32 s43, s43, 1
    s_cmp_lt_i32 s43, 0
    s_cbranch_scc1 Lred_rdy0x
    s_and_b64 vcc, vcc, s[18:19]
    s_cbranch_scc0 Lred_rdy0x
    s_sleep 8
    s_branch Lred_spin0x
Lred_rdy0x:
    s_add_u32 s16, s16, 8192
    buffer_load_dword v5, v4, s[4:7], s16 offen sc1
    buffer_load_dwordx4 v[148:151], v1, s[4:7], s40 offen offset:0 sc1
    buffer_load_dwordx4 v[152:155], v1, s[4:7], s40 offen offset:1024 sc1
    s_add_u32 s37, s40, 32768
    buffer_load_dwordx4 v[156:159], v1, s[4:7], s37 offen offset:0 sc1
    buffer_load_dwordx4 v[160:163], v1, s[4:7], s37 offen offset:1024 sc1
    s_add_u32 s37, s40, 65536
    buffer_load_dwordx4 v[164:167], v1, s[4:7], s37 offen offset:0 sc1
    buffer_load_dwordx4 v[168:171], v1, s[4:7], s37 offen offset:1024 sc1
    s_add_u32 s37, s40, 98304
    buffer_load_dwordx4 v[172:175], v1, s[4:7], s37 offen offset:0 sc1
    buffer_load_dwordx4 v[176:179], v1, s[4:7], s37 offen offset:1024 sc1
    s_add_u32 m0, s34, 0
    s_nop 0
    buffer_load_dwordx4 v1, s[8:11], s33 offen offset:0 sc1 lds
    buffer_load_dwordx4 v1, s[8:11], s33 offen offset:1024 sc1 lds
    buffer_load_dwordx4 v1, s[8:11], s33 offen offset:2048 sc1 lds
    buffer_load_dwordx4 v1, s[8:11], s33 offen offset:3072 sc1 lds
    s_add_u32 s32, s32, 1
    s_add_u32 s40, s40, 131072
    s_add_u32 s33, s33, 116736
    s_add_u32 s34, s34, 36864
    s_cmp_ge_u32 s34, 147456
    s_cselect_b32 s38, 147456, 0
    s_sub_u32 s34, s34, s38
    s_cmp_ge_i32 s32, 63
    s_cselect_b32 s18, 0xffff, s18
    s_branch Lred_top1
Lred_top1:
    s_waitcnt vmcnt(10)
    v_mfma_f32_16x16x32_bf16 v[36:39], v[94:97], v[152:155], v[36:39]
    s_barrier
    v_mfma_f32_16x16x32_bf16 v[32:35], v[96:99], v[152:155], v[32:35]
    s_waitcnt vmcnt(9)
    v_add_u32 v2, s35, v1
    v_cmp_gt_i32 vcc, s32, v5
    v_mfma_f32_16x16x32_bf16 v[28:31], v[94:97], v[148:151], v[28:31]
    v_mfma_f32_16x16x32_bf16 v[24:27], v[96:99], v[148:151], v[24:27]
    s_waitcnt vmcnt(8)
    s_and_b64 vcc, vcc, s[18:19]
    s_cbranch_scc1 Lred_v11
    v_mfma_f32_16x16x32_bf16 v[24:27], v[96:99], v[156:159], v[24:27]
    s_add_u32 s16, s16, 8192
    v_mfma_f32_16x16x32_bf16 v[28:31], v[94:97], v[156:159], v[28:31]
    buffer_load_dwordx4 v[116:119], v1, s[4:7], s40 offen offset:0 sc1
    v_mfma_f32_16x16x32_bf16 v[32:35], v[96:99], v[160:163], v[32:35]
    ds_read_b128 v[40:43], v2 offset:0
    s_add_u32 s31, s31, 1
    v_mfma_f32_16x16x32_bf16 v[36:39], v[94:97], v[160:163], v[36:39]
    s_waitcnt vmcnt(7)
    v_mov_b32 v6, s31
    v_mfma_f32_16x16x32_bf16 v[36:39], v[94:97], v[168:171], v[36:39]
    ds_read_b128 v[44:47], v2 offset:1024
    v_mfma_f32_16x16x32_bf16 v[32:35], v[96:99], v[168:171], v[32:35]
    buffer_load_dwordx4 v[120:123], v1, s[4:7], s40 offen offset:1024 sc1
    v_mfma_f32_16x16x32_bf16 v[28:31], v[94:97], v[164:167], v[28:31]
    ds_read_b128 v[48:51], v2 offset:2048
    s_add_u32 s37, s40, 32768
    v_mfma_f32_16x16x32_bf16 v[24:27], v[96:99], v[164:167], v[24:27]
    s_waitcnt vmcnt(6)
    buffer_store_dword v6, v80, s[20:23], s17 offen sc1
    v_mfma_f32_16x16x32_bf16 v[24:27], v[96:99], v[172:175], v[24:27]
    ds_read_b128 v[52:55], v2 offset:3072
    s_add_u32 s17, s17, 8192
    v_mfma_f32_16x16x32_bf16 v[28:31], v[94:97], v[172:175], v[28:31]
    buffer_load_dwordx4 v[124:127], v1, s[4:7], s37 offen offset:0 sc1
    v_mfma_f32_16x16x32_bf16 v[32:35], v[96:99], v[176:179], v[32:35]
    v_mfma_f32_16x16x32_bf16 v[36:39], v[94:97], v[176:179], v[36:39]
    s_waitcnt lgkmcnt(2)
    v_mfma_f32_16x16x32_bf16 v[8:11], a[0:3], v[40:43], v[100:103]
    ds_read_b128 v[56:59], v2 offset:4096
    v_cvt_pk_bf16_f32 v72, v24, v25
    v_mfma_f32_16x16x32_bf16 v[8:11], a[16:19], v[44:47], v[8:11]
    buffer_load_dwordx4 v[128:131], v1, s[4:7], s37 offen offset:1024 sc1
    v_mfma_f32_16x16x32_bf16 v[12:15], a[20:23], v[44:47], v[104:107]
    s_add_u32 s37, s40, 65536
    v_cvt_pk_bf16_f32 v73, v26, v27
    v_mfma_f32_16x16x32_bf16 v[12:15], a[4:7], v[40:43], v[12:15]
    ds_write_b64 v204, v[72:73]
    v_mfma_f32_16x16x32_bf16 v[16:19], a[8:11], v[40:43], v[108:111]
    ds_read_b128 v[60:63], v2 offset:5120
    v_cvt_pk_bf16_f32 v74, v28, v29
    v_mfma_f32_16x16x32_bf16 v[16:19], a[24:27], v[44:47], v[16:19]
    buffer_load_dwordx4 v[132:135], v1, s[4:7], s37 offen offset:0 sc1
    v_mfma_f32_16x16x32_bf16 v[20:23], a[28:31], v[44:47], v[112:115]
    v_cvt_pk_bf16_f32 v75, v30, v31
    v_mfma_f32_16x16x32_bf16 v[20:23], a[12:15], v[40:43], v[20:23]
    s_waitcnt lgkmcnt(3)
    ds_write_b64 v205, v[74:75]
    v_mfma_f32_16x16x32_bf16 v[20:23], a[44:47], v[48:51], v[20:23]
    ds_read_b128 v[64:67], v2 offset:6144
    v_cvt_pk_bf16_f32 v76, v32, v33
    v_mfma_f32_16x16x32_bf16 v[20:23], a[60:63], v[52:55], v[20:23]
    buffer_load_dwordx4 v[136:139], v1, s[4:7], s37 offen offset:1024 sc1
    v_mfma_f32_16x16x32_bf16 v[16:19], a[56:59], v[52:55], v[16:19]
    s_add_u32 s37, s40, 98304
    v_cvt_pk_bf16_f32 v77, v34, v35
    v_mfma_f32_16x16x32_bf16 v[16:19], a[40:43], v[48:51], v[16:19]
    ds_write_b64 v206, v[76:77]
    v_mfma_f32_16x16x32_bf16 v[12:15], a[36:39], v[48:51], v[12:15]
    ds_read_b128 v[68:71], v2 offset:7168
    v_cvt_pk_bf16_f32 v78, v36, v37
    v_mfma_f32_16x16x32_bf16 v[12:15], a[52:55], v[52:55], v[12:15]
    buffer_load_dwordx4 v[140:143], v1, s[4:7], s37 offen offset:0 sc1
    v_mfma_f32_16x16x32_bf16 v[8:11], a[48:51], v[52:55], v[8:11]
    v_cvt_pk_bf16_f32 v79, v38, v39
    v_mfma_f32_16x16x32_bf16 v[8:11], a[32:35], v[48:51], v[8:11]
    s_waitcnt lgkmcnt(4)
    ds_write_b64 v207, v[78:79]
    v_mfma_f32_16x16x32_bf16 v[8:11], a[64:67], v[56:59], v[8:11]
    ds_read_b128 v[40:43], v2 offset:8192
    v_mfma_f32_16x16x32_bf16 v[8:11], a[80:83], v[60:63], v[8:11]
    buffer_load_dwordx4 v[144:147], v1, s[4:7], s37 offen offset:1024 sc1
    v_mfma_f32_16x16x32_bf16 v[12:15], a[84:87], v[60:63], v[12:15]
    s_add_u32 m0, s34, 0
    ds_read_b128 v[196:199], v222 offset:0
    v_mfma_f32_16x16x32_bf16 v[12:15], a[68:71], v[56:59], v[12:15]
    ds_read_b128 v[200:203], v222 offset:1024
    v_mfma_f32_16x16x32_bf16 v[86:89], v[72:75], v[72:75], 0
    v_mfma_f32_16x16x32_bf16 v[82:85], v[90:93], v[72:75], 0
    buffer_load_dword v5, v4, s[4:7], s16 offen sc1
    v_mfma_f32_16x16x32_bf16 v[86:89], v[76:79], v[76:79], v[86:89]
    v_mfma_f32_16x16x32_bf16 v[82:85], v[90:93], v[76:79], v[82:85]
    s_waitcnt lgkmcnt(1)
    v_mfma_f32_16x16x32_bf16 v[16:19], a[72:75], v[56:59], v[16:19]
    ds_read_b128 v[44:47], v2 offset:9216
    v_mfma_f32_16x16x32_bf16 v[16:19], a[88:91], v[60:63], v[16:19]
    buffer_store_dwordx4 v[196:199], v208, s[24:27], s54 offen sc1
    s_waitcnt lgkmcnt(1)
    v_mfma_f32_16x16x32_bf16 v[20:23], a[92:95], v[60:63], v[20:23]
    v_mfma_f32_16x16x32_bf16 v[20:23], a[76:79], v[56:59], v[20:23]
    v_mfma_f32_16x16x32_bf16 v[20:23], a[108:111], v[64:67], v[20:23]
    ds_read_b128 v[48:51], v2 offset:10240
    v_mfma_f32_16x16x32_bf16 v[20:23], a[124:127], v[68:71], v[20:23]
    buffer_store_dwordx4 v[200:203], v209, s[24:27], s54 offen sc1
    v_cndmask_b32 v86, v86, v87, s[44:45]
    v_mfma_f32_16x16x32_bf16 v[16:19], a[120:123], v[68:71], v[16:19]
    v_cndmask_b32 v88, v88, v89, s[44:45]
    v_cndmask_b32 v83, v86, v88, s[46:47]
    v_mfma_f32_16x16x32_bf16 v[16:19], a[104:107], v[64:67], v[16:19]
    buffer_store_dwordx2 v[82:83], v7, s[12:15], s36 offen offset:0 sc1
    s_mov_b32 s22, s14
    v_mfma_f32_16x16x32_bf16 v[12:15], a[100:103], v[64:67], v[12:15]
    ds_read_b128 v[52:55], v2 offset:11264
    s_add_u32 s36, s36, 34816
    v_mfma_f32_16x16x32_bf16 v[12:15], a[116:119], v[68:71], v[12:15]
    buffer_load_dwordx4 v1, s[8:11], s33 offen offset:0 sc1 lds
    v_mfma_f32_16x16x32_bf16 v[8:11], a[112:115], v[68:71], v[8:11]
    s_sub_u32 s42, s42, 32768
    v_mfma_f32_16x16x32_bf16 v[8:11], a[96:99], v[64:67], v[8:11]
    s_waitcnt lgkmcnt(2)
    v_mfma_f32_16x16x32_bf16 v[8:11], a[128:131], v[40:43], v[8:11]
    ds_read_b128 v[56:59], v2 offset:12288
    v_mfma_f32_16x16x32_bf16 v[8:11], a[144:147], v[44:47], v[8:11]
    buffer_load_dwordx4 v1, s[8:11], s33 offen offset:1024 sc1 lds
    v_mfma_f32_16x16x32_bf16 v[12:15], a[148:151], v[44:47], v[12:15]
    s_cmp_lt_i32 s31, 31
    s_cselect_b32 s14, s6, 0
    s_cselect_b32 s54, s36, s42
    v_mfma_f32_16x16x32_bf16 v[12:15], a[132:135], v[40:43], v[12:15]
    s_cmp_lt_i32 s31, 31
    s_cselect_b64 s[24:25], s[4:5], s[80:81]
    s_cselect_b32 s26, s6, 0x400000
    v_mfma_f32_16x16x32_bf16 v[16:19], a[136:139], v[40:43], v[16:19]
    ds_read_b128 v[60:63], v2 offset:13312
    v_mfma_f32_16x16x32_bf16 v[16:19], a[152:155], v[44:47], v[16:19]
    buffer_load_dwordx4 v1, s[8:11], s33 offen offset:2048 sc1 lds
    v_mfma_f32_16x16x32_bf16 v[20:23], a[156:159], v[44:47], v[20:23]
    s_cmp_lt_i32 s31, 31
    s_cselect_b64 s[48:49], 0, -1
    v_cndmask_b32 v204, v210, v216, s[48:49]
    v_mfma_f32_16x16x32_bf16 v[20:23], a[140:143], v[40:43], v[20:23]
    s_waitcnt lgkmcnt(2)
    v_cndmask_b32 v205, v211, v217, s[48:49]
    v_cndmask_b32 v206, v212, v218, s[48:49]
    v_mfma_f32_16x16x32_bf16 v[20:23], a[172:175], v[48:51], v[20:23]
    ds_read_b128 v[64:67], v2 offset:14336
    v_cndmask_b32 v207, v213, v219, s[48:49]
    v_mfma_f32_16x16x32_bf16 v[20:23], a[188:191], v[52:55], v[20:23]
    buffer_load_dwordx4 v1, s[8:11], s33 offen offset:3072 sc1 lds
    v_mfma_f32_16x16x32_bf16 v[16:19], a[184:187], v[52:55], v[16:19]
    s_add_u32 s32, s32, 1
    s_add_u32 s40, s40, 131072
    s_add_u32 s33, s33, 116736
    v_mfma_f32_16x16x32_bf16 v[16:19], a[168:171], v[48:51], v[16:19]
    s_add_u32 s34, s34, 36864
    s_cmp_ge_u32 s34, 147456
    s_cselect_b32 s38, 147456, 0
    v_mfma_f32_16x16x32_bf16 v[12:15], a[164:167], v[48:51], v[12:15]
    ds_read_b128 v[68:71], v2 offset:15360
    s_sub_u32 s34, s34, s38
    v_mfma_f32_16x16x32_bf16 v[12:15], a[180:183], v[52:55], v[12:15]
    s_cmp_ge_i32 s32, 63
    s_cselect_b32 s18, 0xffff, s18
    v_cndmask_b32 v208, v214, v220, s[48:49]
    v_mfma_f32_16x16x32_bf16 v[8:11], a[176:179], v[52:55], v[8:11]
    buffer_load_dwordx4 v[188:191], v1, s[4:7], s41 offen offset:0 sc1
    v_mfma_f32_16x16x32_bf16 v[8:11], a[160:163], v[48:51], v[8:11]
    s_waitcnt lgkmcnt(2)
    v_cndmask_b32 v209, v215, v221, s[48:49]
    s_add_u32 s35, s35, 36864
    v_mfma_f32_16x16x32_bf16 v[8:11], a[192:195], v[56:59], v[8:11]
    s_cmp_eq_u32 s35, 147456
    s_cselect_b32 s35, 0, s35
    v_mfma_f32_16x16x32_bf16 v[8:11], a[208:211], v[60:63], v[8:11]
    v_mfma_f32_16x16x32_bf16 v[12:15], a[212:215], v[60:63], v[12:15]
    buffer_load_dwordx4 v[192:195], v1, s[4:7], s41 offen offset:1024 sc1
    v_mfma_f32_16x16x32_bf16 v[12:15], a[196:199], v[56:59], v[12:15]
    s_add_u32 s41, s41, 36864
    v_mfma_f32_16x16x32_bf16 v[16:19], a[200:203], v[56:59], v[16:19]
    v_mfma_f32_16x16x32_bf16 v[16:19], a[216:219], v[60:63], v[16:19]
    v_mfma_f32_16x16x32_bf16 v[20:23], a[220:223], v[60:63], v[20:23]
    v_mfma_f32_16x16x32_bf16 v[20:23], a[204:207], v[56:59], v[20:23]
    s_waitcnt lgkmcnt(0)
    v_mfma_f32_16x16x32_bf16 v[20:23], a[236:239], v[64:67], v[20:23]
    v_mfma_f32_16x16x32_bf16 v[20:23], a[252:255], v[68:71], v[20:23]
    v_mfma_f32_16x16x32_bf16 v[16:19], a[248:251], v[68:71], v[16:19]
    v_mfma_f32_16x16x32_bf16 v[16:19], a[232:235], v[64:67], v[16:19]
    v_mfma_f32_16x16x32_bf16 v[12:15], a[228:231], v[64:67], v[12:15]
    v_mfma_f32_16x16x32_bf16 v[12:15], a[244:247], v[68:71], v[12:15]
    v_mfma_f32_16x16x32_bf16 v[8:11], a[240:243], v[68:71], v[8:11]
    v_mfma_f32_16x16x32_bf16 v[8:11], a[224:227], v[64:67], v[8:11]
    s_waitcnt vmcnt(19)
    v_mfma_f32_16x16x32_bf16 v[8:11], v[96:99], v[180:183], v[8:11]
    v_mfma_f32_16x16x32_bf16 v[12:15], v[94:97], v[180:183], v[12:15]
    v_mfma_f32_16x16x32_bf16 v[16:19], v[96:99], v[184:187], v[16:19]
    v_mfma_f32_16x16x32_bf16 v[20:23], v[94:97], v[184:187], v[20:23]
    s_cmp_lt_i32 s31, 63
    s_cbranch_scc1 Lred_run0
    s_branch L_exit
Lred_v11:
    s_nop 1
    s_waitcnt vmcnt(8)
    v_mfma_f32_16x16x32_bf16 v[24:27], v[96:99], v[156:159], v[24:27]
    buffer_load_dword v5, v4, s[4:7], s16 offen sc1
    v_mfma_f32_16x16x32_bf16 v[28:31], v[94:97], v[156:159], v[28:31]
    s_add_u32 s31, s31, 1
    v_mov_b32 v6, s31
    v_mfma_f32_16x16x32_bf16 v[32:35], v[96:99], v[160:163], v[32:35]
    ds_read_b128 v[40:43], v2 offset:0
    v_mfma_f32_16x16x32_bf16 v[36:39], v[94:97], v[160:163], v[36:39]
    s_waitcnt vmcnt(7)
    v_mfma_f32_16x16x32_bf16 v[36:39], v[94:97], v[168:171], v[36:39]
    ds_read_b128 v[44:47], v2 offset:1024
    v_mfma_f32_16x16x32_bf16 v[32:35], v[96:99], v[168:171], v[32:35]
    buffer_store_dword v6, v80, s[20:23], s17 offen sc1
    s_add_u32 s17, s17, 8192
    v_mfma_f32_16x16x32_bf16 v[28:31], v[94:97], v[164:167], v[28:31]
    ds_read_b128 v[48:51], v2 offset:2048
    v_mfma_f32_16x16x32_bf16 v[24:27], v[96:99], v[164:167], v[24:27]
    s_waitcnt vmcnt(6)
    v_mfma_f32_16x16x32_bf16 v[24:27], v[96:99], v[172:175], v[24:27]
    ds_read_b128 v[52:55], v2 offset:3072
    v_mfma_f32_16x16x32_bf16 v[28:31], v[94:97], v[172:175], v[28:31]
    v_mfma_f32_16x16x32_bf16 v[32:35], v[96:99], v[176:179], v[32:35]
    v_mfma_f32_16x16x32_bf16 v[36:39], v[94:97], v[176:179], v[36:39]
    s_waitcnt lgkmcnt(2)
    v_mfma_f32_16x16x32_bf16 v[8:11], a[0:3], v[40:43], v[100:103]
    ds_read_b128 v[56:59], v2 offset:4096
    v_mfma_f32_16x16x32_bf16 v[8:11], a[16:19], v[44:47], v[8:11]
    v_cvt_pk_bf16_f32 v72, v24, v25
    v_cvt_pk_bf16_f32 v73, v26, v27
    v_mfma_f32_16x16x32_bf16 v[12:15], a[20:23], v[44:47], v[104:107]
    ds_write_b64 v204, v[72:73]
    v_mfma_f32_16x16x32_bf16 v[12:15], a[4:7], v[40:43], v[12:15]
    v_cvt_pk_bf16_f32 v74, v28, v29
    v_cvt_pk_bf16_f32 v75, v30, v31
    v_mfma_f32_16x16x32_bf16 v[16:19], a[8:11], v[40:43], v[108:111]
    ds_read_b128 v[60:63], v2 offset:5120
    v_mfma_f32_16x16x32_bf16 v[16:19], a[24:27], v[44:47], v[16:19]
    ds_write_b64 v205, v[74:75]
    v_mfma_f32_16x16x32_bf16 v[20:23], a[28:31], v[44:47], v[112:115]
    s_waitcnt vmcnt(1)
    v_cmp_gt_i32 vcc, s32, v5
    v_cvt_pk_bf16_f32 v76, v32, v33
    v_mfma_f32_16x16x32_bf16 v[20:23], a[12:15], v[40:43], v[20:23]
    s_waitcnt lgkmcnt(4)
    v_cvt_pk_bf16_f32 v77, v34, v35
    v_mfma_f32_16x16x32_bf16 v[20:23], a[44:47], v[48:51], v[20:23]
    ds_read_b128 v[64:67], v2 offset:6144
    v_mfma_f32_16x16x32_bf16 v[20:23], a[60:63], v[52:55], v[20:23]
    s_and_b64 vcc, vcc, s[18:19]
    s_cbranch_scc1 Lred_v12
    v_mfma_f32_16x16x32_bf16 v[16:19], a[56:59], v[52:55], v[16:19]
    s_add_u32 s16, s16, 8192
    v_mfma_f32_16x16x32_bf16 v[16:19], a[40:43], v[48:51], v[16:19]
    buffer_load_dwordx4 v[116:119], v1, s[4:7], s40 offen offset:0 sc1
    v_mfma_f32_16x16x32_bf16 v[12:15], a[36:39], v[48:51], v[12:15]
    ds_read_b128 v[68:71], v2 offset:7168
    v_mfma_f32_16x16x32_bf16 v[12:15], a[52:55], v[52:55], v[12:15]
    ds_write_b64 v206, v[76:77]
    v_mfma_f32_16x16x32_bf16 v[8:11], a[48:51], v[52:55], v[8:11]
    v_cvt_pk_bf16_f32 v78, v36, v37
    v_cvt_pk_bf16_f32 v79, v38, v39
    v_mfma_f32_16x16x32_bf16 v[8:11], a[32:35], v[48:51], v[8:11]
    s_waitcnt lgkmcnt(4)
    buffer_load_dwordx4 v[120:123], v1, s[4:7], s40 offen offset:1024 sc1
    v_mfma_f32_16x16x32_bf16 v[8:11], a[64:67], v[56:59], v[8:11]
    ds_read_b128 v[40:43], v2 offset:8192
    s_add_u32 s37, s40, 32768
    v_mfma_f32_16x16x32_bf16 v[8:11], a[80:83], v[60:63], v[8:11]
    ds_write_b64 v207, v[78:79]
    v_mfma_f32_16x16x32_bf16 v[12:15], a[84:87], v[60:63], v[12:15]
    ds_read_b128 v[196:199], v222 offset:0
    v_mfma_f32_16x16x32_bf16 v[12:15], a[68:71], v[56:59], v[12:15]
    buffer_load_dword v5, v4, s[4:7], s16 offen sc1
    v_mfma_f32_16x16x32_bf16 v[16:19], a[72:75], v[56:59], v[16:19]
    ds_read_b128 v[44:47], v2 offset:9216
    v_mfma_f32_16x16x32_bf16 v[16:19], a[88:91], v[60:63], v[16:19]
    ds_read_b128 v[200:203], v222 offset:1024
    v_mfma_f32_16x16x32_bf16 v[86:89], v[72:75], v[72:75], 0
    v_mfma_f32_16x16x32_bf16 v[82:85], v[90:93], v[72:75], 0
    buffer_load_dwordx4 v[124:127], v1, s[4:7], s37 offen offset:0 sc1
    v_mfma_f32_16x16x32_bf16 v[86:89], v[76:79], v[76:79], v[86:89]
    v_mfma_f32_16x16x32_bf16 v[82:85], v[90:93], v[76:79], v[82:85]
    s_waitcnt lgkmcnt(2)
    v_mfma_f32_16x16x32_bf16 v[20:23], a[92:95], v[60:63], v[20:23]
    v_mfma_f32_16x16x32_bf16 v[20:23], a[76:79], v[56:59], v[20:23]
    buffer_store_dwordx4 v[196:199], v208, s[24:27], s54 offen sc1
    s_waitcnt lgkmcnt(0)
    v_mfma_f32_16x16x32_bf16 v[20:23], a[108:111], v[64:67], v[20:23]
    ds_read_b128 v[48:51], v2 offset:10240
    v_mfma_f32_16x16x32_bf16 v[20:23], a[124:127], v[68:71], v[20:23]
    v_mfma_f32_16x16x32_bf16 v[16:19], a[120:123], v[68:71], v[16:19]
    v_mfma_f32_16x16x32_bf16 v[16:19], a[104:107], v[64:67], v[16:19]
    buffer_store_dwordx4 v[200:203], v209, s[24:27], s54 offen sc1
    v_cndmask_b32 v86, v86, v87, s[44:45]
    v_mfma_f32_16x16x32_bf16 v[12:15], a[100:103], v[64:67], v[12:15]
    ds_read_b128 v[52:55], v2 offset:11264
    v_cndmask_b32 v88, v88, v89, s[44:45]
    v_mfma_f32_16x16x32_bf16 v[12:15], a[116:119], v[68:71], v[12:15]
    v_cndmask_b32 v83, v86, v88, s[46:47]
    v_mfma_f32_16x16x32_bf16 v[8:11], a[112:115], v[68:71], v[8:11]
    buffer_store_dwordx2 v[82:83], v7, s[12:15], s36 offen offset:0 sc1
    s_mov_b32 s22, s14
    v_mfma_f32_16x16x32_bf16 v[8:11], a[96:99], v[64:67], v[8:11]
    buffer_load_dwordx4 v[128:131], v1, s[4:7], s37 offen offset:1024 sc1
    v_mfma_f32_16x16x32_bf16 v[8:11], a[128:131], v[40:43], v[8:11]
    ds_read_b128 v[56:59], v2 offset:12288
    s_add_u32 s37, s40, 65536
    v_mfma_f32_16x16x32_bf16 v[8:11], a[144:147], v[44:47], v[8:11]
    s_add_u32 s36, s36, 34816
    s_sub_u32 s42, s42, 32768
    v_mfma_f32_16x16x32_bf16 v[12:15], a[148:151], v[44:47], v[12:15]
    s_cmp_lt_i32 s31, 31
    s_cselect_b32 s14, s6, 0
    s_cselect_b32 s54, s36, s42
    v_mfma_f32_16x16x32_bf16 v[12:15], a[132:135], v[40:43], v[12:15]
    buffer_load_dwordx4 v[132:135], v1, s[4:7], s37 offen offset:0 sc1
    v_mfma_f32_16x16x32_bf16 v[16:19], a[136:139], v[40:43], v[16:19]
    ds_read_b128 v[60:63], v2 offset:13312
    v_mfma_f32_16x16x32_bf16 v[16:19], a[152:155], v[44:47], v[16:19]
    s_cmp_lt_i32 s31, 31
    s_cselect_b64 s[24:25], s[4:5], s[80:81]
    s_cselect_b32 s26, s6, 0x400000
    v_mfma_f32_16x16x32_bf16 v[20:23], a[156:159], v[44:47], v[20:23]
    s_cmp_lt_i32 s31, 31
    s_cselect_b64 s[48:49], 0, -1
    v_cndmask_b32 v204, v210, v216, s[48:49]
    v_mfma_f32_16x16x32_bf16 v[20:23], a[140:143], v[40:43], v[20:23]
    s_waitcnt lgkmcnt(2)
    buffer_load_dwordx4 v[136:139], v1, s[4:7], s37 offen offset:1024 sc1
    v_mfma_f32_16x16x32_bf16 v[20:23], a[172:175], v[48:51], v[20:23]
    ds_read_b128 v[64:67], v2 offset:14336
    s_add_u32 s37, s40, 98304
    v_mfma_f32_16x16x32_bf16 v[20:23], a[188:191], v[52:55], v[20:23]
    v_cndmask_b32 v205, v211, v217, s[48:49]
    v_cndmask_b32 v206, v212, v218, s[48:49]
    v_mfma_f32_16x16x32_bf16 v[16:19], a[184:187], v[52:55], v[16:19]
    v_cndmask_b32 v207, v213, v219, s[48:49]
    v_cndmask_b32 v208, v214, v220, s[48:49]
    v_mfma_f32_16x16x32_bf16 v[16:19], a[168:171], v[48:51], v[16:19]
    buffer_load_dwordx4 v[140:143], v1, s[4:7], s37 offen offset:0 sc1
    v_mfma_f32_16x16x32_bf16 v[12:15], a[164:167], v[48:51], v[12:15]
    ds_read_b128 v[68:71], v2 offset:15360
    v_cndmask_b32 v209, v215, v221, s[48:49]
    v_mfma_f32_16x16x32_bf16 v[12:15], a[180:183], v[52:55], v[12:15]
    s_add_u32 s35, s35, 36864
    s_cmp_eq_u32 s35, 147456
    s_cselect_b32 s35, 0, s35
    v_mfma_f32_16x16x32_bf16 v[8:11], a[176:179], v[52:55], v[8:11]
    v_mfma_f32_16x16x32_bf16 v[8:11], a[160:163], v[48:51], v[8:11]
    s_waitcnt lgkmcnt(2)
    buffer_load_dwordx4 v[144:147], v1, s[4:7], s37 offen offset:1024 sc1
    v_mfma_f32_16x16x32_bf16 v[8:11], a[192:195], v[56:59], v[8:11]
    s_add_u32 m0, s34, 0
    v_mfma_f32_16x16x32_bf16 v[8:11], a[208:211], v[60:63], v[8:11]
    v_mfma_f32_16x16x32_bf16 v[12:15], a[212:215], v[60:63], v[12:15]
    v_mfma_f32_16x16x32_bf16 v[12:15], a[196:199], v[56:59], v[12:15]
    buffer_load_dwordx4 v1, s[8:11], s33 offen offset:0 sc1 lds
    v_mfma_f32_16x16x32_bf16 v[16:19], a[200:203], v[56:59], v[16:19]
    v_mfma_f32_16x16x32_bf16 v[16:19], a[216:219], v[60:63], v[16:19]
    v_mfma_f32_16x16x32_bf16 v[20:23], a[220:223], v[60:63], v[20:23]
    v_mfma_f32_16x16x32_bf16 v[20:23], a[204:207], v[56:59], v[20:23]
    s_waitcnt lgkmcnt(0)
    buffer_load_dwordx4 v1, s[8:11], s33 offen offset:1024 sc1 lds
    v_mfma_f32_16x16x32_bf16 v[20:23], a[236:239], v[64:67], v[20:23]
    v_mfma_f32_16x16x32_bf16 v[20:23], a[252:255], v[68:71], v[20:23]
    v_mfma_f32_16x16x32_bf16 v[16:19], a[248:251], v[68:71], v[16:19]
    v_mfma_f32_16x16x32_bf16 v[16:19], a[232:235], v[64:67], v[16:19]
    buffer_load_dwordx4 v1, s[8:11], s33 offen offset:2048 sc1 lds
    v_mfma_f32_16x16x32_bf16 v[12:15], a[228:231], v[64:67], v[12:15]
    v_mfma_f32_16x16x32_bf16 v[12:15], a[244:247], v[68:71], v[12:15]
    v_mfma_f32_16x16x32_bf16 v[8:11], a[240:243], v[68:71], v[8:11]
    v_mfma_f32_16x16x32_bf16 v[8:11], a[224:227], v[64:67], v[8:11]
    buffer_load_dwordx4 v1, s[8:11], s33 offen offset:3072 sc1 lds
    v_mfma_f32_16x16x32_bf16 v[8:11], v[96:99], v[180:183], v[8:11]
    s_add_u32 s32, s32, 1
    s_add_u32 s40, s40, 131072
    s_add_u32 s33, s33, 116736
    v_mfma_f32_16x16x32_bf16 v[12:15], v[94:97], v[180:183], v[12:15]
    s_add_u32 s34, s34, 36864
    s_cmp_ge_u32 s34, 147456
    s_cselect_b32 s38, 147456, 0
    v_mfma_f32_16x16x32_bf16 v[16:19], v[96:99], v[184:187], v[16:19]
    s_sub_u32 s34, s34, s38
    s_cmp_ge_i32 s32, 63
    s_cselect_b32 s18, 0xffff, s18
    v_mfma_f32_16x16x32_bf16 v[20:23], v[94:97], v[184:187], v[20:23]
    buffer_load_dwordx4 v[188:191], v1, s[4:7], s41 offen offset:0 sc1
    buffer_load_dwordx4 v[192:195], v1, s[4:7], s41 offen offset:1024 sc1
    s_add_u32 s41, s41, 36864
    s_cmp_lt_i32 s31, 63
    s_cbranch_scc1 Lred_top0
    s_branch L_exit
Lred_v12:
    s_cmp_lt_i32 s31, 63
    s_cbranch_scc1 Lred_more
    ds_write_b64 v206, v[76:77]
    v_cvt_pk_bf16_f32 v78, v36, v37
    v_cvt_pk_bf16_f32 v79, v38, v39
    ds_write_b64 v207, v[78:79]
    ds_read_b128 v[196:199], v222 offset:0
    ds_read_b128 v[200:203], v222 offset:1024
    v_mfma_f32_16x16x32_bf16 v[86:89], v[72:75], v[72:75], 0
    v_mfma_f32_16x16x32_bf16 v[82:85], v[90:93], v[72:75], 0
    v_mfma_f32_16x16x32_bf16 v[86:89], v[76:79], v[76:79], v[86:89]
    v_mfma_f32_16x16x32_bf16 v[82:85], v[90:93], v[76:79], v[82:85]
    s_waitcnt lgkmcnt(1)
    buffer_store_dwordx4 v[196:199], v208, s[24:27], s54 offen sc1
    s_waitcnt lgkmcnt(0)
    buffer_store_dwordx4 v[200:203], v209, s[24:27], s54 offen sc1
    s_nop 2
    v_cndmask_b32 v86, v86, v87, s[44:45]
    v_cndmask_b32 v88, v88, v89, s[44:45]
    v_cndmask_b32 v83, v86, v88, s[46:47]
    buffer_store_dwordx2 v[82:83], v7, s[12:15], s36 offen offset:0 sc1
    s_mov_b32 s22, s14
    s_add_u32 s36, s36, 34816
    s_sub_u32 s42, s42, 32768
    s_cmp_lt_i32 s31, 31
    s_cselect_b32 s14, s6, 0
    s_cselect_b32 s54, s36, s42
    s_cmp_lt_i32 s31, 31
    s_cselect_b64 s[24:25], s[4:5], s[80:81]
    s_cselect_b32 s26, s6, 0x400000
    s_cmp_lt_i32 s31, 31
    s_cselect_b64 s[48:49], 0, -1
    v_cndmask_b32 v204, v210, v216, s[48:49]
    v_cndmask_b32 v205, v211, v217, s[48:49]
    v_cndmask_b32 v206, v212, v218, s[48:49]
    v_cndmask_b32 v207, v213, v219, s[48:49]
    v_cndmask_b32 v208, v214, v220, s[48:49]
    v_cndmask_b32 v209, v215, v221, s[48:49]
    s_add_u32 s35, s35, 36864
    s_cmp_eq_u32 s35, 147456
    s_cselect_b32 s35, 0, s35
    s_branch L_exit
Lred_more:
    v_mfma_f32_16x16x32_bf16 v[16:19], a[56:59], v[52:55], v[16:19]
    buffer_load_dword v5, v4, s[4:7], s16 offen sc1
    v_mfma_f32_16x16x32_bf16 v[16:19], a[40:43], v[48:51], v[16:19]
    ds_write_b64 v206, v[76:77]
    v_mfma_f32_16x16x32_bf16 v[12:15], a[36:39], v[48:51], v[12:15]
    ds_read_b128 v[68:71], v2 offset:7168
    v_cvt_pk_bf16_f32 v78, v36, v37
    v_mfma_f32_16x16x32_bf16 v[12:15], a[52:55], v[52:55], v[12:15]
    v_cvt_pk_bf16_f32 v79, v38, v39
    v_mfma_f32_16x16x32_bf16 v[8:11], a[48:51], v[52:55], v[8:11]
    ds_write_b64 v207, v[78:79]
    v_mfma_f32_16x16x32_bf16 v[8:11], a[32:35], v[48:51], v[8:11]
    s_waitcnt lgkmcnt(5)
    ds_read_b128 v[196:199], v222 offset:0
    v_mfma_f32_16x16x32_bf16 v[8:11], a[64:67], v[56:59], v[8:11]
    ds_read_b128 v[40:43], v2 offset:8192
    v_mfma_f32_16x16x32_bf16 v[8:11], a[80:83], v[60:63], v[8:11]
    ds_read_b128 v[200:203], v222 offset:1024
    v_mfma_f32_16x16x32_bf16 v[86:89], v[72:75], v[72:75], 0
    buffer_load_dwordx4 v[188:191], v1, s[4:7], s41 offen offset:0 sc1
    v_mfma_f32_16x16x32_bf16 v[82:85], v[90:93], v[72:75], 0
    v_mfma_f32_16x16x32_bf16 v[86:89], v[76:79], v[76:79], v[86:89]
    v_mfma_f32_16x16x32_bf16 v[82:85], v[90:93], v[76:79], v[82:85]
    s_waitcnt lgkmcnt(2)
    v_mfma_f32_16x16x32_bf16 v[12:15], a[84:87], v[60:63], v[12:15]
    buffer_store_dwordx4 v[196:199], v208, s[24:27], s54 offen sc1
    s_waitcnt lgkmcnt(0)
    v_mfma_f32_16x16x32_bf16 v[12:15], a[68:71], v[56:59], v[12:15]
    v_mfma_f32_16x16x32_bf16 v[16:19], a[72:75], v[56:59], v[16:19]
    ds_read_b128 v[44:47], v2 offset:9216
    v_mfma_f32_16x16x32_bf16 v[16:19], a[88:91], v[60:63], v[16:19]
    v_mfma_f32_16x16x32_bf16 v[20:23], a[92:95], v[60:63], v[20:23]
    buffer_store_dwordx4 v[200:203], v209, s[24:27], s54 offen sc1
    v_cndmask_b32 v86, v86, v87, s[44:45]
    v_mfma_f32_16x16x32_bf16 v[20:23], a[76:79], v[56:59], v[20:23]
    v_cndmask_b32 v88, v88, v89, s[44:45]
    v_cndmask_b32 v83, v86, v88, s[46:47]
    v_mfma_f32_16x16x32_bf16 v[20:23], a[108:111], v[64:67], v[20:23]
    ds_read_b128 v[48:51], v2 offset:10240
    s_waitcnt vmcnt(3)
    v_mfma_f32_16x16x32_bf16 v[20:23], a[124:127], v[68:71], v[20:23]
    buffer_store_dwordx2 v[82:83], v7, s[12:15], s36 offen offset:0 sc1
    v_cmp_gt_i32 vcc, s32, v5
    v_mfma_f32_16x16x32_bf16 v[16:19], a[120:123], v[68:71], v[16:19]
    s_mov_b32 s22, s14
    s_add_u32 s36, s36, 34816
    s_sub_u32 s42, s42, 32768
    v_mfma_f32_16x16x32_bf16 v[16:19], a[104:107], v[64:67], v[16:19]
    s_and_b64 vcc, vcc, s[18:19]
    s_cbranch_scc1 Lred_v13
    v_mfma_f32_16x16x32_bf16 v[12:15], a[100:103], v[64:67], v[12:15]
    ds_read_b128 v[52:55], v2 offset:11264
    s_add_u32 s16, s16, 8192
    v_mfma_f32_16x16x32_bf16 v[12:15], a[116:119], v[68:71], v[12:15]
    buffer_load_dword v5, v4, s[4:7], s16 offen sc1
    v_mfma_f32_16x16x32_bf16 v[8:11], a[112:115], v[68:71], v[8:11]
    s_cmp_lt_i32 s31, 31
    s_cselect_b32 s14, s6, 0
    s_cselect_b32 s54, s36, s42
    v_mfma_f32_16x16x32_bf16 v[8:11], a[96:99], v[64:67], v[8:11]
    s_waitcnt lgkmcnt(2)
    v_mfma_f32_16x16x32_bf16 v[8:11], a[128:131], v[40:43], v[8:11]
    ds_read_b128 v[56:59], v2 offset:12288
    v_mfma_f32_16x16x32_bf16 v[8:11], a[144:147], v[44:47], v[8:11]
    buffer_load_dwordx4 v[116:119], v1, s[4:7], s40 offen offset:0 sc1
    v_mfma_f32_16x16x32_bf16 v[12:15], a[148:151], v[44:47], v[12:15]
    s_cmp_lt_i32 s31, 31
    s_cselect_b64 s[24:25], s[4:5], s[80:81]
    s_cselect_b32 s26, s6, 0x400000
    v_mfma_f32_16x16x32_bf16 v[12:15], a[132:135], v[40:43], v[12:15]
    s_cmp_lt_i32 s31, 31
    s_cselect_b64 s[48:49], 0, -1
    v_cndmask_b32 v204, v210, v216, s[48:49]
    v_mfma_f32_16x16x32_bf16 v[16:19], a[136:139], v[40:43], v[16:19]
    ds_read_b128 v[60:63], v2 offset:13312
    v_cndmask_b32 v205, v211, v217, s[48:49]
    v_mfma_f32_16x16x32_bf16 v[16:19], a[152:155], v[44:47], v[16:19]
    buffer_load_dwordx4 v[120:123], v1, s[4:7], s40 offen offset:1024 sc1
    v_mfma_f32_16x16x32_bf16 v[20:23], a[156:159], v[44:47], v[20:23]
    s_add_u32 s37, s40, 32768
    v_cndmask_b32 v206, v212, v218, s[48:49]
    v_cndmask_b32 v207, v213, v219, s[48:49]
    v_mfma_f32_16x16x32_bf16 v[20:23], a[140:143], v[40:43], v[20:23]
    s_waitcnt lgkmcnt(2)
    v_cndmask_b32 v208, v214, v220, s[48:49]
    v_cndmask_b32 v209, v215, v221, s[48:49]
    v_mfma_f32_16x16x32_bf16 v[20:23], a[172:175], v[48:51], v[20:23]
    ds_read_b128 v[64:67], v2 offset:14336
    s_add_u32 s35, s35, 36864
    v_mfma_f32_16x16x32_bf16 v[20:23], a[188:191], v[52:55], v[20:23]
    buffer_load_dwordx4 v[124:127], v1, s[4:7], s37 offen offset:0 sc1
    v_mfma_f32_16x16x32_bf16 v[16:19], a[184:187], v[52:55], v[16:19]
    s_cmp_eq_u32 s35, 147456
    s_cselect_b32 s35, 0, s35
    v_mfma_f32_16x16x32_bf16 v[16:19], a[168:171], v[48:51], v[16:19]
    v_mfma_f32_16x16x32_bf16 v[12:15], a[164:167], v[48:51], v[12:15]
    ds_read_b128 v[68:71], v2 offset:15360
    v_mfma_f32_16x16x32_bf16 v[12:15], a[180:183], v[52:55], v[12:15]
    buffer_load_dwordx4 v[128:131], v1, s[4:7], s37 offen offset:1024 sc1
    v_mfma_f32_16x16x32_bf16 v[8:11], a[176:179], v[52:55], v[8:11]
    s_add_u32 s37, s40, 65536
    v_mfma_f32_16x16x32_bf16 v[8:11], a[160:163], v[48:51], v[8:11]
    s_waitcnt lgkmcnt(2)
    v_mfma_f32_16x16x32_bf16 v[8:11], a[192:195], v[56:59], v[8:11]
    v_mfma_f32_16x16x32_bf16 v[8:11], a[208:211], v[60:63], v[8:11]
    buffer_load_dwordx4 v[132:135], v1, s[4:7], s37 offen offset:0 sc1
    v_mfma_f32_16x16x32_bf16 v[12:15], a[212:215], v[60:63], v[12:15]
    v_mfma_f32_16x16x32_bf16 v[12:15], a[196:199], v[56:59], v[12:15]
    v_mfma_f32_16x16x32_bf16 v[16:19], a[200:203], v[56:59], v[16:19]
    v_mfma_f32_16x16x32_bf16 v[16:19], a[216:219], v[60:63], v[16:19]
    buffer_load_dwordx4 v[136:139], v1, s[4:7], s37 offen offset:1024 sc1
    v_mfma_f32_16x16x32_bf16 v[20:23], a[220:223], v[60:63], v[20:23]
    s_add_u32 s37, s40, 98304
    v_mfma_f32_16x16x32_bf16 v[20:23], a[204:207], v[56:59], v[20:23]
    s_waitcnt lgkmcnt(0)
    v_mfma_f32_16x16x32_bf16 v[20:23], a[236:239], v[64:67], v[20:23]
    v_mfma_f32_16x16x32_bf16 v[20:23], a[252:255], v[68:71], v[20:23]
    buffer_load_dwordx4 v[140:143], v1, s[4:7], s37 offen offset:0 sc1
    v_mfma_f32_16x16x32_bf16 v[16:19], a[248:251], v[68:71], v[16:19]
    v_mfma_f32_16x16x32_bf16 v[16:19], a[232:235], v[64:67], v[16:19]
    v_mfma_f32_16x16x32_bf16 v[12:15], a[228:231], v[64:67], v[12:15]
    v_mfma_f32_16x16x32_bf16 v[12:15], a[244:247], v[68:71], v[12:15]
    buffer_load_dwordx4 v[144:147], v1, s[4:7], s37 offen offset:1024 sc1
    v_mfma_f32_16x16x32_bf16 v[8:11], a[240:243], v[68:71], v[8:11]
    s_add_u32 m0, s34, 0
    v_mfma_f32_16x16x32_bf16 v[8:11], a[224:227], v[64:67], v[8:11]
    v_mfma_f32_16x16x32_bf16 v[8:11], v[96:99], v[180:183], v[8:11]
    v_mfma_f32_16x16x32_bf16 v[12:15], v[94:97], v[180:183], v[12:15]
    buffer_load_dwordx4 v1, s[8:11], s33 offen offset:0 sc1 lds
    v_mfma_f32_16x16x32_bf16 v[16:19], v[96:99], v[184:187], v[16:19]
    v_mfma_f32_16x16x32_bf16 v[20:23], v[94:97], v[184:187], v[20:23]
    buffer_load_dwordx4 v1, s[8:11], s33 offen offset:1024 sc1 lds
    buffer_load_dwordx4 v1, s[8:11], s33 offen offset:2048 sc1 lds
    buffer_load_dwordx4 v1, s[8:11], s33 offen offset:3072 sc1 lds
    s_add_u32 s32, s32, 1
    s_add_u32 s40, s40, 131072
    s_add_u32 s33, s33, 116736
    s_add_u32 s34, s34, 36864
    s_cmp_ge_u32 s34, 147456
    s_cselect_b32 s38, 147456, 0
    s_sub_u32 s34, s34, s38
    s_cmp_ge_i32 s32, 63
    s_cselect_b32 s18, 0xffff, s18
    buffer_load_dwordx4 v[192:195], v1, s[4:7], s41 offen offset:1024 sc1
    s_add_u32 s41, s41, 36864
    s_cmp_lt_i32 s31, 63
    s_cbranch_scc1 Lred_top0
    s_branch L_exit
Lred_v13:
    v_mfma_f32_16x16x32_bf16 v[12:15], a[100:103], v[64:67], v[12:15]
    ds_read_b128 v[52:55], v2 offset:11264
    v_mfma_f32_16x16x32_bf16 v[12:15], a[116:119], v[68:71], v[12:15]
    buffer_load_dword v5, v4, s[4:7], s16 offen sc1
    v_mfma_f32_16x16x32_bf16 v[8:11], a[112:115], v[68:71], v[8:11]
    s_cmp_lt_i32 s31, 31
    s_cselect_b32 s14, s6, 0
    s_cselect_b32 s54, s36, s42
    v_mfma_f32_16x16x32_bf16 v[8:11], a[96:99], v[64:67], v[8:11]
    s_waitcnt lgkmcnt(2)
    v_mfma_f32_16x16x32_bf16 v[8:11], a[128:131], v[40:43], v[8:11]
    ds_read_b128 v[56:59], v2 offset:12288
    v_mfma_f32_16x16x32_bf16 v[8:11], a[144:147], v[44:47], v[8:11]
    s_cmp_lt_i32 s31, 31
    s_cselect_b64 s[24:25], s[4:5], s[80:81]
    s_cselect_b32 s26, s6, 0x400000
    v_mfma_f32_16x16x32_bf16 v[12:15], a[148:151], v[44:47], v[12:15]
    s_cmp_lt_i32 s31, 31
    s_cselect_b64 s[48:49], 0, -1
    v_cndmask_b32 v204, v210, v216, s[48:49]
    v_mfma_f32_16x16x32_bf16 v[12:15], a[132:135], v[40:43], v[12:15]
    buffer_load_dwordx4 v[192:195], v1, s[4:7], s41 offen offset:1024 sc1
    v_mfma_f32_16x16x32_bf16 v[16:19], a[136:139], v[40:43], v[16:19]
    ds_read_b128 v[60:63], v2 offset:13312
    v_cndmask_b32 v205, v211, v217, s[48:49]
    v_mfma_f32_16x16x32_bf16 v[16:19], a[152:155], v[44:47], v[16:19]
    s_add_u32 s41, s41, 36864
    v_cndmask_b32 v206, v212, v218, s[48:49]
    v_cndmask_b32 v207, v213, v219, s[48:49]
    v_mfma_f32_16x16x32_bf16 v[20:23], a[156:159], v[44:47], v[20:23]
    v_cndmask_b32 v208, v214, v220, s[48:49]
    v_cndmask_b32 v209, v215, v221, s[48:49]
    v_mfma_f32_16x16x32_bf16 v[20:23], a[140:143], v[40:43], v[20:23]
    s_waitcnt lgkmcnt(2)
    s_add_u32 s35, s35, 36864
    v_mfma_f32_16x16x32_bf16 v[20:23], a[172:175], v[48:51], v[20:23]
    ds_read_b128 v[64:67], v2 offset:14336
    v_mfma_f32_16x16x32_bf16 v[20:23], a[188:191], v[52:55], v[20:23]
    s_cmp_eq_u32 s35, 147456
    s_cselect_b32 s35, 0, s35
    v_mfma_f32_16x16x32_bf16 v[16:19], a[184:187], v[52:55], v[16:19]
    v_mfma_f32_16x16x32_bf16 v[16:19], a[168:171], v[48:51], v[16:19]
    v_mfma_f32_16x16x32_bf16 v[12:15], a[164:167], v[48:51], v[12:15]
    ds_read_b128 v[68:71], v2 offset:15360
    v_mfma_f32_16x16x32_bf16 v[12:15], a[180:183], v[52:55], v[12:15]
    v_mfma_f32_16x16x32_bf16 v[8:11], a[176:179], v[52:55], v[8:11]
    v_mfma_f32_16x16x32_bf16 v[8:11], a[160:163], v[48:51], v[8:11]
    s_waitcnt vmcnt(1) lgkmcnt(2)
    v_cmp_gt_i32 vcc, s32, v5
    v_mfma_f32_16x16x32_bf16 v[8:11], a[192:195], v[56:59], v[8:11]
    v_mfma_f32_16x16x32_bf16 v[8:11], a[208:211], v[60:63], v[8:11]
    s_and_b64 vcc, vcc, s[18:19]
    s_cbranch_scc1 Lred_v14
    v_mfma_f32_16x16x32_bf16 v[12:15], a[212:215], v[60:63], v[12:15]
    s_add_u32 s16, s16, 8192
    v_mfma_f32_16x16x32_bf16 v[12:15], a[196:199], v[56:59], v[12:15]
    buffer_load_dword v5, v4, s[4:7], s16 offen sc1
    v_mfma_f32_16x16x32_bf16 v[16:19], a[200:203], v[56:59], v[16:19]
    v_mfma_f32_16x16x32_bf16 v[16:19], a[216:219], v[60:63], v[16:19]
    v_mfma_f32_16x16x32_bf16 v[20:23], a[220:223], v[60:63], v[20:23]
    v_mfma_f32_16x16x32_bf16 v[20:23], a[204:207], v[56:59], v[20:23]
    s_waitcnt lgkmcnt(0)
    buffer_load_dwordx4 v[116:119], v1, s[4:7], s40 offen offset:0 sc1
    v_mfma_f32_16x16x32_bf16 v[20:23], a[236:239], v[64:67], v[20:23]
    v_mfma_f32_16x16x32_bf16 v[20:23], a[252:255], v[68:71], v[20:23]
    v_mfma_f32_16x16x32_bf16 v[16:19], a[248:251], v[68:71], v[16:19]
    v_mfma_f32_16x16x32_bf16 v[16:19], a[232:235], v[64:67], v[16:19]
    buffer_load_dwordx4 v[120:123], v1, s[4:7], s40 offen offset:1024 sc1
    v_mfma_f32_16x16x32_bf16 v[12:15], a[228:231], v[64:67], v[12:15]
    s_add_u32 s37, s40, 32768
    v_mfma_f32_16x16x32_bf16 v[12:15], a[244:247], v[68:71], v[12:15]
    v_mfma_f32_16x16x32_bf16 v[8:11], a[240:243], v[68:71], v[8:11]
    v_mfma_f32_16x16x32_bf16 v[8:11], a[224:227], v[64:67], v[8:11]
    buffer_load_dwordx4 v[124:127], v1, s[4:7], s37 offen offset:0 sc1
    v_mfma_f32_16x16x32_bf16 v[8:11], v[96:99], v[180:183], v[8:11]
    v_mfma_f32_16x16x32_bf16 v[12:15], v[94:97], v[180:183], v[12:15]
    v_mfma_f32_16x16x32_bf16 v[16:19], v[96:99], v[184:187], v[16:19]
    v_mfma_f32_16x16x32_bf16 v[20:23], v[94:97], v[184:187], v[20:23]
    buffer_load_dwordx4 v[128:131], v1, s[4:7], s37 offen offset:1024 sc1
    s_add_u32 s37, s40, 65536
    buffer_load_dwordx4 v[132:135], v1, s[4:7], s37 offen offset:0 sc1
    buffer_load_dwordx4 v[136:139], v1, s[4:7], s37 offen offset:1024 sc1
    s_add_u32 s37, s40, 98304
    buffer_load_dwordx4 v[140:143], v1, s[4:7], s37 offen offset:0 sc1
    buffer_load_dwordx4 v[144:147], v1, s[4:7], s37 offen offset:1024 sc1
    s_add_u32 m0, s34, 0
    s_nop 0
    buffer_load_dwordx4 v1, s[8:11], s33 offen offset:0 sc1 lds
    buffer_load_dwordx4 v1, s[8:11], s33 offen offset:1024 sc1 lds
    buffer_load_dwordx4 v1, s[8:11], s33 offen offset:2048 sc1 lds
    buffer_load_dwordx4 v1, s[8:11], s33 offen offset:3072 sc1 lds
    s_add_u32 s32, s32, 1
    s_add_u32 s40, s40, 131072
    s_add_u32 s33, s33, 116736
    s_add_u32 s34, s34, 36864
    s_cmp_ge_u32 s34, 147456
    s_cselect_b32 s38, 147456, 0
    s_sub_u32 s34, s34, s38
    s_cmp_ge_i32 s32, 63
    s_cselect_b32 s18, 0xffff, s18
    s_cmp_lt_i32 s31, 63
    s_cbranch_scc1 Lred_top0
    s_branch L_exit
Lred_v14:
    v_mfma_f32_16x16x32_bf16 v[12:15], a[212:215], v[60:63], v[12:15]
    buffer_load_dword v5, v4, s[4:7], s16 offen sc1
    v_mfma_f32_16x16x32_bf16 v[12:15], a[196:199], v[56:59], v[12:15]
    v_mfma_f32_16x16x32_bf16 v[16:19], a[200:203], v[56:59], v[16:19]
    v_mfma_f32_16x16x32_bf16 v[16:19], a[216:219], v[60:63], v[16:19]
    v_mfma_f32_16x16x32_bf16 v[20:23], a[220:223], v[60:63], v[20:23]
    v_mfma_f32_16x16x32_bf16 v[20:23], a[204:207], v[56:59], v[20:23]
    s_waitcnt lgkmcnt(0)
    v_mfma_f32_16x16x32_bf16 v[20:23], a[236:239], v[64:67], v[20:23]
    v_mfma_f32_16x16x32_bf16 v[20:23], a[252:255], v[68:71], v[20:23]
    v_mfma_f32_16x16x32_bf16 v[16:19], a[248:251], v[68:71], v[16:19]
    v_mfma_f32_16x16x32_bf16 v[16:19], a[232:235], v[64:67], v[16:19]
    v_mfma_f32_16x16x32_bf16 v[12:15], a[228:231], v[64:67], v[12:15]
    v_mfma_f32_16x16x32_bf16 v[12:15], a[244:247], v[68:71], v[12:15]
    v_mfma_f32_16x16x32_bf16 v[8:11], a[240:243], v[68:71], v[8:11]
    v_mfma_f32_16x16x32_bf16 v[8:11], a[224:227], v[64:67], v[8:11]
    v_mfma_f32_16x16x32_bf16 v[8:11], v[96:99], v[180:183], v[8:11]
    v_mfma_f32_16x16x32_bf16 v[12:15], v[94:97], v[180:183], v[12:15]
    v_mfma_f32_16x16x32_bf16 v[16:19], v[96:99], v[184:187], v[16:19]
    v_mfma_f32_16x16x32_bf16 v[20:23], v[94:97], v[184:187], v[20:23]
    s_waitcnt vmcnt(0)
    v_cmp_gt_i32 vcc, s32, v5
    s_sub_u32 s43, s43, 1
    s_cmp_lt_i32 s43, 0
    s_cbranch_scc1 Lred_rdy1x
    s_and_b64 vcc, vcc, s[18:19]
    s_cbranch_scc0 Lred_rdy1x
Lred_spin1x:
    buffer_load_dword v5, v4, s[4:7], s16 offen sc1
    s_waitcnt vmcnt(0)
    v_cmp_gt_i32 vcc, s32, v5
    s_sub_u32 s43, s43, 1
    s_cmp_lt_i32 s43, 0
    s_cbranch_scc1 Lred_rdy1x
    s_and_b64 vcc, vcc, s[18:19]
    s_cbranch_scc0 Lred_rdy1x
    s_sleep 8
    s_branch Lred_spin1x
Lred_rdy1x:
    s_add_u32 s16, s16, 8192
    buffer_load_dword v5, v4, s[4:7], s16 offen sc1
    buffer_load_dwordx4 v[116:119], v1, s[4:7], s40 offen offset:0 sc1
    buffer_load_dwordx4 v[120:123], v1, s[4:7], s40 offen offset:1024 sc1
    s_add_u32 s37, s40, 32768
    buffer_load_dwordx4 v[124:127], v1, s[4:7], s37 offen offset:0 sc1
    buffer_load_dwordx4 v[128:131], v1, s[4:7], s37 offen offset:1024 sc1
    s_add_u32 s37, s40, 65536
    buffer_load_dwordx4 v[132:135], v1, s[4:7], s37 offen offset:0 sc1
    buffer_load_dwordx4 v[136:139], v1, s[4:7], s37 offen offset:1024 sc1
    s_add_u32 s37, s40, 98304
    buffer_load_dwordx4 v[140:143], v1, s[4:7], s37 offen offset:0 sc1
    buffer_load_dwordx4 v[144:147], v1, s[4:7], s37 offen offset:1024 sc1
    s_add_u32 m0, s34, 0
    s_nop 0
    buffer_load_dwordx4 v1, s[8:11], s33 offen offset:0 sc1 lds
    buffer_load_dwordx4 v1, s[8:11], s33 offen offset:1024 sc1 lds
    buffer_load_dwordx4 v1, s[8:11], s33 offen offset:2048 sc1 lds
    buffer_load_dwordx4 v1, s[8:11], s33 offen offset:3072 sc1 lds
    s_add_u32 s32, s32, 1
    s_add_u32 s40, s40, 131072
    s_add_u32 s33, s33, 116736
    s_add_u32 s34, s34, 36864
    s_cmp_ge_u32 s34, 147456
    s_cselect_b32 s38, 147456, 0
    s_sub_u32 s34, s34, s38
    s_cmp_ge_i32 s32, 63
    s_cselect_b32 s18, 0xffff, s18
    s_branch Lred_top0
Lqkv_start:
    s_mov_b32 s12, s66
    s_mov_b32 s13, s67
    s_mov_b32 s14, 0x600000
    s_mov_b32 s15, 0x00020000
    v_lshrrev_b32 v24, 3, v0
    v_mul_u32_u24 v24, 6144, v24
    v_bfe_u32 v25, v0, 4, 2
    v_lshlrev_b32 v25, 1, v25
    v_and_b32 v26, 7, v0
    v_xor_b32 v25, v25, v26
    v_lshl_add_u32 v40, v25, 4, v24
    v_add_u32 v41, 48128, v40
    s_mul_i32 s86, s29, 0x80
    s_mul_i32 s37, s30, 98304
    s_add_u32 s86, s86, s37
    s_lshl_b32 s87, s30, 11
    s_add_u32 m0, s87, 73728
    s_add_u32 s37, s86, 0
    buffer_load_dwordx4 v40, s[12:15], s37 offen offset:0 lds
    buffer_load_dwordx4 v41, s[12:15], s37 offen offset:1024 lds
    s_add_u32 m0, s87, 81920
    s_add_u32 s37, s86, 2048
    buffer_load_dwordx4 v40, s[12:15], s37 offen offset:0 lds
    buffer_load_dwordx4 v41, s[12:15], s37 offen offset:1024 lds
    s_add_u32 m0, s87, 90112
    s_add_u32 s37, s86, 4096
    buffer_load_dwordx4 v40, s[12:15], s37 offen offset:0 lds
    buffer_load_dwordx4 v41, s[12:15], s37 offen offset:1024 lds
    s_add_u32 m0, s87, 98304
    s_add_u32 s37, s86, 393216
    buffer_load_dwordx4 v40, s[12:15], s37 offen offset:0 lds
    buffer_load_dwordx4 v41, s[12:15], s37 offen offset:1024 lds
    s_add_u32 m0, s87, 106496
    s_add_u32 s37, s86, 395264
    buffer_load_dwordx4 v40, s[12:15], s37 offen offset:0 lds
    buffer_load_dwordx4 v41, s[12:15], s37 offen offset:1024 lds
    s_add_u32 m0, s87, 114688
    s_add_u32 s37, s86, 397312
    buffer_load_dwordx4 v40, s[12:15], s37 offen offset:0 lds
    buffer_load_dwordx4 v41, s[12:15], s37 offen offset:1024 lds
    v_bfe_u32 v24, v0, 3, 2
    v_and_b32 v25, 3, v0
    v_lshlrev_b32 v25, 3, v25
    v_lshrrev_b32 v26, 2, v0
    v_lshl_add_u32 v26, v26, 7, v25
    v_lshrrev_b32 v27, 5, v0
    v_lshl_add_u32 v27, v27, 10, v26
    s_mov_b32 s37, 0
    s_mov_b32 s38, s30
    s_lshl_b32 s37, s37, 13
    v_xor_b32 v28, s38, v24
    v_lshl_add_u32 v28, v28, 5, s37
    v_add_u32 v42, v28, v26
    v_add_u32 v46, v28, v27
    s_mov_b32 s37, 1
    s_mov_b32 s38, s30
    s_lshl_b32 s37, s37, 13
    v_xor_b32 v28, s38, v24
    v_lshl_add_u32 v28, v28, 5, s37
    v_add_u32 v43, v28, v26
    v_add_u32 v47, v28, v27
    s_mov_b32 s37, 2
    s_mov_b32 s38, s30
    s_lshl_b32 s37, s37, 13
    v_xor_b32 v28, s38, v24
    v_lshl_add_u32 v28, v28, 5, s37
    v_add_u32 v44, v28, v26
    v_add_u32 v48, v28, v27
    v_mov_b32 v28, 0x3f803f80
    v_mov_b32 v29, 0x3f803f80
    v_mov_b32 v30, 0x3f803f80
    v_mov_b32 v31, 0x3f803f80
    s_mul_i32 s37, s28, 0x80000
    s_add_u32 s37, s37, 0x6001e00
    v_min_u32 v4, 15, v0
    v_lshl_add_u32 v4, v4, 5, s37
    s_mul_i32 s37, s28, 0x80000
    s_mul_i32 s53, s29, 0x80
    s_add_u32 s37, s37, s53
    s_mul_i32 s53, s30, 0x20
    s_add_u32 s37, s37, s53
    s_add_u32 s37, s37, 0x5f80000
    v_mov_b32 v8, s37
    s_cmp_eq_u32 s28, 0
    s_cselect_b32 s37, 64, 16
    v_cmp_le_u32 vcc, s37, v0
    s_nop 1
    v_cndmask_b32 v4, v4, v8, vcc
    s_mul_i32 s33, s28, 0x220000
    s_lshr_b32 s38, s30, 1
    s_mul_i32 s36, s28, 0x200000
    s_mul_i32 s53, s29, 0x800
    s_add_u32 s36, s36, s53
    s_mul_i32 s53, s38, 0x400
    s_add_u32 s36, s36, s53
    s_add_u32 s36, s36, 0x9f0000
    s_and_b32 s38, s30, 1
    v_lshrrev_b32 v8, 5, v0
    v_cmp_eq_u32 vcc, s38, v8
    v_add_u32 v8, 0, v1
    v_mov_b32 v7, 0x40000000
    v_cndmask_b32 v7, v7, v8, vcc
    s_mul_i32 s40, s28, 0x10000
    s_mul_i32 s53, s29, 0x1000
    s_add_u32 s40, s40, s53
    s_mul_i32 s53, s30, 0x400
    s_add_u32 s40, s40, s53
    s_add_u32 s40, s40, 0x1c00000
    s_sub_u32 s41, s40, 327680
    s_mov_b32 s24, s84
    s_mov_b32 s25, s85
    s_mov_b32 s26, 0x6200000
    s_mov_b32 s27, 0x00020000
    s_cmp_eq_u32 s28, 0
    s_cselect_b32 s26, 0, s26
    s_cselect_b32 s42, 0xf149f2ca, 0
    v_mov_b32 v86, 0
    v_mov_b32 v87, 0
    v_mov_b32 v90, 0
    v_mov_b32 v91, 0
    s_lshl_b32 s37, s30, 9
    s_add_u32 s38, s37, 147456
    v_lshl_add_u32 v36, v0, 3, s38
    v_xor_b32 v37, 512, v36
    v_add_u32 v39, 4096, v36
    s_add_u32 s38, s37, 151552
    v_and_b32 v8, 15, v0
    v_lshl_add_u32 v8, v8, 5, s38
    v_lshrrev_b32 v9, 4, v0
    v_lshl_add_u32 v38, v9, 3, v8
    s_mov_b32 s44, 0xaaaaaaaa
    s_mov_b32 s45, 0xaaaaaaaa
    s_mov_b32 s48, 0xfff0ffff
    s_mov_b32 s49, 0xf000ff00
    s_mov_b32 s50, 0xffc0fffc
    s_mov_b32 s51, 0xc000fc00
    s_mov_b32 s52, 0x3e8293ee
    v_mov_b32 v10, 0x0c0c0c0c
    v_mov_b32 v8, 0xc0c0100
    v_mov_b32 v9, 0x1000c0c
    v_cndmask_b32 v8, v8, v9, s[44:45]
    v_cndmask_b32 v102, v8, v10, s[48:49]
    v_cndmask_b32 v104, v10, v8, s[48:49]
    v_mov_b32 v8, 0xc0c0302
    v_mov_b32 v9, 0x3020c0c
    v_cndmask_b32 v8, v8, v9, s[44:45]
    v_cndmask_b32 v103, v8, v10, s[50:51]
    v_cndmask_b32 v105, v10, v8, s[50:51]
    s_mov_b32 s31, -1
    s_mov_b32 s35, 0
    s_mov_b32 s16, 0
    v_mov_b32 v5, 0
    s_mul_i32 s17, s28, 0x80000
    s_mul_i32 s53, s29, 0x80
    s_add_u32 s17, s17, s53
    s_mul_i32 s53, s30, 0x20
    s_add_u32 s17, s17, s53
    s_add_u32 s17, s17, 0x5ffa000
    v_cmp_eq_u32 vcc, 0, v0
    v_mov_b32 v21, 0x40000000
    s_nop 0
    v_cndmask_b32 v21, v21, v0, vcc
    v_mov_b32 v2, v1
    s_mul_i32 s34, s30, 9216
    s_min_u32 s34, s34, 25600
    s_add_u32 s33, s33, s34
    v_lshlrev_b32 v20, 3, v0
    s_mov_b64 s[18:19], 0x1ffff
    v_mov_b32 v8, 0x40000000
    v_cndmask_b32 v4, v8, v4, s[18:19]
    v_add_u32 v12, 73728, v42
    v_add_u32 v13, 73728, v43
    v_add_u32 v14, 73728, v44
    s_waitcnt vmcnt(6) lgkmcnt(0)
    s_barrier
    s_add_u32 m0, s87, 122880
    s_add_u32 s37, s86, 786432
    buffer_load_dwordx4 v40, s[12:15], s37 offen offset:0 lds
    ds_read_b64_tr_b16 a[0:1], v12 offset:0
    ds_read_b64_tr_b16 a[2:3], v12 offset:2048
    ds_read_b64_tr_b16 a[4:5], v13 offset:0
    buffer_load_dwordx4 v41, s[12:15], s37 offen offset:1024 lds
    ds_read_b64_tr_b16 a[6:7], v13 offset:2048
    ds_read_b64_tr_b16 a[8:9], v14 offset:0
    ds_read_b64_tr_b16 a[10:11], v14 offset:2048
    s_add_u32 m0, s87, 131072
    s_add_u32 s37, s86, 788480
    buffer_load_dwordx4 v40, s[12:15], s37 offen offset:0 lds
    ds_read_b64_tr_b16 a[12:13], v12 offset:4096
    ds_read_b64_tr_b16 a[14:15], v12 offset:6144
    ds_read_b64_tr_b16 a[16:17], v13 offset:4096
    buffer_load_dwordx4 v41, s[12:15], s37 offen offset:1024 lds
    ds_read_b64_tr_b16 a[18:19], v13 offset:6144
    ds_read_b64_tr_b16 a[20:21], v14 offset:4096
    ds_read_b64_tr_b16 a[22:23], v14 offset:6144
    s_add_u32 m0, s87, 139264
    s_add_u32 s37, s86, 790528
    buffer_load_dwordx4 v40, s[12:15], s37 offen offset:0 lds
    v_add_u32 v16, 98304, v42
    v_add_u32 v17, 98304, v43
    v_add_u32 v18, 98304, v44
    buffer_load_dwordx4 v41, s[12:15], s37 offen offset:1024 lds
    s_waitcnt vmcnt(6) lgkmcnt(0)
    s_barrier
    s_add_u32 m0, s87, 73728
    s_add_u32 s37, s86, 1179648
    buffer_load_dwordx4 v40, s[12:15], s37 offen offset:0 lds
    ds_read_b64_tr_b16 a[24:25], v16 offset:0
    ds_read_b64_tr_b16 a[26:27], v16 offset:2048
    ds_read_b64_tr_b16 a[28:29], v17 offset:0
    ds_read_b64_tr_b16 a[30:31], v17 offset:2048
    buffer_load_dwordx4 v41, s[12:15], s37 offen offset:1024 lds
    ds_read_b64_tr_b16 a[32:33], v18 offset:0
    ds_read_b64_tr_b16 a[34:35], v18 offset:2048
    ds_read_b64_tr_b16 a[36:37], v16 offset:4096
    ds_read_b64_tr_b16 a[38:39], v16 offset:6144
    s_add_u32 m0, s87, 81920
    s_add_u32 s37, s86, 1181696
    buffer_load_dwordx4 v40, s[12:15], s37 offen offset:0 lds
    ds_read_b64_tr_b16 a[40:41], v17 offset:4096
    ds_read_b64_tr_b16 a[42:43], v17 offset:6144
    ds_read_b64_tr_b16 a[44:45], v18 offset:4096
    ds_read_b64_tr_b16 a[46:47], v18 offset:6144
    buffer_load_dwordx4 v41, s[12:15], s37 offen offset:1024 lds
    v_mfma_f32_16x16x32_bf16 v[56:59], a[0:3], v[28:31], 0
    v_mfma_f32_16x16x32_bf16 v[60:63], a[4:7], v[28:31], 0
    v_mfma_f32_16x16x32_bf16 v[64:67], a[8:11], v[28:31], 0
    v_mfma_f32_16x16x32_bf16 v[56:59], a[12:15], v[28:31], v[56:59]
    s_add_u32 m0, s87, 90112
    s_add_u32 s37, s86, 1183744
    buffer_load_dwordx4 v40, s[12:15], s37 offen offset:0 lds
    v_mfma_f32_16x16x32_bf16 v[60:63], a[16:19], v[28:31], v[60:63]
    v_mfma_f32_16x16x32_bf16 v[64:67], a[20:23], v[28:31], v[64:67]
    v_add_u32 v12, 122880, v42
    v_add_u32 v13, 122880, v43
    buffer_load_dwordx4 v41, s[12:15], s37 offen offset:1024 lds
    v_add_u32 v14, 122880, v44
    s_waitcnt vmcnt(6) lgkmcnt(0)
    s_barrier
    s_add_u32 m0, s87, 98304
    s_add_u32 s37, s86, 1572864
    buffer_load_dwordx4 v40, s[12:15], s37 offen offset:0 lds
    ds_read_b64_tr_b16 a[48:49], v12 offset:0
    ds_read_b64_tr_b16 a[50:51], v12 offset:2048
    ds_read_b64_tr_b16 a[52:53], v13 offset:0
    ds_read_b64_tr_b16 a[54:55], v13 offset:2048
    buffer_load_dwordx4 v41, s[12:15], s37 offen offset:1024 lds
    ds_read_b64_tr_b16 a[56:57], v14 offset:0
    ds_read_b64_tr_b16 a[58:59], v14 offset:2048
    ds_read_b64_tr_b16 a[60:61], v12 offset:4096
    ds_read_b64_tr_b16 a[62:63], v12 offset:6144
    s_add_u32 m0, s87, 106496
    s_add_u32 s37, s86, 1574912
    buffer_load_dwordx4 v40, s[12:15], s37 offen offset:0 lds
    ds_read_b64_tr_b16 a[64:65], v13 offset:4096
    ds_read_b64_tr_b16 a[66:67], v13 offset:6144
    ds_read_b64_tr_b16 a[68:69], v14 offset:4096
    ds_read_b64_tr_b16 a[70:71], v14 offset:6144
    buffer_load_dwordx4 v41, s[12:15], s37 offen offset:1024 lds
    v_mfma_f32_16x16x32_bf16 v[56:59], a[24:27], v[28:31], v[56:59]
    v_mfma_f32_16x16x32_bf16 v[60:63], a[28:31], v[28:31], v[60:63]
    v_mfma_f32_16x16x32_bf16 v[64:67], a[32:35], v[28:31], v[64:67]
    v_mfma_f32_16x16x32_bf16 v[56:59], a[36:39], v[28:31], v[56:59]
    s_add_u32 m0, s87, 114688
    s_add_u32 s37, s86, 1576960
    buffer_load_dwordx4 v40, s[12:15], s37 offen offset:0 lds
    v_mfma_f32_16x16x32_bf16 v[60:63], a[40:43], v[28:31], v[60:63]
    v_mfma_f32_16x16x32_bf16 v[64:67], a[44:47], v[28:31], v[64:67]
    v_add_u32 v16, 73728, v42
    v_add_u32 v17, 73728, v43
    buffer_load_dwordx4 v41, s[12:15], s37 offen offset:1024 lds
    v_add_u32 v18, 73728, v44
    s_waitcnt vmcnt(6) lgkmcnt(0)
    s_barrier
    s_add_u32 m0, s87, 122880
    s_add_u32 s37, s86, 1966080
    buffer_load_dwordx4 v40, s[12:15], s37 offen offset:0 lds
    ds_read_b64_tr_b16 a[72:73], v16 offset:0
    ds_read_b64_tr_b16 a[74:75], v16 offset:2048
    ds_read_b64_tr_b16 a[76:77], v17 offset:0
    ds_read_b64_tr_b16 a[78:79], v17 offset:2048
    buffer_load_dwordx4 v41, s[12:15], s37 offen offset:1024 lds
    ds_read_b64_tr_b16 a[80:81], v18 offset:0
    ds_read_b64_tr_b16 a[82:83], v18 offset:2048
    ds_read_b64_tr_b16 a[84:85], v16 offset:4096
    ds_read_b64_tr_b16 a[86:87], v16 offset:6144
    s_add_u32 m0, s87, 131072
    s_add_u32 s37, s86, 1968128
    buffer_load_dwordx4 v40, s[12:15], s37 offen offset:0 lds
    ds_read_b64_tr_b16 a[88:89], v17 offset:4096
    ds_read_b64_tr_b16 a[90:91], v17 offset:6144
    ds_read_b64_tr_b16 a[92:93], v18 offset:4096
    ds_read_b64_tr_b16 a[94:95], v18 offset:6144
    buffer_load_dwordx4 v41, s[12:15], s37 offen offset:1024 lds
    v_mfma_f32_16x16x32_bf16 v[56:59], a[48:51], v[28:31], v[56:59]
    v_mfma_f32_16x16x32_bf16 v[60:63], a[52:55], v[28:31], v[60:63]
    v_mfma_f32_16x16x32_bf16 v[64:67], a[56:59], v[28:31], v[64:67]
    v_mfma_f32_16x16x32_bf16 v[56:59], a[60:63], v[28:31], v[56:59]
    s_add_u32 m0, s87, 139264
    s_add_u32 s37, s86, 1970176
    buffer_load_dwordx4 v40, s[12:15], s37 offen offset:0 lds
    v_mfma_f32_16x16x32_bf16 v[60:63], a[64:67], v[28:31], v[60:63]
    v_mfma_f32_16x16x32_bf16 v[64:67], a[68:71], v[28:31], v[64:67]
    v_add_u32 v12, 98304, v42
    v_add_u32 v13, 98304, v43
    buffer_load_dwordx4 v41, s[12:15], s37 offen offset:1024 lds
    v_add_u32 v14, 98304, v44
    s_waitcnt vmcnt(6) lgkmcnt(0)
    s_barrier
    s_add_u32 m0, s87, 73728
    s_add_u32 s37, s86, 2359296
    buffer_load_dwordx4 v40, s[12:15], s37 offen offset:0 lds
    ds_read_b64_tr_b16 a[96:97], v12 offset:0
    ds_read_b64_tr_b16 a[98:99], v12 offset:2048
    ds_read_b64_tr_b16 a[100:101], v13 offset:0
    ds_read_b64_tr_b16 a[102:103], v13 offset:2048
    buffer_load_dwordx4 v41, s[12:15], s37 offen offset:1024 lds
    ds_read_b64_tr_b16 a[104:105], v14 offset:0
    ds_read_b64_tr_b16 a[106:107], v14 offset:2048
    ds_read_b64_tr_b16 a[108:109], v12 offset:4096
    ds_read_b64_tr_b16 a[110:111], v12 offset:6144
    s_add_u32 m0, s87, 81920
    s_add_u32 s37, s86, 2361344
    buffer_load_dwordx4 v40, s[12:15], s37 offen offset:0 lds
    ds_read_b64_tr_b16 a[112:113], v13 offset:4096
    ds_read_b64_tr_b16 a[114:115], v13 offset:6144
    ds_read_b64_tr_b16 a[116:117], v14 offset:4096
    ds_read_b64_tr_b16 a[118:119], v14 offset:6144
    buffer_load_dwordx4 v41, s[12:15], s37 offen offset:1024 lds
    v_mfma_f32_16x16x32_bf16 v[56:59], a[72:75], v[28:31], v[56:59]
    v_mfma_f32_16x16x32_bf16 v[60:63], a[76:79], v[28:31], v[60:63]
    v_mfma_f32_16x16x32_bf16 v[64:67], a[80:83], v[28:31], v[64:67]
    v_mfma_f32_16x16x32_bf16 v[56:59], a[84:87], v[28:31], v[56:59]
    s_add_u32 m0, s87, 90112
    s_add_u32 s37, s86, 2363392
    buffer_load_dwordx4 v40, s[12:15], s37 offen offset:0 lds
    v_mfma_f32_16x16x32_bf16 v[60:63], a[88:91], v[28:31], v[60:63]
    v_mfma_f32_16x16x32_bf16 v[64:67], a[92:95], v[28:31], v[64:67]
    v_add_u32 v16, 122880, v42
    v_add_u32 v17, 122880, v43
    buffer_load_dwordx4 v41, s[12:15], s37 offen offset:1024 lds
    v_add_u32 v18, 122880, v44
    s_waitcnt vmcnt(6) lgkmcnt(0)
    s_barrier
    s_add_u32 m0, s87, 98304
    s_add_u32 s37, s86, 2752512
    buffer_load_dwordx4 v40, s[12:15], s37 offen offset:0 lds
    ds_read_b64_tr_b16 a[120:121], v16 offset:0
    ds_read_b64_tr_b16 a[122:123], v16 offset:2048
    ds_read_b64_tr_b16 a[124:125], v17 offset:0
    ds_read_b64_tr_b16 a[126:127], v17 offset:2048
    buffer_load_dwordx4 v41, s[12:15], s37 offen offset:1024 lds
    ds_read_b64_tr_b16 a[128:129], v18 offset:0
    ds_read_b64_tr_b16 a[130:131], v18 offset:2048
    ds_read_b64_tr_b16 a[132:133], v16 offset:4096
    ds_read_b64_tr_b16 a[134:135], v16 offset:6144
    s_add_u32 m0, s87, 106496
    s_add_u32 s37, s86, 2754560
    buffer_load_dwordx4 v40, s[12:15], s37 offen offset:0 lds
    ds_read_b64_tr_b16 a[136:137], v17 offset:4096
    ds_read_b64_tr_b16 a[138:139], v17 offset:6144
    ds_read_b64_tr_b16 a[140:141], v18 offset:4096
    ds_read_b64_tr_b16 a[142:143], v18 offset:6144
    buffer_load_dwordx4 v41, s[12:15], s37 offen offset:1024 lds
    v_mfma_f32_16x16x32_bf16 v[56:59], a[96:99], v[28:31], v[56:59]
    v_mfma_f32_16x16x32_bf16 v[60:63], a[100:103], v[28:31], v[60:63]
    v_mfma_f32_16x16x32_bf16 v[64:67], a[104:107], v[28:31], v[64:67]
    v_mfma_f32_16x16x32_bf16 v[56:59], a[108:111], v[28:31], v[56:59]
    s_add_u32 m0, s87, 114688
    s_add_u32 s37, s86, 2756608
    buffer_load_dwordx4 v40, s[12:15], s37 offen offset:0 lds
    v_mfma_f32_16x16x32_bf16 v[60:63], a[112:115], v[28:31], v[60:63]
    v_mfma_f32_16x16x32_bf16 v[64:67], a[116:119], v[28:31], v[64:67]
    v_add_u32 v12, 73728, v42
    v_add_u32 v13, 73728, v43
    buffer_load_dwordx4 v41, s[12:15], s37 offen offset:1024 lds
    v_add_u32 v14, 73728, v44
    s_waitcnt vmcnt(6) lgkmcnt(0)
    s_barrier
    s_add_u32 m0, s87, 122880
    s_add_u32 s37, s86, 3145728
    buffer_load_dwordx4 v40, s[12:15], s37 offen offset:0 lds
    ds_read_b64_tr_b16 a[144:145], v12 offset:0
    ds_read_b64_tr_b16 a[146:147], v12 offset:2048
    ds_read_b64_tr_b16 a[148:149], v13 offset:0
    ds_read_b64_tr_b16 a[150:151], v13 offset:2048
    buffer_load_dwordx4 v41, s[12:15], s37 offen offset:1024 lds
    ds_read_b64_tr_b16 a[152:153], v14 offset:0
    ds_read_b64_tr_b16 a[154:155], v14 offset:2048
    ds_read_b64_tr_b16 a[156:157], v12 offset:4096
    ds_read_b64_tr_b16 a[158:159], v12 offset:6144
    s_add_u32 m0, s87, 131072
    s_add_u32 s37, s86, 3147776
    buffer_load_dwordx4 v40, s[12:15], s37 offen offset:0 lds
    ds_read_b64_tr_b16 a[160:161], v13 offset:4096
    ds_read_b64_tr_b16 a[162:163], v13 offset:6144
    ds_read_b64_tr_b16 a[164:165], v14 offset:4096
    ds_read_b64_tr_b16 a[166:167], v14 offset:6144
    buffer_load_dwordx4 v41, s[12:15], s37 offen offset:1024 lds
    v_mfma_f32_16x16x32_bf16 v[56:59], a[120:123], v[28:31], v[56:59]
    v_mfma_f32_16x16x32_bf16 v[60:63], a[124:127], v[28:31], v[60:63]
    v_mfma_f32_16x16x32_bf16 v[64:67], a[128:131], v[28:31], v[64:67]
    v_mfma_f32_16x16x32_bf16 v[56:59], a[132:135], v[28:31], v[56:59]
    s_add_u32 m0, s87, 139264
    s_add_u32 s37, s86, 3149824
    buffer_load_dwordx4 v40, s[12:15], s37 offen offset:0 lds
    v_mfma_f32_16x16x32_bf16 v[60:63], a[136:139], v[28:31], v[60:63]
    v_mfma_f32_16x16x32_bf16 v[64:67], a[140:143], v[28:31], v[64:67]
    v_add_u32 v16, 98304, v42
    v_add_u32 v17, 98304, v43
    buffer_load_dwordx4 v41, s[12:15], s37 offen offset:1024 lds
    v_add_u32 v18, 98304, v44
    s_waitcnt vmcnt(6) lgkmcnt(0)
    s_barrier
    s_add_u32 m0, s87, 73728
    s_add_u32 s37, s86, 3538944
    buffer_load_dwordx4 v40, s[12:15], s37 offen offset:0 lds
    ds_read_b64_tr_b16 a[168:169], v16 offset:0
    ds_read_b64_tr_b16 a[170:171], v16 offset:2048
    ds_read_b64_tr_b16 a[172:173], v17 offset:0
    ds_read_b64_tr_b16 a[174:175], v17 offset:2048
    buffer_load_dwordx4 v41, s[12:15], s37 offen offset:1024 lds
    ds_read_b64_tr_b16 a[176:177], v18 offset:0
    ds_read_b64_tr_b16 a[178:179], v18 offset:2048
    ds_read_b64_tr_b16 a[180:181], v16 offset:4096
    ds_read_b64_tr_b16 a[182:183], v16 offset:6144
    s_add_u32 m0, s87, 81920
    s_add_u32 s37, s86, 3540992
    buffer_load_dwordx4 v40, s[12:15], s37 offen offset:0 lds
    ds_read_b64_tr_b16 a[184:185], v17 offset:4096
    ds_read_b64_tr_b16 a[186:187], v17 offset:6144
    ds_read_b64_tr_b16 a[188:189], v18 offset:4096
    ds_read_b64_tr_b16 a[190:191], v18 offset:6144
    buffer_load_dwordx4 v41, s[12:15], s37 offen offset:1024 lds
    v_mfma_f32_16x16x32_bf16 v[56:59], a[144:147], v[28:31], v[56:59]
    v_mfma_f32_16x16x32_bf16 v[60:63], a[148:151], v[28:31], v[60:63]
    v_mfma_f32_16x16x32_bf16 v[64:67], a[152:155], v[28:31], v[64:67]
    v_mfma_f32_16x16x32_bf16 v[56:59], a[156:159], v[28:31], v[56:59]
    s_add_u32 m0, s87, 90112
    s_add_u32 s37, s86, 3543040
    buffer_load_dwordx4 v40, s[12:15], s37 offen offset:0 lds
    v_mfma_f32_16x16x32_bf16 v[60:63], a[160:163], v[28:31], v[60:63]
    v_mfma_f32_16x16x32_bf16 v[64:67], a[164:167], v[28:31], v[64:67]
    v_add_u32 v12, 122880, v42
    v_add_u32 v13, 122880, v43
    buffer_load_dwordx4 v41, s[12:15], s37 offen offset:1024 lds
    v_add_u32 v14, 122880, v44
    s_waitcnt vmcnt(6) lgkmcnt(0)
    s_barrier
    s_add_u32 m0, s87, 98304
    s_add_u32 s37, s86, 3932160
    buffer_load_dwordx4 v40, s[12:15], s37 offen offset:0 lds
    ds_read_b64_tr_b16 a[192:193], v12 offset:0
    ds_read_b64_tr_b16 a[194:195], v12 offset:2048
    ds_read_b64_tr_b16 a[196:197], v13 offset:0
    ds_read_b64_tr_b16 a[198:199], v13 offset:2048
    buffer_load_dwordx4 v41, s[12:15], s37 offen offset:1024 lds
    ds_read_b64_tr_b16 a[200:201], v14 offset:0
    ds_read_b64_tr_b16 a[202:203], v14 offset:2048
    ds_read_b64_tr_b16 a[204:205], v12 offset:4096
    ds_read_b64_tr_b16 a[206:207], v12 offset:6144
    s_add_u32 m0, s87, 106496
    s_add_u32 s37, s86, 3934208
    buffer_load_dwordx4 v40, s[12:15], s37 offen offset:0 lds
    ds_read_b64_tr_b16 a[208:209], v13 offset:4096
    ds_read_b64_tr_b16 a[210:211], v13 offset:6144
    ds_read_b64_tr_b16 a[212:213], v14 offset:4096
    ds_read_b64_tr_b16 a[214:215], v14 offset:6144
    buffer_load_dwordx4 v41, s[12:15], s37 offen offset:1024 lds
    v_mfma_f32_16x16x32_bf16 v[56:59], a[168:171], v[28:31], v[56:59]
    v_mfma_f32_16x16x32_bf16 v[60:63], a[172:175], v[28:31], v[60:63]
    v_mfma_f32_16x16x32_bf16 v[64:67], a[176:179], v[28:31], v[64:67]
    v_mfma_f32_16x16x32_bf16 v[56:59], a[180:183], v[28:31], v[56:59]
    s_add_u32 m0, s87, 114688
    s_add_u32 s37, s86, 3936256
    buffer_load_dwordx4 v40, s[12:15], s37 offen offset:0 lds
    v_mfma_f32_16x16x32_bf16 v[60:63], a[184:187], v[28:31], v[60:63]
    v_mfma_f32_16x16x32_bf16 v[64:67], a[188:191], v[28:31], v[64:67]
    v_add_u32 v16, 73728, v42
    v_add_u32 v17, 73728, v43
    buffer_load_dwordx4 v41, s[12:15], s37 offen offset:1024 lds
    v_add_u32 v18, 73728, v44
    s_waitcnt vmcnt(6) lgkmcnt(0)
    s_barrier
    s_add_u32 m0, s87, 122880
    s_add_u32 s37, s86, 4325376
    buffer_load_dwordx4 v40, s[12:15], s37 offen offset:0 lds
    ds_read_b64_tr_b16 a[216:217], v16 offset:0
    ds_read_b64_tr_b16 a[218:219], v16 offset:2048
    ds_read_b64_tr_b16 a[220:221], v17 offset:0
    ds_read_b64_tr_b16 a[222:223], v17 offset:2048
    buffer_load_dwordx4 v41, s[12:15], s37 offen offset:1024 lds
    ds_read_b64_tr_b16 a[224:225], v18 offset:0
    ds_read_b64_tr_b16 a[226:227], v18 offset:2048
    ds_read_b64_tr_b16 a[228:229], v16 offset:4096
    ds_read_b64_tr_b16 a[230:231], v16 offset:6144
    s_add_u32 m0, s87, 131072
    s_add_u32 s37, s86, 4327424
    buffer_load_dwordx4 v40, s[12:15], s37 offen offset:0 lds
    ds_read_b64_tr_b16 a[232:233], v17 offset:4096
    ds_read_b64_tr_b16 a[234:235], v17 offset:6144
    ds_read_b64_tr_b16 a[236:237], v18 offset:4096
    ds_read_b64_tr_b16 a[238:239], v18 offset:6144
    buffer_load_dwordx4 v41, s[12:15], s37 offen offset:1024 lds
    v_mfma_f32_16x16x32_bf16 v[56:59], a[192:195], v[28:31], v[56:59]
    v_mfma_f32_16x16x32_bf16 v[60:63], a[196:199], v[28:31], v[60:63]
    v_mfma_f32_16x16x32_bf16 v[64:67], a[200:203], v[28:31], v[64:67]
    v_mfma_f32_16x16x32_bf16 v[56:59], a[204:207], v[28:31], v[56:59]
    s_add_u32 m0, s87, 139264
    s_add_u32 s37, s86, 4329472
    buffer_load_dwordx4 v40, s[12:15], s37 offen offset:0 lds
    v_mfma_f32_16x16x32_bf16 v[60:63], a[208:211], v[28:31], v[60:63]
    v_mfma_f32_16x16x32_bf16 v[64:67], a[212:215], v[28:31], v[64:67]
    v_add_u32 v12, 98304, v42
    v_add_u32 v13, 98304, v43
    buffer_load_dwordx4 v41, s[12:15], s37 offen offset:1024 lds
    v_add_u32 v14, 98304, v44
    s_waitcnt vmcnt(6) lgkmcnt(0)
    s_barrier
    s_add_u32 m0, s87, 73728
    s_add_u32 s37, s86, 4718592
    buffer_load_dwordx4 v40, s[12:15], s37 offen offset:0 lds
    ds_read_b64_tr_b16 a[240:241], v12 offset:0
    ds_read_b64_tr_b16 a[242:243], v12 offset:2048
    ds_read_b64_tr_b16 a[244:245], v13 offset:0
    ds_read_b64_tr_b16 a[246:247], v13 offset:2048
    buffer_load_dwordx4 v41, s[12:15], s37 offen offset:1024 lds
    ds_read_b64_tr_b16 a[248:249], v14 offset:0
    ds_read_b64_tr_b16 a[250:251], v14 offset:2048
    ds_read_b64_tr_b16 a[252:253], v12 offset:4096
    ds_read_b64_tr_b16 a[254:255], v12 offset:6144
    s_add_u32 m0, s87, 81920
    s_add_u32 s37, s86, 4720640
    buffer_load_dwordx4 v40, s[12:15], s37 offen offset:0 lds
    ds_read_b64_tr_b16 v[128:129], v13 offset:4096
    ds_read_b64_tr_b16 v[130:131], v13 offset:6144
    ds_read_b64_tr_b16 v[132:133], v14 offset:4096
    ds_read_b64_tr_b16 v[134:135], v14 offset:6144
    buffer_load_dwordx4 v41, s[12:15], s37 offen offset:1024 lds
    v_mfma_f32_16x16x32_bf16 v[56:59], a[216:219], v[28:31], v[56:59]
    v_mfma_f32_16x16x32_bf16 v[60:63], a[220:223], v[28:31], v[60:63]
    v_mfma_f32_16x16x32_bf16 v[64:67], a[224:227], v[28:31], v[64:67]
    v_mfma_f32_16x16x32_bf16 v[56:59], a[228:231], v[28:31], v[56:59]
    s_add_u32 m0, s87, 90112
    s_add_u32 s37, s86, 4722688
    buffer_load_dwordx4 v40, s[12:15], s37 offen offset:0 lds
    v_mfma_f32_16x16x32_bf16 v[60:63], a[232:235], v[28:31], v[60:63]
    v_mfma_f32_16x16x32_bf16 v[64:67], a[236:239], v[28:31], v[64:67]
    v_add_u32 v16, 122880, v42
    v_add_u32 v17, 122880, v43
    buffer_load_dwordx4 v41, s[12:15], s37 offen offset:1024 lds
    v_add_u32 v18, 122880, v44
    s_waitcnt vmcnt(6) lgkmcnt(0)
    s_barrier
    s_mov_b32 s20, s82
    s_mov_b32 s21, s83
    s_mov_b32 s22, 0x100
    s_mov_b32 s23, 0x00020000
    v_and_b32 v8, 15, v0
    v_lshlrev_b32 v8, 4, v8
    v_mov_b32 v10, 8
    s_mul_i32 s38, s28, 0x40
    s_add_u32 s38, s38, 0x4
    v_writelane_b32 v8, s38, 16
    v_writelane_b32 v10, 12, 16
    buffer_load_dword v9, v8, s[20:23], 0 offen sc1
    s_add_u32 m0, s87, 98304
    s_add_u32 s37, s86, 5111808
    buffer_load_dwordx4 v40, s[12:15], s37 offen offset:0 lds
    ds_read_b64_tr_b16 v[136:137], v16 offset:0
    ds_read_b64_tr_b16 v[138:139], v16 offset:2048
    ds_read_b64_tr_b16 v[140:141], v17 offset:0
    ds_read_b64_tr_b16 v[142:143], v17 offset:2048
    buffer_load_dwordx4 v41, s[12:15], s37 offen offset:1024 lds
    ds_read_b64_tr_b16 v[144:145], v18 offset:0
    ds_read_b64_tr_b16 v[146:147], v18 offset:2048
    ds_read_b64_tr_b16 v[148:149], v16 offset:4096
    ds_read_b64_tr_b16 v[150:151], v16 offset:6144
    s_add_u32 m0, s87, 106496
    s_add_u32 s37, s86, 5113856
    buffer_load_dwordx4 v40, s[12:15], s37 offen offset:0 lds
    ds_read_b64_tr_b16 v[152:153], v17 offset:4096
    ds_read_b64_tr_b16 v[154:155], v17 offset:6144
    ds_read_b64_tr_b16 v[156:157], v18 offset:4096
    ds_read_b64_tr_b16 v[158:159], v18 offset:6144
    buffer_load_dwordx4 v41, s[12:15], s37 offen offset:1024 lds
    v_mfma_f32_16x16x32_bf16 v[56:59], a[240:243], v[28:31], v[56:59]
    v_mfma_f32_16x16x32_bf16 v[60:63], a[244:247], v[28:31], v[60:63]
    v_mfma_f32_16x16x32_bf16 v[64:67], a[248:251], v[28:31], v[64:67]
    v_mfma_f32_16x16x32_bf16 v[56:59], a[252:255], v[28:31], v[56:59]
    s_add_u32 m0, s87, 114688
    s_add_u32 s37, s86, 5115904
    buffer_load_dwordx4 v40, s[12:15], s37 offen offset:0 lds
    v_mfma_f32_16x16x32_bf16 v[60:63], v[128:131], v[28:31], v[60:63]
    v_mfma_f32_16x16x32_bf16 v[64:67], v[132:135], v[28:31], v[64:67]
    v_add_u32 v12, 73728, v42
    v_add_u32 v13, 73728, v43
    buffer_load_dwordx4 v41, s[12:15], s37 offen offset:1024 lds
    v_add_u32 v14, 73728, v44
    s_waitcnt vmcnt(7) lgkmcnt(0)
    s_barrier
    s_add_u32 m0, s87, 122880
    s_add_u32 s37, s86, 5505024
    buffer_load_dwordx4 v40, s[12:15], s37 offen offset:0 lds
    ds_read_b64_tr_b16 v[160:161], v12 offset:0
    ds_read_b64_tr_b16 v[162:163], v12 offset:2048
    ds_read_b64_tr_b16 v[164:165], v13 offset:0
    ds_read_b64_tr_b16 v[166:167], v13 offset:2048
    buffer_load_dwordx4 v41, s[12:15], s37 offen offset:1024 lds
    ds_read_b64_tr_b16 v[168:169], v14 offset:0
    ds_read_b64_tr_b16 v[170:171], v14 offset:2048
    ds_read_b64_tr_b16 v[172:173], v12 offset:4096
    ds_read_b64_tr_b16 v[174:175], v12 offset:6144
    s_add_u32 m0, s87, 131072
    s_add_u32 s37, s86, 5507072
    buffer_load_dwordx4 v40, s[12:15], s37 offen offset:0 lds
    ds_read_b64_tr_b16 v[176:177], v13 offset:4096
    ds_read_b64_tr_b16 v[178:179], v13 offset:6144
    ds_read_b64_tr_b16 v[180:181], v14 offset:4096
    ds_read_b64_tr_b16 v[182:183], v14 offset:6144
    buffer_load_dwordx4 v41, s[12:15], s37 offen offset:1024 lds
    v_mfma_f32_16x16x32_bf16 v[56:59], v[136:139], v[28:31], v[56:59]
    v_mfma_f32_16x16x32_bf16 v[60:63], v[140:143], v[28:31], v[60:63]
    v_mfma_f32_16x16x32_bf16 v[64:67], v[144:147], v[28:31], v[64:67]
    v_mfma_f32_16x16x32_bf16 v[56:59], v[148:151], v[28:31], v[56:59]
    s_add_u32 m0, s87, 139264
    s_add_u32 s37, s86, 5509120
    buffer_load_dwordx4 v40, s[12:15], s37 offen offset:0 lds
    v_mfma_f32_16x16x32_bf16 v[60:63], v[152:155], v[28:31], v[60:63]
    v_mfma_f32_16x16x32_bf16 v[64:67], v[156:159], v[28:31], v[64:67]
    v_add_u32 v16, 98304, v42
    v_add_u32 v17, 98304, v43
    buffer_load_dwordx4 v41, s[12:15], s37 offen offset:1024 lds
    v_add_u32 v18, 98304, v44
    s_waitcnt vmcnt(6) lgkmcnt(0)
    s_barrier
    s_add_u32 m0, s87, 73728
    s_add_u32 s37, s86, 5898240
    buffer_load_dwordx4 v40, s[12:15], s37 offen offset:0 lds
    ds_read_b64_tr_b16 v[184:185], v16 offset:0
    ds_read_b64_tr_b16 v[186:187], v16 offset:2048
    ds_read_b64_tr_b16 v[188:189], v17 offset:0
    ds_read_b64_tr_b16 v[190:191], v17 offset:2048
    buffer_load_dwordx4 v41, s[12:15], s37 offen offset:1024 lds
    ds_read_b64_tr_b16 v[192:193], v18 offset:0
    ds_read_b64_tr_b16 v[194:195], v18 offset:2048
    ds_read_b64_tr_b16 v[196:197], v16 offset:4096
    ds_read_b64_tr_b16 v[198:199], v16 offset:6144
    s_add_u32 m0, s87, 81920
    s_add_u32 s37, s86, 5900288
    buffer_load_dwordx4 v40, s[12:15], s37 offen offset:0 lds
    ds_read_b64_tr_b16 v[200:201], v17 offset:4096
    ds_read_b64_tr_b16 v[202:203], v17 offset:6144
    ds_read_b64_tr_b16 v[204:205], v18 offset:4096
    ds_read_b64_tr_b16 v[206:207], v18 offset:6144
    buffer_load_dwordx4 v41, s[12:15], s37 offen offset:1024 lds
    v_mfma_f32_16x16x32_bf16 v[56:59], v[160:163], v[28:31], v[56:59]
    v_mfma_f32_16x16x32_bf16 v[60:63], v[164:167], v[28:31], v[60:63]
    v_mfma_f32_16x16x32_bf16 v[64:67], v[168:171], v[28:31], v[64:67]
    v_mfma_f32_16x16x32_bf16 v[56:59], v[172:175], v[28:31], v[56:59]
    s_add_u32 m0, s87, 90112
    s_add_u32 s37, s86, 5902336
    buffer_load_dwordx4 v40, s[12:15], s37 offen offset:0 lds
    v_mfma_f32_16x16x32_bf16 v[60:63], v[176:179], v[28:31], v[60:63]
    v_mfma_f32_16x16x32_bf16 v[64:67], v[180:183], v[28:31], v[64:67]
    v_add_u32 v12, 122880, v42
    v_add_u32 v13, 122880, v43
    buffer_load_dwordx4 v41, s[12:15], s37 offen offset:1024 lds
    v_add_u32 v14, 122880, v44
Lqkv_wa:
    v_cmp_gt_u32 vcc, v10, v9
    s_sub_u32 s43, s43, 1
    s_cmp_lt_i32 s43, 0
    s_cbranch_scc1 Lqkv_all
    s_cbranch_vccz Lqkv_all
    s_sleep 2
    buffer_load_dword v9, v8, s[20:23], 0 offen sc1
    s_waitcnt vmcnt(0)
    s_branch Lqkv_wa
Lqkv_all:
    s_mov_b32 s18, 0xffff
    s_mov_b32 s32, 1
    s_mov_b32 s16, 278528
    s_mov_b32 s10, s6
    s_add_u32 m0, s34, 0
    s_nop 0
    buffer_load_dwordx4 v1, s[8:11], s33 offen offset:0 sc1 lds
    buffer_load_dwordx4 v1, s[8:11], s33 offen offset:1024 sc1 lds
    buffer_load_dwordx4 v1, s[8:11], s33 offen offset:2048 sc1 lds
    buffer_load_dwordx4 v1, s[8:11], s33 offen offset:3072 sc1 lds
    s_add_u32 m0, s34, 4096
    s_add_u32 s37, s33, 4096
    buffer_load_dwordx4 v1, s[8:11], s37 offen offset:0 sc1 lds
    buffer_load_dwordx4 v1, s[8:11], s37 offen offset:1024 sc1 lds
    buffer_load_dwordx4 v1, s[8:11], s37 offen offset:2048 sc1 lds
    buffer_load_dwordx4 v1, s[8:11], s37 offen offset:3072 sc1 lds
    s_add_u32 m0, s34, 8192
    s_add_u32 s37, s33, 8192
    buffer_load_dwordx4 v1, s[8:11], s37 offen offset:0 sc1 lds
    s_add_u32 s33, s33, 34816
    s_add_u32 s34, s34, 36864
    s_cmp_ge_u32 s34, 147456
    s_cselect_b32 s38, 147456, 0
    s_sub_u32 s34, s34, s38
    s_mov_b32 s10, s6
    s_add_u32 m0, s34, 0
    s_nop 0
    buffer_load_dwordx4 v1, s[8:11], s33 offen offset:0 sc1 lds
    buffer_load_dwordx4 v1, s[8:11], s33 offen offset:1024 sc1 lds
    buffer_load_dwordx4 v1, s[8:11], s33 offen offset:2048 sc1 lds
    buffer_load_dwordx4 v1, s[8:11], s33 offen offset:3072 sc1 lds
    s_add_u32 m0, s34, 4096
    s_add_u32 s37, s33, 4096
    buffer_load_dwordx4 v1, s[8:11], s37 offen offset:0 sc1 lds
    buffer_load_dwordx4 v1, s[8:11], s37 offen offset:1024 sc1 lds
    buffer_load_dwordx4 v1, s[8:11], s37 offen offset:2048 sc1 lds
    buffer_load_dwordx4 v1, s[8:11], s37 offen offset:3072 sc1 lds
    s_add_u32 m0, s34, 8192
    s_add_u32 s37, s33, 8192
    buffer_load_dwordx4 v1, s[8:11], s37 offen offset:0 sc1 lds
    s_add_u32 s16, s16, 8192
    s_and_b32 s16, s16, 524287
    buffer_load_dword v5, v4, s[4:7], s16 offen sc1
    s_add_u32 s31, s31, 1
    s_sub_u32 s54, s31, 2
    v_mov_b32 v6, s54
    s_cmp_ge_i32 s31, 30
    s_cselect_b32 s18, 0x1ffff, s18
    s_add_u32 s33, s33, 34816
    s_add_u32 s34, s34, 36864
    s_cmp_ge_u32 s34, 147456
    s_cselect_b32 s38, 147456, 0
    s_sub_u32 s34, s34, s38
    s_waitcnt vmcnt(25) lgkmcnt(0)
    s_barrier
    ds_read_b64_tr_b16 v[208:209], v12 offset:0
    ds_read_b64_tr_b16 v[210:211], v12 offset:2048
    ds_read_b64_tr_b16 v[212:213], v13 offset:0
    ds_read_b64_tr_b16 v[214:215], v13 offset:2048
    ds_read_b64_tr_b16 v[216:217], v14 offset:0
    ds_read_b64_tr_b16 v[218:219], v14 offset:2048
    ds_read_b64_tr_b16 v[220:221], v12 offset:4096
    ds_read_b64_tr_b16 v[222:223], v12 offset:6144
    ds_read_b64_tr_b16 v[224:225], v13 offset:4096
    ds_read_b64_tr_b16 v[226:227], v13 offset:6144
    ds_read_b64_tr_b16 v[228:229], v14 offset:4096
    ds_read_b64_tr_b16 v[230:231], v14 offset:6144
    v_mfma_f32_16x16x32_bf16 v[56:59], v[184:187], v[28:31], v[56:59]
    v_mfma_f32_16x16x32_bf16 v[60:63], v[188:191], v[28:31], v[60:63]
    v_mfma_f32_16x16x32_bf16 v[64:67], v[192:195], v[28:31], v[64:67]
    v_mfma_f32_16x16x32_bf16 v[56:59], v[196:199], v[28:31], v[56:59]
    v_mfma_f32_16x16x32_bf16 v[60:63], v[200:203], v[28:31], v[60:63]
    v_mfma_f32_16x16x32_bf16 v[64:67], v[204:207], v[28:31], v[64:67]
    v_add_u32 v16, 73728, v42
    v_add_u32 v17, 73728, v43
    v_add_u32 v18, 73728, v44
    s_waitcnt vmcnt(19) lgkmcnt(0)
    s_barrier
    ds_read_b64_tr_b16 v[232:233], v16 offset:0
    ds_read_b64_tr_b16 v[234:235], v16 offset:2048
    ds_read_b64_tr_b16 v[236:237], v17 offset:0
    ds_read_b64_tr_b16 v[238:239], v17 offset:2048
    ds_read_b64_tr_b16 v[240:241], v18 offset:0
    ds_read_b64_tr_b16 v[242:243], v18 offset:2048
    ds_read_b64_tr_b16 v[244:245], v16 offset:4096
    ds_read_b64_tr_b16 v[246:247], v16 offset:6144
    ds_read_b64_tr_b16 v[248:249], v17 offset:4096
    ds_read_b64_tr_b16 v[250:251], v17 offset:6144
    ds_read_b64_tr_b16 v[252:253], v18 offset:4096
    ds_read_b64_tr_b16 v[254:255], v18 offset:6144
    v_mfma_f32_16x16x32_bf16 v[56:59], v[208:211], v[28:31], v[56:59]
    v_mfma_f32_16x16x32_bf16 v[60:63], v[212:215], v[28:31], v[60:63]
    v_mfma_f32_16x16x32_bf16 v[64:67], v[216:219], v[28:31], v[64:67]
    v_mfma_f32_16x16x32_bf16 v[56:59], v[220:223], v[28:31], v[56:59]
    v_mfma_f32_16x16x32_bf16 v[60:63], v[224:227], v[28:31], v[60:63]
    v_mfma_f32_16x16x32_bf16 v[64:67], v[228:231], v[28:31], v[64:67]
    s_waitcnt lgkmcnt(0)
    v_mfma_f32_16x16x32_bf16 v[56:59], v[232:235], v[28:31], v[56:59]
    v_mfma_f32_16x16x32_bf16 v[60:63], v[236:239], v[28:31], v[60:63]
    v_mfma_f32_16x16x32_bf16 v[64:67], v[240:243], v[28:31], v[64:67]
    v_mfma_f32_16x16x32_bf16 v[56:59], v[244:247], v[28:31], v[56:59]
    v_mfma_f32_16x16x32_bf16 v[60:63], v[248:251], v[28:31], v[60:63]
    v_mfma_f32_16x16x32_bf16 v[64:67], v[252:255], v[28:31], v[64:67]
    s_mov_b32 s12, s84
    s_mov_b32 s13, s85
    s_mov_b32 s14, 0x6200000
    s_mov_b32 s15, 0x00020000
    s_waitcnt vmcnt(10)
    s_barrier
    ds_read_b128 v[40:43], v2 offset:0
    ds_read_b128 v[44:47], v2 offset:1024
    ds_read_b128 v[48:51], v2 offset:2048
    ds_read_b128 v[52:55], v2 offset:3072
    s_mov_b32 s14, 0
    buffer_store_dword v6, v21, s[12:15], s17 offen sc1
    buffer_store_dword v6, v21, s[12:15], s17 offen sc1
    s_cmp_eq_u32 s30, 1
    s_cbranch_scc1 Lqkv_g01
    s_cmp_eq_u32 s30, 2
    s_cbranch_scc1 Lqkv_g02
    s_cmp_eq_u32 s30, 3
    s_cbranch_scc1 Lqkv_g03
    s_branch Lqkv_g00
Lqkv_s10:
    s_waitcnt lgkmcnt(2)
    v_mfma_f32_16x16x32_bf16 v[24:27], a[0:3], v[40:43], 0
    s_add_u32 m0, s34, 0
    v_mul_f32 v124, s52, v71
    v_mov_b32 v106, s42
    v_mfma_f32_16x16x32_bf16 v[24:27], a[12:15], v[44:47], v[24:27]
    s_add_u32 s35, s35, 36864
    v_mov_b32 v107, s42
    v_mov_b32 v108, s42
    v_mfma_f32_16x16x32_bf16 v[28:31], a[16:19], v[44:47], 0
    s_cmp_eq_u32 s35, 147456
    s_cselect_b32 s35, 0, s35
    v_mov_b32 v109, s42
    v_mfma_f32_16x16x32_bf16 v[28:31], a[4:7], v[40:43], v[28:31]
    s_waitcnt vmcnt(1)
    v_fma_f32 v16, -v68, v64, v16
    v_fma_f32 v17, -v68, v65, v17
    v_mfma_f32_16x16x32_bf16 v[106:109], v[96:99], v[88:91], v[106:109]
    v_fma_f32 v18, -v68, v66, v18
    v_fma_f32 v19, -v68, v67, v19
    v_mfma_f32_16x16x32_bf16 v[32:35], a[8:11], v[40:43], 0
    ds_read_b128 v[40:43], v3 offset:4096
    v_mul_f32 v16, v16, v69
    v_mfma_f32_16x16x32_bf16 v[32:35], a[20:23], v[44:47], v[32:35]
    ds_read_b128 v[44:47], v3 offset:5120
    s_waitcnt lgkmcnt(2)
    v_mfma_f32_16x16x32_bf16 v[32:35], a[32:35], v[48:51], v[32:35]
    v_cndmask_b32 v106, v106, v107, s[44:45]
    v_cndmask_b32 v108, v108, v109, s[44:45]
    v_mfma_f32_16x16x32_bf16 v[32:35], a[44:47], v[52:55], v[32:35]
    v_cndmask_b32 v120, v106, v118, s[48:49]
    v_cndmask_b32 v121, v108, v119, s[50:51]
    v_mfma_f32_16x16x32_bf16 v[28:31], a[40:43], v[52:55], v[28:31]
    v_mul_f32 v17, v17, v69
    v_mul_f32 v18, v18, v69
    v_mfma_f32_16x16x32_bf16 v[28:31], a[28:31], v[48:51], v[28:31]
    ds_write_b64 v36, v[120:121] offset:2048
    v_mfma_f32_16x16x32_bf16 v[24:27], a[24:27], v[48:51], v[24:27]
    ds_read_b128 v[48:51], v3 offset:6144
    v_mul_f32 v19, v19, v69
    v_mfma_f32_16x16x32_bf16 v[24:27], a[36:39], v[52:55], v[24:27]
    ds_read_b128 v[52:55], v3 offset:7168
    s_waitcnt lgkmcnt(3)
    v_mfma_f32_16x16x32_bf16 v[24:27], a[48:51], v[40:43], v[24:27]
    v_cvt_pk_bf16_f32 v16, v16, v17
    v_cvt_pk_bf16_f32 v17, v18, v19
    v_mfma_f32_16x16x32_bf16 v[24:27], a[60:63], v[44:47], v[24:27]
    s_waitcnt lgkmcnt(2)
    ds_write_b64 v38, v[16:17]
    v_mfma_f32_16x16x32_bf16 v[28:31], a[64:67], v[44:47], v[28:31]
    ds_read_b64_tr_b16 v[92:93], v39
    v_fma_f32 v12, -v68, v60, v12
    v_mfma_f32_16x16x32_bf16 v[28:31], a[52:55], v[40:43], v[28:31]
    s_barrier
    v_mfma_f32_16x16x32_bf16 v[32:35], a[56:59], v[40:43], v[32:35]
    ds_read_b128 v[40:43], v3 offset:8192
    v_fma_f32 v13, -v68, v61, v13
    v_mfma_f32_16x16x32_bf16 v[32:35], a[68:71], v[44:47], v[32:35]
    ds_read_b128 v[44:47], v3 offset:9216
    s_waitcnt lgkmcnt(4)
    v_mfma_f32_16x16x32_bf16 v[32:35], a[80:83], v[48:51], v[32:35]
    buffer_load_dwordx4 v1, s[8:11], s33 offen offset:0 sc1 lds
    v_mfma_f32_16x16x32_bf16 v[32:35], a[92:95], v[52:55], v[32:35]
    ds_read_b64 v[122:123], v37 offset:2048
    v_fma_f32 v14, -v68, v62, v14
    v_mfma_f32_16x16x32_bf16 v[28:31], a[88:91], v[52:55], v[28:31]
    v_fma_f32 v15, -v68, v63, v15
    v_mul_f32 v12, v12, v69
    v_mfma_f32_16x16x32_bf16 v[28:31], a[76:79], v[48:51], v[28:31]
    v_mul_f32 v13, v13, v69
    v_mul_f32 v14, v14, v69
    v_mfma_f32_16x16x32_bf16 v[24:27], a[72:75], v[48:51], v[24:27]
    ds_read_b128 v[48:51], v3 offset:10240
    v_mul_f32 v15, v15, v69
    v_mfma_f32_16x16x32_bf16 v[24:27], a[84:87], v[52:55], v[24:27]
    ds_read_b128 v[52:55], v3 offset:11264
    s_waitcnt lgkmcnt(3)
    v_mfma_f32_16x16x32_bf16 v[24:27], a[96:99], v[40:43], v[24:27]
    buffer_store_dword v6, v21, s[12:15], s17 offen sc1
    s_waitcnt lgkmcnt(2)
    v_mfma_f32_16x16x32_bf16 v[24:27], a[108:111], v[44:47], v[24:27]
    s_cmp_ge_i32 s54, 0
    s_cselect_b32 s14, s6, 0
    v_add_f32 v122, v122, v120
    v_mfma_f32_16x16x32_bf16 v[28:31], a[112:115], v[44:47], v[28:31]
    s_add_u32 s17, s17, 8192
    v_add_f32 v123, v123, v121
    v_max_f32 v22, v122, v123
    v_mfma_f32_16x16x32_bf16 v[28:31], a[100:103], v[40:43], v[28:31]
    buffer_load_dwordx4 v1, s[8:11], s33 offen offset:1024 sc1 lds
    v_mfma_f32_16x16x32_bf16 v[32:35], a[104:107], v[40:43], v[32:35]
    ds_read_b128 v[40:43], v3 offset:12288
    v_mov_b32 v23, v22
    v_mfma_f32_16x16x32_bf16 v[32:35], a[116:119], v[44:47], v[32:35]
    ds_read_b128 v[44:47], v3 offset:13312
    s_waitcnt lgkmcnt(2)
    v_mfma_f32_16x16x32_bf16 v[32:35], a[128:131], v[48:51], v[32:35]
    v_permlane16_swap_b32 v22, v23
    v_mfma_f32_16x16x32_bf16 v[32:35], a[140:143], v[52:55], v[32:35]
    v_max_f32 v22, v22, v23
    v_mov_b32 v23, v22
    v_mfma_f32_16x16x32_bf16 v[28:31], a[136:139], v[52:55], v[28:31]
    buffer_load_dwordx4 v1, s[8:11], s33 offen offset:2048 sc1 lds
    v_mfma_f32_16x16x32_bf16 v[28:31], a[124:127], v[48:51], v[28:31]
    v_permlane32_swap_b32 v22, v23
    v_mfma_f32_16x16x32_bf16 v[24:27], a[120:123], v[48:51], v[24:27]
    ds_read_b128 v[48:51], v3 offset:14336
    v_max_f32 v22, v22, v23
    v_mfma_f32_16x16x32_bf16 v[24:27], a[132:135], v[52:55], v[24:27]
    ds_read_b128 v[52:55], v3 offset:15360
    s_waitcnt lgkmcnt(2)
    v_mfma_f32_16x16x32_bf16 v[24:27], a[144:147], v[40:43], v[24:27]
    v_mul_f32 v22, v124, v22
    v_fma_f32 v122, v122, v124, -v22
    v_mfma_f32_16x16x32_bf16 v[24:27], a[156:159], v[44:47], v[24:27]
    buffer_load_dwordx4 v1, s[8:11], s33 offen offset:3072 sc1 lds
    v_mfma_f32_16x16x32_bf16 v[28:31], a[160:163], v[44:47], v[28:31]
    s_add_u32 m0, s34, 4096
    v_fma_f32 v123, v123, v124, -v22
    v_sub_u32 v76, v3, v20
    v_mfma_f32_16x16x32_bf16 v[28:31], a[148:151], v[40:43], v[28:31]
    s_add_u32 s37, s33, 4096
    v_exp_f32 v122, v122
    v_mfma_f32_16x16x32_bf16 v[32:35], a[152:155], v[40:43], v[32:35]
    ds_read_b128 v[40:43], v3 offset:16384
    v_cvt_pk_bf16_f32 v84, v12, v13
    v_mfma_f32_16x16x32_bf16 v[32:35], a[164:167], v[44:47], v[32:35]
    ds_read_b128 v[44:47], v3 offset:17408
    s_waitcnt lgkmcnt(2)
    v_mfma_f32_16x16x32_bf16 v[32:35], a[176:179], v[48:51], v[32:35]
    buffer_load_dwordx4 v1, s[8:11], s37 offen offset:0 sc1 lds
    v_mfma_f32_16x16x32_bf16 v[32:35], a[188:191], v[52:55], v[32:35]
    ds_read2st64_b64 v[80:83], v76 offset0:66 offset1:67
    v_cvt_pk_bf16_f32 v85, v14, v15
    v_mfma_f32_16x16x32_bf16 v[28:31], a[184:187], v[52:55], v[28:31]
    ds_read2st64_b64 v[76:79], v76 offset0:64 offset1:65
    v_fma_f32 v8, -v68, v56, v8
    v_mfma_f32_16x16x32_bf16 v[28:31], a[172:175], v[48:51], v[28:31]
    v_exp_f32 v123, v123
    v_mfma_f32_16x16x32_bf16 v[24:27], a[168:171], v[48:51], v[24:27]
    ds_read_b128 v[48:51], v3 offset:18432
    v_add_f32 v22, v122, v123
    v_mfma_f32_16x16x32_bf16 v[24:27], a[180:183], v[52:55], v[24:27]
    ds_read_b128 v[52:55], v3 offset:19456
    s_waitcnt lgkmcnt(4)
    v_mfma_f32_16x16x32_bf16 v[24:27], a[192:195], v[40:43], v[24:27]
    buffer_load_dwordx4 v1, s[8:11], s37 offen offset:1024 sc1 lds
    v_mfma_f32_16x16x32_bf16 v[24:27], a[204:207], v[44:47], v[24:27]
    v_mov_b32 v23, v22
    v_fma_f32 v9, -v68, v57, v9
    v_mfma_f32_16x16x32_bf16 v[28:31], a[208:211], v[44:47], v[28:31]
    v_permlane16_swap_b32 v22, v23
    v_mfma_f32_16x16x32_bf16 v[28:31], a[196:199], v[40:43], v[28:31]
    v_add_f32 v22, v22, v23
    v_mov_b32 v23, v22
    v_mfma_f32_16x16x32_bf16 v[32:35], a[200:203], v[40:43], v[32:35]
    ds_read_b128 v[40:43], v3 offset:20480
    v_fma_f32 v10, -v68, v58, v10
    v_mfma_f32_16x16x32_bf16 v[32:35], a[212:215], v[44:47], v[32:35]
    ds_read_b128 v[44:47], v3 offset:21504
    s_waitcnt lgkmcnt(2)
    v_mfma_f32_16x16x32_bf16 v[32:35], a[224:227], v[48:51], v[32:35]
    buffer_load_dwordx4 v1, s[8:11], s37 offen offset:2048 sc1 lds
    v_mfma_f32_16x16x32_bf16 v[32:35], a[236:239], v[52:55], v[32:35]
    v_permlane32_swap_b32 v22, v23
    v_mfma_f32_16x16x32_bf16 v[28:31], a[232:235], v[52:55], v[28:31]
    v_add_f32 v22, v22, v23
    v_fma_f32 v11, -v68, v59, v11
    v_mfma_f32_16x16x32_bf16 v[28:31], a[220:223], v[48:51], v[28:31]
    v_rcp_f32 v22, v22
    v_mfma_f32_16x16x32_bf16 v[24:27], a[216:219], v[48:51], v[24:27]
    ds_read_b128 v[48:51], v3 offset:22528
    v_mul_f32 v122, v122, v22
    v_mfma_f32_16x16x32_bf16 v[24:27], a[228:231], v[52:55], v[24:27]
    ds_read_b128 v[52:55], v3 offset:23552
    s_waitcnt lgkmcnt(2)
    v_mfma_f32_16x16x32_bf16 v[24:27], a[240:243], v[40:43], v[24:27]
    buffer_load_dwordx4 v1, s[8:11], s37 offen offset:3072 sc1 lds
    v_mfma_f32_16x16x32_bf16 v[24:27], a[252:255], v[44:47], v[24:27]
    s_add_u32 m0, s34, 8192
    v_mul_f32 v123, v123, v22
    v_cvt_pk_bf16_f32 v23, v122, v123
    v_mfma_f32_16x16x32_bf16 v[28:31], v[128:131], v[44:47], v[28:31]
    s_add_u32 s37, s33, 8192
    v_perm_b32 v114, v23, v23, v102
    v_perm_b32 v115, v23, v23, v103
    v_mfma_f32_16x16x32_bf16 v[28:31], a[244:247], v[40:43], v[28:31]
    v_perm_b32 v116, v23, v23, v104
    v_perm_b32 v117, v23, v23, v105
    v_mfma_f32_16x16x32_bf16 v[32:35], a[248:251], v[40:43], v[32:35]
    ds_read_b128 v[40:43], v3 offset:24576
    v_mov_b32 v100, v94
    v_mfma_f32_16x16x32_bf16 v[32:35], v[132:135], v[44:47], v[32:35]
    ds_read_b128 v[44:47], v3 offset:25600
    s_waitcnt lgkmcnt(2)
    v_mfma_f32_16x16x32_bf16 v[32:35], v[144:147], v[48:51], v[32:35]
    buffer_load_dwordx4 v1, s[8:11], s37 offen offset:0 sc1 lds
    v_mfma_f32_16x16x32_bf16 v[32:35], v[156:159], v[52:55], v[32:35]
    v_mov_b32 v101, v95
    v_cvt_pk_bf16_f32 v88, v8, v9
    v_mfma_f32_16x16x32_bf16 v[28:31], v[152:155], v[52:55], v[28:31]
    v_cvt_pk_bf16_f32 v89, v10, v11
    v_add_f32 v76, v76, v80
    v_mfma_f32_16x16x32_bf16 v[72:75], v[98:101], v[114:117], 0
    v_add_f32 v77, v77, v81
    v_add_f32 v78, v78, v82
    v_mfma_f32_16x16x32_bf16 v[110:113], v[84:87], v[88:91], 0
    v_mov_b32 v8, v84
    v_mov_b32 v9, v85
    v_mfma_f32_16x16x32_bf16 v[28:31], v[140:143], v[48:51], v[28:31]
    v_add_f32 v79, v79, v83
    v_add_f32 v70, v76, v78
    v_mfma_f32_16x16x32_bf16 v[24:27], v[136:139], v[48:51], v[24:27]
    ds_read_b128 v[48:51], v3 offset:26624
    v_cvt_pk_bf16_f32 v114, v72, v73
    v_mfma_f32_16x16x32_bf16 v[24:27], v[148:151], v[52:55], v[24:27]
    ds_read_b128 v[52:55], v3 offset:27648
    s_waitcnt lgkmcnt(2)
    v_mfma_f32_16x16x32_bf16 v[24:27], v[160:163], v[40:43], v[24:27]
    v_mov_b32 v10, v92
    v_mov_b32 v11, v93
    v_mfma_f32_16x16x32_bf16 v[24:27], v[172:175], v[44:47], v[24:27]
    buffer_store_dwordx4 v[8:11], v1, s[4:7], s40 offen sc1
    v_cvt_pk_bf16_f32 v115, v74, v75
    v_mfma_f32_16x16x32_bf16 v[28:31], v[176:179], v[44:47], v[28:31]
    s_add_u32 s40, s40, 262144
    v_cvt_pk_bf16_f32 v116, v72, v73
    v_cvt_pk_bf16_f32 v117, v74, v75
    v_mfma_f32_16x16x32_bf16 v[28:31], v[164:167], v[40:43], v[28:31]
    s_add_u32 s41, s41, 262144
    v_permlane32_swap_b32 v114, v116
    v_mfma_f32_16x16x32_bf16 v[32:35], v[168:171], v[40:43], v[32:35]
    ds_read_b128 v[40:43], v3 offset:28672
    v_cndmask_b32 v118, v110, v111, s[44:45]
    v_mfma_f32_16x16x32_bf16 v[32:35], v[180:183], v[44:47], v[32:35]
    ds_read_b128 v[44:47], v3 offset:29696
    s_waitcnt lgkmcnt(2)
    v_mfma_f32_16x16x32_bf16 v[32:35], v[192:195], v[48:51], v[32:35]
    s_add_u32 s31, s31, 1
    v_permlane32_swap_b32 v115, v117
    v_mfma_f32_16x16x32_bf16 v[32:35], v[204:207], v[52:55], v[32:35]
    buffer_store_dwordx4 v[114:117], v7, s[12:15], s36 offen sc1
    v_cndmask_b32 v119, v112, v113, s[44:45]
    v_mfma_f32_16x16x32_bf16 v[28:31], v[200:203], v[52:55], v[28:31]
    s_add_u32 s36, s36, 32768
    v_add_f32 v71, v77, v79
    v_add_u32 v2, s35, v1
    v_mfma_f32_16x16x32_bf16 v[28:31], v[188:191], v[48:51], v[28:31]
    s_sub_u32 s54, s31, 2
    v_mov_b32 v6, s54
    v_mfma_f32_16x16x32_bf16 v[24:27], v[184:187], v[48:51], v[24:27]
    ds_read_b128 v[48:51], v3 offset:30720
    v_mfma_f32_16x16x32_bf16 v[24:27], v[196:199], v[52:55], v[24:27]
    ds_read_b128 v[52:55], v3 offset:31744
    s_waitcnt lgkmcnt(2)
    v_mfma_f32_16x16x32_bf16 v[24:27], v[208:211], v[40:43], v[24:27]
    s_cmp_ge_i32 s31, 30
    s_cselect_b32 s18, 0x1ffff, s18
    s_add_u32 s33, s33, 34816
    v_mfma_f32_16x16x32_bf16 v[24:27], v[220:223], v[44:47], v[24:27]
    s_add_u32 s34, s34, 36864
    v_permlane16_swap_b32 v70, v71
    v_mfma_f32_16x16x32_bf16 v[28:31], v[224:227], v[44:47], v[28:31]
    s_cmp_ge_u32 s34, 147456
    s_cselect_b32 s38, 147456, 0
    v_add_f32 v70, v70, v71
    v_mfma_f32_16x16x32_bf16 v[28:31], v[212:215], v[40:43], v[28:31]
    s_sub_u32 s34, s34, s38
    s_waitcnt vmcnt(12)
    v_cmp_gt_i32 vcc, s32, v5
    v_mfma_f32_16x16x32_bf16 v[32:35], v[216:219], v[40:43], v[32:35]
    ds_read_b128 v[40:43], v2 offset:0
    v_mov_b32 v71, v70
    v_mfma_f32_16x16x32_bf16 v[32:35], v[228:231], v[44:47], v[32:35]
    ds_read_b128 v[44:47], v2 offset:1024
    s_waitcnt lgkmcnt(2)
    v_mfma_f32_16x16x32_bf16 v[32:35], v[240:243], v[48:51], v[32:35]
    s_and_b64 vcc, vcc, s[18:19]
    s_cbranch_scc1 Lqkv_slows10
Lqkv_backs10:
    v_mfma_f32_16x16x32_bf16 v[32:35], v[252:255], v[52:55], v[32:35]
    s_add_u32 s16, s16, 8192
    v_permlane32_swap_b32 v70, v71
    v_mfma_f32_16x16x32_bf16 v[28:31], v[248:251], v[52:55], v[28:31]
    s_and_b32 s16, s16, 524287
    v_add_f32 v70, v70, v71
    v_mul_f32 v70, 0x3a800000, v70
    v_mfma_f32_16x16x32_bf16 v[28:31], v[236:239], v[48:51], v[28:31]
    buffer_load_dword v5, v4, s[4:7], s16 offen sc1
    v_mfma_f32_16x16x32_bf16 v[24:27], v[232:235], v[48:51], v[24:27]
    ds_read_b128 v[48:51], v2 offset:2048
    v_mov_b32 v71, v70
    v_mfma_f32_16x16x32_bf16 v[24:27], v[244:247], v[52:55], v[24:27]
    ds_read_b128 v[52:55], v2 offset:3072
    v_permlane16_swap_b32 v70, v71
    v_fma_f32 v71, -v70, v70, v71
    v_max_f32 v71, 0, v71
    v_add_f32 v71, 0x3727c5ac, v71
    v_rsq_f32 v71, v71
    s_nop 1
    s_branch Lqkv_g00
    .p2align 6
Lqkv_g10:
    s_waitcnt lgkmcnt(2)
    v_mfma_f32_16x16x32_bf16 v[24:27], a[0:3], v[40:43], 0
    s_add_u32 m0, s34, 0
    v_mul_f32 v124, s52, v71
    v_fma_f32 v16, -v68, v64, v16
    v_mfma_f32_16x16x32_bf16 v[24:27], a[12:15], v[44:47], v[24:27]
    s_add_u32 s35, s35, 36864
    v_fma_f32 v12, -v68, v60, v12
    v_fma_f32 v13, -v68, v61, v13
    v_mfma_f32_16x16x32_bf16 v[28:31], a[16:19], v[44:47], 0
    s_cmp_eq_u32 s35, 147456
    s_cselect_b32 s35, 0, s35
    v_fma_f32 v14, -v68, v62, v14
    v_mfma_f32_16x16x32_bf16 v[28:31], a[4:7], v[40:43], v[28:31]
    v_fma_f32 v15, -v68, v63, v15
    v_mul_f32 v12, v12, v69
    v_mfma_f32_16x16x32_bf16 v[32:35], a[8:11], v[40:43], 0
    ds_read_b128 v[40:43], v3 offset:4096
    v_mul_f32 v13, v13, v69
    v_mfma_f32_16x16x32_bf16 v[32:35], a[20:23], v[44:47], v[32:35]
    ds_read_b128 v[44:47], v3 offset:5120
    s_waitcnt lgkmcnt(2)
    v_mfma_f32_16x16x32_bf16 v[32:35], a[32:35], v[48:51], v[32:35]
    v_mul_f32 v14, v14, v69
    v_mul_f32 v15, v15, v69
    v_mfma_f32_16x16x32_bf16 v[32:35], a[44:47], v[52:55], v[32:35]
    v_cvt_pk_bf16_f32 v84, v12, v13
    v_cvt_pk_bf16_f32 v85, v14, v15
    v_mfma_f32_16x16x32_bf16 v[28:31], a[40:43], v[52:55], v[28:31]
    v_fma_f32 v17, -v68, v65, v17
    v_fma_f32 v18, -v68, v66, v18
    v_mfma_f32_16x16x32_bf16 v[106:109], v[84:87], v[88:91], 0
    v_fma_f32 v19, -v68, v67, v19
    v_mul_f32 v16, v16, v69
    v_mfma_f32_16x16x32_bf16 v[28:31], a[28:31], v[48:51], v[28:31]
    v_mul_f32 v17, v17, v69
    v_mul_f32 v18, v18, v69
    v_mfma_f32_16x16x32_bf16 v[24:27], a[24:27], v[48:51], v[24:27]
    ds_read_b128 v[48:51], v3 offset:6144
    v_mul_f32 v19, v19, v69
    v_mfma_f32_16x16x32_bf16 v[24:27], a[36:39], v[52:55], v[24:27]
    ds_read_b128 v[52:55], v3 offset:7168
    s_waitcnt lgkmcnt(2)
    v_mfma_f32_16x16x32_bf16 v[24:27], a[48:51], v[40:43], v[24:27]
    v_cndmask_b32 v106, v106, v107, s[44:45]
    v_cndmask_b32 v108, v108, v109, s[44:45]
    v_mfma_f32_16x16x32_bf16 v[24:27], a[60:63], v[44:47], v[24:27]
    v_cndmask_b32 v120, v106, v118, s[48:49]
    v_cndmask_b32 v121, v108, v119, s[50:51]
    v_mfma_f32_16x16x32_bf16 v[28:31], a[64:67], v[44:47], v[28:31]
    ds_write_b64 v36, v[120:121] offset:2048
    v_mfma_f32_16x16x32_bf16 v[28:31], a[52:55], v[40:43], v[28:31]
    v_cvt_pk_bf16_f32 v16, v16, v17
    v_cvt_pk_bf16_f32 v17, v18, v19
    v_mfma_f32_16x16x32_bf16 v[32:35], a[56:59], v[40:43], v[32:35]
    ds_read_b128 v[40:43], v3 offset:8192
    v_fma_f32 v8, -v68, v56, v8
    v_mfma_f32_16x16x32_bf16 v[32:35], a[68:71], v[44:47], v[32:35]
    ds_read_b128 v[44:47], v3 offset:9216
    s_waitcnt lgkmcnt(3)
    v_mfma_f32_16x16x32_bf16 v[32:35], a[80:83], v[48:51], v[32:35]
    s_waitcnt vmcnt(3) lgkmcnt(2)
    s_barrier
    v_mfma_f32_16x16x32_bf16 v[32:35], a[92:95], v[52:55], v[32:35]
    ds_write_b64 v38, v[16:17]
    v_mfma_f32_16x16x32_bf16 v[28:31], a[88:91], v[52:55], v[28:31]
    ds_read_b64_tr_b16 v[92:93], v39
    v_fma_f32 v9, -v68, v57, v9
    v_mfma_f32_16x16x32_bf16 v[28:31], a[76:79], v[48:51], v[28:31]
    buffer_load_dwordx4 v1, s[8:11], s33 offen offset:0 sc1 lds
    v_mfma_f32_16x16x32_bf16 v[24:27], a[72:75], v[48:51], v[24:27]
    ds_read_b128 v[48:51], v3 offset:10240
    v_fma_f32 v10, -v68, v58, v10
    v_mfma_f32_16x16x32_bf16 v[24:27], a[84:87], v[52:55], v[24:27]
    ds_read_b128 v[52:55], v3 offset:11264
    s_waitcnt lgkmcnt(4)
    v_mfma_f32_16x16x32_bf16 v[24:27], a[96:99], v[40:43], v[24:27]
    s_waitcnt vmcnt(3)
    buffer_store_dword v6, v21, s[12:15], s17 offen sc1
    v_mfma_f32_16x16x32_bf16 v[24:27], a[108:111], v[44:47], v[24:27]
    ds_read_b64 v[122:123], v37 offset:2048
    v_fma_f32 v11, -v68, v59, v11
    v_mfma_f32_16x16x32_bf16 v[28:31], a[112:115], v[44:47], v[28:31]
    s_cmp_ge_i32 s54, 0
    s_cselect_b32 s14, s6, 0
    v_cvt_pk_bf16_f32 v88, v8, v9
    v_mfma_f32_16x16x32_bf16 v[28:31], a[100:103], v[40:43], v[28:31]
    s_add_u32 s17, s17, 8192
    v_sub_u32 v76, v3, v20
    v_cvt_pk_bf16_f32 v89, v10, v11
    v_mfma_f32_16x16x32_bf16 v[32:35], a[104:107], v[40:43], v[32:35]
    ds_read_b128 v[40:43], v3 offset:12288
    v_add_u32 v2, s35, v1
    v_mfma_f32_16x16x32_bf16 v[110:113], v[84:87], v[88:91], 0
    buffer_load_dwordx4 v1, s[8:11], s33 offen offset:1024 sc1 lds
    v_mfma_f32_16x16x32_bf16 v[32:35], a[116:119], v[44:47], v[32:35]
    ds_read_b128 v[44:47], v3 offset:13312
    s_waitcnt lgkmcnt(2)
    v_mfma_f32_16x16x32_bf16 v[32:35], a[128:131], v[48:51], v[32:35]
    ds_read2st64_b64 v[80:83], v76 offset0:66 offset1:67
    v_add_f32 v122, v122, v120
    v_mfma_f32_16x16x32_bf16 v[32:35], a[140:143], v[52:55], v[32:35]
    ds_read2st64_b64 v[76:79], v76 offset0:64 offset1:65
    v_add_f32 v123, v123, v121
    v_mfma_f32_16x16x32_bf16 v[28:31], a[136:139], v[52:55], v[28:31]
    v_max_f32 v22, v122, v123
    v_mov_b32 v23, v22
    v_mfma_f32_16x16x32_bf16 v[28:31], a[124:127], v[48:51], v[28:31]
    buffer_load_dwordx4 v1, s[8:11], s33 offen offset:2048 sc1 lds
    v_mfma_f32_16x16x32_bf16 v[24:27], a[120:123], v[48:51], v[24:27]
    ds_read_b128 v[48:51], v3 offset:14336
    v_cndmask_b32 v118, v110, v111, s[44:45]
    v_mfma_f32_16x16x32_bf16 v[24:27], a[132:135], v[52:55], v[24:27]
    ds_read_b128 v[52:55], v3 offset:15360
    s_waitcnt lgkmcnt(4)
    v_mfma_f32_16x16x32_bf16 v[24:27], a[144:147], v[40:43], v[24:27]
    v_permlane16_swap_b32 v22, v23
    v_mfma_f32_16x16x32_bf16 v[24:27], a[156:159], v[44:47], v[24:27]
    v_max_f32 v22, v22, v23
    v_mov_b32 v23, v22
    v_mfma_f32_16x16x32_bf16 v[28:31], a[160:163], v[44:47], v[28:31]
    buffer_load_dwordx4 v1, s[8:11], s33 offen offset:3072 sc1 lds
    v_mfma_f32_16x16x32_bf16 v[28:31], a[148:151], v[40:43], v[28:31]
    s_add_u32 m0, s34, 4096
    v_permlane32_swap_b32 v22, v23
    v_mfma_f32_16x16x32_bf16 v[32:35], a[152:155], v[40:43], v[32:35]
    ds_read_b128 v[40:43], v3 offset:16384
    v_max_f32 v22, v22, v23
    v_mfma_f32_16x16x32_bf16 v[32:35], a[164:167], v[44:47], v[32:35]
    ds_read_b128 v[44:47], v3 offset:17408
    s_waitcnt lgkmcnt(2)
    v_mfma_f32_16x16x32_bf16 v[32:35], a[176:179], v[48:51], v[32:35]
    s_add_u32 s37, s33, 4096
    v_mul_f32 v22, v124, v22
    v_fma_f32 v122, v122, v124, -v22
    v_mfma_f32_16x16x32_bf16 v[32:35], a[188:191], v[52:55], v[32:35]
    buffer_load_dwordx4 v1, s[8:11], s37 offen offset:0 sc1 lds
    v_mfma_f32_16x16x32_bf16 v[28:31], a[184:187], v[52:55], v[28:31]
    v_fma_f32 v123, v123, v124, -v22
    v_cndmask_b32 v119, v112, v113, s[44:45]
    v_mfma_f32_16x16x32_bf16 v[28:31], a[172:175], v[48:51], v[28:31]
    v_exp_f32 v122, v122
    v_mfma_f32_16x16x32_bf16 v[24:27], a[168:171], v[48:51], v[24:27]
    ds_read_b128 v[48:51], v3 offset:18432
    v_add_f32 v76, v76, v80
    v_mfma_f32_16x16x32_bf16 v[24:27], a[180:183], v[52:55], v[24:27]
    ds_read_b128 v[52:55], v3 offset:19456
    s_waitcnt lgkmcnt(2)
    v_mfma_f32_16x16x32_bf16 v[24:27], a[192:195], v[40:43], v[24:27]
    buffer_load_dwordx4 v1, s[8:11], s37 offen offset:1024 sc1 lds
    v_mfma_f32_16x16x32_bf16 v[24:27], a[204:207], v[44:47], v[24:27]
    v_exp_f32 v123, v123
    v_mfma_f32_16x16x32_bf16 v[28:31], a[208:211], v[44:47], v[28:31]
    v_add_f32 v22, v122, v123
    v_mov_b32 v23, v22
    v_mfma_f32_16x16x32_bf16 v[28:31], a[196:199], v[40:43], v[28:31]
    s_nop 0
    v_permlane16_swap_b32 v22, v23
    v_mfma_f32_16x16x32_bf16 v[32:35], a[200:203], v[40:43], v[32:35]
    ds_read_b128 v[40:43], v3 offset:20480
    v_add_f32 v22, v22, v23
    v_mfma_f32_16x16x32_bf16 v[32:35], a[212:215], v[44:47], v[32:35]
    ds_read_b128 v[44:47], v3 offset:21504
    s_waitcnt lgkmcnt(2)
    v_mfma_f32_16x16x32_bf16 v[32:35], a[224:227], v[48:51], v[32:35]
    buffer_load_dwordx4 v1, s[8:11], s37 offen offset:2048 sc1 lds
    v_mfma_f32_16x16x32_bf16 v[32:35], a[236:239], v[52:55], v[32:35]
    v_mov_b32 v23, v22
    v_add_f32 v77, v77, v81
    v_mfma_f32_16x16x32_bf16 v[28:31], a[232:235], v[52:55], v[28:31]
    v_permlane32_swap_b32 v22, v23
    v_mfma_f32_16x16x32_bf16 v[28:31], a[220:223], v[48:51], v[28:31]
    v_add_f32 v22, v22, v23
    v_add_f32 v78, v78, v82
    v_mfma_f32_16x16x32_bf16 v[24:27], a[216:219], v[48:51], v[24:27]
    ds_read_b128 v[48:51], v3 offset:22528
    v_add_f32 v79, v79, v83
    v_mfma_f32_16x16x32_bf16 v[24:27], a[228:231], v[52:55], v[24:27]
    ds_read_b128 v[52:55], v3 offset:23552
    s_waitcnt lgkmcnt(2)
    v_mfma_f32_16x16x32_bf16 v[24:27], a[240:243], v[40:43], v[24:27]
    buffer_load_dwordx4 v1, s[8:11], s37 offen offset:3072 sc1 lds
    v_mfma_f32_16x16x32_bf16 v[24:27], a[252:255], v[44:47], v[24:27]
    s_add_u32 m0, s34, 8192
    v_rcp_f32 v22, v22
    v_mfma_f32_16x16x32_bf16 v[28:31], v[128:131], v[44:47], v[28:31]
    s_add_u32 s37, s33, 8192
    v_mul_f32 v122, v122, v22
    v_mul_f32 v123, v123, v22
    v_mfma_f32_16x16x32_bf16 v[28:31], a[244:247], v[40:43], v[28:31]
    v_cvt_pk_bf16_f32 v23, v122, v123
    v_perm_b32 v114, v23, v23, v102
    v_mfma_f32_16x16x32_bf16 v[32:35], a[248:251], v[40:43], v[32:35]
    ds_read_b128 v[40:43], v3 offset:24576
    v_perm_b32 v115, v23, v23, v103
    v_mfma_f32_16x16x32_bf16 v[32:35], v[132:135], v[44:47], v[32:35]
    ds_read_b128 v[44:47], v3 offset:25600
    s_waitcnt lgkmcnt(2)
    v_mfma_f32_16x16x32_bf16 v[32:35], v[144:147], v[48:51], v[32:35]
    buffer_load_dwordx4 v1, s[8:11], s37 offen offset:0 sc1 lds
    v_mfma_f32_16x16x32_bf16 v[32:35], v[156:159], v[52:55], v[32:35]
    v_perm_b32 v116, v23, v23, v104
    v_perm_b32 v117, v23, v23, v105
    v_mfma_f32_16x16x32_bf16 v[28:31], v[152:155], v[52:55], v[28:31]
    v_add_f32 v70, v76, v78
    v_add_f32 v71, v77, v79
    v_mfma_f32_16x16x32_bf16 v[72:75], v[92:95], v[114:117], 0
    s_nop 0
    v_permlane16_swap_b32 v70, v71
    v_mfma_f32_16x16x32_bf16 v[28:31], v[140:143], v[48:51], v[28:31]
    v_add_f32 v70, v70, v71
    v_mov_b32 v71, v70
    v_mfma_f32_16x16x32_bf16 v[24:27], v[136:139], v[48:51], v[24:27]
    ds_read_b128 v[48:51], v3 offset:26624
    v_mfma_f32_16x16x32_bf16 v[24:27], v[148:151], v[52:55], v[24:27]
    ds_read_b128 v[52:55], v3 offset:27648
    s_waitcnt lgkmcnt(2)
    v_mfma_f32_16x16x32_bf16 v[24:27], v[160:163], v[40:43], v[24:27]
    v_cvt_pk_bf16_f32 v114, v72, v73
    v_cvt_pk_bf16_f32 v115, v74, v75
    v_mfma_f32_16x16x32_bf16 v[24:27], v[172:175], v[44:47], v[24:27]
    v_cvt_pk_bf16_f32 v116, v72, v73
    v_cvt_pk_bf16_f32 v117, v74, v75
    v_mfma_f32_16x16x32_bf16 v[28:31], v[176:179], v[44:47], v[28:31]
    v_permlane32_swap_b32 v114, v116
    v_mfma_f32_16x16x32_bf16 v[28:31], v[164:167], v[40:43], v[28:31]
    s_add_u32 s31, s31, 1
    v_permlane32_swap_b32 v115, v117
    v_mfma_f32_16x16x32_bf16 v[32:35], v[168:171], v[40:43], v[32:35]
    ds_read_b128 v[40:43], v3 offset:28672
    s_sub_u32 s54, s31, 2
    v_mfma_f32_16x16x32_bf16 v[32:35], v[180:183], v[44:47], v[32:35]
    ds_read_b128 v[44:47], v3 offset:29696
    s_waitcnt lgkmcnt(2)
    v_mfma_f32_16x16x32_bf16 v[32:35], v[192:195], v[48:51], v[32:35]
    buffer_store_dwordx4 v[114:117], v7, s[12:15], s36 offen sc1
    v_mov_b32 v6, s54
    v_mfma_f32_16x16x32_bf16 v[32:35], v[204:207], v[52:55], v[32:35]
    s_add_u32 s36, s36, 32768
    v_permlane32_swap_b32 v70, v71
    v_mfma_f32_16x16x32_bf16 v[28:31], v[200:203], v[52:55], v[28:31]
    s_cmp_ge_i32 s31, 30
    s_cselect_b32 s18, 0x1ffff, s18
    v_add_f32 v70, v70, v71
    v_mfma_f32_16x16x32_bf16 v[28:31], v[188:191], v[48:51], v[28:31]
    s_add_u32 s33, s33, 34816
    v_mul_f32 v70, 0x3a800000, v70
    v_mov_b32 v71, v70
    v_mfma_f32_16x16x32_bf16 v[24:27], v[184:187], v[48:51], v[24:27]
    ds_read_b128 v[48:51], v3 offset:30720
    s_add_u32 s34, s34, 36864
    v_mfma_f32_16x16x32_bf16 v[24:27], v[196:199], v[52:55], v[24:27]
    ds_read_b128 v[52:55], v3 offset:31744
    s_waitcnt lgkmcnt(2)
    v_mfma_f32_16x16x32_bf16 v[24:27], v[208:211], v[40:43], v[24:27]
    s_cmp_ge_u32 s34, 147456
    s_cselect_b32 s38, 147456, 0
    s_sub_u32 s34, s34, s38
    v_mfma_f32_16x16x32_bf16 v[24:27], v[220:223], v[44:47], v[24:27]
    s_waitcnt vmcnt(11)
    v_cmp_gt_i32 vcc, s32, v5
    v_mfma_f32_16x16x32_bf16 v[28:31], v[224:227], v[44:47], v[28:31]
    v_permlane16_swap_b32 v70, v71
    v_mfma_f32_16x16x32_bf16 v[28:31], v[212:215], v[40:43], v[28:31]
    s_and_b64 vcc, vcc, s[18:19]
    s_cbranch_scc1 Lqkv_slowg10
Lqkv_backg10:
    v_mfma_f32_16x16x32_bf16 v[32:35], v[216:219], v[40:43], v[32:35]
    ds_read_b128 v[40:43], v2 offset:0
    v_fma_f32 v71, -v70, v70, v71
    v_mfma_f32_16x16x32_bf16 v[32:35], v[228:231], v[44:47], v[32:35]
    ds_read_b128 v[44:47], v2 offset:1024
    s_waitcnt lgkmcnt(2)
    v_mfma_f32_16x16x32_bf16 v[32:35], v[240:243], v[48:51], v[32:35]
    s_add_u32 s16, s16, 8192
    v_max_f32 v71, 0, v71
    v_add_f32 v71, 0x3727c5ac, v71
    v_mfma_f32_16x16x32_bf16 v[32:35], v[252:255], v[52:55], v[32:35]
    s_and_b32 s16, s16, 524287
    v_rsq_f32 v71, v71
    v_mfma_f32_16x16x32_bf16 v[28:31], v[248:251], v[52:55], v[28:31]
    buffer_load_dword v5, v4, s[4:7], s16 offen sc1
    v_mfma_f32_16x16x32_bf16 v[28:31], v[236:239], v[48:51], v[28:31]
    v_mfma_f32_16x16x32_bf16 v[24:27], v[232:235], v[48:51], v[24:27]
    ds_read_b128 v[48:51], v2 offset:2048
    v_mfma_f32_16x16x32_bf16 v[24:27], v[244:247], v[52:55], v[24:27]
    ds_read_b128 v[52:55], v2 offset:3072
    s_cmp_eq_u32 s31, 64
    s_cbranch_scc1 Lqkv_tail
Lqkv_g00:
    s_waitcnt lgkmcnt(2)
    v_mfma_f32_16x16x32_bf16 v[8:11], a[0:3], v[40:43], 0
    s_add_u32 m0, s34, 0
    v_mul_f32 v124, s52, v69
    v_fma_f32 v32, -v70, v64, v32
    v_mfma_f32_16x16x32_bf16 v[8:11], a[12:15], v[44:47], v[8:11]
    s_add_u32 s35, s35, 36864
    v_fma_f32 v28, -v70, v60, v28
    v_fma_f32 v29, -v70, v61, v29
    v_mfma_f32_16x16x32_bf16 v[12:15], a[16:19], v[44:47], 0
    s_cmp_eq_u32 s35, 147456
    s_cselect_b32 s35, 0, s35
    v_fma_f32 v30, -v70, v62, v30
    v_mfma_f32_16x16x32_bf16 v[12:15], a[4:7], v[40:43], v[12:15]
    v_fma_f32 v31, -v70, v63, v31
    v_mul_f32 v28, v28, v71
    v_mfma_f32_16x16x32_bf16 v[16:19], a[8:11], v[40:43], 0
    ds_read_b128 v[40:43], v2 offset:4096
    v_mul_f32 v29, v29, v71
    v_mfma_f32_16x16x32_bf16 v[16:19], a[20:23], v[44:47], v[16:19]
    ds_read_b128 v[44:47], v2 offset:5120
    s_waitcnt lgkmcnt(2)
    v_mfma_f32_16x16x32_bf16 v[16:19], a[32:35], v[48:51], v[16:19]
    v_mul_f32 v30, v30, v71
    v_mul_f32 v31, v31, v71
    v_mfma_f32_16x16x32_bf16 v[16:19], a[44:47], v[52:55], v[16:19]
    v_cvt_pk_bf16_f32 v84, v28, v29
    v_cvt_pk_bf16_f32 v85, v30, v31
    v_mfma_f32_16x16x32_bf16 v[12:15], a[40:43], v[52:55], v[12:15]
    v_fma_f32 v33, -v70, v65, v33
    v_fma_f32 v34, -v70, v66, v34
    v_mfma_f32_16x16x32_bf16 v[106:109], v[84:87], v[88:91], 0
    v_fma_f32 v35, -v70, v67, v35
    v_mul_f32 v32, v32, v71
    v_mfma_f32_16x16x32_bf16 v[12:15], a[28:31], v[48:51], v[12:15]
    v_mul_f32 v33, v33, v71
    v_mul_f32 v34, v34, v71
    v_mfma_f32_16x16x32_bf16 v[8:11], a[24:27], v[48:51], v[8:11]
    ds_read_b128 v[48:51], v2 offset:6144
    v_mul_f32 v35, v35, v71
    v_mfma_f32_16x16x32_bf16 v[8:11], a[36:39], v[52:55], v[8:11]
    ds_read_b128 v[52:55], v2 offset:7168
    s_waitcnt lgkmcnt(2)
    v_mfma_f32_16x16x32_bf16 v[8:11], a[48:51], v[40:43], v[8:11]
    v_cndmask_b32 v106, v106, v107, s[44:45]
    v_cndmask_b32 v108, v108, v109, s[44:45]
    v_mfma_f32_16x16x32_bf16 v[8:11], a[60:63], v[44:47], v[8:11]
    v_cndmask_b32 v120, v106, v118, s[48:49]
    v_cndmask_b32 v121, v108, v119, s[50:51]
    v_mfma_f32_16x16x32_bf16 v[12:15], a[64:67], v[44:47], v[12:15]
    ds_write_b64 v36, v[120:121] offset:0
    v_mfma_f32_16x16x32_bf16 v[12:15], a[52:55], v[40:43], v[12:15]
    v_cvt_pk_bf16_f32 v32, v32, v33
    v_cvt_pk_bf16_f32 v33, v34, v35
    v_mfma_f32_16x16x32_bf16 v[16:19], a[56:59], v[40:43], v[16:19]
    ds_read_b128 v[40:43], v2 offset:8192
    v_fma_f32 v24, -v70, v56, v24
    v_mfma_f32_16x16x32_bf16 v[16:19], a[68:71], v[44:47], v[16:19]
    ds_read_b128 v[44:47], v2 offset:9216
    s_waitcnt lgkmcnt(3)
    v_mfma_f32_16x16x32_bf16 v[16:19], a[80:83], v[48:51], v[16:19]
    s_waitcnt vmcnt(2) lgkmcnt(2)
    s_barrier
    v_mfma_f32_16x16x32_bf16 v[16:19], a[92:95], v[52:55], v[16:19]
    ds_write_b64 v38, v[32:33]
    v_mfma_f32_16x16x32_bf16 v[12:15], a[88:91], v[52:55], v[12:15]
    ds_read_b64_tr_b16 v[94:95], v39
    v_fma_f32 v25, -v70, v57, v25
    v_mfma_f32_16x16x32_bf16 v[12:15], a[76:79], v[48:51], v[12:15]
    buffer_load_dwordx4 v1, s[8:11], s33 offen offset:0 sc1 lds
    v_mfma_f32_16x16x32_bf16 v[8:11], a[72:75], v[48:51], v[8:11]
    ds_read_b128 v[48:51], v2 offset:10240
    v_fma_f32 v26, -v70, v58, v26
    v_mfma_f32_16x16x32_bf16 v[8:11], a[84:87], v[52:55], v[8:11]
    ds_read_b128 v[52:55], v2 offset:11264
    s_waitcnt lgkmcnt(4)
    v_mfma_f32_16x16x32_bf16 v[8:11], a[96:99], v[40:43], v[8:11]
    s_waitcnt vmcnt(2)
    buffer_store_dword v6, v21, s[12:15], s17 offen sc1
    v_mfma_f32_16x16x32_bf16 v[8:11], a[108:111], v[44:47], v[8:11]
    ds_read_b64 v[122:123], v37 offset:0
    v_fma_f32 v27, -v70, v59, v27
    v_mfma_f32_16x16x32_bf16 v[12:15], a[112:115], v[44:47], v[12:15]
    s_cmp_ge_i32 s54, 0
    s_cselect_b32 s14, s6, 0
    v_cvt_pk_bf16_f32 v88, v24, v25
    v_mfma_f32_16x16x32_bf16 v[12:15], a[100:103], v[40:43], v[12:15]
    s_add_u32 s17, s17, 8192
    v_sub_u32 v76, v2, v20
    v_cvt_pk_bf16_f32 v89, v26, v27
    v_mfma_f32_16x16x32_bf16 v[16:19], a[104:107], v[40:43], v[16:19]
    ds_read_b128 v[40:43], v2 offset:12288
    v_add_u32 v3, s35, v1
    v_mfma_f32_16x16x32_bf16 v[110:113], v[84:87], v[88:91], 0
    buffer_load_dwordx4 v1, s[8:11], s33 offen offset:1024 sc1 lds
    v_mfma_f32_16x16x32_bf16 v[16:19], a[116:119], v[44:47], v[16:19]
    ds_read_b128 v[44:47], v2 offset:13312
    s_waitcnt lgkmcnt(2)
    v_mfma_f32_16x16x32_bf16 v[16:19], a[128:131], v[48:51], v[16:19]
    ds_read2st64_b64 v[80:83], v76 offset0:66 offset1:67
    v_add_f32 v122, v122, v120
    v_mfma_f32_16x16x32_bf16 v[16:19], a[140:143], v[52:55], v[16:19]
    ds_read2st64_b64 v[76:79], v76 offset0:64 offset1:65
    v_add_f32 v123, v123, v121
    v_mfma_f32_16x16x32_bf16 v[12:15], a[136:139], v[52:55], v[12:15]
    v_max_f32 v22, v122, v123
    v_mov_b32 v23, v22
    v_mfma_f32_16x16x32_bf16 v[12:15], a[124:127], v[48:51], v[12:15]
    buffer_load_dwordx4 v1, s[8:11], s33 offen offset:2048 sc1 lds
    v_mfma_f32_16x16x32_bf16 v[8:11], a[120:123], v[48:51], v[8:11]
    ds_read_b128 v[48:51], v2 offset:14336
    v_cndmask_b32 v118, v110, v111, s[44:45]
    v_mfma_f32_16x16x32_bf16 v[8:11], a[132:135], v[52:55], v[8:11]
    ds_read_b128 v[52:55], v2 offset:15360
    s_waitcnt lgkmcnt(4)
    v_mfma_f32_16x16x32_bf16 v[8:11], a[144:147], v[40:43], v[8:11]
    v_permlane16_swap_b32 v22, v23
    v_mfma_f32_16x16x32_bf16 v[8:11], a[156:159], v[44:47], v[8:11]
    v_max_f32 v22, v22, v23
    v_mov_b32 v23, v22
    v_mfma_f32_16x16x32_bf16 v[12:15], a[160:163], v[44:47], v[12:15]
    buffer_load_dwordx4 v1, s[8:11], s33 offen offset:3072 sc1 lds
    v_mfma_f32_16x16x32_bf16 v[12:15], a[148:151], v[40:43], v[12:15]
    s_add_u32 m0, s34, 4096
    v_permlane32_swap_b32 v22, v23
    v_mfma_f32_16x16x32_bf16 v[16:19], a[152:155], v[40:43], v[16:19]
    ds_read_b128 v[40:43], v2 offset:16384
    v_max_f32 v22, v22, v23
    v_mfma_f32_16x16x32_bf16 v[16:19], a[164:167], v[44:47], v[16:19]
    ds_read_b128 v[44:47], v2 offset:17408
    s_waitcnt lgkmcnt(2)
    v_mfma_f32_16x16x32_bf16 v[16:19], a[176:179], v[48:51], v[16:19]
    s_add_u32 s37, s33, 4096
    v_mul_f32 v22, v124, v22
    v_fma_f32 v122, v122, v124, -v22
    v_mfma_f32_16x16x32_bf16 v[16:19], a[188:191], v[52:55], v[16:19]
    buffer_load_dwordx4 v1, s[8:11], s37 offen offset:0 sc1 lds
    v_mfma_f32_16x16x32_bf16 v[12:15], a[184:187], v[52:55], v[12:15]
    v_fma_f32 v123, v123, v124, -v22
    v_cndmask_b32 v119, v112, v113, s[44:45]
    v_mfma_f32_16x16x32_bf16 v[12:15], a[172:175], v[48:51], v[12:15]
    v_exp_f32 v122, v122
    v_mfma_f32_16x16x32_bf16 v[8:11], a[168:171], v[48:51], v[8:11]
    ds_read_b128 v[48:51], v2 offset:18432
    v_add_f32 v76, v76, v80
    v_mfma_f32_16x16x32_bf16 v[8:11], a[180:183], v[52:55], v[8:11]
    ds_read_b128 v[52:55], v2 offset:19456
    s_waitcnt lgkmcnt(2)
    v_mfma_f32_16x16x32_bf16 v[8:11], a[192:195], v[40:43], v[8:11]
    buffer_load_dwordx4 v1, s[8:11], s37 offen offset:1024 sc1 lds
    v_mfma_f32_16x16x32_bf16 v[8:11], a[204:207], v[44:47], v[8:11]
    v_exp_f32 v123, v123
    v_mfma_f32_16x16x32_bf16 v[12:15], a[208:211], v[44:47], v[12:15]
    v_add_f32 v22, v122, v123
    v_mov_b32 v23, v22
    v_mfma_f32_16x16x32_bf16 v[12:15], a[196:199], v[40:43], v[12:15]
    s_nop 0
    v_permlane16_swap_b32 v22, v23
    v_mfma_f32_16x16x32_bf16 v[16:19], a[200:203], v[40:43], v[16:19]
    ds_read_b128 v[40:43], v2 offset:20480
    v_add_f32 v22, v22, v23
    v_mfma_f32_16x16x32_bf16 v[16:19], a[212:215], v[44:47], v[16:19]
    ds_read_b128 v[44:47], v2 offset:21504
    s_waitcnt lgkmcnt(2)
    v_mfma_f32_16x16x32_bf16 v[16:19], a[224:227], v[48:51], v[16:19]
    buffer_load_dwordx4 v1, s[8:11], s37 offen offset:2048 sc1 lds
    v_mfma_f32_16x16x32_bf16 v[16:19], a[236:239], v[52:55], v[16:19]
    v_mov_b32 v23, v22
    v_add_f32 v77, v77, v81
    v_mfma_f32_16x16x32_bf16 v[12:15], a[232:235], v[52:55], v[12:15]
    v_permlane32_swap_b32 v22, v23
    v_mfma_f32_16x16x32_bf16 v[12:15], a[220:223], v[48:51], v[12:15]
    v_add_f32 v22, v22, v23
    v_add_f32 v78, v78, v82
    v_mfma_f32_16x16x32_bf16 v[8:11], a[216:219], v[48:51], v[8:11]
    ds_read_b128 v[48:51], v2 offset:22528
    v_add_f32 v79, v79, v83
    v_mfma_f32_16x16x32_bf16 v[8:11], a[228:231], v[52:55], v[8:11]
    ds_read_b128 v[52:55], v2 offset:23552
    s_waitcnt lgkmcnt(2)
    v_mfma_f32_16x16x32_bf16 v[8:11], a[240:243], v[40:43], v[8:11]
    buffer_load_dwordx4 v1, s[8:11], s37 offen offset:3072 sc1 lds
    v_mfma_f32_16x16x32_bf16 v[8:11], a[252:255], v[44:47], v[8:11]
    s_add_u32 m0, s34, 8192
    v_rcp_f32 v22, v22
    v_mfma_f32_16x16x32_bf16 v[12:15], v[128:131], v[44:47], v[12:15]
    s_add_u32 s37, s33, 8192
    v_mul_f32 v122, v122, v22
    v_mul_f32 v123, v123, v22
    v_mfma_f32_16x16x32_bf16 v[12:15], a[244:247], v[40:43], v[12:15]
    v_cvt_pk_bf16_f32 v23, v122, v123
    v_perm_b32 v116, v23, v23, v102
    v_mfma_f32_16x16x32_bf16 v[16:19], a[248:251], v[40:43], v[16:19]
    ds_read_b128 v[40:43], v2 offset:24576
    v_perm_b32 v117, v23, v23, v103
    v_mfma_f32_16x16x32_bf16 v[16:19], v[132:135], v[44:47], v[16:19]
    ds_read_b128 v[44:47], v2 offset:25600
    s_waitcnt lgkmcnt(2)
    v_mfma_f32_16x16x32_bf16 v[16:19], v[144:147], v[48:51], v[16:19]
    buffer_load_dwordx4 v1, s[8:11], s37 offen offset:0 sc1 lds
    v_mfma_f32_16x16x32_bf16 v[16:19], v[156:159], v[52:55], v[16:19]
    v_perm_b32 v114, v23, v23, v104
    v_perm_b32 v115, v23, v23, v105
    v_mfma_f32_16x16x32_bf16 v[12:15], v[152:155], v[52:55], v[12:15]
    v_add_f32 v68, v76, v78
    v_add_f32 v69, v77, v79
    v_mfma_f32_16x16x32_bf16 v[72:75], v[92:95], v[114:117], 0
    s_nop 0
    v_permlane16_swap_b32 v68, v69
    v_mfma_f32_16x16x32_bf16 v[12:15], v[140:143], v[48:51], v[12:15]
    v_add_f32 v68, v68, v69
    v_mov_b32 v69, v68
    v_mfma_f32_16x16x32_bf16 v[8:11], v[136:139], v[48:51], v[8:11]
    ds_read_b128 v[48:51], v2 offset:26624
    v_mfma_f32_16x16x32_bf16 v[8:11], v[148:151], v[52:55], v[8:11]
    ds_read_b128 v[52:55], v2 offset:27648
    s_waitcnt lgkmcnt(2)
    v_mfma_f32_16x16x32_bf16 v[8:11], v[160:163], v[40:43], v[8:11]
    v_cvt_pk_bf16_f32 v114, v72, v73
    v_cvt_pk_bf16_f32 v115, v74, v75
    v_mfma_f32_16x16x32_bf16 v[8:11], v[172:175], v[44:47], v[8:11]
    v_cvt_pk_bf16_f32 v116, v72, v73
    v_cvt_pk_bf16_f32 v117, v74, v75
    v_mfma_f32_16x16x32_bf16 v[12:15], v[176:179], v[44:47], v[12:15]
    v_permlane32_swap_b32 v114, v116
    v_mfma_f32_16x16x32_bf16 v[12:15], v[164:167], v[40:43], v[12:15]
    s_add_u32 s31, s31, 1
    v_permlane32_swap_b32 v115, v117
    v_mfma_f32_16x16x32_bf16 v[16:19], v[168:171], v[40:43], v[16:19]
    ds_read_b128 v[40:43], v2 offset:28672
    s_sub_u32 s54, s31, 2
    v_mfma_f32_16x16x32_bf16 v[16:19], v[180:183], v[44:47], v[16:19]
    ds_read_b128 v[44:47], v2 offset:29696
    s_waitcnt lgkmcnt(2)
    v_mfma_f32_16x16x32_bf16 v[16:19], v[192:195], v[48:51], v[16:19]
    buffer_store_dwordx4 v[114:117], v7, s[12:15], s36 offen sc1
    v_mov_b32 v6, s54
    v_mfma_f32_16x16x32_bf16 v[16:19], v[204:207], v[52:55], v[16:19]
    s_add_u32 s36, s36, 32768
    v_permlane32_swap_b32 v68, v69
    v_mfma_f32_16x16x32_bf16 v[12:15], v[200:203], v[52:55], v[12:15]
    s_cmp_ge_i32 s31, 30
    s_cselect_b32 s18, 0x1ffff, s18
    v_add_f32 v68, v68, v69
    v_mfma_f32_16x16x32_bf16 v[12:15], v[188:191], v[48:51], v[12:15]
    s_add_u32 s33, s33, 34816
    v_mul_f32 v68, 0x3a800000, v68
    v_mov_b32 v69, v68
    v_mfma_f32_16x16x32_bf16 v[8:11], v[184:187], v[48:51], v[8:11]
    ds_read_b128 v[48:51], v2 offset:30720
    s_add_u32 s34, s34, 36864
    v_mfma_f32_16x16x32_bf16 v[8:11], v[196:199], v[52:55], v[8:11]
    ds_read_b128 v[52:55], v2 offset:31744
    s_waitcnt lgkmcnt(2)
    v_mfma_f32_16x16x32_bf16 v[8:11], v[208:211], v[40:43], v[8:11]
    s_cmp_ge_u32 s34, 147456
    s_cselect_b32 s38, 147456, 0
    s_sub_u32 s34, s34, s38
    v_mfma_f32_16x16x32_bf16 v[8:11], v[220:223], v[44:47], v[8:11]
    buffer_load_dwordx4 v[96:99], v1, s[24:27], s41 offen sc1
    v_mfma_f32_16x16x32_bf16 v[12:15], v[224:227], v[44:47], v[12:15]
    s_waitcnt vmcnt(12)
    v_cmp_gt_i32 vcc, s32, v5
    v_mfma_f32_16x16x32_bf16 v[12:15], v[212:215], v[40:43], v[12:15]
    v_permlane16_swap_b32 v68, v69
    v_mfma_f32_16x16x32_bf16 v[16:19], v[216:219], v[40:43], v[16:19]
    ds_read_b128 v[40:43], v3 offset:0
    v_fma_f32 v69, -v68, v68, v69
    v_mfma_f32_16x16x32_bf16 v[16:19], v[228:231], v[44:47], v[16:19]
    ds_read_b128 v[44:47], v3 offset:1024
    s_waitcnt lgkmcnt(2)
    v_mfma_f32_16x16x32_bf16 v[16:19], v[240:243], v[48:51], v[16:19]
    s_and_b64 vcc, vcc, s[18:19]
    s_cbranch_scc1 Lqkv_slowg00
Lqkv_backg00:
    v_mfma_f32_16x16x32_bf16 v[16:19], v[252:255], v[52:55], v[16:19]
    s_add_u32 s16, s16, 8192
    v_max_f32 v69, 0, v69
    v_add_f32 v69, 0x3727c5ac, v69
    v_mfma_f32_16x16x32_bf16 v[12:15], v[248:251], v[52:55], v[12:15]
    s_and_b32 s16, s16, 524287
    v_rsq_f32 v69, v69
    v_mfma_f32_16x16x32_bf16 v[12:15], v[236:239], v[48:51], v[12:15]
    buffer_load_dword v5, v4, s[4:7], s16 offen sc1
    v_mfma_f32_16x16x32_bf16 v[8:11], v[232:235], v[48:51], v[8:11]
    ds_read_b128 v[48:51], v3 offset:2048
    v_mfma_f32_16x16x32_bf16 v[8:11], v[244:247], v[52:55], v[8:11]
    ds_read_b128 v[52:55], v3 offset:3072
    s_and_b32 s37, s31, 30
    s_cbranch_scc1 Lqkv_g10
    s_branch Lqkv_s10
Lqkv_slows10:
Lqkv_spins10:
    buffer_load_dword v5, v4, s[4:7], s16 offen sc1
    s_waitcnt vmcnt(0)
    v_cmp_gt_i32 vcc, s32, v5
    s_sub_u32 s43, s43, 1
    s_cmp_lt_i32 s43, 0
    s_cbranch_scc1 Lqkv_backs10
    s_and_b64 vcc, vcc, s[18:19]
    s_cbranch_scc0 Lqkv_backs10
    s_sleep 8
    s_branch Lqkv_spins10
Lqkv_slowg10:
Lqkv_sping10:
    buffer_load_dword v5, v4, s[4:7], s16 offen sc1
    s_waitcnt vmcnt(0)
    v_cmp_gt_i32 vcc, s32, v5
    s_sub_u32 s43, s43, 1
    s_cmp_lt_i32 s43, 0
    s_cbranch_scc1 Lqkv_backg10
    s_and_b64 vcc, vcc, s[18:19]
    s_cbranch_scc0 Lqkv_backg10
    s_sleep 8
    s_branch Lqkv_sping10
Lqkv_slowg00:
Lqkv_sping00:
    buffer_load_dword v5, v4, s[4:7], s16 offen sc1
    s_waitcnt vmcnt(0)
    v_cmp_gt_i32 vcc, s32, v5
    s_sub_u32 s43, s43, 1
    s_cmp_lt_i32 s43, 0
    s_cbranch_scc1 Lqkv_backg00
    s_and_b64 vcc, vcc, s[18:19]
    s_cbranch_scc0 Lqkv_backg00
    s_sleep 8
    s_branch Lqkv_sping00
Lqkv_s11:
    s_waitcnt lgkmcnt(2)
    v_mfma_f32_16x16x32_bf16 v[24:27], a[0:3], v[40:43], 0
    s_add_u32 m0, s34, 0
    v_mul_f32 v124, s52, v71
    v_mov_b32 v106, s42
    v_mfma_f32_16x16x32_bf16 v[24:27], a[12:15], v[44:47], v[24:27]
    s_add_u32 s35, s35, 36864
    v_mov_b32 v107, s42
    v_mov_b32 v108, s42
    v_mfma_f32_16x16x32_bf16 v[28:31], a[16:19], v[44:47], 0
    s_cmp_eq_u32 s35, 147456
    s_cselect_b32 s35, 0, s35
    v_mov_b32 v109, s42
    v_mfma_f32_16x16x32_bf16 v[28:31], a[4:7], v[40:43], v[28:31]
    s_waitcnt vmcnt(1)
    v_fma_f32 v16, -v68, v64, v16
    v_fma_f32 v17, -v68, v65, v17
    v_mfma_f32_16x16x32_bf16 v[106:109], v[96:99], v[88:91], v[106:109]
    v_fma_f32 v18, -v68, v66, v18
    v_fma_f32 v19, -v68, v67, v19
    v_mfma_f32_16x16x32_bf16 v[32:35], a[8:11], v[40:43], 0
    ds_read_b128 v[40:43], v3 offset:4096
    v_mul_f32 v16, v16, v69
    v_mfma_f32_16x16x32_bf16 v[32:35], a[20:23], v[44:47], v[32:35]
    ds_read_b128 v[44:47], v3 offset:5120
    s_waitcnt lgkmcnt(2)
    v_mfma_f32_16x16x32_bf16 v[32:35], a[32:35], v[48:51], v[32:35]
    v_cndmask_b32 v106, v106, v107, s[44:45]
    v_cndmask_b32 v108, v108, v109, s[44:45]
    v_mfma_f32_16x16x32_bf16 v[32:35], a[44:47], v[52:55], v[32:35]
    v_cndmask_b32 v120, v106, v118, s[48:49]
    v_cndmask_b32 v121, v108, v119, s[50:51]
    v_mfma_f32_16x16x32_bf16 v[28:31], a[40:43], v[52:55], v[28:31]
    v_mul_f32 v17, v17, v69
    v_mul_f32 v18, v18, v69
    v_mfma_f32_16x16x32_bf16 v[28:31], a[28:31], v[48:51], v[28:31]
    ds_write_b64 v36, v[120:121] offset:2048
    v_mfma_f32_16x16x32_bf16 v[24:27], a[24:27], v[48:51], v[24:27]
    ds_read_b128 v[48:51], v3 offset:6144
    v_mul_f32 v19, v19, v69
    v_mfma_f32_16x16x32_bf16 v[24:27], a[36:39], v[52:55], v[24:27]
    ds_read_b128 v[52:55], v3 offset:7168
    s_waitcnt lgkmcnt(3)
    v_mfma_f32_16x16x32_bf16 v[24:27], a[48:51], v[40:43], v[24:27]
    v_cvt_pk_bf16_f32 v16, v16, v17
    v_cvt_pk_bf16_f32 v17, v18, v19
    v_mfma_f32_16x16x32_bf16 v[24:27], a[60:63], v[44:47], v[24:27]
    s_waitcnt lgkmcnt(2)
    ds_write_b64 v38, v[16:17]
    v_mfma_f32_16x16x32_bf16 v[28:31], a[64:67], v[44:47], v[28:31]
    ds_read_b64_tr_b16 v[92:93], v39
    v_fma_f32 v12, -v68, v60, v12
    v_mfma_f32_16x16x32_bf16 v[28:31], a[52:55], v[40:43], v[28:31]
    buffer_load_dwordx4 v1, s[8:11], s33 offen offset:0 sc1 lds
    v_mfma_f32_16x16x32_bf16 v[32:35], a[56:59], v[40:43], v[32:35]
    ds_read_b128 v[40:43], v3 offset:8192
    v_fma_f32 v13, -v68, v61, v13
    v_mfma_f32_16x16x32_bf16 v[32:35], a[68:71], v[44:47], v[32:35]
    ds_read_b128 v[44:47], v3 offset:9216
    s_waitcnt lgkmcnt(4)
    v_mfma_f32_16x16x32_bf16 v[32:35], a[80:83], v[48:51], v[32:35]
    s_barrier
    v_mfma_f32_16x16x32_bf16 v[32:35], a[92:95], v[52:55], v[32:35]
    ds_read_b64 v[122:123], v37 offset:2048
    v_fma_f32 v14, -v68, v62, v14
    v_mfma_f32_16x16x32_bf16 v[28:31], a[88:91], v[52:55], v[28:31]
    buffer_load_dwordx4 v1, s[8:11], s33 offen offset:1024 sc1 lds
    v_mfma_f32_16x16x32_bf16 v[28:31], a[76:79], v[48:51], v[28:31]
    v_fma_f32 v15, -v68, v63, v15
    v_mul_f32 v12, v12, v69
    v_mfma_f32_16x16x32_bf16 v[24:27], a[72:75], v[48:51], v[24:27]
    ds_read_b128 v[48:51], v3 offset:10240
    v_mul_f32 v13, v13, v69
    v_mfma_f32_16x16x32_bf16 v[24:27], a[84:87], v[52:55], v[24:27]
    ds_read_b128 v[52:55], v3 offset:11264
    s_waitcnt lgkmcnt(3)
    v_mfma_f32_16x16x32_bf16 v[24:27], a[96:99], v[40:43], v[24:27]
    buffer_store_dword v6, v21, s[12:15], s17 offen sc1
    s_waitcnt lgkmcnt(2)
    v_mfma_f32_16x16x32_bf16 v[24:27], a[108:111], v[44:47], v[24:27]
    s_cmp_ge_i32 s54, 0
    s_cselect_b32 s14, s6, 0
    v_add_f32 v122, v122, v120
    v_mfma_f32_16x16x32_bf16 v[28:31], a[112:115], v[44:47], v[28:31]
    s_add_u32 s17, s17, 8192
    v_add_f32 v123, v123, v121
    v_max_f32 v22, v122, v123
    v_mfma_f32_16x16x32_bf16 v[28:31], a[100:103], v[40:43], v[28:31]
    buffer_load_dwordx4 v1, s[8:11], s33 offen offset:2048 sc1 lds
    v_mfma_f32_16x16x32_bf16 v[32:35], a[104:107], v[40:43], v[32:35]
    ds_read_b128 v[40:43], v3 offset:12288
    v_mov_b32 v23, v22
    v_mfma_f32_16x16x32_bf16 v[32:35], a[116:119], v[44:47], v[32:35]
    ds_read_b128 v[44:47], v3 offset:13312
    s_waitcnt lgkmcnt(2)
    v_mfma_f32_16x16x32_bf16 v[32:35], a[128:131], v[48:51], v[32:35]
    v_permlane16_swap_b32 v22, v23
    v_mfma_f32_16x16x32_bf16 v[32:35], a[140:143], v[52:55], v[32:35]
    v_max_f32 v22, v22, v23
    v_mov_b32 v23, v22
    v_mfma_f32_16x16x32_bf16 v[28:31], a[136:139], v[52:55], v[28:31]
    buffer_load_dwordx4 v1, s[8:11], s33 offen offset:3072 sc1 lds
    v_mfma_f32_16x16x32_bf16 v[28:31], a[124:127], v[48:51], v[28:31]
    s_add_u32 m0, s34, 4096
    v_permlane32_swap_b32 v22, v23
    v_mfma_f32_16x16x32_bf16 v[24:27], a[120:123], v[48:51], v[24:27]
    ds_read_b128 v[48:51], v3 offset:14336
    v_max_f32 v22, v22, v23
    v_mfma_f32_16x16x32_bf16 v[24:27], a[132:135], v[52:55], v[24:27]
    ds_read_b128 v[52:55], v3 offset:15360
    s_waitcnt lgkmcnt(2)
    v_mfma_f32_16x16x32_bf16 v[24:27], a[144:147], v[40:43], v[24:27]
    s_add_u32 s37, s33, 4096
    v_mul_f32 v22, v124, v22
    v_fma_f32 v122, v122, v124, -v22
    v_mfma_f32_16x16x32_bf16 v[24:27], a[156:159], v[44:47], v[24:27]
    buffer_load_dwordx4 v1, s[8:11], s37 offen offset:0 sc1 lds
    v_mfma_f32_16x16x32_bf16 v[28:31], a[160:163], v[44:47], v[28:31]
    v_fma_f32 v123, v123, v124, -v22
    v_sub_u32 v76, v3, v20
    v_mfma_f32_16x16x32_bf16 v[28:31], a[148:151], v[40:43], v[28:31]
    ds_read2st64_b64 v[80:83], v76 offset0:66 offset1:67
    v_mul_f32 v14, v14, v69
    v_mfma_f32_16x16x32_bf16 v[32:35], a[152:155], v[40:43], v[32:35]
    ds_read_b128 v[40:43], v3 offset:16384
    v_mul_f32 v15, v15, v69
    v_mfma_f32_16x16x32_bf16 v[32:35], a[164:167], v[44:47], v[32:35]
    ds_read_b128 v[44:47], v3 offset:17408
    s_waitcnt lgkmcnt(3)
    v_mfma_f32_16x16x32_bf16 v[32:35], a[176:179], v[48:51], v[32:35]
    buffer_load_dwordx4 v1, s[8:11], s37 offen offset:1024 sc1 lds
    v_mfma_f32_16x16x32_bf16 v[32:35], a[188:191], v[52:55], v[32:35]
    ds_read2st64_b64 v[76:79], v76 offset0:64 offset1:65
    v_cvt_pk_bf16_f32 v84, v12, v13
    v_mfma_f32_16x16x32_bf16 v[28:31], a[184:187], v[52:55], v[28:31]
    v_exp_f32 v122, v122
    v_mfma_f32_16x16x32_bf16 v[28:31], a[172:175], v[48:51], v[28:31]
    v_exp_f32 v123, v123
    v_mfma_f32_16x16x32_bf16 v[24:27], a[168:171], v[48:51], v[24:27]
    ds_read_b128 v[48:51], v3 offset:18432
    v_add_f32 v22, v122, v123
    v_mfma_f32_16x16x32_bf16 v[24:27], a[180:183], v[52:55], v[24:27]
    ds_read_b128 v[52:55], v3 offset:19456
    s_waitcnt lgkmcnt(3)
    v_mfma_f32_16x16x32_bf16 v[24:27], a[192:195], v[40:43], v[24:27]
    buffer_load_dwordx4 v1, s[8:11], s37 offen offset:2048 sc1 lds
    v_mfma_f32_16x16x32_bf16 v[24:27], a[204:207], v[44:47], v[24:27]
    v_mov_b32 v23, v22
    v_cvt_pk_bf16_f32 v85, v14, v15
    v_mfma_f32_16x16x32_bf16 v[28:31], a[208:211], v[44:47], v[28:31]
    v_permlane16_swap_b32 v22, v23
    v_mfma_f32_16x16x32_bf16 v[28:31], a[196:199], v[40:43], v[28:31]
    v_add_f32 v22, v22, v23
    v_mov_b32 v23, v22
    v_mfma_f32_16x16x32_bf16 v[32:35], a[200:203], v[40:43], v[32:35]
    ds_read_b128 v[40:43], v3 offset:20480
    v_fma_f32 v8, -v68, v56, v8
    v_mfma_f32_16x16x32_bf16 v[32:35], a[212:215], v[44:47], v[32:35]
    ds_read_b128 v[44:47], v3 offset:21504
    s_waitcnt lgkmcnt(2)
    v_mfma_f32_16x16x32_bf16 v[32:35], a[224:227], v[48:51], v[32:35]
    buffer_load_dwordx4 v1, s[8:11], s37 offen offset:3072 sc1 lds
    v_mfma_f32_16x16x32_bf16 v[32:35], a[236:239], v[52:55], v[32:35]
    s_add_u32 m0, s34, 8192
    v_permlane32_swap_b32 v22, v23
    v_mfma_f32_16x16x32_bf16 v[28:31], a[232:235], v[52:55], v[28:31]
    s_add_u32 s37, s33, 8192
    v_add_f32 v22, v22, v23
    v_fma_f32 v9, -v68, v57, v9
    v_mfma_f32_16x16x32_bf16 v[28:31], a[220:223], v[48:51], v[28:31]
    v_rcp_f32 v22, v22
    v_mfma_f32_16x16x32_bf16 v[24:27], a[216:219], v[48:51], v[24:27]
    ds_read_b128 v[48:51], v3 offset:22528
    v_mul_f32 v122, v122, v22
    v_mfma_f32_16x16x32_bf16 v[24:27], a[228:231], v[52:55], v[24:27]
    ds_read_b128 v[52:55], v3 offset:23552
    s_waitcnt lgkmcnt(2)
    v_mfma_f32_16x16x32_bf16 v[24:27], a[240:243], v[40:43], v[24:27]
    buffer_load_dwordx4 v1, s[8:11], s37 offen offset:0 sc1 lds
    v_mfma_f32_16x16x32_bf16 v[24:27], a[252:255], v[44:47], v[24:27]
    v_mul_f32 v123, v123, v22
    v_cvt_pk_bf16_f32 v23, v122, v123
    v_mfma_f32_16x16x32_bf16 v[28:31], v[128:131], v[44:47], v[28:31]
    v_perm_b32 v114, v23, v23, v102
    v_perm_b32 v115, v23, v23, v103
    v_mfma_f32_16x16x32_bf16 v[28:31], a[244:247], v[40:43], v[28:31]
    v_perm_b32 v116, v23, v23, v104
    v_perm_b32 v117, v23, v23, v105
    v_mfma_f32_16x16x32_bf16 v[32:35], a[248:251], v[40:43], v[32:35]
    ds_read_b128 v[40:43], v3 offset:24576
    v_mov_b32 v100, v94
    v_mfma_f32_16x16x32_bf16 v[32:35], v[132:135], v[44:47], v[32:35]
    ds_read_b128 v[44:47], v3 offset:25600
    s_waitcnt lgkmcnt(2)
    v_mfma_f32_16x16x32_bf16 v[32:35], v[144:147], v[48:51], v[32:35]
    v_mov_b32 v101, v95
    v_fma_f32 v10, -v68, v58, v10
    v_mfma_f32_16x16x32_bf16 v[32:35], v[156:159], v[52:55], v[32:35]
    v_fma_f32 v11, -v68, v59, v11
    v_cvt_pk_bf16_f32 v88, v8, v9
    v_mfma_f32_16x16x32_bf16 v[72:75], v[98:101], v[114:117], 0
    v_cvt_pk_bf16_f32 v89, v10, v11
    v_add_f32 v76, v76, v80
    v_mfma_f32_16x16x32_bf16 v[28:31], v[152:155], v[52:55], v[28:31]
    v_add_f32 v77, v77, v81
    v_add_f32 v78, v78, v82
    v_mfma_f32_16x16x32_bf16 v[110:113], v[84:87], v[88:91], 0
    v_mov_b32 v8, v84
    v_mov_b32 v9, v85
    v_mfma_f32_16x16x32_bf16 v[28:31], v[140:143], v[48:51], v[28:31]
    v_cvt_pk_bf16_f32 v114, v72, v73
    v_cvt_pk_bf16_f32 v115, v74, v75
    v_mfma_f32_16x16x32_bf16 v[24:27], v[136:139], v[48:51], v[24:27]
    ds_read_b128 v[48:51], v3 offset:26624
    v_cvt_pk_bf16_f32 v116, v72, v73
    v_mfma_f32_16x16x32_bf16 v[24:27], v[148:151], v[52:55], v[24:27]
    ds_read_b128 v[52:55], v3 offset:27648
    s_waitcnt lgkmcnt(2)
    v_mfma_f32_16x16x32_bf16 v[24:27], v[160:163], v[40:43], v[24:27]
    v_mov_b32 v10, v92
    v_mov_b32 v11, v93
    v_mfma_f32_16x16x32_bf16 v[24:27], v[172:175], v[44:47], v[24:27]
    buffer_store_dwordx4 v[8:11], v1, s[4:7], s40 offen sc1
    v_cvt_pk_bf16_f32 v117, v74, v75
    v_mfma_f32_16x16x32_bf16 v[28:31], v[176:179], v[44:47], v[28:31]
    s_add_u32 s40, s40, 262144
    v_permlane32_swap_b32 v114, v116
    v_mfma_f32_16x16x32_bf16 v[28:31], v[164:167], v[40:43], v[28:31]
    s_add_u32 s41, s41, 262144
    v_permlane32_swap_b32 v115, v117
    v_mfma_f32_16x16x32_bf16 v[32:35], v[168:171], v[40:43], v[32:35]
    ds_read_b128 v[40:43], v3 offset:28672
    v_cndmask_b32 v118, v110, v111, s[44:45]
    v_mfma_f32_16x16x32_bf16 v[32:35], v[180:183], v[44:47], v[32:35]
    ds_read_b128 v[44:47], v3 offset:29696
    s_waitcnt lgkmcnt(2)
    v_mfma_f32_16x16x32_bf16 v[32:35], v[192:195], v[48:51], v[32:35]
    buffer_store_dwordx4 v[114:117], v7, s[12:15], s36 offen sc1
    v_cndmask_b32 v119, v112, v113, s[44:45]
    v_mfma_f32_16x16x32_bf16 v[32:35], v[204:207], v[52:55], v[32:35]
    s_add_u32 s36, s36, 32768
    v_add_f32 v79, v79, v83
    v_add_f32 v70, v76, v78
    v_mfma_f32_16x16x32_bf16 v[28:31], v[200:203], v[52:55], v[28:31]
    s_add_u32 s31, s31, 1
    v_add_f32 v71, v77, v79
    v_add_u32 v2, s35, v1
    v_mfma_f32_16x16x32_bf16 v[28:31], v[188:191], v[48:51], v[28:31]
    s_sub_u32 s54, s31, 2
    v_mov_b32 v6, s54
    v_mfma_f32_16x16x32_bf16 v[24:27], v[184:187], v[48:51], v[24:27]
    ds_read_b128 v[48:51], v3 offset:30720
    v_mfma_f32_16x16x32_bf16 v[24:27], v[196:199], v[52:55], v[24:27]
    ds_read_b128 v[52:55], v3 offset:31744
    s_waitcnt lgkmcnt(2)
    v_mfma_f32_16x16x32_bf16 v[24:27], v[208:211], v[40:43], v[24:27]
    s_cmp_ge_i32 s31, 30
    s_cselect_b32 s18, 0x1ffff, s18
    s_add_u32 s33, s33, 34816
    v_mfma_f32_16x16x32_bf16 v[24:27], v[220:223], v[44:47], v[24:27]
    s_add_u32 s34, s34, 36864
    v_permlane16_swap_b32 v70, v71
    v_mfma_f32_16x16x32_bf16 v[28:31], v[224:227], v[44:47], v[28:31]
    s_cmp_ge_u32 s34, 147456
    s_cselect_b32 s38, 147456, 0
    v_add_f32 v70, v70, v71
    v_mfma_f32_16x16x32_bf16 v[28:31], v[212:215], v[40:43], v[28:31]
    s_sub_u32 s34, s34, s38
    s_waitcnt vmcnt(12)
    v_cmp_gt_i32 vcc, s32, v5
    v_mfma_f32_16x16x32_bf16 v[32:35], v[216:219], v[40:43], v[32:35]
    ds_read_b128 v[40:43], v2 offset:0
    v_mov_b32 v71, v70
    v_mfma_f32_16x16x32_bf16 v[32:35], v[228:231], v[44:47], v[32:35]
    ds_read_b128 v[44:47], v2 offset:1024
    s_waitcnt lgkmcnt(2)
    v_mfma_f32_16x16x32_bf16 v[32:35], v[240:243], v[48:51], v[32:35]
    s_and_b64 vcc, vcc, s[18:19]
    s_cbranch_scc1 Lqkv_slows11
Lqkv_backs11:
    v_mfma_f32_16x16x32_bf16 v[32:35], v[252:255], v[52:55], v[32:35]
    s_add_u32 s16, s16, 8192
    v_permlane32_swap_b32 v70, v71
    v_mfma_f32_16x16x32_bf16 v[28:31], v[248:251], v[52:55], v[28:31]
    s_and_b32 s16, s16, 524287
    v_add_f32 v70, v70, v71
    v_mul_f32 v70, 0x3a800000, v70
    v_mfma_f32_16x16x32_bf16 v[28:31], v[236:239], v[48:51], v[28:31]
    buffer_load_dword v5, v4, s[4:7], s16 offen sc1
    v_mfma_f32_16x16x32_bf16 v[24:27], v[232:235], v[48:51], v[24:27]
    ds_read_b128 v[48:51], v2 offset:2048
    v_mov_b32 v71, v70
    v_mfma_f32_16x16x32_bf16 v[24:27], v[244:247], v[52:55], v[24:27]
    ds_read_b128 v[52:55], v2 offset:3072
    v_permlane16_swap_b32 v70, v71
    v_fma_f32 v71, -v70, v70, v71
    v_max_f32 v71, 0, v71
    v_add_f32 v71, 0x3727c5ac, v71
    v_rsq_f32 v71, v71
    s_nop 1
    s_branch Lqkv_g01
    .p2align 6
Lqkv_g11:
    s_waitcnt lgkmcnt(2)
    v_mfma_f32_16x16x32_bf16 v[24:27], a[0:3], v[40:43], 0
    s_add_u32 m0, s34, 0
    v_mul_f32 v124, s52, v71
    v_fma_f32 v16, -v68, v64, v16
    v_mfma_f32_16x16x32_bf16 v[24:27], a[12:15], v[44:47], v[24:27]
    s_add_u32 s35, s35, 36864
    v_fma_f32 v12, -v68, v60, v12
    v_fma_f32 v13, -v68, v61, v13
    v_mfma_f32_16x16x32_bf16 v[28:31], a[16:19], v[44:47], 0
    s_cmp_eq_u32 s35, 147456
    s_cselect_b32 s35, 0, s35
    v_fma_f32 v14, -v68, v62, v14
    v_mfma_f32_16x16x32_bf16 v[28:31], a[4:7], v[40:43], v[28:31]
    v_fma_f32 v15, -v68, v63, v15
    v_mul_f32 v12, v12, v69
    v_mfma_f32_16x16x32_bf16 v[32:35], a[8:11], v[40:43], 0
    ds_read_b128 v[40:43], v3 offset:4096
    v_mul_f32 v13, v13, v69
    v_mfma_f32_16x16x32_bf16 v[32:35], a[20:23], v[44:47], v[32:35]
    ds_read_b128 v[44:47], v3 offset:5120
    s_waitcnt lgkmcnt(2)
    v_mfma_f32_16x16x32_bf16 v[32:35], a[32:35], v[48:51], v[32:35]
    v_mul_f32 v14, v14, v69
    v_mul_f32 v15, v15, v69
    v_mfma_f32_16x16x32_bf16 v[32:35], a[44:47], v[52:55], v[32:35]
    v_cvt_pk_bf16_f32 v84, v12, v13
    v_cvt_pk_bf16_f32 v85, v14, v15
    v_mfma_f32_16x16x32_bf16 v[28:31], a[40:43], v[52:55], v[28:31]
    v_fma_f32 v17, -v68, v65, v17
    v_fma_f32 v18, -v68, v66, v18
    v_mfma_f32_16x16x32_bf16 v[106:109], v[84:87], v[88:91], 0
    v_fma_f32 v19, -v68, v67, v19
    v_mul_f32 v16, v16, v69
    v_mfma_f32_16x16x32_bf16 v[28:31], a[28:31], v[48:51], v[28:31]
    v_mul_f32 v17, v17, v69
    v_mul_f32 v18, v18, v69
    v_mfma_f32_16x16x32_bf16 v[24:27], a[24:27], v[48:51], v[24:27]
    ds_read_b128 v[48:51], v3 offset:6144
    v_mul_f32 v19, v19, v69
    v_mfma_f32_16x16x32_bf16 v[24:27], a[36:39], v[52:55], v[24:27]
    ds_read_b128 v[52:55], v3 offset:7168
    s_waitcnt lgkmcnt(2)
    v_mfma_f32_16x16x32_bf16 v[24:27], a[48:51], v[40:43], v[24:27]
    v_cndmask_b32 v106, v106, v107, s[44:45]
    v_cndmask_b32 v108, v108, v109, s[44:45]
    v_mfma_f32_16x16x32_bf16 v[24:27], a[60:63], v[44:47], v[24:27]
    v_cndmask_b32 v120, v106, v118, s[48:49]
    v_cndmask_b32 v121, v108, v119, s[50:51]
    v_mfma_f32_16x16x32_bf16 v[28:31], a[64:67], v[44:47], v[28:31]
    ds_write_b64 v36, v[120:121] offset:2048
    v_mfma_f32_16x16x32_bf16 v[28:31], a[52:55], v[40:43], v[28:31]
    v_cvt_pk_bf16_f32 v16, v16, v17
    v_cvt_pk_bf16_f32 v17, v18, v19
    v_mfma_f32_16x16x32_bf16 v[32:35], a[56:59], v[40:43], v[32:35]
    ds_read_b128 v[40:43], v3 offset:8192
    v_fma_f32 v8, -v68, v56, v8
    v_mfma_f32_16x16x32_bf16 v[32:35], a[68:71], v[44:47], v[32:35]
    ds_read_b128 v[44:47], v3 offset:9216
    s_waitcnt lgkmcnt(3)
    v_mfma_f32_16x16x32_bf16 v[32:35], a[80:83], v[48:51], v[32:35]
    s_waitcnt vmcnt(3) lgkmcnt(2)
    ds_write_b64 v38, v[16:17]
    v_mfma_f32_16x16x32_bf16 v[32:35], a[92:95], v[52:55], v[32:35]
    s_barrier
    v_mfma_f32_16x16x32_bf16 v[28:31], a[88:91], v[52:55], v[28:31]
    ds_read_b64_tr_b16 v[92:93], v39
    v_fma_f32 v9, -v68, v57, v9
    v_mfma_f32_16x16x32_bf16 v[28:31], a[76:79], v[48:51], v[28:31]
    buffer_load_dwordx4 v1, s[8:11], s33 offen offset:0 sc1 lds
    v_mfma_f32_16x16x32_bf16 v[24:27], a[72:75], v[48:51], v[24:27]
    ds_read_b128 v[48:51], v3 offset:10240
    v_fma_f32 v10, -v68, v58, v10
    v_mfma_f32_16x16x32_bf16 v[24:27], a[84:87], v[52:55], v[24:27]
    ds_read_b128 v[52:55], v3 offset:11264
    s_waitcnt lgkmcnt(4)
    v_mfma_f32_16x16x32_bf16 v[24:27], a[96:99], v[40:43], v[24:27]
    s_waitcnt vmcnt(3)
    buffer_store_dword v6, v21, s[12:15], s17 offen sc1
    v_mfma_f32_16x16x32_bf16 v[24:27], a[108:111], v[44:47], v[24:27]
    ds_read_b64 v[122:123], v37 offset:2048
    v_fma_f32 v11, -v68, v59, v11
    v_mfma_f32_16x16x32_bf16 v[28:31], a[112:115], v[44:47], v[28:31]
    s_cmp_ge_i32 s54, 0
    s_cselect_b32 s14, s6, 0
    v_cvt_pk_bf16_f32 v88, v8, v9
    v_mfma_f32_16x16x32_bf16 v[28:31], a[100:103], v[40:43], v[28:31]
    s_add_u32 s17, s17, 8192
    v_sub_u32 v76, v3, v20
    v_cvt_pk_bf16_f32 v89, v10, v11
    v_mfma_f32_16x16x32_bf16 v[32:35], a[104:107], v[40:43], v[32:35]
    ds_read_b128 v[40:43], v3 offset:12288
    v_add_u32 v2, s35, v1
    v_mfma_f32_16x16x32_bf16 v[110:113], v[84:87], v[88:91], 0
    buffer_load_dwordx4 v1, s[8:11], s33 offen offset:1024 sc1 lds
    v_mfma_f32_16x16x32_bf16 v[32:35], a[116:119], v[44:47], v[32:35]
    ds_read_b128 v[44:47], v3 offset:13312
    s_waitcnt lgkmcnt(2)
    v_mfma_f32_16x16x32_bf16 v[32:35], a[128:131], v[48:51], v[32:35]
    ds_read2st64_b64 v[80:83], v76 offset0:66 offset1:67
    v_add_f32 v122, v122, v120
    v_mfma_f32_16x16x32_bf16 v[32:35], a[140:143], v[52:55], v[32:35]
    ds_read2st64_b64 v[76:79], v76 offset0:64 offset1:65
    v_add_f32 v123, v123, v121
    v_mfma_f32_16x16x32_bf16 v[28:31], a[136:139], v[52:55], v[28:31]
    v_max_f32 v22, v122, v123
    v_mov_b32 v23, v22
    v_mfma_f32_16x16x32_bf16 v[28:31], a[124:127], v[48:51], v[28:31]
    buffer_load_dwordx4 v1, s[8:11], s33 offen offset:2048 sc1 lds
    v_mfma_f32_16x16x32_bf16 v[24:27], a[120:123], v[48:51], v[24:27]
    ds_read_b128 v[48:51], v3 offset:14336
    v_cndmask_b32 v118, v110, v111, s[44:45]
    v_mfma_f32_16x16x32_bf16 v[24:27], a[132:135], v[52:55], v[24:27]
    ds_read_b128 v[52:55], v3 offset:15360
    s_waitcnt lgkmcnt(4)
    v_mfma_f32_16x16x32_bf16 v[24:27], a[144:147], v[40:43], v[24:27]
    v_permlane16_swap_b32 v22, v23
    v_mfma_f32_16x16x32_bf16 v[24:27], a[156:159], v[44:47], v[24:27]
    v_max_f32 v22, v22, v23
    v_mov_b32 v23, v22
    v_mfma_f32_16x16x32_bf16 v[28:31], a[160:163], v[44:47], v[28:31]
    buffer_load_dwordx4 v1, s[8:11], s33 offen offset:3072 sc1 lds
    v_mfma_f32_16x16x32_bf16 v[28:31], a[148:151], v[40:43], v[28:31]
    s_add_u32 m0, s34, 4096
    v_permlane32_swap_b32 v22, v23
    v_mfma_f32_16x16x32_bf16 v[32:35], a[152:155], v[40:43], v[32:35]
    ds_read_b128 v[40:43], v3 offset:16384
    v_max_f32 v22, v22, v23
    v_mfma_f32_16x16x32_bf16 v[32:35], a[164:167], v[44:47], v[32:35]
    ds_read_b128 v[44:47], v3 offset:17408
    s_waitcnt lgkmcnt(2)
    v_mfma_f32_16x16x32_bf16 v[32:35], a[176:179], v[48:51], v[32:35]
    s_add_u32 s37, s33, 4096
    v_mul_f32 v22, v124, v22
    v_fma_f32 v122, v122, v124, -v22
    v_mfma_f32_16x16x32_bf16 v[32:35], a[188:191], v[52:55], v[32:35]
    buffer_load_dwordx4 v1, s[8:11], s37 offen offset:0 sc1 lds
    v_mfma_f32_16x16x32_bf16 v[28:31], a[184:187], v[52:55], v[28:31]
    v_fma_f32 v123, v123, v124, -v22
    v_cndmask_b32 v119, v112, v113, s[44:45]
    v_mfma_f32_16x16x32_bf16 v[28:31], a[172:175], v[48:51], v[28:31]
    v_exp_f32 v122, v122
    v_mfma_f32_16x16x32_bf16 v[24:27], a[168:171], v[48:51], v[24:27]
    ds_read_b128 v[48:51], v3 offset:18432
    v_add_f32 v76, v76, v80
    v_mfma_f32_16x16x32_bf16 v[24:27], a[180:183], v[52:55], v[24:27]
    ds_read_b128 v[52:55], v3 offset:19456
    s_waitcnt lgkmcnt(2)
    v_mfma_f32_16x16x32_bf16 v[24:27], a[192:195], v[40:43], v[24:27]
    buffer_load_dwordx4 v1, s[8:11], s37 offen offset:1024 sc1 lds
    v_mfma_f32_16x16x32_bf16 v[24:27], a[204:207], v[44:47], v[24:27]
    v_exp_f32 v123, v123
    v_mfma_f32_16x16x32_bf16 v[28:31], a[208:211], v[44:47], v[28:31]
    v_add_f32 v22, v122, v123
    v_mov_b32 v23, v22
    v_mfma_f32_16x16x32_bf16 v[28:31], a[196:199], v[40:43], v[28:31]
    s_nop 0
    v_permlane16_swap_b32 v22, v23
    v_mfma_f32_16x16x32_bf16 v[32:35], a[200:203], v[40:43], v[32:35]
    ds_read_b128 v[40:43], v3 offset:20480
    v_add_f32 v22, v22, v23
    v_mfma_f32_16x16x32_bf16 v[32:35], a[212:215], v[44:47], v[32:35]
    ds_read_b128 v[44:47], v3 offset:21504
    s_waitcnt lgkmcnt(2)
    v_mfma_f32_16x16x32_bf16 v[32:35], a[224:227], v[48:51], v[32:35]
    buffer_load_dwordx4 v1, s[8:11], s37 offen offset:2048 sc1 lds
    v_mfma_f32_16x16x32_bf16 v[32:35], a[236:239], v[52:55], v[32:35]
    v_mov_b32 v23, v22
    v_add_f32 v77, v77, v81
    v_mfma_f32_16x16x32_bf16 v[28:31], a[232:235], v[52:55], v[28:31]
    v_permlane32_swap_b32 v22, v23
    v_mfma_f32_16x16x32_bf16 v[28:31], a[220:223], v[48:51], v[28:31]
    v_add_f32 v22, v22, v23
    v_add_f32 v78, v78, v82
    v_mfma_f32_16x16x32_bf16 v[24:27], a[216:219], v[48:51], v[24:27]
    ds_read_b128 v[48:51], v3 offset:22528
    v_add_f32 v79, v79, v83
    v_mfma_f32_16x16x32_bf16 v[24:27], a[228:231], v[52:55], v[24:27]
    ds_read_b128 v[52:55], v3 offset:23552
    s_waitcnt lgkmcnt(2)
    v_mfma_f32_16x16x32_bf16 v[24:27], a[240:243], v[40:43], v[24:27]
    buffer_load_dwordx4 v1, s[8:11], s37 offen offset:3072 sc1 lds
    v_mfma_f32_16x16x32_bf16 v[24:27], a[252:255], v[44:47], v[24:27]
    s_add_u32 m0, s34, 8192
    v_rcp_f32 v22, v22
    v_mfma_f32_16x16x32_bf16 v[28:31], v[128:131], v[44:47], v[28:31]
    s_add_u32 s37, s33, 8192
    v_mul_f32 v122, v122, v22
    v_mul_f32 v123, v123, v22
    v_mfma_f32_16x16x32_bf16 v[28:31], a[244:247], v[40:43], v[28:31]
    v_cvt_pk_bf16_f32 v23, v122, v123
    v_perm_b32 v114, v23, v23, v102
    v_mfma_f32_16x16x32_bf16 v[32:35], a[248:251], v[40:43], v[32:35]
    ds_read_b128 v[40:43], v3 offset:24576
    v_perm_b32 v115, v23, v23, v103
    v_mfma_f32_16x16x32_bf16 v[32:35], v[132:135], v[44:47], v[32:35]
    ds_read_b128 v[44:47], v3 offset:25600
    s_waitcnt lgkmcnt(2)
    v_mfma_f32_16x16x32_bf16 v[32:35], v[144:147], v[48:51], v[32:35]
    buffer_load_dwordx4 v1, s[8:11], s37 offen offset:0 sc1 lds
    v_mfma_f32_16x16x32_bf16 v[32:35], v[156:159], v[52:55], v[32:35]
    v_perm_b32 v116, v23, v23, v104
    v_perm_b32 v117, v23, v23, v105
    v_mfma_f32_16x16x32_bf16 v[28:31], v[152:155], v[52:55], v[28:31]
    v_add_f32 v70, v76, v78
    v_add_f32 v71, v77, v79
    v_mfma_f32_16x16x32_bf16 v[72:75], v[92:95], v[114:117], 0
    s_nop 0
    v_permlane16_swap_b32 v70, v71
    v_mfma_f32_16x16x32_bf16 v[28:31], v[140:143], v[48:51], v[28:31]
    v_add_f32 v70, v70, v71
    v_mov_b32 v71, v70
    v_mfma_f32_16x16x32_bf16 v[24:27], v[136:139], v[48:51], v[24:27]
    ds_read_b128 v[48:51], v3 offset:26624
    v_mfma_f32_16x16x32_bf16 v[24:27], v[148:151], v[52:55], v[24:27]
    ds_read_b128 v[52:55], v3 offset:27648
    s_waitcnt lgkmcnt(2)
    v_mfma_f32_16x16x32_bf16 v[24:27], v[160:163], v[40:43], v[24:27]
    v_cvt_pk_bf16_f32 v114, v72, v73
    v_cvt_pk_bf16_f32 v115, v74, v75
    v_mfma_f32_16x16x32_bf16 v[24:27], v[172:175], v[44:47], v[24:27]
    v_cvt_pk_bf16_f32 v116, v72, v73
    v_cvt_pk_bf16_f32 v117, v74, v75
    v_mfma_f32_16x16x32_bf16 v[28:31], v[176:179], v[44:47], v[28:31]
    v_permlane32_swap_b32 v114, v116
    v_mfma_f32_16x16x32_bf16 v[28:31], v[164:167], v[40:43], v[28:31]
    s_add_u32 s31, s31, 1
    v_permlane32_swap_b32 v115, v117
    v_mfma_f32_16x16x32_bf16 v[32:35], v[168:171], v[40:43], v[32:35]
    ds_read_b128 v[40:43], v3 offset:28672
    s_sub_u32 s54, s31, 2
    v_mfma_f32_16x16x32_bf16 v[32:35], v[180:183], v[44:47], v[32:35]
    ds_read_b128 v[44:47], v3 offset:29696
    s_waitcnt lgkmcnt(2)
    v_mfma_f32_16x16x32_bf16 v[32:35], v[192:195], v[48:51], v[32:35]
    buffer_store_dwordx4 v[114:117], v7, s[12:15], s36 offen sc1
    v_mov_b32 v6, s54
    v_mfma_f32_16x16x32_bf16 v[32:35], v[204:207], v[52:55], v[32:35]
    s_add_u32 s36, s36, 32768
    v_permlane32_swap_b32 v70, v71
    v_mfma_f32_16x16x32_bf16 v[28:31], v[200:203], v[52:55], v[28:31]
    s_cmp_ge_i32 s31, 30
    s_cselect_b32 s18, 0x1ffff, s18
    v_add_f32 v70, v70, v71
    v_mfma_f32_16x16x32_bf16 v[28:31], v[188:191], v[48:51], v[28:31]
    s_add_u32 s33, s33, 34816
    v_mul_f32 v70, 0x3a800000, v70
    v_mov_b32 v71, v70
    v_mfma_f32_16x16x32_bf16 v[24:27], v[184:187], v[48:51], v[24:27]
    ds_read_b128 v[48:51], v3 offset:30720
    s_add_u32 s34, s34, 36864
    v_mfma_f32_16x16x32_bf16 v[24:27], v[196:199], v[52:55], v[24:27]
    ds_read_b128 v[52:55], v3 offset:31744
    s_waitcnt lgkmcnt(2)
    v_mfma_f32_16x16x32_bf16 v[24:27], v[208:211], v[40:43], v[24:27]
    s_cmp_ge_u32 s34, 147456
    s_cselect_b32 s38, 147456, 0
    s_sub_u32 s34, s34, s38
    v_mfma_f32_16x16x32_bf16 v[24:27], v[220:223], v[44:47], v[24:27]
    s_waitcnt vmcnt(11)
    v_cmp_gt_i32 vcc, s32, v5
    v_mfma_f32_16x16x32_bf16 v[28:31], v[224:227], v[44:47], v[28:31]
    v_permlane16_swap_b32 v70, v71
    v_mfma_f32_16x16x32_bf16 v[28:31], v[212:215], v[40:43], v[28:31]
    s_and_b64 vcc, vcc, s[18:19]
    s_cbranch_scc1 Lqkv_slowg11
Lqkv_backg11:
    v_mfma_f32_16x16x32_bf16 v[32:35], v[216:219], v[40:43], v[32:35]
    ds_read_b128 v[40:43], v2 offset:0
    v_fma_f32 v71, -v70, v70, v71
    v_mfma_f32_16x16x32_bf16 v[32:35], v[228:231], v[44:47], v[32:35]
    ds_read_b128 v[44:47], v2 offset:1024
    s_waitcnt lgkmcnt(2)
    v_mfma_f32_16x16x32_bf16 v[32:35], v[240:243], v[48:51], v[32:35]
    s_add_u32 s16, s16, 8192
    v_max_f32 v71, 0, v71
    v_add_f32 v71, 0x3727c5ac, v71
    v_mfma_f32_16x16x32_bf16 v[32:35], v[252:255], v[52:55], v[32:35]
    s_and_b32 s16, s16, 524287
    v_rsq_f32 v71, v71
    v_mfma_f32_16x16x32_bf16 v[28:31], v[248:251], v[52:55], v[28:31]
    buffer_load_dword v5, v4, s[4:7], s16 offen sc1
    v_mfma_f32_16x16x32_bf16 v[28:31], v[236:239], v[48:51], v[28:31]
    v_mfma_f32_16x16x32_bf16 v[24:27], v[232:235], v[48:51], v[24:27]
    ds_read_b128 v[48:51], v2 offset:2048
    v_mfma_f32_16x16x32_bf16 v[24:27], v[244:247], v[52:55], v[24:27]
    ds_read_b128 v[52:55], v2 offset:3072
    s_cmp_eq_u32 s31, 64
    s_cbranch_scc1 Lqkv_tail
Lqkv_g01:
    s_waitcnt lgkmcnt(2)
    v_mfma_f32_16x16x32_bf16 v[8:11], a[0:3], v[40:43], 0
    s_add_u32 m0, s34, 0
    v_mul_f32 v124, s52, v69
    v_fma_f32 v32, -v70, v64, v32
    v_mfma_f32_16x16x32_bf16 v[8:11], a[12:15], v[44:47], v[8:11]
    s_add_u32 s35, s35, 36864
    v_fma_f32 v28, -v70, v60, v28
    v_fma_f32 v29, -v70, v61, v29
    v_mfma_f32_16x16x32_bf16 v[12:15], a[16:19], v[44:47], 0
    s_cmp_eq_u32 s35, 147456
    s_cselect_b32 s35, 0, s35
    v_fma_f32 v30, -v70, v62, v30
    v_mfma_f32_16x16x32_bf16 v[12:15], a[4:7], v[40:43], v[12:15]
    v_fma_f32 v31, -v70, v63, v31
    v_mul_f32 v28, v28, v71
    v_mfma_f32_16x16x32_bf16 v[16:19], a[8:11], v[40:43], 0
    ds_read_b128 v[40:43], v2 offset:4096
    v_mul_f32 v29, v29, v71
    v_mfma_f32_16x16x32_bf16 v[16:19], a[20:23], v[44:47], v[16:19]
    ds_read_b128 v[44:47], v2 offset:5120
    s_waitcnt lgkmcnt(2)
    v_mfma_f32_16x16x32_bf16 v[16:19], a[32:35], v[48:51], v[16:19]
    v_mul_f32 v30, v30, v71
    v_mul_f32 v31, v31, v71
    v_mfma_f32_16x16x32_bf16 v[16:19], a[44:47], v[52:55], v[16:19]
    v_cvt_pk_bf16_f32 v84, v28, v29
    v_cvt_pk_bf16_f32 v85, v30, v31
    v_mfma_f32_16x16x32_bf16 v[12:15], a[40:43], v[52:55], v[12:15]
    v_fma_f32 v33, -v70, v65, v33
    v_fma_f32 v34, -v70, v66, v34
    v_mfma_f32_16x16x32_bf16 v[106:109], v[84:87], v[88:91], 0
    v_fma_f32 v35, -v70, v67, v35
    v_mul_f32 v32, v32, v71
    v_mfma_f32_16x16x32_bf16 v[12:15], a[28:31], v[48:51], v[12:15]
    v_mul_f32 v33, v33, v71
    v_mul_f32 v34, v34, v71
    v_mfma_f32_16x16x32_bf16 v[8:11], a[24:27], v[48:51], v[8:11]
    ds_read_b128 v[48:51], v2 offset:6144
    v_mul_f32 v35, v35, v71
    v_mfma_f32_16x16x32_bf16 v[8:11], a[36:39], v[52:55], v[8:11]
    ds_read_b128 v[52:55], v2 offset:7168
    s_waitcnt lgkmcnt(2)
    v_mfma_f32_16x16x32_bf16 v[8:11], a[48:51], v[40:43], v[8:11]
    v_cndmask_b32 v106, v106, v107, s[44:45]
    v_cndmask_b32 v108, v108, v109, s[44:45]
    v_mfma_f32_16x16x32_bf16 v[8:11], a[60:63], v[44:47], v[8:11]
    v_cndmask_b32 v120, v106, v118, s[48:49]
    v_cndmask_b32 v121, v108, v119, s[50:51]
    v_mfma_f32_16x16x32_bf16 v[12:15], a[64:67], v[44:47], v[12:15]
    ds_write_b64 v36, v[120:121] offset:0
    v_mfma_f32_16x16x32_bf16 v[12:15], a[52:55], v[40:43], v[12:15]
    v_cvt_pk_bf16_f32 v32, v32, v33
    v_cvt_pk_bf16_f32 v33, v34, v35
    v_mfma_f32_16x16x32_bf16 v[16:19], a[56:59], v[40:43], v[16:19]
    ds_read_b128 v[40:43], v2 offset:8192
    v_fma_f32 v24, -v70, v56, v24
    v_mfma_f32_16x16x32_bf16 v[16:19], a[68:71], v[44:47], v[16:19]
    ds_read_b128 v[44:47], v2 offset:9216
    s_waitcnt lgkmcnt(3)
    v_mfma_f32_16x16x32_bf16 v[16:19], a[80:83], v[48:51], v[16:19]
    s_waitcnt vmcnt(2) lgkmcnt(2)
    ds_write_b64 v38, v[32:33]
    v_mfma_f32_16x16x32_bf16 v[16:19], a[92:95], v[52:55], v[16:19]
    s_barrier
    v_mfma_f32_16x16x32_bf16 v[12:15], a[88:91], v[52:55], v[12:15]
    ds_read_b64_tr_b16 v[94:95], v39
    v_fma_f32 v25, -v70, v57, v25
    v_mfma_f32_16x16x32_bf16 v[12:15], a[76:79], v[48:51], v[12:15]
    buffer_load_dwordx4 v1, s[8:11], s33 offen offset:0 sc1 lds
    v_mfma_f32_16x16x32_bf16 v[8:11], a[72:75], v[48:51], v[8:11]
    ds_read_b128 v[48:51], v2 offset:10240
    v_fma_f32 v26, -v70, v58, v26
    v_mfma_f32_16x16x32_bf16 v[8:11], a[84:87], v[52:55], v[8:11]
    ds_read_b128 v[52:55], v2 offset:11264
    s_waitcnt lgkmcnt(4)
    v_mfma_f32_16x16x32_bf16 v[8:11], a[96:99], v[40:43], v[8:11]
    s_waitcnt vmcnt(2)
    buffer_store_dword v6, v21, s[12:15], s17 offen sc1
    v_mfma_f32_16x16x32_bf16 v[8:11], a[108:111], v[44:47], v[8:11]
    ds_read_b64 v[122:123], v37 offset:0
    v_fma_f32 v27, -v70, v59, v27
    v_mfma_f32_16x16x32_bf16 v[12:15], a[112:115], v[44:47], v[12:15]
    s_cmp_ge_i32 s54, 0
    s_cselect_b32 s14, s6, 0
    v_cvt_pk_bf16_f32 v88, v24, v25
    v_mfma_f32_16x16x32_bf16 v[12:15], a[100:103], v[40:43], v[12:15]
    s_add_u32 s17, s17, 8192
    v_sub_u32 v76, v2, v20
    v_cvt_pk_bf16_f32 v89, v26, v27
    v_mfma_f32_16x16x32_bf16 v[16:19], a[104:107], v[40:43], v[16:19]
    ds_read_b128 v[40:43], v2 offset:12288
    v_add_u32 v3, s35, v1
    v_mfma_f32_16x16x32_bf16 v[110:113], v[84:87], v[88:91], 0
    buffer_load_dwordx4 v1, s[8:11], s33 offen offset:1024 sc1 lds
    v_mfma_f32_16x16x32_bf16 v[16:19], a[116:119], v[44:47], v[16:19]
    ds_read_b128 v[44:47], v2 offset:13312
    s_waitcnt lgkmcnt(2)
    v_mfma_f32_16x16x32_bf16 v[16:19], a[128:131], v[48:51], v[16:19]
    ds_read2st64_b64 v[80:83], v76 offset0:66 offset1:67
    v_add_f32 v122, v122, v120
    v_mfma_f32_16x16x32_bf16 v[16:19], a[140:143], v[52:55], v[16:19]
    ds_read2st64_b64 v[76:79], v76 offset0:64 offset1:65
    v_add_f32 v123, v123, v121
    v_mfma_f32_16x16x32_bf16 v[12:15], a[136:139], v[52:55], v[12:15]
    v_max_f32 v22, v122, v123
    v_mov_b32 v23, v22
    v_mfma_f32_16x16x32_bf16 v[12:15], a[124:127], v[48:51], v[12:15]
    buffer_load_dwordx4 v1, s[8:11], s33 offen offset:2048 sc1 lds
    v_mfma_f32_16x16x32_bf16 v[8:11], a[120:123], v[48:51], v[8:11]
    ds_read_b128 v[48:51], v2 offset:14336
    v_cndmask_b32 v118, v110, v111, s[44:45]
    v_mfma_f32_16x16x32_bf16 v[8:11], a[132:135], v[52:55], v[8:11]
    ds_read_b128 v[52:55], v2 offset:15360
    s_waitcnt lgkmcnt(4)
    v_mfma_f32_16x16x32_bf16 v[8:11], a[144:147], v[40:43], v[8:11]
    v_permlane16_swap_b32 v22, v23
    v_mfma_f32_16x16x32_bf16 v[8:11], a[156:159], v[44:47], v[8:11]
    v_max_f32 v22, v22, v23
    v_mov_b32 v23, v22
    v_mfma_f32_16x16x32_bf16 v[12:15], a[160:163], v[44:47], v[12:15]
    buffer_load_dwordx4 v1, s[8:11], s33 offen offset:3072 sc1 lds
    v_mfma_f32_16x16x32_bf16 v[12:15], a[148:151], v[40:43], v[12:15]
    s_add_u32 m0, s34, 4096
    v_permlane32_swap_b32 v22, v23
    v_mfma_f32_16x16x32_bf16 v[16:19], a[152:155], v[40:43], v[16:19]
    ds_read_b128 v[40:43], v2 offset:16384
    v_max_f32 v22, v22, v23
    v_mfma_f32_16x16x32_bf16 v[16:19], a[164:167], v[44:47], v[16:19]
    ds_read_b128 v[44:47], v2 offset:17408
    s_waitcnt lgkmcnt(2)
    v_mfma_f32_16x16x32_bf16 v[16:19], a[176:179], v[48:51], v[16:19]
    s_add_u32 s37, s33, 4096
    v_mul_f32 v22, v124, v22
    v_fma_f32 v122, v122, v124, -v22
    v_mfma_f32_16x16x32_bf16 v[16:19], a[188:191], v[52:55], v[16:19]
    buffer_load_dwordx4 v1, s[8:11], s37 offen offset:0 sc1 lds
    v_mfma_f32_16x16x32_bf16 v[12:15], a[184:187], v[52:55], v[12:15]
    v_fma_f32 v123, v123, v124, -v22
    v_cndmask_b32 v119, v112, v113, s[44:45]
    v_mfma_f32_16x16x32_bf16 v[12:15], a[172:175], v[48:51], v[12:15]
    v_exp_f32 v122, v122
    v_mfma_f32_16x16x32_bf16 v[8:11], a[168:171], v[48:51], v[8:11]
    ds_read_b128 v[48:51], v2 offset:18432
    v_add_f32 v76, v76, v80
    v_mfma_f32_16x16x32_bf16 v[8:11], a[180:183], v[52:55], v[8:11]
    ds_read_b128 v[52:55], v2 offset:19456
    s_waitcnt lgkmcnt(2)
    v_mfma_f32_16x16x32_bf16 v[8:11], a[192:195], v[40:43], v[8:11]
    buffer_load_dwordx4 v1, s[8:11], s37 offen offset:1024 sc1 lds
    v_mfma_f32_16x16x32_bf16 v[8:11], a[204:207], v[44:47], v[8:11]
    v_exp_f32 v123, v123
    v_mfma_f32_16x16x32_bf16 v[12:15], a[208:211], v[44:47], v[12:15]
    v_add_f32 v22, v122, v123
    v_mov_b32 v23, v22
    v_mfma_f32_16x16x32_bf16 v[12:15], a[196:199], v[40:43], v[12:15]
    s_nop 0
    v_permlane16_swap_b32 v22, v23
    v_mfma_f32_16x16x32_bf16 v[16:19], a[200:203], v[40:43], v[16:19]
    ds_read_b128 v[40:43], v2 offset:20480
    v_add_f32 v22, v22, v23
    v_mfma_f32_16x16x32_bf16 v[16:19], a[212:215], v[44:47], v[16:19]
    ds_read_b128 v[44:47], v2 offset:21504
    s_waitcnt lgkmcnt(2)
    v_mfma_f32_16x16x32_bf16 v[16:19], a[224:227], v[48:51], v[16:19]
    buffer_load_dwordx4 v1, s[8:11], s37 offen offset:2048 sc1 lds
    v_mfma_f32_16x16x32_bf16 v[16:19], a[236:239], v[52:55], v[16:19]
    v_mov_b32 v23, v22
    v_add_f32 v77, v77, v81
    v_mfma_f32_16x16x32_bf16 v[12:15], a[232:235], v[52:55], v[12:15]
    v_permlane32_swap_b32 v22, v23
    v_mfma_f32_16x16x32_bf16 v[12:15], a[220:223], v[48:51], v[12:15]
    v_add_f32 v22, v22, v23
    v_add_f32 v78, v78, v82
    v_mfma_f32_16x16x32_bf16 v[8:11], a[216:219], v[48:51], v[8:11]
    ds_read_b128 v[48:51], v2 offset:22528
    v_add_f32 v79, v79, v83
    v_mfma_f32_16x16x32_bf16 v[8:11], a[228:231], v[52:55], v[8:11]
    ds_read_b128 v[52:55], v2 offset:23552
    s_waitcnt lgkmcnt(2)
    v_mfma_f32_16x16x32_bf16 v[8:11], a[240:243], v[40:43], v[8:11]
    buffer_load_dwordx4 v1, s[8:11], s37 offen offset:3072 sc1 lds
    v_mfma_f32_16x16x32_bf16 v[8:11], a[252:255], v[44:47], v[8:11]
    s_add_u32 m0, s34, 8192
    v_rcp_f32 v22, v22
    v_mfma_f32_16x16x32_bf16 v[12:15], v[128:131], v[44:47], v[12:15]
    s_add_u32 s37, s33, 8192
    v_mul_f32 v122, v122, v22
    v_mul_f32 v123, v123, v22
    v_mfma_f32_16x16x32_bf16 v[12:15], a[244:247], v[40:43], v[12:15]
    v_cvt_pk_bf16_f32 v23, v122, v123
    v_perm_b32 v116, v23, v23, v102
    v_mfma_f32_16x16x32_bf16 v[16:19], a[248:251], v[40:43], v[16:19]
    ds_read_b128 v[40:43], v2 offset:24576
    v_perm_b32 v117, v23, v23, v103
    v_mfma_f32_16x16x32_bf16 v[16:19], v[132:135], v[44:47], v[16:19]
    ds_read_b128 v[44:47], v2 offset:25600
    s_waitcnt lgkmcnt(2)
    v_mfma_f32_16x16x32_bf16 v[16:19], v[144:147], v[48:51], v[16:19]
    buffer_load_dwordx4 v1, s[8:11], s37 offen offset:0 sc1 lds
    v_mfma_f32_16x16x32_bf16 v[16:19], v[156:159], v[52:55], v[16:19]
    v_perm_b32 v114, v23, v23, v104
    v_perm_b32 v115, v23, v23, v105
    v_mfma_f32_16x16x32_bf16 v[12:15], v[152:155], v[52:55], v[12:15]
    v_add_f32 v68, v76, v78
    v_add_f32 v69, v77, v79
    v_mfma_f32_16x16x32_bf16 v[72:75], v[92:95], v[114:117], 0
    s_nop 0
    v_permlane16_swap_b32 v68, v69
    v_mfma_f32_16x16x32_bf16 v[12:15], v[140:143], v[48:51], v[12:15]
    v_add_f32 v68, v68, v69
    v_mov_b32 v69, v68
    v_mfma_f32_16x16x32_bf16 v[8:11], v[136:139], v[48:51], v[8:11]
    ds_read_b128 v[48:51], v2 offset:26624
    v_mfma_f32_16x16x32_bf16 v[8:11], v[148:151], v[52:55], v[8:11]
    ds_read_b128 v[52:55], v2 offset:27648
    s_waitcnt lgkmcnt(2)
    v_mfma_f32_16x16x32_bf16 v[8:11], v[160:163], v[40:43], v[8:11]
    v_cvt_pk_bf16_f32 v114, v72, v73
    v_cvt_pk_bf16_f32 v115, v74, v75
    v_mfma_f32_16x16x32_bf16 v[8:11], v[172:175], v[44:47], v[8:11]
    v_cvt_pk_bf16_f32 v116, v72, v73
    v_cvt_pk_bf16_f32 v117, v74, v75
    v_mfma_f32_16x16x32_bf16 v[12:15], v[176:179], v[44:47], v[12:15]
    v_permlane32_swap_b32 v114, v116
    v_mfma_f32_16x16x32_bf16 v[12:15], v[164:167], v[40:43], v[12:15]
    s_add_u32 s31, s31, 1
    v_permlane32_swap_b32 v115, v117
    v_mfma_f32_16x16x32_bf16 v[16:19], v[168:171], v[40:43], v[16:19]
    ds_read_b128 v[40:43], v2 offset:28672
    s_sub_u32 s54, s31, 2
    v_mfma_f32_16x16x32_bf16 v[16:19], v[180:183], v[44:47], v[16:19]
    ds_read_b128 v[44:47], v2 offset:29696
    s_waitcnt lgkmcnt(2)
    v_mfma_f32_16x16x32_bf16 v[16:19], v[192:195], v[48:51], v[16:19]
    buffer_store_dwordx4 v[114:117], v7, s[12:15], s36 offen sc1
    v_mov_b32 v6, s54
    v_mfma_f32_16x16x32_bf16 v[16:19], v[204:207], v[52:55], v[16:19]
    s_add_u32 s36, s36, 32768
    v_permlane32_swap_b32 v68, v69
    v_mfma_f32_16x16x32_bf16 v[12:15], v[200:203], v[52:55], v[12:15]
    s_cmp_ge_i32 s31, 30
    s_cselect_b32 s18, 0x1ffff, s18
    v_add_f32 v68, v68, v69
    v_mfma_f32_16x16x32_bf16 v[12:15], v[188:191], v[48:51], v[12:15]
    s_add_u32 s33, s33, 34816
    v_mul_f32 v68, 0x3a800000, v68
    v_mov_b32 v69, v68
    v_mfma_f32_16x16x32_bf16 v[8:11], v[184:187], v[48:51], v[8:11]
    ds_read_b128 v[48:51], v2 offset:30720
    s_add_u32 s34, s34, 36864
    v_mfma_f32_16x16x32_bf16 v[8:11], v[196:199], v[52:55], v[8:11]
    ds_read_b128 v[52:55], v2 offset:31744
    s_waitcnt lgkmcnt(2)
    v_mfma_f32_16x16x32_bf16 v[8:11], v[208:211], v[40:43], v[8:11]
    s_cmp_ge_u32 s34, 147456
    s_cselect_b32 s38, 147456, 0
    s_sub_u32 s34, s34, s38
    v_mfma_f32_16x16x32_bf16 v[8:11], v[220:223], v[44:47], v[8:11]
    buffer_load_dwordx4 v[96:99], v1, s[24:27], s41 offen sc1
    v_mfma_f32_16x16x32_bf16 v[12:15], v[224:227], v[44:47], v[12:15]
    s_waitcnt vmcnt(12)
    v_cmp_gt_i32 vcc, s32, v5
    v_mfma_f32_16x16x32_bf16 v[12:15], v[212:215], v[40:43], v[12:15]
    v_permlane16_swap_b32 v68, v69
    v_mfma_f32_16x16x32_bf16 v[16:19], v[216:219], v[40:43], v[16:19]
    ds_read_b128 v[40:43], v3 offset:0
    v_fma_f32 v69, -v68, v68, v69
    v_mfma_f32_16x16x32_bf16 v[16:19], v[228:231], v[44:47], v[16:19]
    ds_read_b128 v[44:47], v3 offset:1024
    s_waitcnt lgkmcnt(2)
    v_mfma_f32_16x16x32_bf16 v[16:19], v[240:243], v[48:51], v[16:19]
    s_and_b64 vcc, vcc, s[18:19]
    s_cbranch_scc1 Lqkv_slowg01
Lqkv_backg01:
    v_mfma_f32_16x16x32_bf16 v[16:19], v[252:255], v[52:55], v[16:19]
    s_add_u32 s16, s16, 8192
    v_max_f32 v69, 0, v69
    v_add_f32 v69, 0x3727c5ac, v69
    v_mfma_f32_16x16x32_bf16 v[12:15], v[248:251], v[52:55], v[12:15]
    s_and_b32 s16, s16, 524287
    v_rsq_f32 v69, v69
    v_mfma_f32_16x16x32_bf16 v[12:15], v[236:239], v[48:51], v[12:15]
    buffer_load_dword v5, v4, s[4:7], s16 offen sc1
    v_mfma_f32_16x16x32_bf16 v[8:11], v[232:235], v[48:51], v[8:11]
    ds_read_b128 v[48:51], v3 offset:2048
    v_mfma_f32_16x16x32_bf16 v[8:11], v[244:247], v[52:55], v[8:11]
    ds_read_b128 v[52:55], v3 offset:3072
    s_and_b32 s37, s31, 30
    s_cbranch_scc1 Lqkv_g11
    s_branch Lqkv_s11
Lqkv_slows11:
Lqkv_spins11:
    buffer_load_dword v5, v4, s[4:7], s16 offen sc1
    s_waitcnt vmcnt(0)
    v_cmp_gt_i32 vcc, s32, v5
    s_sub_u32 s43, s43, 1
    s_cmp_lt_i32 s43, 0
    s_cbranch_scc1 Lqkv_backs11
    s_and_b64 vcc, vcc, s[18:19]
    s_cbranch_scc0 Lqkv_backs11
    s_sleep 8
    s_branch Lqkv_spins11
Lqkv_slowg11:
Lqkv_sping11:
    buffer_load_dword v5, v4, s[4:7], s16 offen sc1
    s_waitcnt vmcnt(0)
    v_cmp_gt_i32 vcc, s32, v5
    s_sub_u32 s43, s43, 1
    s_cmp_lt_i32 s43, 0
    s_cbranch_scc1 Lqkv_backg11
    s_and_b64 vcc, vcc, s[18:19]
    s_cbranch_scc0 Lqkv_backg11
    s_sleep 8
    s_branch Lqkv_sping11
Lqkv_slowg01:
Lqkv_sping01:
    buffer_load_dword v5, v4, s[4:7], s16 offen sc1
    s_waitcnt vmcnt(0)
    v_cmp_gt_i32 vcc, s32, v5
    s_sub_u32 s43, s43, 1
    s_cmp_lt_i32 s43, 0
    s_cbranch_scc1 Lqkv_backg01
    s_and_b64 vcc, vcc, s[18:19]
    s_cbranch_scc0 Lqkv_backg01
    s_sleep 8
    s_branch Lqkv_sping01
Lqkv_s12:
    s_waitcnt lgkmcnt(2)
    v_mfma_f32_16x16x32_bf16 v[24:27], a[0:3], v[40:43], 0
    s_add_u32 m0, s34, 0
    v_mul_f32 v124, s52, v71
    v_mov_b32 v106, s42
    v_mfma_f32_16x16x32_bf16 v[24:27], a[12:15], v[44:47], v[24:27]
    s_add_u32 s35, s35, 36864
    v_mov_b32 v107, s42
    v_mov_b32 v108, s42
    v_mfma_f32_16x16x32_bf16 v[28:31], a[16:19], v[44:47], 0
    s_cmp_eq_u32 s35, 147456
    s_cselect_b32 s35, 0, s35
    v_mov_b32 v109, s42
    v_mfma_f32_16x16x32_bf16 v[28:31], a[4:7], v[40:43], v[28:31]
    s_waitcnt vmcnt(1)
    v_fma_f32 v16, -v68, v64, v16
    v_fma_f32 v17, -v68, v65, v17
    v_mfma_f32_16x16x32_bf16 v[106:109], v[96:99], v[88:91], v[106:109]
    v_fma_f32 v18, -v68, v66, v18
    v_fma_f32 v19, -v68, v67, v19
    v_mfma_f32_16x16x32_bf16 v[32:35], a[8:11], v[40:43], 0
    ds_read_b128 v[40:43], v3 offset:4096
    v_mul_f32 v16, v16, v69
    v_mfma_f32_16x16x32_bf16 v[32:35], a[20:23], v[44:47], v[32:35]
    ds_read_b128 v[44:47], v3 offset:5120
    s_waitcnt lgkmcnt(2)
    v_mfma_f32_16x16x32_bf16 v[32:35], a[32:35], v[48:51], v[32:35]
    v_cndmask_b32 v106, v106, v107, s[44:45]
    v_cndmask_b32 v108, v108, v109, s[44:45]
    v_mfma_f32_16x16x32_bf16 v[32:35], a[44:47], v[52:55], v[32:35]
    v_cndmask_b32 v120, v106, v118, s[48:49]
    v_cndmask_b32 v121, v108, v119, s[50:51]
    v_mfma_f32_16x16x32_bf16 v[28:31], a[40:43], v[52:55], v[28:31]
    v_mul_f32 v17, v17, v69
    v_mul_f32 v18, v18, v69
    v_mfma_f32_16x16x32_bf16 v[28:31], a[28:31], v[48:51], v[28:31]
    ds_write_b64 v36, v[120:121] offset:2048
    v_mfma_f32_16x16x32_bf16 v[24:27], a[24:27], v[48:51], v[24:27]
    ds_read_b128 v[48:51], v3 offset:6144
    v_mul_f32 v19, v19, v69
    v_mfma_f32_16x16x32_bf16 v[24:27], a[36:39], v[52:55], v[24:27]
    ds_read_b128 v[52:55], v3 offset:7168
    s_waitcnt lgkmcnt(3)
    v_mfma_f32_16x16x32_bf16 v[24:27], a[48:51], v[40:43], v[24:27]
    v_cvt_pk_bf16_f32 v16, v16, v17
    v_cvt_pk_bf16_f32 v17, v18, v19
    v_mfma_f32_16x16x32_bf16 v[24:27], a[60:63], v[44:47], v[24:27]
    s_waitcnt lgkmcnt(2)
    ds_write_b64 v38, v[16:17]
    v_mfma_f32_16x16x32_bf16 v[28:31], a[64:67], v[44:47], v[28:31]
    ds_read_b64_tr_b16 v[92:93], v39
    v_fma_f32 v12, -v68, v60, v12
    v_mfma_f32_16x16x32_bf16 v[28:31], a[52:55], v[40:43], v[28:31]
    buffer_load_dwordx4 v1, s[8:11], s33 offen offset:0 sc1 lds
    v_mfma_f32_16x16x32_bf16 v[32:35], a[56:59], v[40:43], v[32:35]
    ds_read_b128 v[40:43], v3 offset:8192
    v_fma_f32 v13, -v68, v61, v13
    v_mfma_f32_16x16x32_bf16 v[32:35], a[68:71], v[44:47], v[32:35]
    ds_read_b128 v[44:47], v3 offset:9216
    s_waitcnt lgkmcnt(4)
    v_mfma_f32_16x16x32_bf16 v[32:35], a[80:83], v[48:51], v[32:35]
    v_fma_f32 v14, -v68, v62, v14
    v_fma_f32 v15, -v68, v63, v15
    v_mfma_f32_16x16x32_bf16 v[32:35], a[92:95], v[52:55], v[32:35]
    s_barrier
    v_mfma_f32_16x16x32_bf16 v[28:31], a[88:91], v[52:55], v[28:31]
    buffer_load_dwordx4 v1, s[8:11], s33 offen offset:1024 sc1 lds
    v_mfma_f32_16x16x32_bf16 v[28:31], a[76:79], v[48:51], v[28:31]
    ds_read_b64 v[122:123], v37 offset:2048
    v_mul_f32 v12, v12, v69
    v_mfma_f32_16x16x32_bf16 v[24:27], a[72:75], v[48:51], v[24:27]
    ds_read_b128 v[48:51], v3 offset:10240
    v_mul_f32 v13, v13, v69
    v_mfma_f32_16x16x32_bf16 v[24:27], a[84:87], v[52:55], v[24:27]
    ds_read_b128 v[52:55], v3 offset:11264
    s_waitcnt lgkmcnt(3)
    v_mfma_f32_16x16x32_bf16 v[24:27], a[96:99], v[40:43], v[24:27]
    buffer_store_dword v6, v21, s[12:15], s17 offen sc1
    v_mul_f32 v14, v14, v69
    v_mfma_f32_16x16x32_bf16 v[24:27], a[108:111], v[44:47], v[24:27]
    s_cmp_ge_i32 s54, 0
    s_cselect_b32 s14, s6, 0
    v_mul_f32 v15, v15, v69
    v_mfma_f32_16x16x32_bf16 v[28:31], a[112:115], v[44:47], v[28:31]
    s_waitcnt lgkmcnt(2)
    buffer_load_dwordx4 v1, s[8:11], s33 offen offset:2048 sc1 lds
    v_mfma_f32_16x16x32_bf16 v[28:31], a[100:103], v[40:43], v[28:31]
    s_add_u32 s17, s17, 8192
    v_add_f32 v122, v122, v120
    v_add_f32 v123, v123, v121
    v_mfma_f32_16x16x32_bf16 v[32:35], a[104:107], v[40:43], v[32:35]
    ds_read_b128 v[40:43], v3 offset:12288
    v_max_f32 v22, v122, v123
    v_mfma_f32_16x16x32_bf16 v[32:35], a[116:119], v[44:47], v[32:35]
    ds_read_b128 v[44:47], v3 offset:13312
    s_waitcnt lgkmcnt(2)
    v_mfma_f32_16x16x32_bf16 v[32:35], a[128:131], v[48:51], v[32:35]
    v_mov_b32 v23, v22
    v_sub_u32 v76, v3, v20
    v_mfma_f32_16x16x32_bf16 v[32:35], a[140:143], v[52:55], v[32:35]
    buffer_load_dwordx4 v1, s[8:11], s33 offen offset:3072 sc1 lds
    v_mfma_f32_16x16x32_bf16 v[28:31], a[136:139], v[52:55], v[28:31]
    s_add_u32 m0, s34, 4096
    v_permlane16_swap_b32 v22, v23
    v_mfma_f32_16x16x32_bf16 v[28:31], a[124:127], v[48:51], v[28:31]
    s_add_u32 s37, s33, 4096
    v_max_f32 v22, v22, v23
    v_mov_b32 v23, v22
    v_mfma_f32_16x16x32_bf16 v[24:27], a[120:123], v[48:51], v[24:27]
    ds_read_b128 v[48:51], v3 offset:14336
    v_cvt_pk_bf16_f32 v84, v12, v13
    v_mfma_f32_16x16x32_bf16 v[24:27], a[132:135], v[52:55], v[24:27]
    ds_read_b128 v[52:55], v3 offset:15360
    s_waitcnt lgkmcnt(2)
    v_mfma_f32_16x16x32_bf16 v[24:27], a[144:147], v[40:43], v[24:27]
    buffer_load_dwordx4 v1, s[8:11], s37 offen offset:0 sc1 lds
    v_mfma_f32_16x16x32_bf16 v[24:27], a[156:159], v[44:47], v[24:27]
    ds_read2st64_b64 v[80:83], v76 offset0:66 offset1:67
    v_cvt_pk_bf16_f32 v85, v14, v15
    v_mfma_f32_16x16x32_bf16 v[28:31], a[160:163], v[44:47], v[28:31]
    ds_read2st64_b64 v[76:79], v76 offset0:64 offset1:65
    v_fma_f32 v8, -v68, v56, v8
    v_mfma_f32_16x16x32_bf16 v[28:31], a[148:151], v[40:43], v[28:31]
    v_permlane32_swap_b32 v22, v23
    v_mfma_f32_16x16x32_bf16 v[32:35], a[152:155], v[40:43], v[32:35]
    ds_read_b128 v[40:43], v3 offset:16384
    v_max_f32 v22, v22, v23
    v_mfma_f32_16x16x32_bf16 v[32:35], a[164:167], v[44:47], v[32:35]
    ds_read_b128 v[44:47], v3 offset:17408
    s_waitcnt lgkmcnt(4)
    v_mfma_f32_16x16x32_bf16 v[32:35], a[176:179], v[48:51], v[32:35]
    buffer_load_dwordx4 v1, s[8:11], s37 offen offset:1024 sc1 lds
    v_mfma_f32_16x16x32_bf16 v[32:35], a[188:191], v[52:55], v[32:35]
    v_mul_f32 v22, v124, v22
    v_fma_f32 v122, v122, v124, -v22
    v_mfma_f32_16x16x32_bf16 v[28:31], a[184:187], v[52:55], v[28:31]
    v_fma_f32 v123, v123, v124, -v22
    v_fma_f32 v9, -v68, v57, v9
    v_mfma_f32_16x16x32_bf16 v[28:31], a[172:175], v[48:51], v[28:31]
    v_exp_f32 v122, v122
    v_mfma_f32_16x16x32_bf16 v[24:27], a[168:171], v[48:51], v[24:27]
    ds_read_b128 v[48:51], v3 offset:18432
    v_fma_f32 v10, -v68, v58, v10
    v_mfma_f32_16x16x32_bf16 v[24:27], a[180:183], v[52:55], v[24:27]
    ds_read_b128 v[52:55], v3 offset:19456
    s_waitcnt lgkmcnt(2)
    v_mfma_f32_16x16x32_bf16 v[24:27], a[192:195], v[40:43], v[24:27]
    buffer_load_dwordx4 v1, s[8:11], s37 offen offset:2048 sc1 lds
    v_mfma_f32_16x16x32_bf16 v[24:27], a[204:207], v[44:47], v[24:27]
    v_exp_f32 v123, v123
    v_mfma_f32_16x16x32_bf16 v[28:31], a[208:211], v[44:47], v[28:31]
    v_add_f32 v22, v122, v123
    v_mov_b32 v23, v22
    v_mfma_f32_16x16x32_bf16 v[28:31], a[196:199], v[40:43], v[28:31]
    s_nop 0
    v_permlane16_swap_b32 v22, v23
    v_mfma_f32_16x16x32_bf16 v[32:35], a[200:203], v[40:43], v[32:35]
    ds_read_b128 v[40:43], v3 offset:20480
    v_add_f32 v22, v22, v23
    v_mfma_f32_16x16x32_bf16 v[32:35], a[212:215], v[44:47], v[32:35]
    ds_read_b128 v[44:47], v3 offset:21504
    s_waitcnt lgkmcnt(2)
    v_mfma_f32_16x16x32_bf16 v[32:35], a[224:227], v[48:51], v[32:35]
    buffer_load_dwordx4 v1, s[8:11], s37 offen offset:3072 sc1 lds
    v_mfma_f32_16x16x32_bf16 v[32:35], a[236:239], v[52:55], v[32:35]
    s_add_u32 m0, s34, 8192
    v_mov_b32 v23, v22
    v_fma_f32 v11, -v68, v59, v11
    v_mfma_f32_16x16x32_bf16 v[28:31], a[232:235], v[52:55], v[28:31]
    s_add_u32 s37, s33, 8192
    v_permlane32_swap_b32 v22, v23
    v_mfma_f32_16x16x32_bf16 v[28:31], a[220:223], v[48:51], v[28:31]
    v_add_f32 v22, v22, v23
    v_cvt_pk_bf16_f32 v88, v8, v9
    v_mfma_f32_16x16x32_bf16 v[24:27], a[216:219], v[48:51], v[24:27]
    ds_read_b128 v[48:51], v3 offset:22528
    v_cvt_pk_bf16_f32 v89, v10, v11
    v_mfma_f32_16x16x32_bf16 v[24:27], a[228:231], v[52:55], v[24:27]
    ds_read_b128 v[52:55], v3 offset:23552
    s_waitcnt lgkmcnt(2)
    v_mfma_f32_16x16x32_bf16 v[110:113], v[84:87], v[88:91], 0
    buffer_load_dwordx4 v1, s[8:11], s37 offen offset:0 sc1 lds
    v_mfma_f32_16x16x32_bf16 v[24:27], a[240:243], v[40:43], v[24:27]
    v_mov_b32 v8, v84
    v_mov_b32 v9, v85
    v_mfma_f32_16x16x32_bf16 v[24:27], a[252:255], v[44:47], v[24:27]
    v_rcp_f32 v22, v22
    v_mfma_f32_16x16x32_bf16 v[28:31], v[128:131], v[44:47], v[28:31]
    v_mul_f32 v122, v122, v22
    v_mul_f32 v123, v123, v22
    v_mfma_f32_16x16x32_bf16 v[28:31], a[244:247], v[40:43], v[28:31]
    v_cvt_pk_bf16_f32 v23, v122, v123
    v_perm_b32 v114, v23, v23, v102
    v_mfma_f32_16x16x32_bf16 v[32:35], a[248:251], v[40:43], v[32:35]
    ds_read_b128 v[40:43], v3 offset:24576
    v_mov_b32 v10, v92
    v_mfma_f32_16x16x32_bf16 v[32:35], v[132:135], v[44:47], v[32:35]
    ds_read_b128 v[44:47], v3 offset:25600
    s_waitcnt lgkmcnt(2)
    v_mfma_f32_16x16x32_bf16 v[32:35], v[144:147], v[48:51], v[32:35]
    v_mov_b32 v11, v93
    v_perm_b32 v115, v23, v23, v103
    v_mfma_f32_16x16x32_bf16 v[32:35], v[156:159], v[52:55], v[32:35]
    buffer_store_dwordx4 v[8:11], v1, s[4:7], s40 offen sc1
    v_perm_b32 v116, v23, v23, v104
    v_mfma_f32_16x16x32_bf16 v[28:31], v[152:155], v[52:55], v[28:31]
    s_add_u32 s40, s40, 262144
    v_perm_b32 v117, v23, v23, v105
    v_mov_b32 v100, v94
    v_mfma_f32_16x16x32_bf16 v[28:31], v[140:143], v[48:51], v[28:31]
    s_add_u32 s41, s41, 262144
    v_mov_b32 v101, v95
    v_cndmask_b32 v118, v110, v111, s[44:45]
    v_mfma_f32_16x16x32_bf16 v[24:27], v[136:139], v[48:51], v[24:27]
    ds_read_b128 v[48:51], v3 offset:26624
    v_cndmask_b32 v119, v112, v113, s[44:45]
    v_mfma_f32_16x16x32_bf16 v[72:75], v[98:101], v[114:117], 0
    v_add_f32 v76, v76, v80
    v_add_f32 v77, v77, v81
    v_mfma_f32_16x16x32_bf16 v[24:27], v[148:151], v[52:55], v[24:27]
    ds_read_b128 v[52:55], v3 offset:27648
    s_waitcnt lgkmcnt(2)
    v_mfma_f32_16x16x32_bf16 v[24:27], v[160:163], v[40:43], v[24:27]
    v_add_f32 v78, v78, v82
    v_add_f32 v79, v79, v83
    v_mfma_f32_16x16x32_bf16 v[24:27], v[172:175], v[44:47], v[24:27]
    v_cvt_pk_bf16_f32 v114, v72, v73
    v_cvt_pk_bf16_f32 v115, v74, v75
    v_mfma_f32_16x16x32_bf16 v[28:31], v[176:179], v[44:47], v[28:31]
    v_cvt_pk_bf16_f32 v116, v72, v73
    v_cvt_pk_bf16_f32 v117, v74, v75
    v_mfma_f32_16x16x32_bf16 v[28:31], v[164:167], v[40:43], v[28:31]
    s_add_u32 s31, s31, 1
    v_permlane32_swap_b32 v114, v116
    v_mfma_f32_16x16x32_bf16 v[32:35], v[168:171], v[40:43], v[32:35]
    ds_read_b128 v[40:43], v3 offset:28672
    v_add_f32 v70, v76, v78
    v_mfma_f32_16x16x32_bf16 v[32:35], v[180:183], v[44:47], v[32:35]
    ds_read_b128 v[44:47], v3 offset:29696
    s_waitcnt lgkmcnt(2)
    v_mfma_f32_16x16x32_bf16 v[32:35], v[192:195], v[48:51], v[32:35]
    s_sub_u32 s54, s31, 2
    v_permlane32_swap_b32 v115, v117
    v_mfma_f32_16x16x32_bf16 v[32:35], v[204:207], v[52:55], v[32:35]
    buffer_store_dwordx4 v[114:117], v7, s[12:15], s36 offen sc1
    v_mov_b32 v6, s54
    v_mfma_f32_16x16x32_bf16 v[28:31], v[200:203], v[52:55], v[28:31]
    s_add_u32 s36, s36, 32768
    v_add_f32 v71, v77, v79
    v_add_u32 v2, s35, v1
    v_mfma_f32_16x16x32_bf16 v[28:31], v[188:191], v[48:51], v[28:31]
    s_cmp_ge_i32 s31, 30
    s_cselect_b32 s18, 0x1ffff, s18
    s_add_u32 s33, s33, 34816
    v_mfma_f32_16x16x32_bf16 v[24:27], v[184:187], v[48:51], v[24:27]
    ds_read_b128 v[48:51], v3 offset:30720
    s_add_u32 s34, s34, 36864
    v_mfma_f32_16x16x32_bf16 v[24:27], v[196:199], v[52:55], v[24:27]
    ds_read_b128 v[52:55], v3 offset:31744
    s_waitcnt lgkmcnt(2)
    v_mfma_f32_16x16x32_bf16 v[24:27], v[208:211], v[40:43], v[24:27]
    s_cmp_ge_u32 s34, 147456
    s_cselect_b32 s38, 147456, 0
    s_sub_u32 s34, s34, s38
    v_mfma_f32_16x16x32_bf16 v[24:27], v[220:223], v[44:47], v[24:27]
    s_waitcnt vmcnt(12)
    v_cmp_gt_i32 vcc, s32, v5
    v_mfma_f32_16x16x32_bf16 v[28:31], v[224:227], v[44:47], v[28:31]
    v_permlane16_swap_b32 v70, v71
    v_mfma_f32_16x16x32_bf16 v[28:31], v[212:215], v[40:43], v[28:31]
    s_and_b64 vcc, vcc, s[18:19]
    s_cbranch_scc1 Lqkv_slows12
Lqkv_backs12:
    v_mfma_f32_16x16x32_bf16 v[32:35], v[216:219], v[40:43], v[32:35]
    ds_read_b128 v[40:43], v2 offset:0
    v_add_f32 v70, v70, v71
    v_mfma_f32_16x16x32_bf16 v[32:35], v[228:231], v[44:47], v[32:35]
    ds_read_b128 v[44:47], v2 offset:1024
    s_waitcnt lgkmcnt(2)
    v_mfma_f32_16x16x32_bf16 v[32:35], v[240:243], v[48:51], v[32:35]
    s_add_u32 s16, s16, 8192
    v_mov_b32 v71, v70
    s_and_b32 s16, s16, 524287
    v_mfma_f32_16x16x32_bf16 v[32:35], v[252:255], v[52:55], v[32:35]
    buffer_load_dword v5, v4, s[4:7], s16 offen sc1
    v_mfma_f32_16x16x32_bf16 v[28:31], v[248:251], v[52:55], v[28:31]
    v_permlane32_swap_b32 v70, v71
    v_mfma_f32_16x16x32_bf16 v[28:31], v[236:239], v[48:51], v[28:31]
    v_add_f32 v70, v70, v71
    v_mul_f32 v70, 0x3a800000, v70
    v_mfma_f32_16x16x32_bf16 v[24:27], v[232:235], v[48:51], v[24:27]
    ds_read_b128 v[48:51], v2 offset:2048
    v_mov_b32 v71, v70
    v_mfma_f32_16x16x32_bf16 v[24:27], v[244:247], v[52:55], v[24:27]
    ds_read_b128 v[52:55], v2 offset:3072
    v_permlane16_swap_b32 v70, v71
    v_fma_f32 v71, -v70, v70, v71
    v_max_f32 v71, 0, v71
    v_add_f32 v71, 0x3727c5ac, v71
    v_rsq_f32 v71, v71
    s_nop 1
    s_branch Lqkv_g02
    .p2align 6
Lqkv_g12:
    s_waitcnt lgkmcnt(2)
    v_mfma_f32_16x16x32_bf16 v[24:27], a[0:3], v[40:43], 0
    s_add_u32 m0, s34, 0
    v_mul_f32 v124, s52, v71
    v_fma_f32 v16, -v68, v64, v16
    v_mfma_f32_16x16x32_bf16 v[24:27], a[12:15], v[44:47], v[24:27]
    s_add_u32 s35, s35, 36864
    v_fma_f32 v12, -v68, v60, v12
    v_fma_f32 v13, -v68, v61, v13
    v_mfma_f32_16x16x32_bf16 v[28:31], a[16:19], v[44:47], 0
    s_cmp_eq_u32 s35, 147456
    s_cselect_b32 s35, 0, s35
    v_fma_f32 v14, -v68, v62, v14
    v_mfma_f32_16x16x32_bf16 v[28:31], a[4:7], v[40:43], v[28:31]
    v_fma_f32 v15, -v68, v63, v15
    v_mul_f32 v12, v12, v69
    v_mfma_f32_16x16x32_bf16 v[32:35], a[8:11], v[40:43], 0
    ds_read_b128 v[40:43], v3 offset:4096
    v_mul_f32 v13, v13, v69
    v_mfma_f32_16x16x32_bf16 v[32:35], a[20:23], v[44:47], v[32:35]
    ds_read_b128 v[44:47], v3 offset:5120
    s_waitcnt lgkmcnt(2)
    v_mfma_f32_16x16x32_bf16 v[32:35], a[32:35], v[48:51], v[32:35]
    v_mul_f32 v14, v14, v69
    v_mul_f32 v15, v15, v69
    v_mfma_f32_16x16x32_bf16 v[32:35], a[44:47], v[52:55], v[32:35]
    v_cvt_pk_bf16_f32 v84, v12, v13
    v_cvt_pk_bf16_f32 v85, v14, v15
    v_mfma_f32_16x16x32_bf16 v[28:31], a[40:43], v[52:55], v[28:31]
    v_fma_f32 v17, -v68, v65, v17
    v_fma_f32 v18, -v68, v66, v18
    v_mfma_f32_16x16x32_bf16 v[106:109], v[84:87], v[88:91], 0
    v_fma_f32 v19, -v68, v67, v19
    v_mul_f32 v16, v16, v69
    v_mfma_f32_16x16x32_bf16 v[28:31], a[28:31], v[48:51], v[28:31]
    v_mul_f32 v17, v17, v69
    v_mul_f32 v18, v18, v69
    v_mfma_f32_16x16x32_bf16 v[24:27], a[24:27], v[48:51], v[24:27]
    ds_read_b128 v[48:51], v3 offset:6144
    v_mul_f32 v19, v19, v69
    v_mfma_f32_16x16x32_bf16 v[24:27], a[36:39], v[52:55], v[24:27]
    ds_read_b128 v[52:55], v3 offset:7168
    s_waitcnt lgkmcnt(2)
    v_mfma_f32_16x16x32_bf16 v[24:27], a[48:51], v[40:43], v[24:27]
    v_cndmask_b32 v106, v106, v107, s[44:45]
    v_cndmask_b32 v108, v108, v109, s[44:45]
    v_mfma_f32_16x16x32_bf16 v[24:27], a[60:63], v[44:47], v[24:27]
    v_cndmask_b32 v120, v106, v118, s[48:49]
    v_cndmask_b32 v121, v108, v119, s[50:51]
    v_mfma_f32_16x16x32_bf16 v[28:31], a[64:67], v[44:47], v[28:31]
    ds_write_b64 v36, v[120:121] offset:2048
    v_mfma_f32_16x16x32_bf16 v[28:31], a[52:55], v[40:43], v[28:31]
    v_cvt_pk_bf16_f32 v16, v16, v17
    v_cvt_pk_bf16_f32 v17, v18, v19
    v_mfma_f32_16x16x32_bf16 v[32:35], a[56:59], v[40:43], v[32:35]
    ds_read_b128 v[40:43], v3 offset:8192
    v_fma_f32 v8, -v68, v56, v8
    v_mfma_f32_16x16x32_bf16 v[32:35], a[68:71], v[44:47], v[32:35]
    ds_read_b128 v[44:47], v3 offset:9216
    s_waitcnt lgkmcnt(3)
    v_mfma_f32_16x16x32_bf16 v[32:35], a[80:83], v[48:51], v[32:35]
    s_waitcnt vmcnt(3) lgkmcnt(2)
    ds_write_b64 v38, v[16:17]
    v_mfma_f32_16x16x32_bf16 v[32:35], a[92:95], v[52:55], v[32:35]
    ds_read_b64_tr_b16 v[92:93], v39
    v_fma_f32 v9, -v68, v57, v9
    v_mfma_f32_16x16x32_bf16 v[28:31], a[88:91], v[52:55], v[28:31]
    s_barrier
    v_mfma_f32_16x16x32_bf16 v[28:31], a[76:79], v[48:51], v[28:31]
    buffer_load_dwordx4 v1, s[8:11], s33 offen offset:0 sc1 lds
    v_mfma_f32_16x16x32_bf16 v[24:27], a[72:75], v[48:51], v[24:27]
    ds_read_b128 v[48:51], v3 offset:10240
    v_fma_f32 v10, -v68, v58, v10
    v_mfma_f32_16x16x32_bf16 v[24:27], a[84:87], v[52:55], v[24:27]
    ds_read_b128 v[52:55], v3 offset:11264
    s_waitcnt lgkmcnt(4)
    v_mfma_f32_16x16x32_bf16 v[24:27], a[96:99], v[40:43], v[24:27]
    s_waitcnt vmcnt(3)
    buffer_store_dword v6, v21, s[12:15], s17 offen sc1
    v_mfma_f32_16x16x32_bf16 v[24:27], a[108:111], v[44:47], v[24:27]
    ds_read_b64 v[122:123], v37 offset:2048
    v_fma_f32 v11, -v68, v59, v11
    v_mfma_f32_16x16x32_bf16 v[28:31], a[112:115], v[44:47], v[28:31]
    s_cmp_ge_i32 s54, 0
    s_cselect_b32 s14, s6, 0
    v_cvt_pk_bf16_f32 v88, v8, v9
    v_mfma_f32_16x16x32_bf16 v[28:31], a[100:103], v[40:43], v[28:31]
    s_add_u32 s17, s17, 8192
    v_sub_u32 v76, v3, v20
    v_cvt_pk_bf16_f32 v89, v10, v11
    v_mfma_f32_16x16x32_bf16 v[32:35], a[104:107], v[40:43], v[32:35]
    ds_read_b128 v[40:43], v3 offset:12288
    v_add_u32 v2, s35, v1
    v_mfma_f32_16x16x32_bf16 v[110:113], v[84:87], v[88:91], 0
    buffer_load_dwordx4 v1, s[8:11], s33 offen offset:1024 sc1 lds
    v_mfma_f32_16x16x32_bf16 v[32:35], a[116:119], v[44:47], v[32:35]
    ds_read_b128 v[44:47], v3 offset:13312
    s_waitcnt lgkmcnt(2)
    v_mfma_f32_16x16x32_bf16 v[32:35], a[128:131], v[48:51], v[32:35]
    ds_read2st64_b64 v[80:83], v76 offset0:66 offset1:67
    v_add_f32 v122, v122, v120
    v_mfma_f32_16x16x32_bf16 v[32:35], a[140:143], v[52:55], v[32:35]
    ds_read2st64_b64 v[76:79], v76 offset0:64 offset1:65
    v_add_f32 v123, v123, v121
    v_mfma_f32_16x16x32_bf16 v[28:31], a[136:139], v[52:55], v[28:31]
    v_max_f32 v22, v122, v123
    v_mov_b32 v23, v22
    v_mfma_f32_16x16x32_bf16 v[28:31], a[124:127], v[48:51], v[28:31]
    buffer_load_dwordx4 v1, s[8:11], s33 offen offset:2048 sc1 lds
    v_mfma_f32_16x16x32_bf16 v[24:27], a[120:123], v[48:51], v[24:27]
    ds_read_b128 v[48:51], v3 offset:14336
    v_cndmask_b32 v118, v110, v111, s[44:45]
    v_mfma_f32_16x16x32_bf16 v[24:27], a[132:135], v[52:55], v[24:27]
    ds_read_b128 v[52:55], v3 offset:15360
    s_waitcnt lgkmcnt(4)
    v_mfma_f32_16x16x32_bf16 v[24:27], a[144:147], v[40:43], v[24:27]
    v_permlane16_swap_b32 v22, v23
    v_mfma_f32_16x16x32_bf16 v[24:27], a[156:159], v[44:47], v[24:27]
    v_max_f32 v22, v22, v23
    v_mov_b32 v23, v22
    v_mfma_f32_16x16x32_bf16 v[28:31], a[160:163], v[44:47], v[28:31]
    buffer_load_dwordx4 v1, s[8:11], s33 offen offset:3072 sc1 lds
    v_mfma_f32_16x16x32_bf16 v[28:31], a[148:151], v[40:43], v[28:31]
    s_add_u32 m0, s34, 4096
    v_permlane32_swap_b32 v22, v23
    v_mfma_f32_16x16x32_bf16 v[32:35], a[152:155], v[40:43], v[32:35]
    ds_read_b128 v[40:43], v3 offset:16384
    v_max_f32 v22, v22, v23
    v_mfma_f32_16x16x32_bf16 v[32:35], a[164:167], v[44:47], v[32:35]
    ds_read_b128 v[44:47], v3 offset:17408
    s_waitcnt lgkmcnt(2)
    v_mfma_f32_16x16x32_bf16 v[32:35], a[176:179], v[48:51], v[32:35]
    s_add_u32 s37, s33, 4096
    v_mul_f32 v22, v124, v22
    v_fma_f32 v122, v122, v124, -v22
    v_mfma_f32_16x16x32_bf16 v[32:35], a[188:191], v[52:55], v[32:35]
    buffer_load_dwordx4 v1, s[8:11], s37 offen offset:0 sc1 lds
    v_mfma_f32_16x16x32_bf16 v[28:31], a[184:187], v[52:55], v[28:31]
    v_fma_f32 v123, v123, v124, -v22
    v_cndmask_b32 v119, v112, v113, s[44:45]
    v_mfma_f32_16x16x32_bf16 v[28:31], a[172:175], v[48:51], v[28:31]
    v_exp_f32 v122, v122
    v_mfma_f32_16x16x32_bf16 v[24:27], a[168:171], v[48:51], v[24:27]
    ds_read_b128 v[48:51], v3 offset:18432
    v_add_f32 v76, v76, v80
    v_mfma_f32_16x16x32_bf16 v[24:27], a[180:183], v[52:55], v[24:27]
    ds_read_b128 v[52:55], v3 offset:19456
    s_waitcnt lgkmcnt(2)
    v_mfma_f32_16x16x32_bf16 v[24:27], a[192:195], v[40:43], v[24:27]
    buffer_load_dwordx4 v1, s[8:11], s37 offen offset:1024 sc1 lds
    v_mfma_f32_16x16x32_bf16 v[24:27], a[204:207], v[44:47], v[24:27]
    v_exp_f32 v123, v123
    v_mfma_f32_16x16x32_bf16 v[28:31], a[208:211], v[44:47], v[28:31]
    v_add_f32 v22, v122, v123
    v_mov_b32 v23, v22
    v_mfma_f32_16x16x32_bf16 v[28:31], a[196:199], v[40:43], v[28:31]
    s_nop 0
    v_permlane16_swap_b32 v22, v23
    v_mfma_f32_16x16x32_bf16 v[32:35], a[200:203], v[40:43], v[32:35]
    ds_read_b128 v[40:43], v3 offset:20480
    v_add_f32 v22, v22, v23
    v_mfma_f32_16x16x32_bf16 v[32:35], a[212:215], v[44:47], v[32:35]
    ds_read_b128 v[44:47], v3 offset:21504
    s_waitcnt lgkmcnt(2)
    v_mfma_f32_16x16x32_bf16 v[32:35], a[224:227], v[48:51], v[32:35]
    buffer_load_dwordx4 v1, s[8:11], s37 offen offset:2048 sc1 lds
    v_mfma_f32_16x16x32_bf16 v[32:35], a[236:239], v[52:55], v[32:35]
    v_mov_b32 v23, v22
    v_add_f32 v77, v77, v81
    v_mfma_f32_16x16x32_bf16 v[28:31], a[232:235], v[52:55], v[28:31]
    v_permlane32_swap_b32 v22, v23
    v_mfma_f32_16x16x32_bf16 v[28:31], a[220:223], v[48:51], v[28:31]
    v_add_f32 v22, v22, v23
    v_add_f32 v78, v78, v82
    v_mfma_f32_16x16x32_bf16 v[24:27], a[216:219], v[48:51], v[24:27]
    ds_read_b128 v[48:51], v3 offset:22528
    v_add_f32 v79, v79, v83
    v_mfma_f32_16x16x32_bf16 v[24:27], a[228:231], v[52:55], v[24:27]
    ds_read_b128 v[52:55], v3 offset:23552
    s_waitcnt lgkmcnt(2)
    v_mfma_f32_16x16x32_bf16 v[24:27], a[240:243], v[40:43], v[24:27]
    buffer_load_dwordx4 v1, s[8:11], s37 offen offset:3072 sc1 lds
    v_mfma_f32_16x16x32_bf16 v[24:27], a[252:255], v[44:47], v[24:27]
    s_add_u32 m0, s34, 8192
    v_rcp_f32 v22, v22
    v_mfma_f32_16x16x32_bf16 v[28:31], v[128:131], v[44:47], v[28:31]
    s_add_u32 s37, s33, 8192
    v_mul_f32 v122, v122, v22
    v_mul_f32 v123, v123, v22
    v_mfma_f32_16x16x32_bf16 v[28:31], a[244:247], v[40:43], v[28:31]
    v_cvt_pk_bf16_f32 v23, v122, v123
    v_perm_b32 v114, v23, v23, v102
    v_mfma_f32_16x16x32_bf16 v[32:35], a[248:251], v[40:43], v[32:35]
    ds_read_b128 v[40:43], v3 offset:24576
    v_perm_b32 v115, v23, v23, v103
    v_mfma_f32_16x16x32_bf16 v[32:35], v[132:135], v[44:47], v[32:35]
    ds_read_b128 v[44:47], v3 offset:25600
    s_waitcnt lgkmcnt(2)
    v_mfma_f32_16x16x32_bf16 v[32:35], v[144:147], v[48:51], v[32:35]
    buffer_load_dwordx4 v1, s[8:11], s37 offen offset:0 sc1 lds
    v_mfma_f32_16x16x32_bf16 v[32:35], v[156:159], v[52:55], v[32:35]
    v_perm_b32 v116, v23, v23, v104
    v_perm_b32 v117, v23, v23, v105
    v_mfma_f32_16x16x32_bf16 v[28:31], v[152:155], v[52:55], v[28:31]
    v_add_f32 v70, v76, v78
    v_add_f32 v71, v77, v79
    v_mfma_f32_16x16x32_bf16 v[72:75], v[92:95], v[114:117], 0
    s_nop 0
    v_permlane16_swap_b32 v70, v71
    v_mfma_f32_16x16x32_bf16 v[28:31], v[140:143], v[48:51], v[28:31]
    v_add_f32 v70, v70, v71
    v_mov_b32 v71, v70
    v_mfma_f32_16x16x32_bf16 v[24:27], v[136:139], v[48:51], v[24:27]
    ds_read_b128 v[48:51], v3 offset:26624
    v_mfma_f32_16x16x32_bf16 v[24:27], v[148:151], v[52:55], v[24:27]
    ds_read_b128 v[52:55], v3 offset:27648
    s_waitcnt lgkmcnt(2)
    v_mfma_f32_16x16x32_bf16 v[24:27], v[160:163], v[40:43], v[24:27]
    v_cvt_pk_bf16_f32 v114, v72, v73
    v_cvt_pk_bf16_f32 v115, v74, v75
    v_mfma_f32_16x16x32_bf16 v[24:27], v[172:175], v[44:47], v[24:27]
    v_cvt_pk_bf16_f32 v116, v72, v73
    v_cvt_pk_bf16_f32 v117, v74, v75
    v_mfma_f32_16x16x32_bf16 v[28:31], v[176:179], v[44:47], v[28:31]
    v_permlane32_swap_b32 v114, v116
    v_mfma_f32_16x16x32_bf16 v[28:31], v[164:167], v[40:43], v[28:31]
    s_add_u32 s31, s31, 1
    v_permlane32_swap_b32 v115, v117
    v_mfma_f32_16x16x32_bf16 v[32:35], v[168:171], v[40:43], v[32:35]
    ds_read_b128 v[40:43], v3 offset:28672
    s_sub_u32 s54, s31, 2
    v_mfma_f32_16x16x32_bf16 v[32:35], v[180:183], v[44:47], v[32:35]
    ds_read_b128 v[44:47], v3 offset:29696
    s_waitcnt lgkmcnt(2)
    v_mfma_f32_16x16x32_bf16 v[32:35], v[192:195], v[48:51], v[32:35]
    buffer_store_dwordx4 v[114:117], v7, s[12:15], s36 offen sc1
    v_mov_b32 v6, s54
    v_mfma_f32_16x16x32_bf16 v[32:35], v[204:207], v[52:55], v[32:35]
    s_add_u32 s36, s36, 32768
    v_permlane32_swap_b32 v70, v71
    v_mfma_f32_16x16x32_bf16 v[28:31], v[200:203], v[52:55], v[28:31]
    s_cmp_ge_i32 s31, 30
    s_cselect_b32 s18, 0x1ffff, s18
    v_add_f32 v70, v70, v71
    v_mfma_f32_16x16x32_bf16 v[28:31], v[188:191], v[48:51], v[28:31]
    s_add_u32 s33, s33, 34816
    v_mul_f32 v70, 0x3a800000, v70
    v_mov_b32 v71, v70
    v_mfma_f32_16x16x32_bf16 v[24:27], v[184:187], v[48:51], v[24:27]
    ds_read_b128 v[48:51], v3 offset:30720
    s_add_u32 s34, s34, 36864
    v_mfma_f32_16x16x32_bf16 v[24:27], v[196:199], v[52:55], v[24:27]
    ds_read_b128 v[52:55], v3 offset:31744
    s_waitcnt lgkmcnt(2)
    v_mfma_f32_16x16x32_bf16 v[24:27], v[208:211], v[40:43], v[24:27]
    s_cmp_ge_u32 s34, 147456
    s_cselect_b32 s38, 147456, 0
    s_sub_u32 s34, s34, s38
    v_mfma_f32_16x16x32_bf16 v[24:27], v[220:223], v[44:47], v[24:27]
    s_waitcnt vmcnt(11)
    v_cmp_gt_i32 vcc, s32, v5
    v_mfma_f32_16x16x32_bf16 v[28:31], v[224:227], v[44:47], v[28:31]
    v_permlane16_swap_b32 v70, v71
    v_mfma_f32_16x16x32_bf16 v[28:31], v[212:215], v[40:43], v[28:31]
    s_and_b64 vcc, vcc, s[18:19]
    s_cbranch_scc1 Lqkv_slowg12
Lqkv_backg12:
    v_mfma_f32_16x16x32_bf16 v[32:35], v[216:219], v[40:43], v[32:35]
    ds_read_b128 v[40:43], v2 offset:0
    v_fma_f32 v71, -v70, v70, v71
    v_mfma_f32_16x16x32_bf16 v[32:35], v[228:231], v[44:47], v[32:35]
    ds_read_b128 v[44:47], v2 offset:1024
    s_waitcnt lgkmcnt(2)
    v_mfma_f32_16x16x32_bf16 v[32:35], v[240:243], v[48:51], v[32:35]
    s_add_u32 s16, s16, 8192
    v_max_f32 v71, 0, v71
    v_add_f32 v71, 0x3727c5ac, v71
    v_mfma_f32_16x16x32_bf16 v[32:35], v[252:255], v[52:55], v[32:35]
    s_and_b32 s16, s16, 524287
    v_rsq_f32 v71, v71
    v_mfma_f32_16x16x32_bf16 v[28:31], v[248:251], v[52:55], v[28:31]
    buffer_load_dword v5, v4, s[4:7], s16 offen sc1
    v_mfma_f32_16x16x32_bf16 v[28:31], v[236:239], v[48:51], v[28:31]
    v_mfma_f32_16x16x32_bf16 v[24:27], v[232:235], v[48:51], v[24:27]
    ds_read_b128 v[48:51], v2 offset:2048
    v_mfma_f32_16x16x32_bf16 v[24:27], v[244:247], v[52:55], v[24:27]
    ds_read_b128 v[52:55], v2 offset:3072
    s_cmp_eq_u32 s31, 64
    s_cbranch_scc1 Lqkv_tail
Lqkv_g02:
    s_waitcnt lgkmcnt(2)
    v_mfma_f32_16x16x32_bf16 v[8:11], a[0:3], v[40:43], 0
    s_add_u32 m0, s34, 0
    v_mul_f32 v124, s52, v69
    v_fma_f32 v32, -v70, v64, v32
    v_mfma_f32_16x16x32_bf16 v[8:11], a[12:15], v[44:47], v[8:11]
    s_add_u32 s35, s35, 36864
    v_fma_f32 v28, -v70, v60, v28
    v_fma_f32 v29, -v70, v61, v29
    v_mfma_f32_16x16x32_bf16 v[12:15], a[16:19], v[44:47], 0
    s_cmp_eq_u32 s35, 147456
    s_cselect_b32 s35, 0, s35
    v_fma_f32 v30, -v70, v62, v30
    v_mfma_f32_16x16x32_bf16 v[12:15], a[4:7], v[40:43], v[12:15]
    v_fma_f32 v31, -v70, v63, v31
    v_mul_f32 v28, v28, v71
    v_mfma_f32_16x16x32_bf16 v[16:19], a[8:11], v[40:43], 0
    ds_read_b128 v[40:43], v2 offset:4096
    v_mul_f32 v29, v29, v71
    v_mfma_f32_16x16x32_bf16 v[16:19], a[20:23], v[44:47], v[16:19]
    ds_read_b128 v[44:47], v2 offset:5120
    s_waitcnt lgkmcnt(2)
    v_mfma_f32_16x16x32_bf16 v[16:19], a[32:35], v[48:51], v[16:19]
    v_mul_f32 v30, v30, v71
    v_mul_f32 v31, v31, v71
    v_mfma_f32_16x16x32_bf16 v[16:19], a[44:47], v[52:55], v[16:19]
    v_cvt_pk_bf16_f32 v84, v28, v29
    v_cvt_pk_bf16_f32 v85, v30, v31
    v_mfma_f32_16x16x32_bf16 v[12:15], a[40:43], v[52:55], v[12:15]
    v_fma_f32 v33, -v70, v65, v33
    v_fma_f32 v34, -v70, v66, v34
    v_mfma_f32_16x16x32_bf16 v[106:109], v[84:87], v[88:91], 0
    v_fma_f32 v35, -v70, v67, v35
    v_mul_f32 v32, v32, v71
    v_mfma_f32_16x16x32_bf16 v[12:15], a[28:31], v[48:51], v[12:15]
    v_mul_f32 v33, v33, v71
    v_mul_f32 v34, v34, v71
    v_mfma_f32_16x16x32_bf16 v[8:11], a[24:27], v[48:51], v[8:11]
    ds_read_b128 v[48:51], v2 offset:6144
    v_mul_f32 v35, v35, v71
    v_mfma_f32_16x16x32_bf16 v[8:11], a[36:39], v[52:55], v[8:11]
    ds_read_b128 v[52:55], v2 offset:7168
    s_waitcnt lgkmcnt(2)
    v_mfma_f32_16x16x32_bf16 v[8:11], a[48:51], v[40:43], v[8:11]
    v_cndmask_b32 v106, v106, v107, s[44:45]
    v_cndmask_b32 v108, v108, v109, s[44:45]
    v_mfma_f32_16x16x32_bf16 v[8:11], a[60:63], v[44:47], v[8:11]
    v_cndmask_b32 v120, v106, v118, s[48:49]
    v_cndmask_b32 v121, v108, v119, s[50:51]
    v_mfma_f32_16x16x32_bf16 v[12:15], a[64:67], v[44:47], v[12:15]
    ds_write_b64 v36, v[120:121] offset:0
    v_mfma_f32_16x16x32_bf16 v[12:15], a[52:55], v[40:43], v[12:15]
    v_cvt_pk_bf16_f32 v32, v32, v33
    v_cvt_pk_bf16_f32 v33, v34, v35
    v_mfma_f32_16x16x32_bf16 v[16:19], a[56:59], v[40:43], v[16:19]
    ds_read_b128 v[40:43], v2 offset:8192
    v_fma_f32 v24, -v70, v56, v24
    v_mfma_f32_16x16x32_bf16 v[16:19], a[68:71], v[44:47], v[16:19]
    ds_read_b128 v[44:47], v2 offset:9216
    s_waitcnt lgkmcnt(3)
    v_mfma_f32_16x16x32_bf16 v[16:19], a[80:83], v[48:51], v[16:19]
    s_waitcnt vmcnt(2) lgkmcnt(2)
    ds_write_b64 v38, v[32:33]
    v_mfma_f32_16x16x32_bf16 v[16:19], a[92:95], v[52:55], v[16:19]
    ds_read_b64_tr_b16 v[94:95], v39
    v_fma_f32 v25, -v70, v57, v25
    v_mfma_f32_16x16x32_bf16 v[12:15], a[88:91], v[52:55], v[12:15]
    s_barrier
    v_mfma_f32_16x16x32_bf16 v[12:15], a[76:79], v[48:51], v[12:15]
    buffer_load_dwordx4 v1, s[8:11], s33 offen offset:0 sc1 lds
    v_mfma_f32_16x16x32_bf16 v[8:11], a[72:75], v[48:51], v[8:11]
    ds_read_b128 v[48:51], v2 offset:10240
    v_fma_f32 v26, -v70, v58, v26
    v_mfma_f32_16x16x32_bf16 v[8:11], a[84:87], v[52:55], v[8:11]
    ds_read_b128 v[52:55], v2 offset:11264
    s_waitcnt lgkmcnt(4)
    v_mfma_f32_16x16x32_bf16 v[8:11], a[96:99], v[40:43], v[8:11]
    s_waitcnt vmcnt(2)
    buffer_store_dword v6, v21, s[12:15], s17 offen sc1
    v_mfma_f32_16x16x32_bf16 v[8:11], a[108:111], v[44:47], v[8:11]
    ds_read_b64 v[122:123], v37 offset:0
    v_fma_f32 v27, -v70, v59, v27
    v_mfma_f32_16x16x32_bf16 v[12:15], a[112:115], v[44:47], v[12:15]
    s_cmp_ge_i32 s54, 0
    s_cselect_b32 s14, s6, 0
    v_cvt_pk_bf16_f32 v88, v24, v25
    v_mfma_f32_16x16x32_bf16 v[12:15], a[100:103], v[40:43], v[12:15]
    s_add_u32 s17, s17, 8192
    v_sub_u32 v76, v2, v20
    v_cvt_pk_bf16_f32 v89, v26, v27
    v_mfma_f32_16x16x32_bf16 v[16:19], a[104:107], v[40:43], v[16:19]
    ds_read_b128 v[40:43], v2 offset:12288
    v_add_u32 v3, s35, v1
    v_mfma_f32_16x16x32_bf16 v[110:113], v[84:87], v[88:91], 0
    buffer_load_dwordx4 v1, s[8:11], s33 offen offset:1024 sc1 lds
    v_mfma_f32_16x16x32_bf16 v[16:19], a[116:119], v[44:47], v[16:19]
    ds_read_b128 v[44:47], v2 offset:13312
    s_waitcnt lgkmcnt(2)
    v_mfma_f32_16x16x32_bf16 v[16:19], a[128:131], v[48:51], v[16:19]
    ds_read2st64_b64 v[80:83], v76 offset0:66 offset1:67
    v_add_f32 v122, v122, v120
    v_mfma_f32_16x16x32_bf16 v[16:19], a[140:143], v[52:55], v[16:19]
    ds_read2st64_b64 v[76:79], v76 offset0:64 offset1:65
    v_add_f32 v123, v123, v121
    v_mfma_f32_16x16x32_bf16 v[12:15], a[136:139], v[52:55], v[12:15]
    v_max_f32 v22, v122, v123
    v_mov_b32 v23, v22
    v_mfma_f32_16x16x32_bf16 v[12:15], a[124:127], v[48:51], v[12:15]
    buffer_load_dwordx4 v1, s[8:11], s33 offen offset:2048 sc1 lds
    v_mfma_f32_16x16x32_bf16 v[8:11], a[120:123], v[48:51], v[8:11]
    ds_read_b128 v[48:51], v2 offset:14336
    v_cndmask_b32 v118, v110, v111, s[44:45]
    v_mfma_f32_16x16x32_bf16 v[8:11], a[132:135], v[52:55], v[8:11]
    ds_read_b128 v[52:55], v2 offset:15360
    s_waitcnt lgkmcnt(4)
    v_mfma_f32_16x16x32_bf16 v[8:11], a[144:147], v[40:43], v[8:11]
    v_permlane16_swap_b32 v22, v23
    v_mfma_f32_16x16x32_bf16 v[8:11], a[156:159], v[44:47], v[8:11]
    v_max_f32 v22, v22, v23
    v_mov_b32 v23, v22
    v_mfma_f32_16x16x32_bf16 v[12:15], a[160:163], v[44:47], v[12:15]
    buffer_load_dwordx4 v1, s[8:11], s33 offen offset:3072 sc1 lds
    v_mfma_f32_16x16x32_bf16 v[12:15], a[148:151], v[40:43], v[12:15]
    s_add_u32 m0, s34, 4096
    v_permlane32_swap_b32 v22, v23
    v_mfma_f32_16x16x32_bf16 v[16:19], a[152:155], v[40:43], v[16:19]
    ds_read_b128 v[40:43], v2 offset:16384
    v_max_f32 v22, v22, v23
    v_mfma_f32_16x16x32_bf16 v[16:19], a[164:167], v[44:47], v[16:19]
    ds_read_b128 v[44:47], v2 offset:17408
    s_waitcnt lgkmcnt(2)
    v_mfma_f32_16x16x32_bf16 v[16:19], a[176:179], v[48:51], v[16:19]
    s_add_u32 s37, s33, 4096
    v_mul_f32 v22, v124, v22
    v_fma_f32 v122, v122, v124, -v22
    v_mfma_f32_16x16x32_bf16 v[16:19], a[188:191], v[52:55], v[16:19]
    buffer_load_dwordx4 v1, s[8:11], s37 offen offset:0 sc1 lds
    v_mfma_f32_16x16x32_bf16 v[12:15], a[184:187], v[52:55], v[12:15]
    v_fma_f32 v123, v123, v124, -v22
    v_cndmask_b32 v119, v112, v113, s[44:45]
    v_mfma_f32_16x16x32_bf16 v[12:15], a[172:175], v[48:51], v[12:15]
    v_exp_f32 v122, v122
    v_mfma_f32_16x16x32_bf16 v[8:11], a[168:171], v[48:51], v[8:11]
    ds_read_b128 v[48:51], v2 offset:18432
    v_add_f32 v76, v76, v80
    v_mfma_f32_16x16x32_bf16 v[8:11], a[180:183], v[52:55], v[8:11]
    ds_read_b128 v[52:55], v2 offset:19456
    s_waitcnt lgkmcnt(2)
    v_mfma_f32_16x16x32_bf16 v[8:11], a[192:195], v[40:43], v[8:11]
    buffer_load_dwordx4 v1, s[8:11], s37 offen offset:1024 sc1 lds
    v_mfma_f32_16x16x32_bf16 v[8:11], a[204:207], v[44:47], v[8:11]
    v_exp_f32 v123, v123
    v_mfma_f32_16x16x32_bf16 v[12:15], a[208:211], v[44:47], v[12:15]
    v_add_f32 v22, v122, v123
    v_mov_b32 v23, v22
    v_mfma_f32_16x16x32_bf16 v[12:15], a[196:199], v[40:43], v[12:15]
    s_nop 0
    v_permlane16_swap_b32 v22, v23
    v_mfma_f32_16x16x32_bf16 v[16:19], a[200:203], v[40:43], v[16:19]
    ds_read_b128 v[40:43], v2 offset:20480
    v_add_f32 v22, v22, v23
    v_mfma_f32_16x16x32_bf16 v[16:19], a[212:215], v[44:47], v[16:19]
    ds_read_b128 v[44:47], v2 offset:21504
    s_waitcnt lgkmcnt(2)
    v_mfma_f32_16x16x32_bf16 v[16:19], a[224:227], v[48:51], v[16:19]
    buffer_load_dwordx4 v1, s[8:11], s37 offen offset:2048 sc1 lds
    v_mfma_f32_16x16x32_bf16 v[16:19], a[236:239], v[52:55], v[16:19]
    v_mov_b32 v23, v22
    v_add_f32 v77, v77, v81
    v_mfma_f32_16x16x32_bf16 v[12:15], a[232:235], v[52:55], v[12:15]
    v_permlane32_swap_b32 v22, v23
    v_mfma_f32_16x16x32_bf16 v[12:15], a[220:223], v[48:51], v[12:15]
    v_add_f32 v22, v22, v23
    v_add_f32 v78, v78, v82
    v_mfma_f32_16x16x32_bf16 v[8:11], a[216:219], v[48:51], v[8:11]
    ds_read_b128 v[48:51], v2 offset:22528
    v_add_f32 v79, v79, v83
    v_mfma_f32_16x16x32_bf16 v[8:11], a[228:231], v[52:55], v[8:11]
    ds_read_b128 v[52:55], v2 offset:23552
    s_waitcnt lgkmcnt(2)
    v_mfma_f32_16x16x32_bf16 v[8:11], a[240:243], v[40:43], v[8:11]
    buffer_load_dwordx4 v1, s[8:11], s37 offen offset:3072 sc1 lds
    v_mfma_f32_16x16x32_bf16 v[8:11], a[252:255], v[44:47], v[8:11]
    s_add_u32 m0, s34, 8192
    v_rcp_f32 v22, v22
    v_mfma_f32_16x16x32_bf16 v[12:15], v[128:131], v[44:47], v[12:15]
    s_add_u32 s37, s33, 8192
    v_mul_f32 v122, v122, v22
    v_mul_f32 v123, v123, v22
    v_mfma_f32_16x16x32_bf16 v[12:15], a[244:247], v[40:43], v[12:15]
    v_cvt_pk_bf16_f32 v23, v122, v123
    v_perm_b32 v116, v23, v23, v102
    v_mfma_f32_16x16x32_bf16 v[16:19], a[248:251], v[40:43], v[16:19]
    ds_read_b128 v[40:43], v2 offset:24576
    v_perm_b32 v117, v23, v23, v103
    v_mfma_f32_16x16x32_bf16 v[16:19], v[132:135], v[44:47], v[16:19]
    ds_read_b128 v[44:47], v2 offset:25600
    s_waitcnt lgkmcnt(2)
    v_mfma_f32_16x16x32_bf16 v[16:19], v[144:147], v[48:51], v[16:19]
    buffer_load_dwordx4 v1, s[8:11], s37 offen offset:0 sc1 lds
    v_mfma_f32_16x16x32_bf16 v[16:19], v[156:159], v[52:55], v[16:19]
    v_perm_b32 v114, v23, v23, v104
    v_perm_b32 v115, v23, v23, v105
    v_mfma_f32_16x16x32_bf16 v[12:15], v[152:155], v[52:55], v[12:15]
    v_add_f32 v68, v76, v78
    v_add_f32 v69, v77, v79
    v_mfma_f32_16x16x32_bf16 v[72:75], v[92:95], v[114:117], 0
    s_nop 0
    v_permlane16_swap_b32 v68, v69
    v_mfma_f32_16x16x32_bf16 v[12:15], v[140:143], v[48:51], v[12:15]
    v_add_f32 v68, v68, v69
    v_mov_b32 v69, v68
    v_mfma_f32_16x16x32_bf16 v[8:11], v[136:139], v[48:51], v[8:11]
    ds_read_b128 v[48:51], v2 offset:26624
    v_mfma_f32_16x16x32_bf16 v[8:11], v[148:151], v[52:55], v[8:11]
    ds_read_b128 v[52:55], v2 offset:27648
    s_waitcnt lgkmcnt(2)
    v_mfma_f32_16x16x32_bf16 v[8:11], v[160:163], v[40:43], v[8:11]
    v_cvt_pk_bf16_f32 v114, v72, v73
    v_cvt_pk_bf16_f32 v115, v74, v75
    v_mfma_f32_16x16x32_bf16 v[8:11], v[172:175], v[44:47], v[8:11]
    v_cvt_pk_bf16_f32 v116, v72, v73
    v_cvt_pk_bf16_f32 v117, v74, v75
    v_mfma_f32_16x16x32_bf16 v[12:15], v[176:179], v[44:47], v[12:15]
    v_permlane32_swap_b32 v114, v116
    v_mfma_f32_16x16x32_bf16 v[12:15], v[164:167], v[40:43], v[12:15]
    s_add_u32 s31, s31, 1
    v_permlane32_swap_b32 v115, v117
    v_mfma_f32_16x16x32_bf16 v[16:19], v[168:171], v[40:43], v[16:19]
    ds_read_b128 v[40:43], v2 offset:28672
    s_sub_u32 s54, s31, 2
    v_mfma_f32_16x16x32_bf16 v[16:19], v[180:183], v[44:47], v[16:19]
    ds_read_b128 v[44:47], v2 offset:29696
    s_waitcnt lgkmcnt(2)
    v_mfma_f32_16x16x32_bf16 v[16:19], v[192:195], v[48:51], v[16:19]
    buffer_store_dwordx4 v[114:117], v7, s[12:15], s36 offen sc1
    v_mov_b32 v6, s54
    v_mfma_f32_16x16x32_bf16 v[16:19], v[204:207], v[52:55], v[16:19]
    s_add_u32 s36, s36, 32768
    v_permlane32_swap_b32 v68, v69
    v_mfma_f32_16x16x32_bf16 v[12:15], v[200:203], v[52:55], v[12:15]
    s_cmp_ge_i32 s31, 30
    s_cselect_b32 s18, 0x1ffff, s18
    v_add_f32 v68, v68, v69
    v_mfma_f32_16x16x32_bf16 v[12:15], v[188:191], v[48:51], v[12:15]
    s_add_u32 s33, s33, 34816
    v_mul_f32 v68, 0x3a800000, v68
    v_mov_b32 v69, v68
    v_mfma_f32_16x16x32_bf16 v[8:11], v[184:187], v[48:51], v[8:11]
    ds_read_b128 v[48:51], v2 offset:30720
    s_add_u32 s34, s34, 36864
    v_mfma_f32_16x16x32_bf16 v[8:11], v[196:199], v[52:55], v[8:11]
    ds_read_b128 v[52:55], v2 offset:31744
    s_waitcnt lgkmcnt(2)
    v_mfma_f32_16x16x32_bf16 v[8:11], v[208:211], v[40:43], v[8:11]
    s_cmp_ge_u32 s34, 147456
    s_cselect_b32 s38, 147456, 0
    s_sub_u32 s34, s34, s38
    v_mfma_f32_16x16x32_bf16 v[8:11], v[220:223], v[44:47], v[8:11]
    buffer_load_dwordx4 v[96:99], v1, s[24:27], s41 offen sc1
    v_mfma_f32_16x16x32_bf16 v[12:15], v[224:227], v[44:47], v[12:15]
    s_waitcnt vmcnt(12)
    v_cmp_gt_i32 vcc, s32, v5
    v_mfma_f32_16x16x32_bf16 v[12:15], v[212:215], v[40:43], v[12:15]
    v_permlane16_swap_b32 v68, v69
    v_mfma_f32_16x16x32_bf16 v[16:19], v[216:219], v[40:43], v[16:19]
    ds_read_b128 v[40:43], v3 offset:0
    v_fma_f32 v69, -v68, v68, v69
    v_mfma_f32_16x16x32_bf16 v[16:19], v[228:231], v[44:47], v[16:19]
    ds_read_b128 v[44:47], v3 offset:1024
    s_waitcnt lgkmcnt(2)
    v_mfma_f32_16x16x32_bf16 v[16:19], v[240:243], v[48:51], v[16:19]
    s_and_b64 vcc, vcc, s[18:19]
    s_cbranch_scc1 Lqkv_slowg02
Lqkv_backg02:
    v_mfma_f32_16x16x32_bf16 v[16:19], v[252:255], v[52:55], v[16:19]
    s_add_u32 s16, s16, 8192
    v_max_f32 v69, 0, v69
    v_add_f32 v69, 0x3727c5ac, v69
    v_mfma_f32_16x16x32_bf16 v[12:15], v[248:251], v[52:55], v[12:15]
    s_and_b32 s16, s16, 524287
    v_rsq_f32 v69, v69
    v_mfma_f32_16x16x32_bf16 v[12:15], v[236:239], v[48:51], v[12:15]
    buffer_load_dword v5, v4, s[4:7], s16 offen sc1
    v_mfma_f32_16x16x32_bf16 v[8:11], v[232:235], v[48:51], v[8:11]
    ds_read_b128 v[48:51], v3 offset:2048
    v_mfma_f32_16x16x32_bf16 v[8:11], v[244:247], v[52:55], v[8:11]
    ds_read_b128 v[52:55], v3 offset:3072
    s_and_b32 s37, s31, 30
    s_cbranch_scc1 Lqkv_g12
    s_branch Lqkv_s12
Lqkv_slows12:
Lqkv_spins12:
    buffer_load_dword v5, v4, s[4:7], s16 offen sc1
    s_waitcnt vmcnt(0)
    v_cmp_gt_i32 vcc, s32, v5
    s_sub_u32 s43, s43, 1
    s_cmp_lt_i32 s43, 0
    s_cbranch_scc1 Lqkv_backs12
    s_and_b64 vcc, vcc, s[18:19]
    s_cbranch_scc0 Lqkv_backs12
    s_sleep 8
    s_branch Lqkv_spins12
Lqkv_slowg12:
Lqkv_sping12:
    buffer_load_dword v5, v4, s[4:7], s16 offen sc1
    s_waitcnt vmcnt(0)
    v_cmp_gt_i32 vcc, s32, v5
    s_sub_u32 s43, s43, 1
    s_cmp_lt_i32 s43, 0
    s_cbranch_scc1 Lqkv_backg12
    s_and_b64 vcc, vcc, s[18:19]
    s_cbranch_scc0 Lqkv_backg12
    s_sleep 8
    s_branch Lqkv_sping12
Lqkv_slowg02:
Lqkv_sping02:
    buffer_load_dword v5, v4, s[4:7], s16 offen sc1
    s_waitcnt vmcnt(0)
    v_cmp_gt_i32 vcc, s32, v5
    s_sub_u32 s43, s43, 1
    s_cmp_lt_i32 s43, 0
    s_cbranch_scc1 Lqkv_backg02
    s_and_b64 vcc, vcc, s[18:19]
    s_cbranch_scc0 Lqkv_backg02
    s_sleep 8
    s_branch Lqkv_sping02
Lqkv_s13:
    s_waitcnt lgkmcnt(2)
    v_mfma_f32_16x16x32_bf16 v[24:27], a[0:3], v[40:43], 0
    s_add_u32 m0, s34, 0
    v_mul_f32 v124, s52, v71
    v_mov_b32 v106, s42
    v_mfma_f32_16x16x32_bf16 v[24:27], a[12:15], v[44:47], v[24:27]
    s_add_u32 s35, s35, 36864
    v_mov_b32 v107, s42
    v_mov_b32 v108, s42
    v_mfma_f32_16x16x32_bf16 v[28:31], a[16:19], v[44:47], 0
    s_cmp_eq_u32 s35, 147456
    s_cselect_b32 s35, 0, s35
    v_mov_b32 v109, s42
    v_mfma_f32_16x16x32_bf16 v[28:31], a[4:7], v[40:43], v[28:31]
    s_waitcnt vmcnt(1)
    v_fma_f32 v16, -v68, v64, v16
    v_fma_f32 v17, -v68, v65, v17
    v_mfma_f32_16x16x32_bf16 v[106:109], v[96:99], v[88:91], v[106:109]
    v_fma_f32 v18, -v68, v66, v18
    v_fma_f32 v19, -v68, v67, v19
    v_mfma_f32_16x16x32_bf16 v[32:35], a[8:11], v[40:43], 0
    ds_read_b128 v[40:43], v3 offset:4096
    v_mul_f32 v16, v16, v69
    v_mfma_f32_16x16x32_bf16 v[32:35], a[20:23], v[44:47], v[32:35]
    ds_read_b128 v[44:47], v3 offset:5120
    s_waitcnt lgkmcnt(2)
    v_mfma_f32_16x16x32_bf16 v[32:35], a[32:35], v[48:51], v[32:35]
    v_cndmask_b32 v106, v106, v107, s[44:45]
    v_cndmask_b32 v108, v108, v109, s[44:45]
    v_mfma_f32_16x16x32_bf16 v[32:35], a[44:47], v[52:55], v[32:35]
    v_cndmask_b32 v120, v106, v118, s[48:49]
    v_cndmask_b32 v121, v108, v119, s[50:51]
    v_mfma_f32_16x16x32_bf16 v[28:31], a[40:43], v[52:55], v[28:31]
    v_mul_f32 v17, v17, v69
    v_mul_f32 v18, v18, v69
    v_mfma_f32_16x16x32_bf16 v[28:31], a[28:31], v[48:51], v[28:31]
    ds_write_b64 v36, v[120:121] offset:2048
    v_mfma_f32_16x16x32_bf16 v[24:27], a[24:27], v[48:51], v[24:27]
    ds_read_b128 v[48:51], v3 offset:6144
    v_mul_f32 v19, v19, v69
    v_mfma_f32_16x16x32_bf16 v[24:27], a[36:39], v[52:55], v[24:27]
    ds_read_b128 v[52:55], v3 offset:7168
    s_waitcnt lgkmcnt(3)
    v_mfma_f32_16x16x32_bf16 v[24:27], a[48:51], v[40:43], v[24:27]
    v_cvt_pk_bf16_f32 v16, v16, v17
    v_cvt_pk_bf16_f32 v17, v18, v19
    v_mfma_f32_16x16x32_bf16 v[24:27], a[60:63], v[44:47], v[24:27]
    s_waitcnt lgkmcnt(2)
    ds_write_b64 v38, v[16:17]
    v_mfma_f32_16x16x32_bf16 v[28:31], a[64:67], v[44:47], v[28:31]
    ds_read_b64_tr_b16 v[92:93], v39
    v_fma_f32 v12, -v68, v60, v12
    v_mfma_f32_16x16x32_bf16 v[28:31], a[52:55], v[40:43], v[28:31]
    buffer_load_dwordx4 v1, s[8:11], s33 offen offset:0 sc1 lds
    v_mfma_f32_16x16x32_bf16 v[32:35], a[56:59], v[40:43], v[32:35]
    ds_read_b128 v[40:43], v3 offset:8192
    v_fma_f32 v13, -v68, v61, v13
    v_mfma_f32_16x16x32_bf16 v[32:35], a[68:71], v[44:47], v[32:35]
    ds_read_b128 v[44:47], v3 offset:9216
    s_waitcnt lgkmcnt(4)
    v_mfma_f32_16x16x32_bf16 v[32:35], a[80:83], v[48:51], v[32:35]
    v_fma_f32 v14, -v68, v62, v14
    v_fma_f32 v15, -v68, v63, v15
    v_mfma_f32_16x16x32_bf16 v[32:35], a[92:95], v[52:55], v[32:35]
    v_mul_f32 v12, v12, v69
    v_mul_f32 v13, v13, v69
    v_mfma_f32_16x16x32_bf16 v[28:31], a[88:91], v[52:55], v[28:31]
    s_barrier
    v_mfma_f32_16x16x32_bf16 v[28:31], a[76:79], v[48:51], v[28:31]
    buffer_load_dwordx4 v1, s[8:11], s33 offen offset:1024 sc1 lds
    v_mfma_f32_16x16x32_bf16 v[24:27], a[72:75], v[48:51], v[24:27]
    ds_read_b128 v[48:51], v3 offset:10240
    v_mul_f32 v14, v14, v69
    v_mfma_f32_16x16x32_bf16 v[24:27], a[84:87], v[52:55], v[24:27]
    ds_read_b128 v[52:55], v3 offset:11264
    s_waitcnt lgkmcnt(2)
    v_mfma_f32_16x16x32_bf16 v[24:27], a[96:99], v[40:43], v[24:27]
    buffer_store_dword v6, v21, s[12:15], s17 offen sc1
    v_mul_f32 v15, v15, v69
    v_mfma_f32_16x16x32_bf16 v[24:27], a[108:111], v[44:47], v[24:27]
    ds_read_b64 v[122:123], v37 offset:2048
    v_cvt_pk_bf16_f32 v84, v12, v13
    v_mfma_f32_16x16x32_bf16 v[28:31], a[112:115], v[44:47], v[28:31]
    s_cmp_ge_i32 s54, 0
    s_cselect_b32 s14, s6, 0
    v_cvt_pk_bf16_f32 v85, v14, v15
    v_mfma_f32_16x16x32_bf16 v[28:31], a[100:103], v[40:43], v[28:31]
    s_add_u32 s17, s17, 8192
    v_sub_u32 v76, v3, v20
    v_fma_f32 v8, -v68, v56, v8
    v_mfma_f32_16x16x32_bf16 v[32:35], a[104:107], v[40:43], v[32:35]
    ds_read_b128 v[40:43], v3 offset:12288
    v_fma_f32 v9, -v68, v57, v9
    v_mfma_f32_16x16x32_bf16 v[32:35], a[116:119], v[44:47], v[32:35]
    ds_read_b128 v[44:47], v3 offset:13312
    s_waitcnt lgkmcnt(3)
    v_mfma_f32_16x16x32_bf16 v[32:35], a[128:131], v[48:51], v[32:35]
    buffer_load_dwordx4 v1, s[8:11], s33 offen offset:2048 sc1 lds
    v_mfma_f32_16x16x32_bf16 v[32:35], a[140:143], v[52:55], v[32:35]
    s_waitcnt lgkmcnt(2)
    v_add_f32 v122, v122, v120
    v_add_f32 v123, v123, v121
    v_mfma_f32_16x16x32_bf16 v[28:31], a[136:139], v[52:55], v[28:31]
    ds_read2st64_b64 v[80:83], v76 offset0:66 offset1:67
    v_max_f32 v22, v122, v123
    v_mfma_f32_16x16x32_bf16 v[28:31], a[124:127], v[48:51], v[28:31]
    ds_read2st64_b64 v[76:79], v76 offset0:64 offset1:65
    v_mov_b32 v23, v22
    v_mfma_f32_16x16x32_bf16 v[24:27], a[120:123], v[48:51], v[24:27]
    ds_read_b128 v[48:51], v3 offset:14336
    v_fma_f32 v10, -v68, v58, v10
    v_mfma_f32_16x16x32_bf16 v[24:27], a[132:135], v[52:55], v[24:27]
    ds_read_b128 v[52:55], v3 offset:15360
    s_waitcnt lgkmcnt(4)
    v_mfma_f32_16x16x32_bf16 v[24:27], a[144:147], v[40:43], v[24:27]
    buffer_load_dwordx4 v1, s[8:11], s33 offen offset:3072 sc1 lds
    v_mfma_f32_16x16x32_bf16 v[24:27], a[156:159], v[44:47], v[24:27]
    s_add_u32 m0, s34, 4096
    v_permlane16_swap_b32 v22, v23
    v_mfma_f32_16x16x32_bf16 v[28:31], a[160:163], v[44:47], v[28:31]
    s_add_u32 s37, s33, 4096
    v_max_f32 v22, v22, v23
    v_mov_b32 v23, v22
    v_mfma_f32_16x16x32_bf16 v[28:31], a[148:151], v[40:43], v[28:31]
    s_nop 0
    v_permlane32_swap_b32 v22, v23
    v_mfma_f32_16x16x32_bf16 v[32:35], a[152:155], v[40:43], v[32:35]
    ds_read_b128 v[40:43], v3 offset:16384
    v_max_f32 v22, v22, v23
    v_mfma_f32_16x16x32_bf16 v[32:35], a[164:167], v[44:47], v[32:35]
    ds_read_b128 v[44:47], v3 offset:17408
    s_waitcnt lgkmcnt(2)
    v_mfma_f32_16x16x32_bf16 v[32:35], a[176:179], v[48:51], v[32:35]
    buffer_load_dwordx4 v1, s[8:11], s37 offen offset:0 sc1 lds
    v_mfma_f32_16x16x32_bf16 v[32:35], a[188:191], v[52:55], v[32:35]
    v_mul_f32 v22, v124, v22
    v_fma_f32 v122, v122, v124, -v22
    v_mfma_f32_16x16x32_bf16 v[28:31], a[184:187], v[52:55], v[28:31]
    v_fma_f32 v123, v123, v124, -v22
    v_fma_f32 v11, -v68, v59, v11
    v_mfma_f32_16x16x32_bf16 v[28:31], a[172:175], v[48:51], v[28:31]
    v_exp_f32 v122, v122
    v_mfma_f32_16x16x32_bf16 v[24:27], a[168:171], v[48:51], v[24:27]
    ds_read_b128 v[48:51], v3 offset:18432
    v_cvt_pk_bf16_f32 v88, v8, v9
    v_mfma_f32_16x16x32_bf16 v[24:27], a[180:183], v[52:55], v[24:27]
    ds_read_b128 v[52:55], v3 offset:19456
    s_waitcnt lgkmcnt(2)
    v_mfma_f32_16x16x32_bf16 v[24:27], a[192:195], v[40:43], v[24:27]
    buffer_load_dwordx4 v1, s[8:11], s37 offen offset:1024 sc1 lds
    v_mfma_f32_16x16x32_bf16 v[24:27], a[204:207], v[44:47], v[24:27]
    v_exp_f32 v123, v123
    v_mfma_f32_16x16x32_bf16 v[28:31], a[208:211], v[44:47], v[28:31]
    v_add_f32 v22, v122, v123
    v_mov_b32 v23, v22
    v_mfma_f32_16x16x32_bf16 v[28:31], a[196:199], v[40:43], v[28:31]
    s_nop 0
    v_permlane16_swap_b32 v22, v23
    v_mfma_f32_16x16x32_bf16 v[32:35], a[200:203], v[40:43], v[32:35]
    ds_read_b128 v[40:43], v3 offset:20480
    v_add_f32 v22, v22, v23
    v_mfma_f32_16x16x32_bf16 v[32:35], a[212:215], v[44:47], v[32:35]
    ds_read_b128 v[44:47], v3 offset:21504
    s_waitcnt lgkmcnt(2)
    v_mfma_f32_16x16x32_bf16 v[32:35], a[224:227], v[48:51], v[32:35]
    buffer_load_dwordx4 v1, s[8:11], s37 offen offset:2048 sc1 lds
    v_mfma_f32_16x16x32_bf16 v[32:35], a[236:239], v[52:55], v[32:35]
    v_mov_b32 v23, v22
    v_cvt_pk_bf16_f32 v89, v10, v11
    v_mfma_f32_16x16x32_bf16 v[28:31], a[232:235], v[52:55], v[28:31]
    v_permlane32_swap_b32 v22, v23
    v_mfma_f32_16x16x32_bf16 v[110:113], v[84:87], v[88:91], 0
    v_mov_b32 v8, v84
    v_mov_b32 v9, v85
    v_mfma_f32_16x16x32_bf16 v[28:31], a[220:223], v[48:51], v[28:31]
    v_add_f32 v22, v22, v23
    v_add_f32 v76, v76, v80
    v_mfma_f32_16x16x32_bf16 v[24:27], a[216:219], v[48:51], v[24:27]
    ds_read_b128 v[48:51], v3 offset:22528
    v_add_f32 v77, v77, v81
    v_mfma_f32_16x16x32_bf16 v[24:27], a[228:231], v[52:55], v[24:27]
    ds_read_b128 v[52:55], v3 offset:23552
    s_waitcnt lgkmcnt(2)
    v_mfma_f32_16x16x32_bf16 v[24:27], a[240:243], v[40:43], v[24:27]
    buffer_load_dwordx4 v1, s[8:11], s37 offen offset:3072 sc1 lds
    v_mfma_f32_16x16x32_bf16 v[24:27], a[252:255], v[44:47], v[24:27]
    s_add_u32 m0, s34, 8192
    v_mov_b32 v10, v92
    v_mov_b32 v11, v93
    v_mfma_f32_16x16x32_bf16 v[28:31], v[128:131], v[44:47], v[28:31]
    s_add_u32 s37, s33, 8192
    v_rcp_f32 v22, v22
    v_mfma_f32_16x16x32_bf16 v[28:31], a[244:247], v[40:43], v[28:31]
    v_mul_f32 v122, v122, v22
    v_mul_f32 v123, v123, v22
    v_mfma_f32_16x16x32_bf16 v[32:35], a[248:251], v[40:43], v[32:35]
    ds_read_b128 v[40:43], v3 offset:24576
    v_cvt_pk_bf16_f32 v23, v122, v123
    v_mfma_f32_16x16x32_bf16 v[32:35], v[132:135], v[44:47], v[32:35]
    ds_read_b128 v[44:47], v3 offset:25600
    s_waitcnt lgkmcnt(2)
    v_mfma_f32_16x16x32_bf16 v[32:35], v[144:147], v[48:51], v[32:35]
    buffer_store_dwordx4 v[8:11], v1, s[4:7], s40 offen sc1
    v_perm_b32 v114, v23, v23, v102
    v_mfma_f32_16x16x32_bf16 v[32:35], v[156:159], v[52:55], v[32:35]
    s_add_u32 s40, s40, 262144
    v_perm_b32 v115, v23, v23, v103
    v_perm_b32 v116, v23, v23, v104
    v_mfma_f32_16x16x32_bf16 v[28:31], v[152:155], v[52:55], v[28:31]
    s_add_u32 s41, s41, 262144
    v_perm_b32 v117, v23, v23, v105
    v_mov_b32 v100, v94
    v_mfma_f32_16x16x32_bf16 v[28:31], v[140:143], v[48:51], v[28:31]
    v_mov_b32 v101, v95
    v_cndmask_b32 v118, v110, v111, s[44:45]
    v_mfma_f32_16x16x32_bf16 v[24:27], v[136:139], v[48:51], v[24:27]
    ds_read_b128 v[48:51], v3 offset:26624
    v_cndmask_b32 v119, v112, v113, s[44:45]
    v_mfma_f32_16x16x32_bf16 v[72:75], v[98:101], v[114:117], 0
    buffer_load_dwordx4 v1, s[8:11], s37 offen offset:0 sc1 lds
    v_mfma_f32_16x16x32_bf16 v[24:27], v[148:151], v[52:55], v[24:27]
    ds_read_b128 v[52:55], v3 offset:27648
    s_waitcnt lgkmcnt(2)
    v_mfma_f32_16x16x32_bf16 v[24:27], v[160:163], v[40:43], v[24:27]
    v_add_f32 v78, v78, v82
    v_add_f32 v79, v79, v83
    v_mfma_f32_16x16x32_bf16 v[24:27], v[172:175], v[44:47], v[24:27]
    v_cvt_pk_bf16_f32 v114, v72, v73
    v_cvt_pk_bf16_f32 v115, v74, v75
    v_mfma_f32_16x16x32_bf16 v[28:31], v[176:179], v[44:47], v[28:31]
    v_cvt_pk_bf16_f32 v116, v72, v73
    v_cvt_pk_bf16_f32 v117, v74, v75
    v_mfma_f32_16x16x32_bf16 v[28:31], v[164:167], v[40:43], v[28:31]
    s_add_u32 s31, s31, 1
    v_permlane32_swap_b32 v114, v116
    v_mfma_f32_16x16x32_bf16 v[32:35], v[168:171], v[40:43], v[32:35]
    ds_read_b128 v[40:43], v3 offset:28672
    v_add_f32 v70, v76, v78
    v_mfma_f32_16x16x32_bf16 v[32:35], v[180:183], v[44:47], v[32:35]
    ds_read_b128 v[44:47], v3 offset:29696
    s_waitcnt lgkmcnt(2)
    v_mfma_f32_16x16x32_bf16 v[32:35], v[192:195], v[48:51], v[32:35]
    s_sub_u32 s54, s31, 2
    v_permlane32_swap_b32 v115, v117
    v_mfma_f32_16x16x32_bf16 v[32:35], v[204:207], v[52:55], v[32:35]
    buffer_store_dwordx4 v[114:117], v7, s[12:15], s36 offen sc1
    v_mov_b32 v6, s54
    v_mfma_f32_16x16x32_bf16 v[28:31], v[200:203], v[52:55], v[28:31]
    s_add_u32 s36, s36, 32768
    v_add_f32 v71, v77, v79
    v_add_u32 v2, s35, v1
    v_mfma_f32_16x16x32_bf16 v[28:31], v[188:191], v[48:51], v[28:31]
    s_cmp_ge_i32 s31, 30
    s_cselect_b32 s18, 0x1ffff, s18
    s_add_u32 s33, s33, 34816
    v_mfma_f32_16x16x32_bf16 v[24:27], v[184:187], v[48:51], v[24:27]
    ds_read_b128 v[48:51], v3 offset:30720
    s_add_u32 s34, s34, 36864
    v_mfma_f32_16x16x32_bf16 v[24:27], v[196:199], v[52:55], v[24:27]
    ds_read_b128 v[52:55], v3 offset:31744
    s_waitcnt lgkmcnt(2)
    v_mfma_f32_16x16x32_bf16 v[24:27], v[208:211], v[40:43], v[24:27]
    s_cmp_ge_u32 s34, 147456
    s_cselect_b32 s38, 147456, 0
    s_sub_u32 s34, s34, s38
    v_mfma_f32_16x16x32_bf16 v[24:27], v[220:223], v[44:47], v[24:27]
    s_waitcnt vmcnt(12)
    v_cmp_gt_i32 vcc, s32, v5
    v_mfma_f32_16x16x32_bf16 v[28:31], v[224:227], v[44:47], v[28:31]
    v_permlane16_swap_b32 v70, v71
    v_mfma_f32_16x16x32_bf16 v[28:31], v[212:215], v[40:43], v[28:31]
    s_and_b64 vcc, vcc, s[18:19]
    s_cbranch_scc1 Lqkv_slows13
Lqkv_backs13:
    v_mfma_f32_16x16x32_bf16 v[32:35], v[216:219], v[40:43], v[32:35]
    ds_read_b128 v[40:43], v2 offset:0
    v_add_f32 v70, v70, v71
    v_mfma_f32_16x16x32_bf16 v[32:35], v[228:231], v[44:47], v[32:35]
    ds_read_b128 v[44:47], v2 offset:1024
    s_waitcnt lgkmcnt(2)
    v_mfma_f32_16x16x32_bf16 v[32:35], v[240:243], v[48:51], v[32:35]
    s_add_u32 s16, s16, 8192
    v_mov_b32 v71, v70
    s_and_b32 s16, s16, 524287
    v_mfma_f32_16x16x32_bf16 v[32:35], v[252:255], v[52:55], v[32:35]
    buffer_load_dword v5, v4, s[4:7], s16 offen sc1
    v_mfma_f32_16x16x32_bf16 v[28:31], v[248:251], v[52:55], v[28:31]
    v_permlane32_swap_b32 v70, v71
    v_mfma_f32_16x16x32_bf16 v[28:31], v[236:239], v[48:51], v[28:31]
    v_add_f32 v70, v70, v71
    v_mul_f32 v70, 0x3a800000, v70
    v_mfma_f32_16x16x32_bf16 v[24:27], v[232:235], v[48:51], v[24:27]
    ds_read_b128 v[48:51], v2 offset:2048
    v_mov_b32 v71, v70
    v_mfma_f32_16x16x32_bf16 v[24:27], v[244:247], v[52:55], v[24:27]
    ds_read_b128 v[52:55], v2 offset:3072
    v_permlane16_swap_b32 v70, v71
    v_fma_f32 v71, -v70, v70, v71
    v_max_f32 v71, 0, v71
    v_add_f32 v71, 0x3727c5ac, v71
    v_rsq_f32 v71, v71
    s_nop 1
    s_branch Lqkv_g03
    .p2align 6
Lqkv_g13:
    s_waitcnt lgkmcnt(2)
    v_mfma_f32_16x16x32_bf16 v[24:27], a[0:3], v[40:43], 0
    s_add_u32 m0, s34, 0
    v_mul_f32 v124, s52, v71
    v_fma_f32 v16, -v68, v64, v16
    v_mfma_f32_16x16x32_bf16 v[24:27], a[12:15], v[44:47], v[24:27]
    s_add_u32 s35, s35, 36864
    v_fma_f32 v12, -v68, v60, v12
    v_fma_f32 v13, -v68, v61, v13
    v_mfma_f32_16x16x32_bf16 v[28:31], a[16:19], v[44:47], 0
    s_cmp_eq_u32 s35, 147456
    s_cselect_b32 s35, 0, s35
    v_fma_f32 v14, -v68, v62, v14
    v_mfma_f32_16x16x32_bf16 v[28:31], a[4:7], v[40:43], v[28:31]
    v_fma_f32 v15, -v68, v63, v15
    v_mul_f32 v12, v12, v69
    v_mfma_f32_16x16x32_bf16 v[32:35], a[8:11], v[40:43], 0
    ds_read_b128 v[40:43], v3 offset:4096
    v_mul_f32 v13, v13, v69
    v_mfma_f32_16x16x32_bf16 v[32:35], a[20:23], v[44:47], v[32:35]
    ds_read_b128 v[44:47], v3 offset:5120
    s_waitcnt lgkmcnt(2)
    v_mfma_f32_16x16x32_bf16 v[32:35], a[32:35], v[48:51], v[32:35]
    v_mul_f32 v14, v14, v69
    v_mul_f32 v15, v15, v69
    v_mfma_f32_16x16x32_bf16 v[32:35], a[44:47], v[52:55], v[32:35]
    v_cvt_pk_bf16_f32 v84, v12, v13
    v_cvt_pk_bf16_f32 v85, v14, v15
    v_mfma_f32_16x16x32_bf16 v[28:31], a[40:43], v[52:55], v[28:31]
    v_fma_f32 v17, -v68, v65, v17
    v_fma_f32 v18, -v68, v66, v18
    v_mfma_f32_16x16x32_bf16 v[106:109], v[84:87], v[88:91], 0
    v_fma_f32 v19, -v68, v67, v19
    v_mul_f32 v16, v16, v69
    v_mfma_f32_16x16x32_bf16 v[28:31], a[28:31], v[48:51], v[28:31]
    v_mul_f32 v17, v17, v69
    v_mul_f32 v18, v18, v69
    v_mfma_f32_16x16x32_bf16 v[24:27], a[24:27], v[48:51], v[24:27]
    ds_read_b128 v[48:51], v3 offset:6144
    v_mul_f32 v19, v19, v69
    v_mfma_f32_16x16x32_bf16 v[24:27], a[36:39], v[52:55], v[24:27]
    ds_read_b128 v[52:55], v3 offset:7168
    s_waitcnt lgkmcnt(2)
    v_mfma_f32_16x16x32_bf16 v[24:27], a[48:51], v[40:43], v[24:27]
    v_cndmask_b32 v106, v106, v107, s[44:45]
    v_cndmask_b32 v108, v108, v109, s[44:45]
    v_mfma_f32_16x16x32_bf16 v[24:27], a[60:63], v[44:47], v[24:27]
    v_cndmask_b32 v120, v106, v118, s[48:49]
    v_cndmask_b32 v121, v108, v119, s[50:51]
    v_mfma_f32_16x16x32_bf16 v[28:31], a[64:67], v[44:47], v[28:31]
    ds_write_b64 v36, v[120:121] offset:2048
    v_mfma_f32_16x16x32_bf16 v[28:31], a[52:55], v[40:43], v[28:31]
    v_cvt_pk_bf16_f32 v16, v16, v17
    v_cvt_pk_bf16_f32 v17, v18, v19
    v_mfma_f32_16x16x32_bf16 v[32:35], a[56:59], v[40:43], v[32:35]
    ds_read_b128 v[40:43], v3 offset:8192
    v_fma_f32 v8, -v68, v56, v8
    v_mfma_f32_16x16x32_bf16 v[32:35], a[68:71], v[44:47], v[32:35]
    ds_read_b128 v[44:47], v3 offset:9216
    s_waitcnt lgkmcnt(3)
    v_mfma_f32_16x16x32_bf16 v[32:35], a[80:83], v[48:51], v[32:35]
    s_waitcnt vmcnt(3) lgkmcnt(2)
    ds_write_b64 v38, v[16:17]
    v_mfma_f32_16x16x32_bf16 v[32:35], a[92:95], v[52:55], v[32:35]
    ds_read_b64_tr_b16 v[92:93], v39
    v_fma_f32 v9, -v68, v57, v9
    v_mfma_f32_16x16x32_bf16 v[28:31], a[88:91], v[52:55], v[28:31]
    buffer_load_dwordx4 v1, s[8:11], s33 offen offset:0 sc1 lds
    v_mfma_f32_16x16x32_bf16 v[28:31], a[76:79], v[48:51], v[28:31]
    s_barrier
    v_mfma_f32_16x16x32_bf16 v[24:27], a[72:75], v[48:51], v[24:27]
    ds_read_b128 v[48:51], v3 offset:10240
    v_fma_f32 v10, -v68, v58, v10
    v_mfma_f32_16x16x32_bf16 v[24:27], a[84:87], v[52:55], v[24:27]
    ds_read_b128 v[52:55], v3 offset:11264
    s_waitcnt lgkmcnt(4)
    v_mfma_f32_16x16x32_bf16 v[24:27], a[96:99], v[40:43], v[24:27]
    s_waitcnt vmcnt(3)
    buffer_store_dword v6, v21, s[12:15], s17 offen sc1
    v_mfma_f32_16x16x32_bf16 v[24:27], a[108:111], v[44:47], v[24:27]
    ds_read_b64 v[122:123], v37 offset:2048
    v_fma_f32 v11, -v68, v59, v11
    v_mfma_f32_16x16x32_bf16 v[28:31], a[112:115], v[44:47], v[28:31]
    s_cmp_ge_i32 s54, 0
    s_cselect_b32 s14, s6, 0
    v_cvt_pk_bf16_f32 v88, v8, v9
    v_mfma_f32_16x16x32_bf16 v[28:31], a[100:103], v[40:43], v[28:31]
    s_add_u32 s17, s17, 8192
    v_sub_u32 v76, v3, v20
    v_cvt_pk_bf16_f32 v89, v10, v11
    v_mfma_f32_16x16x32_bf16 v[32:35], a[104:107], v[40:43], v[32:35]
    ds_read_b128 v[40:43], v3 offset:12288
    v_add_u32 v2, s35, v1
    v_mfma_f32_16x16x32_bf16 v[110:113], v[84:87], v[88:91], 0
    buffer_load_dwordx4 v1, s[8:11], s33 offen offset:1024 sc1 lds
    v_mfma_f32_16x16x32_bf16 v[32:35], a[116:119], v[44:47], v[32:35]
    ds_read_b128 v[44:47], v3 offset:13312
    s_waitcnt lgkmcnt(2)
    v_mfma_f32_16x16x32_bf16 v[32:35], a[128:131], v[48:51], v[32:35]
    ds_read2st64_b64 v[80:83], v76 offset0:66 offset1:67
    v_add_f32 v122, v122, v120
    v_mfma_f32_16x16x32_bf16 v[32:35], a[140:143], v[52:55], v[32:35]
    ds_read2st64_b64 v[76:79], v76 offset0:64 offset1:65
    v_add_f32 v123, v123, v121
    v_mfma_f32_16x16x32_bf16 v[28:31], a[136:139], v[52:55], v[28:31]
    v_max_f32 v22, v122, v123
    v_mov_b32 v23, v22
    v_mfma_f32_16x16x32_bf16 v[28:31], a[124:127], v[48:51], v[28:31]
    buffer_load_dwordx4 v1, s[8:11], s33 offen offset:2048 sc1 lds
    v_mfma_f32_16x16x32_bf16 v[24:27], a[120:123], v[48:51], v[24:27]
    ds_read_b128 v[48:51], v3 offset:14336
    v_cndmask_b32 v118, v110, v111, s[44:45]
    v_mfma_f32_16x16x32_bf16 v[24:27], a[132:135], v[52:55], v[24:27]
    ds_read_b128 v[52:55], v3 offset:15360
    s_waitcnt lgkmcnt(4)
    v_mfma_f32_16x16x32_bf16 v[24:27], a[144:147], v[40:43], v[24:27]
    v_permlane16_swap_b32 v22, v23
    v_mfma_f32_16x16x32_bf16 v[24:27], a[156:159], v[44:47], v[24:27]
    v_max_f32 v22, v22, v23
    v_mov_b32 v23, v22
    v_mfma_f32_16x16x32_bf16 v[28:31], a[160:163], v[44:47], v[28:31]
    buffer_load_dwordx4 v1, s[8:11], s33 offen offset:3072 sc1 lds
    v_mfma_f32_16x16x32_bf16 v[28:31], a[148:151], v[40:43], v[28:31]
    s_add_u32 m0, s34, 4096
    v_permlane32_swap_b32 v22, v23
    v_mfma_f32_16x16x32_bf16 v[32:35], a[152:155], v[40:43], v[32:35]
    ds_read_b128 v[40:43], v3 offset:16384
    v_max_f32 v22, v22, v23
    v_mfma_f32_16x16x32_bf16 v[32:35], a[164:167], v[44:47], v[32:35]
    ds_read_b128 v[44:47], v3 offset:17408
    s_waitcnt lgkmcnt(2)
    v_mfma_f32_16x16x32_bf16 v[32:35], a[176:179], v[48:51], v[32:35]
    s_add_u32 s37, s33, 4096
    v_mul_f32 v22, v124, v22
    v_fma_f32 v122, v122, v124, -v22
    v_mfma_f32_16x16x32_bf16 v[32:35], a[188:191], v[52:55], v[32:35]
    buffer_load_dwordx4 v1, s[8:11], s37 offen offset:0 sc1 lds
    v_mfma_f32_16x16x32_bf16 v[28:31], a[184:187], v[52:55], v[28:31]
    v_fma_f32 v123, v123, v124, -v22
    v_cndmask_b32 v119, v112, v113, s[44:45]
    v_mfma_f32_16x16x32_bf16 v[28:31], a[172:175], v[48:51], v[28:31]
    v_exp_f32 v122, v122
    v_mfma_f32_16x16x32_bf16 v[24:27], a[168:171], v[48:51], v[24:27]
    ds_read_b128 v[48:51], v3 offset:18432
    v_add_f32 v76, v76, v80
    v_mfma_f32_16x16x32_bf16 v[24:27], a[180:183], v[52:55], v[24:27]
    ds_read_b128 v[52:55], v3 offset:19456
    s_waitcnt lgkmcnt(2)
    v_mfma_f32_16x16x32_bf16 v[24:27], a[192:195], v[40:43], v[24:27]
    buffer_load_dwordx4 v1, s[8:11], s37 offen offset:1024 sc1 lds
    v_mfma_f32_16x16x32_bf16 v[24:27], a[204:207], v[44:47], v[24:27]
    v_exp_f32 v123, v123
    v_mfma_f32_16x16x32_bf16 v[28:31], a[208:211], v[44:47], v[28:31]
    v_add_f32 v22, v122, v123
    v_mov_b32 v23, v22
    v_mfma_f32_16x16x32_bf16 v[28:31], a[196:199], v[40:43], v[28:31]
    s_nop 0
    v_permlane16_swap_b32 v22, v23
    v_mfma_f32_16x16x32_bf16 v[32:35], a[200:203], v[40:43], v[32:35]
    ds_read_b128 v[40:43], v3 offset:20480
    v_add_f32 v22, v22, v23
    v_mfma_f32_16x16x32_bf16 v[32:35], a[212:215], v[44:47], v[32:35]
    ds_read_b128 v[44:47], v3 offset:21504
    s_waitcnt lgkmcnt(2)
    v_mfma_f32_16x16x32_bf16 v[32:35], a[224:227], v[48:51], v[32:35]
    buffer_load_dwordx4 v1, s[8:11], s37 offen offset:2048 sc1 lds
    v_mfma_f32_16x16x32_bf16 v[32:35], a[236:239], v[52:55], v[32:35]
    v_mov_b32 v23, v22
    v_add_f32 v77, v77, v81
    v_mfma_f32_16x16x32_bf16 v[28:31], a[232:235], v[52:55], v[28:31]
    v_permlane32_swap_b32 v22, v23
    v_mfma_f32_16x16x32_bf16 v[28:31], a[220:223], v[48:51], v[28:31]
    v_add_f32 v22, v22, v23
    v_add_f32 v78, v78, v82
    v_mfma_f32_16x16x32_bf16 v[24:27], a[216:219], v[48:51], v[24:27]
    ds_read_b128 v[48:51], v3 offset:22528
    v_add_f32 v79, v79, v83
    v_mfma_f32_16x16x32_bf16 v[24:27], a[228:231], v[52:55], v[24:27]
    ds_read_b128 v[52:55], v3 offset:23552
    s_waitcnt lgkmcnt(2)
    v_mfma_f32_16x16x32_bf16 v[24:27], a[240:243], v[40:43], v[24:27]
    buffer_load_dwordx4 v1, s[8:11], s37 offen offset:3072 sc1 lds
    v_mfma_f32_16x16x32_bf16 v[24:27], a[252:255], v[44:47], v[24:27]
    s_add_u32 m0, s34, 8192
    v_rcp_f32 v22, v22
    v_mfma_f32_16x16x32_bf16 v[28:31], v[128:131], v[44:47], v[28:31]
    s_add_u32 s37, s33, 8192
    v_mul_f32 v122, v122, v22
    v_mul_f32 v123, v123, v22
    v_mfma_f32_16x16x32_bf16 v[28:31], a[244:247], v[40:43], v[28:31]
    v_cvt_pk_bf16_f32 v23, v122, v123
    v_perm_b32 v114, v23, v23, v102
    v_mfma_f32_16x16x32_bf16 v[32:35], a[248:251], v[40:43], v[32:35]
    ds_read_b128 v[40:43], v3 offset:24576
    v_perm_b32 v115, v23, v23, v103
    v_mfma_f32_16x16x32_bf16 v[32:35], v[132:135], v[44:47], v[32:35]
    ds_read_b128 v[44:47], v3 offset:25600
    s_waitcnt lgkmcnt(2)
    v_mfma_f32_16x16x32_bf16 v[32:35], v[144:147], v[48:51], v[32:35]
    buffer_load_dwordx4 v1, s[8:11], s37 offen offset:0 sc1 lds
    v_mfma_f32_16x16x32_bf16 v[32:35], v[156:159], v[52:55], v[32:35]
    v_perm_b32 v116, v23, v23, v104
    v_perm_b32 v117, v23, v23, v105
    v_mfma_f32_16x16x32_bf16 v[28:31], v[152:155], v[52:55], v[28:31]
    v_add_f32 v70, v76, v78
    v_add_f32 v71, v77, v79
    v_mfma_f32_16x16x32_bf16 v[72:75], v[92:95], v[114:117], 0
    s_nop 0
    v_permlane16_swap_b32 v70, v71
    v_mfma_f32_16x16x32_bf16 v[28:31], v[140:143], v[48:51], v[28:31]
    v_add_f32 v70, v70, v71
    v_mov_b32 v71, v70
    v_mfma_f32_16x16x32_bf16 v[24:27], v[136:139], v[48:51], v[24:27]
    ds_read_b128 v[48:51], v3 offset:26624
    v_mfma_f32_16x16x32_bf16 v[24:27], v[148:151], v[52:55], v[24:27]
    ds_read_b128 v[52:55], v3 offset:27648
    s_waitcnt lgkmcnt(2)
    v_mfma_f32_16x16x32_bf16 v[24:27], v[160:163], v[40:43], v[24:27]
    v_cvt_pk_bf16_f32 v114, v72, v73
    v_cvt_pk_bf16_f32 v115, v74, v75
    v_mfma_f32_16x16x32_bf16 v[24:27], v[172:175], v[44:47], v[24:27]
    v_cvt_pk_bf16_f32 v116, v72, v73
    v_cvt_pk_bf16_f32 v117, v74, v75
    v_mfma_f32_16x16x32_bf16 v[28:31], v[176:179], v[44:47], v[28:31]
    v_permlane32_swap_b32 v114, v116
    v_mfma_f32_16x16x32_bf16 v[28:31], v[164:167], v[40:43], v[28:31]
    s_add_u32 s31, s31, 1
    v_permlane32_swap_b32 v115, v117
    v_mfma_f32_16x16x32_bf16 v[32:35], v[168:171], v[40:43], v[32:35]
    ds_read_b128 v[40:43], v3 offset:28672
    s_sub_u32 s54, s31, 2
    v_mfma_f32_16x16x32_bf16 v[32:35], v[180:183], v[44:47], v[32:35]
    ds_read_b128 v[44:47], v3 offset:29696
    s_waitcnt lgkmcnt(2)
    v_mfma_f32_16x16x32_bf16 v[32:35], v[192:195], v[48:51], v[32:35]
    buffer_store_dwordx4 v[114:117], v7, s[12:15], s36 offen sc1
    v_mov_b32 v6, s54
    v_mfma_f32_16x16x32_bf16 v[32:35], v[204:207], v[52:55], v[32:35]
    s_add_u32 s36, s36, 32768
    v_permlane32_swap_b32 v70, v71
    v_mfma_f32_16x16x32_bf16 v[28:31], v[200:203], v[52:55], v[28:31]
    s_cmp_ge_i32 s31, 30
    s_cselect_b32 s18, 0x1ffff, s18
    v_add_f32 v70, v70, v71
    v_mfma_f32_16x16x32_bf16 v[28:31], v[188:191], v[48:51], v[28:31]
    s_add_u32 s33, s33, 34816
    v_mul_f32 v70, 0x3a800000, v70
    v_mov_b32 v71, v70
    v_mfma_f32_16x16x32_bf16 v[24:27], v[184:187], v[48:51], v[24:27]
    ds_read_b128 v[48:51], v3 offset:30720
    s_add_u32 s34, s34, 36864
    v_mfma_f32_16x16x32_bf16 v[24:27], v[196:199], v[52:55], v[24:27]
    ds_read_b128 v[52:55], v3 offset:31744
    s_waitcnt lgkmcnt(2)
    v_mfma_f32_16x16x32_bf16 v[24:27], v[208:211], v[40:43], v[24:27]
    s_cmp_ge_u32 s34, 147456
    s_cselect_b32 s38, 147456, 0
    s_sub_u32 s34, s34, s38
    v_mfma_f32_16x16x32_bf16 v[24:27], v[220:223], v[44:47], v[24:27]
    s_waitcnt vmcnt(11)
    v_cmp_gt_i32 vcc, s32, v5
    v_mfma_f32_16x16x32_bf16 v[28:31], v[224:227], v[44:47], v[28:31]
    v_permlane16_swap_b32 v70, v71
    v_mfma_f32_16x16x32_bf16 v[28:31], v[212:215], v[40:43], v[28:31]
    s_and_b64 vcc, vcc, s[18:19]
    s_cbranch_scc1 Lqkv_slowg13
Lqkv_backg13:
    v_mfma_f32_16x16x32_bf16 v[32:35], v[216:219], v[40:43], v[32:35]
    ds_read_b128 v[40:43], v2 offset:0
    v_fma_f32 v71, -v70, v70, v71
    v_mfma_f32_16x16x32_bf16 v[32:35], v[228:231], v[44:47], v[32:35]
    ds_read_b128 v[44:47], v2 offset:1024
    s_waitcnt lgkmcnt(2)
    v_mfma_f32_16x16x32_bf16 v[32:35], v[240:243], v[48:51], v[32:35]
    s_add_u32 s16, s16, 8192
    v_max_f32 v71, 0, v71
    v_add_f32 v71, 0x3727c5ac, v71
    v_mfma_f32_16x16x32_bf16 v[32:35], v[252:255], v[52:55], v[32:35]
    s_and_b32 s16, s16, 524287
    v_rsq_f32 v71, v71
    v_mfma_f32_16x16x32_bf16 v[28:31], v[248:251], v[52:55], v[28:31]
    buffer_load_dword v5, v4, s[4:7], s16 offen sc1
    v_mfma_f32_16x16x32_bf16 v[28:31], v[236:239], v[48:51], v[28:31]
    v_mfma_f32_16x16x32_bf16 v[24:27], v[232:235], v[48:51], v[24:27]
    ds_read_b128 v[48:51], v2 offset:2048
    v_mfma_f32_16x16x32_bf16 v[24:27], v[244:247], v[52:55], v[24:27]
    ds_read_b128 v[52:55], v2 offset:3072
    s_cmp_eq_u32 s31, 64
    s_cbranch_scc1 Lqkv_tail
Lqkv_g03:
    s_waitcnt lgkmcnt(2)
    v_mfma_f32_16x16x32_bf16 v[8:11], a[0:3], v[40:43], 0
    s_add_u32 m0, s34, 0
    v_mul_f32 v124, s52, v69
    v_fma_f32 v32, -v70, v64, v32
    v_mfma_f32_16x16x32_bf16 v[8:11], a[12:15], v[44:47], v[8:11]
    s_add_u32 s35, s35, 36864
    v_fma_f32 v28, -v70, v60, v28
    v_fma_f32 v29, -v70, v61, v29
    v_mfma_f32_16x16x32_bf16 v[12:15], a[16:19], v[44:47], 0
    s_cmp_eq_u32 s35, 147456
    s_cselect_b32 s35, 0, s35
    v_fma_f32 v30, -v70, v62, v30
    v_mfma_f32_16x16x32_bf16 v[12:15], a[4:7], v[40:43], v[12:15]
    v_fma_f32 v31, -v70, v63, v31
    v_mul_f32 v28, v28, v71
    v_mfma_f32_16x16x32_bf16 v[16:19], a[8:11], v[40:43], 0
    ds_read_b128 v[40:43], v2 offset:4096
    v_mul_f32 v29, v29, v71
    v_mfma_f32_16x16x32_bf16 v[16:19], a[20:23], v[44:47], v[16:19]
    ds_read_b128 v[44:47], v2 offset:5120
    s_waitcnt lgkmcnt(2)
    v_mfma_f32_16x16x32_bf16 v[16:19], a[32:35], v[48:51], v[16:19]
    v_mul_f32 v30, v30, v71
    v_mul_f32 v31, v31, v71
    v_mfma_f32_16x16x32_bf16 v[16:19], a[44:47], v[52:55], v[16:19]
    v_cvt_pk_bf16_f32 v84, v28, v29
    v_cvt_pk_bf16_f32 v85, v30, v31
    v_mfma_f32_16x16x32_bf16 v[12:15], a[40:43], v[52:55], v[12:15]
    v_fma_f32 v33, -v70, v65, v33
    v_fma_f32 v34, -v70, v66, v34
    v_mfma_f32_16x16x32_bf16 v[106:109], v[84:87], v[88:91], 0
    v_fma_f32 v35, -v70, v67, v35
    v_mul_f32 v32, v32, v71
    v_mfma_f32_16x16x32_bf16 v[12:15], a[28:31], v[48:51], v[12:15]
    v_mul_f32 v33, v33, v71
    v_mul_f32 v34, v34, v71
    v_mfma_f32_16x16x32_bf16 v[8:11], a[24:27], v[48:51], v[8:11]
    ds_read_b128 v[48:51], v2 offset:6144
    v_mul_f32 v35, v35, v71
    v_mfma_f32_16x16x32_bf16 v[8:11], a[36:39], v[52:55], v[8:11]
    ds_read_b128 v[52:55], v2 offset:7168
    s_waitcnt lgkmcnt(2)
    v_mfma_f32_16x16x32_bf16 v[8:11], a[48:51], v[40:43], v[8:11]
    v_cndmask_b32 v106, v106, v107, s[44:45]
    v_cndmask_b32 v108, v108, v109, s[44:45]
    v_mfma_f32_16x16x32_bf16 v[8:11], a[60:63], v[44:47], v[8:11]
    v_cndmask_b32 v120, v106, v118, s[48:49]
    v_cndmask_b32 v121, v108, v119, s[50:51]
    v_mfma_f32_16x16x32_bf16 v[12:15], a[64:67], v[44:47], v[12:15]
    ds_write_b64 v36, v[120:121] offset:0
    v_mfma_f32_16x16x32_bf16 v[12:15], a[52:55], v[40:43], v[12:15]
    v_cvt_pk_bf16_f32 v32, v32, v33
    v_cvt_pk_bf16_f32 v33, v34, v35
    v_mfma_f32_16x16x32_bf16 v[16:19], a[56:59], v[40:43], v[16:19]
    ds_read_b128 v[40:43], v2 offset:8192
    v_fma_f32 v24, -v70, v56, v24
    v_mfma_f32_16x16x32_bf16 v[16:19], a[68:71], v[44:47], v[16:19]
    ds_read_b128 v[44:47], v2 offset:9216
    s_waitcnt lgkmcnt(3)
    v_mfma_f32_16x16x32_bf16 v[16:19], a[80:83], v[48:51], v[16:19]
    s_waitcnt vmcnt(2) lgkmcnt(2)
    ds_write_b64 v38, v[32:33]
    v_mfma_f32_16x16x32_bf16 v[16:19], a[92:95], v[52:55], v[16:19]
    ds_read_b64_tr_b16 v[94:95], v39
    v_fma_f32 v25, -v70, v57, v25
    v_mfma_f32_16x16x32_bf16 v[12:15], a[88:91], v[52:55], v[12:15]
    buffer_load_dwordx4 v1, s[8:11], s33 offen offset:0 sc1 lds
    v_mfma_f32_16x16x32_bf16 v[12:15], a[76:79], v[48:51], v[12:15]
    s_barrier
    v_mfma_f32_16x16x32_bf16 v[8:11], a[72:75], v[48:51], v[8:11]
    ds_read_b128 v[48:51], v2 offset:10240
    v_fma_f32 v26, -v70, v58, v26
    v_mfma_f32_16x16x32_bf16 v[8:11], a[84:87], v[52:55], v[8:11]
    ds_read_b128 v[52:55], v2 offset:11264
    s_waitcnt lgkmcnt(4)
    v_mfma_f32_16x16x32_bf16 v[8:11], a[96:99], v[40:43], v[8:11]
    s_waitcnt vmcnt(2)
    buffer_store_dword v6, v21, s[12:15], s17 offen sc1
    v_mfma_f32_16x16x32_bf16 v[8:11], a[108:111], v[44:47], v[8:11]
    ds_read_b64 v[122:123], v37 offset:0
    v_fma_f32 v27, -v70, v59, v27
    v_mfma_f32_16x16x32_bf16 v[12:15], a[112:115], v[44:47], v[12:15]
    s_cmp_ge_i32 s54, 0
    s_cselect_b32 s14, s6, 0
    v_cvt_pk_bf16_f32 v88, v24, v25
    v_mfma_f32_16x16x32_bf16 v[12:15], a[100:103], v[40:43], v[12:15]
    s_add_u32 s17, s17, 8192
    v_sub_u32 v76, v2, v20
    v_cvt_pk_bf16_f32 v89, v26, v27
    v_mfma_f32_16x16x32_bf16 v[16:19], a[104:107], v[40:43], v[16:19]
    ds_read_b128 v[40:43], v2 offset:12288
    v_add_u32 v3, s35, v1
    v_mfma_f32_16x16x32_bf16 v[110:113], v[84:87], v[88:91], 0
    buffer_load_dwordx4 v1, s[8:11], s33 offen offset:1024 sc1 lds
    v_mfma_f32_16x16x32_bf16 v[16:19], a[116:119], v[44:47], v[16:19]
    ds_read_b128 v[44:47], v2 offset:13312
    s_waitcnt lgkmcnt(2)
    v_mfma_f32_16x16x32_bf16 v[16:19], a[128:131], v[48:51], v[16:19]
    ds_read2st64_b64 v[80:83], v76 offset0:66 offset1:67
    v_add_f32 v122, v122, v120
    v_mfma_f32_16x16x32_bf16 v[16:19], a[140:143], v[52:55], v[16:19]
    ds_read2st64_b64 v[76:79], v76 offset0:64 offset1:65
    v_add_f32 v123, v123, v121
    v_mfma_f32_16x16x32_bf16 v[12:15], a[136:139], v[52:55], v[12:15]
    v_max_f32 v22, v122, v123
    v_mov_b32 v23, v22
    v_mfma_f32_16x16x32_bf16 v[12:15], a[124:127], v[48:51], v[12:15]
    buffer_load_dwordx4 v1, s[8:11], s33 offen offset:2048 sc1 lds
    v_mfma_f32_16x16x32_bf16 v[8:11], a[120:123], v[48:51], v[8:11]
    ds_read_b128 v[48:51], v2 offset:14336
    v_cndmask_b32 v118, v110, v111, s[44:45]
    v_mfma_f32_16x16x32_bf16 v[8:11], a[132:135], v[52:55], v[8:11]
    ds_read_b128 v[52:55], v2 offset:15360
    s_waitcnt lgkmcnt(4)
    v_mfma_f32_16x16x32_bf16 v[8:11], a[144:147], v[40:43], v[8:11]
    v_permlane16_swap_b32 v22, v23
    v_mfma_f32_16x16x32_bf16 v[8:11], a[156:159], v[44:47], v[8:11]
    v_max_f32 v22, v22, v23
    v_mov_b32 v23, v22
    v_mfma_f32_16x16x32_bf16 v[12:15], a[160:163], v[44:47], v[12:15]
    buffer_load_dwordx4 v1, s[8:11], s33 offen offset:3072 sc1 lds
    v_mfma_f32_16x16x32_bf16 v[12:15], a[148:151], v[40:43], v[12:15]
    s_add_u32 m0, s34, 4096
    v_permlane32_swap_b32 v22, v23
    v_mfma_f32_16x16x32_bf16 v[16:19], a[152:155], v[40:43], v[16:19]
    ds_read_b128 v[40:43], v2 offset:16384
    v_max_f32 v22, v22, v23
    v_mfma_f32_16x16x32_bf16 v[16:19], a[164:167], v[44:47], v[16:19]
    ds_read_b128 v[44:47], v2 offset:17408
    s_waitcnt lgkmcnt(2)
    v_mfma_f32_16x16x32_bf16 v[16:19], a[176:179], v[48:51], v[16:19]
    s_add_u32 s37, s33, 4096
    v_mul_f32 v22, v124, v22
    v_fma_f32 v122, v122, v124, -v22
    v_mfma_f32_16x16x32_bf16 v[16:19], a[188:191], v[52:55], v[16:19]
    buffer_load_dwordx4 v1, s[8:11], s37 offen offset:0 sc1 lds
    v_mfma_f32_16x16x32_bf16 v[12:15], a[184:187], v[52:55], v[12:15]
    v_fma_f32 v123, v123, v124, -v22
    v_cndmask_b32 v119, v112, v113, s[44:45]
    v_mfma_f32_16x16x32_bf16 v[12:15], a[172:175], v[48:51], v[12:15]
    v_exp_f32 v122, v122
    v_mfma_f32_16x16x32_bf16 v[8:11], a[168:171], v[48:51], v[8:11]
    ds_read_b128 v[48:51], v2 offset:18432
    v_add_f32 v76, v76, v80
    v_mfma_f32_16x16x32_bf16 v[8:11], a[180:183], v[52:55], v[8:11]
    ds_read_b128 v[52:55], v2 offset:19456
    s_waitcnt lgkmcnt(2)
    v_mfma_f32_16x16x32_bf16 v[8:11], a[192:195], v[40:43], v[8:11]
    buffer_load_dwordx4 v1, s[8:11], s37 offen offset:1024 sc1 lds
    v_mfma_f32_16x16x32_bf16 v[8:11], a[204:207], v[44:47], v[8:11]
    v_exp_f32 v123, v123
    v_mfma_f32_16x16x32_bf16 v[12:15], a[208:211], v[44:47], v[12:15]
    v_add_f32 v22, v122, v123
    v_mov_b32 v23, v22
    v_mfma_f32_16x16x32_bf16 v[12:15], a[196:199], v[40:43], v[12:15]
    s_nop 0
    v_permlane16_swap_b32 v22, v23
    v_mfma_f32_16x16x32_bf16 v[16:19], a[200:203], v[40:43], v[16:19]
    ds_read_b128 v[40:43], v2 offset:20480
    v_add_f32 v22, v22, v23
    v_mfma_f32_16x16x32_bf16 v[16:19], a[212:215], v[44:47], v[16:19]
    ds_read_b128 v[44:47], v2 offset:21504
    s_waitcnt lgkmcnt(2)
    v_mfma_f32_16x16x32_bf16 v[16:19], a[224:227], v[48:51], v[16:19]
    buffer_load_dwordx4 v1, s[8:11], s37 offen offset:2048 sc1 lds
    v_mfma_f32_16x16x32_bf16 v[16:19], a[236:239], v[52:55], v[16:19]
    v_mov_b32 v23, v22
    v_add_f32 v77, v77, v81
    v_mfma_f32_16x16x32_bf16 v[12:15], a[232:235], v[52:55], v[12:15]
    v_permlane32_swap_b32 v22, v23
    v_mfma_f32_16x16x32_bf16 v[12:15], a[220:223], v[48:51], v[12:15]
    v_add_f32 v22, v22, v23
    v_add_f32 v78, v78, v82
    v_mfma_f32_16x16x32_bf16 v[8:11], a[216:219], v[48:51], v[8:11]
    ds_read_b128 v[48:51], v2 offset:22528
    v_add_f32 v79, v79, v83
    v_mfma_f32_16x16x32_bf16 v[8:11], a[228:231], v[52:55], v[8:11]
    ds_read_b128 v[52:55], v2 offset:23552
    s_waitcnt lgkmcnt(2)
    v_mfma_f32_16x16x32_bf16 v[8:11], a[240:243], v[40:43], v[8:11]
    buffer_load_dwordx4 v1, s[8:11], s37 offen offset:3072 sc1 lds
    v_mfma_f32_16x16x32_bf16 v[8:11], a[252:255], v[44:47], v[8:11]
    s_add_u32 m0, s34, 8192
    v_rcp_f32 v22, v22
    v_mfma_f32_16x16x32_bf16 v[12:15], v[128:131], v[44:47], v[12:15]
    s_add_u32 s37, s33, 8192
    v_mul_f32 v122, v122, v22
    v_mul_f32 v123, v123, v22
    v_mfma_f32_16x16x32_bf16 v[12:15], a[244:247], v[40:43], v[12:15]
    v_cvt_pk_bf16_f32 v23, v122, v123
    v_perm_b32 v116, v23, v23, v102
    v_mfma_f32_16x16x32_bf16 v[16:19], a[248:251], v[40:43], v[16:19]
    ds_read_b128 v[40:43], v2 offset:24576
    v_perm_b32 v117, v23, v23, v103
    v_mfma_f32_16x16x32_bf16 v[16:19], v[132:135], v[44:47], v[16:19]
    ds_read_b128 v[44:47], v2 offset:25600
    s_waitcnt lgkmcnt(2)
    v_mfma_f32_16x16x32_bf16 v[16:19], v[144:147], v[48:51], v[16:19]
    buffer_load_dwordx4 v1, s[8:11], s37 offen offset:0 sc1 lds
    v_mfma_f32_16x16x32_bf16 v[16:19], v[156:159], v[52:55], v[16:19]
    v_perm_b32 v114, v23, v23, v104
    v_perm_b32 v115, v23, v23, v105
    v_mfma_f32_16x16x32_bf16 v[12:15], v[152:155], v[52:55], v[12:15]
    v_add_f32 v68, v76, v78
    v_add_f32 v69, v77, v79
    v_mfma_f32_16x16x32_bf16 v[72:75], v[92:95], v[114:117], 0
    s_nop 0
    v_permlane16_swap_b32 v68, v69
    v_mfma_f32_16x16x32_bf16 v[12:15], v[140:143], v[48:51], v[12:15]
    v_add_f32 v68, v68, v69
    v_mov_b32 v69, v68
    v_mfma_f32_16x16x32_bf16 v[8:11], v[136:139], v[48:51], v[8:11]
    ds_read_b128 v[48:51], v2 offset:26624
    v_mfma_f32_16x16x32_bf16 v[8:11], v[148:151], v[52:55], v[8:11]
    ds_read_b128 v[52:55], v2 offset:27648
    s_waitcnt lgkmcnt(2)
    v_mfma_f32_16x16x32_bf16 v[8:11], v[160:163], v[40:43], v[8:11]
    v_cvt_pk_bf16_f32 v114, v72, v73
    v_cvt_pk_bf16_f32 v115, v74, v75
    v_mfma_f32_16x16x32_bf16 v[8:11], v[172:175], v[44:47], v[8:11]
    v_cvt_pk_bf16_f32 v116, v72, v73
    v_cvt_pk_bf16_f32 v117, v74, v75
    v_mfma_f32_16x16x32_bf16 v[12:15], v[176:179], v[44:47], v[12:15]
    v_permlane32_swap_b32 v114, v116
    v_mfma_f32_16x16x32_bf16 v[12:15], v[164:167], v[40:43], v[12:15]
    s_add_u32 s31, s31, 1
    v_permlane32_swap_b32 v115, v117
    v_mfma_f32_16x16x32_bf16 v[16:19], v[168:171], v[40:43], v[16:19]
    ds_read_b128 v[40:43], v2 offset:28672
    s_sub_u32 s54, s31, 2
    v_mfma_f32_16x16x32_bf16 v[16:19], v[180:183], v[44:47], v[16:19]
    ds_read_b128 v[44:47], v2 offset:29696
    s_waitcnt lgkmcnt(2)
    v_mfma_f32_16x16x32_bf16 v[16:19], v[192:195], v[48:51], v[16:19]
    buffer_store_dwordx4 v[114:117], v7, s[12:15], s36 offen sc1
    v_mov_b32 v6, s54
    v_mfma_f32_16x16x32_bf16 v[16:19], v[204:207], v[52:55], v[16:19]
    s_add_u32 s36, s36, 32768
    v_permlane32_swap_b32 v68, v69
    v_mfma_f32_16x16x32_bf16 v[12:15], v[200:203], v[52:55], v[12:15]
    s_cmp_ge_i32 s31, 30
    s_cselect_b32 s18, 0x1ffff, s18
    v_add_f32 v68, v68, v69
    v_mfma_f32_16x16x32_bf16 v[12:15], v[188:191], v[48:51], v[12:15]
    s_add_u32 s33, s33, 34816
    v_mul_f32 v68, 0x3a800000, v68
    v_mov_b32 v69, v68
    v_mfma_f32_16x16x32_bf16 v[8:11], v[184:187], v[48:51], v[8:11]
    ds_read_b128 v[48:51], v2 offset:30720
    s_add_u32 s34, s34, 36864
    v_mfma_f32_16x16x32_bf16 v[8:11], v[196:199], v[52:55], v[8:11]
    ds_read_b128 v[52:55], v2 offset:31744
    s_waitcnt lgkmcnt(2)
    v_mfma_f32_16x16x32_bf16 v[8:11], v[208:211], v[40:43], v[8:11]
    s_cmp_ge_u32 s34, 147456
    s_cselect_b32 s38, 147456, 0
    s_sub_u32 s34, s34, s38
    v_mfma_f32_16x16x32_bf16 v[8:11], v[220:223], v[44:47], v[8:11]
    buffer_load_dwordx4 v[96:99], v1, s[24:27], s41 offen sc1
    v_mfma_f32_16x16x32_bf16 v[12:15], v[224:227], v[44:47], v[12:15]
    s_waitcnt vmcnt(12)
    v_cmp_gt_i32 vcc, s32, v5
    v_mfma_f32_16x16x32_bf16 v[12:15], v[212:215], v[40:43], v[12:15]
    v_permlane16_swap_b32 v68, v69
    v_mfma_f32_16x16x32_bf16 v[16:19], v[216:219], v[40:43], v[16:19]
    ds_read_b128 v[40:43], v3 offset:0
    v_fma_f32 v69, -v68, v68, v69
    v_mfma_f32_16x16x32_bf16 v[16:19], v[228:231], v[44:47], v[16:19]
    ds_read_b128 v[44:47], v3 offset:1024
    s_waitcnt lgkmcnt(2)
    v_mfma_f32_16x16x32_bf16 v[16:19], v[240:243], v[48:51], v[16:19]
    s_and_b64 vcc, vcc, s[18:19]
    s_cbranch_scc1 Lqkv_slowg03
Lqkv_backg03:
    v_mfma_f32_16x16x32_bf16 v[16:19], v[252:255], v[52:55], v[16:19]
    s_add_u32 s16, s16, 8192
    v_max_f32 v69, 0, v69
    v_add_f32 v69, 0x3727c5ac, v69
    v_mfma_f32_16x16x32_bf16 v[12:15], v[248:251], v[52:55], v[12:15]
    s_and_b32 s16, s16, 524287
    v_rsq_f32 v69, v69
    v_mfma_f32_16x16x32_bf16 v[12:15], v[236:239], v[48:51], v[12:15]
    buffer_load_dword v5, v4, s[4:7], s16 offen sc1
    v_mfma_f32_16x16x32_bf16 v[8:11], v[232:235], v[48:51], v[8:11]
    ds_read_b128 v[48:51], v3 offset:2048
    v_mfma_f32_16x16x32_bf16 v[8:11], v[244:247], v[52:55], v[8:11]
    ds_read_b128 v[52:55], v3 offset:3072
    s_and_b32 s37, s31, 30
    s_cbranch_scc1 Lqkv_g13
    s_branch Lqkv_s13
Lqkv_slows13:
Lqkv_spins13:
    buffer_load_dword v5, v4, s[4:7], s16 offen sc1
    s_waitcnt vmcnt(0)
    v_cmp_gt_i32 vcc, s32, v5
    s_sub_u32 s43, s43, 1
    s_cmp_lt_i32 s43, 0
    s_cbranch_scc1 Lqkv_backs13
    s_and_b64 vcc, vcc, s[18:19]
    s_cbranch_scc0 Lqkv_backs13
    s_sleep 8
    s_branch Lqkv_spins13
Lqkv_slowg13:
Lqkv_sping13:
    buffer_load_dword v5, v4, s[4:7], s16 offen sc1
    s_waitcnt vmcnt(0)
    v_cmp_gt_i32 vcc, s32, v5
    s_sub_u32 s43, s43, 1
    s_cmp_lt_i32 s43, 0
    s_cbranch_scc1 Lqkv_backg13
    s_and_b64 vcc, vcc, s[18:19]
    s_cbranch_scc0 Lqkv_backg13
    s_sleep 8
    s_branch Lqkv_sping13
Lqkv_slowg03:
Lqkv_sping03:
    buffer_load_dword v5, v4, s[4:7], s16 offen sc1
    s_waitcnt vmcnt(0)
    v_cmp_gt_i32 vcc, s32, v5
    s_sub_u32 s43, s43, 1
    s_cmp_lt_i32 s43, 0
    s_cbranch_scc1 Lqkv_backg03
    s_and_b64 vcc, vcc, s[18:19]
    s_cbranch_scc0 Lqkv_backg03
    s_sleep 8
    s_branch Lqkv_sping03
Lqkv_tail:
    v_mul_f32 v124, s52, v69
    v_mov_b32 v6, s54
    s_nop 3
    v_fma_f32 v28, -v70, v60, v28
    v_fma_f32 v29, -v70, v61, v29
    v_fma_f32 v30, -v70, v62, v30
    v_fma_f32 v31, -v70, v63, v31
    v_mul_f32 v28, v28, v71
    v_mul_f32 v29, v29, v71
    v_mul_f32 v30, v30, v71
    v_mul_f32 v31, v31, v71
    v_cvt_pk_bf16_f32 v84, v28, v29
    v_cvt_pk_bf16_f32 v85, v30, v31
    v_fma_f32 v32, -v70, v64, v32
    v_fma_f32 v33, -v70, v65, v33
    v_mfma_f32_16x16x32_bf16 v[106:109], v[84:87], v[88:91], 0
    v_fma_f32 v34, -v70, v66, v34
    v_fma_f32 v35, -v70, v67, v35
    v_mul_f32 v32, v32, v71
    v_mul_f32 v33, v33, v71
    v_mul_f32 v34, v34, v71
    v_mul_f32 v35, v35, v71
    v_cvt_pk_bf16_f32 v32, v32, v33
    v_cvt_pk_bf16_f32 v33, v34, v35
    v_cndmask_b32 v106, v106, v107, s[44:45]
    v_cndmask_b32 v108, v108, v109, s[44:45]
    v_cndmask_b32 v120, v106, v118, s[48:49]
    v_cndmask_b32 v121, v108, v119, s[50:51]
    ds_write_b64 v36, v[120:121] offset:0
    ds_write_b64 v38, v[32:33]
    ds_read_b64_tr_b16 v[94:95], v39
    v_fma_f32 v24, -v70, v56, v24
    v_fma_f32 v25, -v70, v57, v25
    v_fma_f32 v26, -v70, v58, v26
    v_fma_f32 v27, -v70, v59, v27
    v_cvt_pk_bf16_f32 v88, v24, v25
    v_cvt_pk_bf16_f32 v89, v26, v27
    s_nop 1
    v_mfma_f32_16x16x32_bf16 v[110:113], v[84:87], v[88:91], 0
    s_nop 7
    v_cndmask_b32 v118, v110, v111, s[44:45]
    v_cndmask_b32 v119, v112, v113, s[44:45]
    s_waitcnt lgkmcnt(2)
    s_barrier
    ds_read_b64 v[122:123], v37 offset:0
    s_waitcnt lgkmcnt(0)
    v_add_f32 v122, v122, v120
    v_add_f32 v123, v123, v121
    v_max_f32 v22, v122, v123
    v_mov_b32 v23, v22
    s_nop 1
    v_permlane16_swap_b32 v22, v23
    v_max_f32 v22, v22, v23
    v_mov_b32 v23, v22
    s_nop 1
    v_permlane32_swap_b32 v22, v23
    v_max_f32 v22, v22, v23
    v_mul_f32 v22, v124, v22
    v_fma_f32 v122, v122, v124, -v22
    v_fma_f32 v123, v123, v124, -v22
    v_exp_f32 v122, v122
    v_exp_f32 v123, v123
    s_nop 0
    v_add_f32 v22, v122, v123
    v_mov_b32 v23, v22
    s_nop 1
    v_permlane16_swap_b32 v22, v23
    v_add_f32 v22, v22, v23
    v_mov_b32 v23, v22
    s_nop 1
    v_permlane32_swap_b32 v22, v23
    v_add_f32 v22, v22, v23
    v_rcp_f32 v22, v22
    s_nop 0
    v_mul_f32 v122, v122, v22
    v_mul_f32 v123, v123, v22
    v_cvt_pk_bf16_f32 v23, v122, v123
    v_perm_b32 v116, v23, v23, v102
    v_perm_b32 v117, v23, v23, v103
    v_perm_b32 v114, v23, v23, v104
    v_perm_b32 v115, v23, v23, v105
    s_nop 1
    v_mfma_f32_16x16x32_bf16 v[72:75], v[92:95], v[114:117], 0
    s_nop 7
    v_cvt_pk_bf16_f32 v114, v72, v73
    v_cvt_pk_bf16_f32 v115, v74, v75
    v_cvt_pk_bf16_f32 v116, v72, v73
    v_cvt_pk_bf16_f32 v117, v74, v75
    s_nop 0
    v_permlane32_swap_b32 v114, v116
    v_permlane32_swap_b32 v115, v117
    s_waitcnt vmcnt(1)
    buffer_store_dword v6, v21, s[12:15], s17 offen sc1
    buffer_store_dwordx4 v[114:117], v7, s[12:15], s36 offen sc1
    s_add_u32 s36, s36, 32768
    v_mul_f32 v124, s52, v71
    v_mov_b32 v106, s42
    v_mov_b32 v107, s42
    v_mov_b32 v108, s42
    v_mov_b32 v109, s42
    s_nop 1
    v_mfma_f32_16x16x32_bf16 v[106:109], v[96:99], v[88:91], v[106:109]
    s_nop 7
    v_cndmask_b32 v106, v106, v107, s[44:45]
    v_cndmask_b32 v108, v108, v109, s[44:45]
    v_cndmask_b32 v120, v106, v118, s[48:49]
    v_cndmask_b32 v121, v108, v119, s[50:51]
    ds_write_b64 v36, v[120:121] offset:2048
    s_waitcnt lgkmcnt(0)
    s_barrier
    ds_read_b64 v[122:123], v37 offset:2048
    s_waitcnt lgkmcnt(0)
    v_add_f32 v122, v122, v120
    v_add_f32 v123, v123, v121
    v_max_f32 v22, v122, v123
    v_mov_b32 v23, v22
    s_nop 1
    v_permlane16_swap_b32 v22, v23
    v_max_f32 v22, v22, v23
    v_mov_b32 v23, v22
    s_nop 1
    v_permlane32_swap_b32 v22, v23
    v_max_f32 v22, v22, v23
    v_mul_f32 v22, v124, v22
    v_fma_f32 v122, v122, v124, -v22
    v_fma_f32 v123, v123, v124, -v22
    v_exp_f32 v122, v122
    v_exp_f32 v123, v123
    s_nop 0
    v_add_f32 v22, v122, v123
    v_mov_b32 v23, v22
    s_nop 1
    v_permlane16_swap_b32 v22, v23
    v_add_f32 v22, v22, v23
    v_mov_b32 v23, v22
    s_nop 1
    v_permlane32_swap_b32 v22, v23
    v_add_f32 v22, v22, v23
    v_rcp_f32 v22, v22
    s_nop 0
    v_mul_f32 v122, v122, v22
    v_mul_f32 v123, v123, v22
    v_cvt_pk_bf16_f32 v23, v122, v123
    v_perm_b32 v114, v23, v23, v102
    v_perm_b32 v115, v23, v23, v103
    v_perm_b32 v116, v23, v23, v104
    v_perm_b32 v117, v23, v23, v105
    v_mov_b32 v100, v94
    v_mov_b32 v101, v95
    s_nop 1
    v_mfma_f32_16x16x32_bf16 v[72:75], v[98:101], v[114:117], 0
    s_nop 7
    v_cvt_pk_bf16_f32 v114, v72, v73
    v_cvt_pk_bf16_f32 v115, v74, v75
    v_cvt_pk_bf16_f32 v116, v72, v73
    v_cvt_pk_bf16_f32 v117, v74, v75
    s_nop 0
    v_permlane32_swap_b32 v114, v116
    v_permlane32_swap_b32 v115, v117
    buffer_store_dwordx4 v[114:117], v7, s[12:15], s36 offen sc1
    s_add_u32 s36, s36, 32768
    v_mov_b32 v8, 63
    s_waitcnt vmcnt(1)
    s_add_u32 s17, s17, 8192
    buffer_store_dword v8, v21, s[12:15], s17 offen sc1
    v_mov_b32 v9, 64
    s_waitcnt vmcnt(1)
    s_add_u32 s17, s17, 8192
    buffer_store_dword v9, v21, s[12:15], s17 offen sc1
    s_branch L_exit
Lwo_start:
    s_mov_b32 s12, s68
    s_mov_b32 s13, s69
    s_mov_b32 s14, 0x200000
    s_mov_b32 s15, 0x00020000
    v_lshrrev_b32 v24, 3, v0
    v_mul_u32_u24 v24, 2048, v24
    v_bfe_u32 v25, v0, 4, 2
    v_lshlrev_b32 v25, 1, v25
    v_and_b32 v26, 7, v0
    v_xor_b32 v25, v25, v26
    v_lshl_add_u32 v40, v25, 4, v24
    v_add_u32 v41, 15360, v40
    s_mul_i32 s86, s29, 0x100
    s_add_u32 s86, s86, 0xfffff000
    s_mul_i32 s37, s30, 32768
    s_add_u32 s86, s86, s37
    s_lshl_b32 s87, s30, 11
    s_add_u32 m0, s87, 0
    s_add_u32 s37, s86, 0
    buffer_load_dwordx4 v40, s[12:15], s37 offen offset:0 lds
    buffer_load_dwordx4 v41, s[12:15], s37 offen offset:1024 lds
    s_add_u32 m0, s87, 8192
    s_add_u32 s37, s86, 128
    buffer_load_dwordx4 v40, s[12:15], s37 offen offset:0 lds
    buffer_load_dwordx4 v41, s[12:15], s37 offen offset:1024 lds
    s_add_u32 m0, s87, 16384
    s_add_u32 s37, s86, 131072
    buffer_load_dwordx4 v40, s[12:15], s37 offen offset:0 lds
    buffer_load_dwordx4 v41, s[12:15], s37 offen offset:1024 lds
    s_add_u32 m0, s87, 24576
    s_add_u32 s37, s86, 131200
    buffer_load_dwordx4 v40, s[12:15], s37 offen offset:0 lds
    buffer_load_dwordx4 v41, s[12:15], s37 offen offset:1024 lds
    s_add_u32 m0, s87, 32768
    s_add_u32 s37, s86, 262144
    buffer_load_dwordx4 v40, s[12:15], s37 offen offset:0 lds
    buffer_load_dwordx4 v41, s[12:15], s37 offen offset:1024 lds
    s_add_u32 m0, s87, 40960
    s_add_u32 s37, s86, 262272
    buffer_load_dwordx4 v40, s[12:15], s37 offen offset:0 lds
    buffer_load_dwordx4 v41, s[12:15], s37 offen offset:1024 lds
    s_add_u32 m0, s87, 49152
    s_add_u32 s37, s86, 393216
    buffer_load_dwordx4 v40, s[12:15], s37 offen offset:0 lds
    buffer_load_dwordx4 v41, s[12:15], s37 offen offset:1024 lds
    s_add_u32 m0, s87, 57344
    s_add_u32 s37, s86, 393344
    buffer_load_dwordx4 v40, s[12:15], s37 offen offset:0 lds
    buffer_load_dwordx4 v41, s[12:15], s37 offen offset:1024 lds
    s_add_u32 m0, s87, 65536
    s_add_u32 s37, s86, 524288
    buffer_load_dwordx4 v40, s[12:15], s37 offen offset:0 lds
    buffer_load_dwordx4 v41, s[12:15], s37 offen offset:1024 lds
    s_add_u32 m0, s87, 73728
    s_add_u32 s37, s86, 524416
    buffer_load_dwordx4 v40, s[12:15], s37 offen offset:0 lds
    buffer_load_dwordx4 v41, s[12:15], s37 offen offset:1024 lds
    s_add_u32 m0, s87, 81920
    s_add_u32 s37, s86, 655360
    buffer_load_dwordx4 v40, s[12:15], s37 offen offset:0 lds
    buffer_load_dwordx4 v41, s[12:15], s37 offen offset:1024 lds
    s_add_u32 m0, s87, 90112
    s_add_u32 s37, s86, 655488
    buffer_load_dwordx4 v40, s[12:15], s37 offen offset:0 lds
    buffer_load_dwordx4 v41, s[12:15], s37 offen offset:1024 lds
    s_add_u32 m0, s87, 98304
    s_add_u32 s37, s86, 786432
    buffer_load_dwordx4 v40, s[12:15], s37 offen offset:0 lds
    buffer_load_dwordx4 v41, s[12:15], s37 offen offset:1024 lds
    s_add_u32 m0, s87, 106496
    s_add_u32 s37, s86, 786560
    buffer_load_dwordx4 v40, s[12:15], s37 offen offset:0 lds
    buffer_load_dwordx4 v41, s[12:15], s37 offen offset:1024 lds
    s_add_u32 m0, s87, 114688
    s_add_u32 s37, s86, 917504
    buffer_load_dwordx4 v40, s[12:15], s37 offen offset:0 lds
    buffer_load_dwordx4 v41, s[12:15], s37 offen offset:1024 lds
    s_add_u32 m0, s87, 122880
    s_add_u32 s37, s86, 917632
    buffer_load_dwordx4 v40, s[12:15], s37 offen offset:0 lds
    buffer_load_dwordx4 v41, s[12:15], s37 offen offset:1024 lds
    s_add_u32 m0, s87, 131072
    s_add_u32 s37, s86, 1048576
    buffer_load_dwordx4 v40, s[12:15], s37 offen offset:0 lds
    buffer_load_dwordx4 v41, s[12:15], s37 offen offset:1024 lds
    s_add_u32 m0, s87, 139264
    s_add_u32 s37, s86, 1048704
    buffer_load_dwordx4 v40, s[12:15], s37 offen offset:0 lds
    buffer_load_dwordx4 v41, s[12:15], s37 offen offset:1024 lds
    v_bfe_u32 v24, v0, 3, 2
    v_and_b32 v25, 3, v0
    v_lshlrev_b32 v25, 3, v25
    v_lshrrev_b32 v26, 2, v0
    v_lshl_add_u32 v26, v26, 7, v25
    v_lshrrev_b32 v27, 5, v0
    v_lshl_add_u32 v27, v27, 10, v26
    s_lshr_b32 s37, s30, 1
    s_and_b32 s38, s30, 1
    s_lshl_b32 s38, s38, 1
    s_add_u32 s38, s38, 0
    s_lshl_b32 s37, s37, 13
    v_xor_b32 v28, s38, v24
    v_lshl_add_u32 v28, v28, 5, s37
    v_add_u32 v42, v28, v26
    v_add_u32 v46, v28, v27
    s_lshr_b32 s37, s30, 1
    s_and_b32 s38, s30, 1
    s_lshl_b32 s38, s38, 1
    s_add_u32 s38, s38, 1
    s_lshl_b32 s37, s37, 13
    v_xor_b32 v28, s38, v24
    v_lshl_add_u32 v28, v28, 5, s37
    v_add_u32 v43, v28, v26
    v_add_u32 v47, v28, v27
    v_mov_b32 v84, 0x3f803f80
    v_mov_b32 v85, 0x3f803f80
    v_mov_b32 v86, 0x3f803f80
    v_mov_b32 v87, 0x3f803f80
    s_mov_b32 s44, 0xaaaaaaaa
    s_mov_b32 s45, 0xaaaaaaaa
    s_mov_b32 s46, 0xcccccccc
    s_mov_b32 s47, 0xcccccccc
    s_mov_b32 s38, 0xf0000f
    s_mov_b32 s39, 0xf0000f00
    v_and_b32 v8, 15, v0
    v_lshlrev_b32 v8, 3, v8
    v_mov_b32 v7, 0x40000000
    v_cndmask_b32 v7, v7, v8, s[38:39]
    s_mul_i32 s37, s29, 0xfffff200
    s_mul_i32 s53, s30, 0xfffffc80
    s_add_u32 s37, s37, s53
    s_add_u32 s37, s37, 0x16000
    v_add_u32 v7, s37, v7
    v_mov_b32 v88, 0
    v_mov_b32 v89, 0
    v_mov_b32 v92, 0
    v_mov_b32 v93, 0
    v_mov_b32 v8, 0x3f80
    v_mov_b32 v9, 0x3f800000
    s_mov_b32 s38, 0x100001
    s_mov_b32 s39, 0x10000100
    v_cndmask_b32 v90, v88, v8, s[38:39]
    s_mov_b32 s38, 0x200002
    s_mov_b32 s39, 0x20000200
    v_cndmask_b32 v90, v90, v9, s[38:39]
    s_mov_b32 s38, 0x400004
    s_mov_b32 s39, 0x40000400
    v_cndmask_b32 v91, v88, v8, s[38:39]
    s_mov_b32 s38, 0x800008
    s_mov_b32 s39, 0x80000800
    v_cndmask_b32 v91, v91, v9, s[38:39]
    s_mul_i32 s37, s28, 0x80000
    s_add_u32 s37, s37, 0x6000000
    v_min_u32 v4, 63, v0
    v_lshl_add_u32 v4, v4, 5, s37
    s_mov_b32 s32, 1
    s_mul_i32 s33, s28, 0x200000
    s_add_u32 s33, s33, 0xa00000
    s_mul_i32 s40, s28, 0x220000
    s_mul_i32 s53, s29, 0x1000
    s_add_u32 s40, s40, s53
    s_mul_i32 s53, s30, 0x400
    s_add_u32 s40, s40, s53
    s_add_u32 s40, s40, 0xffff0000
    s_mul_i32 s36, s28, 0x240000
    s_mul_i32 s53, s29, 0x1000
    s_add_u32 s36, s36, s53
    s_mul_i32 s53, s30, 0x400
    s_add_u32 s36, s36, s53
    s_add_u32 s36, s36, 0x11e7000
    s_mov_b32 s31, -1
    s_mov_b32 s35, 0
    s_mov_b32 s16, 0
    v_mov_b32 v5, 0
    s_mul_i32 s17, s28, 0x80000
    s_mul_i32 s53, s29, 0x80
    s_add_u32 s17, s17, s53
    s_mul_i32 s53, s30, 0x20
    s_add_u32 s17, s17, s53
    s_add_u32 s17, s17, 0x5ffe000
    v_cmp_eq_u32 vcc, 0, v0
    v_mov_b32 v102, 0x40000000
    s_nop 0
    v_cndmask_b32 v102, v102, v0, vcc
    v_mov_b32 v2, v1
    s_mul_i32 s34, s30, 4096
    s_mul_i32 s3, s30, 0x0
    s_add_u32 s3, s3, 0x4000
    s_add_u32 s41, s3, 4096
    s_add_u32 s33, s33, s34
    s_mov_b64 s[18:19], -1
    v_mov_b32 v8, 0x40000000
    v_cndmask_b32 v4, v8, v4, s[18:19]
    v_add_u32 v12, 0, v46
    v_add_u32 v13, 0, v47
    s_waitcnt vmcnt(32) lgkmcnt(0)
    s_barrier
    s_add_u32 m0, s87, 147456
    s_add_u32 s37, s86, 1179648
    buffer_load_dwordx4 v40, s[12:15], s37 offen offset:0 lds
    ds_read_b64_tr_b16 a[0:1], v12 offset:0
    ds_read_b64_tr_b16 a[2:3], v12 offset:1024
    ds_read_b64_tr_b16 a[4:5], v13 offset:0
    buffer_load_dwordx4 v41, s[12:15], s37 offen offset:1024 lds
    ds_read_b64_tr_b16 a[6:7], v13 offset:1024
    ds_read_b64_tr_b16 a[8:9], v12 offset:4096
    ds_read_b64_tr_b16 a[10:11], v12 offset:5120
    s_add_u32 m0, s87, 155648
    s_add_u32 s37, s86, 1179776
    buffer_load_dwordx4 v40, s[12:15], s37 offen offset:0 lds
    ds_read_b64_tr_b16 a[12:13], v13 offset:4096
    ds_read_b64_tr_b16 a[14:15], v13 offset:5120
    v_add_u32 v16, 16384, v46
    buffer_load_dwordx4 v41, s[12:15], s37 offen offset:1024 lds
    v_add_u32 v17, 16384, v47
    s_waitcnt vmcnt(32) lgkmcnt(0)
    s_barrier
    s_add_u32 m0, s87, 0
    s_add_u32 s37, s86, 1310720
    buffer_load_dwordx4 v40, s[12:15], s37 offen offset:0 lds
    ds_read_b64_tr_b16 a[16:17], v16 offset:0
    ds_read_b64_tr_b16 a[18:19], v16 offset:1024
    ds_read_b64_tr_b16 a[20:21], v17 offset:0
    buffer_load_dwordx4 v41, s[12:15], s37 offen offset:1024 lds
    ds_read_b64_tr_b16 a[22:23], v17 offset:1024
    ds_read_b64_tr_b16 a[24:25], v16 offset:4096
    ds_read_b64_tr_b16 a[26:27], v16 offset:5120
    s_add_u32 m0, s87, 8192
    s_add_u32 s37, s86, 1310848
    buffer_load_dwordx4 v40, s[12:15], s37 offen offset:0 lds
    ds_read_b64_tr_b16 a[28:29], v17 offset:4096
    ds_read_b64_tr_b16 a[30:31], v17 offset:5120
    v_add_u32 v12, 32768, v46
    buffer_load_dwordx4 v41, s[12:15], s37 offen offset:1024 lds
    v_add_u32 v13, 32768, v47
    s_waitcnt vmcnt(32) lgkmcnt(0)
    s_barrier
    s_add_u32 m0, s87, 16384
    s_add_u32 s37, s86, 1441792
    buffer_load_dwordx4 v40, s[12:15], s37 offen offset:0 lds
    ds_read_b64_tr_b16 a[32:33], v12 offset:0
    ds_read_b64_tr_b16 a[34:35], v12 offset:1024
    ds_read_b64_tr_b16 a[36:37], v13 offset:0
    buffer_load_dwordx4 v41, s[12:15], s37 offen offset:1024 lds
    ds_read_b64_tr_b16 a[38:39], v13 offset:1024
    ds_read_b64_tr_b16 a[40:41], v12 offset:4096
    ds_read_b64_tr_b16 a[42:43], v12 offset:5120
    s_add_u32 m0, s87, 24576
    s_add_u32 s37, s86, 1441920
    buffer_load_dwordx4 v40, s[12:15], s37 offen offset:0 lds
    ds_read_b64_tr_b16 a[44:45], v13 offset:4096
    ds_read_b64_tr_b16 a[46:47], v13 offset:5120
    v_add_u32 v16, 49152, v46
    buffer_load_dwordx4 v41, s[12:15], s37 offen offset:1024 lds
    v_add_u32 v17, 49152, v47
    s_waitcnt vmcnt(32) lgkmcnt(0)
    s_barrier
    s_add_u32 m0, s87, 32768
    s_add_u32 s37, s86, 1572864
    buffer_load_dwordx4 v40, s[12:15], s37 offen offset:0 lds
    ds_read_b64_tr_b16 a[48:49], v16 offset:0
    ds_read_b64_tr_b16 a[50:51], v16 offset:1024
    ds_read_b64_tr_b16 a[52:53], v17 offset:0
    buffer_load_dwordx4 v41, s[12:15], s37 offen offset:1024 lds
    ds_read_b64_tr_b16 a[54:55], v17 offset:1024
    ds_read_b64_tr_b16 a[56:57], v16 offset:4096
    ds_read_b64_tr_b16 a[58:59], v16 offset:5120
    s_add_u32 m0, s87, 40960
    s_add_u32 s37, s86, 1572992
    buffer_load_dwordx4 v40, s[12:15], s37 offen offset:0 lds
    ds_read_b64_tr_b16 a[60:61], v17 offset:4096
    ds_read_b64_tr_b16 a[62:63], v17 offset:5120
    v_add_u32 v12, 65536, v46
    buffer_load_dwordx4 v41, s[12:15], s37 offen offset:1024 lds
    v_add_u32 v13, 65536, v47
    s_waitcnt vmcnt(32) lgkmcnt(0)
    s_barrier
    s_add_u32 m0, s87, 49152
    s_add_u32 s37, s86, 1703936
    buffer_load_dwordx4 v40, s[12:15], s37 offen offset:0 lds
    ds_read_b64_tr_b16 a[64:65], v12 offset:0
    ds_read_b64_tr_b16 a[66:67], v12 offset:1024
    ds_read_b64_tr_b16 a[68:69], v13 offset:0
    buffer_load_dwordx4 v41, s[12:15], s37 offen offset:1024 lds
    ds_read_b64_tr_b16 a[70:71], v13 offset:1024
    ds_read_b64_tr_b16 a[72:73], v12 offset:4096
    ds_read_b64_tr_b16 a[74:75], v12 offset:5120
    s_add_u32 m0, s87, 57344
    s_add_u32 s37, s86, 1704064
    buffer_load_dwordx4 v40, s[12:15], s37 offen offset:0 lds
    ds_read_b64_tr_b16 a[76:77], v13 offset:4096
    ds_read_b64_tr_b16 a[78:79], v13 offset:5120
    v_add_u32 v16, 81920, v46
    buffer_load_dwordx4 v41, s[12:15], s37 offen offset:1024 lds
    v_add_u32 v17, 81920, v47
    s_waitcnt vmcnt(32) lgkmcnt(0)
    s_barrier
    s_add_u32 m0, s87, 65536
    s_add_u32 s37, s86, 1835008
    buffer_load_dwordx4 v40, s[12:15], s37 offen offset:0 lds
    ds_read_b64_tr_b16 a[80:81], v16 offset:0
    ds_read_b64_tr_b16 a[82:83], v16 offset:1024
    ds_read_b64_tr_b16 a[84:85], v17 offset:0
    buffer_load_dwordx4 v41, s[12:15], s37 offen offset:1024 lds
    ds_read_b64_tr_b16 a[86:87], v17 offset:1024
    ds_read_b64_tr_b16 a[88:89], v16 offset:4096
    ds_read_b64_tr_b16 a[90:91], v16 offset:5120
    s_add_u32 m0, s87, 73728
    s_add_u32 s37, s86, 1835136
    buffer_load_dwordx4 v40, s[12:15], s37 offen offset:0 lds
    ds_read_b64_tr_b16 a[92:93], v17 offset:4096
    ds_read_b64_tr_b16 a[94:95], v17 offset:5120
    v_add_u32 v12, 98304, v46
    buffer_load_dwordx4 v41, s[12:15], s37 offen offset:1024 lds
    v_add_u32 v13, 98304, v47
    s_waitcnt vmcnt(32) lgkmcnt(0)
    s_barrier
    s_add_u32 m0, s87, 81920
    s_add_u32 s37, s86, 1966080
    buffer_load_dwordx4 v40, s[12:15], s37 offen offset:0 lds
    ds_read_b64_tr_b16 a[96:97], v12 offset:0
    ds_read_b64_tr_b16 a[98:99], v12 offset:1024
    ds_read_b64_tr_b16 a[100:101], v13 offset:0
    buffer_load_dwordx4 v41, s[12:15], s37 offen offset:1024 lds
    ds_read_b64_tr_b16 a[102:103], v13 offset:1024
    ds_read_b64_tr_b16 a[104:105], v12 offset:4096
    ds_read_b64_tr_b16 a[106:107], v12 offset:5120
    s_add_u32 m0, s87, 90112
    s_add_u32 s37, s86, 1966208
    buffer_load_dwordx4 v40, s[12:15], s37 offen offset:0 lds
    ds_read_b64_tr_b16 a[108:109], v13 offset:4096
    ds_read_b64_tr_b16 a[110:111], v13 offset:5120
    v_add_u32 v16, 114688, v46
    buffer_load_dwordx4 v41, s[12:15], s37 offen offset:1024 lds
    v_add_u32 v17, 114688, v47
    s_waitcnt vmcnt(32) lgkmcnt(0)
    s_barrier
    ds_read_b64_tr_b16 a[112:113], v16 offset:0
    ds_read_b64_tr_b16 a[114:115], v16 offset:1024
    ds_read_b64_tr_b16 a[116:117], v17 offset:0
    ds_read_b64_tr_b16 a[118:119], v17 offset:1024
    ds_read_b64_tr_b16 a[120:121], v16 offset:4096
    ds_read_b64_tr_b16 a[122:123], v16 offset:5120
    ds_read_b64_tr_b16 a[124:125], v17 offset:4096
    ds_read_b64_tr_b16 a[126:127], v17 offset:5120
    v_add_u32 v12, 131072, v46
    v_add_u32 v13, 131072, v47
    s_waitcnt vmcnt(28) lgkmcnt(0)
    s_barrier
    ds_read_b64_tr_b16 a[128:129], v12 offset:0
    ds_read_b64_tr_b16 a[130:131], v12 offset:1024
    ds_read_b64_tr_b16 a[132:133], v13 offset:0
    ds_read_b64_tr_b16 a[134:135], v13 offset:1024
    ds_read_b64_tr_b16 a[136:137], v12 offset:4096
    ds_read_b64_tr_b16 a[138:139], v12 offset:5120
    ds_read_b64_tr_b16 a[140:141], v13 offset:4096
    ds_read_b64_tr_b16 a[142:143], v13 offset:5120
    v_add_u32 v16, 147456, v46
    v_add_u32 v17, 147456, v47
    s_waitcnt vmcnt(24) lgkmcnt(0)
    s_barrier
    ds_read_b64_tr_b16 a[144:145], v16 offset:0
    ds_read_b64_tr_b16 a[146:147], v16 offset:1024
    ds_read_b64_tr_b16 a[148:149], v17 offset:0
    ds_read_b64_tr_b16 a[150:151], v17 offset:1024
    ds_read_b64_tr_b16 a[152:153], v16 offset:4096
    ds_read_b64_tr_b16 a[154:155], v16 offset:5120
    ds_read_b64_tr_b16 a[156:157], v17 offset:4096
    ds_read_b64_tr_b16 a[158:159], v17 offset:5120
    v_add_u32 v12, 0, v46
    v_add_u32 v13, 0, v47
    s_waitcnt vmcnt(20) lgkmcnt(0)
    s_barrier
    ds_read_b64_tr_b16 a[160:161], v12 offset:0
    ds_read_b64_tr_b16 a[162:163], v12 offset:1024
    ds_read_b64_tr_b16 a[164:165], v13 offset:0
    ds_read_b64_tr_b16 a[166:167], v13 offset:1024
    ds_read_b64_tr_b16 a[168:169], v12 offset:4096
    ds_read_b64_tr_b16 a[170:171], v12 offset:5120
    ds_read_b64_tr_b16 a[172:173], v13 offset:4096
    ds_read_b64_tr_b16 a[174:175], v13 offset:5120
    v_add_u32 v16, 16384, v46
    v_add_u32 v17, 16384, v47
    s_waitcnt vmcnt(16) lgkmcnt(0)
    s_barrier
    ds_read_b64_tr_b16 a[176:177], v16 offset:0
    ds_read_b64_tr_b16 a[178:179], v16 offset:1024
    ds_read_b64_tr_b16 a[180:181], v17 offset:0
    ds_read_b64_tr_b16 a[182:183], v17 offset:1024
    ds_read_b64_tr_b16 a[184:185], v16 offset:4096
    ds_read_b64_tr_b16 a[186:187], v16 offset:5120
    ds_read_b64_tr_b16 a[188:189], v17 offset:4096
    ds_read_b64_tr_b16 a[190:191], v17 offset:5120
    v_add_u32 v12, 32768, v46
    v_add_u32 v13, 32768, v47
    s_waitcnt vmcnt(12) lgkmcnt(0)
    s_barrier
    ds_read_b64_tr_b16 a[192:193], v12 offset:0
    ds_read_b64_tr_b16 a[194:195], v12 offset:1024
    ds_read_b64_tr_b16 a[196:197], v13 offset:0
    ds_read_b64_tr_b16 a[198:199], v13 offset:1024
    ds_read_b64_tr_b16 a[200:201], v12 offset:4096
    ds_read_b64_tr_b16 a[202:203], v12 offset:5120
    ds_read_b64_tr_b16 a[204:205], v13 offset:4096
    ds_read_b64_tr_b16 a[206:207], v13 offset:5120
    v_add_u32 v16, 49152, v46
    v_add_u32 v17, 49152, v47
    s_waitcnt vmcnt(8) lgkmcnt(0)
    s_barrier
    ds_read_b64_tr_b16 a[208:209], v16 offset:0
    ds_read_b64_tr_b16 a[210:211], v16 offset:1024
    ds_read_b64_tr_b16 a[212:213], v17 offset:0
    ds_read_b64_tr_b16 a[214:215], v17 offset:1024
    ds_read_b64_tr_b16 a[216:217], v16 offset:4096
    ds_read_b64_tr_b16 a[218:219], v16 offset:5120
    ds_read_b64_tr_b16 a[220:221], v17 offset:4096
    ds_read_b64_tr_b16 a[222:223], v17 offset:5120
    v_add_u32 v12, 65536, v46
    v_add_u32 v13, 65536, v47
    s_waitcnt vmcnt(4) lgkmcnt(0)
    s_barrier
    ds_read_b64_tr_b16 a[224:225], v12 offset:0
    ds_read_b64_tr_b16 a[226:227], v12 offset:1024
    ds_read_b64_tr_b16 a[228:229], v13 offset:0
    ds_read_b64_tr_b16 a[230:231], v13 offset:1024
    ds_read_b64_tr_b16 a[232:233], v12 offset:4096
    ds_read_b64_tr_b16 a[234:235], v12 offset:5120
    ds_read_b64_tr_b16 a[236:237], v13 offset:4096
    ds_read_b64_tr_b16 a[238:239], v13 offset:5120
    v_add_u32 v16, 81920, v46
    v_add_u32 v17, 81920, v47
    s_waitcnt vmcnt(0) lgkmcnt(0)
    s_barrier
    ds_read_b64_tr_b16 a[240:241], v16 offset:0
    ds_read_b64_tr_b16 a[242:243], v16 offset:1024
    ds_read_b64_tr_b16 a[244:245], v17 offset:0
    ds_read_b64_tr_b16 a[246:247], v17 offset:1024
    ds_read_b64_tr_b16 a[248:249], v16 offset:4096
    ds_read_b64_tr_b16 a[250:251], v16 offset:5120
    ds_read_b64_tr_b16 a[252:253], v17 offset:4096
    ds_read_b64_tr_b16 a[254:255], v17 offset:5120
    s_waitcnt lgkmcnt(0)
    s_mov_b32 s12, s84
    s_mov_b32 s13, s85
    s_mov_b32 s14, 0x6200000
    s_mov_b32 s15, 0x00020000
    s_barrier
    s_mov_b32 s20, s82
    s_mov_b32 s21, s83
    s_mov_b32 s22, 0x100
    s_mov_b32 s23, 0x00020000
    v_and_b32 v8, 15, v0
    v_lshlrev_b32 v8, 4, v8
    v_mov_b32 v10, 8
    buffer_load_dword v9, v8, s[20:23], 0 offen sc1
    s_waitcnt vmcnt(0)
Lwo_wa:
    v_cmp_gt_u32 vcc, v10, v9
    s_sub_u32 s43, s43, 1
    s_cmp_lt_i32 s43, 0
    s_cbranch_scc1 Lwo_all
    s_cbranch_vccz Lwo_all
    s_sleep 2
    buffer_load_dword v9, v8, s[20:23], 0 offen sc1
    s_waitcnt vmcnt(0)
    s_branch Lwo_wa
Lwo_all:
    s_mov_b32 s14, 0
    s_cmp_lg_u32 s30, 0
    s_cbranch_scc1 Lwo_fok
Lwo_fspin:
    buffer_load_dword v5, v4, s[4:7], s16 offen sc1
    s_waitcnt vmcnt(0)
    v_cmp_gt_i32 vcc, s32, v5
    s_sub_u32 s43, s43, 1
    s_cmp_lt_i32 s43, 0
    s_cbranch_scc1 Lwo_fok
    s_and_b64 vcc, vcc, s[18:19]
    s_cbranch_scc0 Lwo_fok
    s_sleep 8
    s_branch Lwo_fspin
Lwo_fok:
    s_barrier
    buffer_load_dwordx4 v[94:97], v1, s[4:7], s40 offen sc1
    s_add_u32 s40, s40, 34816
    s_branch Lwo_rdy1
    .p2align 6
Lwo_body00:
    s_waitcnt lgkmcnt(2)
    v_mfma_f32_16x16x32_bf16 v[8:11], a[0:3], v[40:43], 0
    ds_read_b128 v[56:59], v2 offset:4096
    s_add_u32 m0, s34, 0
    v_mfma_f32_16x16x32_bf16 v[8:11], a[8:11], v[44:47], v[8:11]
    s_waitcnt vmcnt(5)
    v_cmp_gt_i32 vcc, s32, v5
    v_cvt_pk_bf16_f32 v72, v24, v25
    v_mfma_f32_16x16x32_bf16 v[12:15], a[12:15], v[44:47], 0
    ds_read_b128 v[60:63], v2 offset:5120
    v_cvt_pk_bf16_f32 v73, v26, v27
    v_mfma_f32_16x16x32_bf16 v[12:15], a[4:7], v[40:43], v[12:15]
    s_waitcnt lgkmcnt(2)
    s_and_b64 vcc, vcc, s[18:19]
    s_cbranch_scc1 Lwo_v01
    v_mfma_f32_16x16x32_bf16 v[12:15], a[20:23], v[48:51], v[12:15]
    ds_read_b128 v[64:67], v2 offset:6144
    v_cvt_pk_bf16_f32 v74, v28, v29
    v_mfma_f32_16x16x32_bf16 v[12:15], a[28:31], v[52:55], v[12:15]
    buffer_load_dwordx4 v1, s[8:11], s33 offen offset:0 sc1 lds
    v_mfma_f32_16x16x32_bf16 v[8:11], a[24:27], v[52:55], v[8:11]
    ds_read_b128 v[68:71], v2 offset:7168
    v_cvt_pk_bf16_f32 v75, v30, v31
    v_mfma_f32_16x16x32_bf16 v[8:11], a[16:19], v[48:51], v[8:11]
    s_waitcnt lgkmcnt(2)
    s_add_u32 s31, s31, 1
    v_mov_b32 v6, s31
    v_mfma_f32_16x16x32_bf16 v[80:83], v[72:75], v[72:75], 0
    s_add_u32 s35, s35, 36864
    s_cmp_eq_u32 s35, 147456
    s_cselect_b32 s35, 0, s35
    v_mfma_f32_16x16x32_bf16 v[76:79], v[84:87], v[72:75], 0
    buffer_store_dwordx4 v[72:75], v1, s[12:15], s36 offen sc1
    v_add_u32 v3, s35, v1
    v_mfma_f32_16x16x32_bf16 v[8:11], a[32:35], v[56:59], v[8:11]
    ds_read_b128 v[40:43], v2 offset:8192
    v_cndmask_b32 v80, v80, v81, s[44:45]
    v_mfma_f32_16x16x32_bf16 v[8:11], a[40:43], v[60:63], v[8:11]
    v_cndmask_b32 v82, v82, v83, s[44:45]
    v_mfma_f32_16x16x32_bf16 v[12:15], a[44:47], v[60:63], v[12:15]
    ds_read_b128 v[44:47], v2 offset:9216
    v_cndmask_b32 v77, v80, v82, s[46:47]
    v_mfma_f32_16x16x32_bf16 v[12:15], a[36:39], v[56:59], v[12:15]
    s_waitcnt lgkmcnt(2)
    buffer_load_dwordx4 v1, s[8:11], s33 offen offset:1024 sc1 lds
    v_mfma_f32_16x16x32_bf16 v[12:15], a[52:55], v[64:67], v[12:15]
    ds_read_b128 v[48:51], v2 offset:10240
    v_mfma_f32_16x16x32_bf16 v[12:15], a[60:63], v[68:71], v[12:15]
    buffer_store_dwordx2 v[76:77], v7, s[12:15], s36 offen offset:0 sc1
    s_add_u32 s36, s36, 36864
    v_mfma_f32_16x16x32_bf16 v[8:11], a[56:59], v[68:71], v[8:11]
    ds_read_b128 v[52:55], v2 offset:11264
    v_mfma_f32_16x16x32_bf16 v[8:11], a[48:51], v[64:67], v[8:11]
    s_waitcnt lgkmcnt(2)
    buffer_load_dwordx4 v1, s[8:11], s33 offen offset:2048 sc1 lds
    v_mfma_f32_16x16x32_bf16 v[8:11], a[64:67], v[40:43], v[8:11]
    ds_read_b128 v[56:59], v2 offset:12288
    v_mfma_f32_16x16x32_bf16 v[8:11], a[72:75], v[44:47], v[8:11]
    v_mfma_f32_16x16x32_bf16 v[12:15], a[76:79], v[44:47], v[12:15]
    ds_read_b128 v[60:63], v2 offset:13312
    v_mfma_f32_16x16x32_bf16 v[12:15], a[68:71], v[40:43], v[12:15]
    s_waitcnt lgkmcnt(2)
    buffer_load_dwordx4 v1, s[8:11], s33 offen offset:3072 sc1 lds
    v_mfma_f32_16x16x32_bf16 v[12:15], a[84:87], v[48:51], v[12:15]
    ds_read_b128 v[64:67], v2 offset:14336
    s_waitcnt vmcnt(7)
    v_mfma_f32_16x16x32_bf16 v[12:15], a[92:95], v[52:55], v[12:15]
    s_barrier
    v_mfma_f32_16x16x32_bf16 v[8:11], a[88:91], v[52:55], v[8:11]
    ds_read_b128 v[68:71], v2 offset:15360
    s_add_u32 s16, s16, 8192
    v_mfma_f32_16x16x32_bf16 v[8:11], a[80:83], v[48:51], v[8:11]
    s_waitcnt lgkmcnt(2)
    s_add_u32 m0, s34, s3
    s_add_u32 s37, s33, s3
    v_mfma_f32_16x16x32_bf16 v[8:11], a[96:99], v[56:59], v[8:11]
    ds_read_b128 v[40:43], v2 offset:16384
    v_mfma_f32_16x16x32_bf16 v[8:11], a[104:107], v[60:63], v[8:11]
    buffer_load_dwordx4 v1, s[8:11], s37 offen offset:0 sc1 lds
    v_mfma_f32_16x16x32_bf16 v[12:15], a[108:111], v[60:63], v[12:15]
    ds_read_b128 v[44:47], v2 offset:17408
    v_mfma_f32_16x16x32_bf16 v[12:15], a[100:103], v[56:59], v[12:15]
    s_waitcnt lgkmcnt(2)
    v_mfma_f32_16x16x32_bf16 v[12:15], a[116:119], v[64:67], v[12:15]
    ds_read_b128 v[48:51], v2 offset:18432
    v_mfma_f32_16x16x32_bf16 v[12:15], a[124:127], v[68:71], v[12:15]
    buffer_load_dword v5, v4, s[4:7], s16 offen sc1
    v_mfma_f32_16x16x32_bf16 v[8:11], a[120:123], v[68:71], v[8:11]
    ds_read_b128 v[52:55], v2 offset:19456
    v_mfma_f32_16x16x32_bf16 v[8:11], a[112:115], v[64:67], v[8:11]
    s_waitcnt lgkmcnt(2)
    v_mfma_f32_16x16x32_bf16 v[8:11], a[128:131], v[40:43], v[8:11]
    ds_read_b128 v[56:59], v2 offset:20480
    v_mfma_f32_16x16x32_bf16 v[8:11], a[136:139], v[44:47], v[8:11]
    buffer_load_dwordx4 v1, s[8:11], s37 offen offset:1024 sc1 lds
    v_mfma_f32_16x16x32_bf16 v[12:15], a[140:143], v[44:47], v[12:15]
    ds_read_b128 v[60:63], v2 offset:21504
    v_mfma_f32_16x16x32_bf16 v[12:15], a[132:135], v[40:43], v[12:15]
    s_waitcnt lgkmcnt(2)
    v_mfma_f32_16x16x32_bf16 v[12:15], a[148:151], v[48:51], v[12:15]
    ds_read_b128 v[64:67], v2 offset:22528
    v_mfma_f32_16x16x32_bf16 v[12:15], a[156:159], v[52:55], v[12:15]
    buffer_load_dwordx4 v1, s[8:11], s37 offen offset:2048 sc1 lds
    v_mfma_f32_16x16x32_bf16 v[8:11], a[152:155], v[52:55], v[8:11]
    ds_read_b128 v[68:71], v2 offset:23552
    v_mfma_f32_16x16x32_bf16 v[8:11], a[144:147], v[48:51], v[8:11]
    s_waitcnt lgkmcnt(2)
    v_mfma_f32_16x16x32_bf16 v[8:11], a[160:163], v[56:59], v[8:11]
    ds_read_b128 v[40:43], v2 offset:24576
    v_mfma_f32_16x16x32_bf16 v[8:11], a[168:171], v[60:63], v[8:11]
    buffer_load_dwordx4 v1, s[8:11], s37 offen offset:3072 sc1 lds
    v_mfma_f32_16x16x32_bf16 v[12:15], a[172:175], v[60:63], v[12:15]
    ds_read_b128 v[44:47], v2 offset:25600
    s_add_u32 s32, s32, 1
    v_mfma_f32_16x16x32_bf16 v[12:15], a[164:167], v[56:59], v[12:15]
    s_waitcnt lgkmcnt(2)
    s_add_u32 s33, s33, 32768
    s_add_u32 s34, s34, 36864
    v_mfma_f32_16x16x32_bf16 v[12:15], a[180:183], v[64:67], v[12:15]
    ds_read_b128 v[48:51], v2 offset:26624
    v_mfma_f32_16x16x32_bf16 v[12:15], a[188:191], v[68:71], v[12:15]
    s_cmp_ge_u32 s34, 147456
    s_cselect_b32 s38, 147456, 0
    s_sub_u32 s34, s34, s38
    v_mfma_f32_16x16x32_bf16 v[8:11], a[184:187], v[68:71], v[8:11]
    ds_read_b128 v[52:55], v2 offset:27648
    v_mfma_f32_16x16x32_bf16 v[8:11], a[176:179], v[64:67], v[8:11]
    s_waitcnt lgkmcnt(2)
    buffer_load_dwordx4 v[98:101], v1, s[4:7], s40 offen sc1
    v_mfma_f32_16x16x32_bf16 v[8:11], a[192:195], v[40:43], v[8:11]
    ds_read_b128 v[56:59], v2 offset:28672
    s_add_u32 s40, s40, 34816
    v_mfma_f32_16x16x32_bf16 v[8:11], a[200:203], v[44:47], v[8:11]
    v_mfma_f32_16x16x32_bf16 v[12:15], a[204:207], v[44:47], v[12:15]
    ds_read_b128 v[60:63], v2 offset:29696
    v_mfma_f32_16x16x32_bf16 v[12:15], a[196:199], v[40:43], v[12:15]
    s_waitcnt lgkmcnt(2)
    v_mfma_f32_16x16x32_bf16 v[12:15], a[212:215], v[48:51], v[12:15]
    ds_read_b128 v[64:67], v2 offset:30720
    v_mfma_f32_16x16x32_bf16 v[12:15], a[220:223], v[52:55], v[12:15]
    s_waitcnt vmcnt(8)
    buffer_store_dword v6, v102, s[12:15], s17 offen sc1
    v_mfma_f32_16x16x32_bf16 v[8:11], a[216:219], v[52:55], v[8:11]
    ds_read_b128 v[68:71], v2 offset:31744
    s_mov_b32 s14, s6
    v_mfma_f32_16x16x32_bf16 v[8:11], a[208:211], v[48:51], v[8:11]
    s_waitcnt vmcnt(7) lgkmcnt(2)
    s_barrier
    v_mfma_f32_16x16x32_bf16 v[8:11], a[224:227], v[56:59], v[8:11]
    s_add_u32 s17, s17, 8192
    v_mfma_f32_16x16x32_bf16 v[8:11], a[232:235], v[60:63], v[8:11]
    v_mfma_f32_16x16x32_bf16 v[12:15], a[236:239], v[60:63], v[12:15]
    ds_read_b128 v[40:43], v3 offset:0
    v_mfma_f32_16x16x32_bf16 v[12:15], a[228:231], v[56:59], v[12:15]
    s_waitcnt lgkmcnt(1)
    v_mfma_f32_16x16x32_bf16 v[12:15], a[244:247], v[64:67], v[12:15]
    ds_read_b128 v[44:47], v3 offset:1024
    v_mfma_f32_16x16x32_bf16 v[12:15], a[252:255], v[68:71], v[12:15]
    v_mfma_f32_16x16x32_bf16 v[8:11], a[248:251], v[68:71], v[8:11]
    ds_read_b128 v[48:51], v3 offset:2048
    v_mfma_f32_16x16x32_bf16 v[8:11], a[240:243], v[64:67], v[8:11]
    v_mfma_f32_16x16x32_bf16 v[8:11], v[90:93], v[94:97], v[8:11]
    ds_read_b128 v[52:55], v3 offset:3072
    v_mfma_f32_16x16x32_bf16 v[12:15], v[88:91], v[94:97], v[12:15]
Lwo_body10:
    s_waitcnt lgkmcnt(2)
    v_mfma_f32_16x16x32_bf16 v[24:27], a[0:3], v[40:43], 0
    ds_read_b128 v[56:59], v3 offset:4096
    s_add_u32 m0, s34, 0
    v_mfma_f32_16x16x32_bf16 v[24:27], a[8:11], v[44:47], v[24:27]
    s_waitcnt vmcnt(5)
    v_cmp_gt_i32 vcc, s32, v5
    v_cvt_pk_bf16_f32 v72, v8, v9
    v_mfma_f32_16x16x32_bf16 v[28:31], a[12:15], v[44:47], 0
    ds_read_b128 v[60:63], v3 offset:5120
    v_cvt_pk_bf16_f32 v73, v10, v11
    v_mfma_f32_16x16x32_bf16 v[28:31], a[4:7], v[40:43], v[28:31]
    s_waitcnt lgkmcnt(2)
    s_and_b64 vcc, vcc, s[18:19]
    s_cbranch_scc1 Lwo_v11
    v_mfma_f32_16x16x32_bf16 v[28:31], a[20:23], v[48:51], v[28:31]
    ds_read_b128 v[64:67], v3 offset:6144
    v_cvt_pk_bf16_f32 v74, v12, v13
    v_mfma_f32_16x16x32_bf16 v[28:31], a[28:31], v[52:55], v[28:31]
    buffer_load_dwordx4 v1, s[8:11], s33 offen offset:0 sc1 lds
    v_mfma_f32_16x16x32_bf16 v[24:27], a[24:27], v[52:55], v[24:27]
    ds_read_b128 v[68:71], v3 offset:7168
    v_cvt_pk_bf16_f32 v75, v14, v15
    v_mfma_f32_16x16x32_bf16 v[24:27], a[16:19], v[48:51], v[24:27]
    s_waitcnt lgkmcnt(2)
    s_add_u32 s31, s31, 1
    v_mov_b32 v6, s31
    v_mfma_f32_16x16x32_bf16 v[80:83], v[72:75], v[72:75], 0
    s_add_u32 s35, s35, 36864
    s_cmp_eq_u32 s35, 147456
    s_cselect_b32 s35, 0, s35
    v_mfma_f32_16x16x32_bf16 v[76:79], v[84:87], v[72:75], 0
    buffer_store_dwordx4 v[72:75], v1, s[12:15], s36 offen sc1
    v_add_u32 v2, s35, v1
    v_mfma_f32_16x16x32_bf16 v[24:27], a[32:35], v[56:59], v[24:27]
    ds_read_b128 v[40:43], v3 offset:8192
    v_cndmask_b32 v80, v80, v81, s[44:45]
    v_mfma_f32_16x16x32_bf16 v[24:27], a[40:43], v[60:63], v[24:27]
    v_cndmask_b32 v82, v82, v83, s[44:45]
    v_mfma_f32_16x16x32_bf16 v[28:31], a[44:47], v[60:63], v[28:31]
    ds_read_b128 v[44:47], v3 offset:9216
    v_cndmask_b32 v77, v80, v82, s[46:47]
    v_mfma_f32_16x16x32_bf16 v[28:31], a[36:39], v[56:59], v[28:31]
    s_waitcnt lgkmcnt(2)
    buffer_load_dwordx4 v1, s[8:11], s33 offen offset:1024 sc1 lds
    v_mfma_f32_16x16x32_bf16 v[28:31], a[52:55], v[64:67], v[28:31]
    ds_read_b128 v[48:51], v3 offset:10240
    v_mfma_f32_16x16x32_bf16 v[28:31], a[60:63], v[68:71], v[28:31]
    buffer_store_dwordx2 v[76:77], v7, s[12:15], s36 offen offset:0 sc1
    s_add_u32 s36, s36, 36864
    v_mfma_f32_16x16x32_bf16 v[24:27], a[56:59], v[68:71], v[24:27]
    ds_read_b128 v[52:55], v3 offset:11264
    v_mfma_f32_16x16x32_bf16 v[24:27], a[48:51], v[64:67], v[24:27]
    s_waitcnt lgkmcnt(2)
    buffer_load_dwordx4 v1, s[8:11], s33 offen offset:2048 sc1 lds
    v_mfma_f32_16x16x32_bf16 v[24:27], a[64:67], v[40:43], v[24:27]
    ds_read_b128 v[56:59], v3 offset:12288
    v_mfma_f32_16x16x32_bf16 v[24:27], a[72:75], v[44:47], v[24:27]
    v_mfma_f32_16x16x32_bf16 v[28:31], a[76:79], v[44:47], v[28:31]
    ds_read_b128 v[60:63], v3 offset:13312
    v_mfma_f32_16x16x32_bf16 v[28:31], a[68:71], v[40:43], v[28:31]
    s_waitcnt lgkmcnt(2)
    buffer_load_dwordx4 v1, s[8:11], s33 offen offset:3072 sc1 lds
    v_mfma_f32_16x16x32_bf16 v[28:31], a[84:87], v[48:51], v[28:31]
    ds_read_b128 v[64:67], v3 offset:14336
    s_waitcnt vmcnt(7)
    v_mfma_f32_16x16x32_bf16 v[28:31], a[92:95], v[52:55], v[28:31]
    s_barrier
    v_mfma_f32_16x16x32_bf16 v[24:27], a[88:91], v[52:55], v[24:27]
    ds_read_b128 v[68:71], v3 offset:15360
    s_add_u32 s16, s16, 8192
    v_mfma_f32_16x16x32_bf16 v[24:27], a[80:83], v[48:51], v[24:27]
    s_waitcnt lgkmcnt(2)
    s_add_u32 m0, s34, s3
    s_add_u32 s37, s33, s3
    v_mfma_f32_16x16x32_bf16 v[24:27], a[96:99], v[56:59], v[24:27]
    ds_read_b128 v[40:43], v3 offset:16384
    v_mfma_f32_16x16x32_bf16 v[24:27], a[104:107], v[60:63], v[24:27]
    buffer_load_dwordx4 v1, s[8:11], s37 offen offset:0 sc1 lds
    v_mfma_f32_16x16x32_bf16 v[28:31], a[108:111], v[60:63], v[28:31]
    ds_read_b128 v[44:47], v3 offset:17408
    v_mfma_f32_16x16x32_bf16 v[28:31], a[100:103], v[56:59], v[28:31]
    s_waitcnt lgkmcnt(2)
    v_mfma_f32_16x16x32_bf16 v[28:31], a[116:119], v[64:67], v[28:31]
    ds_read_b128 v[48:51], v3 offset:18432
    v_mfma_f32_16x16x32_bf16 v[28:31], a[124:127], v[68:71], v[28:31]
    buffer_load_dword v5, v4, s[4:7], s16 offen sc1
    v_mfma_f32_16x16x32_bf16 v[24:27], a[120:123], v[68:71], v[24:27]
    ds_read_b128 v[52:55], v3 offset:19456
    v_mfma_f32_16x16x32_bf16 v[24:27], a[112:115], v[64:67], v[24:27]
    s_waitcnt lgkmcnt(2)
    v_mfma_f32_16x16x32_bf16 v[24:27], a[128:131], v[40:43], v[24:27]
    ds_read_b128 v[56:59], v3 offset:20480
    v_mfma_f32_16x16x32_bf16 v[24:27], a[136:139], v[44:47], v[24:27]
    buffer_load_dwordx4 v1, s[8:11], s37 offen offset:1024 sc1 lds
    v_mfma_f32_16x16x32_bf16 v[28:31], a[140:143], v[44:47], v[28:31]
    ds_read_b128 v[60:63], v3 offset:21504
    v_mfma_f32_16x16x32_bf16 v[28:31], a[132:135], v[40:43], v[28:31]
    s_waitcnt lgkmcnt(2)
    v_mfma_f32_16x16x32_bf16 v[28:31], a[148:151], v[48:51], v[28:31]
    ds_read_b128 v[64:67], v3 offset:22528
    v_mfma_f32_16x16x32_bf16 v[28:31], a[156:159], v[52:55], v[28:31]
    buffer_load_dwordx4 v1, s[8:11], s37 offen offset:2048 sc1 lds
    v_mfma_f32_16x16x32_bf16 v[24:27], a[152:155], v[52:55], v[24:27]
    ds_read_b128 v[68:71], v3 offset:23552
    v_mfma_f32_16x16x32_bf16 v[24:27], a[144:147], v[48:51], v[24:27]
    s_waitcnt lgkmcnt(2)
    v_mfma_f32_16x16x32_bf16 v[24:27], a[160:163], v[56:59], v[24:27]
    ds_read_b128 v[40:43], v3 offset:24576
    v_mfma_f32_16x16x32_bf16 v[24:27], a[168:171], v[60:63], v[24:27]
    buffer_load_dwordx4 v1, s[8:11], s37 offen offset:3072 sc1 lds
    v_mfma_f32_16x16x32_bf16 v[28:31], a[172:175], v[60:63], v[28:31]
    ds_read_b128 v[44:47], v3 offset:25600
    s_add_u32 s32, s32, 1
    v_mfma_f32_16x16x32_bf16 v[28:31], a[164:167], v[56:59], v[28:31]
    s_waitcnt lgkmcnt(2)
    s_add_u32 s33, s33, 32768
    s_add_u32 s34, s34, 36864
    v_mfma_f32_16x16x32_bf16 v[28:31], a[180:183], v[64:67], v[28:31]
    ds_read_b128 v[48:51], v3 offset:26624
    v_mfma_f32_16x16x32_bf16 v[28:31], a[188:191], v[68:71], v[28:31]
    s_cmp_ge_u32 s34, 147456
    s_cselect_b32 s38, 147456, 0
    s_sub_u32 s34, s34, s38
    v_mfma_f32_16x16x32_bf16 v[24:27], a[184:187], v[68:71], v[24:27]
    ds_read_b128 v[52:55], v3 offset:27648
    v_mfma_f32_16x16x32_bf16 v[24:27], a[176:179], v[64:67], v[24:27]
    s_waitcnt lgkmcnt(2)
    buffer_load_dwordx4 v[94:97], v1, s[4:7], s40 offen sc1
    v_mfma_f32_16x16x32_bf16 v[24:27], a[192:195], v[40:43], v[24:27]
    ds_read_b128 v[56:59], v3 offset:28672
    s_add_u32 s40, s40, 34816
    v_mfma_f32_16x16x32_bf16 v[24:27], a[200:203], v[44:47], v[24:27]
    v_mfma_f32_16x16x32_bf16 v[28:31], a[204:207], v[44:47], v[28:31]
    ds_read_b128 v[60:63], v3 offset:29696
    v_mfma_f32_16x16x32_bf16 v[28:31], a[196:199], v[40:43], v[28:31]
    s_waitcnt lgkmcnt(2)
    v_mfma_f32_16x16x32_bf16 v[28:31], a[212:215], v[48:51], v[28:31]
    ds_read_b128 v[64:67], v3 offset:30720
    v_mfma_f32_16x16x32_bf16 v[28:31], a[220:223], v[52:55], v[28:31]
    s_waitcnt vmcnt(8)
    buffer_store_dword v6, v102, s[12:15], s17 offen sc1
    v_mfma_f32_16x16x32_bf16 v[24:27], a[216:219], v[52:55], v[24:27]
    ds_read_b128 v[68:71], v3 offset:31744
    s_mov_b32 s14, s6
    v_mfma_f32_16x16x32_bf16 v[24:27], a[208:211], v[48:51], v[24:27]
    s_waitcnt vmcnt(7) lgkmcnt(2)
    s_barrier
    v_mfma_f32_16x16x32_bf16 v[24:27], a[224:227], v[56:59], v[24:27]
    s_add_u32 s17, s17, 8192
    v_mfma_f32_16x16x32_bf16 v[24:27], a[232:235], v[60:63], v[24:27]
    v_mfma_f32_16x16x32_bf16 v[28:31], a[236:239], v[60:63], v[28:31]
    ds_read_b128 v[40:43], v2 offset:0
    v_mfma_f32_16x16x32_bf16 v[28:31], a[228:231], v[56:59], v[28:31]
    s_waitcnt lgkmcnt(1)
    v_mfma_f32_16x16x32_bf16 v[28:31], a[244:247], v[64:67], v[28:31]
    ds_read_b128 v[44:47], v2 offset:1024
    v_mfma_f32_16x16x32_bf16 v[28:31], a[252:255], v[68:71], v[28:31]
    v_mfma_f32_16x16x32_bf16 v[24:27], a[248:251], v[68:71], v[24:27]
    ds_read_b128 v[48:51], v2 offset:2048
    v_mfma_f32_16x16x32_bf16 v[24:27], a[240:243], v[64:67], v[24:27]
    v_mfma_f32_16x16x32_bf16 v[24:27], v[90:93], v[98:101], v[24:27]
    ds_read_b128 v[52:55], v2 offset:3072
    v_mfma_f32_16x16x32_bf16 v[28:31], v[88:91], v[98:101], v[28:31]
    s_cmp_lt_i32 s31, 63
    s_cbranch_scc1 Lwo_body00
    s_branch L_exit
Lwo_v01:
    v_mfma_f32_16x16x32_bf16 v[12:15], a[20:23], v[48:51], v[12:15]
    ds_read_b128 v[64:67], v2 offset:6144
    v_cvt_pk_bf16_f32 v74, v28, v29
    v_mfma_f32_16x16x32_bf16 v[12:15], a[28:31], v[52:55], v[12:15]
    buffer_load_dword v5, v4, s[4:7], s16 offen sc1
    v_mfma_f32_16x16x32_bf16 v[8:11], a[24:27], v[52:55], v[8:11]
    ds_read_b128 v[68:71], v2 offset:7168
    v_cvt_pk_bf16_f32 v75, v30, v31
    v_mfma_f32_16x16x32_bf16 v[8:11], a[16:19], v[48:51], v[8:11]
    s_waitcnt lgkmcnt(2)
    s_add_u32 s31, s31, 1
    v_mov_b32 v6, s31
    v_mfma_f32_16x16x32_bf16 v[80:83], v[72:75], v[72:75], 0
    s_add_u32 s35, s35, 36864
    s_cmp_eq_u32 s35, 147456
    s_cselect_b32 s35, 0, s35
    v_mfma_f32_16x16x32_bf16 v[76:79], v[84:87], v[72:75], 0
    buffer_store_dwordx4 v[72:75], v1, s[12:15], s36 offen sc1
    v_add_u32 v3, s35, v1
    v_mfma_f32_16x16x32_bf16 v[8:11], a[32:35], v[56:59], v[8:11]
    ds_read_b128 v[40:43], v2 offset:8192
    v_cndmask_b32 v80, v80, v81, s[44:45]
    v_mfma_f32_16x16x32_bf16 v[8:11], a[40:43], v[60:63], v[8:11]
    v_cndmask_b32 v82, v82, v83, s[44:45]
    v_mfma_f32_16x16x32_bf16 v[12:15], a[44:47], v[60:63], v[12:15]
    ds_read_b128 v[44:47], v2 offset:9216
    v_cndmask_b32 v77, v80, v82, s[46:47]
    v_mfma_f32_16x16x32_bf16 v[12:15], a[36:39], v[56:59], v[12:15]
    s_waitcnt lgkmcnt(2)
    buffer_store_dwordx2 v[76:77], v7, s[12:15], s36 offen offset:0 sc1
    v_mfma_f32_16x16x32_bf16 v[12:15], a[52:55], v[64:67], v[12:15]
    ds_read_b128 v[48:51], v2 offset:10240
    s_add_u32 s36, s36, 36864
    v_mfma_f32_16x16x32_bf16 v[12:15], a[60:63], v[68:71], v[12:15]
    v_mfma_f32_16x16x32_bf16 v[8:11], a[56:59], v[68:71], v[8:11]
    ds_read_b128 v[52:55], v2 offset:11264
    v_mfma_f32_16x16x32_bf16 v[8:11], a[48:51], v[64:67], v[8:11]
    s_waitcnt lgkmcnt(2)
    v_mfma_f32_16x16x32_bf16 v[8:11], a[64:67], v[40:43], v[8:11]
    ds_read_b128 v[56:59], v2 offset:12288
    v_mfma_f32_16x16x32_bf16 v[8:11], a[72:75], v[44:47], v[8:11]
    v_mfma_f32_16x16x32_bf16 v[12:15], a[76:79], v[44:47], v[12:15]
    ds_read_b128 v[60:63], v2 offset:13312
    v_mfma_f32_16x16x32_bf16 v[12:15], a[68:71], v[40:43], v[12:15]
    s_waitcnt lgkmcnt(2)
    v_mfma_f32_16x16x32_bf16 v[12:15], a[84:87], v[48:51], v[12:15]
    ds_read_b128 v[64:67], v2 offset:14336
    s_waitcnt vmcnt(4)
    v_mfma_f32_16x16x32_bf16 v[12:15], a[92:95], v[52:55], v[12:15]
    s_barrier
    v_mfma_f32_16x16x32_bf16 v[8:11], a[88:91], v[52:55], v[8:11]
    ds_read_b128 v[68:71], v2 offset:15360
    v_mfma_f32_16x16x32_bf16 v[8:11], a[80:83], v[48:51], v[8:11]
    s_waitcnt lgkmcnt(2)
    v_mfma_f32_16x16x32_bf16 v[8:11], a[96:99], v[56:59], v[8:11]
    ds_read_b128 v[40:43], v2 offset:16384
    v_mfma_f32_16x16x32_bf16 v[8:11], a[104:107], v[60:63], v[8:11]
    v_mfma_f32_16x16x32_bf16 v[12:15], a[108:111], v[60:63], v[12:15]
    ds_read_b128 v[44:47], v2 offset:17408
    v_mfma_f32_16x16x32_bf16 v[12:15], a[100:103], v[56:59], v[12:15]
    s_waitcnt lgkmcnt(2)
    v_mfma_f32_16x16x32_bf16 v[12:15], a[116:119], v[64:67], v[12:15]
    ds_read_b128 v[48:51], v2 offset:18432
    v_mfma_f32_16x16x32_bf16 v[12:15], a[124:127], v[68:71], v[12:15]
    v_mfma_f32_16x16x32_bf16 v[8:11], a[120:123], v[68:71], v[8:11]
    ds_read_b128 v[52:55], v2 offset:19456
    v_mfma_f32_16x16x32_bf16 v[8:11], a[112:115], v[64:67], v[8:11]
    s_waitcnt lgkmcnt(2)
    v_mfma_f32_16x16x32_bf16 v[8:11], a[128:131], v[40:43], v[8:11]
    ds_read_b128 v[56:59], v2 offset:20480
    v_mfma_f32_16x16x32_bf16 v[8:11], a[136:139], v[44:47], v[8:11]
    s_waitcnt vmcnt(2)
    v_cmp_gt_i32 vcc, s32, v5
    v_mfma_f32_16x16x32_bf16 v[12:15], a[140:143], v[44:47], v[12:15]
    ds_read_b128 v[60:63], v2 offset:21504
    v_mfma_f32_16x16x32_bf16 v[12:15], a[132:135], v[40:43], v[12:15]
    s_waitcnt lgkmcnt(2)
    s_and_b64 vcc, vcc, s[18:19]
    s_cbranch_scc1 Lwo_v02
    v_mfma_f32_16x16x32_bf16 v[12:15], a[148:151], v[48:51], v[12:15]
    ds_read_b128 v[64:67], v2 offset:22528
    v_mfma_f32_16x16x32_bf16 v[12:15], a[156:159], v[52:55], v[12:15]
    buffer_load_dwordx4 v1, s[8:11], s33 offen offset:0 sc1 lds
    v_mfma_f32_16x16x32_bf16 v[8:11], a[152:155], v[52:55], v[8:11]
    ds_read_b128 v[68:71], v2 offset:23552
    v_mfma_f32_16x16x32_bf16 v[8:11], a[144:147], v[48:51], v[8:11]
    s_waitcnt lgkmcnt(2)
    v_mfma_f32_16x16x32_bf16 v[8:11], a[160:163], v[56:59], v[8:11]
    ds_read_b128 v[40:43], v2 offset:24576
    v_mfma_f32_16x16x32_bf16 v[8:11], a[168:171], v[60:63], v[8:11]
    buffer_load_dwordx4 v1, s[8:11], s33 offen offset:1024 sc1 lds
    v_mfma_f32_16x16x32_bf16 v[12:15], a[172:175], v[60:63], v[12:15]
    ds_read_b128 v[44:47], v2 offset:25600
    v_mfma_f32_16x16x32_bf16 v[12:15], a[164:167], v[56:59], v[12:15]
    s_waitcnt lgkmcnt(2)
    v_mfma_f32_16x16x32_bf16 v[12:15], a[180:183], v[64:67], v[12:15]
    ds_read_b128 v[48:51], v2 offset:26624
    v_mfma_f32_16x16x32_bf16 v[12:15], a[188:191], v[68:71], v[12:15]
    buffer_load_dwordx4 v1, s[8:11], s33 offen offset:2048 sc1 lds
    v_mfma_f32_16x16x32_bf16 v[8:11], a[184:187], v[68:71], v[8:11]
    ds_read_b128 v[52:55], v2 offset:27648
    v_mfma_f32_16x16x32_bf16 v[8:11], a[176:179], v[64:67], v[8:11]
    s_waitcnt lgkmcnt(2)
    v_mfma_f32_16x16x32_bf16 v[8:11], a[192:195], v[40:43], v[8:11]
    ds_read_b128 v[56:59], v2 offset:28672
    v_mfma_f32_16x16x32_bf16 v[8:11], a[200:203], v[44:47], v[8:11]
    buffer_load_dwordx4 v1, s[8:11], s33 offen offset:3072 sc1 lds
    v_mfma_f32_16x16x32_bf16 v[12:15], a[204:207], v[44:47], v[12:15]
    ds_read_b128 v[60:63], v2 offset:29696
    s_add_u32 s16, s16, 8192
    v_mfma_f32_16x16x32_bf16 v[12:15], a[196:199], v[40:43], v[12:15]
    s_waitcnt lgkmcnt(2)
    s_add_u32 m0, s34, s3
    s_add_u32 s37, s33, s3
    v_mfma_f32_16x16x32_bf16 v[12:15], a[212:215], v[48:51], v[12:15]
    ds_read_b128 v[64:67], v2 offset:30720
    s_waitcnt vmcnt(4)
    v_mfma_f32_16x16x32_bf16 v[12:15], a[220:223], v[52:55], v[12:15]
    buffer_load_dword v5, v4, s[4:7], s16 offen sc1
    v_mfma_f32_16x16x32_bf16 v[8:11], a[216:219], v[52:55], v[8:11]
    ds_read_b128 v[68:71], v2 offset:31744
    v_mfma_f32_16x16x32_bf16 v[8:11], a[208:211], v[48:51], v[8:11]
    s_waitcnt vmcnt(1) lgkmcnt(2)
    s_barrier
    v_mfma_f32_16x16x32_bf16 v[8:11], a[224:227], v[56:59], v[8:11]
    buffer_store_dword v6, v102, s[12:15], s17 offen sc1
    s_mov_b32 s14, s6
    v_mfma_f32_16x16x32_bf16 v[8:11], a[232:235], v[60:63], v[8:11]
    buffer_load_dwordx4 v1, s[8:11], s37 offen offset:0 sc1 lds
    v_mfma_f32_16x16x32_bf16 v[12:15], a[236:239], v[60:63], v[12:15]
    ds_read_b128 v[40:43], v3 offset:0
    s_add_u32 s17, s17, 8192
    v_mfma_f32_16x16x32_bf16 v[12:15], a[228:231], v[56:59], v[12:15]
    s_waitcnt lgkmcnt(1)
    v_mfma_f32_16x16x32_bf16 v[12:15], a[244:247], v[64:67], v[12:15]
    ds_read_b128 v[44:47], v3 offset:1024
    v_mfma_f32_16x16x32_bf16 v[12:15], a[252:255], v[68:71], v[12:15]
    buffer_load_dwordx4 v1, s[8:11], s37 offen offset:1024 sc1 lds
    v_mfma_f32_16x16x32_bf16 v[8:11], a[248:251], v[68:71], v[8:11]
    ds_read_b128 v[48:51], v3 offset:2048
    v_mfma_f32_16x16x32_bf16 v[8:11], a[240:243], v[64:67], v[8:11]
    v_mfma_f32_16x16x32_bf16 v[8:11], v[90:93], v[94:97], v[8:11]
    ds_read_b128 v[52:55], v3 offset:3072
    v_mfma_f32_16x16x32_bf16 v[12:15], v[88:91], v[94:97], v[12:15]
    buffer_load_dwordx4 v1, s[8:11], s37 offen offset:2048 sc1 lds
    buffer_load_dwordx4 v1, s[8:11], s37 offen offset:3072 sc1 lds
    s_add_u32 s32, s32, 1
    s_add_u32 s33, s33, 32768
    s_add_u32 s34, s34, 36864
    s_cmp_ge_u32 s34, 147456
    s_cselect_b32 s38, 147456, 0
    s_sub_u32 s34, s34, s38
    buffer_load_dwordx4 v[98:101], v1, s[4:7], s40 offen sc1
    s_add_u32 s40, s40, 34816
    s_cmp_ge_i32 s31, 63
    s_cbranch_scc1 L_exit
    s_branch Lwo_body10
Lwo_v02:
    v_mfma_f32_16x16x32_bf16 v[12:15], a[148:151], v[48:51], v[12:15]
    ds_read_b128 v[64:67], v2 offset:22528
    v_mfma_f32_16x16x32_bf16 v[12:15], a[156:159], v[52:55], v[12:15]
    v_mfma_f32_16x16x32_bf16 v[8:11], a[152:155], v[52:55], v[8:11]
    ds_read_b128 v[68:71], v2 offset:23552
    v_mfma_f32_16x16x32_bf16 v[8:11], a[144:147], v[48:51], v[8:11]
    s_waitcnt lgkmcnt(2)
    buffer_load_dwordx4 v[98:101], v1, s[4:7], s40 offen sc1
    v_mfma_f32_16x16x32_bf16 v[8:11], a[160:163], v[56:59], v[8:11]
    ds_read_b128 v[40:43], v2 offset:24576
    s_add_u32 s40, s40, 34816
    v_mfma_f32_16x16x32_bf16 v[8:11], a[168:171], v[60:63], v[8:11]
    v_mfma_f32_16x16x32_bf16 v[12:15], a[172:175], v[60:63], v[12:15]
    ds_read_b128 v[44:47], v2 offset:25600
    v_mfma_f32_16x16x32_bf16 v[12:15], a[164:167], v[56:59], v[12:15]
    s_waitcnt lgkmcnt(2)
    v_mfma_f32_16x16x32_bf16 v[12:15], a[180:183], v[64:67], v[12:15]
    ds_read_b128 v[48:51], v2 offset:26624
    v_mfma_f32_16x16x32_bf16 v[12:15], a[188:191], v[68:71], v[12:15]
    v_mfma_f32_16x16x32_bf16 v[8:11], a[184:187], v[68:71], v[8:11]
    ds_read_b128 v[52:55], v2 offset:27648
    v_mfma_f32_16x16x32_bf16 v[8:11], a[176:179], v[64:67], v[8:11]
    s_waitcnt lgkmcnt(2)
    v_mfma_f32_16x16x32_bf16 v[8:11], a[192:195], v[40:43], v[8:11]
    ds_read_b128 v[56:59], v2 offset:28672
    v_mfma_f32_16x16x32_bf16 v[8:11], a[200:203], v[44:47], v[8:11]
    v_mfma_f32_16x16x32_bf16 v[12:15], a[204:207], v[44:47], v[12:15]
    ds_read_b128 v[60:63], v2 offset:29696
    v_mfma_f32_16x16x32_bf16 v[12:15], a[196:199], v[40:43], v[12:15]
    s_waitcnt vmcnt(1) lgkmcnt(2)
    buffer_store_dword v6, v102, s[12:15], s17 offen sc1
    v_mfma_f32_16x16x32_bf16 v[12:15], a[212:215], v[48:51], v[12:15]
    ds_read_b128 v[64:67], v2 offset:30720
    s_mov_b32 s14, s6
    v_mfma_f32_16x16x32_bf16 v[12:15], a[220:223], v[52:55], v[12:15]
    buffer_load_dword v5, v4, s[4:7], s16 offen sc1
    v_mfma_f32_16x16x32_bf16 v[8:11], a[216:219], v[52:55], v[8:11]
    ds_read_b128 v[68:71], v2 offset:31744
    s_add_u32 s17, s17, 8192
    v_mfma_f32_16x16x32_bf16 v[8:11], a[208:211], v[48:51], v[8:11]
    s_waitcnt lgkmcnt(2)
    v_mfma_f32_16x16x32_bf16 v[8:11], a[224:227], v[56:59], v[8:11]
    v_mfma_f32_16x16x32_bf16 v[8:11], a[232:235], v[60:63], v[8:11]
    v_mfma_f32_16x16x32_bf16 v[12:15], a[236:239], v[60:63], v[12:15]
    v_mfma_f32_16x16x32_bf16 v[12:15], a[228:231], v[56:59], v[12:15]
    s_waitcnt lgkmcnt(0)
    v_mfma_f32_16x16x32_bf16 v[12:15], a[244:247], v[64:67], v[12:15]
    v_mfma_f32_16x16x32_bf16 v[12:15], a[252:255], v[68:71], v[12:15]
    v_mfma_f32_16x16x32_bf16 v[8:11], a[248:251], v[68:71], v[8:11]
    v_mfma_f32_16x16x32_bf16 v[8:11], a[240:243], v[64:67], v[8:11]
    v_mfma_f32_16x16x32_bf16 v[8:11], v[90:93], v[94:97], v[8:11]
    v_mfma_f32_16x16x32_bf16 v[12:15], v[88:91], v[94:97], v[12:15]
    s_nop 6
    v_cvt_pk_bf16_f32 v72, v8, v9
    v_cvt_pk_bf16_f32 v73, v10, v11
    v_cvt_pk_bf16_f32 v74, v12, v13
    v_cvt_pk_bf16_f32 v75, v14, v15
    s_nop 1
    v_mfma_f32_16x16x32_bf16 v[80:83], v[72:75], v[72:75], 0
    v_mfma_f32_16x16x32_bf16 v[76:79], v[84:87], v[72:75], 0
    buffer_store_dwordx4 v[72:75], v1, s[12:15], s36 offen sc1
    s_nop 5
    v_cndmask_b32 v80, v80, v81, s[44:45]
    v_cndmask_b32 v82, v82, v83, s[44:45]
    v_cndmask_b32 v77, v80, v82, s[46:47]
    buffer_store_dwordx2 v[76:77], v7, s[12:15], s36 offen offset:0 sc1
    s_add_u32 s54, s31, 1
    v_mov_b32 v6, s54
    s_waitcnt vmcnt(2)
    s_cmp_ge_i32 s31, 63
    s_cbranch_scc1 Lwo_late0
    v_cmp_gt_i32 vcc, s32, v5
    s_sub_u32 s43, s43, 1
    s_cmp_lt_i32 s43, 0
    s_cbranch_scc1 Lwo_rdy0
    s_and_b64 vcc, vcc, s[18:19]
    s_cbranch_scc0 Lwo_rdy0
Lwo_late0:
    buffer_load_dword v5, v4, s[4:7], s16 offen sc1
    s_waitcnt vmcnt(1)
    buffer_store_dword v6, v102, s[12:15], s17 offen sc1
    s_mov_b32 s14, 0
    s_cmp_ge_i32 s31, 63
    s_cbranch_scc1 L_exit
    s_waitcnt vmcnt(1)
    v_cmp_gt_i32 vcc, s32, v5
    s_sub_u32 s43, s43, 1
    s_cmp_lt_i32 s43, 0
    s_cbranch_scc1 Lwo_rdy0
    s_and_b64 vcc, vcc, s[18:19]
    s_cbranch_scc0 Lwo_rdy0
Lwo_spin0:
    buffer_load_dword v5, v4, s[4:7], s16 offen sc1
    s_waitcnt vmcnt(0)
    v_cmp_gt_i32 vcc, s32, v5
    s_sub_u32 s43, s43, 1
    s_cmp_lt_i32 s43, 0
    s_cbranch_scc1 Lwo_rdy0
    s_and_b64 vcc, vcc, s[18:19]
    s_cbranch_scc0 Lwo_rdy0
    s_sleep 8
    s_branch Lwo_spin0
Lwo_rdy0:
    s_add_u32 m0, s34, 0
    s_nop 0
    buffer_load_dwordx4 v1, s[8:11], s33 offen offset:0 sc1 lds
    buffer_load_dwordx4 v1, s[8:11], s33 offen offset:1024 sc1 lds
    buffer_load_dwordx4 v1, s[8:11], s33 offen offset:2048 sc1 lds
    buffer_load_dwordx4 v1, s[8:11], s33 offen offset:3072 sc1 lds
    s_add_u32 s16, s16, 8192
    buffer_load_dword v5, v4, s[4:7], s16 offen sc1
    s_add_u32 m0, s34, s3
    s_add_u32 s37, s33, s3
    buffer_load_dwordx4 v1, s[8:11], s37 offen offset:0 sc1 lds
    buffer_load_dwordx4 v1, s[8:11], s37 offen offset:1024 sc1 lds
    buffer_load_dwordx4 v1, s[8:11], s37 offen offset:2048 sc1 lds
    buffer_load_dwordx4 v1, s[8:11], s37 offen offset:3072 sc1 lds
    s_add_u32 s32, s32, 1
    s_add_u32 s33, s33, 32768
    s_add_u32 s34, s34, 36864
    s_cmp_ge_u32 s34, 147456
    s_cselect_b32 s38, 147456, 0
    s_sub_u32 s34, s34, s38
    s_waitcnt vmcnt(5)
    buffer_store_dword v6, v102, s[12:15], s17 offen sc1
Lwo_go0:
    s_mov_b32 s14, 0
    s_barrier
    ds_read_b128 v[40:43], v3 offset:0
    ds_read_b128 v[44:47], v3 offset:1024
    ds_read_b128 v[48:51], v3 offset:2048
    ds_read_b128 v[52:55], v3 offset:3072
    s_branch Lwo_body10
Lwo_v11:
    v_mfma_f32_16x16x32_bf16 v[28:31], a[20:23], v[48:51], v[28:31]
    ds_read_b128 v[64:67], v3 offset:6144
    v_cvt_pk_bf16_f32 v74, v12, v13
    v_mfma_f32_16x16x32_bf16 v[28:31], a[28:31], v[52:55], v[28:31]
    buffer_load_dword v5, v4, s[4:7], s16 offen sc1
    v_mfma_f32_16x16x32_bf16 v[24:27], a[24:27], v[52:55], v[24:27]
    ds_read_b128 v[68:71], v3 offset:7168
    v_cvt_pk_bf16_f32 v75, v14, v15
    v_mfma_f32_16x16x32_bf16 v[24:27], a[16:19], v[48:51], v[24:27]
    s_waitcnt lgkmcnt(2)
    s_add_u32 s31, s31, 1
    v_mov_b32 v6, s31
    v_mfma_f32_16x16x32_bf16 v[80:83], v[72:75], v[72:75], 0
    s_add_u32 s35, s35, 36864
    s_cmp_eq_u32 s35, 147456
    s_cselect_b32 s35, 0, s35
    v_mfma_f32_16x16x32_bf16 v[76:79], v[84:87], v[72:75], 0
    buffer_store_dwordx4 v[72:75], v1, s[12:15], s36 offen sc1
    v_add_u32 v2, s35, v1
    v_mfma_f32_16x16x32_bf16 v[24:27], a[32:35], v[56:59], v[24:27]
    ds_read_b128 v[40:43], v3 offset:8192
    v_cndmask_b32 v80, v80, v81, s[44:45]
    v_mfma_f32_16x16x32_bf16 v[24:27], a[40:43], v[60:63], v[24:27]
    v_cndmask_b32 v82, v82, v83, s[44:45]
    v_mfma_f32_16x16x32_bf16 v[28:31], a[44:47], v[60:63], v[28:31]
    ds_read_b128 v[44:47], v3 offset:9216
    v_cndmask_b32 v77, v80, v82, s[46:47]
    v_mfma_f32_16x16x32_bf16 v[28:31], a[36:39], v[56:59], v[28:31]
    s_waitcnt lgkmcnt(2)
    buffer_store_dwordx2 v[76:77], v7, s[12:15], s36 offen offset:0 sc1
    v_mfma_f32_16x16x32_bf16 v[28:31], a[52:55], v[64:67], v[28:31]
    ds_read_b128 v[48:51], v3 offset:10240
    s_add_u32 s36, s36, 36864
    v_mfma_f32_16x16x32_bf16 v[28:31], a[60:63], v[68:71], v[28:31]
    v_mfma_f32_16x16x32_bf16 v[24:27], a[56:59], v[68:71], v[24:27]
    ds_read_b128 v[52:55], v3 offset:11264
    v_mfma_f32_16x16x32_bf16 v[24:27], a[48:51], v[64:67], v[24:27]
    s_waitcnt lgkmcnt(2)
    v_mfma_f32_16x16x32_bf16 v[24:27], a[64:67], v[40:43], v[24:27]
    ds_read_b128 v[56:59], v3 offset:12288
    v_mfma_f32_16x16x32_bf16 v[24:27], a[72:75], v[44:47], v[24:27]
    v_mfma_f32_16x16x32_bf16 v[28:31], a[76:79], v[44:47], v[28:31]
    ds_read_b128 v[60:63], v3 offset:13312
    v_mfma_f32_16x16x32_bf16 v[28:31], a[68:71], v[40:43], v[28:31]
    s_waitcnt lgkmcnt(2)
    v_mfma_f32_16x16x32_bf16 v[28:31], a[84:87], v[48:51], v[28:31]
    ds_read_b128 v[64:67], v3 offset:14336
    s_waitcnt vmcnt(4)
    v_mfma_f32_16x16x32_bf16 v[28:31], a[92:95], v[52:55], v[28:31]
    s_barrier
    v_mfma_f32_16x16x32_bf16 v[24:27], a[88:91], v[52:55], v[24:27]
    ds_read_b128 v[68:71], v3 offset:15360
    v_mfma_f32_16x16x32_bf16 v[24:27], a[80:83], v[48:51], v[24:27]
    s_waitcnt lgkmcnt(2)
    v_mfma_f32_16x16x32_bf16 v[24:27], a[96:99], v[56:59], v[24:27]
    ds_read_b128 v[40:43], v3 offset:16384
    v_mfma_f32_16x16x32_bf16 v[24:27], a[104:107], v[60:63], v[24:27]
    v_mfma_f32_16x16x32_bf16 v[28:31], a[108:111], v[60:63], v[28:31]
    ds_read_b128 v[44:47], v3 offset:17408
    v_mfma_f32_16x16x32_bf16 v[28:31], a[100:103], v[56:59], v[28:31]
    s_waitcnt lgkmcnt(2)
    v_mfma_f32_16x16x32_bf16 v[28:31], a[116:119], v[64:67], v[28:31]
    ds_read_b128 v[48:51], v3 offset:18432
    v_mfma_f32_16x16x32_bf16 v[28:31], a[124:127], v[68:71], v[28:31]
    v_mfma_f32_16x16x32_bf16 v[24:27], a[120:123], v[68:71], v[24:27]
    ds_read_b128 v[52:55], v3 offset:19456
    v_mfma_f32_16x16x32_bf16 v[24:27], a[112:115], v[64:67], v[24:27]
    s_waitcnt lgkmcnt(2)
    v_mfma_f32_16x16x32_bf16 v[24:27], a[128:131], v[40:43], v[24:27]
    ds_read_b128 v[56:59], v3 offset:20480
    v_mfma_f32_16x16x32_bf16 v[24:27], a[136:139], v[44:47], v[24:27]
    s_waitcnt vmcnt(2)
    v_cmp_gt_i32 vcc, s32, v5
    v_mfma_f32_16x16x32_bf16 v[28:31], a[140:143], v[44:47], v[28:31]
    ds_read_b128 v[60:63], v3 offset:21504
    v_mfma_f32_16x16x32_bf16 v[28:31], a[132:135], v[40:43], v[28:31]
    s_waitcnt lgkmcnt(2)
    s_and_b64 vcc, vcc, s[18:19]
    s_cbranch_scc1 Lwo_v12
    v_mfma_f32_16x16x32_bf16 v[28:31], a[148:151], v[48:51], v[28:31]
    ds_read_b128 v[64:67], v3 offset:22528
    v_mfma_f32_16x16x32_bf16 v[28:31], a[156:159], v[52:55], v[28:31]
    buffer_load_dwordx4 v1, s[8:11], s33 offen offset:0 sc1 lds
    v_mfma_f32_16x16x32_bf16 v[24:27], a[152:155], v[52:55], v[24:27]
    ds_read_b128 v[68:71], v3 offset:23552
    v_mfma_f32_16x16x32_bf16 v[24:27], a[144:147], v[48:51], v[24:27]
    s_waitcnt lgkmcnt(2)
    v_mfma_f32_16x16x32_bf16 v[24:27], a[160:163], v[56:59], v[24:27]
    ds_read_b128 v[40:43], v3 offset:24576
    v_mfma_f32_16x16x32_bf16 v[24:27], a[168:171], v[60:63], v[24:27]
    buffer_load_dwordx4 v1, s[8:11], s33 offen offset:1024 sc1 lds
    v_mfma_f32_16x16x32_bf16 v[28:31], a[172:175], v[60:63], v[28:31]
    ds_read_b128 v[44:47], v3 offset:25600
    v_mfma_f32_16x16x32_bf16 v[28:31], a[164:167], v[56:59], v[28:31]
    s_waitcnt lgkmcnt(2)
    v_mfma_f32_16x16x32_bf16 v[28:31], a[180:183], v[64:67], v[28:31]
    ds_read_b128 v[48:51], v3 offset:26624
    v_mfma_f32_16x16x32_bf16 v[28:31], a[188:191], v[68:71], v[28:31]
    buffer_load_dwordx4 v1, s[8:11], s33 offen offset:2048 sc1 lds
    v_mfma_f32_16x16x32_bf16 v[24:27], a[184:187], v[68:71], v[24:27]
    ds_read_b128 v[52:55], v3 offset:27648
    v_mfma_f32_16x16x32_bf16 v[24:27], a[176:179], v[64:67], v[24:27]
    s_waitcnt lgkmcnt(2)
    v_mfma_f32_16x16x32_bf16 v[24:27], a[192:195], v[40:43], v[24:27]
    ds_read_b128 v[56:59], v3 offset:28672
    v_mfma_f32_16x16x32_bf16 v[24:27], a[200:203], v[44:47], v[24:27]
    buffer_load_dwordx4 v1, s[8:11], s33 offen offset:3072 sc1 lds
    v_mfma_f32_16x16x32_bf16 v[28:31], a[204:207], v[44:47], v[28:31]
    ds_read_b128 v[60:63], v3 offset:29696
    s_add_u32 s16, s16, 8192
    v_mfma_f32_16x16x32_bf16 v[28:31], a[196:199], v[40:43], v[28:31]
    s_waitcnt lgkmcnt(2)
    s_add_u32 m0, s34, s3
    s_add_u32 s37, s33, s3
    v_mfma_f32_16x16x32_bf16 v[28:31], a[212:215], v[48:51], v[28:31]
    ds_read_b128 v[64:67], v3 offset:30720
    s_waitcnt vmcnt(4)
    v_mfma_f32_16x16x32_bf16 v[28:31], a[220:223], v[52:55], v[28:31]
    buffer_load_dword v5, v4, s[4:7], s16 offen sc1
    v_mfma_f32_16x16x32_bf16 v[24:27], a[216:219], v[52:55], v[24:27]
    ds_read_b128 v[68:71], v3 offset:31744
    v_mfma_f32_16x16x32_bf16 v[24:27], a[208:211], v[48:51], v[24:27]
    s_waitcnt vmcnt(1) lgkmcnt(2)
    s_barrier
    v_mfma_f32_16x16x32_bf16 v[24:27], a[224:227], v[56:59], v[24:27]
    buffer_store_dword v6, v102, s[12:15], s17 offen sc1
    s_mov_b32 s14, s6
    v_mfma_f32_16x16x32_bf16 v[24:27], a[232:235], v[60:63], v[24:27]
    buffer_load_dwordx4 v1, s[8:11], s37 offen offset:0 sc1 lds
    v_mfma_f32_16x16x32_bf16 v[28:31], a[236:239], v[60:63], v[28:31]
    ds_read_b128 v[40:43], v2 offset:0
    s_add_u32 s17, s17, 8192
    v_mfma_f32_16x16x32_bf16 v[28:31], a[228:231], v[56:59], v[28:31]
    s_waitcnt lgkmcnt(1)
    v_mfma_f32_16x16x32_bf16 v[28:31], a[244:247], v[64:67], v[28:31]
    ds_read_b128 v[44:47], v2 offset:1024
    v_mfma_f32_16x16x32_bf16 v[28:31], a[252:255], v[68:71], v[28:31]
    buffer_load_dwordx4 v1, s[8:11], s37 offen offset:1024 sc1 lds
    v_mfma_f32_16x16x32_bf16 v[24:27], a[248:251], v[68:71], v[24:27]
    ds_read_b128 v[48:51], v2 offset:2048
    v_mfma_f32_16x16x32_bf16 v[24:27], a[240:243], v[64:67], v[24:27]
    v_mfma_f32_16x16x32_bf16 v[24:27], v[90:93], v[98:101], v[24:27]
    ds_read_b128 v[52:55], v2 offset:3072
    v_mfma_f32_16x16x32_bf16 v[28:31], v[88:91], v[98:101], v[28:31]
    buffer_load_dwordx4 v1, s[8:11], s37 offen offset:2048 sc1 lds
    buffer_load_dwordx4 v1, s[8:11], s37 offen offset:3072 sc1 lds
    s_add_u32 s32, s32, 1
    s_add_u32 s33, s33, 32768
    s_add_u32 s34, s34, 36864
    s_cmp_ge_u32 s34, 147456
    s_cselect_b32 s38, 147456, 0
    s_sub_u32 s34, s34, s38
    buffer_load_dwordx4 v[94:97], v1, s[4:7], s40 offen sc1
    s_add_u32 s40, s40, 34816
    s_cmp_ge_i32 s31, 63
    s_cbranch_scc1 L_exit
    s_branch Lwo_body00
Lwo_v12:
    v_mfma_f32_16x16x32_bf16 v[28:31], a[148:151], v[48:51], v[28:31]
    ds_read_b128 v[64:67], v3 offset:22528
    v_mfma_f32_16x16x32_bf16 v[28:31], a[156:159], v[52:55], v[28:31]
    v_mfma_f32_16x16x32_bf16 v[24:27], a[152:155], v[52:55], v[24:27]
    ds_read_b128 v[68:71], v3 offset:23552
    v_mfma_f32_16x16x32_bf16 v[24:27], a[144:147], v[48:51], v[24:27]
    s_waitcnt lgkmcnt(2)
    buffer_load_dwordx4 v[94:97], v1, s[4:7], s40 offen sc1
    v_mfma_f32_16x16x32_bf16 v[24:27], a[160:163], v[56:59], v[24:27]
    ds_read_b128 v[40:43], v3 offset:24576
    s_add_u32 s40, s40, 34816
    v_mfma_f32_16x16x32_bf16 v[24:27], a[168:171], v[60:63], v[24:27]
    v_mfma_f32_16x16x32_bf16 v[28:31], a[172:175], v[60:63], v[28:31]
    ds_read_b128 v[44:47], v3 offset:25600
    v_mfma_f32_16x16x32_bf16 v[28:31], a[164:167], v[56:59], v[28:31]
    s_waitcnt lgkmcnt(2)
    v_mfma_f32_16x16x32_bf16 v[28:31], a[180:183], v[64:67], v[28:31]
    ds_read_b128 v[48:51], v3 offset:26624
    v_mfma_f32_16x16x32_bf16 v[28:31], a[188:191], v[68:71], v[28:31]
    v_mfma_f32_16x16x32_bf16 v[24:27], a[184:187], v[68:71], v[24:27]
    ds_read_b128 v[52:55], v3 offset:27648
    v_mfma_f32_16x16x32_bf16 v[24:27], a[176:179], v[64:67], v[24:27]
    s_waitcnt lgkmcnt(2)
    v_mfma_f32_16x16x32_bf16 v[24:27], a[192:195], v[40:43], v[24:27]
    ds_read_b128 v[56:59], v3 offset:28672
    v_mfma_f32_16x16x32_bf16 v[24:27], a[200:203], v[44:47], v[24:27]
    v_mfma_f32_16x16x32_bf16 v[28:31], a[204:207], v[44:47], v[28:31]
    ds_read_b128 v[60:63], v3 offset:29696
    v_mfma_f32_16x16x32_bf16 v[28:31], a[196:199], v[40:43], v[28:31]
    s_waitcnt vmcnt(1) lgkmcnt(2)
    buffer_store_dword v6, v102, s[12:15], s17 offen sc1
    v_mfma_f32_16x16x32_bf16 v[28:31], a[212:215], v[48:51], v[28:31]
    ds_read_b128 v[64:67], v3 offset:30720
    s_mov_b32 s14, s6
    v_mfma_f32_16x16x32_bf16 v[28:31], a[220:223], v[52:55], v[28:31]
    buffer_load_dword v5, v4, s[4:7], s16 offen sc1
    v_mfma_f32_16x16x32_bf16 v[24:27], a[216:219], v[52:55], v[24:27]
    ds_read_b128 v[68:71], v3 offset:31744
    s_add_u32 s17, s17, 8192
    v_mfma_f32_16x16x32_bf16 v[24:27], a[208:211], v[48:51], v[24:27]
    s_waitcnt lgkmcnt(2)
    v_mfma_f32_16x16x32_bf16 v[24:27], a[224:227], v[56:59], v[24:27]
    v_mfma_f32_16x16x32_bf16 v[24:27], a[232:235], v[60:63], v[24:27]
    v_mfma_f32_16x16x32_bf16 v[28:31], a[236:239], v[60:63], v[28:31]
    v_mfma_f32_16x16x32_bf16 v[28:31], a[228:231], v[56:59], v[28:31]
    s_waitcnt lgkmcnt(0)
    v_mfma_f32_16x16x32_bf16 v[28:31], a[244:247], v[64:67], v[28:31]
    v_mfma_f32_16x16x32_bf16 v[28:31], a[252:255], v[68:71], v[28:31]
    v_mfma_f32_16x16x32_bf16 v[24:27], a[248:251], v[68:71], v[24:27]
    v_mfma_f32_16x16x32_bf16 v[24:27], a[240:243], v[64:67], v[24:27]
    v_mfma_f32_16x16x32_bf16 v[24:27], v[90:93], v[98:101], v[24:27]
    v_mfma_f32_16x16x32_bf16 v[28:31], v[88:91], v[98:101], v[28:31]
    s_nop 6
    v_cvt_pk_bf16_f32 v72, v24, v25
    v_cvt_pk_bf16_f32 v73, v26, v27
    v_cvt_pk_bf16_f32 v74, v28, v29
    v_cvt_pk_bf16_f32 v75, v30, v31
    s_nop 1
    v_mfma_f32_16x16x32_bf16 v[80:83], v[72:75], v[72:75], 0
    v_mfma_f32_16x16x32_bf16 v[76:79], v[84:87], v[72:75], 0
    buffer_store_dwordx4 v[72:75], v1, s[12:15], s36 offen sc1
    s_nop 5
    v_cndmask_b32 v80, v80, v81, s[44:45]
    v_cndmask_b32 v82, v82, v83, s[44:45]
    v_cndmask_b32 v77, v80, v82, s[46:47]
    buffer_store_dwordx2 v[76:77], v7, s[12:15], s36 offen offset:0 sc1
    s_add_u32 s54, s31, 1
    v_mov_b32 v6, s54
    s_waitcnt vmcnt(2)
    s_cmp_ge_i32 s31, 63
    s_cbranch_scc1 Lwo_late1
    v_cmp_gt_i32 vcc, s32, v5
    s_sub_u32 s43, s43, 1
    s_cmp_lt_i32 s43, 0
    s_cbranch_scc1 Lwo_rdy1
    s_and_b64 vcc, vcc, s[18:19]
    s_cbranch_scc0 Lwo_rdy1
Lwo_late1:
    buffer_load_dword v5, v4, s[4:7], s16 offen sc1
    s_waitcnt vmcnt(1)
    buffer_store_dword v6, v102, s[12:15], s17 offen sc1
    s_mov_b32 s14, 0
    s_cmp_ge_i32 s31, 63
    s_cbranch_scc1 L_exit
    s_waitcnt vmcnt(1)
    v_cmp_gt_i32 vcc, s32, v5
    s_sub_u32 s43, s43, 1
    s_cmp_lt_i32 s43, 0
    s_cbranch_scc1 Lwo_rdy1
    s_and_b64 vcc, vcc, s[18:19]
    s_cbranch_scc0 Lwo_rdy1
Lwo_spin1:
    buffer_load_dword v5, v4, s[4:7], s16 offen sc1
    s_waitcnt vmcnt(0)
    v_cmp_gt_i32 vcc, s32, v5
    s_sub_u32 s43, s43, 1
    s_cmp_lt_i32 s43, 0
    s_cbranch_scc1 Lwo_rdy1
    s_and_b64 vcc, vcc, s[18:19]
    s_cbranch_scc0 Lwo_rdy1
    s_sleep 8
    s_branch Lwo_spin1
Lwo_rdy1:
    s_add_u32 m0, s34, 0
    s_nop 0
    buffer_load_dwordx4 v1, s[8:11], s33 offen offset:0 sc1 lds
    buffer_load_dwordx4 v1, s[8:11], s33 offen offset:1024 sc1 lds
    buffer_load_dwordx4 v1, s[8:11], s33 offen offset:2048 sc1 lds
    buffer_load_dwordx4 v1, s[8:11], s33 offen offset:3072 sc1 lds
    s_add_u32 s16, s16, 8192
    buffer_load_dword v5, v4, s[4:7], s16 offen sc1
    s_add_u32 m0, s34, s3
    s_add_u32 s37, s33, s3
    buffer_load_dwordx4 v1, s[8:11], s37 offen offset:0 sc1 lds
    buffer_load_dwordx4 v1, s[8:11], s37 offen offset:1024 sc1 lds
    buffer_load_dwordx4 v1, s[8:11], s37 offen offset:2048 sc1 lds
    buffer_load_dwordx4 v1, s[8:11], s37 offen offset:3072 sc1 lds
    s_add_u32 s32, s32, 1
    s_add_u32 s33, s33, 32768
    s_add_u32 s34, s34, 36864
    s_cmp_ge_u32 s34, 147456
    s_cselect_b32 s38, 147456, 0
    s_sub_u32 s34, s34, s38
    s_waitcnt vmcnt(5)
    buffer_store_dword v6, v102, s[12:15], s17 offen sc1
Lwo_go1:
    s_mov_b32 s14, 0
    s_barrier
    ds_read_b128 v[40:43], v2 offset:0
    ds_read_b128 v[44:47], v2 offset:1024
    ds_read_b128 v[48:51], v2 offset:2048
    ds_read_b128 v[52:55], v2 offset:3072
    s_branch Lwo_body00
Lffa_start:
    s_mov_b32 s12, s72
    s_mov_b32 s13, s73
    s_mov_b32 s14, 0x700000
    s_mov_b32 s15, 0x00020000
    v_lshrrev_b32 v24, 3, v0
    v_mul_u32_u24 v24, 7168, v24
    v_bfe_u32 v25, v0, 4, 2
    v_lshlrev_b32 v25, 1, v25
    v_and_b32 v26, 7, v0
    v_xor_b32 v25, v25, v26
    v_lshl_add_u32 v40, v25, 4, v24
    v_add_u32 v41, 56320, v40
    s_mul_i32 s86, s29, 0x180
    s_add_u32 s86, s86, 0xffffdc00
    s_mul_i32 s37, s30, 114688
    s_add_u32 s86, s86, s37
    s_lshl_b32 s87, s30, 11
    s_add_u32 m0, s87, 0
    s_add_u32 s37, s86, 0
    buffer_load_dwordx4 v40, s[12:15], s37 offen offset:0 lds
    buffer_load_dwordx4 v41, s[12:15], s37 offen offset:1024 lds
    s_add_u32 m0, s87, 8192
    s_add_u32 s37, s86, 128
    buffer_load_dwordx4 v40, s[12:15], s37 offen offset:0 lds
    buffer_load_dwordx4 v41, s[12:15], s37 offen offset:1024 lds
    s_add_u32 m0, s87, 16384
    s_add_u32 s37, s86, 256
    buffer_load_dwordx4 v40, s[12:15], s37 offen offset:0 lds
    buffer_load_dwordx4 v41, s[12:15], s37 offen offset:1024 lds
    s_add_u32 m0, s87, 24576
    s_add_u32 s37, s86, 458752
    buffer_load_dwordx4 v40, s[12:15], s37 offen offset:0 lds
    buffer_load_dwordx4 v41, s[12:15], s37 offen offset:1024 lds
    s_add_u32 m0, s87, 32768
    s_add_u32 s37, s86, 458880
    buffer_load_dwordx4 v40, s[12:15], s37 offen offset:0 lds
    buffer_load_dwordx4 v41, s[12:15], s37 offen offset:1024 lds
    s_add_u32 m0, s87, 40960
    s_add_u32 s37, s86, 459008
    buffer_load_dwordx4 v40, s[12:15], s37 offen offset:0 lds
    buffer_load_dwordx4 v41, s[12:15], s37 offen offset:1024 lds
    s_add_u32 m0, s87, 49152
    s_add_u32 s37, s86, 917504
    buffer_load_dwordx4 v40, s[12:15], s37 offen offset:0 lds
    buffer_load_dwordx4 v41, s[12:15], s37 offen offset:1024 lds
    s_add_u32 m0, s87, 57344
    s_add_u32 s37, s86, 917632
    buffer_load_dwordx4 v40, s[12:15], s37 offen offset:0 lds
    buffer_load_dwordx4 v41, s[12:15], s37 offen offset:1024 lds
    s_add_u32 m0, s87, 65536
    s_add_u32 s37, s86, 917760
    buffer_load_dwordx4 v40, s[12:15], s37 offen offset:0 lds
    buffer_load_dwordx4 v41, s[12:15], s37 offen offset:1024 lds
    s_add_u32 m0, s87, 73728
    s_add_u32 s37, s86, 1376256
    buffer_load_dwordx4 v40, s[12:15], s37 offen offset:0 lds
    buffer_load_dwordx4 v41, s[12:15], s37 offen offset:1024 lds
    s_add_u32 m0, s87, 81920
    s_add_u32 s37, s86, 1376384
    buffer_load_dwordx4 v40, s[12:15], s37 offen offset:0 lds
    buffer_load_dwordx4 v41, s[12:15], s37 offen offset:1024 lds
    s_add_u32 m0, s87, 90112
    s_add_u32 s37, s86, 1376512
    buffer_load_dwordx4 v40, s[12:15], s37 offen offset:0 lds
    buffer_load_dwordx4 v41, s[12:15], s37 offen offset:1024 lds
    s_add_u32 m0, s87, 98304
    s_add_u32 s37, s86, 1835008
    buffer_load_dwordx4 v40, s[12:15], s37 offen offset:0 lds
    buffer_load_dwordx4 v41, s[12:15], s37 offen offset:1024 lds
    s_add_u32 m0, s87, 106496
    s_add_u32 s37, s86, 1835136
    buffer_load_dwordx4 v40, s[12:15], s37 offen offset:0 lds
    buffer_load_dwordx4 v41, s[12:15], s37 offen offset:1024 lds
    s_add_u32 m0, s87, 114688
    s_add_u32 s37, s86, 1835264
    buffer_load_dwordx4 v40, s[12:15], s37 offen offset:0 lds
    buffer_load_dwordx4 v41, s[12:15], s37 offen offset:1024 lds
    v_bfe_u32 v24, v0, 3, 2
    v_and_b32 v25, 3, v0
    v_lshlrev_b32 v25, 3, v25
    v_lshrrev_b32 v26, 2, v0
    v_lshl_add_u32 v26, v26, 7, v25
    v_lshrrev_b32 v27, 5, v0
    v_lshl_add_u32 v27, v27, 10, v26
    s_lshr_b32 s37, s30, 1
    s_and_b32 s38, s30, 1
    s_lshl_b32 s38, s38, 1
    s_add_u32 s38, s38, 0
    s_lshl_b32 s37, s37, 13
    v_xor_b32 v28, s38, v24
    v_lshl_add_u32 v28, v28, 5, s37
    v_add_u32 v42, v28, v26
    v_add_u32 v46, v28, v27
    s_lshr_b32 s37, s30, 1
    s_and_b32 s38, s30, 1
    s_lshl_b32 s38, s38, 1
    s_add_u32 s38, s38, 1
    s_lshl_b32 s37, s37, 13
    v_xor_b32 v28, s38, v24
    v_lshl_add_u32 v28, v28, 5, s37
    v_add_u32 v43, v28, v26
    v_add_u32 v47, v28, v27
    s_mov_b32 s37, 2
    s_mov_b32 s38, s30
    s_lshl_b32 s37, s37, 13
    v_xor_b32 v28, s38, v24
    v_lshl_add_u32 v28, v28, 5, s37
    v_add_u32 v44, v28, v26
    v_add_u32 v48, v28, v27
    v_mov_b32 v28, 0x3f803f80
    v_mov_b32 v29, 0x3f803f80
    v_mov_b32 v30, 0x3f803f80
    v_mov_b32 v31, 0x3f803f80
    s_mov_b32 s20, s74
    s_mov_b32 s21, s75
    s_mov_b32 s22, 0x1c00
    s_mov_b32 s23, 0x00020000
    v_lshrrev_b32 v8, 4, v0
    v_lshlrev_b32 v8, 3, v8
    s_mul_i32 s37, s29, 0x180
    s_mul_i32 s53, s30, 0x40
    s_add_u32 s37, s37, s53
    s_add_u32 s37, s37, 0xffffdc00
    buffer_load_dwordx2 v[10:11], v8, s[20:23], s37 offen
    s_mul_i32 s37, s29, 0x180
    s_mul_i32 s53, s30, 0x40
    s_add_u32 s37, s37, s53
    s_add_u32 s37, s37, 0xffffdc20
    buffer_load_dwordx2 v[12:13], v8, s[20:23], s37 offen
    s_mul_i32 s37, s29, 0x180
    s_mul_i32 s53, s30, 0x20
    s_add_u32 s37, s37, s53
    s_add_u32 s37, s37, 0xffffdd00
    buffer_load_dwordx2 v[14:15], v8, s[20:23], s37 offen
    s_waitcnt vmcnt(0)
    v_lshlrev_b32 v68, 16, v10
    v_and_b32 v69, 0xffff0000, v10
    v_lshlrev_b32 v70, 16, v11
    v_and_b32 v71, 0xffff0000, v11
    v_lshlrev_b32 v72, 16, v12
    v_and_b32 v73, 0xffff0000, v12
    v_lshlrev_b32 v74, 16, v13
    v_and_b32 v75, 0xffff0000, v13
    v_lshlrev_b32 v76, 16, v14
    v_and_b32 v77, 0xffff0000, v14
    v_lshlrev_b32 v78, 16, v15
    v_and_b32 v79, 0xffff0000, v15
    s_mul_i32 s37, s28, 0x80000
    s_add_u32 s37, s37, 0x6000800
    v_min_u32 v4, 31, v0
    v_lshl_add_u32 v4, v4, 5, s37
    s_mov_b32 s32, 1
    s_mul_i32 s33, s28, 0x240000
    s_add_u32 s33, s33, 0x1200000
    s_mul_i32 s36, s28, 0x720000
    s_mul_i32 s53, s29, 0x1800
    s_add_u32 s36, s36, s53
    s_mul_i32 s53, s30, 0x400
    s_add_u32 s36, s36, s53
    s_add_u32 s36, s36, 0x1fbf800
    s_lshr_b32 s37, s30, 1
    s_sub_u32 s37, s37, s30
    s_add_u32 s37, s37, 4
    s_lshl_b32 s37, s37, 10
    s_and_b32 s38, s30, 1
    v_lshrrev_b32 v8, 5, v0
    v_cmp_eq_u32 vcc, s38, v8
    v_add_u32 v8, s37, v1
    v_mov_b32 v7, 0x40000000
    v_cndmask_b32 v7, v7, v8, vcc
    s_mov_b32 s31, -1
    s_mov_b32 s35, 0
    s_mov_b32 s16, 0
    v_mov_b32 v5, 0
    s_mul_i32 s17, s28, 0x80000
    s_mul_i32 s53, s29, 0x80
    s_add_u32 s17, s17, s53
    s_mul_i32 s53, s30, 0x20
    s_add_u32 s17, s17, s53
    s_add_u32 s17, s17, 0x5ffe000
    v_cmp_eq_u32 vcc, 0, v0
    v_mov_b32 v22, 0x40000000
    s_nop 0
    v_cndmask_b32 v22, v22, v0, vcc
    v_mov_b32 v2, v1
    s_mul_i32 s34, s30, 4096
    s_mul_i32 s3, s30, 0xfffff400
    s_add_u32 s3, s3, 0x8000
    s_add_u32 s41, s3, 4096
    s_add_u32 s33, s33, s34
    v_lshlrev_b32 v20, 3, v0
    s_mov_b64 s[18:19], 0xffffffff
    s_mov_b32 s19, 0
    v_mov_b32 v8, 0x40000000
    v_cndmask_b32 v4, v8, v4, s[18:19]
    v_add_u32 v12, 0, v42
    v_add_u32 v13, 0, v43
    v_add_u32 v14, 0, v44
    s_waitcnt vmcnt(24) lgkmcnt(0)
    s_barrier
    s_add_u32 m0, s87, 122880
    s_add_u32 s37, s86, 2293760
    buffer_load_dwordx4 v40, s[12:15], s37 offen offset:0 lds
    ds_read_b64_tr_b16 a[0:1], v12 offset:0
    ds_read_b64_tr_b16 a[2:3], v12 offset:2048
    ds_read_b64_tr_b16 a[4:5], v13 offset:0
    buffer_load_dwordx4 v41, s[12:15], s37 offen offset:1024 lds
    ds_read_b64_tr_b16 a[6:7], v13 offset:2048
    ds_read_b64_tr_b16 a[8:9], v14 offset:0
    ds_read_b64_tr_b16 a[10:11], v14 offset:2048
    s_add_u32 m0, s87, 131072
    s_add_u32 s37, s86, 2293888
    buffer_load_dwordx4 v40, s[12:15], s37 offen offset:0 lds
    ds_read_b64_tr_b16 a[12:13], v12 offset:4096
    ds_read_b64_tr_b16 a[14:15], v12 offset:6144
    ds_read_b64_tr_b16 a[16:17], v13 offset:4096
    buffer_load_dwordx4 v41, s[12:15], s37 offen offset:1024 lds
    ds_read_b64_tr_b16 a[18:19], v13 offset:6144
    ds_read_b64_tr_b16 a[20:21], v14 offset:4096
    ds_read_b64_tr_b16 a[22:23], v14 offset:6144
    s_add_u32 m0, s87, 139264
    s_add_u32 s37, s86, 2294016
    buffer_load_dwordx4 v40, s[12:15], s37 offen offset:0 lds
    v_add_u32 v16, 24576, v42
    v_add_u32 v17, 24576, v43
    v_add_u32 v18, 24576, v44
    buffer_load_dwordx4 v41, s[12:15], s37 offen offset:1024 lds
    s_waitcnt vmcnt(24) lgkmcnt(0)
    s_barrier
    s_add_u32 m0, s87, 0
    s_add_u32 s37, s86, 2752512
    buffer_load_dwordx4 v40, s[12:15], s37 offen offset:0 lds
    ds_read_b64_tr_b16 a[24:25], v16 offset:0
    ds_read_b64_tr_b16 a[26:27], v16 offset:2048
    ds_read_b64_tr_b16 a[28:29], v17 offset:0
    ds_read_b64_tr_b16 a[30:31], v17 offset:2048
    buffer_load_dwordx4 v41, s[12:15], s37 offen offset:1024 lds
    ds_read_b64_tr_b16 a[32:33], v18 offset:0
    ds_read_b64_tr_b16 a[34:35], v18 offset:2048
    ds_read_b64_tr_b16 a[36:37], v16 offset:4096
    ds_read_b64_tr_b16 a[38:39], v16 offset:6144
    s_add_u32 m0, s87, 8192
    s_add_u32 s37, s86, 2752640
    buffer_load_dwordx4 v40, s[12:15], s37 offen offset:0 lds
    ds_read_b64_tr_b16 a[40:41], v17 offset:4096
    ds_read_b64_tr_b16 a[42:43], v17 offset:6144
    ds_read_b64_tr_b16 a[44:45], v18 offset:4096
    ds_read_b64_tr_b16 a[46:47], v18 offset:6144
    buffer_load_dwordx4 v41, s[12:15], s37 offen offset:1024 lds
    v_mfma_f32_16x16x32_bf16 v[56:59], a[0:3], v[28:31], 0
    v_mfma_f32_16x16x32_bf16 v[60:63], a[4:7], v[28:31], 0
    v_mfma_f32_16x16x32_bf16 v[64:67], a[8:11], v[28:31], 0
    v_mfma_f32_16x16x32_bf16 v[56:59], a[12:15], v[28:31], v[56:59]
    s_add_u32 m0, s87, 16384
    s_add_u32 s37, s86, 2752768
    buffer_load_dwordx4 v40, s[12:15], s37 offen offset:0 lds
    v_mfma_f32_16x16x32_bf16 v[60:63], a[16:19], v[28:31], v[60:63]
    v_mfma_f32_16x16x32_bf16 v[64:67], a[20:23], v[28:31], v[64:67]
    v_add_u32 v12, 49152, v42
    v_add_u32 v13, 49152, v43
    buffer_load_dwordx4 v41, s[12:15], s37 offen offset:1024 lds
    v_add_u32 v14, 49152, v44
    s_waitcnt vmcnt(24) lgkmcnt(0)
    s_barrier
    s_add_u32 m0, s87, 24576
    s_add_u32 s37, s86, 3211264
    buffer_load_dwordx4 v40, s[12:15], s37 offen offset:0 lds
    ds_read_b64_tr_b16 a[48:49], v12 offset:0
    ds_read_b64_tr_b16 a[50:51], v12 offset:2048
    ds_read_b64_tr_b16 a[52:53], v13 offset:0
    ds_read_b64_tr_b16 a[54:55], v13 offset:2048
    buffer_load_dwordx4 v41, s[12:15], s37 offen offset:1024 lds
    ds_read_b64_tr_b16 a[56:57], v14 offset:0
    ds_read_b64_tr_b16 a[58:59], v14 offset:2048
    ds_read_b64_tr_b16 a[60:61], v12 offset:4096
    ds_read_b64_tr_b16 a[62:63], v12 offset:6144
    s_add_u32 m0, s87, 32768
    s_add_u32 s37, s86, 3211392
    buffer_load_dwordx4 v40, s[12:15], s37 offen offset:0 lds
    ds_read_b64_tr_b16 a[64:65], v13 offset:4096
    ds_read_b64_tr_b16 a[66:67], v13 offset:6144
    ds_read_b64_tr_b16 a[68:69], v14 offset:4096
    ds_read_b64_tr_b16 a[70:71], v14 offset:6144
    buffer_load_dwordx4 v41, s[12:15], s37 offen offset:1024 lds
    v_mfma_f32_16x16x32_bf16 v[56:59], a[24:27], v[28:31], v[56:59]
    v_mfma_f32_16x16x32_bf16 v[60:63], a[28:31], v[28:31], v[60:63]
    v_mfma_f32_16x16x32_bf16 v[64:67], a[32:35], v[28:31], v[64:67]
    v_mfma_f32_16x16x32_bf16 v[56:59], a[36:39], v[28:31], v[56:59]
    s_add_u32 m0, s87, 40960
    s_add_u32 s37, s86, 3211520
    buffer_load_dwordx4 v40, s[12:15], s37 offen offset:0 lds
    v_mfma_f32_16x16x32_bf16 v[60:63], a[40:43], v[28:31], v[60:63]
    v_mfma_f32_16x16x32_bf16 v[64:67], a[44:47], v[28:31], v[64:67]
    v_add_u32 v16, 73728, v42
    v_add_u32 v17, 73728, v43
    buffer_load_dwordx4 v41, s[12:15], s37 offen offset:1024 lds
    v_add_u32 v18, 73728, v44
    s_waitcnt vmcnt(24) lgkmcnt(0)
    s_barrier
    s_add_u32 m0, s87, 49152
    s_add_u32 s37, s86, 3670016
    buffer_load_dwordx4 v40, s[12:15], s37 offen offset:0 lds
    ds_read_b64_tr_b16 a[72:73], v16 offset:0
    ds_read_b64_tr_b16 a[74:75], v16 offset:2048
    ds_read_b64_tr_b16 a[76:77], v17 offset:0
    ds_read_b64_tr_b16 a[78:79], v17 offset:2048
    buffer_load_dwordx4 v41, s[12:15], s37 offen offset:1024 lds
    ds_read_b64_tr_b16 a[80:81], v18 offset:0
    ds_read_b64_tr_b16 a[82:83], v18 offset:2048
    ds_read_b64_tr_b16 a[84:85], v16 offset:4096
    ds_read_b64_tr_b16 a[86:87], v16 offset:6144
    s_add_u32 m0, s87, 57344
    s_add_u32 s37, s86, 3670144
    buffer_load_dwordx4 v40, s[12:15], s37 offen offset:0 lds
    ds_read_b64_tr_b16 a[88:89], v17 offset:4096
    ds_read_b64_tr_b16 a[90:91], v17 offset:6144
    ds_read_b64_tr_b16 a[92:93], v18 offset:4096
    ds_read_b64_tr_b16 a[94:95], v18 offset:6144
    buffer_load_dwordx4 v41, s[12:15], s37 offen offset:1024 lds
    v_mfma_f32_16x16x32_bf16 v[56:59], a[48:51], v[28:31], v[56:59]
    v_mfma_f32_16x16x32_bf16 v[60:63], a[52:55], v[28:31], v[60:63]
    v_mfma_f32_16x16x32_bf16 v[64:67], a[56:59], v[28:31], v[64:67]
    v_mfma_f32_16x16x32_bf16 v[56:59], a[60:63], v[28:31], v[56:59]
    s_add_u32 m0, s87, 65536
    s_add_u32 s37, s86, 3670272
    buffer_load_dwordx4 v40, s[12:15], s37 offen offset:0 lds
    v_mfma_f32_16x16x32_bf16 v[60:63], a[64:67], v[28:31], v[60:63]
    v_mfma_f32_16x16x32_bf16 v[64:67], a[68:71], v[28:31], v[64:67]
    v_add_u32 v12, 98304, v42
    v_add_u32 v13, 98304, v43
    buffer_load_dwordx4 v41, s[12:15], s37 offen offset:1024 lds
    v_add_u32 v14, 98304, v44
    s_waitcnt vmcnt(24) lgkmcnt(0)
    s_barrier
    s_add_u32 m0, s87, 73728
    s_add_u32 s37, s86, 4128768
    buffer_load_dwordx4 v40, s[12:15], s37 offen offset:0 lds
    ds_read_b64_tr_b16 a[96:97], v12 offset:0
    ds_read_b64_tr_b16 a[98:99], v12 offset:2048
    ds_read_b64_tr_b16 a[100:101], v13 offset:0
    ds_read_b64_tr_b16 a[102:103], v13 offset:2048
    buffer_load_dwordx4 v41, s[12:15], s37 offen offset:1024 lds
    ds_read_b64_tr_b16 a[104:105], v14 offset:0
    ds_read_b64_tr_b16 a[106:107], v14 offset:2048
    ds_read_b64_tr_b16 a[108:109], v12 offset:4096
    ds_read_b64_tr_b16 a[110:111], v12 offset:6144
    s_add_u32 m0, s87, 81920
    s_add_u32 s37, s86, 4128896
    buffer_load_dwordx4 v40, s[12:15], s37 offen offset:0 lds
    ds_read_b64_tr_b16 a[112:113], v13 offset:4096
    ds_read_b64_tr_b16 a[114:115], v13 offset:6144
    ds_read_b64_tr_b16 a[116:117], v14 offset:4096
    ds_read_b64_tr_b16 a[118:119], v14 offset:6144
    buffer_load_dwordx4 v41, s[12:15], s37 offen offset:1024 lds
    v_mfma_f32_16x16x32_bf16 v[56:59], a[72:75], v[28:31], v[56:59]
    v_mfma_f32_16x16x32_bf16 v[60:63], a[76:79], v[28:31], v[60:63]
    v_mfma_f32_16x16x32_bf16 v[64:67], a[80:83], v[28:31], v[64:67]
    v_mfma_f32_16x16x32_bf16 v[56:59], a[84:87], v[28:31], v[56:59]
    s_add_u32 m0, s87, 90112
    s_add_u32 s37, s86, 4129024
    buffer_load_dwordx4 v40, s[12:15], s37 offen offset:0 lds
    v_mfma_f32_16x16x32_bf16 v[60:63], a[88:91], v[28:31], v[60:63]
    v_mfma_f32_16x16x32_bf16 v[64:67], a[92:95], v[28:31], v[64:67]
    v_add_u32 v16, 122880, v42
    v_add_u32 v17, 122880, v43
    buffer_load_dwordx4 v41, s[12:15], s37 offen offset:1024 lds
    v_add_u32 v18, 122880, v44
    s_waitcnt vmcnt(24) lgkmcnt(0)
    s_barrier
    s_add_u32 m0, s87, 98304
    s_add_u32 s37, s86, 4587520
    buffer_load_dwordx4 v40, s[12:15], s37 offen offset:0 lds
    ds_read_b64_tr_b16 a[120:121], v16 offset:0
    ds_read_b64_tr_b16 a[122:123], v16 offset:2048
    ds_read_b64_tr_b16 a[124:125], v17 offset:0
    ds_read_b64_tr_b16 a[126:127], v17 offset:2048
    buffer_load_dwordx4 v41, s[12:15], s37 offen offset:1024 lds
    ds_read_b64_tr_b16 a[128:129], v18 offset:0
    ds_read_b64_tr_b16 a[130:131], v18 offset:2048
    ds_read_b64_tr_b16 a[132:133], v16 offset:4096
    ds_read_b64_tr_b16 a[134:135], v16 offset:6144
    s_add_u32 m0, s87, 106496
    s_add_u32 s37, s86, 4587648
    buffer_load_dwordx4 v40, s[12:15], s37 offen offset:0 lds
    ds_read_b64_tr_b16 a[136:137], v17 offset:4096
    ds_read_b64_tr_b16 a[138:139], v17 offset:6144
    ds_read_b64_tr_b16 a[140:141], v18 offset:4096
    ds_read_b64_tr_b16 a[142:143], v18 offset:6144
    buffer_load_dwordx4 v41, s[12:15], s37 offen offset:1024 lds
    v_mfma_f32_16x16x32_bf16 v[56:59], a[96:99], v[28:31], v[56:59]
    v_mfma_f32_16x16x32_bf16 v[60:63], a[100:103], v[28:31], v[60:63]
    v_mfma_f32_16x16x32_bf16 v[64:67], a[104:107], v[28:31], v[64:67]
    v_mfma_f32_16x16x32_bf16 v[56:59], a[108:111], v[28:31], v[56:59]
    s_add_u32 m0, s87, 114688
    s_add_u32 s37, s86, 4587776
    buffer_load_dwordx4 v40, s[12:15], s37 offen offset:0 lds
    v_mfma_f32_16x16x32_bf16 v[60:63], a[112:115], v[28:31], v[60:63]
    v_mfma_f32_16x16x32_bf16 v[64:67], a[116:119], v[28:31], v[64:67]
    v_add_u32 v12, 0, v42
    v_add_u32 v13, 0, v43
    buffer_load_dwordx4 v41, s[12:15], s37 offen offset:1024 lds
    v_add_u32 v14, 0, v44
    s_waitcnt vmcnt(24) lgkmcnt(0)
    s_barrier
    s_add_u32 m0, s87, 122880
    s_add_u32 s37, s86, 5046272
    buffer_load_dwordx4 v40, s[12:15], s37 offen offset:0 lds
    ds_read_b64_tr_b16 a[144:145], v12 offset:0
    ds_read_b64_tr_b16 a[146:147], v12 offset:2048
    ds_read_b64_tr_b16 a[148:149], v13 offset:0
    ds_read_b64_tr_b16 a[150:151], v13 offset:2048
    buffer_load_dwordx4 v41, s[12:15], s37 offen offset:1024 lds
    ds_read_b64_tr_b16 a[152:153], v14 offset:0
    ds_read_b64_tr_b16 a[154:155], v14 offset:2048
    ds_read_b64_tr_b16 a[156:157], v12 offset:4096
    ds_read_b64_tr_b16 a[158:159], v12 offset:6144
    s_add_u32 m0, s87, 131072
    s_add_u32 s37, s86, 5046400
    buffer_load_dwordx4 v40, s[12:15], s37 offen offset:0 lds
    ds_read_b64_tr_b16 a[160:161], v13 offset:4096
    ds_read_b64_tr_b16 a[162:163], v13 offset:6144
    ds_read_b64_tr_b16 a[164:165], v14 offset:4096
    ds_read_b64_tr_b16 a[166:167], v14 offset:6144
    buffer_load_dwordx4 v41, s[12:15], s37 offen offset:1024 lds
    v_mfma_f32_16x16x32_bf16 v[56:59], a[120:123], v[28:31], v[56:59]
    v_mfma_f32_16x16x32_bf16 v[60:63], a[124:127], v[28:31], v[60:63]
    v_mfma_f32_16x16x32_bf16 v[64:67], a[128:131], v[28:31], v[64:67]
    v_mfma_f32_16x16x32_bf16 v[56:59], a[132:135], v[28:31], v[56:59]
    s_add_u32 m0, s87, 139264
    s_add_u32 s37, s86, 5046528
    buffer_load_dwordx4 v40, s[12:15], s37 offen offset:0 lds
    v_mfma_f32_16x16x32_bf16 v[60:63], a[136:139], v[28:31], v[60:63]
    v_mfma_f32_16x16x32_bf16 v[64:67], a[140:143], v[28:31], v[64:67]
    v_add_u32 v16, 24576, v42
    v_add_u32 v17, 24576, v43
    buffer_load_dwordx4 v41, s[12:15], s37 offen offset:1024 lds
    v_add_u32 v18, 24576, v44
    s_waitcnt vmcnt(24) lgkmcnt(0)
    s_barrier
    s_add_u32 m0, s87, 0
    s_add_u32 s37, s86, 5505024
    buffer_load_dwordx4 v40, s[12:15], s37 offen offset:0 lds
    ds_read_b64_tr_b16 a[168:169], v16 offset:0
    ds_read_b64_tr_b16 a[170:171], v16 offset:2048
    ds_read_b64_tr_b16 a[172:173], v17 offset:0
    ds_read_b64_tr_b16 a[174:175], v17 offset:2048
    buffer_load_dwordx4 v41, s[12:15], s37 offen offset:1024 lds
    ds_read_b64_tr_b16 a[176:177], v18 offset:0
    ds_read_b64_tr_b16 a[178:179], v18 offset:2048
    ds_read_b64_tr_b16 a[180:181], v16 offset:4096
    ds_read_b64_tr_b16 a[182:183], v16 offset:6144
    s_add_u32 m0, s87, 8192
    s_add_u32 s37, s86, 5505152
    buffer_load_dwordx4 v40, s[12:15], s37 offen offset:0 lds
    ds_read_b64_tr_b16 a[184:185], v17 offset:4096
    ds_read_b64_tr_b16 a[186:187], v17 offset:6144
    ds_read_b64_tr_b16 a[188:189], v18 offset:4096
    ds_read_b64_tr_b16 a[190:191], v18 offset:6144
    buffer_load_dwordx4 v41, s[12:15], s37 offen offset:1024 lds
    v_mfma_f32_16x16x32_bf16 v[56:59], a[144:147], v[28:31], v[56:59]
    v_mfma_f32_16x16x32_bf16 v[60:63], a[148:151], v[28:31], v[60:63]
    v_mfma_f32_16x16x32_bf16 v[64:67], a[152:155], v[28:31], v[64:67]
    v_mfma_f32_16x16x32_bf16 v[56:59], a[156:159], v[28:31], v[56:59]
    s_add_u32 m0, s87, 16384
    s_add_u32 s37, s86, 5505280
    buffer_load_dwordx4 v40, s[12:15], s37 offen offset:0 lds
    v_mfma_f32_16x16x32_bf16 v[60:63], a[160:163], v[28:31], v[60:63]
    v_mfma_f32_16x16x32_bf16 v[64:67], a[164:167], v[28:31], v[64:67]
    v_add_u32 v12, 49152, v42
    v_add_u32 v13, 49152, v43
    buffer_load_dwordx4 v41, s[12:15], s37 offen offset:1024 lds
    v_add_u32 v14, 49152, v44
    s_waitcnt vmcnt(24) lgkmcnt(0)
    s_barrier
    s_add_u32 m0, s87, 24576
    s_add_u32 s37, s86, 5963776
    buffer_load_dwordx4 v40, s[12:15], s37 offen offset:0 lds
    ds_read_b64_tr_b16 a[192:193], v12 offset:0
    ds_read_b64_tr_b16 a[194:195], v12 offset:2048
    ds_read_b64_tr_b16 a[196:197], v13 offset:0
    ds_read_b64_tr_b16 a[198:199], v13 offset:2048
    buffer_load_dwordx4 v41, s[12:15], s37 offen offset:1024 lds
    ds_read_b64_tr_b16 a[200:201], v14 offset:0
    ds_read_b64_tr_b16 a[202:203], v14 offset:2048
    ds_read_b64_tr_b16 a[204:205], v12 offset:4096
    ds_read_b64_tr_b16 a[206:207], v12 offset:6144
    s_add_u32 m0, s87, 32768
    s_add_u32 s37, s86, 5963904
    buffer_load_dwordx4 v40, s[12:15], s37 offen offset:0 lds
    ds_read_b64_tr_b16 a[208:209], v13 offset:4096
    ds_read_b64_tr_b16 a[210:211], v13 offset:6144
    ds_read_b64_tr_b16 a[212:213], v14 offset:4096
    ds_read_b64_tr_b16 a[214:215], v14 offset:6144
    buffer_load_dwordx4 v41, s[12:15], s37 offen offset:1024 lds
    v_mfma_f32_16x16x32_bf16 v[56:59], a[168:171], v[28:31], v[56:59]
    v_mfma_f32_16x16x32_bf16 v[60:63], a[172:175], v[28:31], v[60:63]
    v_mfma_f32_16x16x32_bf16 v[64:67], a[176:179], v[28:31], v[64:67]
    v_mfma_f32_16x16x32_bf16 v[56:59], a[180:183], v[28:31], v[56:59]
    s_add_u32 m0, s87, 40960
    s_add_u32 s37, s86, 5964032
    buffer_load_dwordx4 v40, s[12:15], s37 offen offset:0 lds
    v_mfma_f32_16x16x32_bf16 v[60:63], a[184:187], v[28:31], v[60:63]
    v_mfma_f32_16x16x32_bf16 v[64:67], a[188:191], v[28:31], v[64:67]
    v_add_u32 v16, 73728, v42
    v_add_u32 v17, 73728, v43
    buffer_load_dwordx4 v41, s[12:15], s37 offen offset:1024 lds
    v_add_u32 v18, 73728, v44
    s_waitcnt vmcnt(24) lgkmcnt(0)
    s_barrier
    s_add_u32 m0, s87, 49152
    s_add_u32 s37, s86, 6422528
    buffer_load_dwordx4 v40, s[12:15], s37 offen offset:0 lds
    ds_read_b64_tr_b16 a[216:217], v16 offset:0
    ds_read_b64_tr_b16 a[218:219], v16 offset:2048
    ds_read_b64_tr_b16 a[220:221], v17 offset:0
    ds_read_b64_tr_b16 a[222:223], v17 offset:2048
    buffer_load_dwordx4 v41, s[12:15], s37 offen offset:1024 lds
    ds_read_b64_tr_b16 a[224:225], v18 offset:0
    ds_read_b64_tr_b16 a[226:227], v18 offset:2048
    ds_read_b64_tr_b16 a[228:229], v16 offset:4096
    ds_read_b64_tr_b16 a[230:231], v16 offset:6144
    s_add_u32 m0, s87, 57344
    s_add_u32 s37, s86, 6422656
    buffer_load_dwordx4 v40, s[12:15], s37 offen offset:0 lds
    ds_read_b64_tr_b16 a[232:233], v17 offset:4096
    ds_read_b64_tr_b16 a[234:235], v17 offset:6144
    ds_read_b64_tr_b16 a[236:237], v18 offset:4096
    ds_read_b64_tr_b16 a[238:239], v18 offset:6144
    buffer_load_dwordx4 v41, s[12:15], s37 offen offset:1024 lds
    v_mfma_f32_16x16x32_bf16 v[56:59], a[192:195], v[28:31], v[56:59]
    v_mfma_f32_16x16x32_bf16 v[60:63], a[196:199], v[28:31], v[60:63]
    v_mfma_f32_16x16x32_bf16 v[64:67], a[200:203], v[28:31], v[64:67]
    v_mfma_f32_16x16x32_bf16 v[56:59], a[204:207], v[28:31], v[56:59]
    s_add_u32 m0, s87, 65536
    s_add_u32 s37, s86, 6422784
    buffer_load_dwordx4 v40, s[12:15], s37 offen offset:0 lds
    v_mfma_f32_16x16x32_bf16 v[60:63], a[208:211], v[28:31], v[60:63]
    v_mfma_f32_16x16x32_bf16 v[64:67], a[212:215], v[28:31], v[64:67]
    v_add_u32 v12, 98304, v42
    v_add_u32 v13, 98304, v43
    buffer_load_dwordx4 v41, s[12:15], s37 offen offset:1024 lds
    v_add_u32 v14, 98304, v44
    s_waitcnt vmcnt(24) lgkmcnt(0)
    s_barrier
    s_add_u32 m0, s87, 73728
    s_add_u32 s37, s86, 6881280
    buffer_load_dwordx4 v40, s[12:15], s37 offen offset:0 lds
    ds_read_b64_tr_b16 a[240:241], v12 offset:0
    ds_read_b64_tr_b16 a[242:243], v12 offset:2048
    ds_read_b64_tr_b16 a[244:245], v13 offset:0
    ds_read_b64_tr_b16 a[246:247], v13 offset:2048
    buffer_load_dwordx4 v41, s[12:15], s37 offen offset:1024 lds
    ds_read_b64_tr_b16 a[248:249], v14 offset:0
    ds_read_b64_tr_b16 a[250:251], v14 offset:2048
    ds_read_b64_tr_b16 a[252:253], v12 offset:4096
    ds_read_b64_tr_b16 a[254:255], v12 offset:6144
    s_add_u32 m0, s87, 81920
    s_add_u32 s37, s86, 6881408
    buffer_load_dwordx4 v40, s[12:15], s37 offen offset:0 lds
    ds_read_b64_tr_b16 v[128:129], v13 offset:4096
    ds_read_b64_tr_b16 v[130:131], v13 offset:6144
    ds_read_b64_tr_b16 v[132:133], v14 offset:4096
    ds_read_b64_tr_b16 v[134:135], v14 offset:6144
    buffer_load_dwordx4 v41, s[12:15], s37 offen offset:1024 lds
    v_mfma_f32_16x16x32_bf16 v[56:59], a[216:219], v[28:31], v[56:59]
    v_mfma_f32_16x16x32_bf16 v[60:63], a[220:223], v[28:31], v[60:63]
    v_mfma_f32_16x16x32_bf16 v[64:67], a[224:227], v[28:31], v[64:67]
    v_mfma_f32_16x16x32_bf16 v[56:59], a[228:231], v[28:31], v[56:59]
    s_add_u32 m0, s87, 90112
    s_add_u32 s37, s86, 6881536
    buffer_load_dwordx4 v40, s[12:15], s37 offen offset:0 lds
    v_mfma_f32_16x16x32_bf16 v[60:63], a[232:235], v[28:31], v[60:63]
    v_mfma_f32_16x16x32_bf16 v[64:67], a[236:239], v[28:31], v[64:67]
    v_add_u32 v16, 122880, v42
    v_add_u32 v17, 122880, v43
    buffer_load_dwordx4 v41, s[12:15], s37 offen offset:1024 lds
    v_add_u32 v18, 122880, v44
    s_waitcnt vmcnt(24) lgkmcnt(0)
    s_barrier
    ds_read_b64_tr_b16 v[136:137], v16 offset:0
    ds_read_b64_tr_b16 v[138:139], v16 offset:2048
    ds_read_b64_tr_b16 v[140:141], v17 offset:0
    ds_read_b64_tr_b16 v[142:143], v17 offset:2048
    ds_read_b64_tr_b16 v[144:145], v18 offset:0
    ds_read_b64_tr_b16 v[146:147], v18 offset:2048
    ds_read_b64_tr_b16 v[148:149], v16 offset:4096
    ds_read_b64_tr_b16 v[150:151], v16 offset:6144
    ds_read_b64_tr_b16 v[152:153], v17 offset:4096
    ds_read_b64_tr_b16 v[154:155], v17 offset:6144
    ds_read_b64_tr_b16 v[156:157], v18 offset:4096
    ds_read_b64_tr_b16 v[158:159], v18 offset:6144
    v_mfma_f32_16x16x32_bf16 v[56:59], a[240:243], v[28:31], v[56:59]
    v_mfma_f32_16x16x32_bf16 v[60:63], a[244:247], v[28:31], v[60:63]
    v_mfma_f32_16x16x32_bf16 v[64:67], a[248:251], v[28:31], v[64:67]
    v_mfma_f32_16x16x32_bf16 v[56:59], a[252:255], v[28:31], v[56:59]
    v_mfma_f32_16x16x32_bf16 v[60:63], v[128:131], v[28:31], v[60:63]
    v_mfma_f32_16x16x32_bf16 v[64:67], v[132:135], v[28:31], v[64:67]
    v_add_u32 v12, 0, v42
    v_add_u32 v13, 0, v43
    v_add_u32 v14, 0, v44
    s_waitcnt vmcnt(18) lgkmcnt(0)
    s_barrier
    ds_read_b64_tr_b16 v[160:161], v12 offset:0
    ds_read_b64_tr_b16 v[162:163], v12 offset:2048
    ds_read_b64_tr_b16 v[164:165], v13 offset:0
    ds_read_b64_tr_b16 v[166:167], v13 offset:2048
    ds_read_b64_tr_b16 v[168:169], v14 offset:0
    ds_read_b64_tr_b16 v[170:171], v14 offset:2048
    ds_read_b64_tr_b16 v[172:173], v12 offset:4096
    ds_read_b64_tr_b16 v[174:175], v12 offset:6144
    ds_read_b64_tr_b16 v[176:177], v13 offset:4096
    ds_read_b64_tr_b16 v[178:179], v13 offset:6144
    ds_read_b64_tr_b16 v[180:181], v14 offset:4096
    ds_read_b64_tr_b16 v[182:183], v14 offset:6144
    v_mfma_f32_16x16x32_bf16 v[56:59], v[136:139], v[28:31], v[56:59]
    v_mfma_f32_16x16x32_bf16 v[60:63], v[140:143], v[28:31], v[60:63]
    v_mfma_f32_16x16x32_bf16 v[64:67], v[144:147], v[28:31], v[64:67]
    v_mfma_f32_16x16x32_bf16 v[56:59], v[148:151], v[28:31], v[56:59]
    v_mfma_f32_16x16x32_bf16 v[60:63], v[152:155], v[28:31], v[60:63]
    v_mfma_f32_16x16x32_bf16 v[64:67], v[156:159], v[28:31], v[64:67]
    v_add_u32 v16, 24576, v42
    v_add_u32 v17, 24576, v43
    v_add_u32 v18, 24576, v44
    s_waitcnt vmcnt(12) lgkmcnt(0)
    s_barrier
    ds_read_b64_tr_b16 v[184:185], v16 offset:0
    ds_read_b64_tr_b16 v[186:187], v16 offset:2048
    ds_read_b64_tr_b16 v[188:189], v17 offset:0
    ds_read_b64_tr_b16 v[190:191], v17 offset:2048
    ds_read_b64_tr_b16 v[192:193], v18 offset:0
    ds_read_b64_tr_b16 v[194:195], v18 offset:2048
    ds_read_b64_tr_b16 v[196:197], v16 offset:4096
    ds_read_b64_tr_b16 v[198:199], v16 offset:6144
    ds_read_b64_tr_b16 v[200:201], v17 offset:4096
    ds_read_b64_tr_b16 v[202:203], v17 offset:6144
    ds_read_b64_tr_b16 v[204:205], v18 offset:4096
    ds_read_b64_tr_b16 v[206:207], v18 offset:6144
    v_mfma_f32_16x16x32_bf16 v[56:59], v[160:163], v[28:31], v[56:59]
    v_mfma_f32_16x16x32_bf16 v[60:63], v[164:167], v[28:31], v[60:63]
    v_mfma_f32_16x16x32_bf16 v[64:67], v[168:171], v[28:31], v[64:67]
    v_mfma_f32_16x16x32_bf16 v[56:59], v[172:175], v[28:31], v[56:59]
    v_mfma_f32_16x16x32_bf16 v[60:63], v[176:179], v[28:31], v[60:63]
    v_mfma_f32_16x16x32_bf16 v[64:67], v[180:183], v[28:31], v[64:67]
    v_add_u32 v12, 49152, v42
    v_add_u32 v13, 49152, v43
    v_add_u32 v14, 49152, v44
    s_waitcnt vmcnt(6) lgkmcnt(0)
    s_barrier
    ds_read_b64_tr_b16 v[208:209], v12 offset:0
    ds_read_b64_tr_b16 v[210:211], v12 offset:2048
    ds_read_b64_tr_b16 v[212:213], v13 offset:0
    ds_read_b64_tr_b16 v[214:215], v13 offset:2048
    ds_read_b64_tr_b16 v[216:217], v14 offset:0
    ds_read_b64_tr_b16 v[218:219], v14 offset:2048
    ds_read_b64_tr_b16 v[220:221], v12 offset:4096
    ds_read_b64_tr_b16 v[222:223], v12 offset:6144
    ds_read_b64_tr_b16 v[224:225], v13 offset:4096
    ds_read_b64_tr_b16 v[226:227], v13 offset:6144
    ds_read_b64_tr_b16 v[228:229], v14 offset:4096
    ds_read_b64_tr_b16 v[230:231], v14 offset:6144
    v_mfma_f32_16x16x32_bf16 v[56:59], v[184:187], v[28:31], v[56:59]
    v_mfma_f32_16x16x32_bf16 v[60:63], v[188:191], v[28:31], v[60:63]
    v_mfma_f32_16x16x32_bf16 v[64:67], v[192:195], v[28:31], v[64:67]
    v_mfma_f32_16x16x32_bf16 v[56:59], v[196:199], v[28:31], v[56:59]
    v_mfma_f32_16x16x32_bf16 v[60:63], v[200:203], v[28:31], v[60:63]
    v_mfma_f32_16x16x32_bf16 v[64:67], v[204:207], v[28:31], v[64:67]
    v_add_u32 v16, 73728, v42
    v_add_u32 v17, 73728, v43
    v_add_u32 v18, 73728, v44
    s_waitcnt vmcnt(0) lgkmcnt(0)
    s_barrier
    ds_read_b64_tr_b16 v[232:233], v16 offset:0
    ds_read_b64_tr_b16 v[234:235], v16 offset:2048
    ds_read_b64_tr_b16 v[236:237], v17 offset:0
    ds_read_b64_tr_b16 v[238:239], v17 offset:2048
    ds_read_b64_tr_b16 v[240:241], v18 offset:0
    ds_read_b64_tr_b16 v[242:243], v18 offset:2048
    ds_read_b64_tr_b16 v[244:245], v16 offset:4096
    ds_read_b64_tr_b16 v[246:247], v16 offset:6144
    ds_read_b64_tr_b16 v[248:249], v17 offset:4096
    ds_read_b64_tr_b16 v[250:251], v17 offset:6144
    ds_read_b64_tr_b16 v[252:253], v18 offset:4096
    ds_read_b64_tr_b16 v[254:255], v18 offset:6144
    v_mfma_f32_16x16x32_bf16 v[56:59], v[208:211], v[28:31], v[56:59]
    v_mfma_f32_16x16x32_bf16 v[60:63], v[212:215], v[28:31], v[60:63]
    v_mfma_f32_16x16x32_bf16 v[64:67], v[216:219], v[28:31], v[64:67]
    v_mfma_f32_16x16x32_bf16 v[56:59], v[220:223], v[28:31], v[56:59]
    v_mfma_f32_16x16x32_bf16 v[60:63], v[224:227], v[28:31], v[60:63]
    v_mfma_f32_16x16x32_bf16 v[64:67], v[228:231], v[28:31], v[64:67]
    s_waitcnt lgkmcnt(0)
    v_mfma_f32_16x16x32_bf16 v[56:59], v[232:235], v[28:31], v[56:59]
    v_mfma_f32_16x16x32_bf16 v[60:63], v[236:239], v[28:31], v[60:63]
    v_mfma_f32_16x16x32_bf16 v[64:67], v[240:243], v[28:31], v[64:67]
    v_mfma_f32_16x16x32_bf16 v[56:59], v[244:247], v[28:31], v[56:59]
    v_mfma_f32_16x16x32_bf16 v[60:63], v[248:251], v[28:31], v[60:63]
    v_mfma_f32_16x16x32_bf16 v[64:67], v[252:255], v[28:31], v[64:67]
    s_mov_b32 s12, s84
    s_mov_b32 s13, s85
    s_mov_b32 s14, 0x6200000
    s_mov_b32 s15, 0x00020000
    s_barrier
    s_mov_b32 s20, s82
    s_mov_b32 s21, s83
    s_mov_b32 s22, 0x100
    s_mov_b32 s23, 0x00020000
    v_and_b32 v8, 15, v0
    v_lshlrev_b32 v8, 4, v8
    v_mov_b32 v10, 8
    buffer_load_dword v9, v8, s[20:23], 0 offen sc1
    s_waitcnt vmcnt(0)
Lffa_wa:
    v_cmp_gt_u32 vcc, v10, v9
    s_sub_u32 s43, s43, 1
    s_cmp_lt_i32 s43, 0
    s_cbranch_scc1 Lffa_all
    s_cbranch_vccz Lffa_all
    s_sleep 2
    buffer_load_dword v9, v8, s[20:23], 0 offen sc1
    s_waitcnt vmcnt(0)
    s_branch Lffa_wa
Lffa_all:
    s_mov_b32 s14, 0
    s_cmp_lg_u32 s30, 0
    s_cbranch_scc1 Lffa_fok
Lffa_fspin:
    buffer_load_dword v5, v4, s[4:7], s16 offen sc1
    s_waitcnt vmcnt(0)
    v_cmp_gt_i32 vcc, s32, v5
    s_sub_u32 s43, s43, 1
    s_cmp_lt_i32 s43, 0
    s_cbranch_scc1 Lffa_fok
    s_and_b64 vcc, vcc, s[18:19]
    s_cbranch_scc0 Lffa_fok
    s_sleep 8
    s_branch Lffa_fspin
Lffa_fok:
    s_barrier
    s_branch Lffa_rdy1
    .p2align 6
Lffa_body00:
    s_waitcnt lgkmcnt(2)
    v_mfma_f32_16x16x32_bf16 v[8:11], a[0:3], v[40:43], 0
    s_add_u32 m0, s34, 0
    v_fma_f32 v124, v32, v21, v88
    v_fma_f32 v125, v33, v21, v89
    v_mfma_f32_16x16x32_bf16 v[8:11], a[12:15], v[44:47], v[8:11]
    s_add_u32 s31, s31, 1
    v_mov_b32 v6, s31
    v_fma_f32 v126, v34, v21, v90
    v_mfma_f32_16x16x32_bf16 v[12:15], a[16:19], v[44:47], 0
    s_add_u32 s35, s35, 36864
    v_fma_f32 v127, v35, v21, v91
    v_mul_f32 v124, v124, |v124|
    v_mfma_f32_16x16x32_bf16 v[12:15], a[4:7], v[40:43], v[12:15]
    s_cmp_eq_u32 s35, 147456
    s_cselect_b32 s35, 0, s35
    v_mul_f32 v125, v125, |v125|
    v_mfma_f32_16x16x32_bf16 v[16:19], a[8:11], v[40:43], 0
    ds_read_b128 v[40:43], v2 offset:4096
    v_mul_f32 v126, v126, |v126|
    v_mfma_f32_16x16x32_bf16 v[16:19], a[20:23], v[44:47], v[16:19]
    ds_read_b128 v[44:47], v2 offset:5120
    s_waitcnt lgkmcnt(2)
    v_mfma_f32_16x16x32_bf16 v[16:19], a[32:35], v[48:51], v[16:19]
    v_mul_f32 v127, v127, |v127|
    v_cvt_pk_bf16_f32 v124, v124, v125
    v_mfma_f32_16x16x32_bf16 v[16:19], a[44:47], v[52:55], v[16:19]
    v_cvt_pk_bf16_f32 v126, v126, v127
    v_pk_max_i16 v96, v124, 0
    v_mfma_f32_16x16x32_bf16 v[12:15], a[40:43], v[52:55], v[12:15]
    v_pk_max_i16 v97, v126, 0
    v_pk_max_i16 v98, v124, 0
    v_mfma_f32_16x16x32_bf16 v[12:15], a[28:31], v[48:51], v[12:15]
    v_pk_max_i16 v99, v126, 0
    v_fma_f32 v116, v24, v21, v80
    v_mfma_f32_16x16x32_bf16 v[8:11], a[24:27], v[48:51], v[8:11]
    ds_read_b128 v[48:51], v2 offset:6144
    v_fma_f32 v117, v25, v21, v81
    v_mfma_f32_16x16x32_bf16 v[8:11], a[36:39], v[52:55], v[8:11]
    ds_read_b128 v[52:55], v2 offset:7168
    s_waitcnt lgkmcnt(2)
    v_mfma_f32_16x16x32_bf16 v[8:11], a[48:51], v[40:43], v[8:11]
    v_permlane32_swap_b32 v96, v98
    v_mfma_f32_16x16x32_bf16 v[8:11], a[60:63], v[44:47], v[8:11]
    v_permlane32_swap_b32 v97, v99
    v_mfma_f32_16x16x32_bf16 v[12:15], a[64:67], v[44:47], v[12:15]
    buffer_store_dwordx4 v[96:99], v7, s[12:15], s36 offen sc1
    v_fma_f32 v118, v26, v21, v82
    v_mfma_f32_16x16x32_bf16 v[12:15], a[52:55], v[40:43], v[12:15]
    s_waitcnt vmcnt(2)
    v_cmp_gt_i32 vcc, s32, v5
    v_fma_f32 v119, v27, v21, v83
    v_mfma_f32_16x16x32_bf16 v[16:19], a[56:59], v[40:43], v[16:19]
    ds_read_b128 v[40:43], v2 offset:8192
    v_fma_f32 v120, v28, v21, v84
    v_mfma_f32_16x16x32_bf16 v[16:19], a[68:71], v[44:47], v[16:19]
    ds_read_b128 v[44:47], v2 offset:9216
    s_waitcnt lgkmcnt(2)
    v_mfma_f32_16x16x32_bf16 v[16:19], a[80:83], v[48:51], v[16:19]
    s_and_b64 vcc, vcc, s[18:19]
    s_cbranch_scc1 Lffa_v01
    v_mfma_f32_16x16x32_bf16 v[16:19], a[92:95], v[52:55], v[16:19]
    buffer_load_dwordx4 v1, s[8:11], s33 offen offset:0 sc1 lds
    v_mfma_f32_16x16x32_bf16 v[12:15], a[88:91], v[52:55], v[12:15]
    v_fma_f32 v121, v29, v21, v85
    v_fma_f32 v122, v30, v21, v86
    v_mfma_f32_16x16x32_bf16 v[12:15], a[76:79], v[48:51], v[12:15]
    v_fma_f32 v123, v31, v21, v87
    v_mul_f32 v116, v116, |v116|
    v_mfma_f32_16x16x32_bf16 v[8:11], a[72:75], v[48:51], v[8:11]
    ds_read_b128 v[48:51], v2 offset:10240
    v_mul_f32 v117, v117, |v117|
    v_mfma_f32_16x16x32_bf16 v[8:11], a[84:87], v[52:55], v[8:11]
    ds_read_b128 v[52:55], v2 offset:11264
    s_waitcnt lgkmcnt(2)
    v_mfma_f32_16x16x32_bf16 v[8:11], a[96:99], v[40:43], v[8:11]
    buffer_load_dwordx4 v1, s[8:11], s33 offen offset:1024 sc1 lds
    v_mfma_f32_16x16x32_bf16 v[8:11], a[108:111], v[44:47], v[8:11]
    v_mul_f32 v118, v118, |v118|
    v_mul_f32 v119, v119, |v119|
    v_mfma_f32_16x16x32_bf16 v[12:15], a[112:115], v[44:47], v[12:15]
    v_mul_f32 v120, v120, |v120|
    v_mul_f32 v121, v121, |v121|
    v_mfma_f32_16x16x32_bf16 v[12:15], a[100:103], v[40:43], v[12:15]
    buffer_load_dwordx4 v1, s[8:11], s33 offen offset:2048 sc1 lds
    v_mfma_f32_16x16x32_bf16 v[16:19], a[104:107], v[40:43], v[16:19]
    ds_read_b128 v[40:43], v2 offset:12288
    v_mul_f32 v122, v122, |v122|
    v_mfma_f32_16x16x32_bf16 v[16:19], a[116:119], v[44:47], v[16:19]
    ds_read_b128 v[44:47], v2 offset:13312
    s_waitcnt lgkmcnt(2)
    v_mfma_f32_16x16x32_bf16 v[16:19], a[128:131], v[48:51], v[16:19]
    buffer_load_dwordx4 v1, s[8:11], s33 offen offset:3072 sc1 lds
    v_mfma_f32_16x16x32_bf16 v[16:19], a[140:143], v[52:55], v[16:19]
    s_add_u32 m0, s34, s3
    s_add_u32 s37, s33, s3
    v_sub_u32 v100, v2, v20
    v_mfma_f32_16x16x32_bf16 v[12:15], a[136:139], v[52:55], v[12:15]
    ds_read2st64_b64 v[112:115], v100 offset0:70 offset1:71
    v_mul_f32 v123, v123, |v123|
    v_mfma_f32_16x16x32_bf16 v[12:15], a[124:127], v[48:51], v[12:15]
    buffer_load_dwordx4 v1, s[8:11], s37 offen offset:0 sc1 lds
    v_mfma_f32_16x16x32_bf16 v[8:11], a[120:123], v[48:51], v[8:11]
    ds_read_b128 v[48:51], v2 offset:14336
    s_add_u32 s16, s16, 8192
    v_mfma_f32_16x16x32_bf16 v[8:11], a[132:135], v[52:55], v[8:11]
    ds_read_b128 v[52:55], v2 offset:15360
    s_waitcnt lgkmcnt(3)
    v_mfma_f32_16x16x32_bf16 v[8:11], a[144:147], v[40:43], v[8:11]
    s_waitcnt vmcnt(6)
    s_barrier
    v_mfma_f32_16x16x32_bf16 v[8:11], a[156:159], v[44:47], v[8:11]
    s_add_u32 m0, s34, 16384
    s_add_u32 s37, s33, 16384
    v_cvt_pk_bf16_f32 v116, v116, v117
    v_mfma_f32_16x16x32_bf16 v[12:15], a[160:163], v[44:47], v[12:15]
    ds_read2st64_b64 v[108:111], v100 offset0:68 offset1:69
    v_cvt_pk_bf16_f32 v118, v118, v119
    v_mfma_f32_16x16x32_bf16 v[12:15], a[148:151], v[40:43], v[12:15]
    ds_read2st64_b64 v[104:107], v100 offset0:66 offset1:67
    v_cvt_pk_bf16_f32 v120, v120, v121
    v_mfma_f32_16x16x32_bf16 v[16:19], a[152:155], v[40:43], v[16:19]
    ds_read_b128 v[40:43], v2 offset:16384
    v_cvt_pk_bf16_f32 v122, v122, v123
    v_mfma_f32_16x16x32_bf16 v[16:19], a[164:167], v[44:47], v[16:19]
    ds_read_b128 v[44:47], v2 offset:17408
    s_waitcnt lgkmcnt(4)
    v_mfma_f32_16x16x32_bf16 v[16:19], a[176:179], v[48:51], v[16:19]
    ds_read2st64_b64 v[100:103], v100 offset0:64 offset1:65
    v_pk_max_i16 v92, v116, 0
    v_mfma_f32_16x16x32_bf16 v[16:19], a[188:191], v[52:55], v[16:19]
    v_pk_max_i16 v93, v118, 0
    v_pk_max_i16 v94, v120, 0
    v_mfma_f32_16x16x32_bf16 v[12:15], a[184:187], v[52:55], v[12:15]
    v_pk_max_i16 v95, v122, 0
    v_add_u32 v3, s35, v1
    v_mfma_f32_16x16x32_bf16 v[12:15], a[172:175], v[48:51], v[12:15]
    buffer_store_dwordx4 v[92:95], v1, s[12:15], s36 offen sc1
    s_add_u32 s36, s36, 116736
    v_mfma_f32_16x16x32_bf16 v[8:11], a[168:171], v[48:51], v[8:11]
    ds_read_b128 v[48:51], v2 offset:18432
    v_mfma_f32_16x16x32_bf16 v[8:11], a[180:183], v[52:55], v[8:11]
    ds_read_b128 v[52:55], v2 offset:19456
    s_waitcnt lgkmcnt(3)
    v_mfma_f32_16x16x32_bf16 v[8:11], a[192:195], v[40:43], v[8:11]
    buffer_load_dwordx4 v1, s[8:11], s37 offen offset:0 sc1 lds
    v_mfma_f32_16x16x32_bf16 v[8:11], a[204:207], v[44:47], v[8:11]
    s_waitcnt lgkmcnt(2)
    v_add_f32 v100, v100, v108
    v_add_f32 v101, v101, v109
    v_mfma_f32_16x16x32_bf16 v[12:15], a[208:211], v[44:47], v[12:15]
    v_add_f32 v102, v102, v110
    v_add_f32 v103, v103, v111
    v_mfma_f32_16x16x32_bf16 v[12:15], a[196:199], v[40:43], v[12:15]
    buffer_load_dwordx4 v1, s[8:11], s37 offen offset:1024 sc1 lds
    v_mfma_f32_16x16x32_bf16 v[16:19], a[200:203], v[40:43], v[16:19]
    ds_read_b128 v[40:43], v2 offset:20480
    v_add_f32 v104, v104, v112
    v_mfma_f32_16x16x32_bf16 v[16:19], a[212:215], v[44:47], v[16:19]
    ds_read_b128 v[44:47], v2 offset:21504
    s_waitcnt lgkmcnt(2)
    v_mfma_f32_16x16x32_bf16 v[16:19], a[224:227], v[48:51], v[16:19]
    buffer_load_dwordx4 v1, s[8:11], s37 offen offset:2048 sc1 lds
    v_mfma_f32_16x16x32_bf16 v[16:19], a[236:239], v[52:55], v[16:19]
    v_add_f32 v105, v105, v113
    v_add_f32 v106, v106, v114
    v_mfma_f32_16x16x32_bf16 v[12:15], a[232:235], v[52:55], v[12:15]
    v_add_f32 v107, v107, v115
    v_add_f32 v100, v100, v104
    v_mfma_f32_16x16x32_bf16 v[12:15], a[220:223], v[48:51], v[12:15]
    buffer_load_dwordx4 v1, s[8:11], s37 offen offset:3072 sc1 lds
    v_mfma_f32_16x16x32_bf16 v[8:11], a[216:219], v[48:51], v[8:11]
    ds_read_b128 v[48:51], v2 offset:22528
    s_add_u32 s32, s32, 1
    v_mfma_f32_16x16x32_bf16 v[8:11], a[228:231], v[52:55], v[8:11]
    ds_read_b128 v[52:55], v2 offset:23552
    s_waitcnt lgkmcnt(2)
    v_mfma_f32_16x16x32_bf16 v[8:11], a[240:243], v[40:43], v[8:11]
    s_add_u32 s33, s33, 36864
    s_add_u32 s34, s34, 36864
    v_add_f32 v101, v101, v105
    v_mfma_f32_16x16x32_bf16 v[8:11], a[252:255], v[44:47], v[8:11]
    s_cmp_ge_u32 s34, 147456
    s_cselect_b32 s38, 147456, 0
    s_sub_u32 s34, s34, s38
    v_mfma_f32_16x16x32_bf16 v[12:15], v[128:131], v[44:47], v[12:15]
    v_add_f32 v102, v102, v106
    v_add_f32 v103, v103, v107
    v_mfma_f32_16x16x32_bf16 v[12:15], a[244:247], v[40:43], v[12:15]
    v_add_f32 v100, v100, v102
    v_add_f32 v101, v101, v103
    v_mfma_f32_16x16x32_bf16 v[16:19], a[248:251], v[40:43], v[16:19]
    ds_read_b128 v[40:43], v2 offset:24576
    v_mfma_f32_16x16x32_bf16 v[16:19], v[132:135], v[44:47], v[16:19]
    ds_read_b128 v[44:47], v2 offset:25600
    s_waitcnt lgkmcnt(2)
    v_mfma_f32_16x16x32_bf16 v[16:19], v[144:147], v[48:51], v[16:19]
    buffer_load_dword v5, v4, s[4:7], s16 offen sc1
    v_mfma_f32_16x16x32_bf16 v[16:19], v[156:159], v[52:55], v[16:19]
    v_permlane16_swap_b32 v100, v101
    v_mfma_f32_16x16x32_bf16 v[12:15], v[152:155], v[52:55], v[12:15]
    v_add_f32 v100, v100, v101
    v_mov_b32 v101, v100
    v_mfma_f32_16x16x32_bf16 v[12:15], v[140:143], v[48:51], v[12:15]
    s_nop 0
    v_permlane32_swap_b32 v100, v101
    v_mfma_f32_16x16x32_bf16 v[8:11], v[136:139], v[48:51], v[8:11]
    ds_read_b128 v[48:51], v2 offset:26624
    v_add_f32 v100, v100, v101
    v_mfma_f32_16x16x32_bf16 v[8:11], v[148:151], v[52:55], v[8:11]
    ds_read_b128 v[52:55], v2 offset:27648
    s_waitcnt lgkmcnt(2)
    v_mfma_f32_16x16x32_bf16 v[8:11], v[160:163], v[40:43], v[8:11]
    v_mul_f32 v100, 0x3a800000, v100
    v_mov_b32 v101, v100
    v_mfma_f32_16x16x32_bf16 v[8:11], v[172:175], v[44:47], v[8:11]
    s_nop 0
    v_permlane16_swap_b32 v100, v101
    v_mfma_f32_16x16x32_bf16 v[12:15], v[176:179], v[44:47], v[12:15]
    v_fma_f32 v101, -v100, v100, v101
    v_max_f32 v101, 0, v101
    v_mfma_f32_16x16x32_bf16 v[12:15], v[164:167], v[40:43], v[12:15]
    v_add_f32 v101, 0x3727c5ac, v101
    v_mfma_f32_16x16x32_bf16 v[16:19], v[168:171], v[40:43], v[16:19]
    ds_read_b128 v[40:43], v2 offset:28672
    v_mfma_f32_16x16x32_bf16 v[16:19], v[180:183], v[44:47], v[16:19]
    ds_read_b128 v[44:47], v2 offset:29696
    s_waitcnt lgkmcnt(2)
    v_mfma_f32_16x16x32_bf16 v[16:19], v[192:195], v[48:51], v[16:19]
    v_rsq_f32 v21, v101
    v_mfma_f32_16x16x32_bf16 v[16:19], v[204:207], v[52:55], v[16:19]
    v_mul_f32 v100, v100, v21
    v_fma_f32 v80, -v100, v56, v68
    v_mfma_f32_16x16x32_bf16 v[12:15], v[200:203], v[52:55], v[12:15]
    v_fma_f32 v81, -v100, v57, v69
    v_fma_f32 v82, -v100, v58, v70
    v_mfma_f32_16x16x32_bf16 v[12:15], v[188:191], v[48:51], v[12:15]
    v_fma_f32 v83, -v100, v59, v71
    v_fma_f32 v84, -v100, v60, v72
    v_mfma_f32_16x16x32_bf16 v[8:11], v[184:187], v[48:51], v[8:11]
    ds_read_b128 v[48:51], v2 offset:30720
    v_fma_f32 v85, -v100, v61, v73
    v_mfma_f32_16x16x32_bf16 v[8:11], v[196:199], v[52:55], v[8:11]
    ds_read_b128 v[52:55], v2 offset:31744
    s_waitcnt lgkmcnt(2)
    v_mfma_f32_16x16x32_bf16 v[8:11], v[208:211], v[40:43], v[8:11]
    s_waitcnt vmcnt(6)
    s_barrier
    v_mfma_f32_16x16x32_bf16 v[8:11], v[220:223], v[44:47], v[8:11]
    v_fma_f32 v86, -v100, v62, v74
    v_fma_f32 v87, -v100, v63, v75
    v_mfma_f32_16x16x32_bf16 v[12:15], v[224:227], v[44:47], v[12:15]
    v_fma_f32 v88, -v100, v64, v76
    v_fma_f32 v89, -v100, v65, v77
    v_mfma_f32_16x16x32_bf16 v[12:15], v[212:215], v[40:43], v[12:15]
    s_waitcnt vmcnt(5)
    buffer_store_dword v6, v22, s[12:15], s17 offen sc1
    v_mfma_f32_16x16x32_bf16 v[16:19], v[216:219], v[40:43], v[16:19]
    ds_read_b128 v[40:43], v3 offset:0
    v_fma_f32 v90, -v100, v66, v78
    v_mfma_f32_16x16x32_bf16 v[16:19], v[228:231], v[44:47], v[16:19]
    ds_read_b128 v[44:47], v3 offset:1024
    s_waitcnt lgkmcnt(2)
    v_mfma_f32_16x16x32_bf16 v[16:19], v[240:243], v[48:51], v[16:19]
    s_mov_b32 s14, s6
    v_fma_f32 v91, -v100, v67, v79
    s_add_u32 s17, s17, 8192
    v_mfma_f32_16x16x32_bf16 v[16:19], v[252:255], v[52:55], v[16:19]
    v_mfma_f32_16x16x32_bf16 v[12:15], v[248:251], v[52:55], v[12:15]
    v_mfma_f32_16x16x32_bf16 v[12:15], v[236:239], v[48:51], v[12:15]
    v_mfma_f32_16x16x32_bf16 v[8:11], v[232:235], v[48:51], v[8:11]
    ds_read_b128 v[48:51], v3 offset:2048
    v_mfma_f32_16x16x32_bf16 v[8:11], v[244:247], v[52:55], v[8:11]
    ds_read_b128 v[52:55], v3 offset:3072
Lffa_body10:
    s_waitcnt lgkmcnt(2)
    v_mfma_f32_16x16x32_bf16 v[24:27], a[0:3], v[40:43], 0
    s_add_u32 m0, s34, 0
    v_fma_f32 v124, v16, v21, v88
    v_fma_f32 v125, v17, v21, v89
    v_mfma_f32_16x16x32_bf16 v[24:27], a[12:15], v[44:47], v[24:27]
    s_add_u32 s31, s31, 1
    v_mov_b32 v6, s31
    v_fma_f32 v126, v18, v21, v90
    v_mfma_f32_16x16x32_bf16 v[28:31], a[16:19], v[44:47], 0
    s_add_u32 s35, s35, 36864
    v_fma_f32 v127, v19, v21, v91
    v_mul_f32 v124, v124, |v124|
    v_mfma_f32_16x16x32_bf16 v[28:31], a[4:7], v[40:43], v[28:31]
    s_cmp_eq_u32 s35, 147456
    s_cselect_b32 s35, 0, s35
    v_mul_f32 v125, v125, |v125|
    v_mfma_f32_16x16x32_bf16 v[32:35], a[8:11], v[40:43], 0
    ds_read_b128 v[40:43], v3 offset:4096
    v_mul_f32 v126, v126, |v126|
    v_mfma_f32_16x16x32_bf16 v[32:35], a[20:23], v[44:47], v[32:35]
    ds_read_b128 v[44:47], v3 offset:5120
    s_waitcnt lgkmcnt(2)
    v_mfma_f32_16x16x32_bf16 v[32:35], a[32:35], v[48:51], v[32:35]
    v_mul_f32 v127, v127, |v127|
    v_cvt_pk_bf16_f32 v124, v124, v125
    v_mfma_f32_16x16x32_bf16 v[32:35], a[44:47], v[52:55], v[32:35]
    v_cvt_pk_bf16_f32 v126, v126, v127
    v_pk_max_i16 v96, v124, 0
    v_mfma_f32_16x16x32_bf16 v[28:31], a[40:43], v[52:55], v[28:31]
    v_pk_max_i16 v97, v126, 0
    v_pk_max_i16 v98, v124, 0
    v_mfma_f32_16x16x32_bf16 v[28:31], a[28:31], v[48:51], v[28:31]
    v_pk_max_i16 v99, v126, 0
    v_fma_f32 v116, v8, v21, v80
    v_mfma_f32_16x16x32_bf16 v[24:27], a[24:27], v[48:51], v[24:27]
    ds_read_b128 v[48:51], v3 offset:6144
    v_fma_f32 v117, v9, v21, v81
    v_mfma_f32_16x16x32_bf16 v[24:27], a[36:39], v[52:55], v[24:27]
    ds_read_b128 v[52:55], v3 offset:7168
    s_waitcnt lgkmcnt(2)
    v_mfma_f32_16x16x32_bf16 v[24:27], a[48:51], v[40:43], v[24:27]
    v_permlane32_swap_b32 v96, v98
    v_mfma_f32_16x16x32_bf16 v[24:27], a[60:63], v[44:47], v[24:27]
    v_permlane32_swap_b32 v97, v99
    v_mfma_f32_16x16x32_bf16 v[28:31], a[64:67], v[44:47], v[28:31]
    buffer_store_dwordx4 v[96:99], v7, s[12:15], s36 offen sc1
    v_fma_f32 v118, v10, v21, v82
    v_mfma_f32_16x16x32_bf16 v[28:31], a[52:55], v[40:43], v[28:31]
    s_waitcnt vmcnt(2)
    v_cmp_gt_i32 vcc, s32, v5
    v_fma_f32 v119, v11, v21, v83
    v_mfma_f32_16x16x32_bf16 v[32:35], a[56:59], v[40:43], v[32:35]
    ds_read_b128 v[40:43], v3 offset:8192
    v_fma_f32 v120, v12, v21, v84
    v_mfma_f32_16x16x32_bf16 v[32:35], a[68:71], v[44:47], v[32:35]
    ds_read_b128 v[44:47], v3 offset:9216
    s_waitcnt lgkmcnt(2)
    v_mfma_f32_16x16x32_bf16 v[32:35], a[80:83], v[48:51], v[32:35]
    s_and_b64 vcc, vcc, s[18:19]
    s_cbranch_scc1 Lffa_v11
    v_mfma_f32_16x16x32_bf16 v[32:35], a[92:95], v[52:55], v[32:35]
    buffer_load_dwordx4 v1, s[8:11], s33 offen offset:0 sc1 lds
    v_mfma_f32_16x16x32_bf16 v[28:31], a[88:91], v[52:55], v[28:31]
    v_fma_f32 v121, v13, v21, v85
    v_fma_f32 v122, v14, v21, v86
    v_mfma_f32_16x16x32_bf16 v[28:31], a[76:79], v[48:51], v[28:31]
    v_fma_f32 v123, v15, v21, v87
    v_mul_f32 v116, v116, |v116|
    v_mfma_f32_16x16x32_bf16 v[24:27], a[72:75], v[48:51], v[24:27]
    ds_read_b128 v[48:51], v3 offset:10240
    v_mul_f32 v117, v117, |v117|
    v_mfma_f32_16x16x32_bf16 v[24:27], a[84:87], v[52:55], v[24:27]
    ds_read_b128 v[52:55], v3 offset:11264
    s_waitcnt lgkmcnt(2)
    v_mfma_f32_16x16x32_bf16 v[24:27], a[96:99], v[40:43], v[24:27]
    buffer_load_dwordx4 v1, s[8:11], s33 offen offset:1024 sc1 lds
    v_mfma_f32_16x16x32_bf16 v[24:27], a[108:111], v[44:47], v[24:27]
    v_mul_f32 v118, v118, |v118|
    v_mul_f32 v119, v119, |v119|
    v_mfma_f32_16x16x32_bf16 v[28:31], a[112:115], v[44:47], v[28:31]
    v_mul_f32 v120, v120, |v120|
    v_mul_f32 v121, v121, |v121|
    v_mfma_f32_16x16x32_bf16 v[28:31], a[100:103], v[40:43], v[28:31]
    buffer_load_dwordx4 v1, s[8:11], s33 offen offset:2048 sc1 lds
    v_mfma_f32_16x16x32_bf16 v[32:35], a[104:107], v[40:43], v[32:35]
    ds_read_b128 v[40:43], v3 offset:12288
    v_mul_f32 v122, v122, |v122|
    v_mfma_f32_16x16x32_bf16 v[32:35], a[116:119], v[44:47], v[32:35]
    ds_read_b128 v[44:47], v3 offset:13312
    s_waitcnt lgkmcnt(2)
    v_mfma_f32_16x16x32_bf16 v[32:35], a[128:131], v[48:51], v[32:35]
    buffer_load_dwordx4 v1, s[8:11], s33 offen offset:3072 sc1 lds
    v_mfma_f32_16x16x32_bf16 v[32:35], a[140:143], v[52:55], v[32:35]
    s_add_u32 m0, s34, s3
    s_add_u32 s37, s33, s3
    v_sub_u32 v100, v3, v20
    v_mfma_f32_16x16x32_bf16 v[28:31], a[136:139], v[52:55], v[28:31]
    ds_read2st64_b64 v[112:115], v100 offset0:70 offset1:71
    v_mul_f32 v123, v123, |v123|
    v_mfma_f32_16x16x32_bf16 v[28:31], a[124:127], v[48:51], v[28:31]
    buffer_load_dwordx4 v1, s[8:11], s37 offen offset:0 sc1 lds
    v_mfma_f32_16x16x32_bf16 v[24:27], a[120:123], v[48:51], v[24:27]
    ds_read_b128 v[48:51], v3 offset:14336
    s_add_u32 s16, s16, 8192
    v_mfma_f32_16x16x32_bf16 v[24:27], a[132:135], v[52:55], v[24:27]
    ds_read_b128 v[52:55], v3 offset:15360
    s_waitcnt lgkmcnt(3)
    v_mfma_f32_16x16x32_bf16 v[24:27], a[144:147], v[40:43], v[24:27]
    s_waitcnt vmcnt(6)
    s_barrier
    v_mfma_f32_16x16x32_bf16 v[24:27], a[156:159], v[44:47], v[24:27]
    s_add_u32 m0, s34, 16384
    s_add_u32 s37, s33, 16384
    v_cvt_pk_bf16_f32 v116, v116, v117
    v_mfma_f32_16x16x32_bf16 v[28:31], a[160:163], v[44:47], v[28:31]
    ds_read2st64_b64 v[108:111], v100 offset0:68 offset1:69
    v_cvt_pk_bf16_f32 v118, v118, v119
    v_mfma_f32_16x16x32_bf16 v[28:31], a[148:151], v[40:43], v[28:31]
    ds_read2st64_b64 v[104:107], v100 offset0:66 offset1:67
    v_cvt_pk_bf16_f32 v120, v120, v121
    v_mfma_f32_16x16x32_bf16 v[32:35], a[152:155], v[40:43], v[32:35]
    ds_read_b128 v[40:43], v3 offset:16384
    v_cvt_pk_bf16_f32 v122, v122, v123
    v_mfma_f32_16x16x32_bf16 v[32:35], a[164:167], v[44:47], v[32:35]
    ds_read_b128 v[44:47], v3 offset:17408
    s_waitcnt lgkmcnt(4)
    v_mfma_f32_16x16x32_bf16 v[32:35], a[176:179], v[48:51], v[32:35]
    ds_read2st64_b64 v[100:103], v100 offset0:64 offset1:65
    v_pk_max_i16 v92, v116, 0
    v_mfma_f32_16x16x32_bf16 v[32:35], a[188:191], v[52:55], v[32:35]
    v_pk_max_i16 v93, v118, 0
    v_pk_max_i16 v94, v120, 0
    v_mfma_f32_16x16x32_bf16 v[28:31], a[184:187], v[52:55], v[28:31]
    v_pk_max_i16 v95, v122, 0
    v_add_u32 v2, s35, v1
    v_mfma_f32_16x16x32_bf16 v[28:31], a[172:175], v[48:51], v[28:31]
    buffer_store_dwordx4 v[92:95], v1, s[12:15], s36 offen sc1
    s_add_u32 s36, s36, 116736
    v_mfma_f32_16x16x32_bf16 v[24:27], a[168:171], v[48:51], v[24:27]
    ds_read_b128 v[48:51], v3 offset:18432
    v_mfma_f32_16x16x32_bf16 v[24:27], a[180:183], v[52:55], v[24:27]
    ds_read_b128 v[52:55], v3 offset:19456
    s_waitcnt lgkmcnt(3)
    v_mfma_f32_16x16x32_bf16 v[24:27], a[192:195], v[40:43], v[24:27]
    buffer_load_dwordx4 v1, s[8:11], s37 offen offset:0 sc1 lds
    v_mfma_f32_16x16x32_bf16 v[24:27], a[204:207], v[44:47], v[24:27]
    s_waitcnt lgkmcnt(2)
    v_add_f32 v100, v100, v108
    v_add_f32 v101, v101, v109
    v_mfma_f32_16x16x32_bf16 v[28:31], a[208:211], v[44:47], v[28:31]
    v_add_f32 v102, v102, v110
    v_add_f32 v103, v103, v111
    v_mfma_f32_16x16x32_bf16 v[28:31], a[196:199], v[40:43], v[28:31]
    buffer_load_dwordx4 v1, s[8:11], s37 offen offset:1024 sc1 lds
    v_mfma_f32_16x16x32_bf16 v[32:35], a[200:203], v[40:43], v[32:35]
    ds_read_b128 v[40:43], v3 offset:20480
    v_add_f32 v104, v104, v112
    v_mfma_f32_16x16x32_bf16 v[32:35], a[212:215], v[44:47], v[32:35]
    ds_read_b128 v[44:47], v3 offset:21504
    s_waitcnt lgkmcnt(2)
    v_mfma_f32_16x16x32_bf16 v[32:35], a[224:227], v[48:51], v[32:35]
    buffer_load_dwordx4 v1, s[8:11], s37 offen offset:2048 sc1 lds
    v_mfma_f32_16x16x32_bf16 v[32:35], a[236:239], v[52:55], v[32:35]
    v_add_f32 v105, v105, v113
    v_add_f32 v106, v106, v114
    v_mfma_f32_16x16x32_bf16 v[28:31], a[232:235], v[52:55], v[28:31]
    v_add_f32 v107, v107, v115
    v_add_f32 v100, v100, v104
    v_mfma_f32_16x16x32_bf16 v[28:31], a[220:223], v[48:51], v[28:31]
    buffer_load_dwordx4 v1, s[8:11], s37 offen offset:3072 sc1 lds
    v_mfma_f32_16x16x32_bf16 v[24:27], a[216:219], v[48:51], v[24:27]
    ds_read_b128 v[48:51], v3 offset:22528
    s_add_u32 s32, s32, 1
    v_mfma_f32_16x16x32_bf16 v[24:27], a[228:231], v[52:55], v[24:27]
    ds_read_b128 v[52:55], v3 offset:23552
    s_waitcnt lgkmcnt(2)
    v_mfma_f32_16x16x32_bf16 v[24:27], a[240:243], v[40:43], v[24:27]
    s_add_u32 s33, s33, 36864
    s_add_u32 s34, s34, 36864
    v_add_f32 v101, v101, v105
    v_mfma_f32_16x16x32_bf16 v[24:27], a[252:255], v[44:47], v[24:27]
    s_cmp_ge_u32 s34, 147456
    s_cselect_b32 s38, 147456, 0
    s_sub_u32 s34, s34, s38
    v_mfma_f32_16x16x32_bf16 v[28:31], v[128:131], v[44:47], v[28:31]
    v_add_f32 v102, v102, v106
    v_add_f32 v103, v103, v107
    v_mfma_f32_16x16x32_bf16 v[28:31], a[244:247], v[40:43], v[28:31]
    v_add_f32 v100, v100, v102
    v_add_f32 v101, v101, v103
    v_mfma_f32_16x16x32_bf16 v[32:35], a[248:251], v[40:43], v[32:35]
    ds_read_b128 v[40:43], v3 offset:24576
    v_mfma_f32_16x16x32_bf16 v[32:35], v[132:135], v[44:47], v[32:35]
    ds_read_b128 v[44:47], v3 offset:25600
    s_waitcnt lgkmcnt(2)
    v_mfma_f32_16x16x32_bf16 v[32:35], v[144:147], v[48:51], v[32:35]
    buffer_load_dword v5, v4, s[4:7], s16 offen sc1
    v_mfma_f32_16x16x32_bf16 v[32:35], v[156:159], v[52:55], v[32:35]
    v_permlane16_swap_b32 v100, v101
    v_mfma_f32_16x16x32_bf16 v[28:31], v[152:155], v[52:55], v[28:31]
    v_add_f32 v100, v100, v101
    v_mov_b32 v101, v100
    v_mfma_f32_16x16x32_bf16 v[28:31], v[140:143], v[48:51], v[28:31]
    s_nop 0
    v_permlane32_swap_b32 v100, v101
    v_mfma_f32_16x16x32_bf16 v[24:27], v[136:139], v[48:51], v[24:27]
    ds_read_b128 v[48:51], v3 offset:26624
    v_add_f32 v100, v100, v101
    v_mfma_f32_16x16x32_bf16 v[24:27], v[148:151], v[52:55], v[24:27]
    ds_read_b128 v[52:55], v3 offset:27648
    s_waitcnt lgkmcnt(2)
    v_mfma_f32_16x16x32_bf16 v[24:27], v[160:163], v[40:43], v[24:27]
    v_mul_f32 v100, 0x3a800000, v100
    v_mov_b32 v101, v100
    v_mfma_f32_16x16x32_bf16 v[24:27], v[172:175], v[44:47], v[24:27]
    s_nop 0
    v_permlane16_swap_b32 v100, v101
    v_mfma_f32_16x16x32_bf16 v[28:31], v[176:179], v[44:47], v[28:31]
    v_fma_f32 v101, -v100, v100, v101
    v_max_f32 v101, 0, v101
    v_mfma_f32_16x16x32_bf16 v[28:31], v[164:167], v[40:43], v[28:31]
    v_add_f32 v101, 0x3727c5ac, v101
    v_mfma_f32_16x16x32_bf16 v[32:35], v[168:171], v[40:43], v[32:35]
    ds_read_b128 v[40:43], v3 offset:28672
    v_mfma_f32_16x16x32_bf16 v[32:35], v[180:183], v[44:47], v[32:35]
    ds_read_b128 v[44:47], v3 offset:29696
    s_waitcnt lgkmcnt(2)
    v_mfma_f32_16x16x32_bf16 v[32:35], v[192:195], v[48:51], v[32:35]
    v_rsq_f32 v21, v101
    v_mfma_f32_16x16x32_bf16 v[32:35], v[204:207], v[52:55], v[32:35]
    v_mul_f32 v100, v100, v21
    v_fma_f32 v80, -v100, v56, v68
    v_mfma_f32_16x16x32_bf16 v[28:31], v[200:203], v[52:55], v[28:31]
    v_fma_f32 v81, -v100, v57, v69
    v_fma_f32 v82, -v100, v58, v70
    v_mfma_f32_16x16x32_bf16 v[28:31], v[188:191], v[48:51], v[28:31]
    v_fma_f32 v83, -v100, v59, v71
    v_fma_f32 v84, -v100, v60, v72
    v_mfma_f32_16x16x32_bf16 v[24:27], v[184:187], v[48:51], v[24:27]
    ds_read_b128 v[48:51], v3 offset:30720
    v_fma_f32 v85, -v100, v61, v73
    v_mfma_f32_16x16x32_bf16 v[24:27], v[196:199], v[52:55], v[24:27]
    ds_read_b128 v[52:55], v3 offset:31744
    s_waitcnt lgkmcnt(2)
    v_mfma_f32_16x16x32_bf16 v[24:27], v[208:211], v[40:43], v[24:27]
    s_waitcnt vmcnt(6)
    s_barrier
    v_mfma_f32_16x16x32_bf16 v[24:27], v[220:223], v[44:47], v[24:27]
    v_fma_f32 v86, -v100, v62, v74
    v_fma_f32 v87, -v100, v63, v75
    v_mfma_f32_16x16x32_bf16 v[28:31], v[224:227], v[44:47], v[28:31]
    v_fma_f32 v88, -v100, v64, v76
    v_fma_f32 v89, -v100, v65, v77
    v_mfma_f32_16x16x32_bf16 v[28:31], v[212:215], v[40:43], v[28:31]
    s_waitcnt vmcnt(5)
    buffer_store_dword v6, v22, s[12:15], s17 offen sc1
    v_mfma_f32_16x16x32_bf16 v[32:35], v[216:219], v[40:43], v[32:35]
    ds_read_b128 v[40:43], v2 offset:0
    v_fma_f32 v90, -v100, v66, v78
    v_mfma_f32_16x16x32_bf16 v[32:35], v[228:231], v[44:47], v[32:35]
    ds_read_b128 v[44:47], v2 offset:1024
    s_waitcnt lgkmcnt(2)
    v_mfma_f32_16x16x32_bf16 v[32:35], v[240:243], v[48:51], v[32:35]
    s_mov_b32 s14, s6
    v_fma_f32 v91, -v100, v67, v79
    s_add_u32 s17, s17, 8192
    v_mfma_f32_16x16x32_bf16 v[32:35], v[252:255], v[52:55], v[32:35]
    v_mfma_f32_16x16x32_bf16 v[28:31], v[248:251], v[52:55], v[28:31]
    v_mfma_f32_16x16x32_bf16 v[28:31], v[236:239], v[48:51], v[28:31]
    v_mfma_f32_16x16x32_bf16 v[24:27], v[232:235], v[48:51], v[24:27]
    ds_read_b128 v[48:51], v2 offset:2048
    v_mfma_f32_16x16x32_bf16 v[24:27], v[244:247], v[52:55], v[24:27]
    ds_read_b128 v[52:55], v2 offset:3072
    s_cmp_lt_i32 s31, 63
    s_cbranch_scc1 Lffa_body00
    s_branch L_exit
    .p2align 6
Lffa_body01:
    s_waitcnt lgkmcnt(2)
    v_mfma_f32_16x16x32_bf16 v[8:11], a[0:3], v[40:43], 0
    s_add_u32 m0, s34, 0
    v_fma_f32 v124, v32, v21, v88
    v_fma_f32 v125, v33, v21, v89
    v_mfma_f32_16x16x32_bf16 v[8:11], a[12:15], v[44:47], v[8:11]
    s_add_u32 s31, s31, 1
    v_mov_b32 v6, s31
    v_fma_f32 v126, v34, v21, v90
    v_mfma_f32_16x16x32_bf16 v[12:15], a[16:19], v[44:47], 0
    s_add_u32 s35, s35, 36864
    v_fma_f32 v127, v35, v21, v91
    v_mul_f32 v124, v124, |v124|
    v_mfma_f32_16x16x32_bf16 v[12:15], a[4:7], v[40:43], v[12:15]
    s_cmp_eq_u32 s35, 147456
    s_cselect_b32 s35, 0, s35
    v_mul_f32 v125, v125, |v125|
    v_mfma_f32_16x16x32_bf16 v[16:19], a[8:11], v[40:43], 0
    ds_read_b128 v[40:43], v2 offset:4096
    v_mul_f32 v126, v126, |v126|
    v_mfma_f32_16x16x32_bf16 v[16:19], a[20:23], v[44:47], v[16:19]
    ds_read_b128 v[44:47], v2 offset:5120
    s_waitcnt lgkmcnt(2)
    v_mfma_f32_16x16x32_bf16 v[16:19], a[32:35], v[48:51], v[16:19]
    v_mul_f32 v127, v127, |v127|
    v_cvt_pk_bf16_f32 v124, v124, v125
    v_mfma_f32_16x16x32_bf16 v[16:19], a[44:47], v[52:55], v[16:19]
    v_cvt_pk_bf16_f32 v126, v126, v127
    v_pk_max_i16 v96, v124, 0
    v_mfma_f32_16x16x32_bf16 v[12:15], a[40:43], v[52:55], v[12:15]
    v_pk_max_i16 v97, v126, 0
    v_pk_max_i16 v98, v124, 0
    v_mfma_f32_16x16x32_bf16 v[12:15], a[28:31], v[48:51], v[12:15]
    v_pk_max_i16 v99, v126, 0
    v_fma_f32 v116, v24, v21, v80
    v_mfma_f32_16x16x32_bf16 v[8:11], a[24:27], v[48:51], v[8:11]
    ds_read_b128 v[48:51], v2 offset:6144
    v_fma_f32 v117, v25, v21, v81
    v_mfma_f32_16x16x32_bf16 v[8:11], a[36:39], v[52:55], v[8:11]
    ds_read_b128 v[52:55], v2 offset:7168
    s_waitcnt lgkmcnt(2)
    v_mfma_f32_16x16x32_bf16 v[8:11], a[48:51], v[40:43], v[8:11]
    v_permlane32_swap_b32 v96, v98
    v_mfma_f32_16x16x32_bf16 v[8:11], a[60:63], v[44:47], v[8:11]
    v_permlane32_swap_b32 v97, v99
    v_mfma_f32_16x16x32_bf16 v[12:15], a[64:67], v[44:47], v[12:15]
    buffer_store_dwordx4 v[96:99], v7, s[12:15], s36 offen sc1
    v_fma_f32 v118, v26, v21, v82
    v_mfma_f32_16x16x32_bf16 v[12:15], a[52:55], v[40:43], v[12:15]
    s_waitcnt vmcnt(2)
    v_cmp_gt_i32 vcc, s32, v5
    v_fma_f32 v119, v27, v21, v83
    v_mfma_f32_16x16x32_bf16 v[16:19], a[56:59], v[40:43], v[16:19]
    ds_read_b128 v[40:43], v2 offset:8192
    v_fma_f32 v120, v28, v21, v84
    v_mfma_f32_16x16x32_bf16 v[16:19], a[68:71], v[44:47], v[16:19]
    ds_read_b128 v[44:47], v2 offset:9216
    s_waitcnt lgkmcnt(2)
    v_mfma_f32_16x16x32_bf16 v[16:19], a[80:83], v[48:51], v[16:19]
    s_and_b64 vcc, vcc, s[18:19]
    s_cbranch_scc1 Lffa_v01
    v_mfma_f32_16x16x32_bf16 v[16:19], a[92:95], v[52:55], v[16:19]
    buffer_load_dwordx4 v1, s[8:11], s33 offen offset:0 sc1 lds
    v_mfma_f32_16x16x32_bf16 v[12:15], a[88:91], v[52:55], v[12:15]
    v_fma_f32 v121, v29, v21, v85
    v_fma_f32 v122, v30, v21, v86
    v_mfma_f32_16x16x32_bf16 v[12:15], a[76:79], v[48:51], v[12:15]
    v_fma_f32 v123, v31, v21, v87
    v_mul_f32 v116, v116, |v116|
    v_mfma_f32_16x16x32_bf16 v[8:11], a[72:75], v[48:51], v[8:11]
    ds_read_b128 v[48:51], v2 offset:10240
    v_mul_f32 v117, v117, |v117|
    v_mfma_f32_16x16x32_bf16 v[8:11], a[84:87], v[52:55], v[8:11]
    ds_read_b128 v[52:55], v2 offset:11264
    s_waitcnt lgkmcnt(2)
    v_mfma_f32_16x16x32_bf16 v[8:11], a[96:99], v[40:43], v[8:11]
    buffer_load_dwordx4 v1, s[8:11], s33 offen offset:1024 sc1 lds
    v_mfma_f32_16x16x32_bf16 v[8:11], a[108:111], v[44:47], v[8:11]
    v_mul_f32 v118, v118, |v118|
    v_mul_f32 v119, v119, |v119|
    v_mfma_f32_16x16x32_bf16 v[12:15], a[112:115], v[44:47], v[12:15]
    v_mul_f32 v120, v120, |v120|
    v_mul_f32 v121, v121, |v121|
    v_mfma_f32_16x16x32_bf16 v[12:15], a[100:103], v[40:43], v[12:15]
    buffer_load_dwordx4 v1, s[8:11], s33 offen offset:2048 sc1 lds
    v_mfma_f32_16x16x32_bf16 v[16:19], a[104:107], v[40:43], v[16:19]
    ds_read_b128 v[40:43], v2 offset:12288
    v_mul_f32 v122, v122, |v122|
    v_mfma_f32_16x16x32_bf16 v[16:19], a[116:119], v[44:47], v[16:19]
    ds_read_b128 v[44:47], v2 offset:13312
    s_waitcnt lgkmcnt(2)
    v_mfma_f32_16x16x32_bf16 v[16:19], a[128:131], v[48:51], v[16:19]
    buffer_load_dwordx4 v1, s[8:11], s33 offen offset:3072 sc1 lds
    v_mfma_f32_16x16x32_bf16 v[16:19], a[140:143], v[52:55], v[16:19]
    s_add_u32 m0, s34, s3
    s_add_u32 s37, s33, s3
    v_sub_u32 v100, v2, v20
    v_mfma_f32_16x16x32_bf16 v[12:15], a[136:139], v[52:55], v[12:15]
    ds_read2st64_b64 v[112:115], v100 offset0:70 offset1:71
    v_mul_f32 v123, v123, |v123|
    v_mfma_f32_16x16x32_bf16 v[12:15], a[124:127], v[48:51], v[12:15]
    buffer_load_dwordx4 v1, s[8:11], s37 offen offset:0 sc1 lds
    v_mfma_f32_16x16x32_bf16 v[8:11], a[120:123], v[48:51], v[8:11]
    ds_read_b128 v[48:51], v2 offset:14336
    s_add_u32 s16, s16, 8192
    v_mfma_f32_16x16x32_bf16 v[8:11], a[132:135], v[52:55], v[8:11]
    ds_read_b128 v[52:55], v2 offset:15360
    s_waitcnt lgkmcnt(3)
    v_mfma_f32_16x16x32_bf16 v[8:11], a[144:147], v[40:43], v[8:11]
    s_waitcnt vmcnt(6)
    s_add_u32 m0, s34, 16384
    s_add_u32 s37, s33, 16384
    v_mfma_f32_16x16x32_bf16 v[8:11], a[156:159], v[44:47], v[8:11]
    s_barrier
    v_mfma_f32_16x16x32_bf16 v[12:15], a[160:163], v[44:47], v[12:15]
    ds_read2st64_b64 v[108:111], v100 offset0:68 offset1:69
    v_cvt_pk_bf16_f32 v116, v116, v117
    v_mfma_f32_16x16x32_bf16 v[12:15], a[148:151], v[40:43], v[12:15]
    ds_read2st64_b64 v[104:107], v100 offset0:66 offset1:67
    v_cvt_pk_bf16_f32 v118, v118, v119
    v_mfma_f32_16x16x32_bf16 v[16:19], a[152:155], v[40:43], v[16:19]
    ds_read_b128 v[40:43], v2 offset:16384
    v_cvt_pk_bf16_f32 v120, v120, v121
    v_mfma_f32_16x16x32_bf16 v[16:19], a[164:167], v[44:47], v[16:19]
    ds_read_b128 v[44:47], v2 offset:17408
    s_waitcnt lgkmcnt(4)
    v_mfma_f32_16x16x32_bf16 v[16:19], a[176:179], v[48:51], v[16:19]
    ds_read2st64_b64 v[100:103], v100 offset0:64 offset1:65
    v_cvt_pk_bf16_f32 v122, v122, v123
    v_mfma_f32_16x16x32_bf16 v[16:19], a[188:191], v[52:55], v[16:19]
    v_pk_max_i16 v92, v116, 0
    v_pk_max_i16 v93, v118, 0
    v_mfma_f32_16x16x32_bf16 v[12:15], a[184:187], v[52:55], v[12:15]
    v_pk_max_i16 v94, v120, 0
    v_pk_max_i16 v95, v122, 0
    v_mfma_f32_16x16x32_bf16 v[12:15], a[172:175], v[48:51], v[12:15]
    buffer_store_dwordx4 v[92:95], v1, s[12:15], s36 offen sc1
    v_add_u32 v3, s35, v1
    v_mfma_f32_16x16x32_bf16 v[8:11], a[168:171], v[48:51], v[8:11]
    ds_read_b128 v[48:51], v2 offset:18432
    s_add_u32 s36, s36, 116736
    v_mfma_f32_16x16x32_bf16 v[8:11], a[180:183], v[52:55], v[8:11]
    ds_read_b128 v[52:55], v2 offset:19456
    s_waitcnt lgkmcnt(3)
    v_mfma_f32_16x16x32_bf16 v[8:11], a[192:195], v[40:43], v[8:11]
    buffer_load_dwordx4 v1, s[8:11], s37 offen offset:0 sc1 lds
    v_mfma_f32_16x16x32_bf16 v[8:11], a[204:207], v[44:47], v[8:11]
    s_waitcnt lgkmcnt(2)
    v_add_f32 v100, v100, v108
    v_add_f32 v101, v101, v109
    v_mfma_f32_16x16x32_bf16 v[12:15], a[208:211], v[44:47], v[12:15]
    v_add_f32 v102, v102, v110
    v_add_f32 v103, v103, v111
    v_mfma_f32_16x16x32_bf16 v[12:15], a[196:199], v[40:43], v[12:15]
    buffer_load_dwordx4 v1, s[8:11], s37 offen offset:1024 sc1 lds
    v_mfma_f32_16x16x32_bf16 v[16:19], a[200:203], v[40:43], v[16:19]
    ds_read_b128 v[40:43], v2 offset:20480
    v_add_f32 v104, v104, v112
    v_mfma_f32_16x16x32_bf16 v[16:19], a[212:215], v[44:47], v[16:19]
    ds_read_b128 v[44:47], v2 offset:21504
    s_waitcnt lgkmcnt(2)
    v_mfma_f32_16x16x32_bf16 v[16:19], a[224:227], v[48:51], v[16:19]
    buffer_load_dwordx4 v1, s[8:11], s37 offen offset:2048 sc1 lds
    v_mfma_f32_16x16x32_bf16 v[16:19], a[236:239], v[52:55], v[16:19]
    v_add_f32 v105, v105, v113
    v_add_f32 v106, v106, v114
    v_mfma_f32_16x16x32_bf16 v[12:15], a[232:235], v[52:55], v[12:15]
    v_add_f32 v107, v107, v115
    v_add_f32 v100, v100, v104
    v_mfma_f32_16x16x32_bf16 v[12:15], a[220:223], v[48:51], v[12:15]
    buffer_load_dwordx4 v1, s[8:11], s37 offen offset:3072 sc1 lds
    v_mfma_f32_16x16x32_bf16 v[8:11], a[216:219], v[48:51], v[8:11]
    ds_read_b128 v[48:51], v2 offset:22528
    s_add_u32 s32, s32, 1
    v_mfma_f32_16x16x32_bf16 v[8:11], a[228:231], v[52:55], v[8:11]
    ds_read_b128 v[52:55], v2 offset:23552
    s_waitcnt lgkmcnt(2)
    v_mfma_f32_16x16x32_bf16 v[8:11], a[240:243], v[40:43], v[8:11]
    s_add_u32 s33, s33, 36864
    s_add_u32 s34, s34, 36864
    v_add_f32 v101, v101, v105
    v_mfma_f32_16x16x32_bf16 v[8:11], a[252:255], v[44:47], v[8:11]
    s_cmp_ge_u32 s34, 147456
    s_cselect_b32 s38, 147456, 0
    s_sub_u32 s34, s34, s38
    v_mfma_f32_16x16x32_bf16 v[12:15], v[128:131], v[44:47], v[12:15]
    v_add_f32 v102, v102, v106
    v_add_f32 v103, v103, v107
    v_mfma_f32_16x16x32_bf16 v[12:15], a[244:247], v[40:43], v[12:15]
    v_add_f32 v100, v100, v102
    v_add_f32 v101, v101, v103
    v_mfma_f32_16x16x32_bf16 v[16:19], a[248:251], v[40:43], v[16:19]
    ds_read_b128 v[40:43], v2 offset:24576
    v_mfma_f32_16x16x32_bf16 v[16:19], v[132:135], v[44:47], v[16:19]
    ds_read_b128 v[44:47], v2 offset:25600
    s_waitcnt lgkmcnt(2)
    v_mfma_f32_16x16x32_bf16 v[16:19], v[144:147], v[48:51], v[16:19]
    buffer_load_dword v5, v4, s[4:7], s16 offen sc1
    v_mfma_f32_16x16x32_bf16 v[16:19], v[156:159], v[52:55], v[16:19]
    v_permlane16_swap_b32 v100, v101
    v_mfma_f32_16x16x32_bf16 v[12:15], v[152:155], v[52:55], v[12:15]
    v_add_f32 v100, v100, v101
    v_mov_b32 v101, v100
    v_mfma_f32_16x16x32_bf16 v[12:15], v[140:143], v[48:51], v[12:15]
    s_nop 0
    v_permlane32_swap_b32 v100, v101
    v_mfma_f32_16x16x32_bf16 v[8:11], v[136:139], v[48:51], v[8:11]
    ds_read_b128 v[48:51], v2 offset:26624
    v_add_f32 v100, v100, v101
    v_mfma_f32_16x16x32_bf16 v[8:11], v[148:151], v[52:55], v[8:11]
    ds_read_b128 v[52:55], v2 offset:27648
    s_waitcnt lgkmcnt(2)
    v_mfma_f32_16x16x32_bf16 v[8:11], v[160:163], v[40:43], v[8:11]
    v_mul_f32 v100, 0x3a800000, v100
    v_mov_b32 v101, v100
    v_mfma_f32_16x16x32_bf16 v[8:11], v[172:175], v[44:47], v[8:11]
    s_nop 0
    v_permlane16_swap_b32 v100, v101
    v_mfma_f32_16x16x32_bf16 v[12:15], v[176:179], v[44:47], v[12:15]
    v_fma_f32 v101, -v100, v100, v101
    v_max_f32 v101, 0, v101
    v_mfma_f32_16x16x32_bf16 v[12:15], v[164:167], v[40:43], v[12:15]
    v_add_f32 v101, 0x3727c5ac, v101
    v_mfma_f32_16x16x32_bf16 v[16:19], v[168:171], v[40:43], v[16:19]
    ds_read_b128 v[40:43], v2 offset:28672
    v_mfma_f32_16x16x32_bf16 v[16:19], v[180:183], v[44:47], v[16:19]
    ds_read_b128 v[44:47], v2 offset:29696
    s_waitcnt lgkmcnt(2)
    v_mfma_f32_16x16x32_bf16 v[16:19], v[192:195], v[48:51], v[16:19]
    v_rsq_f32 v21, v101
    v_mfma_f32_16x16x32_bf16 v[16:19], v[204:207], v[52:55], v[16:19]
    v_mul_f32 v100, v100, v21
    v_fma_f32 v80, -v100, v56, v68
    v_mfma_f32_16x16x32_bf16 v[12:15], v[200:203], v[52:55], v[12:15]
    v_fma_f32 v81, -v100, v57, v69
    v_fma_f32 v82, -v100, v58, v70
    v_mfma_f32_16x16x32_bf16 v[12:15], v[188:191], v[48:51], v[12:15]
    v_fma_f32 v83, -v100, v59, v71
    v_fma_f32 v84, -v100, v60, v72
    v_mfma_f32_16x16x32_bf16 v[8:11], v[184:187], v[48:51], v[8:11]
    ds_read_b128 v[48:51], v2 offset:30720
    v_fma_f32 v85, -v100, v61, v73
    v_mfma_f32_16x16x32_bf16 v[8:11], v[196:199], v[52:55], v[8:11]
    ds_read_b128 v[52:55], v2 offset:31744
    s_waitcnt lgkmcnt(2)
    v_mfma_f32_16x16x32_bf16 v[8:11], v[208:211], v[40:43], v[8:11]
    s_waitcnt vmcnt(6)
    v_fma_f32 v86, -v100, v62, v74
    v_fma_f32 v87, -v100, v63, v75
    v_mfma_f32_16x16x32_bf16 v[8:11], v[220:223], v[44:47], v[8:11]
    s_barrier
    v_mfma_f32_16x16x32_bf16 v[12:15], v[224:227], v[44:47], v[12:15]
    v_fma_f32 v88, -v100, v64, v76
    v_fma_f32 v89, -v100, v65, v77
    v_mfma_f32_16x16x32_bf16 v[12:15], v[212:215], v[40:43], v[12:15]
    s_waitcnt vmcnt(5)
    buffer_store_dword v6, v22, s[12:15], s17 offen sc1
    v_mfma_f32_16x16x32_bf16 v[16:19], v[216:219], v[40:43], v[16:19]
    ds_read_b128 v[40:43], v3 offset:0
    v_fma_f32 v90, -v100, v66, v78
    v_mfma_f32_16x16x32_bf16 v[16:19], v[228:231], v[44:47], v[16:19]
    ds_read_b128 v[44:47], v3 offset:1024
    s_waitcnt lgkmcnt(2)
    v_mfma_f32_16x16x32_bf16 v[16:19], v[240:243], v[48:51], v[16:19]
    s_mov_b32 s14, s6
    v_fma_f32 v91, -v100, v67, v79
    s_add_u32 s17, s17, 8192
    v_mfma_f32_16x16x32_bf16 v[16:19], v[252:255], v[52:55], v[16:19]
    v_mfma_f32_16x16x32_bf16 v[12:15], v[248:251], v[52:55], v[12:15]
    v_mfma_f32_16x16x32_bf16 v[12:15], v[236:239], v[48:51], v[12:15]
    v_mfma_f32_16x16x32_bf16 v[8:11], v[232:235], v[48:51], v[8:11]
    ds_read_b128 v[48:51], v3 offset:2048
    v_mfma_f32_16x16x32_bf16 v[8:11], v[244:247], v[52:55], v[8:11]
    ds_read_b128 v[52:55], v3 offset:3072
Lffa_body11:
    s_waitcnt lgkmcnt(2)
    v_mfma_f32_16x16x32_bf16 v[24:27], a[0:3], v[40:43], 0
    s_add_u32 m0, s34, 0
    v_fma_f32 v124, v16, v21, v88
    v_fma_f32 v125, v17, v21, v89
    v_mfma_f32_16x16x32_bf16 v[24:27], a[12:15], v[44:47], v[24:27]
    s_add_u32 s31, s31, 1
    v_mov_b32 v6, s31
    v_fma_f32 v126, v18, v21, v90
    v_mfma_f32_16x16x32_bf16 v[28:31], a[16:19], v[44:47], 0
    s_add_u32 s35, s35, 36864
    v_fma_f32 v127, v19, v21, v91
    v_mul_f32 v124, v124, |v124|
    v_mfma_f32_16x16x32_bf16 v[28:31], a[4:7], v[40:43], v[28:31]
    s_cmp_eq_u32 s35, 147456
    s_cselect_b32 s35, 0, s35
    v_mul_f32 v125, v125, |v125|
    v_mfma_f32_16x16x32_bf16 v[32:35], a[8:11], v[40:43], 0
    ds_read_b128 v[40:43], v3 offset:4096
    v_mul_f32 v126, v126, |v126|
    v_mfma_f32_16x16x32_bf16 v[32:35], a[20:23], v[44:47], v[32:35]
    ds_read_b128 v[44:47], v3 offset:5120
    s_waitcnt lgkmcnt(2)
    v_mfma_f32_16x16x32_bf16 v[32:35], a[32:35], v[48:51], v[32:35]
    v_mul_f32 v127, v127, |v127|
    v_cvt_pk_bf16_f32 v124, v124, v125
    v_mfma_f32_16x16x32_bf16 v[32:35], a[44:47], v[52:55], v[32:35]
    v_cvt_pk_bf16_f32 v126, v126, v127
    v_pk_max_i16 v96, v124, 0
    v_mfma_f32_16x16x32_bf16 v[28:31], a[40:43], v[52:55], v[28:31]
    v_pk_max_i16 v97, v126, 0
    v_pk_max_i16 v98, v124, 0
    v_mfma_f32_16x16x32_bf16 v[28:31], a[28:31], v[48:51], v[28:31]
    v_pk_max_i16 v99, v126, 0
    v_fma_f32 v116, v8, v21, v80
    v_mfma_f32_16x16x32_bf16 v[24:27], a[24:27], v[48:51], v[24:27]
    ds_read_b128 v[48:51], v3 offset:6144
    v_fma_f32 v117, v9, v21, v81
    v_mfma_f32_16x16x32_bf16 v[24:27], a[36:39], v[52:55], v[24:27]
    ds_read_b128 v[52:55], v3 offset:7168
    s_waitcnt lgkmcnt(2)
    v_mfma_f32_16x16x32_bf16 v[24:27], a[48:51], v[40:43], v[24:27]
    v_permlane32_swap_b32 v96, v98
    v_mfma_f32_16x16x32_bf16 v[24:27], a[60:63], v[44:47], v[24:27]
    v_permlane32_swap_b32 v97, v99
    v_mfma_f32_16x16x32_bf16 v[28:31], a[64:67], v[44:47], v[28:31]
    buffer_store_dwordx4 v[96:99], v7, s[12:15], s36 offen sc1
    v_fma_f32 v118, v10, v21, v82
    v_mfma_f32_16x16x32_bf16 v[28:31], a[52:55], v[40:43], v[28:31]
    s_waitcnt vmcnt(2)
    v_cmp_gt_i32 vcc, s32, v5
    v_fma_f32 v119, v11, v21, v83
    v_mfma_f32_16x16x32_bf16 v[32:35], a[56:59], v[40:43], v[32:35]
    ds_read_b128 v[40:43], v3 offset:8192
    v_fma_f32 v120, v12, v21, v84
    v_mfma_f32_16x16x32_bf16 v[32:35], a[68:71], v[44:47], v[32:35]
    ds_read_b128 v[44:47], v3 offset:9216
    s_waitcnt lgkmcnt(2)
    v_mfma_f32_16x16x32_bf16 v[32:35], a[80:83], v[48:51], v[32:35]
    s_and_b64 vcc, vcc, s[18:19]
    s_cbranch_scc1 Lffa_v11
    v_mfma_f32_16x16x32_bf16 v[32:35], a[92:95], v[52:55], v[32:35]
    buffer_load_dwordx4 v1, s[8:11], s33 offen offset:0 sc1 lds
    v_mfma_f32_16x16x32_bf16 v[28:31], a[88:91], v[52:55], v[28:31]
    v_fma_f32 v121, v13, v21, v85
    v_fma_f32 v122, v14, v21, v86
    v_mfma_f32_16x16x32_bf16 v[28:31], a[76:79], v[48:51], v[28:31]
    v_fma_f32 v123, v15, v21, v87
    v_mul_f32 v116, v116, |v116|
    v_mfma_f32_16x16x32_bf16 v[24:27], a[72:75], v[48:51], v[24:27]
    ds_read_b128 v[48:51], v3 offset:10240
    v_mul_f32 v117, v117, |v117|
    v_mfma_f32_16x16x32_bf16 v[24:27], a[84:87], v[52:55], v[24:27]
    ds_read_b128 v[52:55], v3 offset:11264
    s_waitcnt lgkmcnt(2)
    v_mfma_f32_16x16x32_bf16 v[24:27], a[96:99], v[40:43], v[24:27]
    buffer_load_dwordx4 v1, s[8:11], s33 offen offset:1024 sc1 lds
    v_mfma_f32_16x16x32_bf16 v[24:27], a[108:111], v[44:47], v[24:27]
    v_mul_f32 v118, v118, |v118|
    v_mul_f32 v119, v119, |v119|
    v_mfma_f32_16x16x32_bf16 v[28:31], a[112:115], v[44:47], v[28:31]
    v_mul_f32 v120, v120, |v120|
    v_mul_f32 v121, v121, |v121|
    v_mfma_f32_16x16x32_bf16 v[28:31], a[100:103], v[40:43], v[28:31]
    buffer_load_dwordx4 v1, s[8:11], s33 offen offset:2048 sc1 lds
    v_mfma_f32_16x16x32_bf16 v[32:35], a[104:107], v[40:43], v[32:35]
    ds_read_b128 v[40:43], v3 offset:12288
    v_mul_f32 v122, v122, |v122|
    v_mfma_f32_16x16x32_bf16 v[32:35], a[116:119], v[44:47], v[32:35]
    ds_read_b128 v[44:47], v3 offset:13312
    s_waitcnt lgkmcnt(2)
    v_mfma_f32_16x16x32_bf16 v[32:35], a[128:131], v[48:51], v[32:35]
    buffer_load_dwordx4 v1, s[8:11], s33 offen offset:3072 sc1 lds
    v_mfma_f32_16x16x32_bf16 v[32:35], a[140:143], v[52:55], v[32:35]
    s_add_u32 m0, s34, s3
    s_add_u32 s37, s33, s3
    v_sub_u32 v100, v3, v20
    v_mfma_f32_16x16x32_bf16 v[28:31], a[136:139], v[52:55], v[28:31]
    ds_read2st64_b64 v[112:115], v100 offset0:70 offset1:71
    v_mul_f32 v123, v123, |v123|
    v_mfma_f32_16x16x32_bf16 v[28:31], a[124:127], v[48:51], v[28:31]
    buffer_load_dwordx4 v1, s[8:11], s37 offen offset:0 sc1 lds
    v_mfma_f32_16x16x32_bf16 v[24:27], a[120:123], v[48:51], v[24:27]
    ds_read_b128 v[48:51], v3 offset:14336
    s_add_u32 s16, s16, 8192
    v_mfma_f32_16x16x32_bf16 v[24:27], a[132:135], v[52:55], v[24:27]
    ds_read_b128 v[52:55], v3 offset:15360
    s_waitcnt lgkmcnt(3)
    v_mfma_f32_16x16x32_bf16 v[24:27], a[144:147], v[40:43], v[24:27]
    s_waitcnt vmcnt(6)
    s_add_u32 m0, s34, 16384
    s_add_u32 s37, s33, 16384
    v_mfma_f32_16x16x32_bf16 v[24:27], a[156:159], v[44:47], v[24:27]
    s_barrier
    v_mfma_f32_16x16x32_bf16 v[28:31], a[160:163], v[44:47], v[28:31]
    ds_read2st64_b64 v[108:111], v100 offset0:68 offset1:69
    v_cvt_pk_bf16_f32 v116, v116, v117
    v_mfma_f32_16x16x32_bf16 v[28:31], a[148:151], v[40:43], v[28:31]
    ds_read2st64_b64 v[104:107], v100 offset0:66 offset1:67
    v_cvt_pk_bf16_f32 v118, v118, v119
    v_mfma_f32_16x16x32_bf16 v[32:35], a[152:155], v[40:43], v[32:35]
    ds_read_b128 v[40:43], v3 offset:16384
    v_cvt_pk_bf16_f32 v120, v120, v121
    v_mfma_f32_16x16x32_bf16 v[32:35], a[164:167], v[44:47], v[32:35]
    ds_read_b128 v[44:47], v3 offset:17408
    s_waitcnt lgkmcnt(4)
    v_mfma_f32_16x16x32_bf16 v[32:35], a[176:179], v[48:51], v[32:35]
    ds_read2st64_b64 v[100:103], v100 offset0:64 offset1:65
    v_cvt_pk_bf16_f32 v122, v122, v123
    v_mfma_f32_16x16x32_bf16 v[32:35], a[188:191], v[52:55], v[32:35]
    v_pk_max_i16 v92, v116, 0
    v_pk_max_i16 v93, v118, 0
    v_mfma_f32_16x16x32_bf16 v[28:31], a[184:187], v[52:55], v[28:31]
    v_pk_max_i16 v94, v120, 0
    v_pk_max_i16 v95, v122, 0
    v_mfma_f32_16x16x32_bf16 v[28:31], a[172:175], v[48:51], v[28:31]
    buffer_store_dwordx4 v[92:95], v1, s[12:15], s36 offen sc1
    v_add_u32 v2, s35, v1
    v_mfma_f32_16x16x32_bf16 v[24:27], a[168:171], v[48:51], v[24:27]
    ds_read_b128 v[48:51], v3 offset:18432
    s_add_u32 s36, s36, 116736
    v_mfma_f32_16x16x32_bf16 v[24:27], a[180:183], v[52:55], v[24:27]
    ds_read_b128 v[52:55], v3 offset:19456
    s_waitcnt lgkmcnt(3)
    v_mfma_f32_16x16x32_bf16 v[24:27], a[192:195], v[40:43], v[24:27]
    buffer_load_dwordx4 v1, s[8:11], s37 offen offset:0 sc1 lds
    v_mfma_f32_16x16x32_bf16 v[24:27], a[204:207], v[44:47], v[24:27]
    s_waitcnt lgkmcnt(2)
    v_add_f32 v100, v100, v108
    v_add_f32 v101, v101, v109
    v_mfma_f32_16x16x32_bf16 v[28:31], a[208:211], v[44:47], v[28:31]
    v_add_f32 v102, v102, v110
    v_add_f32 v103, v103, v111
    v_mfma_f32_16x16x32_bf16 v[28:31], a[196:199], v[40:43], v[28:31]
    buffer_load_dwordx4 v1, s[8:11], s37 offen offset:1024 sc1 lds
    v_mfma_f32_16x16x32_bf16 v[32:35], a[200:203], v[40:43], v[32:35]
    ds_read_b128 v[40:43], v3 offset:20480
    v_add_f32 v104, v104, v112
    v_mfma_f32_16x16x32_bf16 v[32:35], a[212:215], v[44:47], v[32:35]
    ds_read_b128 v[44:47], v3 offset:21504
    s_waitcnt lgkmcnt(2)
    v_mfma_f32_16x16x32_bf16 v[32:35], a[224:227], v[48:51], v[32:35]
    buffer_load_dwordx4 v1, s[8:11], s37 offen offset:2048 sc1 lds
    v_mfma_f32_16x16x32_bf16 v[32:35], a[236:239], v[52:55], v[32:35]
    v_add_f32 v105, v105, v113
    v_add_f32 v106, v106, v114
    v_mfma_f32_16x16x32_bf16 v[28:31], a[232:235], v[52:55], v[28:31]
    v_add_f32 v107, v107, v115
    v_add_f32 v100, v100, v104
    v_mfma_f32_16x16x32_bf16 v[28:31], a[220:223], v[48:51], v[28:31]
    buffer_load_dwordx4 v1, s[8:11], s37 offen offset:3072 sc1 lds
    v_mfma_f32_16x16x32_bf16 v[24:27], a[216:219], v[48:51], v[24:27]
    ds_read_b128 v[48:51], v3 offset:22528
    s_add_u32 s32, s32, 1
    v_mfma_f32_16x16x32_bf16 v[24:27], a[228:231], v[52:55], v[24:27]
    ds_read_b128 v[52:55], v3 offset:23552
    s_waitcnt lgkmcnt(2)
    v_mfma_f32_16x16x32_bf16 v[24:27], a[240:243], v[40:43], v[24:27]
    s_add_u32 s33, s33, 36864
    s_add_u32 s34, s34, 36864
    v_add_f32 v101, v101, v105
    v_mfma_f32_16x16x32_bf16 v[24:27], a[252:255], v[44:47], v[24:27]
    s_cmp_ge_u32 s34, 147456
    s_cselect_b32 s38, 147456, 0
    s_sub_u32 s34, s34, s38
    v_mfma_f32_16x16x32_bf16 v[28:31], v[128:131], v[44:47], v[28:31]
    v_add_f32 v102, v102, v106
    v_add_f32 v103, v103, v107
    v_mfma_f32_16x16x32_bf16 v[28:31], a[244:247], v[40:43], v[28:31]
    v_add_f32 v100, v100, v102
    v_add_f32 v101, v101, v103
    v_mfma_f32_16x16x32_bf16 v[32:35], a[248:251], v[40:43], v[32:35]
    ds_read_b128 v[40:43], v3 offset:24576
    v_mfma_f32_16x16x32_bf16 v[32:35], v[132:135], v[44:47], v[32:35]
    ds_read_b128 v[44:47], v3 offset:25600
    s_waitcnt lgkmcnt(2)
    v_mfma_f32_16x16x32_bf16 v[32:35], v[144:147], v[48:51], v[32:35]
    buffer_load_dword v5, v4, s[4:7], s16 offen sc1
    v_mfma_f32_16x16x32_bf16 v[32:35], v[156:159], v[52:55], v[32:35]
    v_permlane16_swap_b32 v100, v101
    v_mfma_f32_16x16x32_bf16 v[28:31], v[152:155], v[52:55], v[28:31]
    v_add_f32 v100, v100, v101
    v_mov_b32 v101, v100
    v_mfma_f32_16x16x32_bf16 v[28:31], v[140:143], v[48:51], v[28:31]
    s_nop 0
    v_permlane32_swap_b32 v100, v101
    v_mfma_f32_16x16x32_bf16 v[24:27], v[136:139], v[48:51], v[24:27]
    ds_read_b128 v[48:51], v3 offset:26624
    v_add_f32 v100, v100, v101
    v_mfma_f32_16x16x32_bf16 v[24:27], v[148:151], v[52:55], v[24:27]
    ds_read_b128 v[52:55], v3 offset:27648
    s_waitcnt lgkmcnt(2)
    v_mfma_f32_16x16x32_bf16 v[24:27], v[160:163], v[40:43], v[24:27]
    v_mul_f32 v100, 0x3a800000, v100
    v_mov_b32 v101, v100
    v_mfma_f32_16x16x32_bf16 v[24:27], v[172:175], v[44:47], v[24:27]
    s_nop 0
    v_permlane16_swap_b32 v100, v101
    v_mfma_f32_16x16x32_bf16 v[28:31], v[176:179], v[44:47], v[28:31]
    v_fma_f32 v101, -v100, v100, v101
    v_max_f32 v101, 0, v101
    v_mfma_f32_16x16x32_bf16 v[28:31], v[164:167], v[40:43], v[28:31]
    v_add_f32 v101, 0x3727c5ac, v101
    v_mfma_f32_16x16x32_bf16 v[32:35], v[168:171], v[40:43], v[32:35]
    ds_read_b128 v[40:43], v3 offset:28672
    v_mfma_f32_16x16x32_bf16 v[32:35], v[180:183], v[44:47], v[32:35]
    ds_read_b128 v[44:47], v3 offset:29696
    s_waitcnt lgkmcnt(2)
    v_mfma_f32_16x16x32_bf16 v[32:35], v[192:195], v[48:51], v[32:35]
    v_rsq_f32 v21, v101
    v_mfma_f32_16x16x32_bf16 v[32:35], v[204:207], v[52:55], v[32:35]
    v_mul_f32 v100, v100, v21
    v_fma_f32 v80, -v100, v56, v68
    v_mfma_f32_16x16x32_bf16 v[28:31], v[200:203], v[52:55], v[28:31]
    v_fma_f32 v81, -v100, v57, v69
    v_fma_f32 v82, -v100, v58, v70
    v_mfma_f32_16x16x32_bf16 v[28:31], v[188:191], v[48:51], v[28:31]
    v_fma_f32 v83, -v100, v59, v71
    v_fma_f32 v84, -v100, v60, v72
    v_mfma_f32_16x16x32_bf16 v[24:27], v[184:187], v[48:51], v[24:27]
    ds_read_b128 v[48:51], v3 offset:30720
    v_fma_f32 v85, -v100, v61, v73
    v_mfma_f32_16x16x32_bf16 v[24:27], v[196:199], v[52:55], v[24:27]
    ds_read_b128 v[52:55], v3 offset:31744
    s_waitcnt lgkmcnt(2)
    v_mfma_f32_16x16x32_bf16 v[24:27], v[208:211], v[40:43], v[24:27]
    s_waitcnt vmcnt(6)
    v_fma_f32 v86, -v100, v62, v74
    v_fma_f32 v87, -v100, v63, v75
    v_mfma_f32_16x16x32_bf16 v[24:27], v[220:223], v[44:47], v[24:27]
    s_barrier
    v_mfma_f32_16x16x32_bf16 v[28:31], v[224:227], v[44:47], v[28:31]
    v_fma_f32 v88, -v100, v64, v76
    v_fma_f32 v89, -v100, v65, v77
    v_mfma_f32_16x16x32_bf16 v[28:31], v[212:215], v[40:43], v[28:31]
    s_waitcnt vmcnt(5)
    buffer_store_dword v6, v22, s[12:15], s17 offen sc1
    v_mfma_f32_16x16x32_bf16 v[32:35], v[216:219], v[40:43], v[32:35]
    ds_read_b128 v[40:43], v2 offset:0
    v_fma_f32 v90, -v100, v66, v78
    v_mfma_f32_16x16x32_bf16 v[32:35], v[228:231], v[44:47], v[32:35]
    ds_read_b128 v[44:47], v2 offset:1024
    s_waitcnt lgkmcnt(2)
    v_mfma_f32_16x16x32_bf16 v[32:35], v[240:243], v[48:51], v[32:35]
    s_mov_b32 s14, s6
    v_fma_f32 v91, -v100, v67, v79
    s_add_u32 s17, s17, 8192
    v_mfma_f32_16x16x32_bf16 v[32:35], v[252:255], v[52:55], v[32:35]
    v_mfma_f32_16x16x32_bf16 v[28:31], v[248:251], v[52:55], v[28:31]
    v_mfma_f32_16x16x32_bf16 v[28:31], v[236:239], v[48:51], v[28:31]
    v_mfma_f32_16x16x32_bf16 v[24:27], v[232:235], v[48:51], v[24:27]
    ds_read_b128 v[48:51], v2 offset:2048
    v_mfma_f32_16x16x32_bf16 v[24:27], v[244:247], v[52:55], v[24:27]
    ds_read_b128 v[52:55], v2 offset:3072
    s_cmp_lt_i32 s31, 63
    s_cbranch_scc1 Lffa_body01
    s_branch L_exit
    .p2align 6
Lffa_body02:
    s_waitcnt lgkmcnt(2)
    v_mfma_f32_16x16x32_bf16 v[8:11], a[0:3], v[40:43], 0
    s_add_u32 m0, s34, 0
    v_fma_f32 v124, v32, v21, v88
    v_fma_f32 v125, v33, v21, v89
    v_mfma_f32_16x16x32_bf16 v[8:11], a[12:15], v[44:47], v[8:11]
    s_add_u32 s31, s31, 1
    v_mov_b32 v6, s31
    v_fma_f32 v126, v34, v21, v90
    v_mfma_f32_16x16x32_bf16 v[12:15], a[16:19], v[44:47], 0
    s_add_u32 s35, s35, 36864
    v_fma_f32 v127, v35, v21, v91
    v_mul_f32 v124, v124, |v124|
    v_mfma_f32_16x16x32_bf16 v[12:15], a[4:7], v[40:43], v[12:15]
    s_cmp_eq_u32 s35, 147456
    s_cselect_b32 s35, 0, s35
    v_mul_f32 v125, v125, |v125|
    v_mfma_f32_16x16x32_bf16 v[16:19], a[8:11], v[40:43], 0
    ds_read_b128 v[40:43], v2 offset:4096
    v_mul_f32 v126, v126, |v126|
    v_mfma_f32_16x16x32_bf16 v[16:19], a[20:23], v[44:47], v[16:19]
    ds_read_b128 v[44:47], v2 offset:5120
    s_waitcnt lgkmcnt(2)
    v_mfma_f32_16x16x32_bf16 v[16:19], a[32:35], v[48:51], v[16:19]
    v_mul_f32 v127, v127, |v127|
    v_cvt_pk_bf16_f32 v124, v124, v125
    v_mfma_f32_16x16x32_bf16 v[16:19], a[44:47], v[52:55], v[16:19]
    v_cvt_pk_bf16_f32 v126, v126, v127
    v_pk_max_i16 v96, v124, 0
    v_mfma_f32_16x16x32_bf16 v[12:15], a[40:43], v[52:55], v[12:15]
    v_pk_max_i16 v97, v126, 0
    v_pk_max_i16 v98, v124, 0
    v_mfma_f32_16x16x32_bf16 v[12:15], a[28:31], v[48:51], v[12:15]
    v_pk_max_i16 v99, v126, 0
    v_fma_f32 v116, v24, v21, v80
    v_mfma_f32_16x16x32_bf16 v[8:11], a[24:27], v[48:51], v[8:11]
    ds_read_b128 v[48:51], v2 offset:6144
    v_fma_f32 v117, v25, v21, v81
    v_mfma_f32_16x16x32_bf16 v[8:11], a[36:39], v[52:55], v[8:11]
    ds_read_b128 v[52:55], v2 offset:7168
    s_waitcnt lgkmcnt(2)
    v_mfma_f32_16x16x32_bf16 v[8:11], a[48:51], v[40:43], v[8:11]
    v_permlane32_swap_b32 v96, v98
    v_mfma_f32_16x16x32_bf16 v[8:11], a[60:63], v[44:47], v[8:11]
    v_permlane32_swap_b32 v97, v99
    v_mfma_f32_16x16x32_bf16 v[12:15], a[64:67], v[44:47], v[12:15]
    buffer_store_dwordx4 v[96:99], v7, s[12:15], s36 offen sc1
    v_fma_f32 v118, v26, v21, v82
    v_mfma_f32_16x16x32_bf16 v[12:15], a[52:55], v[40:43], v[12:15]
    s_waitcnt vmcnt(2)
    v_cmp_gt_i32 vcc, s32, v5
    v_fma_f32 v119, v27, v21, v83
    v_mfma_f32_16x16x32_bf16 v[16:19], a[56:59], v[40:43], v[16:19]
    ds_read_b128 v[40:43], v2 offset:8192
    v_fma_f32 v120, v28, v21, v84
    v_mfma_f32_16x16x32_bf16 v[16:19], a[68:71], v[44:47], v[16:19]
    ds_read_b128 v[44:47], v2 offset:9216
    s_waitcnt lgkmcnt(2)
    v_mfma_f32_16x16x32_bf16 v[16:19], a[80:83], v[48:51], v[16:19]
    s_and_b64 vcc, vcc, s[18:19]
    s_cbranch_scc1 Lffa_v01
    v_mfma_f32_16x16x32_bf16 v[16:19], a[92:95], v[52:55], v[16:19]
    buffer_load_dwordx4 v1, s[8:11], s33 offen offset:0 sc1 lds
    v_mfma_f32_16x16x32_bf16 v[12:15], a[88:91], v[52:55], v[12:15]
    v_fma_f32 v121, v29, v21, v85
    v_fma_f32 v122, v30, v21, v86
    v_mfma_f32_16x16x32_bf16 v[12:15], a[76:79], v[48:51], v[12:15]
    v_fma_f32 v123, v31, v21, v87
    v_mul_f32 v116, v116, |v116|
    v_mfma_f32_16x16x32_bf16 v[8:11], a[72:75], v[48:51], v[8:11]
    ds_read_b128 v[48:51], v2 offset:10240
    v_mul_f32 v117, v117, |v117|
    v_mfma_f32_16x16x32_bf16 v[8:11], a[84:87], v[52:55], v[8:11]
    ds_read_b128 v[52:55], v2 offset:11264
    s_waitcnt lgkmcnt(2)
    v_mfma_f32_16x16x32_bf16 v[8:11], a[96:99], v[40:43], v[8:11]
    buffer_load_dwordx4 v1, s[8:11], s33 offen offset:1024 sc1 lds
    v_mfma_f32_16x16x32_bf16 v[8:11], a[108:111], v[44:47], v[8:11]
    v_mul_f32 v118, v118, |v118|
    v_mul_f32 v119, v119, |v119|
    v_mfma_f32_16x16x32_bf16 v[12:15], a[112:115], v[44:47], v[12:15]
    v_mul_f32 v120, v120, |v120|
    v_mul_f32 v121, v121, |v121|
    v_mfma_f32_16x16x32_bf16 v[12:15], a[100:103], v[40:43], v[12:15]
    buffer_load_dwordx4 v1, s[8:11], s33 offen offset:2048 sc1 lds
    v_mfma_f32_16x16x32_bf16 v[16:19], a[104:107], v[40:43], v[16:19]
    ds_read_b128 v[40:43], v2 offset:12288
    v_mul_f32 v122, v122, |v122|
    v_mfma_f32_16x16x32_bf16 v[16:19], a[116:119], v[44:47], v[16:19]
    ds_read_b128 v[44:47], v2 offset:13312
    s_waitcnt lgkmcnt(2)
    v_mfma_f32_16x16x32_bf16 v[16:19], a[128:131], v[48:51], v[16:19]
    buffer_load_dwordx4 v1, s[8:11], s33 offen offset:3072 sc1 lds
    v_mfma_f32_16x16x32_bf16 v[16:19], a[140:143], v[52:55], v[16:19]
    s_add_u32 m0, s34, s3
    s_add_u32 s37, s33, s3
    v_sub_u32 v100, v2, v20
    v_mfma_f32_16x16x32_bf16 v[12:15], a[136:139], v[52:55], v[12:15]
    ds_read2st64_b64 v[112:115], v100 offset0:70 offset1:71
    v_mul_f32 v123, v123, |v123|
    v_mfma_f32_16x16x32_bf16 v[12:15], a[124:127], v[48:51], v[12:15]
    buffer_load_dwordx4 v1, s[8:11], s37 offen offset:0 sc1 lds
    v_mfma_f32_16x16x32_bf16 v[8:11], a[120:123], v[48:51], v[8:11]
    ds_read_b128 v[48:51], v2 offset:14336
    s_add_u32 s16, s16, 8192
    v_mfma_f32_16x16x32_bf16 v[8:11], a[132:135], v[52:55], v[8:11]
    ds_read_b128 v[52:55], v2 offset:15360
    s_waitcnt lgkmcnt(3)
    v_mfma_f32_16x16x32_bf16 v[8:11], a[144:147], v[40:43], v[8:11]
    s_waitcnt vmcnt(6)
    s_add_u32 m0, s34, 16384
    s_add_u32 s37, s33, 16384
    v_mfma_f32_16x16x32_bf16 v[8:11], a[156:159], v[44:47], v[8:11]
    ds_read2st64_b64 v[108:111], v100 offset0:68 offset1:69
    v_cvt_pk_bf16_f32 v116, v116, v117
    v_mfma_f32_16x16x32_bf16 v[12:15], a[160:163], v[44:47], v[12:15]
    s_barrier
    v_mfma_f32_16x16x32_bf16 v[12:15], a[148:151], v[40:43], v[12:15]
    ds_read2st64_b64 v[104:107], v100 offset0:66 offset1:67
    v_cvt_pk_bf16_f32 v118, v118, v119
    v_mfma_f32_16x16x32_bf16 v[16:19], a[152:155], v[40:43], v[16:19]
    ds_read_b128 v[40:43], v2 offset:16384
    v_cvt_pk_bf16_f32 v120, v120, v121
    v_mfma_f32_16x16x32_bf16 v[16:19], a[164:167], v[44:47], v[16:19]
    ds_read_b128 v[44:47], v2 offset:17408
    s_waitcnt lgkmcnt(4)
    v_mfma_f32_16x16x32_bf16 v[16:19], a[176:179], v[48:51], v[16:19]
    ds_read2st64_b64 v[100:103], v100 offset0:64 offset1:65
    v_cvt_pk_bf16_f32 v122, v122, v123
    v_mfma_f32_16x16x32_bf16 v[16:19], a[188:191], v[52:55], v[16:19]
    v_pk_max_i16 v92, v116, 0
    v_pk_max_i16 v93, v118, 0
    v_mfma_f32_16x16x32_bf16 v[12:15], a[184:187], v[52:55], v[12:15]
    v_pk_max_i16 v94, v120, 0
    v_pk_max_i16 v95, v122, 0
    v_mfma_f32_16x16x32_bf16 v[12:15], a[172:175], v[48:51], v[12:15]
    buffer_store_dwordx4 v[92:95], v1, s[12:15], s36 offen sc1
    v_add_u32 v3, s35, v1
    v_mfma_f32_16x16x32_bf16 v[8:11], a[168:171], v[48:51], v[8:11]
    ds_read_b128 v[48:51], v2 offset:18432
    s_add_u32 s36, s36, 116736
    v_mfma_f32_16x16x32_bf16 v[8:11], a[180:183], v[52:55], v[8:11]
    ds_read_b128 v[52:55], v2 offset:19456
    s_waitcnt lgkmcnt(3)
    v_mfma_f32_16x16x32_bf16 v[8:11], a[192:195], v[40:43], v[8:11]
    buffer_load_dwordx4 v1, s[8:11], s37 offen offset:0 sc1 lds
    v_mfma_f32_16x16x32_bf16 v[8:11], a[204:207], v[44:47], v[8:11]
    s_waitcnt lgkmcnt(2)
    v_add_f32 v100, v100, v108
    v_add_f32 v101, v101, v109
    v_mfma_f32_16x16x32_bf16 v[12:15], a[208:211], v[44:47], v[12:15]
    v_add_f32 v102, v102, v110
    v_add_f32 v103, v103, v111
    v_mfma_f32_16x16x32_bf16 v[12:15], a[196:199], v[40:43], v[12:15]
    buffer_load_dwordx4 v1, s[8:11], s37 offen offset:1024 sc1 lds
    v_mfma_f32_16x16x32_bf16 v[16:19], a[200:203], v[40:43], v[16:19]
    ds_read_b128 v[40:43], v2 offset:20480
    v_add_f32 v104, v104, v112
    v_mfma_f32_16x16x32_bf16 v[16:19], a[212:215], v[44:47], v[16:19]
    ds_read_b128 v[44:47], v2 offset:21504
    s_waitcnt lgkmcnt(2)
    v_mfma_f32_16x16x32_bf16 v[16:19], a[224:227], v[48:51], v[16:19]
    buffer_load_dwordx4 v1, s[8:11], s37 offen offset:2048 sc1 lds
    v_mfma_f32_16x16x32_bf16 v[16:19], a[236:239], v[52:55], v[16:19]
    v_add_f32 v105, v105, v113
    v_add_f32 v106, v106, v114
    v_mfma_f32_16x16x32_bf16 v[12:15], a[232:235], v[52:55], v[12:15]
    v_add_f32 v107, v107, v115
    v_add_f32 v100, v100, v104
    v_mfma_f32_16x16x32_bf16 v[12:15], a[220:223], v[48:51], v[12:15]
    buffer_load_dwordx4 v1, s[8:11], s37 offen offset:3072 sc1 lds
    v_mfma_f32_16x16x32_bf16 v[8:11], a[216:219], v[48:51], v[8:11]
    ds_read_b128 v[48:51], v2 offset:22528
    s_add_u32 s32, s32, 1
    v_mfma_f32_16x16x32_bf16 v[8:11], a[228:231], v[52:55], v[8:11]
    ds_read_b128 v[52:55], v2 offset:23552
    s_waitcnt lgkmcnt(2)
    v_mfma_f32_16x16x32_bf16 v[8:11], a[240:243], v[40:43], v[8:11]
    s_add_u32 s33, s33, 36864
    s_add_u32 s34, s34, 36864
    v_add_f32 v101, v101, v105
    v_mfma_f32_16x16x32_bf16 v[8:11], a[252:255], v[44:47], v[8:11]
    s_cmp_ge_u32 s34, 147456
    s_cselect_b32 s38, 147456, 0
    s_sub_u32 s34, s34, s38
    v_mfma_f32_16x16x32_bf16 v[12:15], v[128:131], v[44:47], v[12:15]
    v_add_f32 v102, v102, v106
    v_add_f32 v103, v103, v107
    v_mfma_f32_16x16x32_bf16 v[12:15], a[244:247], v[40:43], v[12:15]
    v_add_f32 v100, v100, v102
    v_add_f32 v101, v101, v103
    v_mfma_f32_16x16x32_bf16 v[16:19], a[248:251], v[40:43], v[16:19]
    ds_read_b128 v[40:43], v2 offset:24576
    v_mfma_f32_16x16x32_bf16 v[16:19], v[132:135], v[44:47], v[16:19]
    ds_read_b128 v[44:47], v2 offset:25600
    s_waitcnt lgkmcnt(2)
    v_mfma_f32_16x16x32_bf16 v[16:19], v[144:147], v[48:51], v[16:19]
    buffer_load_dword v5, v4, s[4:7], s16 offen sc1
    v_mfma_f32_16x16x32_bf16 v[16:19], v[156:159], v[52:55], v[16:19]
    v_permlane16_swap_b32 v100, v101
    v_mfma_f32_16x16x32_bf16 v[12:15], v[152:155], v[52:55], v[12:15]
    v_add_f32 v100, v100, v101
    v_mov_b32 v101, v100
    v_mfma_f32_16x16x32_bf16 v[12:15], v[140:143], v[48:51], v[12:15]
    s_nop 0
    v_permlane32_swap_b32 v100, v101
    v_mfma_f32_16x16x32_bf16 v[8:11], v[136:139], v[48:51], v[8:11]
    ds_read_b128 v[48:51], v2 offset:26624
    v_add_f32 v100, v100, v101
    v_mfma_f32_16x16x32_bf16 v[8:11], v[148:151], v[52:55], v[8:11]
    ds_read_b128 v[52:55], v2 offset:27648
    s_waitcnt lgkmcnt(2)
    v_mfma_f32_16x16x32_bf16 v[8:11], v[160:163], v[40:43], v[8:11]
    v_mul_f32 v100, 0x3a800000, v100
    v_mov_b32 v101, v100
    v_mfma_f32_16x16x32_bf16 v[8:11], v[172:175], v[44:47], v[8:11]
    s_nop 0
    v_permlane16_swap_b32 v100, v101
    v_mfma_f32_16x16x32_bf16 v[12:15], v[176:179], v[44:47], v[12:15]
    v_fma_f32 v101, -v100, v100, v101
    v_max_f32 v101, 0, v101
    v_mfma_f32_16x16x32_bf16 v[12:15], v[164:167], v[40:43], v[12:15]
    v_add_f32 v101, 0x3727c5ac, v101
    v_mfma_f32_16x16x32_bf16 v[16:19], v[168:171], v[40:43], v[16:19]
    ds_read_b128 v[40:43], v2 offset:28672
    v_mfma_f32_16x16x32_bf16 v[16:19], v[180:183], v[44:47], v[16:19]
    ds_read_b128 v[44:47], v2 offset:29696
    s_waitcnt lgkmcnt(2)
    v_mfma_f32_16x16x32_bf16 v[16:19], v[192:195], v[48:51], v[16:19]
    v_rsq_f32 v21, v101
    v_mfma_f32_16x16x32_bf16 v[16:19], v[204:207], v[52:55], v[16:19]
    v_mul_f32 v100, v100, v21
    v_fma_f32 v80, -v100, v56, v68
    v_mfma_f32_16x16x32_bf16 v[12:15], v[200:203], v[52:55], v[12:15]
    v_fma_f32 v81, -v100, v57, v69
    v_fma_f32 v82, -v100, v58, v70
    v_mfma_f32_16x16x32_bf16 v[12:15], v[188:191], v[48:51], v[12:15]
    v_fma_f32 v83, -v100, v59, v71
    v_fma_f32 v84, -v100, v60, v72
    v_mfma_f32_16x16x32_bf16 v[8:11], v[184:187], v[48:51], v[8:11]
    ds_read_b128 v[48:51], v2 offset:30720
    v_fma_f32 v85, -v100, v61, v73
    v_mfma_f32_16x16x32_bf16 v[8:11], v[196:199], v[52:55], v[8:11]
    ds_read_b128 v[52:55], v2 offset:31744
    s_waitcnt lgkmcnt(2)
    v_mfma_f32_16x16x32_bf16 v[8:11], v[208:211], v[40:43], v[8:11]
    s_waitcnt vmcnt(6)
    v_fma_f32 v86, -v100, v62, v74
    v_fma_f32 v87, -v100, v63, v75
    v_mfma_f32_16x16x32_bf16 v[8:11], v[220:223], v[44:47], v[8:11]
    v_fma_f32 v88, -v100, v64, v76
    v_fma_f32 v89, -v100, v65, v77
    v_mfma_f32_16x16x32_bf16 v[12:15], v[224:227], v[44:47], v[12:15]
    s_barrier
    v_mfma_f32_16x16x32_bf16 v[12:15], v[212:215], v[40:43], v[12:15]
    s_waitcnt vmcnt(5)
    buffer_store_dword v6, v22, s[12:15], s17 offen sc1
    v_mfma_f32_16x16x32_bf16 v[16:19], v[216:219], v[40:43], v[16:19]
    ds_read_b128 v[40:43], v3 offset:0
    v_fma_f32 v90, -v100, v66, v78
    v_mfma_f32_16x16x32_bf16 v[16:19], v[228:231], v[44:47], v[16:19]
    ds_read_b128 v[44:47], v3 offset:1024
    s_waitcnt lgkmcnt(2)
    v_mfma_f32_16x16x32_bf16 v[16:19], v[240:243], v[48:51], v[16:19]
    s_mov_b32 s14, s6
    v_fma_f32 v91, -v100, v67, v79
    s_add_u32 s17, s17, 8192
    v_mfma_f32_16x16x32_bf16 v[16:19], v[252:255], v[52:55], v[16:19]
    v_mfma_f32_16x16x32_bf16 v[12:15], v[248:251], v[52:55], v[12:15]
    v_mfma_f32_16x16x32_bf16 v[12:15], v[236:239], v[48:51], v[12:15]
    v_mfma_f32_16x16x32_bf16 v[8:11], v[232:235], v[48:51], v[8:11]
    ds_read_b128 v[48:51], v3 offset:2048
    v_mfma_f32_16x16x32_bf16 v[8:11], v[244:247], v[52:55], v[8:11]
    ds_read_b128 v[52:55], v3 offset:3072
Lffa_body12:
    s_waitcnt lgkmcnt(2)
    v_mfma_f32_16x16x32_bf16 v[24:27], a[0:3], v[40:43], 0
    s_add_u32 m0, s34, 0
    v_fma_f32 v124, v16, v21, v88
    v_fma_f32 v125, v17, v21, v89
    v_mfma_f32_16x16x32_bf16 v[24:27], a[12:15], v[44:47], v[24:27]
    s_add_u32 s31, s31, 1
    v_mov_b32 v6, s31
    v_fma_f32 v126, v18, v21, v90
    v_mfma_f32_16x16x32_bf16 v[28:31], a[16:19], v[44:47], 0
    s_add_u32 s35, s35, 36864
    v_fma_f32 v127, v19, v21, v91
    v_mul_f32 v124, v124, |v124|
    v_mfma_f32_16x16x32_bf16 v[28:31], a[4:7], v[40:43], v[28:31]
    s_cmp_eq_u32 s35, 147456
    s_cselect_b32 s35, 0, s35
    v_mul_f32 v125, v125, |v125|
    v_mfma_f32_16x16x32_bf16 v[32:35], a[8:11], v[40:43], 0
    ds_read_b128 v[40:43], v3 offset:4096
    v_mul_f32 v126, v126, |v126|
    v_mfma_f32_16x16x32_bf16 v[32:35], a[20:23], v[44:47], v[32:35]
    ds_read_b128 v[44:47], v3 offset:5120
    s_waitcnt lgkmcnt(2)
    v_mfma_f32_16x16x32_bf16 v[32:35], a[32:35], v[48:51], v[32:35]
    v_mul_f32 v127, v127, |v127|
    v_cvt_pk_bf16_f32 v124, v124, v125
    v_mfma_f32_16x16x32_bf16 v[32:35], a[44:47], v[52:55], v[32:35]
    v_cvt_pk_bf16_f32 v126, v126, v127
    v_pk_max_i16 v96, v124, 0
    v_mfma_f32_16x16x32_bf16 v[28:31], a[40:43], v[52:55], v[28:31]
    v_pk_max_i16 v97, v126, 0
    v_pk_max_i16 v98, v124, 0
    v_mfma_f32_16x16x32_bf16 v[28:31], a[28:31], v[48:51], v[28:31]
    v_pk_max_i16 v99, v126, 0
    v_fma_f32 v116, v8, v21, v80
    v_mfma_f32_16x16x32_bf16 v[24:27], a[24:27], v[48:51], v[24:27]
    ds_read_b128 v[48:51], v3 offset:6144
    v_fma_f32 v117, v9, v21, v81
    v_mfma_f32_16x16x32_bf16 v[24:27], a[36:39], v[52:55], v[24:27]
    ds_read_b128 v[52:55], v3 offset:7168
    s_waitcnt lgkmcnt(2)
    v_mfma_f32_16x16x32_bf16 v[24:27], a[48:51], v[40:43], v[24:27]
    v_permlane32_swap_b32 v96, v98
    v_mfma_f32_16x16x32_bf16 v[24:27], a[60:63], v[44:47], v[24:27]
    v_permlane32_swap_b32 v97, v99
    v_mfma_f32_16x16x32_bf16 v[28:31], a[64:67], v[44:47], v[28:31]
    buffer_store_dwordx4 v[96:99], v7, s[12:15], s36 offen sc1
    v_fma_f32 v118, v10, v21, v82
    v_mfma_f32_16x16x32_bf16 v[28:31], a[52:55], v[40:43], v[28:31]
    s_waitcnt vmcnt(2)
    v_cmp_gt_i32 vcc, s32, v5
    v_fma_f32 v119, v11, v21, v83
    v_mfma_f32_16x16x32_bf16 v[32:35], a[56:59], v[40:43], v[32:35]
    ds_read_b128 v[40:43], v3 offset:8192
    v_fma_f32 v120, v12, v21, v84
    v_mfma_f32_16x16x32_bf16 v[32:35], a[68:71], v[44:47], v[32:35]
    ds_read_b128 v[44:47], v3 offset:9216
    s_waitcnt lgkmcnt(2)
    v_mfma_f32_16x16x32_bf16 v[32:35], a[80:83], v[48:51], v[32:35]
    s_and_b64 vcc, vcc, s[18:19]
    s_cbranch_scc1 Lffa_v11
    v_mfma_f32_16x16x32_bf16 v[32:35], a[92:95], v[52:55], v[32:35]
    buffer_load_dwordx4 v1, s[8:11], s33 offen offset:0 sc1 lds
    v_mfma_f32_16x16x32_bf16 v[28:31], a[88:91], v[52:55], v[28:31]
    v_fma_f32 v121, v13, v21, v85
    v_fma_f32 v122, v14, v21, v86
    v_mfma_f32_16x16x32_bf16 v[28:31], a[76:79], v[48:51], v[28:31]
    v_fma_f32 v123, v15, v21, v87
    v_mul_f32 v116, v116, |v116|
    v_mfma_f32_16x16x32_bf16 v[24:27], a[72:75], v[48:51], v[24:27]
    ds_read_b128 v[48:51], v3 offset:10240
    v_mul_f32 v117, v117, |v117|
    v_mfma_f32_16x16x32_bf16 v[24:27], a[84:87], v[52:55], v[24:27]
    ds_read_b128 v[52:55], v3 offset:11264
    s_waitcnt lgkmcnt(2)
    v_mfma_f32_16x16x32_bf16 v[24:27], a[96:99], v[40:43], v[24:27]
    buffer_load_dwordx4 v1, s[8:11], s33 offen offset:1024 sc1 lds
    v_mfma_f32_16x16x32_bf16 v[24:27], a[108:111], v[44:47], v[24:27]
    v_mul_f32 v118, v118, |v118|
    v_mul_f32 v119, v119, |v119|
    v_mfma_f32_16x16x32_bf16 v[28:31], a[112:115], v[44:47], v[28:31]
    v_mul_f32 v120, v120, |v120|
    v_mul_f32 v121, v121, |v121|
    v_mfma_f32_16x16x32_bf16 v[28:31], a[100:103], v[40:43], v[28:31]
    buffer_load_dwordx4 v1, s[8:11], s33 offen offset:2048 sc1 lds
    v_mfma_f32_16x16x32_bf16 v[32:35], a[104:107], v[40:43], v[32:35]
    ds_read_b128 v[40:43], v3 offset:12288
    v_mul_f32 v122, v122, |v122|
    v_mfma_f32_16x16x32_bf16 v[32:35], a[116:119], v[44:47], v[32:35]
    ds_read_b128 v[44:47], v3 offset:13312
    s_waitcnt lgkmcnt(2)
    v_mfma_f32_16x16x32_bf16 v[32:35], a[128:131], v[48:51], v[32:35]
    buffer_load_dwordx4 v1, s[8:11], s33 offen offset:3072 sc1 lds
    v_mfma_f32_16x16x32_bf16 v[32:35], a[140:143], v[52:55], v[32:35]
    s_add_u32 m0, s34, s3
    s_add_u32 s37, s33, s3
    v_sub_u32 v100, v3, v20
    v_mfma_f32_16x16x32_bf16 v[28:31], a[136:139], v[52:55], v[28:31]
    ds_read2st64_b64 v[112:115], v100 offset0:70 offset1:71
    v_mul_f32 v123, v123, |v123|
    v_mfma_f32_16x16x32_bf16 v[28:31], a[124:127], v[48:51], v[28:31]
    buffer_load_dwordx4 v1, s[8:11], s37 offen offset:0 sc1 lds
    v_mfma_f32_16x16x32_bf16 v[24:27], a[120:123], v[48:51], v[24:27]
    ds_read_b128 v[48:51], v3 offset:14336
    s_add_u32 s16, s16, 8192
    v_mfma_f32_16x16x32_bf16 v[24:27], a[132:135], v[52:55], v[24:27]
    ds_read_b128 v[52:55], v3 offset:15360
    s_waitcnt lgkmcnt(3)
    v_mfma_f32_16x16x32_bf16 v[24:27], a[144:147], v[40:43], v[24:27]
    s_waitcnt vmcnt(6)
    s_add_u32 m0, s34, 16384
    s_add_u32 s37, s33, 16384
    v_mfma_f32_16x16x32_bf16 v[24:27], a[156:159], v[44:47], v[24:27]
    ds_read2st64_b64 v[108:111], v100 offset0:68 offset1:69
    v_cvt_pk_bf16_f32 v116, v116, v117
    v_mfma_f32_16x16x32_bf16 v[28:31], a[160:163], v[44:47], v[28:31]
    s_barrier
    v_mfma_f32_16x16x32_bf16 v[28:31], a[148:151], v[40:43], v[28:31]
    ds_read2st64_b64 v[104:107], v100 offset0:66 offset1:67
    v_cvt_pk_bf16_f32 v118, v118, v119
    v_mfma_f32_16x16x32_bf16 v[32:35], a[152:155], v[40:43], v[32:35]
    ds_read_b128 v[40:43], v3 offset:16384
    v_cvt_pk_bf16_f32 v120, v120, v121
    v_mfma_f32_16x16x32_bf16 v[32:35], a[164:167], v[44:47], v[32:35]
    ds_read_b128 v[44:47], v3 offset:17408
    s_waitcnt lgkmcnt(4)
    v_mfma_f32_16x16x32_bf16 v[32:35], a[176:179], v[48:51], v[32:35]
    ds_read2st64_b64 v[100:103], v100 offset0:64 offset1:65
    v_cvt_pk_bf16_f32 v122, v122, v123
    v_mfma_f32_16x16x32_bf16 v[32:35], a[188:191], v[52:55], v[32:35]
    v_pk_max_i16 v92, v116, 0
    v_pk_max_i16 v93, v118, 0
    v_mfma_f32_16x16x32_bf16 v[28:31], a[184:187], v[52:55], v[28:31]
    v_pk_max_i16 v94, v120, 0
    v_pk_max_i16 v95, v122, 0
    v_mfma_f32_16x16x32_bf16 v[28:31], a[172:175], v[48:51], v[28:31]
    buffer_store_dwordx4 v[92:95], v1, s[12:15], s36 offen sc1
    v_add_u32 v2, s35, v1
    v_mfma_f32_16x16x32_bf16 v[24:27], a[168:171], v[48:51], v[24:27]
    ds_read_b128 v[48:51], v3 offset:18432
    s_add_u32 s36, s36, 116736
    v_mfma_f32_16x16x32_bf16 v[24:27], a[180:183], v[52:55], v[24:27]
    ds_read_b128 v[52:55], v3 offset:19456
    s_waitcnt lgkmcnt(3)
    v_mfma_f32_16x16x32_bf16 v[24:27], a[192:195], v[40:43], v[24:27]
    buffer_load_dwordx4 v1, s[8:11], s37 offen offset:0 sc1 lds
    v_mfma_f32_16x16x32_bf16 v[24:27], a[204:207], v[44:47], v[24:27]
    s_waitcnt lgkmcnt(2)
    v_add_f32 v100, v100, v108
    v_add_f32 v101, v101, v109
    v_mfma_f32_16x16x32_bf16 v[28:31], a[208:211], v[44:47], v[28:31]
    v_add_f32 v102, v102, v110
    v_add_f32 v103, v103, v111
    v_mfma_f32_16x16x32_bf16 v[28:31], a[196:199], v[40:43], v[28:31]
    buffer_load_dwordx4 v1, s[8:11], s37 offen offset:1024 sc1 lds
    v_mfma_f32_16x16x32_bf16 v[32:35], a[200:203], v[40:43], v[32:35]
    ds_read_b128 v[40:43], v3 offset:20480
    v_add_f32 v104, v104, v112
    v_mfma_f32_16x16x32_bf16 v[32:35], a[212:215], v[44:47], v[32:35]
    ds_read_b128 v[44:47], v3 offset:21504
    s_waitcnt lgkmcnt(2)
    v_mfma_f32_16x16x32_bf16 v[32:35], a[224:227], v[48:51], v[32:35]
    buffer_load_dwordx4 v1, s[8:11], s37 offen offset:2048 sc1 lds
    v_mfma_f32_16x16x32_bf16 v[32:35], a[236:239], v[52:55], v[32:35]
    v_add_f32 v105, v105, v113
    v_add_f32 v106, v106, v114
    v_mfma_f32_16x16x32_bf16 v[28:31], a[232:235], v[52:55], v[28:31]
    v_add_f32 v107, v107, v115
    v_add_f32 v100, v100, v104
    v_mfma_f32_16x16x32_bf16 v[28:31], a[220:223], v[48:51], v[28:31]
    buffer_load_dwordx4 v1, s[8:11], s37 offen offset:3072 sc1 lds
    v_mfma_f32_16x16x32_bf16 v[24:27], a[216:219], v[48:51], v[24:27]
    ds_read_b128 v[48:51], v3 offset:22528
    s_add_u32 s32, s32, 1
    v_mfma_f32_16x16x32_bf16 v[24:27], a[228:231], v[52:55], v[24:27]
    ds_read_b128 v[52:55], v3 offset:23552
    s_waitcnt lgkmcnt(2)
    v_mfma_f32_16x16x32_bf16 v[24:27], a[240:243], v[40:43], v[24:27]
    s_add_u32 s33, s33, 36864
    s_add_u32 s34, s34, 36864
    v_add_f32 v101, v101, v105
    v_mfma_f32_16x16x32_bf16 v[24:27], a[252:255], v[44:47], v[24:27]
    s_cmp_ge_u32 s34, 147456
    s_cselect_b32 s38, 147456, 0
    s_sub_u32 s34, s34, s38
    v_mfma_f32_16x16x32_bf16 v[28:31], v[128:131], v[44:47], v[28:31]
    v_add_f32 v102, v102, v106
    v_add_f32 v103, v103, v107
    v_mfma_f32_16x16x32_bf16 v[28:31], a[244:247], v[40:43], v[28:31]
    v_add_f32 v100, v100, v102
    v_add_f32 v101, v101, v103
    v_mfma_f32_16x16x32_bf16 v[32:35], a[248:251], v[40:43], v[32:35]
    ds_read_b128 v[40:43], v3 offset:24576
    v_mfma_f32_16x16x32_bf16 v[32:35], v[132:135], v[44:47], v[32:35]
    ds_read_b128 v[44:47], v3 offset:25600
    s_waitcnt lgkmcnt(2)
    v_mfma_f32_16x16x32_bf16 v[32:35], v[144:147], v[48:51], v[32:35]
    buffer_load_dword v5, v4, s[4:7], s16 offen sc1
    v_mfma_f32_16x16x32_bf16 v[32:35], v[156:159], v[52:55], v[32:35]
    v_permlane16_swap_b32 v100, v101
    v_mfma_f32_16x16x32_bf16 v[28:31], v[152:155], v[52:55], v[28:31]
    v_add_f32 v100, v100, v101
    v_mov_b32 v101, v100
    v_mfma_f32_16x16x32_bf16 v[28:31], v[140:143], v[48:51], v[28:31]
    s_nop 0
    v_permlane32_swap_b32 v100, v101
    v_mfma_f32_16x16x32_bf16 v[24:27], v[136:139], v[48:51], v[24:27]
    ds_read_b128 v[48:51], v3 offset:26624
    v_add_f32 v100, v100, v101
    v_mfma_f32_16x16x32_bf16 v[24:27], v[148:151], v[52:55], v[24:27]
    ds_read_b128 v[52:55], v3 offset:27648
    s_waitcnt lgkmcnt(2)
    v_mfma_f32_16x16x32_bf16 v[24:27], v[160:163], v[40:43], v[24:27]
    v_mul_f32 v100, 0x3a800000, v100
    v_mov_b32 v101, v100
    v_mfma_f32_16x16x32_bf16 v[24:27], v[172:175], v[44:47], v[24:27]
    s_nop 0
    v_permlane16_swap_b32 v100, v101
    v_mfma_f32_16x16x32_bf16 v[28:31], v[176:179], v[44:47], v[28:31]
    v_fma_f32 v101, -v100, v100, v101
    v_max_f32 v101, 0, v101
    v_mfma_f32_16x16x32_bf16 v[28:31], v[164:167], v[40:43], v[28:31]
    v_add_f32 v101, 0x3727c5ac, v101
    v_mfma_f32_16x16x32_bf16 v[32:35], v[168:171], v[40:43], v[32:35]
    ds_read_b128 v[40:43], v3 offset:28672
    v_mfma_f32_16x16x32_bf16 v[32:35], v[180:183], v[44:47], v[32:35]
    ds_read_b128 v[44:47], v3 offset:29696
    s_waitcnt lgkmcnt(2)
    v_mfma_f32_16x16x32_bf16 v[32:35], v[192:195], v[48:51], v[32:35]
    v_rsq_f32 v21, v101
    v_mfma_f32_16x16x32_bf16 v[32:35], v[204:207], v[52:55], v[32:35]
    v_mul_f32 v100, v100, v21
    v_fma_f32 v80, -v100, v56, v68
    v_mfma_f32_16x16x32_bf16 v[28:31], v[200:203], v[52:55], v[28:31]
    v_fma_f32 v81, -v100, v57, v69
    v_fma_f32 v82, -v100, v58, v70
    v_mfma_f32_16x16x32_bf16 v[28:31], v[188:191], v[48:51], v[28:31]
    v_fma_f32 v83, -v100, v59, v71
    v_fma_f32 v84, -v100, v60, v72
    v_mfma_f32_16x16x32_bf16 v[24:27], v[184:187], v[48:51], v[24:27]
    ds_read_b128 v[48:51], v3 offset:30720
    v_fma_f32 v85, -v100, v61, v73
    v_mfma_f32_16x16x32_bf16 v[24:27], v[196:199], v[52:55], v[24:27]
    ds_read_b128 v[52:55], v3 offset:31744
    s_waitcnt lgkmcnt(2)
    v_mfma_f32_16x16x32_bf16 v[24:27], v[208:211], v[40:43], v[24:27]
    s_waitcnt vmcnt(6)
    v_fma_f32 v86, -v100, v62, v74
    v_fma_f32 v87, -v100, v63, v75
    v_mfma_f32_16x16x32_bf16 v[24:27], v[220:223], v[44:47], v[24:27]
    v_fma_f32 v88, -v100, v64, v76
    v_fma_f32 v89, -v100, v65, v77
    v_mfma_f32_16x16x32_bf16 v[28:31], v[224:227], v[44:47], v[28:31]
    s_barrier
    v_mfma_f32_16x16x32_bf16 v[28:31], v[212:215], v[40:43], v[28:31]
    s_waitcnt vmcnt(5)
    buffer_store_dword v6, v22, s[12:15], s17 offen sc1
    v_mfma_f32_16x16x32_bf16 v[32:35], v[216:219], v[40:43], v[32:35]
    ds_read_b128 v[40:43], v2 offset:0
    v_fma_f32 v90, -v100, v66, v78
    v_mfma_f32_16x16x32_bf16 v[32:35], v[228:231], v[44:47], v[32:35]
    ds_read_b128 v[44:47], v2 offset:1024
    s_waitcnt lgkmcnt(2)
    v_mfma_f32_16x16x32_bf16 v[32:35], v[240:243], v[48:51], v[32:35]
    s_mov_b32 s14, s6
    v_fma_f32 v91, -v100, v67, v79
    s_add_u32 s17, s17, 8192
    v_mfma_f32_16x16x32_bf16 v[32:35], v[252:255], v[52:55], v[32:35]
    v_mfma_f32_16x16x32_bf16 v[28:31], v[248:251], v[52:55], v[28:31]
    v_mfma_f32_16x16x32_bf16 v[28:31], v[236:239], v[48:51], v[28:31]
    v_mfma_f32_16x16x32_bf16 v[24:27], v[232:235], v[48:51], v[24:27]
    ds_read_b128 v[48:51], v2 offset:2048
    v_mfma_f32_16x16x32_bf16 v[24:27], v[244:247], v[52:55], v[24:27]
    ds_read_b128 v[52:55], v2 offset:3072
    s_cmp_lt_i32 s31, 63
    s_cbranch_scc1 Lffa_body02
    s_branch L_exit
    .p2align 6
Lffa_body03:
    s_waitcnt lgkmcnt(2)
    v_mfma_f32_16x16x32_bf16 v[8:11], a[0:3], v[40:43], 0
    s_add_u32 m0, s34, 0
    v_fma_f32 v124, v32, v21, v88
    v_fma_f32 v125, v33, v21, v89
    v_mfma_f32_16x16x32_bf16 v[8:11], a[12:15], v[44:47], v[8:11]
    s_add_u32 s31, s31, 1
    v_mov_b32 v6, s31
    v_fma_f32 v126, v34, v21, v90
    v_mfma_f32_16x16x32_bf16 v[12:15], a[16:19], v[44:47], 0
    s_add_u32 s35, s35, 36864
    v_fma_f32 v127, v35, v21, v91
    v_mul_f32 v124, v124, |v124|
    v_mfma_f32_16x16x32_bf16 v[12:15], a[4:7], v[40:43], v[12:15]
    s_cmp_eq_u32 s35, 147456
    s_cselect_b32 s35, 0, s35
    v_mul_f32 v125, v125, |v125|
    v_mfma_f32_16x16x32_bf16 v[16:19], a[8:11], v[40:43], 0
    ds_read_b128 v[40:43], v2 offset:4096
    v_mul_f32 v126, v126, |v126|
    v_mfma_f32_16x16x32_bf16 v[16:19], a[20:23], v[44:47], v[16:19]
    ds_read_b128 v[44:47], v2 offset:5120
    s_waitcnt lgkmcnt(2)
    v_mfma_f32_16x16x32_bf16 v[16:19], a[32:35], v[48:51], v[16:19]
    v_mul_f32 v127, v127, |v127|
    v_cvt_pk_bf16_f32 v124, v124, v125
    v_mfma_f32_16x16x32_bf16 v[16:19], a[44:47], v[52:55], v[16:19]
    v_cvt_pk_bf16_f32 v126, v126, v127
    v_pk_max_i16 v96, v124, 0
    v_mfma_f32_16x16x32_bf16 v[12:15], a[40:43], v[52:55], v[12:15]
    v_pk_max_i16 v97, v126, 0
    v_pk_max_i16 v98, v124, 0
    v_mfma_f32_16x16x32_bf16 v[12:15], a[28:31], v[48:51], v[12:15]
    v_pk_max_i16 v99, v126, 0
    v_fma_f32 v116, v24, v21, v80
    v_mfma_f32_16x16x32_bf16 v[8:11], a[24:27], v[48:51], v[8:11]
    ds_read_b128 v[48:51], v2 offset:6144
    v_fma_f32 v117, v25, v21, v81
    v_mfma_f32_16x16x32_bf16 v[8:11], a[36:39], v[52:55], v[8:11]
    ds_read_b128 v[52:55], v2 offset:7168
    s_waitcnt lgkmcnt(2)
    v_mfma_f32_16x16x32_bf16 v[8:11], a[48:51], v[40:43], v[8:11]
    v_permlane32_swap_b32 v96, v98
    v_mfma_f32_16x16x32_bf16 v[8:11], a[60:63], v[44:47], v[8:11]
    v_permlane32_swap_b32 v97, v99
    v_mfma_f32_16x16x32_bf16 v[12:15], a[64:67], v[44:47], v[12:15]
    buffer_store_dwordx4 v[96:99], v7, s[12:15], s36 offen sc1
    v_fma_f32 v118, v26, v21, v82
    v_mfma_f32_16x16x32_bf16 v[12:15], a[52:55], v[40:43], v[12:15]
    s_waitcnt vmcnt(2)
    v_cmp_gt_i32 vcc, s32, v5
    v_fma_f32 v119, v27, v21, v83
    v_mfma_f32_16x16x32_bf16 v[16:19], a[56:59], v[40:43], v[16:19]
    ds_read_b128 v[40:43], v2 offset:8192
    v_fma_f32 v120, v28, v21, v84
    v_mfma_f32_16x16x32_bf16 v[16:19], a[68:71], v[44:47], v[16:19]
    ds_read_b128 v[44:47], v2 offset:9216
    s_waitcnt lgkmcnt(2)
    v_mfma_f32_16x16x32_bf16 v[16:19], a[80:83], v[48:51], v[16:19]
    s_and_b64 vcc, vcc, s[18:19]
    s_cbranch_scc1 Lffa_v01
    v_mfma_f32_16x16x32_bf16 v[16:19], a[92:95], v[52:55], v[16:19]
    buffer_load_dwordx4 v1, s[8:11], s33 offen offset:0 sc1 lds
    v_mfma_f32_16x16x32_bf16 v[12:15], a[88:91], v[52:55], v[12:15]
    v_fma_f32 v121, v29, v21, v85
    v_fma_f32 v122, v30, v21, v86
    v_mfma_f32_16x16x32_bf16 v[12:15], a[76:79], v[48:51], v[12:15]
    v_fma_f32 v123, v31, v21, v87
    v_mul_f32 v116, v116, |v116|
    v_mfma_f32_16x16x32_bf16 v[8:11], a[72:75], v[48:51], v[8:11]
    ds_read_b128 v[48:51], v2 offset:10240
    v_mul_f32 v117, v117, |v117|
    v_mfma_f32_16x16x32_bf16 v[8:11], a[84:87], v[52:55], v[8:11]
    ds_read_b128 v[52:55], v2 offset:11264
    s_waitcnt lgkmcnt(2)
    v_mfma_f32_16x16x32_bf16 v[8:11], a[96:99], v[40:43], v[8:11]
    buffer_load_dwordx4 v1, s[8:11], s33 offen offset:1024 sc1 lds
    v_mfma_f32_16x16x32_bf16 v[8:11], a[108:111], v[44:47], v[8:11]
    v_mul_f32 v118, v118, |v118|
    v_mul_f32 v119, v119, |v119|
    v_mfma_f32_16x16x32_bf16 v[12:15], a[112:115], v[44:47], v[12:15]
    v_mul_f32 v120, v120, |v120|
    v_mul_f32 v121, v121, |v121|
    v_mfma_f32_16x16x32_bf16 v[12:15], a[100:103], v[40:43], v[12:15]
    buffer_load_dwordx4 v1, s[8:11], s33 offen offset:2048 sc1 lds
    v_mfma_f32_16x16x32_bf16 v[16:19], a[104:107], v[40:43], v[16:19]
    ds_read_b128 v[40:43], v2 offset:12288
    v_mul_f32 v122, v122, |v122|
    v_mfma_f32_16x16x32_bf16 v[16:19], a[116:119], v[44:47], v[16:19]
    ds_read_b128 v[44:47], v2 offset:13312
    s_waitcnt lgkmcnt(2)
    v_mfma_f32_16x16x32_bf16 v[16:19], a[128:131], v[48:51], v[16:19]
    buffer_load_dwordx4 v1, s[8:11], s33 offen offset:3072 sc1 lds
    v_mfma_f32_16x16x32_bf16 v[16:19], a[140:143], v[52:55], v[16:19]
    s_add_u32 m0, s34, s3
    s_add_u32 s37, s33, s3
    v_sub_u32 v100, v2, v20
    v_mfma_f32_16x16x32_bf16 v[12:15], a[136:139], v[52:55], v[12:15]
    ds_read2st64_b64 v[112:115], v100 offset0:70 offset1:71
    v_mul_f32 v123, v123, |v123|
    v_mfma_f32_16x16x32_bf16 v[12:15], a[124:127], v[48:51], v[12:15]
    buffer_load_dwordx4 v1, s[8:11], s37 offen offset:0 sc1 lds
    v_mfma_f32_16x16x32_bf16 v[8:11], a[120:123], v[48:51], v[8:11]
    ds_read_b128 v[48:51], v2 offset:14336
    s_add_u32 s16, s16, 8192
    v_mfma_f32_16x16x32_bf16 v[8:11], a[132:135], v[52:55], v[8:11]
    ds_read_b128 v[52:55], v2 offset:15360
    s_waitcnt lgkmcnt(3)
    v_mfma_f32_16x16x32_bf16 v[8:11], a[144:147], v[40:43], v[8:11]
    s_waitcnt vmcnt(6)
    s_add_u32 m0, s34, 16384
    s_add_u32 s37, s33, 16384
    v_mfma_f32_16x16x32_bf16 v[8:11], a[156:159], v[44:47], v[8:11]
    ds_read2st64_b64 v[108:111], v100 offset0:68 offset1:69
    v_cvt_pk_bf16_f32 v116, v116, v117
    v_mfma_f32_16x16x32_bf16 v[12:15], a[160:163], v[44:47], v[12:15]
    ds_read2st64_b64 v[104:107], v100 offset0:66 offset1:67
    v_cvt_pk_bf16_f32 v118, v118, v119
    v_mfma_f32_16x16x32_bf16 v[12:15], a[148:151], v[40:43], v[12:15]
    s_barrier
    v_mfma_f32_16x16x32_bf16 v[16:19], a[152:155], v[40:43], v[16:19]
    ds_read_b128 v[40:43], v2 offset:16384
    v_cvt_pk_bf16_f32 v120, v120, v121
    v_mfma_f32_16x16x32_bf16 v[16:19], a[164:167], v[44:47], v[16:19]
    ds_read_b128 v[44:47], v2 offset:17408
    s_waitcnt lgkmcnt(4)
    v_mfma_f32_16x16x32_bf16 v[16:19], a[176:179], v[48:51], v[16:19]
    ds_read2st64_b64 v[100:103], v100 offset0:64 offset1:65
    v_cvt_pk_bf16_f32 v122, v122, v123
    v_mfma_f32_16x16x32_bf16 v[16:19], a[188:191], v[52:55], v[16:19]
    v_pk_max_i16 v92, v116, 0
    v_pk_max_i16 v93, v118, 0
    v_mfma_f32_16x16x32_bf16 v[12:15], a[184:187], v[52:55], v[12:15]
    v_pk_max_i16 v94, v120, 0
    v_pk_max_i16 v95, v122, 0
    v_mfma_f32_16x16x32_bf16 v[12:15], a[172:175], v[48:51], v[12:15]
    buffer_store_dwordx4 v[92:95], v1, s[12:15], s36 offen sc1
    v_add_u32 v3, s35, v1
    v_mfma_f32_16x16x32_bf16 v[8:11], a[168:171], v[48:51], v[8:11]
    ds_read_b128 v[48:51], v2 offset:18432
    s_add_u32 s36, s36, 116736
    v_mfma_f32_16x16x32_bf16 v[8:11], a[180:183], v[52:55], v[8:11]
    ds_read_b128 v[52:55], v2 offset:19456
    s_waitcnt lgkmcnt(3)
    v_mfma_f32_16x16x32_bf16 v[8:11], a[192:195], v[40:43], v[8:11]
    buffer_load_dwordx4 v1, s[8:11], s37 offen offset:0 sc1 lds
    v_mfma_f32_16x16x32_bf16 v[8:11], a[204:207], v[44:47], v[8:11]
    s_waitcnt lgkmcnt(2)
    v_add_f32 v100, v100, v108
    v_add_f32 v101, v101, v109
    v_mfma_f32_16x16x32_bf16 v[12:15], a[208:211], v[44:47], v[12:15]
    v_add_f32 v102, v102, v110
    v_add_f32 v103, v103, v111
    v_mfma_f32_16x16x32_bf16 v[12:15], a[196:199], v[40:43], v[12:15]
    buffer_load_dwordx4 v1, s[8:11], s37 offen offset:1024 sc1 lds
    v_mfma_f32_16x16x32_bf16 v[16:19], a[200:203], v[40:43], v[16:19]
    ds_read_b128 v[40:43], v2 offset:20480
    v_add_f32 v104, v104, v112
    v_mfma_f32_16x16x32_bf16 v[16:19], a[212:215], v[44:47], v[16:19]
    ds_read_b128 v[44:47], v2 offset:21504
    s_waitcnt lgkmcnt(2)
    v_mfma_f32_16x16x32_bf16 v[16:19], a[224:227], v[48:51], v[16:19]
    buffer_load_dwordx4 v1, s[8:11], s37 offen offset:2048 sc1 lds
    v_mfma_f32_16x16x32_bf16 v[16:19], a[236:239], v[52:55], v[16:19]
    v_add_f32 v105, v105, v113
    v_add_f32 v106, v106, v114
    v_mfma_f32_16x16x32_bf16 v[12:15], a[232:235], v[52:55], v[12:15]
    v_add_f32 v107, v107, v115
    v_add_f32 v100, v100, v104
    v_mfma_f32_16x16x32_bf16 v[12:15], a[220:223], v[48:51], v[12:15]
    buffer_load_dwordx4 v1, s[8:11], s37 offen offset:3072 sc1 lds
    v_mfma_f32_16x16x32_bf16 v[8:11], a[216:219], v[48:51], v[8:11]
    ds_read_b128 v[48:51], v2 offset:22528
    s_add_u32 s32, s32, 1
    v_mfma_f32_16x16x32_bf16 v[8:11], a[228:231], v[52:55], v[8:11]
    ds_read_b128 v[52:55], v2 offset:23552
    s_waitcnt lgkmcnt(2)
    v_mfma_f32_16x16x32_bf16 v[8:11], a[240:243], v[40:43], v[8:11]
    s_add_u32 s33, s33, 36864
    s_add_u32 s34, s34, 36864
    v_add_f32 v101, v101, v105
    v_mfma_f32_16x16x32_bf16 v[8:11], a[252:255], v[44:47], v[8:11]
    s_cmp_ge_u32 s34, 147456
    s_cselect_b32 s38, 147456, 0
    s_sub_u32 s34, s34, s38
    v_mfma_f32_16x16x32_bf16 v[12:15], v[128:131], v[44:47], v[12:15]
    v_add_f32 v102, v102, v106
    v_add_f32 v103, v103, v107
    v_mfma_f32_16x16x32_bf16 v[12:15], a[244:247], v[40:43], v[12:15]
    v_add_f32 v100, v100, v102
    v_add_f32 v101, v101, v103
    v_mfma_f32_16x16x32_bf16 v[16:19], a[248:251], v[40:43], v[16:19]
    ds_read_b128 v[40:43], v2 offset:24576
    v_mfma_f32_16x16x32_bf16 v[16:19], v[132:135], v[44:47], v[16:19]
    ds_read_b128 v[44:47], v2 offset:25600
    s_waitcnt lgkmcnt(2)
    v_mfma_f32_16x16x32_bf16 v[16:19], v[144:147], v[48:51], v[16:19]
    buffer_load_dword v5, v4, s[4:7], s16 offen sc1
    v_mfma_f32_16x16x32_bf16 v[16:19], v[156:159], v[52:55], v[16:19]
    v_permlane16_swap_b32 v100, v101
    v_mfma_f32_16x16x32_bf16 v[12:15], v[152:155], v[52:55], v[12:15]
    v_add_f32 v100, v100, v101
    v_mov_b32 v101, v100
    v_mfma_f32_16x16x32_bf16 v[12:15], v[140:143], v[48:51], v[12:15]
    s_nop 0
    v_permlane32_swap_b32 v100, v101
    v_mfma_f32_16x16x32_bf16 v[8:11], v[136:139], v[48:51], v[8:11]
    ds_read_b128 v[48:51], v2 offset:26624
    v_add_f32 v100, v100, v101
    v_mfma_f32_16x16x32_bf16 v[8:11], v[148:151], v[52:55], v[8:11]
    ds_read_b128 v[52:55], v2 offset:27648
    s_waitcnt lgkmcnt(2)
    v_mfma_f32_16x16x32_bf16 v[8:11], v[160:163], v[40:43], v[8:11]
    v_mul_f32 v100, 0x3a800000, v100
    v_mov_b32 v101, v100
    v_mfma_f32_16x16x32_bf16 v[8:11], v[172:175], v[44:47], v[8:11]
    s_nop 0
    v_permlane16_swap_b32 v100, v101
    v_mfma_f32_16x16x32_bf16 v[12:15], v[176:179], v[44:47], v[12:15]
    v_fma_f32 v101, -v100, v100, v101
    v_max_f32 v101, 0, v101
    v_mfma_f32_16x16x32_bf16 v[12:15], v[164:167], v[40:43], v[12:15]
    v_add_f32 v101, 0x3727c5ac, v101
    v_mfma_f32_16x16x32_bf16 v[16:19], v[168:171], v[40:43], v[16:19]
    ds_read_b128 v[40:43], v2 offset:28672
    v_mfma_f32_16x16x32_bf16 v[16:19], v[180:183], v[44:47], v[16:19]
    ds_read_b128 v[44:47], v2 offset:29696
    s_waitcnt lgkmcnt(2)
    v_mfma_f32_16x16x32_bf16 v[16:19], v[192:195], v[48:51], v[16:19]
    v_rsq_f32 v21, v101
    v_mfma_f32_16x16x32_bf16 v[16:19], v[204:207], v[52:55], v[16:19]
    v_mul_f32 v100, v100, v21
    v_fma_f32 v80, -v100, v56, v68
    v_mfma_f32_16x16x32_bf16 v[12:15], v[200:203], v[52:55], v[12:15]
    v_fma_f32 v81, -v100, v57, v69
    v_fma_f32 v82, -v100, v58, v70
    v_mfma_f32_16x16x32_bf16 v[12:15], v[188:191], v[48:51], v[12:15]
    v_fma_f32 v83, -v100, v59, v71
    v_fma_f32 v84, -v100, v60, v72
    v_mfma_f32_16x16x32_bf16 v[8:11], v[184:187], v[48:51], v[8:11]
    ds_read_b128 v[48:51], v2 offset:30720
    v_fma_f32 v85, -v100, v61, v73
    v_mfma_f32_16x16x32_bf16 v[8:11], v[196:199], v[52:55], v[8:11]
    ds_read_b128 v[52:55], v2 offset:31744
    s_waitcnt lgkmcnt(2)
    v_mfma_f32_16x16x32_bf16 v[8:11], v[208:211], v[40:43], v[8:11]
    s_waitcnt vmcnt(6)
    v_fma_f32 v86, -v100, v62, v74
    v_fma_f32 v87, -v100, v63, v75
    v_mfma_f32_16x16x32_bf16 v[8:11], v[220:223], v[44:47], v[8:11]
    v_fma_f32 v88, -v100, v64, v76
    v_fma_f32 v89, -v100, v65, v77
    v_mfma_f32_16x16x32_bf16 v[12:15], v[224:227], v[44:47], v[12:15]
    v_fma_f32 v90, -v100, v66, v78
    v_fma_f32 v91, -v100, v67, v79
    v_mfma_f32_16x16x32_bf16 v[12:15], v[212:215], v[40:43], v[12:15]
    s_barrier
    v_mfma_f32_16x16x32_bf16 v[16:19], v[216:219], v[40:43], v[16:19]
    ds_read_b128 v[40:43], v3 offset:0
    s_waitcnt vmcnt(5)
    v_mfma_f32_16x16x32_bf16 v[16:19], v[228:231], v[44:47], v[16:19]
    ds_read_b128 v[44:47], v3 offset:1024
    s_waitcnt lgkmcnt(2)
    v_mfma_f32_16x16x32_bf16 v[16:19], v[240:243], v[48:51], v[16:19]
    buffer_store_dword v6, v22, s[12:15], s17 offen sc1
    s_mov_b32 s14, s6
    v_mfma_f32_16x16x32_bf16 v[16:19], v[252:255], v[52:55], v[16:19]
    s_add_u32 s17, s17, 8192
    v_mfma_f32_16x16x32_bf16 v[12:15], v[248:251], v[52:55], v[12:15]
    v_mfma_f32_16x16x32_bf16 v[12:15], v[236:239], v[48:51], v[12:15]
    v_mfma_f32_16x16x32_bf16 v[8:11], v[232:235], v[48:51], v[8:11]
    ds_read_b128 v[48:51], v3 offset:2048
    v_mfma_f32_16x16x32_bf16 v[8:11], v[244:247], v[52:55], v[8:11]
    ds_read_b128 v[52:55], v3 offset:3072
Lffa_body13:
    s_waitcnt lgkmcnt(2)
    v_mfma_f32_16x16x32_bf16 v[24:27], a[0:3], v[40:43], 0
    s_add_u32 m0, s34, 0
    v_fma_f32 v124, v16, v21, v88
    v_fma_f32 v125, v17, v21, v89
    v_mfma_f32_16x16x32_bf16 v[24:27], a[12:15], v[44:47], v[24:27]
    s_add_u32 s31, s31, 1
    v_mov_b32 v6, s31
    v_fma_f32 v126, v18, v21, v90
    v_mfma_f32_16x16x32_bf16 v[28:31], a[16:19], v[44:47], 0
    s_add_u32 s35, s35, 36864
    v_fma_f32 v127, v19, v21, v91
    v_mul_f32 v124, v124, |v124|
    v_mfma_f32_16x16x32_bf16 v[28:31], a[4:7], v[40:43], v[28:31]
    s_cmp_eq_u32 s35, 147456
    s_cselect_b32 s35, 0, s35
    v_mul_f32 v125, v125, |v125|
    v_mfma_f32_16x16x32_bf16 v[32:35], a[8:11], v[40:43], 0
    ds_read_b128 v[40:43], v3 offset:4096
    v_mul_f32 v126, v126, |v126|
    v_mfma_f32_16x16x32_bf16 v[32:35], a[20:23], v[44:47], v[32:35]
    ds_read_b128 v[44:47], v3 offset:5120
    s_waitcnt lgkmcnt(2)
    v_mfma_f32_16x16x32_bf16 v[32:35], a[32:35], v[48:51], v[32:35]
    v_mul_f32 v127, v127, |v127|
    v_cvt_pk_bf16_f32 v124, v124, v125
    v_mfma_f32_16x16x32_bf16 v[32:35], a[44:47], v[52:55], v[32:35]
    v_cvt_pk_bf16_f32 v126, v126, v127
    v_pk_max_i16 v96, v124, 0
    v_mfma_f32_16x16x32_bf16 v[28:31], a[40:43], v[52:55], v[28:31]
    v_pk_max_i16 v97, v126, 0
    v_pk_max_i16 v98, v124, 0
    v_mfma_f32_16x16x32_bf16 v[28:31], a[28:31], v[48:51], v[28:31]
    v_pk_max_i16 v99, v126, 0
    v_fma_f32 v116, v8, v21, v80
    v_mfma_f32_16x16x32_bf16 v[24:27], a[24:27], v[48:51], v[24:27]
    ds_read_b128 v[48:51], v3 offset:6144
    v_fma_f32 v117, v9, v21, v81
    v_mfma_f32_16x16x32_bf16 v[24:27], a[36:39], v[52:55], v[24:27]
    ds_read_b128 v[52:55], v3 offset:7168
    s_waitcnt lgkmcnt(2)
    v_mfma_f32_16x16x32_bf16 v[24:27], a[48:51], v[40:43], v[24:27]
    v_permlane32_swap_b32 v96, v98
    v_mfma_f32_16x16x32_bf16 v[24:27], a[60:63], v[44:47], v[24:27]
    v_permlane32_swap_b32 v97, v99
    v_mfma_f32_16x16x32_bf16 v[28:31], a[64:67], v[44:47], v[28:31]
    buffer_store_dwordx4 v[96:99], v7, s[12:15], s36 offen sc1
    v_fma_f32 v118, v10, v21, v82
    v_mfma_f32_16x16x32_bf16 v[28:31], a[52:55], v[40:43], v[28:31]
    s_waitcnt vmcnt(2)
    v_cmp_gt_i32 vcc, s32, v5
    v_fma_f32 v119, v11, v21, v83
    v_mfma_f32_16x16x32_bf16 v[32:35], a[56:59], v[40:43], v[32:35]
    ds_read_b128 v[40:43], v3 offset:8192
    v_fma_f32 v120, v12, v21, v84
    v_mfma_f32_16x16x32_bf16 v[32:35], a[68:71], v[44:47], v[32:35]
    ds_read_b128 v[44:47], v3 offset:9216
    s_waitcnt lgkmcnt(2)
    v_mfma_f32_16x16x32_bf16 v[32:35], a[80:83], v[48:51], v[32:35]
    s_and_b64 vcc, vcc, s[18:19]
    s_cbranch_scc1 Lffa_v11
    v_mfma_f32_16x16x32_bf16 v[32:35], a[92:95], v[52:55], v[32:35]
    buffer_load_dwordx4 v1, s[8:11], s33 offen offset:0 sc1 lds
    v_mfma_f32_16x16x32_bf16 v[28:31], a[88:91], v[52:55], v[28:31]
    v_fma_f32 v121, v13, v21, v85
    v_fma_f32 v122, v14, v21, v86
    v_mfma_f32_16x16x32_bf16 v[28:31], a[76:79], v[48:51], v[28:31]
    v_fma_f32 v123, v15, v21, v87
    v_mul_f32 v116, v116, |v116|
    v_mfma_f32_16x16x32_bf16 v[24:27], a[72:75], v[48:51], v[24:27]
    ds_read_b128 v[48:51], v3 offset:10240
    v_mul_f32 v117, v117, |v117|
    v_mfma_f32_16x16x32_bf16 v[24:27], a[84:87], v[52:55], v[24:27]
    ds_read_b128 v[52:55], v3 offset:11264
    s_waitcnt lgkmcnt(2)
    v_mfma_f32_16x16x32_bf16 v[24:27], a[96:99], v[40:43], v[24:27]
    buffer_load_dwordx4 v1, s[8:11], s33 offen offset:1024 sc1 lds
    v_mfma_f32_16x16x32_bf16 v[24:27], a[108:111], v[44:47], v[24:27]
    v_mul_f32 v118, v118, |v118|
    v_mul_f32 v119, v119, |v119|
    v_mfma_f32_16x16x32_bf16 v[28:31], a[112:115], v[44:47], v[28:31]
    v_mul_f32 v120, v120, |v120|
    v_mul_f32 v121, v121, |v121|
    v_mfma_f32_16x16x32_bf16 v[28:31], a[100:103], v[40:43], v[28:31]
    buffer_load_dwordx4 v1, s[8:11], s33 offen offset:2048 sc1 lds
    v_mfma_f32_16x16x32_bf16 v[32:35], a[104:107], v[40:43], v[32:35]
    ds_read_b128 v[40:43], v3 offset:12288
    v_mul_f32 v122, v122, |v122|
    v_mfma_f32_16x16x32_bf16 v[32:35], a[116:119], v[44:47], v[32:35]
    ds_read_b128 v[44:47], v3 offset:13312
    s_waitcnt lgkmcnt(2)
    v_mfma_f32_16x16x32_bf16 v[32:35], a[128:131], v[48:51], v[32:35]
    buffer_load_dwordx4 v1, s[8:11], s33 offen offset:3072 sc1 lds
    v_mfma_f32_16x16x32_bf16 v[32:35], a[140:143], v[52:55], v[32:35]
    s_add_u32 m0, s34, s3
    s_add_u32 s37, s33, s3
    v_sub_u32 v100, v3, v20
    v_mfma_f32_16x16x32_bf16 v[28:31], a[136:139], v[52:55], v[28:31]
    ds_read2st64_b64 v[112:115], v100 offset0:70 offset1:71
    v_mul_f32 v123, v123, |v123|
    v_mfma_f32_16x16x32_bf16 v[28:31], a[124:127], v[48:51], v[28:31]
    buffer_load_dwordx4 v1, s[8:11], s37 offen offset:0 sc1 lds
    v_mfma_f32_16x16x32_bf16 v[24:27], a[120:123], v[48:51], v[24:27]
    ds_read_b128 v[48:51], v3 offset:14336
    s_add_u32 s16, s16, 8192
    v_mfma_f32_16x16x32_bf16 v[24:27], a[132:135], v[52:55], v[24:27]
    ds_read_b128 v[52:55], v3 offset:15360
    s_waitcnt lgkmcnt(3)
    v_mfma_f32_16x16x32_bf16 v[24:27], a[144:147], v[40:43], v[24:27]
    s_waitcnt vmcnt(6)
    s_add_u32 m0, s34, 16384
    s_add_u32 s37, s33, 16384
    v_mfma_f32_16x16x32_bf16 v[24:27], a[156:159], v[44:47], v[24:27]
    ds_read2st64_b64 v[108:111], v100 offset0:68 offset1:69
    v_cvt_pk_bf16_f32 v116, v116, v117
    v_mfma_f32_16x16x32_bf16 v[28:31], a[160:163], v[44:47], v[28:31]
    ds_read2st64_b64 v[104:107], v100 offset0:66 offset1:67
    v_cvt_pk_bf16_f32 v118, v118, v119
    v_mfma_f32_16x16x32_bf16 v[28:31], a[148:151], v[40:43], v[28:31]
    s_barrier
    v_mfma_f32_16x16x32_bf16 v[32:35], a[152:155], v[40:43], v[32:35]
    ds_read_b128 v[40:43], v3 offset:16384
    v_cvt_pk_bf16_f32 v120, v120, v121
    v_mfma_f32_16x16x32_bf16 v[32:35], a[164:167], v[44:47], v[32:35]
    ds_read_b128 v[44:47], v3 offset:17408
    s_waitcnt lgkmcnt(4)
    v_mfma_f32_16x16x32_bf16 v[32:35], a[176:179], v[48:51], v[32:35]
    ds_read2st64_b64 v[100:103], v100 offset0:64 offset1:65
    v_cvt_pk_bf16_f32 v122, v122, v123
    v_mfma_f32_16x16x32_bf16 v[32:35], a[188:191], v[52:55], v[32:35]
    v_pk_max_i16 v92, v116, 0
    v_pk_max_i16 v93, v118, 0
    v_mfma_f32_16x16x32_bf16 v[28:31], a[184:187], v[52:55], v[28:31]
    v_pk_max_i16 v94, v120, 0
    v_pk_max_i16 v95, v122, 0
    v_mfma_f32_16x16x32_bf16 v[28:31], a[172:175], v[48:51], v[28:31]
    buffer_store_dwordx4 v[92:95], v1, s[12:15], s36 offen sc1
    v_add_u32 v2, s35, v1
    v_mfma_f32_16x16x32_bf16 v[24:27], a[168:171], v[48:51], v[24:27]
    ds_read_b128 v[48:51], v3 offset:18432
    s_add_u32 s36, s36, 116736
    v_mfma_f32_16x16x32_bf16 v[24:27], a[180:183], v[52:55], v[24:27]
    ds_read_b128 v[52:55], v3 offset:19456
    s_waitcnt lgkmcnt(3)
    v_mfma_f32_16x16x32_bf16 v[24:27], a[192:195], v[40:43], v[24:27]
    buffer_load_dwordx4 v1, s[8:11], s37 offen offset:0 sc1 lds
    v_mfma_f32_16x16x32_bf16 v[24:27], a[204:207], v[44:47], v[24:27]
    s_waitcnt lgkmcnt(2)
    v_add_f32 v100, v100, v108
    v_add_f32 v101, v101, v109
    v_mfma_f32_16x16x32_bf16 v[28:31], a[208:211], v[44:47], v[28:31]
    v_add_f32 v102, v102, v110
    v_add_f32 v103, v103, v111
    v_mfma_f32_16x16x32_bf16 v[28:31], a[196:199], v[40:43], v[28:31]
    buffer_load_dwordx4 v1, s[8:11], s37 offen offset:1024 sc1 lds
    v_mfma_f32_16x16x32_bf16 v[32:35], a[200:203], v[40:43], v[32:35]
    ds_read_b128 v[40:43], v3 offset:20480
    v_add_f32 v104, v104, v112
    v_mfma_f32_16x16x32_bf16 v[32:35], a[212:215], v[44:47], v[32:35]
    ds_read_b128 v[44:47], v3 offset:21504
    s_waitcnt lgkmcnt(2)
    v_mfma_f32_16x16x32_bf16 v[32:35], a[224:227], v[48:51], v[32:35]
    buffer_load_dwordx4 v1, s[8:11], s37 offen offset:2048 sc1 lds
    v_mfma_f32_16x16x32_bf16 v[32:35], a[236:239], v[52:55], v[32:35]
    v_add_f32 v105, v105, v113
    v_add_f32 v106, v106, v114
    v_mfma_f32_16x16x32_bf16 v[28:31], a[232:235], v[52:55], v[28:31]
    v_add_f32 v107, v107, v115
    v_add_f32 v100, v100, v104
    v_mfma_f32_16x16x32_bf16 v[28:31], a[220:223], v[48:51], v[28:31]
    buffer_load_dwordx4 v1, s[8:11], s37 offen offset:3072 sc1 lds
    v_mfma_f32_16x16x32_bf16 v[24:27], a[216:219], v[48:51], v[24:27]
    ds_read_b128 v[48:51], v3 offset:22528
    s_add_u32 s32, s32, 1
    v_mfma_f32_16x16x32_bf16 v[24:27], a[228:231], v[52:55], v[24:27]
    ds_read_b128 v[52:55], v3 offset:23552
    s_waitcnt lgkmcnt(2)
    v_mfma_f32_16x16x32_bf16 v[24:27], a[240:243], v[40:43], v[24:27]
    s_add_u32 s33, s33, 36864
    s_add_u32 s34, s34, 36864
    v_add_f32 v101, v101, v105
    v_mfma_f32_16x16x32_bf16 v[24:27], a[252:255], v[44:47], v[24:27]
    s_cmp_ge_u32 s34, 147456
    s_cselect_b32 s38, 147456, 0
    s_sub_u32 s34, s34, s38
    v_mfma_f32_16x16x32_bf16 v[28:31], v[128:131], v[44:47], v[28:31]
    v_add_f32 v102, v102, v106
    v_add_f32 v103, v103, v107
    v_mfma_f32_16x16x32_bf16 v[28:31], a[244:247], v[40:43], v[28:31]
    v_add_f32 v100, v100, v102
    v_add_f32 v101, v101, v103
    v_mfma_f32_16x16x32_bf16 v[32:35], a[248:251], v[40:43], v[32:35]
    ds_read_b128 v[40:43], v3 offset:24576
    v_mfma_f32_16x16x32_bf16 v[32:35], v[132:135], v[44:47], v[32:35]
    ds_read_b128 v[44:47], v3 offset:25600
    s_waitcnt lgkmcnt(2)
    v_mfma_f32_16x16x32_bf16 v[32:35], v[144:147], v[48:51], v[32:35]
    buffer_load_dword v5, v4, s[4:7], s16 offen sc1
    v_mfma_f32_16x16x32_bf16 v[32:35], v[156:159], v[52:55], v[32:35]
    v_permlane16_swap_b32 v100, v101
    v_mfma_f32_16x16x32_bf16 v[28:31], v[152:155], v[52:55], v[28:31]
    v_add_f32 v100, v100, v101
    v_mov_b32 v101, v100
    v_mfma_f32_16x16x32_bf16 v[28:31], v[140:143], v[48:51], v[28:31]
    s_nop 0
    v_permlane32_swap_b32 v100, v101
    v_mfma_f32_16x16x32_bf16 v[24:27], v[136:139], v[48:51], v[24:27]
    ds_read_b128 v[48:51], v3 offset:26624
    v_add_f32 v100, v100, v101
    v_mfma_f32_16x16x32_bf16 v[24:27], v[148:151], v[52:55], v[24:27]
    ds_read_b128 v[52:55], v3 offset:27648
    s_waitcnt lgkmcnt(2)
    v_mfma_f32_16x16x32_bf16 v[24:27], v[160:163], v[40:43], v[24:27]
    v_mul_f32 v100, 0x3a800000, v100
    v_mov_b32 v101, v100
    v_mfma_f32_16x16x32_bf16 v[24:27], v[172:175], v[44:47], v[24:27]
    s_nop 0
    v_permlane16_swap_b32 v100, v101
    v_mfma_f32_16x16x32_bf16 v[28:31], v[176:179], v[44:47], v[28:31]
    v_fma_f32 v101, -v100, v100, v101
    v_max_f32 v101, 0, v101
    v_mfma_f32_16x16x32_bf16 v[28:31], v[164:167], v[40:43], v[28:31]
    v_add_f32 v101, 0x3727c5ac, v101
    v_mfma_f32_16x16x32_bf16 v[32:35], v[168:171], v[40:43], v[32:35]
    ds_read_b128 v[40:43], v3 offset:28672
    v_mfma_f32_16x16x32_bf16 v[32:35], v[180:183], v[44:47], v[32:35]
    ds_read_b128 v[44:47], v3 offset:29696
    s_waitcnt lgkmcnt(2)
    v_mfma_f32_16x16x32_bf16 v[32:35], v[192:195], v[48:51], v[32:35]
    v_rsq_f32 v21, v101
    v_mfma_f32_16x16x32_bf16 v[32:35], v[204:207], v[52:55], v[32:35]
    v_mul_f32 v100, v100, v21
    v_fma_f32 v80, -v100, v56, v68
    v_mfma_f32_16x16x32_bf16 v[28:31], v[200:203], v[52:55], v[28:31]
    v_fma_f32 v81, -v100, v57, v69
    v_fma_f32 v82, -v100, v58, v70
    v_mfma_f32_16x16x32_bf16 v[28:31], v[188:191], v[48:51], v[28:31]
    v_fma_f32 v83, -v100, v59, v71
    v_fma_f32 v84, -v100, v60, v72
    v_mfma_f32_16x16x32_bf16 v[24:27], v[184:187], v[48:51], v[24:27]
    ds_read_b128 v[48:51], v3 offset:30720
    v_fma_f32 v85, -v100, v61, v73
    v_mfma_f32_16x16x32_bf16 v[24:27], v[196:199], v[52:55], v[24:27]
    ds_read_b128 v[52:55], v3 offset:31744
    s_waitcnt lgkmcnt(2)
    v_mfma_f32_16x16x32_bf16 v[24:27], v[208:211], v[40:43], v[24:27]
    s_waitcnt vmcnt(6)
    v_fma_f32 v86, -v100, v62, v74
    v_fma_f32 v87, -v100, v63, v75
    v_mfma_f32_16x16x32_bf16 v[24:27], v[220:223], v[44:47], v[24:27]
    v_fma_f32 v88, -v100, v64, v76
    v_fma_f32 v89, -v100, v65, v77
    v_mfma_f32_16x16x32_bf16 v[28:31], v[224:227], v[44:47], v[28:31]
    v_fma_f32 v90, -v100, v66, v78
    v_fma_f32 v91, -v100, v67, v79
    v_mfma_f32_16x16x32_bf16 v[28:31], v[212:215], v[40:43], v[28:31]
    s_barrier
    v_mfma_f32_16x16x32_bf16 v[32:35], v[216:219], v[40:43], v[32:35]
    ds_read_b128 v[40:43], v2 offset:0
    s_waitcnt vmcnt(5)
    v_mfma_f32_16x16x32_bf16 v[32:35], v[228:231], v[44:47], v[32:35]
    ds_read_b128 v[44:47], v2 offset:1024
    s_waitcnt lgkmcnt(2)
    v_mfma_f32_16x16x32_bf16 v[32:35], v[240:243], v[48:51], v[32:35]
    buffer_store_dword v6, v22, s[12:15], s17 offen sc1
    s_mov_b32 s14, s6
    v_mfma_f32_16x16x32_bf16 v[32:35], v[252:255], v[52:55], v[32:35]
    s_add_u32 s17, s17, 8192
    v_mfma_f32_16x16x32_bf16 v[28:31], v[248:251], v[52:55], v[28:31]
    v_mfma_f32_16x16x32_bf16 v[28:31], v[236:239], v[48:51], v[28:31]
    v_mfma_f32_16x16x32_bf16 v[24:27], v[232:235], v[48:51], v[24:27]
    ds_read_b128 v[48:51], v2 offset:2048
    v_mfma_f32_16x16x32_bf16 v[24:27], v[244:247], v[52:55], v[24:27]
    ds_read_b128 v[52:55], v2 offset:3072
    s_cmp_lt_i32 s31, 63
    s_cbranch_scc1 Lffa_body03
    s_branch L_exit
Lffa_v01:
    v_mfma_f32_16x16x32_bf16 v[16:19], a[92:95], v[52:55], v[16:19]
    buffer_load_dword v5, v4, s[4:7], s16 offen sc1
    v_mfma_f32_16x16x32_bf16 v[12:15], a[88:91], v[52:55], v[12:15]
    v_fma_f32 v121, v29, v21, v85
    v_fma_f32 v122, v30, v21, v86
    v_mfma_f32_16x16x32_bf16 v[12:15], a[76:79], v[48:51], v[12:15]
    v_fma_f32 v123, v31, v21, v87
    v_mul_f32 v116, v116, |v116|
    v_mfma_f32_16x16x32_bf16 v[8:11], a[72:75], v[48:51], v[8:11]
    ds_read_b128 v[48:51], v2 offset:10240
    v_mul_f32 v117, v117, |v117|
    v_mfma_f32_16x16x32_bf16 v[8:11], a[84:87], v[52:55], v[8:11]
    ds_read_b128 v[52:55], v2 offset:11264
    s_waitcnt lgkmcnt(2)
    v_mfma_f32_16x16x32_bf16 v[8:11], a[96:99], v[40:43], v[8:11]
    v_mul_f32 v118, v118, |v118|
    v_mul_f32 v119, v119, |v119|
    v_mfma_f32_16x16x32_bf16 v[8:11], a[108:111], v[44:47], v[8:11]
    v_mul_f32 v120, v120, |v120|
    v_mul_f32 v121, v121, |v121|
    v_mfma_f32_16x16x32_bf16 v[12:15], a[112:115], v[44:47], v[12:15]
    v_mul_f32 v122, v122, |v122|
    v_mul_f32 v123, v123, |v123|
    v_mfma_f32_16x16x32_bf16 v[12:15], a[100:103], v[40:43], v[12:15]
    v_cvt_pk_bf16_f32 v116, v116, v117
    v_cvt_pk_bf16_f32 v118, v118, v119
    v_mfma_f32_16x16x32_bf16 v[16:19], a[104:107], v[40:43], v[16:19]
    ds_read_b128 v[40:43], v2 offset:12288
    v_cvt_pk_bf16_f32 v120, v120, v121
    v_mfma_f32_16x16x32_bf16 v[16:19], a[116:119], v[44:47], v[16:19]
    ds_read_b128 v[44:47], v2 offset:13312
    s_waitcnt lgkmcnt(2)
    v_mfma_f32_16x16x32_bf16 v[16:19], a[128:131], v[48:51], v[16:19]
    v_sub_u32 v100, v2, v20
    v_cvt_pk_bf16_f32 v122, v122, v123
    v_mfma_f32_16x16x32_bf16 v[16:19], a[140:143], v[52:55], v[16:19]
    ds_read2st64_b64 v[112:115], v100 offset0:70 offset1:71
    v_pk_max_i16 v92, v116, 0
    v_mfma_f32_16x16x32_bf16 v[12:15], a[136:139], v[52:55], v[12:15]
    ds_read2st64_b64 v[108:111], v100 offset0:68 offset1:69
    v_pk_max_i16 v93, v118, 0
    v_mfma_f32_16x16x32_bf16 v[12:15], a[124:127], v[48:51], v[12:15]
    ds_read2st64_b64 v[104:107], v100 offset0:66 offset1:67
    v_pk_max_i16 v94, v120, 0
    v_mfma_f32_16x16x32_bf16 v[8:11], a[120:123], v[48:51], v[8:11]
    ds_read_b128 v[48:51], v2 offset:14336
    v_pk_max_i16 v95, v122, 0
    v_mfma_f32_16x16x32_bf16 v[8:11], a[132:135], v[52:55], v[8:11]
    ds_read_b128 v[52:55], v2 offset:15360
    s_waitcnt lgkmcnt(5)
    v_mfma_f32_16x16x32_bf16 v[8:11], a[144:147], v[40:43], v[8:11]
    ds_read2st64_b64 v[100:103], v100 offset0:64 offset1:65
    v_add_u32 v3, s35, v1
    v_mfma_f32_16x16x32_bf16 v[8:11], a[156:159], v[44:47], v[8:11]
    buffer_store_dwordx4 v[92:95], v1, s[12:15], s36 offen sc1
    s_add_u32 s36, s36, 116736
    v_mfma_f32_16x16x32_bf16 v[12:15], a[160:163], v[44:47], v[12:15]
    s_waitcnt vmcnt(3)
    s_barrier
    v_mfma_f32_16x16x32_bf16 v[12:15], a[148:151], v[40:43], v[12:15]
    v_mfma_f32_16x16x32_bf16 v[16:19], a[152:155], v[40:43], v[16:19]
    ds_read_b128 v[40:43], v2 offset:16384
    v_mfma_f32_16x16x32_bf16 v[16:19], a[164:167], v[44:47], v[16:19]
    ds_read_b128 v[44:47], v2 offset:17408
    s_waitcnt lgkmcnt(3)
    v_mfma_f32_16x16x32_bf16 v[16:19], a[176:179], v[48:51], v[16:19]
    v_mfma_f32_16x16x32_bf16 v[16:19], a[188:191], v[52:55], v[16:19]
    s_waitcnt lgkmcnt(2)
    v_add_f32 v100, v100, v108
    v_add_f32 v101, v101, v109
    v_mfma_f32_16x16x32_bf16 v[12:15], a[184:187], v[52:55], v[12:15]
    v_add_f32 v102, v102, v110
    v_add_f32 v103, v103, v111
    v_mfma_f32_16x16x32_bf16 v[12:15], a[172:175], v[48:51], v[12:15]
    v_add_f32 v104, v104, v112
    v_add_f32 v105, v105, v113
    v_mfma_f32_16x16x32_bf16 v[8:11], a[168:171], v[48:51], v[8:11]
    ds_read_b128 v[48:51], v2 offset:18432
    v_add_f32 v106, v106, v114
    v_mfma_f32_16x16x32_bf16 v[8:11], a[180:183], v[52:55], v[8:11]
    ds_read_b128 v[52:55], v2 offset:19456
    s_waitcnt lgkmcnt(2)
    v_mfma_f32_16x16x32_bf16 v[8:11], a[192:195], v[40:43], v[8:11]
    v_add_f32 v107, v107, v115
    v_add_f32 v100, v100, v104
    v_mfma_f32_16x16x32_bf16 v[8:11], a[204:207], v[44:47], v[8:11]
    s_waitcnt vmcnt(1)
    v_cmp_gt_i32 vcc, s32, v5
    v_add_f32 v101, v101, v105
    v_mfma_f32_16x16x32_bf16 v[12:15], a[208:211], v[44:47], v[12:15]
    v_add_f32 v102, v102, v106
    v_add_f32 v103, v103, v107
    v_mfma_f32_16x16x32_bf16 v[12:15], a[196:199], v[40:43], v[12:15]
    s_and_b64 vcc, vcc, s[18:19]
    s_cbranch_scc1 Lffa_v02
    v_mfma_f32_16x16x32_bf16 v[16:19], a[200:203], v[40:43], v[16:19]
    ds_read_b128 v[40:43], v2 offset:20480
    v_add_f32 v100, v100, v102
    v_mfma_f32_16x16x32_bf16 v[16:19], a[212:215], v[44:47], v[16:19]
    ds_read_b128 v[44:47], v2 offset:21504
    s_waitcnt lgkmcnt(2)
    v_mfma_f32_16x16x32_bf16 v[16:19], a[224:227], v[48:51], v[16:19]
    buffer_load_dwordx4 v1, s[8:11], s33 offen offset:0 sc1 lds
    v_mfma_f32_16x16x32_bf16 v[16:19], a[236:239], v[52:55], v[16:19]
    v_add_f32 v101, v101, v103
    v_mfma_f32_16x16x32_bf16 v[12:15], a[232:235], v[52:55], v[12:15]
    s_nop 0
    v_permlane16_swap_b32 v100, v101
    v_mfma_f32_16x16x32_bf16 v[12:15], a[220:223], v[48:51], v[12:15]
    buffer_load_dwordx4 v1, s[8:11], s33 offen offset:1024 sc1 lds
    v_mfma_f32_16x16x32_bf16 v[8:11], a[216:219], v[48:51], v[8:11]
    ds_read_b128 v[48:51], v2 offset:22528
    v_add_f32 v100, v100, v101
    v_mfma_f32_16x16x32_bf16 v[8:11], a[228:231], v[52:55], v[8:11]
    ds_read_b128 v[52:55], v2 offset:23552
    s_waitcnt lgkmcnt(2)
    v_mfma_f32_16x16x32_bf16 v[8:11], a[240:243], v[40:43], v[8:11]
    buffer_load_dwordx4 v1, s[8:11], s33 offen offset:2048 sc1 lds
    v_mfma_f32_16x16x32_bf16 v[8:11], a[252:255], v[44:47], v[8:11]
    v_mov_b32 v101, v100
    v_mfma_f32_16x16x32_bf16 v[12:15], v[128:131], v[44:47], v[12:15]
    s_nop 0
    v_permlane32_swap_b32 v100, v101
    v_mfma_f32_16x16x32_bf16 v[12:15], a[244:247], v[40:43], v[12:15]
    buffer_load_dwordx4 v1, s[8:11], s33 offen offset:3072 sc1 lds
    v_mfma_f32_16x16x32_bf16 v[16:19], a[248:251], v[40:43], v[16:19]
    ds_read_b128 v[40:43], v2 offset:24576
    s_add_u32 m0, s34, s3
    v_mfma_f32_16x16x32_bf16 v[16:19], v[132:135], v[44:47], v[16:19]
    ds_read_b128 v[44:47], v2 offset:25600
    s_waitcnt lgkmcnt(2)
    v_mfma_f32_16x16x32_bf16 v[16:19], v[144:147], v[48:51], v[16:19]
    s_add_u32 s37, s33, s3
    v_add_f32 v100, v100, v101
    v_mul_f32 v100, 0x3a800000, v100
    v_mfma_f32_16x16x32_bf16 v[16:19], v[156:159], v[52:55], v[16:19]
    buffer_load_dwordx4 v1, s[8:11], s37 offen offset:0 sc1 lds
    v_mfma_f32_16x16x32_bf16 v[12:15], v[152:155], v[52:55], v[12:15]
    s_add_u32 s16, s16, 8192
    s_add_u32 m0, s34, 16384
    s_add_u32 s37, s33, 16384
    v_mfma_f32_16x16x32_bf16 v[12:15], v[140:143], v[48:51], v[12:15]
    v_mov_b32 v101, v100
    v_mfma_f32_16x16x32_bf16 v[8:11], v[136:139], v[48:51], v[8:11]
    ds_read_b128 v[48:51], v2 offset:26624
    v_mfma_f32_16x16x32_bf16 v[8:11], v[148:151], v[52:55], v[8:11]
    ds_read_b128 v[52:55], v2 offset:27648
    s_waitcnt lgkmcnt(2)
    v_mfma_f32_16x16x32_bf16 v[8:11], v[160:163], v[40:43], v[8:11]
    buffer_load_dword v5, v4, s[4:7], s16 offen sc1
    v_mfma_f32_16x16x32_bf16 v[8:11], v[172:175], v[44:47], v[8:11]
    v_permlane16_swap_b32 v100, v101
    v_mfma_f32_16x16x32_bf16 v[12:15], v[176:179], v[44:47], v[12:15]
    v_fma_f32 v101, -v100, v100, v101
    v_max_f32 v101, 0, v101
    v_mfma_f32_16x16x32_bf16 v[12:15], v[164:167], v[40:43], v[12:15]
    buffer_load_dwordx4 v1, s[8:11], s37 offen offset:0 sc1 lds
    v_mfma_f32_16x16x32_bf16 v[16:19], v[168:171], v[40:43], v[16:19]
    ds_read_b128 v[40:43], v2 offset:28672
    v_add_f32 v101, 0x3727c5ac, v101
    v_mfma_f32_16x16x32_bf16 v[16:19], v[180:183], v[44:47], v[16:19]
    ds_read_b128 v[44:47], v2 offset:29696
    s_waitcnt lgkmcnt(2)
    v_mfma_f32_16x16x32_bf16 v[16:19], v[192:195], v[48:51], v[16:19]
    buffer_load_dwordx4 v1, s[8:11], s37 offen offset:1024 sc1 lds
    v_mfma_f32_16x16x32_bf16 v[16:19], v[204:207], v[52:55], v[16:19]
    s_waitcnt vmcnt(8)
    buffer_store_dword v6, v22, s[12:15], s17 offen sc1
    v_mfma_f32_16x16x32_bf16 v[12:15], v[200:203], v[52:55], v[12:15]
    s_mov_b32 s14, s6
    v_rsq_f32 v21, v101
    v_mfma_f32_16x16x32_bf16 v[12:15], v[188:191], v[48:51], v[12:15]
    buffer_load_dwordx4 v1, s[8:11], s37 offen offset:2048 sc1 lds
    v_mfma_f32_16x16x32_bf16 v[8:11], v[184:187], v[48:51], v[8:11]
    ds_read_b128 v[48:51], v2 offset:30720
    v_mul_f32 v100, v100, v21
    v_mfma_f32_16x16x32_bf16 v[8:11], v[196:199], v[52:55], v[8:11]
    ds_read_b128 v[52:55], v2 offset:31744
    s_waitcnt lgkmcnt(2)
    v_mfma_f32_16x16x32_bf16 v[8:11], v[208:211], v[40:43], v[8:11]
    buffer_load_dwordx4 v1, s[8:11], s37 offen offset:3072 sc1 lds
    v_mfma_f32_16x16x32_bf16 v[8:11], v[220:223], v[44:47], v[8:11]
    s_add_u32 s32, s32, 1
    s_add_u32 s33, s33, 36864
    s_add_u32 s34, s34, 36864
    v_mfma_f32_16x16x32_bf16 v[12:15], v[224:227], v[44:47], v[12:15]
    s_waitcnt vmcnt(6)
    s_barrier
    v_mfma_f32_16x16x32_bf16 v[12:15], v[212:215], v[40:43], v[12:15]
    s_cmp_ge_u32 s34, 147456
    s_cselect_b32 s38, 147456, 0
    s_sub_u32 s34, s34, s38
    v_mfma_f32_16x16x32_bf16 v[16:19], v[216:219], v[40:43], v[16:19]
    ds_read_b128 v[40:43], v3 offset:0
    v_fma_f32 v80, -v100, v56, v68
    v_mfma_f32_16x16x32_bf16 v[16:19], v[228:231], v[44:47], v[16:19]
    ds_read_b128 v[44:47], v3 offset:1024
    s_waitcnt lgkmcnt(2)
    v_mfma_f32_16x16x32_bf16 v[16:19], v[240:243], v[48:51], v[16:19]
    s_add_u32 s17, s17, 8192
    v_fma_f32 v81, -v100, v57, v69
    v_fma_f32 v82, -v100, v58, v70
    v_mfma_f32_16x16x32_bf16 v[16:19], v[252:255], v[52:55], v[16:19]
    v_fma_f32 v83, -v100, v59, v71
    v_fma_f32 v84, -v100, v60, v72
    v_mfma_f32_16x16x32_bf16 v[12:15], v[248:251], v[52:55], v[12:15]
    v_fma_f32 v85, -v100, v61, v73
    v_fma_f32 v86, -v100, v62, v74
    v_mfma_f32_16x16x32_bf16 v[12:15], v[236:239], v[48:51], v[12:15]
    v_fma_f32 v87, -v100, v63, v75
    v_fma_f32 v88, -v100, v64, v76
    v_mfma_f32_16x16x32_bf16 v[8:11], v[232:235], v[48:51], v[8:11]
    ds_read_b128 v[48:51], v3 offset:2048
    v_fma_f32 v89, -v100, v65, v77
    v_mfma_f32_16x16x32_bf16 v[8:11], v[244:247], v[52:55], v[8:11]
    ds_read_b128 v[52:55], v3 offset:3072
    v_fma_f32 v90, -v100, v66, v78
    v_fma_f32 v91, -v100, v67, v79
    s_nop 1
    s_cmp_ge_i32 s31, 63
    s_cbranch_scc1 L_exit
    s_cmp_eq_u32 s30, 1
    s_cbranch_scc1 Lffa_body11
    s_cmp_eq_u32 s30, 2
    s_cbranch_scc1 Lffa_body12
    s_cmp_eq_u32 s30, 3
    s_cbranch_scc1 Lffa_body13
    s_branch Lffa_body10
Lffa_v02:
    v_mfma_f32_16x16x32_bf16 v[16:19], a[200:203], v[40:43], v[16:19]
    ds_read_b128 v[40:43], v2 offset:20480
    v_add_f32 v100, v100, v102
    v_mfma_f32_16x16x32_bf16 v[16:19], a[212:215], v[44:47], v[16:19]
    ds_read_b128 v[44:47], v2 offset:21504
    s_waitcnt lgkmcnt(2)
    v_mfma_f32_16x16x32_bf16 v[16:19], a[224:227], v[48:51], v[16:19]
    v_add_f32 v101, v101, v103
    v_mfma_f32_16x16x32_bf16 v[16:19], a[236:239], v[52:55], v[16:19]
    s_nop 0
    v_permlane16_swap_b32 v100, v101
    v_mfma_f32_16x16x32_bf16 v[12:15], a[232:235], v[52:55], v[12:15]
    v_add_f32 v100, v100, v101
    v_mov_b32 v101, v100
    v_mfma_f32_16x16x32_bf16 v[12:15], a[220:223], v[48:51], v[12:15]
    s_nop 0
    v_permlane32_swap_b32 v100, v101
    v_mfma_f32_16x16x32_bf16 v[8:11], a[216:219], v[48:51], v[8:11]
    ds_read_b128 v[48:51], v2 offset:22528
    v_add_f32 v100, v100, v101
    v_mfma_f32_16x16x32_bf16 v[8:11], a[228:231], v[52:55], v[8:11]
    ds_read_b128 v[52:55], v2 offset:23552
    s_waitcnt lgkmcnt(2)
    v_mfma_f32_16x16x32_bf16 v[8:11], a[240:243], v[40:43], v[8:11]
    v_mul_f32 v100, 0x3a800000, v100
    v_mov_b32 v101, v100
    v_mfma_f32_16x16x32_bf16 v[8:11], a[252:255], v[44:47], v[8:11]
    s_nop 0
    v_permlane16_swap_b32 v100, v101
    v_mfma_f32_16x16x32_bf16 v[12:15], v[128:131], v[44:47], v[12:15]
    v_fma_f32 v101, -v100, v100, v101
    v_max_f32 v101, 0, v101
    v_mfma_f32_16x16x32_bf16 v[12:15], a[244:247], v[40:43], v[12:15]
    v_add_f32 v101, 0x3727c5ac, v101
    v_mfma_f32_16x16x32_bf16 v[16:19], a[248:251], v[40:43], v[16:19]
    ds_read_b128 v[40:43], v2 offset:24576
    v_mfma_f32_16x16x32_bf16 v[16:19], v[132:135], v[44:47], v[16:19]
    ds_read_b128 v[44:47], v2 offset:25600
    s_waitcnt lgkmcnt(2)
    v_mfma_f32_16x16x32_bf16 v[16:19], v[144:147], v[48:51], v[16:19]
    v_rsq_f32 v21, v101
    v_mfma_f32_16x16x32_bf16 v[16:19], v[156:159], v[52:55], v[16:19]
    v_mul_f32 v100, v100, v21
    v_fma_f32 v80, -v100, v56, v68
    v_mfma_f32_16x16x32_bf16 v[12:15], v[152:155], v[52:55], v[12:15]
    v_fma_f32 v81, -v100, v57, v69
    v_fma_f32 v82, -v100, v58, v70
    v_mfma_f32_16x16x32_bf16 v[12:15], v[140:143], v[48:51], v[12:15]
    v_fma_f32 v83, -v100, v59, v71
    v_fma_f32 v84, -v100, v60, v72
    v_mfma_f32_16x16x32_bf16 v[8:11], v[136:139], v[48:51], v[8:11]
    ds_read_b128 v[48:51], v2 offset:26624
    v_fma_f32 v85, -v100, v61, v73
    v_mfma_f32_16x16x32_bf16 v[8:11], v[148:151], v[52:55], v[8:11]
    ds_read_b128 v[52:55], v2 offset:27648
    s_waitcnt lgkmcnt(2)
    v_mfma_f32_16x16x32_bf16 v[8:11], v[160:163], v[40:43], v[8:11]
    v_fma_f32 v86, -v100, v62, v74
    v_fma_f32 v87, -v100, v63, v75
    v_mfma_f32_16x16x32_bf16 v[8:11], v[172:175], v[44:47], v[8:11]
    v_fma_f32 v88, -v100, v64, v76
    v_fma_f32 v89, -v100, v65, v77
    v_mfma_f32_16x16x32_bf16 v[12:15], v[176:179], v[44:47], v[12:15]
    v_fma_f32 v90, -v100, v66, v78
    v_fma_f32 v91, -v100, v67, v79
    v_mfma_f32_16x16x32_bf16 v[12:15], v[164:167], v[40:43], v[12:15]
    v_mfma_f32_16x16x32_bf16 v[16:19], v[168:171], v[40:43], v[16:19]
    ds_read_b128 v[40:43], v2 offset:28672
    v_mfma_f32_16x16x32_bf16 v[16:19], v[180:183], v[44:47], v[16:19]
    ds_read_b128 v[44:47], v2 offset:29696
    s_waitcnt lgkmcnt(2)
    v_mfma_f32_16x16x32_bf16 v[16:19], v[192:195], v[48:51], v[16:19]
    v_mfma_f32_16x16x32_bf16 v[16:19], v[204:207], v[52:55], v[16:19]
    s_waitcnt vmcnt(0)
    buffer_store_dword v6, v22, s[12:15], s17 offen sc1
    v_mfma_f32_16x16x32_bf16 v[12:15], v[200:203], v[52:55], v[12:15]
    s_mov_b32 s14, s6
    s_add_u32 s17, s17, 8192
    v_mfma_f32_16x16x32_bf16 v[12:15], v[188:191], v[48:51], v[12:15]
    v_mfma_f32_16x16x32_bf16 v[8:11], v[184:187], v[48:51], v[8:11]
    ds_read_b128 v[48:51], v2 offset:30720
    v_mfma_f32_16x16x32_bf16 v[8:11], v[196:199], v[52:55], v[8:11]
    ds_read_b128 v[52:55], v2 offset:31744
    s_waitcnt lgkmcnt(2)
    v_mfma_f32_16x16x32_bf16 v[8:11], v[208:211], v[40:43], v[8:11]
    buffer_load_dword v5, v4, s[4:7], s16 offen sc1
    v_mfma_f32_16x16x32_bf16 v[8:11], v[220:223], v[44:47], v[8:11]
    v_mfma_f32_16x16x32_bf16 v[12:15], v[224:227], v[44:47], v[12:15]
    v_mfma_f32_16x16x32_bf16 v[12:15], v[212:215], v[40:43], v[12:15]
    v_mfma_f32_16x16x32_bf16 v[16:19], v[216:219], v[40:43], v[16:19]
    v_mfma_f32_16x16x32_bf16 v[16:19], v[228:231], v[44:47], v[16:19]
    s_waitcnt lgkmcnt(0)
    v_mfma_f32_16x16x32_bf16 v[16:19], v[240:243], v[48:51], v[16:19]
    v_mfma_f32_16x16x32_bf16 v[16:19], v[252:255], v[52:55], v[16:19]
    v_mfma_f32_16x16x32_bf16 v[12:15], v[248:251], v[52:55], v[12:15]
    v_mfma_f32_16x16x32_bf16 v[12:15], v[236:239], v[48:51], v[12:15]
    v_mfma_f32_16x16x32_bf16 v[8:11], v[232:235], v[48:51], v[8:11]
    v_mfma_f32_16x16x32_bf16 v[8:11], v[244:247], v[52:55], v[8:11]
    s_nop 3
    v_fma_f32 v124, v16, v21, v88
    v_fma_f32 v125, v17, v21, v89
    v_fma_f32 v126, v18, v21, v90
    v_fma_f32 v127, v19, v21, v91
    v_mul_f32 v124, v124, |v124|
    v_mul_f32 v125, v125, |v125|
    v_mul_f32 v126, v126, |v126|
    v_mul_f32 v127, v127, |v127|
    v_cvt_pk_bf16_f32 v124, v124, v125
    v_cvt_pk_bf16_f32 v126, v126, v127
    v_pk_max_i16 v96, v124, 0
    v_pk_max_i16 v97, v126, 0
    v_pk_max_i16 v98, v124, 0
    v_pk_max_i16 v99, v126, 0
    v_fma_f32 v116, v8, v21, v80
    v_permlane32_swap_b32 v96, v98
    v_permlane32_swap_b32 v97, v99
    buffer_store_dwordx4 v[96:99], v7, s[12:15], s36 offen sc1
    v_fma_f32 v117, v9, v21, v81
    v_fma_f32 v118, v10, v21, v82
    v_fma_f32 v119, v11, v21, v83
    v_fma_f32 v120, v12, v21, v84
    v_fma_f32 v121, v13, v21, v85
    v_fma_f32 v122, v14, v21, v86
    v_fma_f32 v123, v15, v21, v87
    v_mul_f32 v116, v116, |v116|
    v_mul_f32 v117, v117, |v117|
    v_mul_f32 v118, v118, |v118|
    v_mul_f32 v119, v119, |v119|
    v_mul_f32 v120, v120, |v120|
    v_mul_f32 v121, v121, |v121|
    v_mul_f32 v122, v122, |v122|
    v_mul_f32 v123, v123, |v123|
    v_cvt_pk_bf16_f32 v116, v116, v117
    v_cvt_pk_bf16_f32 v118, v118, v119
    v_cvt_pk_bf16_f32 v120, v120, v121
    v_cvt_pk_bf16_f32 v122, v122, v123
    v_pk_max_i16 v92, v116, 0
    v_pk_max_i16 v93, v118, 0
    v_pk_max_i16 v94, v120, 0
    v_pk_max_i16 v95, v122, 0
    buffer_store_dwordx4 v[92:95], v1, s[12:15], s36 offen sc1
    s_add_u32 s54, s31, 1
    v_mov_b32 v6, s54
    s_waitcnt vmcnt(2)
    s_cmp_ge_i32 s31, 63
    s_cbranch_scc1 Lffa_late0
    v_cmp_gt_i32 vcc, s32, v5
    s_sub_u32 s43, s43, 1
    s_cmp_lt_i32 s43, 0
    s_cbranch_scc1 Lffa_rdy0
    s_and_b64 vcc, vcc, s[18:19]
    s_cbranch_scc0 Lffa_rdy0
Lffa_late0:
    buffer_load_dword v5, v4, s[4:7], s16 offen sc1
    s_waitcnt vmcnt(1)
    buffer_store_dword v6, v22, s[12:15], s17 offen sc1
    s_mov_b32 s14, 0
    s_cmp_ge_i32 s31, 63
    s_cbranch_scc1 L_exit
    s_waitcnt vmcnt(1)
    v_cmp_gt_i32 vcc, s32, v5
    s_sub_u32 s43, s43, 1
    s_cmp_lt_i32 s43, 0
    s_cbranch_scc1 Lffa_rdy0
    s_and_b64 vcc, vcc, s[18:19]
    s_cbranch_scc0 Lffa_rdy0
Lffa_spin0:
    buffer_load_dword v5, v4, s[4:7], s16 offen sc1
    s_waitcnt vmcnt(0)
    v_cmp_gt_i32 vcc, s32, v5
    s_sub_u32 s43, s43, 1
    s_cmp_lt_i32 s43, 0
    s_cbranch_scc1 Lffa_rdy0
    s_and_b64 vcc, vcc, s[18:19]
    s_cbranch_scc0 Lffa_rdy0
    s_sleep 8
    s_branch Lffa_spin0
Lffa_rdy0:
    s_add_u32 m0, s34, 0
    s_nop 0
    buffer_load_dwordx4 v1, s[8:11], s33 offen offset:0 sc1 lds
    buffer_load_dwordx4 v1, s[8:11], s33 offen offset:1024 sc1 lds
    buffer_load_dwordx4 v1, s[8:11], s33 offen offset:2048 sc1 lds
    buffer_load_dwordx4 v1, s[8:11], s33 offen offset:3072 sc1 lds
    s_add_u32 m0, s34, s3
    s_add_u32 s37, s33, s3
    buffer_load_dwordx4 v1, s[8:11], s37 offen offset:0 sc1 lds
    s_add_u32 s16, s16, 8192
    buffer_load_dword v5, v4, s[4:7], s16 offen sc1
    s_add_u32 m0, s34, 16384
    s_add_u32 s37, s33, 16384
    buffer_load_dwordx4 v1, s[8:11], s37 offen offset:0 sc1 lds
    buffer_load_dwordx4 v1, s[8:11], s37 offen offset:1024 sc1 lds
    buffer_load_dwordx4 v1, s[8:11], s37 offen offset:2048 sc1 lds
    buffer_load_dwordx4 v1, s[8:11], s37 offen offset:3072 sc1 lds
    s_add_u32 s32, s32, 1
    s_add_u32 s33, s33, 36864
    s_add_u32 s34, s34, 36864
    s_cmp_ge_u32 s34, 147456
    s_cselect_b32 s38, 147456, 0
    s_sub_u32 s34, s34, s38
    s_waitcnt vmcnt(5)
    buffer_store_dword v6, v22, s[12:15], s17 offen sc1
Lffa_go0:
    s_mov_b32 s14, 0
    s_barrier
    ds_read_b128 v[40:43], v3 offset:0
    ds_read_b128 v[44:47], v3 offset:1024
    ds_read_b128 v[48:51], v3 offset:2048
    ds_read_b128 v[52:55], v3 offset:3072
    s_cmp_eq_u32 s30, 1
    s_cbranch_scc1 Lffa_body11
    s_cmp_eq_u32 s30, 2
    s_cbranch_scc1 Lffa_body12
    s_cmp_eq_u32 s30, 3
    s_cbranch_scc1 Lffa_body13
    s_branch Lffa_body10
Lffa_v11:
    v_mfma_f32_16x16x32_bf16 v[32:35], a[92:95], v[52:55], v[32:35]
    buffer_load_dword v5, v4, s[4:7], s16 offen sc1
    v_mfma_f32_16x16x32_bf16 v[28:31], a[88:91], v[52:55], v[28:31]
    v_fma_f32 v121, v13, v21, v85
    v_fma_f32 v122, v14, v21, v86
    v_mfma_f32_16x16x32_bf16 v[28:31], a[76:79], v[48:51], v[28:31]
    v_fma_f32 v123, v15, v21, v87
    v_mul_f32 v116, v116, |v116|
    v_mfma_f32_16x16x32_bf16 v[24:27], a[72:75], v[48:51], v[24:27]
    ds_read_b128 v[48:51], v3 offset:10240
    v_mul_f32 v117, v117, |v117|
    v_mfma_f32_16x16x32_bf16 v[24:27], a[84:87], v[52:55], v[24:27]
    ds_read_b128 v[52:55], v3 offset:11264
    s_waitcnt lgkmcnt(2)
    v_mfma_f32_16x16x32_bf16 v[24:27], a[96:99], v[40:43], v[24:27]
    v_mul_f32 v118, v118, |v118|
    v_mul_f32 v119, v119, |v119|
    v_mfma_f32_16x16x32_bf16 v[24:27], a[108:111], v[44:47], v[24:27]
    v_mul_f32 v120, v120, |v120|
    v_mul_f32 v121, v121, |v121|
    v_mfma_f32_16x16x32_bf16 v[28:31], a[112:115], v[44:47], v[28:31]
    v_mul_f32 v122, v122, |v122|
    v_mul_f32 v123, v123, |v123|
    v_mfma_f32_16x16x32_bf16 v[28:31], a[100:103], v[40:43], v[28:31]
    v_cvt_pk_bf16_f32 v116, v116, v117
    v_cvt_pk_bf16_f32 v118, v118, v119
    v_mfma_f32_16x16x32_bf16 v[32:35], a[104:107], v[40:43], v[32:35]
    ds_read_b128 v[40:43], v3 offset:12288
    v_cvt_pk_bf16_f32 v120, v120, v121
    v_mfma_f32_16x16x32_bf16 v[32:35], a[116:119], v[44:47], v[32:35]
    ds_read_b128 v[44:47], v3 offset:13312
    s_waitcnt lgkmcnt(2)
    v_mfma_f32_16x16x32_bf16 v[32:35], a[128:131], v[48:51], v[32:35]
    v_sub_u32 v100, v3, v20
    v_cvt_pk_bf16_f32 v122, v122, v123
    v_mfma_f32_16x16x32_bf16 v[32:35], a[140:143], v[52:55], v[32:35]
    ds_read2st64_b64 v[112:115], v100 offset0:70 offset1:71
    v_pk_max_i16 v92, v116, 0
    v_mfma_f32_16x16x32_bf16 v[28:31], a[136:139], v[52:55], v[28:31]
    ds_read2st64_b64 v[108:111], v100 offset0:68 offset1:69
    v_pk_max_i16 v93, v118, 0
    v_mfma_f32_16x16x32_bf16 v[28:31], a[124:127], v[48:51], v[28:31]
    ds_read2st64_b64 v[104:107], v100 offset0:66 offset1:67
    v_pk_max_i16 v94, v120, 0
    v_mfma_f32_16x16x32_bf16 v[24:27], a[120:123], v[48:51], v[24:27]
    ds_read_b128 v[48:51], v3 offset:14336
    v_pk_max_i16 v95, v122, 0
    v_mfma_f32_16x16x32_bf16 v[24:27], a[132:135], v[52:55], v[24:27]
    ds_read_b128 v[52:55], v3 offset:15360
    s_waitcnt lgkmcnt(5)
    v_mfma_f32_16x16x32_bf16 v[24:27], a[144:147], v[40:43], v[24:27]
    ds_read2st64_b64 v[100:103], v100 offset0:64 offset1:65
    v_add_u32 v2, s35, v1
    v_mfma_f32_16x16x32_bf16 v[24:27], a[156:159], v[44:47], v[24:27]
    buffer_store_dwordx4 v[92:95], v1, s[12:15], s36 offen sc1
    s_add_u32 s36, s36, 116736
    v_mfma_f32_16x16x32_bf16 v[28:31], a[160:163], v[44:47], v[28:31]
    s_waitcnt vmcnt(3)
    s_barrier
    v_mfma_f32_16x16x32_bf16 v[28:31], a[148:151], v[40:43], v[28:31]
    v_mfma_f32_16x16x32_bf16 v[32:35], a[152:155], v[40:43], v[32:35]
    ds_read_b128 v[40:43], v3 offset:16384
    v_mfma_f32_16x16x32_bf16 v[32:35], a[164:167], v[44:47], v[32:35]
    ds_read_b128 v[44:47], v3 offset:17408
    s_waitcnt lgkmcnt(3)
    v_mfma_f32_16x16x32_bf16 v[32:35], a[176:179], v[48:51], v[32:35]
    v_mfma_f32_16x16x32_bf16 v[32:35], a[188:191], v[52:55], v[32:35]
    s_waitcnt lgkmcnt(2)
    v_add_f32 v100, v100, v108
    v_add_f32 v101, v101, v109
    v_mfma_f32_16x16x32_bf16 v[28:31], a[184:187], v[52:55], v[28:31]
    v_add_f32 v102, v102, v110
    v_add_f32 v103, v103, v111
    v_mfma_f32_16x16x32_bf16 v[28:31], a[172:175], v[48:51], v[28:31]
    v_add_f32 v104, v104, v112
    v_add_f32 v105, v105, v113
    v_mfma_f32_16x16x32_bf16 v[24:27], a[168:171], v[48:51], v[24:27]
    ds_read_b128 v[48:51], v3 offset:18432
    v_add_f32 v106, v106, v114
    v_mfma_f32_16x16x32_bf16 v[24:27], a[180:183], v[52:55], v[24:27]
    ds_read_b128 v[52:55], v3 offset:19456
    s_waitcnt lgkmcnt(2)
    v_mfma_f32_16x16x32_bf16 v[24:27], a[192:195], v[40:43], v[24:27]
    v_add_f32 v107, v107, v115
    v_add_f32 v100, v100, v104
    v_mfma_f32_16x16x32_bf16 v[24:27], a[204:207], v[44:47], v[24:27]
    s_waitcnt vmcnt(1)
    v_cmp_gt_i32 vcc, s32, v5
    v_add_f32 v101, v101, v105
    v_mfma_f32_16x16x32_bf16 v[28:31], a[208:211], v[44:47], v[28:31]
    v_add_f32 v102, v102, v106
    v_add_f32 v103, v103, v107
    v_mfma_f32_16x16x32_bf16 v[28:31], a[196:199], v[40:43], v[28:31]
    s_and_b64 vcc, vcc, s[18:19]
    s_cbranch_scc1 Lffa_v12
    v_mfma_f32_16x16x32_bf16 v[32:35], a[200:203], v[40:43], v[32:35]
    ds_read_b128 v[40:43], v3 offset:20480
    v_add_f32 v100, v100, v102
    v_mfma_f32_16x16x32_bf16 v[32:35], a[212:215], v[44:47], v[32:35]
    ds_read_b128 v[44:47], v3 offset:21504
    s_waitcnt lgkmcnt(2)
    v_mfma_f32_16x16x32_bf16 v[32:35], a[224:227], v[48:51], v[32:35]
    buffer_load_dwordx4 v1, s[8:11], s33 offen offset:0 sc1 lds
    v_mfma_f32_16x16x32_bf16 v[32:35], a[236:239], v[52:55], v[32:35]
    v_add_f32 v101, v101, v103
    v_mfma_f32_16x16x32_bf16 v[28:31], a[232:235], v[52:55], v[28:31]
    s_nop 0
    v_permlane16_swap_b32 v100, v101
    v_mfma_f32_16x16x32_bf16 v[28:31], a[220:223], v[48:51], v[28:31]
    buffer_load_dwordx4 v1, s[8:11], s33 offen offset:1024 sc1 lds
    v_mfma_f32_16x16x32_bf16 v[24:27], a[216:219], v[48:51], v[24:27]
    ds_read_b128 v[48:51], v3 offset:22528
    v_add_f32 v100, v100, v101
    v_mfma_f32_16x16x32_bf16 v[24:27], a[228:231], v[52:55], v[24:27]
    ds_read_b128 v[52:55], v3 offset:23552
    s_waitcnt lgkmcnt(2)
    v_mfma_f32_16x16x32_bf16 v[24:27], a[240:243], v[40:43], v[24:27]
    buffer_load_dwordx4 v1, s[8:11], s33 offen offset:2048 sc1 lds
    v_mfma_f32_16x16x32_bf16 v[24:27], a[252:255], v[44:47], v[24:27]
    v_mov_b32 v101, v100
    v_mfma_f32_16x16x32_bf16 v[28:31], v[128:131], v[44:47], v[28:31]
    s_nop 0
    v_permlane32_swap_b32 v100, v101
    v_mfma_f32_16x16x32_bf16 v[28:31], a[244:247], v[40:43], v[28:31]
    buffer_load_dwordx4 v1, s[8:11], s33 offen offset:3072 sc1 lds
    v_mfma_f32_16x16x32_bf16 v[32:35], a[248:251], v[40:43], v[32:35]
    ds_read_b128 v[40:43], v3 offset:24576
    s_add_u32 m0, s34, s3
    v_mfma_f32_16x16x32_bf16 v[32:35], v[132:135], v[44:47], v[32:35]
    ds_read_b128 v[44:47], v3 offset:25600
    s_waitcnt lgkmcnt(2)
    v_mfma_f32_16x16x32_bf16 v[32:35], v[144:147], v[48:51], v[32:35]
    s_add_u32 s37, s33, s3
    v_add_f32 v100, v100, v101
    v_mul_f32 v100, 0x3a800000, v100
    v_mfma_f32_16x16x32_bf16 v[32:35], v[156:159], v[52:55], v[32:35]
    buffer_load_dwordx4 v1, s[8:11], s37 offen offset:0 sc1 lds
    v_mfma_f32_16x16x32_bf16 v[28:31], v[152:155], v[52:55], v[28:31]
    s_add_u32 s16, s16, 8192
    s_add_u32 m0, s34, 16384
    s_add_u32 s37, s33, 16384
    v_mfma_f32_16x16x32_bf16 v[28:31], v[140:143], v[48:51], v[28:31]
    v_mov_b32 v101, v100
    v_mfma_f32_16x16x32_bf16 v[24:27], v[136:139], v[48:51], v[24:27]
    ds_read_b128 v[48:51], v3 offset:26624
    v_mfma_f32_16x16x32_bf16 v[24:27], v[148:151], v[52:55], v[24:27]
    ds_read_b128 v[52:55], v3 offset:27648
    s_waitcnt lgkmcnt(2)
    v_mfma_f32_16x16x32_bf16 v[24:27], v[160:163], v[40:43], v[24:27]
    buffer_load_dword v5, v4, s[4:7], s16 offen sc1
    v_mfma_f32_16x16x32_bf16 v[24:27], v[172:175], v[44:47], v[24:27]
    v_permlane16_swap_b32 v100, v101
    v_mfma_f32_16x16x32_bf16 v[28:31], v[176:179], v[44:47], v[28:31]
    v_fma_f32 v101, -v100, v100, v101
    v_max_f32 v101, 0, v101
    v_mfma_f32_16x16x32_bf16 v[28:31], v[164:167], v[40:43], v[28:31]
    buffer_load_dwordx4 v1, s[8:11], s37 offen offset:0 sc1 lds
    v_mfma_f32_16x16x32_bf16 v[32:35], v[168:171], v[40:43], v[32:35]
    ds_read_b128 v[40:43], v3 offset:28672
    v_add_f32 v101, 0x3727c5ac, v101
    v_mfma_f32_16x16x32_bf16 v[32:35], v[180:183], v[44:47], v[32:35]
    ds_read_b128 v[44:47], v3 offset:29696
    s_waitcnt lgkmcnt(2)
    v_mfma_f32_16x16x32_bf16 v[32:35], v[192:195], v[48:51], v[32:35]
    buffer_load_dwordx4 v1, s[8:11], s37 offen offset:1024 sc1 lds
    v_mfma_f32_16x16x32_bf16 v[32:35], v[204:207], v[52:55], v[32:35]
    s_waitcnt vmcnt(8)
    buffer_store_dword v6, v22, s[12:15], s17 offen sc1
    v_mfma_f32_16x16x32_bf16 v[28:31], v[200:203], v[52:55], v[28:31]
    s_mov_b32 s14, s6
    v_rsq_f32 v21, v101
    v_mfma_f32_16x16x32_bf16 v[28:31], v[188:191], v[48:51], v[28:31]
    buffer_load_dwordx4 v1, s[8:11], s37 offen offset:2048 sc1 lds
    v_mfma_f32_16x16x32_bf16 v[24:27], v[184:187], v[48:51], v[24:27]
    ds_read_b128 v[48:51], v3 offset:30720
    v_mul_f32 v100, v100, v21
    v_mfma_f32_16x16x32_bf16 v[24:27], v[196:199], v[52:55], v[24:27]
    ds_read_b128 v[52:55], v3 offset:31744
    s_waitcnt lgkmcnt(2)
    v_mfma_f32_16x16x32_bf16 v[24:27], v[208:211], v[40:43], v[24:27]
    buffer_load_dwordx4 v1, s[8:11], s37 offen offset:3072 sc1 lds
    v_mfma_f32_16x16x32_bf16 v[24:27], v[220:223], v[44:47], v[24:27]
    s_add_u32 s32, s32, 1
    s_add_u32 s33, s33, 36864
    s_add_u32 s34, s34, 36864
    v_mfma_f32_16x16x32_bf16 v[28:31], v[224:227], v[44:47], v[28:31]
    s_waitcnt vmcnt(6)
    s_barrier
    v_mfma_f32_16x16x32_bf16 v[28:31], v[212:215], v[40:43], v[28:31]
    s_cmp_ge_u32 s34, 147456
    s_cselect_b32 s38, 147456, 0
    s_sub_u32 s34, s34, s38
    v_mfma_f32_16x16x32_bf16 v[32:35], v[216:219], v[40:43], v[32:35]
    ds_read_b128 v[40:43], v2 offset:0
    v_fma_f32 v80, -v100, v56, v68
    v_mfma_f32_16x16x32_bf16 v[32:35], v[228:231], v[44:47], v[32:35]
    ds_read_b128 v[44:47], v2 offset:1024
    s_waitcnt lgkmcnt(2)
    v_mfma_f32_16x16x32_bf16 v[32:35], v[240:243], v[48:51], v[32:35]
    s_add_u32 s17, s17, 8192
    v_fma_f32 v81, -v100, v57, v69
    v_fma_f32 v82, -v100, v58, v70
    v_mfma_f32_16x16x32_bf16 v[32:35], v[252:255], v[52:55], v[32:35]
    v_fma_f32 v83, -v100, v59, v71
    v_fma_f32 v84, -v100, v60, v72
    v_mfma_f32_16x16x32_bf16 v[28:31], v[248:251], v[52:55], v[28:31]
    v_fma_f32 v85, -v100, v61, v73
    v_fma_f32 v86, -v100, v62, v74
    v_mfma_f32_16x16x32_bf16 v[28:31], v[236:239], v[48:51], v[28:31]
    v_fma_f32 v87, -v100, v63, v75
    v_fma_f32 v88, -v100, v64, v76
    v_mfma_f32_16x16x32_bf16 v[24:27], v[232:235], v[48:51], v[24:27]
    ds_read_b128 v[48:51], v2 offset:2048
    v_fma_f32 v89, -v100, v65, v77
    v_mfma_f32_16x16x32_bf16 v[24:27], v[244:247], v[52:55], v[24:27]
    ds_read_b128 v[52:55], v2 offset:3072
    v_fma_f32 v90, -v100, v66, v78
    v_fma_f32 v91, -v100, v67, v79
    s_nop 1
    s_cmp_ge_i32 s31, 63
    s_cbranch_scc1 L_exit
    s_cmp_eq_u32 s30, 1
    s_cbranch_scc1 Lffa_body01
    s_cmp_eq_u32 s30, 2
    s_cbranch_scc1 Lffa_body02
    s_cmp_eq_u32 s30, 3
    s_cbranch_scc1 Lffa_body03
    s_branch Lffa_body00
Lffa_v12:
    v_mfma_f32_16x16x32_bf16 v[32:35], a[200:203], v[40:43], v[32:35]
    ds_read_b128 v[40:43], v3 offset:20480
    v_add_f32 v100, v100, v102
    v_mfma_f32_16x16x32_bf16 v[32:35], a[212:215], v[44:47], v[32:35]
    ds_read_b128 v[44:47], v3 offset:21504
    s_waitcnt lgkmcnt(2)
    v_mfma_f32_16x16x32_bf16 v[32:35], a[224:227], v[48:51], v[32:35]
    v_add_f32 v101, v101, v103
    v_mfma_f32_16x16x32_bf16 v[32:35], a[236:239], v[52:55], v[32:35]
    s_nop 0
    v_permlane16_swap_b32 v100, v101
    v_mfma_f32_16x16x32_bf16 v[28:31], a[232:235], v[52:55], v[28:31]
    v_add_f32 v100, v100, v101
    v_mov_b32 v101, v100
    v_mfma_f32_16x16x32_bf16 v[28:31], a[220:223], v[48:51], v[28:31]
    s_nop 0
    v_permlane32_swap_b32 v100, v101
    v_mfma_f32_16x16x32_bf16 v[24:27], a[216:219], v[48:51], v[24:27]
    ds_read_b128 v[48:51], v3 offset:22528
    v_add_f32 v100, v100, v101
    v_mfma_f32_16x16x32_bf16 v[24:27], a[228:231], v[52:55], v[24:27]
    ds_read_b128 v[52:55], v3 offset:23552
    s_waitcnt lgkmcnt(2)
    v_mfma_f32_16x16x32_bf16 v[24:27], a[240:243], v[40:43], v[24:27]
    v_mul_f32 v100, 0x3a800000, v100
    v_mov_b32 v101, v100
    v_mfma_f32_16x16x32_bf16 v[24:27], a[252:255], v[44:47], v[24:27]
    s_nop 0
    v_permlane16_swap_b32 v100, v101
    v_mfma_f32_16x16x32_bf16 v[28:31], v[128:131], v[44:47], v[28:31]
    v_fma_f32 v101, -v100, v100, v101
    v_max_f32 v101, 0, v101
    v_mfma_f32_16x16x32_bf16 v[28:31], a[244:247], v[40:43], v[28:31]
    v_add_f32 v101, 0x3727c5ac, v101
    v_mfma_f32_16x16x32_bf16 v[32:35], a[248:251], v[40:43], v[32:35]
    ds_read_b128 v[40:43], v3 offset:24576
    v_mfma_f32_16x16x32_bf16 v[32:35], v[132:135], v[44:47], v[32:35]
    ds_read_b128 v[44:47], v3 offset:25600
    s_waitcnt lgkmcnt(2)
    v_mfma_f32_16x16x32_bf16 v[32:35], v[144:147], v[48:51], v[32:35]
    v_rsq_f32 v21, v101
    v_mfma_f32_16x16x32_bf16 v[32:35], v[156:159], v[52:55], v[32:35]
    v_mul_f32 v100, v100, v21
    v_fma_f32 v80, -v100, v56, v68
    v_mfma_f32_16x16x32_bf16 v[28:31], v[152:155], v[52:55], v[28:31]
    v_fma_f32 v81, -v100, v57, v69
    v_fma_f32 v82, -v100, v58, v70
    v_mfma_f32_16x16x32_bf16 v[28:31], v[140:143], v[48:51], v[28:31]
    v_fma_f32 v83, -v100, v59, v71
    v_fma_f32 v84, -v100, v60, v72
    v_mfma_f32_16x16x32_bf16 v[24:27], v[136:139], v[48:51], v[24:27]
    ds_read_b128 v[48:51], v3 offset:26624
    v_fma_f32 v85, -v100, v61, v73
    v_mfma_f32_16x16x32_bf16 v[24:27], v[148:151], v[52:55], v[24:27]
    ds_read_b128 v[52:55], v3 offset:27648
    s_waitcnt lgkmcnt(2)
    v_mfma_f32_16x16x32_bf16 v[24:27], v[160:163], v[40:43], v[24:27]
    v_fma_f32 v86, -v100, v62, v74
    v_fma_f32 v87, -v100, v63, v75
    v_mfma_f32_16x16x32_bf16 v[24:27], v[172:175], v[44:47], v[24:27]
    v_fma_f32 v88, -v100, v64, v76
    v_fma_f32 v89, -v100, v65, v77
    v_mfma_f32_16x16x32_bf16 v[28:31], v[176:179], v[44:47], v[28:31]
    v_fma_f32 v90, -v100, v66, v78
    v_fma_f32 v91, -v100, v67, v79
    v_mfma_f32_16x16x32_bf16 v[28:31], v[164:167], v[40:43], v[28:31]
    v_mfma_f32_16x16x32_bf16 v[32:35], v[168:171], v[40:43], v[32:35]
    ds_read_b128 v[40:43], v3 offset:28672
    v_mfma_f32_16x16x32_bf16 v[32:35], v[180:183], v[44:47], v[32:35]
    ds_read_b128 v[44:47], v3 offset:29696
    s_waitcnt lgkmcnt(2)
    v_mfma_f32_16x16x32_bf16 v[32:35], v[192:195], v[48:51], v[32:35]
    v_mfma_f32_16x16x32_bf16 v[32:35], v[204:207], v[52:55], v[32:35]
    s_waitcnt vmcnt(0)
    buffer_store_dword v6, v22, s[12:15], s17 offen sc1
    v_mfma_f32_16x16x32_bf16 v[28:31], v[200:203], v[52:55], v[28:31]
    s_mov_b32 s14, s6
    s_add_u32 s17, s17, 8192
    v_mfma_f32_16x16x32_bf16 v[28:31], v[188:191], v[48:51], v[28:31]
    v_mfma_f32_16x16x32_bf16 v[24:27], v[184:187], v[48:51], v[24:27]
    ds_read_b128 v[48:51], v3 offset:30720
    v_mfma_f32_16x16x32_bf16 v[24:27], v[196:199], v[52:55], v[24:27]
    ds_read_b128 v[52:55], v3 offset:31744
    s_waitcnt lgkmcnt(2)
    v_mfma_f32_16x16x32_bf16 v[24:27], v[208:211], v[40:43], v[24:27]
    buffer_load_dword v5, v4, s[4:7], s16 offen sc1
    v_mfma_f32_16x16x32_bf16 v[24:27], v[220:223], v[44:47], v[24:27]
    v_mfma_f32_16x16x32_bf16 v[28:31], v[224:227], v[44:47], v[28:31]
    v_mfma_f32_16x16x32_bf16 v[28:31], v[212:215], v[40:43], v[28:31]
    v_mfma_f32_16x16x32_bf16 v[32:35], v[216:219], v[40:43], v[32:35]
    v_mfma_f32_16x16x32_bf16 v[32:35], v[228:231], v[44:47], v[32:35]
    s_waitcnt lgkmcnt(0)
    v_mfma_f32_16x16x32_bf16 v[32:35], v[240:243], v[48:51], v[32:35]
    v_mfma_f32_16x16x32_bf16 v[32:35], v[252:255], v[52:55], v[32:35]
    v_mfma_f32_16x16x32_bf16 v[28:31], v[248:251], v[52:55], v[28:31]
    v_mfma_f32_16x16x32_bf16 v[28:31], v[236:239], v[48:51], v[28:31]
    v_mfma_f32_16x16x32_bf16 v[24:27], v[232:235], v[48:51], v[24:27]
    v_mfma_f32_16x16x32_bf16 v[24:27], v[244:247], v[52:55], v[24:27]
    s_nop 3
    v_fma_f32 v124, v32, v21, v88
    v_fma_f32 v125, v33, v21, v89
    v_fma_f32 v126, v34, v21, v90
    v_fma_f32 v127, v35, v21, v91
    v_mul_f32 v124, v124, |v124|
    v_mul_f32 v125, v125, |v125|
    v_mul_f32 v126, v126, |v126|
    v_mul_f32 v127, v127, |v127|
    v_cvt_pk_bf16_f32 v124, v124, v125
    v_cvt_pk_bf16_f32 v126, v126, v127
    v_pk_max_i16 v96, v124, 0
    v_pk_max_i16 v97, v126, 0
    v_pk_max_i16 v98, v124, 0
    v_pk_max_i16 v99, v126, 0
    v_fma_f32 v116, v24, v21, v80
    v_permlane32_swap_b32 v96, v98
    v_permlane32_swap_b32 v97, v99
    buffer_store_dwordx4 v[96:99], v7, s[12:15], s36 offen sc1
    v_fma_f32 v117, v25, v21, v81
    v_fma_f32 v118, v26, v21, v82
    v_fma_f32 v119, v27, v21, v83
    v_fma_f32 v120, v28, v21, v84
    v_fma_f32 v121, v29, v21, v85
    v_fma_f32 v122, v30, v21, v86
    v_fma_f32 v123, v31, v21, v87
    v_mul_f32 v116, v116, |v116|
    v_mul_f32 v117, v117, |v117|
    v_mul_f32 v118, v118, |v118|
    v_mul_f32 v119, v119, |v119|
    v_mul_f32 v120, v120, |v120|
    v_mul_f32 v121, v121, |v121|
    v_mul_f32 v122, v122, |v122|
    v_mul_f32 v123, v123, |v123|
    v_cvt_pk_bf16_f32 v116, v116, v117
    v_cvt_pk_bf16_f32 v118, v118, v119
    v_cvt_pk_bf16_f32 v120, v120, v121
    v_cvt_pk_bf16_f32 v122, v122, v123
    v_pk_max_i16 v92, v116, 0
    v_pk_max_i16 v93, v118, 0
    v_pk_max_i16 v94, v120, 0
    v_pk_max_i16 v95, v122, 0
    buffer_store_dwordx4 v[92:95], v1, s[12:15], s36 offen sc1
    s_add_u32 s54, s31, 1
    v_mov_b32 v6, s54
    s_waitcnt vmcnt(2)
    s_cmp_ge_i32 s31, 63
    s_cbranch_scc1 Lffa_late1
    v_cmp_gt_i32 vcc, s32, v5
    s_sub_u32 s43, s43, 1
    s_cmp_lt_i32 s43, 0
    s_cbranch_scc1 Lffa_rdy1
    s_and_b64 vcc, vcc, s[18:19]
    s_cbranch_scc0 Lffa_rdy1
Lffa_late1:
    buffer_load_dword v5, v4, s[4:7], s16 offen sc1
    s_waitcnt vmcnt(1)
    buffer_store_dword v6, v22, s[12:15], s17 offen sc1
    s_mov_b32 s14, 0
    s_cmp_ge_i32 s31, 63
    s_cbranch_scc1 L_exit
    s_waitcnt vmcnt(1)
    v_cmp_gt_i32 vcc, s32, v5
    s_sub_u32 s43, s43, 1
    s_cmp_lt_i32 s43, 0
    s_cbranch_scc1 Lffa_rdy1
    s_and_b64 vcc, vcc, s[18:19]
    s_cbranch_scc0 Lffa_rdy1
Lffa_spin1:
    buffer_load_dword v5, v4, s[4:7], s16 offen sc1
    s_waitcnt vmcnt(0)
    v_cmp_gt_i32 vcc, s32, v5
    s_sub_u32 s43, s43, 1
    s_cmp_lt_i32 s43, 0
    s_cbranch_scc1 Lffa_rdy1
    s_and_b64 vcc, vcc, s[18:19]
    s_cbranch_scc0 Lffa_rdy1
    s_sleep 8
    s_branch Lffa_spin1
Lffa_rdy1:
    s_add_u32 m0, s34, 0
    s_nop 0
    buffer_load_dwordx4 v1, s[8:11], s33 offen offset:0 sc1 lds
    buffer_load_dwordx4 v1, s[8:11], s33 offen offset:1024 sc1 lds
    buffer_load_dwordx4 v1, s[8:11], s33 offen offset:2048 sc1 lds
    buffer_load_dwordx4 v1, s[8:11], s33 offen offset:3072 sc1 lds
    s_add_u32 m0, s34, s3
    s_add_u32 s37, s33, s3
    buffer_load_dwordx4 v1, s[8:11], s37 offen offset:0 sc1 lds
    s_add_u32 s16, s16, 8192
    buffer_load_dword v5, v4, s[4:7], s16 offen sc1
    s_add_u32 m0, s34, 16384
    s_add_u32 s37, s33, 16384
    buffer_load_dwordx4 v1, s[8:11], s37 offen offset:0 sc1 lds
    buffer_load_dwordx4 v1, s[8:11], s37 offen offset:1024 sc1 lds
    buffer_load_dwordx4 v1, s[8:11], s37 offen offset:2048 sc1 lds
    buffer_load_dwordx4 v1, s[8:11], s37 offen offset:3072 sc1 lds
    s_add_u32 s32, s32, 1
    s_add_u32 s33, s33, 36864
    s_add_u32 s34, s34, 36864
    s_cmp_ge_u32 s34, 147456
    s_cselect_b32 s38, 147456, 0
    s_sub_u32 s34, s34, s38
    s_waitcnt vmcnt(5)
    buffer_store_dword v6, v22, s[12:15], s17 offen sc1
Lffa_go1:
    s_mov_b32 s14, 0
    s_barrier
    ds_read_b128 v[40:43], v2 offset:0
    ds_read_b128 v[44:47], v2 offset:1024
    ds_read_b128 v[48:51], v2 offset:2048
    ds_read_b128 v[52:55], v2 offset:3072
    s_cmp_eq_u32 s30, 1
    s_cbranch_scc1 Lffa_body01
    s_cmp_eq_u32 s30, 2
    s_cbranch_scc1 Lffa_body02
    s_cmp_eq_u32 s30, 3
    s_cbranch_scc1 Lffa_body03
    s_branch Lffa_body00
Lffb_start:
    s_mov_b32 s12, s76
    s_mov_b32 s13, s77
    s_mov_b32 s14, 0x700000
    s_mov_b32 s15, 0x00020000
    v_lshrrev_b32 v24, 3, v0
    v_mul_u32_u24 v24, 2048, v24
    v_bfe_u32 v25, v0, 4, 2
    v_lshlrev_b32 v25, 1, v25
    v_and_b32 v26, 7, v0
    v_xor_b32 v25, v25, v26
    v_lshl_add_u32 v40, v25, 4, v24
    v_add_u32 v41, 15360, v40
    s_sub_u32 s38, s29, 44
    s_and_b32 s39, s38, 3
    s_lshr_b32 s38, s38, 2
    s_mul_i32 s86, s38, 0x180000
    s_mul_i32 s53, s39, 0x200
    s_add_u32 s86, s86, s53
    s_mul_i32 s37, s30, 32768
    s_add_u32 s86, s86, s37
    s_lshl_b32 s87, s30, 11
    s_add_u32 m0, s87, 0
    s_add_u32 s37, s86, 0
    buffer_load_dwordx4 v40, s[12:15], s37 offen offset:0 lds
    buffer_load_dwordx4 v41, s[12:15], s37 offen offset:1024 lds
    s_add_u32 m0, s87, 8192
    s_add_u32 s37, s86, 128
    buffer_load_dwordx4 v40, s[12:15], s37 offen offset:0 lds
    buffer_load_dwordx4 v41, s[12:15], s37 offen offset:1024 lds
    s_add_u32 m0, s87, 16384
    s_add_u32 s37, s86, 256
    buffer_load_dwordx4 v40, s[12:15], s37 offen offset:0 lds
    buffer_load_dwordx4 v41, s[12:15], s37 offen offset:1024 lds
    s_add_u32 m0, s87, 24576
    s_add_u32 s37, s86, 384
    buffer_load_dwordx4 v40, s[12:15], s37 offen offset:0 lds
    buffer_load_dwordx4 v41, s[12:15], s37 offen offset:1024 lds
    s_add_u32 m0, s87, 32768
    s_add_u32 s37, s86, 131072
    buffer_load_dwordx4 v40, s[12:15], s37 offen offset:0 lds
    buffer_load_dwordx4 v41, s[12:15], s37 offen offset:1024 lds
    s_add_u32 m0, s87, 40960
    s_add_u32 s37, s86, 131200
    buffer_load_dwordx4 v40, s[12:15], s37 offen offset:0 lds
    buffer_load_dwordx4 v41, s[12:15], s37 offen offset:1024 lds
    s_add_u32 m0, s87, 49152
    s_add_u32 s37, s86, 131328
    buffer_load_dwordx4 v40, s[12:15], s37 offen offset:0 lds
    buffer_load_dwordx4 v41, s[12:15], s37 offen offset:1024 lds
    s_add_u32 m0, s87, 57344
    s_add_u32 s37, s86, 131456
    buffer_load_dwordx4 v40, s[12:15], s37 offen offset:0 lds
    buffer_load_dwordx4 v41, s[12:15], s37 offen offset:1024 lds
    s_add_u32 m0, s87, 65536
    s_add_u32 s37, s86, 262144
    buffer_load_dwordx4 v40, s[12:15], s37 offen offset:0 lds
    buffer_load_dwordx4 v41, s[12:15], s37 offen offset:1024 lds
    s_add_u32 m0, s87, 73728
    s_add_u32 s37, s86, 262272
    buffer_load_dwordx4 v40, s[12:15], s37 offen offset:0 lds
    buffer_load_dwordx4 v41, s[12:15], s37 offen offset:1024 lds
    s_add_u32 m0, s87, 81920
    s_add_u32 s37, s86, 262400
    buffer_load_dwordx4 v40, s[12:15], s37 offen offset:0 lds
    buffer_load_dwordx4 v41, s[12:15], s37 offen offset:1024 lds
    s_add_u32 m0, s87, 90112
    s_add_u32 s37, s86, 262528
    buffer_load_dwordx4 v40, s[12:15], s37 offen offset:0 lds
    buffer_load_dwordx4 v41, s[12:15], s37 offen offset:1024 lds
    s_add_u32 m0, s87, 98304
    s_add_u32 s37, s86, 393216
    buffer_load_dwordx4 v40, s[12:15], s37 offen offset:0 lds
    buffer_load_dwordx4 v41, s[12:15], s37 offen offset:1024 lds
    s_add_u32 m0, s87, 106496
    s_add_u32 s37, s86, 393344
    buffer_load_dwordx4 v40, s[12:15], s37 offen offset:0 lds
    buffer_load_dwordx4 v41, s[12:15], s37 offen offset:1024 lds
    s_add_u32 m0, s87, 114688
    s_add_u32 s37, s86, 393472
    buffer_load_dwordx4 v40, s[12:15], s37 offen offset:0 lds
    buffer_load_dwordx4 v41, s[12:15], s37 offen offset:1024 lds
    s_add_u32 m0, s87, 122880
    s_add_u32 s37, s86, 393600
    buffer_load_dwordx4 v40, s[12:15], s37 offen offset:0 lds
    buffer_load_dwordx4 v41, s[12:15], s37 offen offset:1024 lds
    v_bfe_u32 v24, v0, 3, 2
    v_and_b32 v25, 3, v0
    v_lshlrev_b32 v25, 3, v25
    v_lshrrev_b32 v26, 2, v0
    v_lshl_add_u32 v26, v26, 7, v25
    v_lshrrev_b32 v27, 5, v0
    v_lshl_add_u32 v27, v27, 10, v26
    s_mov_b32 s37, s30
    s_mov_b32 s38, 0
    s_lshl_b32 s37, s37, 13
    v_xor_b32 v28, s38, v24
    v_lshl_add_u32 v28, v28, 5, s37
    v_add_u32 v42, v28, v26
    v_add_u32 v46, v28, v27
    s_mov_b32 s37, s30
    s_mov_b32 s38, 1
    s_lshl_b32 s37, s37, 13
    v_xor_b32 v28, s38, v24
    v_lshl_add_u32 v28, v28, 5, s37
    v_add_u32 v43, v28, v26
    v_add_u32 v47, v28, v27
    s_mov_b32 s37, s30
    s_mov_b32 s38, 2
    s_lshl_b32 s37, s37, 13
    v_xor_b32 v28, s38, v24
    v_lshl_add_u32 v28, v28, 5, s37
    v_add_u32 v44, v28, v26
    v_add_u32 v48, v28, v27
    s_mov_b32 s37, s30
    s_mov_b32 s38, 3
    s_lshl_b32 s37, s37, 13
    v_xor_b32 v28, s38, v24
    v_lshl_add_u32 v28, v28, 5, s37
    v_add_u32 v45, v28, v26
    v_add_u32 v49, v28, v27
    s_sub_u32 s38, s29, 44
    s_and_b32 s39, s38, 3
    s_lshr_b32 s38, s38, 2
    s_mul_i32 s37, s28, 0x80000
    s_mul_i32 s53, s38, 0x200
    s_add_u32 s37, s37, s53
    s_add_u32 s37, s37, 0x6000c00
    v_min_u32 v4, 15, v0
    v_lshl_add_u32 v4, v4, 5, s37
    s_mov_b32 s32, 1
    s_mul_i32 s33, s28, 0x720000
    s_mul_i32 s53, s38, 0x6000
    s_add_u32 s33, s33, s53
    s_add_u32 s33, s33, 0x2000000
    s_mul_i32 s36, s28, 0x800000
    s_mul_i32 s53, s38, 0x8000
    s_add_u32 s36, s36, s53
    s_mul_i32 s53, s39, 0x2000
    s_add_u32 s36, s36, s53
    s_mul_i32 s53, s30, 0x800
    s_add_u32 s36, s36, s53
    s_add_u32 s36, s36, 0x3fe0000
    s_mov_b32 s31, -1
    s_mov_b32 s35, 0
    s_mov_b32 s16, 0
    v_mov_b32 v5, 0
    s_mul_i32 s17, s28, 0x80000
    s_mul_i32 s53, s29, 0x80
    s_add_u32 s17, s17, s53
    s_mul_i32 s53, s30, 0x20
    s_add_u32 s17, s17, s53
    s_add_u32 s17, s17, 0x5ffe000
    v_cmp_eq_u32 vcc, 0, v0
    v_mov_b32 v80, 0x40000000
    s_nop 0
    v_cndmask_b32 v80, v80, v0, vcc
    v_mov_b32 v2, v1
    s_mul_i32 s34, s30, 3072
    s_mul_i32 s3, s30, 0x0
    s_add_u32 s3, s3, 0x3000
    s_add_u32 s41, s3, 4096
    s_add_u32 s33, s33, s34
    s_mov_b64 s[18:19], 0xffff
    v_mov_b32 v8, 0x40000000
    v_cndmask_b32 v4, v8, v4, s[18:19]
    v_add_u32 v12, 0, v42
    v_add_u32 v13, 0, v43
    v_add_u32 v14, 0, v44
    v_add_u32 v15, 0, v45
    s_waitcnt vmcnt(24) lgkmcnt(0)
    s_barrier
    s_add_u32 m0, s87, 131072
    s_add_u32 s37, s86, 524288
    buffer_load_dwordx4 v40, s[12:15], s37 offen offset:0 lds
    ds_read_b64_tr_b16 a[0:1], v12 offset:0
    ds_read_b64_tr_b16 a[2:3], v12 offset:2048
    ds_read_b64_tr_b16 a[4:5], v13 offset:0
    buffer_load_dwordx4 v41, s[12:15], s37 offen offset:1024 lds
    ds_read_b64_tr_b16 a[6:7], v13 offset:2048
    ds_read_b64_tr_b16 a[8:9], v14 offset:0
    ds_read_b64_tr_b16 a[10:11], v14 offset:2048
    s_add_u32 m0, s87, 139264
    s_add_u32 s37, s86, 524416
    buffer_load_dwordx4 v40, s[12:15], s37 offen offset:0 lds
    ds_read_b64_tr_b16 a[12:13], v15 offset:0
    ds_read_b64_tr_b16 a[14:15], v15 offset:2048
    ds_read_b64_tr_b16 a[16:17], v12 offset:4096
    buffer_load_dwordx4 v41, s[12:15], s37 offen offset:1024 lds
    ds_read_b64_tr_b16 a[18:19], v12 offset:6144
    ds_read_b64_tr_b16 a[20:21], v13 offset:4096
    ds_read_b64_tr_b16 a[22:23], v13 offset:6144
    s_add_u32 m0, s87, 147456
    s_add_u32 s37, s86, 524544
    buffer_load_dwordx4 v40, s[12:15], s37 offen offset:0 lds
    ds_read_b64_tr_b16 a[24:25], v14 offset:4096
    ds_read_b64_tr_b16 a[26:27], v14 offset:6144
    ds_read_b64_tr_b16 a[28:29], v15 offset:4096
    buffer_load_dwordx4 v41, s[12:15], s37 offen offset:1024 lds
    ds_read_b64_tr_b16 a[30:31], v15 offset:6144
    v_add_u32 v16, 32768, v42
    v_add_u32 v17, 32768, v43
    s_add_u32 m0, s87, 155648
    s_add_u32 s37, s86, 524672
    buffer_load_dwordx4 v40, s[12:15], s37 offen offset:0 lds
    v_add_u32 v18, 32768, v44
    v_add_u32 v19, 32768, v45
    buffer_load_dwordx4 v41, s[12:15], s37 offen offset:1024 lds
    s_waitcnt vmcnt(24) lgkmcnt(0)
    s_barrier
    s_add_u32 m0, s87, 0
    s_add_u32 s37, s86, 655360
    buffer_load_dwordx4 v40, s[12:15], s37 offen offset:0 lds
    ds_read_b64_tr_b16 a[32:33], v16 offset:0
    ds_read_b64_tr_b16 a[34:35], v16 offset:2048
    ds_read_b64_tr_b16 a[36:37], v17 offset:0
    buffer_load_dwordx4 v41, s[12:15], s37 offen offset:1024 lds
    ds_read_b64_tr_b16 a[38:39], v17 offset:2048
    ds_read_b64_tr_b16 a[40:41], v18 offset:0
    ds_read_b64_tr_b16 a[42:43], v18 offset:2048
    s_add_u32 m0, s87, 8192
    s_add_u32 s37, s86, 655488
    buffer_load_dwordx4 v40, s[12:15], s37 offen offset:0 lds
    ds_read_b64_tr_b16 a[44:45], v19 offset:0
    ds_read_b64_tr_b16 a[46:47], v19 offset:2048
    ds_read_b64_tr_b16 a[48:49], v16 offset:4096
    buffer_load_dwordx4 v41, s[12:15], s37 offen offset:1024 lds
    ds_read_b64_tr_b16 a[50:51], v16 offset:6144
    ds_read_b64_tr_b16 a[52:53], v17 offset:4096
    ds_read_b64_tr_b16 a[54:55], v17 offset:6144
    s_add_u32 m0, s87, 16384
    s_add_u32 s37, s86, 655616
    buffer_load_dwordx4 v40, s[12:15], s37 offen offset:0 lds
    ds_read_b64_tr_b16 a[56:57], v18 offset:4096
    ds_read_b64_tr_b16 a[58:59], v18 offset:6144
    ds_read_b64_tr_b16 a[60:61], v19 offset:4096
    buffer_load_dwordx4 v41, s[12:15], s37 offen offset:1024 lds
    ds_read_b64_tr_b16 a[62:63], v19 offset:6144
    v_add_u32 v12, 65536, v46
    v_add_u32 v13, 65536, v47
    s_add_u32 m0, s87, 24576
    s_add_u32 s37, s86, 655744
    buffer_load_dwordx4 v40, s[12:15], s37 offen offset:0 lds
    v_add_u32 v14, 65536, v48
    v_add_u32 v15, 65536, v49
    buffer_load_dwordx4 v41, s[12:15], s37 offen offset:1024 lds
    s_waitcnt vmcnt(24) lgkmcnt(0)
    s_barrier
    s_add_u32 m0, s87, 32768
    s_add_u32 s37, s86, 786432
    buffer_load_dwordx4 v40, s[12:15], s37 offen offset:0 lds
    ds_read_b64_tr_b16 a[64:65], v12 offset:0
    ds_read_b64_tr_b16 a[66:67], v12 offset:1024
    ds_read_b64_tr_b16 a[68:69], v13 offset:0
    buffer_load_dwordx4 v41, s[12:15], s37 offen offset:1024 lds
    ds_read_b64_tr_b16 a[70:71], v13 offset:1024
    ds_read_b64_tr_b16 a[72:73], v14 offset:0
    ds_read_b64_tr_b16 a[74:75], v14 offset:1024
    s_add_u32 m0, s87, 40960
    s_add_u32 s37, s86, 786560
    buffer_load_dwordx4 v40, s[12:15], s37 offen offset:0 lds
    ds_read_b64_tr_b16 a[76:77], v15 offset:0
    ds_read_b64_tr_b16 a[78:79], v15 offset:1024
    ds_read_b64_tr_b16 a[80:81], v12 offset:4096
    buffer_load_dwordx4 v41, s[12:15], s37 offen offset:1024 lds
    ds_read_b64_tr_b16 a[82:83], v12 offset:5120
    ds_read_b64_tr_b16 a[84:85], v13 offset:4096
    ds_read_b64_tr_b16 a[86:87], v13 offset:5120
    s_add_u32 m0, s87, 49152
    s_add_u32 s37, s86, 786688
    buffer_load_dwordx4 v40, s[12:15], s37 offen offset:0 lds
    ds_read_b64_tr_b16 a[88:89], v14 offset:4096
    ds_read_b64_tr_b16 a[90:91], v14 offset:5120
    ds_read_b64_tr_b16 a[92:93], v15 offset:4096
    buffer_load_dwordx4 v41, s[12:15], s37 offen offset:1024 lds
    ds_read_b64_tr_b16 a[94:95], v15 offset:5120
    v_add_u32 v16, 98304, v42
    v_add_u32 v17, 98304, v43
    s_add_u32 m0, s87, 57344
    s_add_u32 s37, s86, 786816
    buffer_load_dwordx4 v40, s[12:15], s37 offen offset:0 lds
    v_add_u32 v18, 98304, v44
    v_add_u32 v19, 98304, v45
    buffer_load_dwordx4 v41, s[12:15], s37 offen offset:1024 lds
    s_waitcnt vmcnt(24) lgkmcnt(0)
    s_barrier
    s_add_u32 m0, s87, 65536
    s_add_u32 s37, s86, 917504
    buffer_load_dwordx4 v40, s[12:15], s37 offen offset:0 lds
    ds_read_b64_tr_b16 a[96:97], v16 offset:0
    ds_read_b64_tr_b16 a[98:99], v16 offset:2048
    ds_read_b64_tr_b16 a[100:101], v17 offset:0
    buffer_load_dwordx4 v41, s[12:15], s37 offen offset:1024 lds
    ds_read_b64_tr_b16 a[102:103], v17 offset:2048
    ds_read_b64_tr_b16 a[104:105], v18 offset:0
    ds_read_b64_tr_b16 a[106:107], v18 offset:2048
    s_add_u32 m0, s87, 73728
    s_add_u32 s37, s86, 917632
    buffer_load_dwordx4 v40, s[12:15], s37 offen offset:0 lds
    ds_read_b64_tr_b16 a[108:109], v19 offset:0
    ds_read_b64_tr_b16 a[110:111], v19 offset:2048
    ds_read_b64_tr_b16 a[112:113], v16 offset:4096
    buffer_load_dwordx4 v41, s[12:15], s37 offen offset:1024 lds
    ds_read_b64_tr_b16 a[114:115], v16 offset:6144
    ds_read_b64_tr_b16 a[116:117], v17 offset:4096
    ds_read_b64_tr_b16 a[118:119], v17 offset:6144
    s_add_u32 m0, s87, 81920
    s_add_u32 s37, s86, 917760
    buffer_load_dwordx4 v40, s[12:15], s37 offen offset:0 lds
    ds_read_b64_tr_b16 a[120:121], v18 offset:4096
    ds_read_b64_tr_b16 a[122:123], v18 offset:6144
    ds_read_b64_tr_b16 a[124:125], v19 offset:4096
    buffer_load_dwordx4 v41, s[12:15], s37 offen offset:1024 lds
    ds_read_b64_tr_b16 a[126:127], v19 offset:6144
    v_add_u32 v12, 131072, v42
    v_add_u32 v13, 131072, v43
    s_add_u32 m0, s87, 90112
    s_add_u32 s37, s86, 917888
    buffer_load_dwordx4 v40, s[12:15], s37 offen offset:0 lds
    v_add_u32 v14, 131072, v44
    v_add_u32 v15, 131072, v45
    buffer_load_dwordx4 v41, s[12:15], s37 offen offset:1024 lds
    s_waitcnt vmcnt(24) lgkmcnt(0)
    s_barrier
    s_add_u32 m0, s87, 98304
    s_add_u32 s37, s86, 1048576
    buffer_load_dwordx4 v40, s[12:15], s37 offen offset:0 lds
    ds_read_b64_tr_b16 a[128:129], v12 offset:0
    ds_read_b64_tr_b16 a[130:131], v12 offset:2048
    ds_read_b64_tr_b16 a[132:133], v13 offset:0
    buffer_load_dwordx4 v41, s[12:15], s37 offen offset:1024 lds
    ds_read_b64_tr_b16 a[134:135], v13 offset:2048
    ds_read_b64_tr_b16 a[136:137], v14 offset:0
    ds_read_b64_tr_b16 a[138:139], v14 offset:2048
    s_add_u32 m0, s87, 106496
    s_add_u32 s37, s86, 1048704
    buffer_load_dwordx4 v40, s[12:15], s37 offen offset:0 lds
    ds_read_b64_tr_b16 a[140:141], v15 offset:0
    ds_read_b64_tr_b16 a[142:143], v15 offset:2048
    ds_read_b64_tr_b16 a[144:145], v12 offset:4096
    buffer_load_dwordx4 v41, s[12:15], s37 offen offset:1024 lds
    ds_read_b64_tr_b16 a[146:147], v12 offset:6144
    ds_read_b64_tr_b16 a[148:149], v13 offset:4096
    ds_read_b64_tr_b16 a[150:151], v13 offset:6144
    s_add_u32 m0, s87, 114688
    s_add_u32 s37, s86, 1048832
    buffer_load_dwordx4 v40, s[12:15], s37 offen offset:0 lds
    ds_read_b64_tr_b16 a[152:153], v14 offset:4096
    ds_read_b64_tr_b16 a[154:155], v14 offset:6144
    ds_read_b64_tr_b16 a[156:157], v15 offset:4096
    buffer_load_dwordx4 v41, s[12:15], s37 offen offset:1024 lds
    ds_read_b64_tr_b16 a[158:159], v15 offset:6144
    v_add_u32 v16, 0, v46
    v_add_u32 v17, 0, v47
    s_add_u32 m0, s87, 122880
    s_add_u32 s37, s86, 1048960
    buffer_load_dwordx4 v40, s[12:15], s37 offen offset:0 lds
    v_add_u32 v18, 0, v48
    v_add_u32 v19, 0, v49
    buffer_load_dwordx4 v41, s[12:15], s37 offen offset:1024 lds
    s_waitcnt vmcnt(24) lgkmcnt(0)
    s_barrier
    s_add_u32 m0, s87, 131072
    s_add_u32 s37, s86, 1179648
    buffer_load_dwordx4 v40, s[12:15], s37 offen offset:0 lds
    ds_read_b64_tr_b16 a[160:161], v16 offset:0
    ds_read_b64_tr_b16 a[162:163], v16 offset:1024
    ds_read_b64_tr_b16 a[164:165], v17 offset:0
    buffer_load_dwordx4 v41, s[12:15], s37 offen offset:1024 lds
    ds_read_b64_tr_b16 a[166:167], v17 offset:1024
    ds_read_b64_tr_b16 a[168:169], v18 offset:0
    ds_read_b64_tr_b16 a[170:171], v18 offset:1024
    s_add_u32 m0, s87, 139264
    s_add_u32 s37, s86, 1179776
    buffer_load_dwordx4 v40, s[12:15], s37 offen offset:0 lds
    ds_read_b64_tr_b16 a[172:173], v19 offset:0
    ds_read_b64_tr_b16 a[174:175], v19 offset:1024
    ds_read_b64_tr_b16 a[176:177], v16 offset:4096
    buffer_load_dwordx4 v41, s[12:15], s37 offen offset:1024 lds
    ds_read_b64_tr_b16 a[178:179], v16 offset:5120
    ds_read_b64_tr_b16 a[180:181], v17 offset:4096
    ds_read_b64_tr_b16 a[182:183], v17 offset:5120
    s_add_u32 m0, s87, 147456
    s_add_u32 s37, s86, 1179904
    buffer_load_dwordx4 v40, s[12:15], s37 offen offset:0 lds
    ds_read_b64_tr_b16 a[184:185], v18 offset:4096
    ds_read_b64_tr_b16 a[186:187], v18 offset:5120
    ds_read_b64_tr_b16 a[188:189], v19 offset:4096
    buffer_load_dwordx4 v41, s[12:15], s37 offen offset:1024 lds
    ds_read_b64_tr_b16 a[190:191], v19 offset:5120
    v_add_u32 v12, 32768, v42
    v_add_u32 v13, 32768, v43
    s_add_u32 m0, s87, 155648
    s_add_u32 s37, s86, 1180032
    buffer_load_dwordx4 v40, s[12:15], s37 offen offset:0 lds
    v_add_u32 v14, 32768, v44
    v_add_u32 v15, 32768, v45
    buffer_load_dwordx4 v41, s[12:15], s37 offen offset:1024 lds
    s_waitcnt vmcnt(24) lgkmcnt(0)
    s_barrier
    s_add_u32 m0, s87, 0
    s_add_u32 s37, s86, 1310720
    buffer_load_dwordx4 v40, s[12:15], s37 offen offset:0 lds
    ds_read_b64_tr_b16 a[192:193], v12 offset:0
    ds_read_b64_tr_b16 a[194:195], v12 offset:2048
    ds_read_b64_tr_b16 a[196:197], v13 offset:0
    buffer_load_dwordx4 v41, s[12:15], s37 offen offset:1024 lds
    ds_read_b64_tr_b16 a[198:199], v13 offset:2048
    ds_read_b64_tr_b16 a[200:201], v14 offset:0
    ds_read_b64_tr_b16 a[202:203], v14 offset:2048
    s_add_u32 m0, s87, 8192
    s_add_u32 s37, s86, 1310848
    buffer_load_dwordx4 v40, s[12:15], s37 offen offset:0 lds
    ds_read_b64_tr_b16 a[204:205], v15 offset:0
    ds_read_b64_tr_b16 a[206:207], v15 offset:2048
    ds_read_b64_tr_b16 a[208:209], v12 offset:4096
    buffer_load_dwordx4 v41, s[12:15], s37 offen offset:1024 lds
    ds_read_b64_tr_b16 a[210:211], v12 offset:6144
    ds_read_b64_tr_b16 a[212:213], v13 offset:4096
    ds_read_b64_tr_b16 a[214:215], v13 offset:6144
    s_add_u32 m0, s87, 16384
    s_add_u32 s37, s86, 1310976
    buffer_load_dwordx4 v40, s[12:15], s37 offen offset:0 lds
    ds_read_b64_tr_b16 a[216:217], v14 offset:4096
    ds_read_b64_tr_b16 a[218:219], v14 offset:6144
    ds_read_b64_tr_b16 a[220:221], v15 offset:4096
    buffer_load_dwordx4 v41, s[12:15], s37 offen offset:1024 lds
    ds_read_b64_tr_b16 a[222:223], v15 offset:6144
    v_add_u32 v16, 65536, v42
    v_add_u32 v17, 65536, v43
    s_add_u32 m0, s87, 24576
    s_add_u32 s37, s86, 1311104
    buffer_load_dwordx4 v40, s[12:15], s37 offen offset:0 lds
    v_add_u32 v18, 65536, v44
    v_add_u32 v19, 65536, v45
    buffer_load_dwordx4 v41, s[12:15], s37 offen offset:1024 lds
    s_waitcnt vmcnt(24) lgkmcnt(0)
    s_barrier
    s_add_u32 m0, s87, 32768
    s_add_u32 s37, s86, 1441792
    buffer_load_dwordx4 v40, s[12:15], s37 offen offset:0 lds
    ds_read_b64_tr_b16 a[224:225], v16 offset:0
    ds_read_b64_tr_b16 a[226:227], v16 offset:2048
    ds_read_b64_tr_b16 a[228:229], v17 offset:0
    buffer_load_dwordx4 v41, s[12:15], s37 offen offset:1024 lds
    ds_read_b64_tr_b16 a[230:231], v17 offset:2048
    ds_read_b64_tr_b16 a[232:233], v18 offset:0
    ds_read_b64_tr_b16 a[234:235], v18 offset:2048
    s_add_u32 m0, s87, 40960
    s_add_u32 s37, s86, 1441920
    buffer_load_dwordx4 v40, s[12:15], s37 offen offset:0 lds
    ds_read_b64_tr_b16 a[236:237], v19 offset:0
    ds_read_b64_tr_b16 a[238:239], v19 offset:2048
    ds_read_b64_tr_b16 a[240:241], v16 offset:4096
    buffer_load_dwordx4 v41, s[12:15], s37 offen offset:1024 lds
    ds_read_b64_tr_b16 a[242:243], v16 offset:6144
    ds_read_b64_tr_b16 a[244:245], v17 offset:4096
    ds_read_b64_tr_b16 a[246:247], v17 offset:6144
    s_add_u32 m0, s87, 49152
    s_add_u32 s37, s86, 1442048
    buffer_load_dwordx4 v40, s[12:15], s37 offen offset:0 lds
    ds_read_b64_tr_b16 a[248:249], v18 offset:4096
    ds_read_b64_tr_b16 a[250:251], v18 offset:6144
    ds_read_b64_tr_b16 a[252:253], v19 offset:4096
    buffer_load_dwordx4 v41, s[12:15], s37 offen offset:1024 lds
    ds_read_b64_tr_b16 a[254:255], v19 offset:6144
    v_add_u32 v12, 98304, v46
    v_add_u32 v13, 98304, v47
    s_add_u32 m0, s87, 57344
    s_add_u32 s37, s86, 1442176
    buffer_load_dwordx4 v40, s[12:15], s37 offen offset:0 lds
    v_add_u32 v14, 98304, v48
    v_add_u32 v15, 98304, v49
    buffer_load_dwordx4 v41, s[12:15], s37 offen offset:1024 lds
    s_waitcnt vmcnt(24) lgkmcnt(0)
    s_barrier
    ds_read_b64_tr_b16 v[128:129], v12 offset:0
    ds_read_b64_tr_b16 v[130:131], v12 offset:1024
    ds_read_b64_tr_b16 v[132:133], v13 offset:0
    ds_read_b64_tr_b16 v[134:135], v13 offset:1024
    ds_read_b64_tr_b16 v[136:137], v14 offset:0
    ds_read_b64_tr_b16 v[138:139], v14 offset:1024
    ds_read_b64_tr_b16 v[140:141], v15 offset:0
    ds_read_b64_tr_b16 v[142:143], v15 offset:1024
    ds_read_b64_tr_b16 v[144:145], v12 offset:4096
    ds_read_b64_tr_b16 v[146:147], v12 offset:5120
    ds_read_b64_tr_b16 v[148:149], v13 offset:4096
    ds_read_b64_tr_b16 v[150:151], v13 offset:5120
    ds_read_b64_tr_b16 v[152:153], v14 offset:4096
    ds_read_b64_tr_b16 v[154:155], v14 offset:5120
    ds_read_b64_tr_b16 v[156:157], v15 offset:4096
    ds_read_b64_tr_b16 v[158:159], v15 offset:5120
    v_add_u32 v16, 131072, v42
    v_add_u32 v17, 131072, v43
    v_add_u32 v18, 131072, v44
    v_add_u32 v19, 131072, v45
    s_waitcnt vmcnt(16) lgkmcnt(0)
    s_barrier
    ds_read_b64_tr_b16 v[160:161], v16 offset:0
    ds_read_b64_tr_b16 v[162:163], v16 offset:2048
    ds_read_b64_tr_b16 v[164:165], v17 offset:0
    ds_read_b64_tr_b16 v[166:167], v17 offset:2048
    ds_read_b64_tr_b16 v[168:169], v18 offset:0
    ds_read_b64_tr_b16 v[170:171], v18 offset:2048
    ds_read_b64_tr_b16 v[172:173], v19 offset:0
    ds_read_b64_tr_b16 v[174:175], v19 offset:2048
    ds_read_b64_tr_b16 v[176:177], v16 offset:4096
    ds_read_b64_tr_b16 v[178:179], v16 offset:6144
    ds_read_b64_tr_b16 v[180:181], v17 offset:4096
    ds_read_b64_tr_b16 v[182:183], v17 offset:6144
    ds_read_b64_tr_b16 v[184:185], v18 offset:4096
    ds_read_b64_tr_b16 v[186:187], v18 offset:6144
    ds_read_b64_tr_b16 v[188:189], v19 offset:4096
    ds_read_b64_tr_b16 v[190:191], v19 offset:6144
    v_add_u32 v12, 0, v42
    v_add_u32 v13, 0, v43
    v_add_u32 v14, 0, v44
    v_add_u32 v15, 0, v45
    s_waitcnt vmcnt(8) lgkmcnt(0)
    s_barrier
    ds_read_b64_tr_b16 v[192:193], v12 offset:0
    ds_read_b64_tr_b16 v[194:195], v12 offset:2048
    ds_read_b64_tr_b16 v[196:197], v13 offset:0
    ds_read_b64_tr_b16 v[198:199], v13 offset:2048
    ds_read_b64_tr_b16 v[200:201], v14 offset:0
    ds_read_b64_tr_b16 v[202:203], v14 offset:2048
    ds_read_b64_tr_b16 v[204:205], v15 offset:0
    ds_read_b64_tr_b16 v[206:207], v15 offset:2048
    ds_read_b64_tr_b16 v[208:209], v12 offset:4096
    ds_read_b64_tr_b16 v[210:211], v12 offset:6144
    ds_read_b64_tr_b16 v[212:213], v13 offset:4096
    ds_read_b64_tr_b16 v[214:215], v13 offset:6144
    ds_read_b64_tr_b16 v[216:217], v14 offset:4096
    ds_read_b64_tr_b16 v[218:219], v14 offset:6144
    ds_read_b64_tr_b16 v[220:221], v15 offset:4096
    ds_read_b64_tr_b16 v[222:223], v15 offset:6144
    v_add_u32 v16, 32768, v46
    v_add_u32 v17, 32768, v47
    v_add_u32 v18, 32768, v48
    v_add_u32 v19, 32768, v49
    s_waitcnt vmcnt(0) lgkmcnt(0)
    s_barrier
    ds_read_b64_tr_b16 v[224:225], v16 offset:0
    ds_read_b64_tr_b16 v[226:227], v16 offset:1024
    ds_read_b64_tr_b16 v[228:229], v17 offset:0
    ds_read_b64_tr_b16 v[230:231], v17 offset:1024
    ds_read_b64_tr_b16 v[232:233], v18 offset:0
    ds_read_b64_tr_b16 v[234:235], v18 offset:1024
    ds_read_b64_tr_b16 v[236:237], v19 offset:0
    ds_read_b64_tr_b16 v[238:239], v19 offset:1024
    ds_read_b64_tr_b16 v[240:241], v16 offset:4096
    ds_read_b64_tr_b16 v[242:243], v16 offset:5120
    ds_read_b64_tr_b16 v[244:245], v17 offset:4096
    ds_read_b64_tr_b16 v[246:247], v17 offset:5120
    ds_read_b64_tr_b16 v[248:249], v18 offset:4096
    ds_read_b64_tr_b16 v[250:251], v18 offset:5120
    ds_read_b64_tr_b16 v[252:253], v19 offset:4096
    ds_read_b64_tr_b16 v[254:255], v19 offset:5120
    s_waitcnt lgkmcnt(0)
    s_mov_b32 s12, s84
    s_mov_b32 s13, s85
    s_mov_b32 s14, 0x6200000
    s_mov_b32 s15, 0x00020000
    s_barrier
    s_mov_b32 s20, s82
    s_mov_b32 s21, s83
    s_mov_b32 s22, 0x100
    s_mov_b32 s23, 0x00020000
    v_and_b32 v8, 15, v0
    v_lshlrev_b32 v8, 4, v8
    v_mov_b32 v10, 8
    buffer_load_dword v9, v8, s[20:23], 0 offen sc1
    s_waitcnt vmcnt(0)
Lffb_wa:
    v_cmp_gt_u32 vcc, v10, v9
    s_sub_u32 s43, s43, 1
    s_cmp_lt_i32 s43, 0
    s_cbranch_scc1 Lffb_all
    s_cbranch_vccz Lffb_all
    s_sleep 2
    buffer_load_dword v9, v8, s[20:23], 0 offen sc1
    s_waitcnt vmcnt(0)
    s_branch Lffb_wa
Lffb_all:
    s_mov_b32 s14, 0
    s_cmp_lg_u32 s30, 0
    s_cbranch_scc1 Lffb_fok
Lffb_fspin:
    buffer_load_dword v5, v4, s[4:7], s16 offen sc1
    s_waitcnt vmcnt(0)
    v_cmp_gt_i32 vcc, s32, v5
    s_sub_u32 s43, s43, 1
    s_cmp_lt_i32 s43, 0
    s_cbranch_scc1 Lffb_fok
    s_and_b64 vcc, vcc, s[18:19]
    s_cbranch_scc0 Lffb_fok
    s_sleep 8
    s_branch Lffb_fspin
Lffb_fok:
    s_barrier
    s_branch Lffb_rdy1
    .p2align 6
Lffb_body00:
    s_waitcnt lgkmcnt(0)
    v_mfma_f32_16x16x32_bf16 v[8:11], a[0:3], v[40:43], 0
    ds_read_b128 v[48:51], v2 offset:2048
    s_add_u32 m0, s34, 0
    v_mfma_f32_16x16x32_bf16 v[8:11], a[16:19], v[44:47], v[8:11]
    s_add_u32 s31, s31, 1
    v_mov_b32 v6, s31
    s_add_u32 s35, s35, 36864
    v_mfma_f32_16x16x32_bf16 v[12:15], a[20:23], v[44:47], 0
    ds_read_b128 v[52:55], v2 offset:3072
    v_cvt_pk_bf16_f32 v72, v24, v25
    v_mfma_f32_16x16x32_bf16 v[12:15], a[4:7], v[40:43], v[12:15]
    s_cmp_eq_u32 s35, 147456
    s_cselect_b32 s35, 0, s35
    v_cvt_pk_bf16_f32 v73, v26, v27
    v_mfma_f32_16x16x32_bf16 v[16:19], a[8:11], v[40:43], 0
    v_cvt_pk_bf16_f32 v74, v28, v29
    v_cvt_pk_bf16_f32 v75, v30, v31
    v_mfma_f32_16x16x32_bf16 v[16:19], a[24:27], v[44:47], v[16:19]
    buffer_store_dwordx4 v[72:75], v1, s[12:15], s36 offen offset:0 sc1
    v_cvt_pk_bf16_f32 v76, v32, v33
    v_mfma_f32_16x16x32_bf16 v[20:23], a[28:31], v[44:47], 0
    v_cvt_pk_bf16_f32 v77, v34, v35
    v_cvt_pk_bf16_f32 v78, v36, v37
    v_mfma_f32_16x16x32_bf16 v[20:23], a[12:15], v[40:43], v[20:23]
    s_waitcnt lgkmcnt(0)
    v_cvt_pk_bf16_f32 v79, v38, v39
    v_add_u32 v3, s35, v1
    v_mfma_f32_16x16x32_bf16 v[20:23], a[44:47], v[48:51], v[20:23]
    ds_read_b128 v[56:59], v2 offset:4096
    v_mfma_f32_16x16x32_bf16 v[20:23], a[60:63], v[52:55], v[20:23]
    buffer_store_dwordx4 v[76:79], v1, s[12:15], s36 offen offset:1024 sc1
    s_add_u32 s36, s36, 131072
    v_mfma_f32_16x16x32_bf16 v[16:19], a[56:59], v[52:55], v[16:19]
    ds_read_b128 v[60:63], v2 offset:5120
    v_mfma_f32_16x16x32_bf16 v[16:19], a[40:43], v[48:51], v[16:19]
    v_mfma_f32_16x16x32_bf16 v[12:15], a[36:39], v[48:51], v[12:15]
    v_mfma_f32_16x16x32_bf16 v[12:15], a[52:55], v[52:55], v[12:15]
    v_mfma_f32_16x16x32_bf16 v[8:11], a[48:51], v[52:55], v[8:11]
    v_mfma_f32_16x16x32_bf16 v[8:11], a[32:35], v[48:51], v[8:11]
    s_waitcnt lgkmcnt(0)
    v_mfma_f32_16x16x32_bf16 v[8:11], a[64:67], v[56:59], v[8:11]
    ds_read_b128 v[64:67], v2 offset:6144
    v_mfma_f32_16x16x32_bf16 v[8:11], a[80:83], v[60:63], v[8:11]
    v_mfma_f32_16x16x32_bf16 v[12:15], a[84:87], v[60:63], v[12:15]
    ds_read_b128 v[68:71], v2 offset:7168
    v_mfma_f32_16x16x32_bf16 v[12:15], a[68:71], v[56:59], v[12:15]
    v_mfma_f32_16x16x32_bf16 v[16:19], a[72:75], v[56:59], v[16:19]
    v_mfma_f32_16x16x32_bf16 v[16:19], a[88:91], v[60:63], v[16:19]
    v_mfma_f32_16x16x32_bf16 v[20:23], a[92:95], v[60:63], v[20:23]
    v_mfma_f32_16x16x32_bf16 v[20:23], a[76:79], v[56:59], v[20:23]
    s_waitcnt lgkmcnt(0)
    v_mfma_f32_16x16x32_bf16 v[20:23], a[108:111], v[64:67], v[20:23]
    ds_read_b128 v[40:43], v2 offset:8192
    s_waitcnt vmcnt(2)
    v_mfma_f32_16x16x32_bf16 v[20:23], a[124:127], v[68:71], v[20:23]
    v_cmp_gt_i32 vcc, s32, v5
    v_mfma_f32_16x16x32_bf16 v[16:19], a[120:123], v[68:71], v[16:19]
    ds_read_b128 v[44:47], v2 offset:9216
    v_mfma_f32_16x16x32_bf16 v[16:19], a[104:107], v[64:67], v[16:19]
    s_and_b64 vcc, vcc, s[18:19]
    s_cbranch_scc1 Lffb_v01
    v_mfma_f32_16x16x32_bf16 v[12:15], a[100:103], v[64:67], v[12:15]
    buffer_load_dwordx4 v1, s[8:11], s33 offen offset:0 sc1 lds
    v_mfma_f32_16x16x32_bf16 v[12:15], a[116:119], v[68:71], v[12:15]
    v_mfma_f32_16x16x32_bf16 v[8:11], a[112:115], v[68:71], v[8:11]
    v_mfma_f32_16x16x32_bf16 v[8:11], a[96:99], v[64:67], v[8:11]
    s_waitcnt lgkmcnt(0)
    v_mfma_f32_16x16x32_bf16 v[8:11], a[128:131], v[40:43], v[8:11]
    ds_read_b128 v[48:51], v2 offset:10240
    v_mfma_f32_16x16x32_bf16 v[8:11], a[144:147], v[44:47], v[8:11]
    buffer_load_dwordx4 v1, s[8:11], s33 offen offset:1024 sc1 lds
    v_mfma_f32_16x16x32_bf16 v[12:15], a[148:151], v[44:47], v[12:15]
    ds_read_b128 v[52:55], v2 offset:11264
    v_mfma_f32_16x16x32_bf16 v[12:15], a[132:135], v[40:43], v[12:15]
    v_mfma_f32_16x16x32_bf16 v[16:19], a[136:139], v[40:43], v[16:19]
    s_barrier
    v_mfma_f32_16x16x32_bf16 v[16:19], a[152:155], v[44:47], v[16:19]
    buffer_load_dwordx4 v1, s[8:11], s33 offen offset:2048 sc1 lds
    v_mfma_f32_16x16x32_bf16 v[20:23], a[156:159], v[44:47], v[20:23]
    s_add_u32 s16, s16, 8192
    s_add_u32 m0, s34, s3
    s_add_u32 s37, s33, s3
    v_mfma_f32_16x16x32_bf16 v[20:23], a[140:143], v[40:43], v[20:23]
    s_waitcnt lgkmcnt(0)
    v_mfma_f32_16x16x32_bf16 v[20:23], a[172:175], v[48:51], v[20:23]
    ds_read_b128 v[56:59], v2 offset:12288
    v_mfma_f32_16x16x32_bf16 v[20:23], a[188:191], v[52:55], v[20:23]
    buffer_load_dwordx4 v1, s[8:11], s37 offen offset:0 sc1 lds
    v_mfma_f32_16x16x32_bf16 v[16:19], a[184:187], v[52:55], v[16:19]
    ds_read_b128 v[60:63], v2 offset:13312
    v_mfma_f32_16x16x32_bf16 v[16:19], a[168:171], v[48:51], v[16:19]
    v_mfma_f32_16x16x32_bf16 v[12:15], a[164:167], v[48:51], v[12:15]
    v_mfma_f32_16x16x32_bf16 v[12:15], a[180:183], v[52:55], v[12:15]
    buffer_load_dwordx4 v1, s[8:11], s37 offen offset:1024 sc1 lds
    v_mfma_f32_16x16x32_bf16 v[8:11], a[176:179], v[52:55], v[8:11]
    v_mfma_f32_16x16x32_bf16 v[8:11], a[160:163], v[48:51], v[8:11]
    s_waitcnt lgkmcnt(0)
    v_mfma_f32_16x16x32_bf16 v[8:11], a[192:195], v[56:59], v[8:11]
    ds_read_b128 v[64:67], v2 offset:14336
    v_mfma_f32_16x16x32_bf16 v[8:11], a[208:211], v[60:63], v[8:11]
    buffer_load_dwordx4 v1, s[8:11], s37 offen offset:2048 sc1 lds
    v_mfma_f32_16x16x32_bf16 v[12:15], a[212:215], v[60:63], v[12:15]
    ds_read_b128 v[68:71], v2 offset:15360
    s_add_u32 s32, s32, 1
    v_mfma_f32_16x16x32_bf16 v[12:15], a[196:199], v[56:59], v[12:15]
    s_add_u32 s33, s33, 116736
    s_add_u32 s34, s34, 36864
    s_waitcnt vmcnt(6)
    v_mfma_f32_16x16x32_bf16 v[16:19], a[200:203], v[56:59], v[16:19]
    s_cmp_ge_u32 s34, 147456
    s_cselect_b32 s38, 147456, 0
    s_sub_u32 s34, s34, s38
    v_mfma_f32_16x16x32_bf16 v[16:19], a[216:219], v[60:63], v[16:19]
    buffer_store_dword v6, v80, s[12:15], s17 offen sc1
    s_mov_b32 s14, s6
    v_mfma_f32_16x16x32_bf16 v[20:23], a[220:223], v[60:63], v[20:23]
    s_add_u32 s17, s17, 8192
    v_mfma_f32_16x16x32_bf16 v[20:23], a[204:207], v[56:59], v[20:23]
    s_waitcnt lgkmcnt(0)
    v_mfma_f32_16x16x32_bf16 v[20:23], a[236:239], v[64:67], v[20:23]
    ds_read_b128 v[40:43], v2 offset:16384
    v_mfma_f32_16x16x32_bf16 v[20:23], a[252:255], v[68:71], v[20:23]
    v_mfma_f32_16x16x32_bf16 v[16:19], a[248:251], v[68:71], v[16:19]
    ds_read_b128 v[44:47], v2 offset:17408
    v_mfma_f32_16x16x32_bf16 v[16:19], a[232:235], v[64:67], v[16:19]
    v_mfma_f32_16x16x32_bf16 v[12:15], a[228:231], v[64:67], v[12:15]
    v_mfma_f32_16x16x32_bf16 v[12:15], a[244:247], v[68:71], v[12:15]
    v_mfma_f32_16x16x32_bf16 v[8:11], a[240:243], v[68:71], v[8:11]
    v_mfma_f32_16x16x32_bf16 v[8:11], a[224:227], v[64:67], v[8:11]
    s_waitcnt lgkmcnt(0)
    v_mfma_f32_16x16x32_bf16 v[8:11], v[128:131], v[40:43], v[8:11]
    ds_read_b128 v[48:51], v2 offset:18432
    v_mfma_f32_16x16x32_bf16 v[8:11], v[144:147], v[44:47], v[8:11]
    v_mfma_f32_16x16x32_bf16 v[12:15], v[148:151], v[44:47], v[12:15]
    ds_read_b128 v[52:55], v2 offset:19456
    v_mfma_f32_16x16x32_bf16 v[12:15], v[132:135], v[40:43], v[12:15]
    v_mfma_f32_16x16x32_bf16 v[16:19], v[136:139], v[40:43], v[16:19]
    v_mfma_f32_16x16x32_bf16 v[16:19], v[152:155], v[44:47], v[16:19]
    v_mfma_f32_16x16x32_bf16 v[20:23], v[156:159], v[44:47], v[20:23]
    v_mfma_f32_16x16x32_bf16 v[20:23], v[140:143], v[40:43], v[20:23]
    s_waitcnt lgkmcnt(0)
    v_mfma_f32_16x16x32_bf16 v[20:23], v[172:175], v[48:51], v[20:23]
    ds_read_b128 v[56:59], v2 offset:20480
    v_mfma_f32_16x16x32_bf16 v[20:23], v[188:191], v[52:55], v[20:23]
    v_mfma_f32_16x16x32_bf16 v[16:19], v[184:187], v[52:55], v[16:19]
    ds_read_b128 v[60:63], v2 offset:21504
    v_mfma_f32_16x16x32_bf16 v[16:19], v[168:171], v[48:51], v[16:19]
    v_mfma_f32_16x16x32_bf16 v[12:15], v[164:167], v[48:51], v[12:15]
    v_mfma_f32_16x16x32_bf16 v[12:15], v[180:183], v[52:55], v[12:15]
    v_mfma_f32_16x16x32_bf16 v[8:11], v[176:179], v[52:55], v[8:11]
    buffer_load_dword v5, v4, s[4:7], s16 offen sc1
    v_mfma_f32_16x16x32_bf16 v[8:11], v[160:163], v[48:51], v[8:11]
    s_waitcnt lgkmcnt(0)
    v_mfma_f32_16x16x32_bf16 v[8:11], v[192:195], v[56:59], v[8:11]
    ds_read_b128 v[64:67], v2 offset:22528
    v_mfma_f32_16x16x32_bf16 v[8:11], v[208:211], v[60:63], v[8:11]
    v_mfma_f32_16x16x32_bf16 v[12:15], v[212:215], v[60:63], v[12:15]
    ds_read_b128 v[68:71], v2 offset:23552
    v_mfma_f32_16x16x32_bf16 v[12:15], v[196:199], v[56:59], v[12:15]
    v_mfma_f32_16x16x32_bf16 v[16:19], v[200:203], v[56:59], v[16:19]
    s_waitcnt vmcnt(5)
    s_barrier
    v_mfma_f32_16x16x32_bf16 v[16:19], v[216:219], v[60:63], v[16:19]
    v_mfma_f32_16x16x32_bf16 v[20:23], v[220:223], v[60:63], v[20:23]
    v_mfma_f32_16x16x32_bf16 v[20:23], v[204:207], v[56:59], v[20:23]
    s_waitcnt lgkmcnt(0)
    v_mfma_f32_16x16x32_bf16 v[20:23], v[236:239], v[64:67], v[20:23]
    ds_read_b128 v[40:43], v3 offset:0
    v_mfma_f32_16x16x32_bf16 v[20:23], v[252:255], v[68:71], v[20:23]
    v_mfma_f32_16x16x32_bf16 v[16:19], v[248:251], v[68:71], v[16:19]
    ds_read_b128 v[44:47], v3 offset:1024
    v_mfma_f32_16x16x32_bf16 v[16:19], v[232:235], v[64:67], v[16:19]
    v_mfma_f32_16x16x32_bf16 v[12:15], v[228:231], v[64:67], v[12:15]
    v_mfma_f32_16x16x32_bf16 v[12:15], v[244:247], v[68:71], v[12:15]
    v_mfma_f32_16x16x32_bf16 v[8:11], v[240:243], v[68:71], v[8:11]
    v_mfma_f32_16x16x32_bf16 v[8:11], v[224:227], v[64:67], v[8:11]
Lffb_body10:
    s_waitcnt lgkmcnt(0)
    v_mfma_f32_16x16x32_bf16 v[24:27], a[0:3], v[40:43], 0
    ds_read_b128 v[48:51], v3 offset:2048
    s_add_u32 m0, s34, 0
    v_mfma_f32_16x16x32_bf16 v[24:27], a[16:19], v[44:47], v[24:27]
    s_add_u32 s31, s31, 1
    v_mov_b32 v6, s31
    s_add_u32 s35, s35, 36864
    v_mfma_f32_16x16x32_bf16 v[28:31], a[20:23], v[44:47], 0
    ds_read_b128 v[52:55], v3 offset:3072
    v_cvt_pk_bf16_f32 v72, v8, v9
    v_mfma_f32_16x16x32_bf16 v[28:31], a[4:7], v[40:43], v[28:31]
    s_cmp_eq_u32 s35, 147456
    s_cselect_b32 s35, 0, s35
    v_cvt_pk_bf16_f32 v73, v10, v11
    v_mfma_f32_16x16x32_bf16 v[32:35], a[8:11], v[40:43], 0
    v_cvt_pk_bf16_f32 v74, v12, v13
    v_cvt_pk_bf16_f32 v75, v14, v15
    v_mfma_f32_16x16x32_bf16 v[32:35], a[24:27], v[44:47], v[32:35]
    buffer_store_dwordx4 v[72:75], v1, s[12:15], s36 offen offset:0 sc1
    v_cvt_pk_bf16_f32 v76, v16, v17
    v_mfma_f32_16x16x32_bf16 v[36:39], a[28:31], v[44:47], 0
    v_cvt_pk_bf16_f32 v77, v18, v19
    v_cvt_pk_bf16_f32 v78, v20, v21
    v_mfma_f32_16x16x32_bf16 v[36:39], a[12:15], v[40:43], v[36:39]
    s_waitcnt lgkmcnt(0)
    v_cvt_pk_bf16_f32 v79, v22, v23
    v_add_u32 v2, s35, v1
    v_mfma_f32_16x16x32_bf16 v[36:39], a[44:47], v[48:51], v[36:39]
    ds_read_b128 v[56:59], v3 offset:4096
    v_mfma_f32_16x16x32_bf16 v[36:39], a[60:63], v[52:55], v[36:39]
    buffer_store_dwordx4 v[76:79], v1, s[12:15], s36 offen offset:1024 sc1
    s_add_u32 s36, s36, 131072
    v_mfma_f32_16x16x32_bf16 v[32:35], a[56:59], v[52:55], v[32:35]
    ds_read_b128 v[60:63], v3 offset:5120
    v_mfma_f32_16x16x32_bf16 v[32:35], a[40:43], v[48:51], v[32:35]
    v_mfma_f32_16x16x32_bf16 v[28:31], a[36:39], v[48:51], v[28:31]
    v_mfma_f32_16x16x32_bf16 v[28:31], a[52:55], v[52:55], v[28:31]
    v_mfma_f32_16x16x32_bf16 v[24:27], a[48:51], v[52:55], v[24:27]
    v_mfma_f32_16x16x32_bf16 v[24:27], a[32:35], v[48:51], v[24:27]
    s_waitcnt lgkmcnt(0)
    v_mfma_f32_16x16x32_bf16 v[24:27], a[64:67], v[56:59], v[24:27]
    ds_read_b128 v[64:67], v3 offset:6144
    v_mfma_f32_16x16x32_bf16 v[24:27], a[80:83], v[60:63], v[24:27]
    v_mfma_f32_16x16x32_bf16 v[28:31], a[84:87], v[60:63], v[28:31]
    ds_read_b128 v[68:71], v3 offset:7168
    v_mfma_f32_16x16x32_bf16 v[28:31], a[68:71], v[56:59], v[28:31]
    v_mfma_f32_16x16x32_bf16 v[32:35], a[72:75], v[56:59], v[32:35]
    v_mfma_f32_16x16x32_bf16 v[32:35], a[88:91], v[60:63], v[32:35]
    v_mfma_f32_16x16x32_bf16 v[36:39], a[92:95], v[60:63], v[36:39]
    v_mfma_f32_16x16x32_bf16 v[36:39], a[76:79], v[56:59], v[36:39]
    s_waitcnt lgkmcnt(0)
    v_mfma_f32_16x16x32_bf16 v[36:39], a[108:111], v[64:67], v[36:39]
    ds_read_b128 v[40:43], v3 offset:8192
    s_waitcnt vmcnt(2)
    v_mfma_f32_16x16x32_bf16 v[36:39], a[124:127], v[68:71], v[36:39]
    v_cmp_gt_i32 vcc, s32, v5
    v_mfma_f32_16x16x32_bf16 v[32:35], a[120:123], v[68:71], v[32:35]
    ds_read_b128 v[44:47], v3 offset:9216
    v_mfma_f32_16x16x32_bf16 v[32:35], a[104:107], v[64:67], v[32:35]
    s_and_b64 vcc, vcc, s[18:19]
    s_cbranch_scc1 Lffb_v11
    v_mfma_f32_16x16x32_bf16 v[28:31], a[100:103], v[64:67], v[28:31]
    buffer_load_dwordx4 v1, s[8:11], s33 offen offset:0 sc1 lds
    v_mfma_f32_16x16x32_bf16 v[28:31], a[116:119], v[68:71], v[28:31]
    v_mfma_f32_16x16x32_bf16 v[24:27], a[112:115], v[68:71], v[24:27]
    v_mfma_f32_16x16x32_bf16 v[24:27], a[96:99], v[64:67], v[24:27]
    s_waitcnt lgkmcnt(0)
    v_mfma_f32_16x16x32_bf16 v[24:27], a[128:131], v[40:43], v[24:27]
    ds_read_b128 v[48:51], v3 offset:10240
    v_mfma_f32_16x16x32_bf16 v[24:27], a[144:147], v[44:47], v[24:27]
    buffer_load_dwordx4 v1, s[8:11], s33 offen offset:1024 sc1 lds
    v_mfma_f32_16x16x32_bf16 v[28:31], a[148:151], v[44:47], v[28:31]
    ds_read_b128 v[52:55], v3 offset:11264
    v_mfma_f32_16x16x32_bf16 v[28:31], a[132:135], v[40:43], v[28:31]
    v_mfma_f32_16x16x32_bf16 v[32:35], a[136:139], v[40:43], v[32:35]
    s_barrier
    v_mfma_f32_16x16x32_bf16 v[32:35], a[152:155], v[44:47], v[32:35]
    buffer_load_dwordx4 v1, s[8:11], s33 offen offset:2048 sc1 lds
    v_mfma_f32_16x16x32_bf16 v[36:39], a[156:159], v[44:47], v[36:39]
    s_add_u32 s16, s16, 8192
    s_add_u32 m0, s34, s3
    s_add_u32 s37, s33, s3
    v_mfma_f32_16x16x32_bf16 v[36:39], a[140:143], v[40:43], v[36:39]
    s_waitcnt lgkmcnt(0)
    v_mfma_f32_16x16x32_bf16 v[36:39], a[172:175], v[48:51], v[36:39]
    ds_read_b128 v[56:59], v3 offset:12288
    v_mfma_f32_16x16x32_bf16 v[36:39], a[188:191], v[52:55], v[36:39]
    buffer_load_dwordx4 v1, s[8:11], s37 offen offset:0 sc1 lds
    v_mfma_f32_16x16x32_bf16 v[32:35], a[184:187], v[52:55], v[32:35]
    ds_read_b128 v[60:63], v3 offset:13312
    v_mfma_f32_16x16x32_bf16 v[32:35], a[168:171], v[48:51], v[32:35]
    v_mfma_f32_16x16x32_bf16 v[28:31], a[164:167], v[48:51], v[28:31]
    v_mfma_f32_16x16x32_bf16 v[28:31], a[180:183], v[52:55], v[28:31]
    buffer_load_dwordx4 v1, s[8:11], s37 offen offset:1024 sc1 lds
    v_mfma_f32_16x16x32_bf16 v[24:27], a[176:179], v[52:55], v[24:27]
    v_mfma_f32_16x16x32_bf16 v[24:27], a[160:163], v[48:51], v[24:27]
    s_waitcnt lgkmcnt(0)
    v_mfma_f32_16x16x32_bf16 v[24:27], a[192:195], v[56:59], v[24:27]
    ds_read_b128 v[64:67], v3 offset:14336
    v_mfma_f32_16x16x32_bf16 v[24:27], a[208:211], v[60:63], v[24:27]
    buffer_load_dwordx4 v1, s[8:11], s37 offen offset:2048 sc1 lds
    v_mfma_f32_16x16x32_bf16 v[28:31], a[212:215], v[60:63], v[28:31]
    ds_read_b128 v[68:71], v3 offset:15360
    s_add_u32 s32, s32, 1
    v_mfma_f32_16x16x32_bf16 v[28:31], a[196:199], v[56:59], v[28:31]
    s_add_u32 s33, s33, 116736
    s_add_u32 s34, s34, 36864
    s_waitcnt vmcnt(6)
    v_mfma_f32_16x16x32_bf16 v[32:35], a[200:203], v[56:59], v[32:35]
    s_cmp_ge_u32 s34, 147456
    s_cselect_b32 s38, 147456, 0
    s_sub_u32 s34, s34, s38
    v_mfma_f32_16x16x32_bf16 v[32:35], a[216:219], v[60:63], v[32:35]
    buffer_store_dword v6, v80, s[12:15], s17 offen sc1
    s_mov_b32 s14, s6
    v_mfma_f32_16x16x32_bf16 v[36:39], a[220:223], v[60:63], v[36:39]
    s_add_u32 s17, s17, 8192
    v_mfma_f32_16x16x32_bf16 v[36:39], a[204:207], v[56:59], v[36:39]
    s_waitcnt lgkmcnt(0)
    v_mfma_f32_16x16x32_bf16 v[36:39], a[236:239], v[64:67], v[36:39]
    ds_read_b128 v[40:43], v3 offset:16384
    v_mfma_f32_16x16x32_bf16 v[36:39], a[252:255], v[68:71], v[36:39]
    v_mfma_f32_16x16x32_bf16 v[32:35], a[248:251], v[68:71], v[32:35]
    ds_read_b128 v[44:47], v3 offset:17408
    v_mfma_f32_16x16x32_bf16 v[32:35], a[232:235], v[64:67], v[32:35]
    v_mfma_f32_16x16x32_bf16 v[28:31], a[228:231], v[64:67], v[28:31]
    v_mfma_f32_16x16x32_bf16 v[28:31], a[244:247], v[68:71], v[28:31]
    v_mfma_f32_16x16x32_bf16 v[24:27], a[240:243], v[68:71], v[24:27]
    v_mfma_f32_16x16x32_bf16 v[24:27], a[224:227], v[64:67], v[24:27]
    s_waitcnt lgkmcnt(0)
    v_mfma_f32_16x16x32_bf16 v[24:27], v[128:131], v[40:43], v[24:27]
    ds_read_b128 v[48:51], v3 offset:18432
    v_mfma_f32_16x16x32_bf16 v[24:27], v[144:147], v[44:47], v[24:27]
    v_mfma_f32_16x16x32_bf16 v[28:31], v[148:151], v[44:47], v[28:31]
    ds_read_b128 v[52:55], v3 offset:19456
    v_mfma_f32_16x16x32_bf16 v[28:31], v[132:135], v[40:43], v[28:31]
    v_mfma_f32_16x16x32_bf16 v[32:35], v[136:139], v[40:43], v[32:35]
    v_mfma_f32_16x16x32_bf16 v[32:35], v[152:155], v[44:47], v[32:35]
    v_mfma_f32_16x16x32_bf16 v[36:39], v[156:159], v[44:47], v[36:39]
    v_mfma_f32_16x16x32_bf16 v[36:39], v[140:143], v[40:43], v[36:39]
    s_waitcnt lgkmcnt(0)
    v_mfma_f32_16x16x32_bf16 v[36:39], v[172:175], v[48:51], v[36:39]
    ds_read_b128 v[56:59], v3 offset:20480
    v_mfma_f32_16x16x32_bf16 v[36:39], v[188:191], v[52:55], v[36:39]
    v_mfma_f32_16x16x32_bf16 v[32:35], v[184:187], v[52:55], v[32:35]
    ds_read_b128 v[60:63], v3 offset:21504
    v_mfma_f32_16x16x32_bf16 v[32:35], v[168:171], v[48:51], v[32:35]
    v_mfma_f32_16x16x32_bf16 v[28:31], v[164:167], v[48:51], v[28:31]
    v_mfma_f32_16x16x32_bf16 v[28:31], v[180:183], v[52:55], v[28:31]
    v_mfma_f32_16x16x32_bf16 v[24:27], v[176:179], v[52:55], v[24:27]
    buffer_load_dword v5, v4, s[4:7], s16 offen sc1
    v_mfma_f32_16x16x32_bf16 v[24:27], v[160:163], v[48:51], v[24:27]
    s_waitcnt lgkmcnt(0)
    v_mfma_f32_16x16x32_bf16 v[24:27], v[192:195], v[56:59], v[24:27]
    ds_read_b128 v[64:67], v3 offset:22528
    v_mfma_f32_16x16x32_bf16 v[24:27], v[208:211], v[60:63], v[24:27]
    v_mfma_f32_16x16x32_bf16 v[28:31], v[212:215], v[60:63], v[28:31]
    ds_read_b128 v[68:71], v3 offset:23552
    v_mfma_f32_16x16x32_bf16 v[28:31], v[196:199], v[56:59], v[28:31]
    v_mfma_f32_16x16x32_bf16 v[32:35], v[200:203], v[56:59], v[32:35]
    s_waitcnt vmcnt(5)
    s_barrier
    v_mfma_f32_16x16x32_bf16 v[32:35], v[216:219], v[60:63], v[32:35]
    v_mfma_f32_16x16x32_bf16 v[36:39], v[220:223], v[60:63], v[36:39]
    v_mfma_f32_16x16x32_bf16 v[36:39], v[204:207], v[56:59], v[36:39]
    s_waitcnt lgkmcnt(0)
    v_mfma_f32_16x16x32_bf16 v[36:39], v[236:239], v[64:67], v[36:39]
    ds_read_b128 v[40:43], v2 offset:0
    v_mfma_f32_16x16x32_bf16 v[36:39], v[252:255], v[68:71], v[36:39]
    v_mfma_f32_16x16x32_bf16 v[32:35], v[248:251], v[68:71], v[32:35]
    ds_read_b128 v[44:47], v2 offset:1024
    v_mfma_f32_16x16x32_bf16 v[32:35], v[232:235], v[64:67], v[32:35]
    v_mfma_f32_16x16x32_bf16 v[28:31], v[228:231], v[64:67], v[28:31]
    v_mfma_f32_16x16x32_bf16 v[28:31], v[244:247], v[68:71], v[28:31]
    v_mfma_f32_16x16x32_bf16 v[24:27], v[240:243], v[68:71], v[24:27]
    v_mfma_f32_16x16x32_bf16 v[24:27], v[224:227], v[64:67], v[24:27]
    s_cmp_lt_i32 s31, 63
    s_cbranch_scc1 Lffb_body00
    s_branch L_exit
    .p2align 6
Lffb_body01:
    s_waitcnt lgkmcnt(0)
    v_mfma_f32_16x16x32_bf16 v[8:11], a[0:3], v[40:43], 0
    ds_read_b128 v[48:51], v2 offset:2048
    s_add_u32 m0, s34, 0
    v_mfma_f32_16x16x32_bf16 v[8:11], a[16:19], v[44:47], v[8:11]
    s_add_u32 s31, s31, 1
    v_mov_b32 v6, s31
    s_add_u32 s35, s35, 36864
    v_mfma_f32_16x16x32_bf16 v[12:15], a[20:23], v[44:47], 0
    ds_read_b128 v[52:55], v2 offset:3072
    v_cvt_pk_bf16_f32 v72, v24, v25
    v_mfma_f32_16x16x32_bf16 v[12:15], a[4:7], v[40:43], v[12:15]
    s_cmp_eq_u32 s35, 147456
    s_cselect_b32 s35, 0, s35
    v_cvt_pk_bf16_f32 v73, v26, v27
    v_mfma_f32_16x16x32_bf16 v[16:19], a[8:11], v[40:43], 0
    v_cvt_pk_bf16_f32 v74, v28, v29
    v_cvt_pk_bf16_f32 v75, v30, v31
    v_mfma_f32_16x16x32_bf16 v[16:19], a[24:27], v[44:47], v[16:19]
    buffer_store_dwordx4 v[72:75], v1, s[12:15], s36 offen offset:0 sc1
    v_cvt_pk_bf16_f32 v76, v32, v33
    v_mfma_f32_16x16x32_bf16 v[20:23], a[28:31], v[44:47], 0
    v_cvt_pk_bf16_f32 v77, v34, v35
    v_cvt_pk_bf16_f32 v78, v36, v37
    v_mfma_f32_16x16x32_bf16 v[20:23], a[12:15], v[40:43], v[20:23]
    s_waitcnt lgkmcnt(0)
    v_cvt_pk_bf16_f32 v79, v38, v39
    v_add_u32 v3, s35, v1
    v_mfma_f32_16x16x32_bf16 v[20:23], a[44:47], v[48:51], v[20:23]
    ds_read_b128 v[56:59], v2 offset:4096
    v_mfma_f32_16x16x32_bf16 v[20:23], a[60:63], v[52:55], v[20:23]
    buffer_store_dwordx4 v[76:79], v1, s[12:15], s36 offen offset:1024 sc1
    s_add_u32 s36, s36, 131072
    v_mfma_f32_16x16x32_bf16 v[16:19], a[56:59], v[52:55], v[16:19]
    ds_read_b128 v[60:63], v2 offset:5120
    v_mfma_f32_16x16x32_bf16 v[16:19], a[40:43], v[48:51], v[16:19]
    v_mfma_f32_16x16x32_bf16 v[12:15], a[36:39], v[48:51], v[12:15]
    v_mfma_f32_16x16x32_bf16 v[12:15], a[52:55], v[52:55], v[12:15]
    v_mfma_f32_16x16x32_bf16 v[8:11], a[48:51], v[52:55], v[8:11]
    v_mfma_f32_16x16x32_bf16 v[8:11], a[32:35], v[48:51], v[8:11]
    s_waitcnt lgkmcnt(0)
    v_mfma_f32_16x16x32_bf16 v[8:11], a[64:67], v[56:59], v[8:11]
    ds_read_b128 v[64:67], v2 offset:6144
    v_mfma_f32_16x16x32_bf16 v[8:11], a[80:83], v[60:63], v[8:11]
    v_mfma_f32_16x16x32_bf16 v[12:15], a[84:87], v[60:63], v[12:15]
    ds_read_b128 v[68:71], v2 offset:7168
    v_mfma_f32_16x16x32_bf16 v[12:15], a[68:71], v[56:59], v[12:15]
    v_mfma_f32_16x16x32_bf16 v[16:19], a[72:75], v[56:59], v[16:19]
    v_mfma_f32_16x16x32_bf16 v[16:19], a[88:91], v[60:63], v[16:19]
    v_mfma_f32_16x16x32_bf16 v[20:23], a[92:95], v[60:63], v[20:23]
    v_mfma_f32_16x16x32_bf16 v[20:23], a[76:79], v[56:59], v[20:23]
    s_waitcnt lgkmcnt(0)
    v_mfma_f32_16x16x32_bf16 v[20:23], a[108:111], v[64:67], v[20:23]
    ds_read_b128 v[40:43], v2 offset:8192
    s_waitcnt vmcnt(2)
    v_mfma_f32_16x16x32_bf16 v[20:23], a[124:127], v[68:71], v[20:23]
    v_cmp_gt_i32 vcc, s32, v5
    v_mfma_f32_16x16x32_bf16 v[16:19], a[120:123], v[68:71], v[16:19]
    ds_read_b128 v[44:47], v2 offset:9216
    v_mfma_f32_16x16x32_bf16 v[16:19], a[104:107], v[64:67], v[16:19]
    s_and_b64 vcc, vcc, s[18:19]
    s_cbranch_scc1 Lffb_v01
    v_mfma_f32_16x16x32_bf16 v[12:15], a[100:103], v[64:67], v[12:15]
    buffer_load_dwordx4 v1, s[8:11], s33 offen offset:0 sc1 lds
    v_mfma_f32_16x16x32_bf16 v[12:15], a[116:119], v[68:71], v[12:15]
    v_mfma_f32_16x16x32_bf16 v[8:11], a[112:115], v[68:71], v[8:11]
    v_mfma_f32_16x16x32_bf16 v[8:11], a[96:99], v[64:67], v[8:11]
    s_waitcnt lgkmcnt(0)
    v_mfma_f32_16x16x32_bf16 v[8:11], a[128:131], v[40:43], v[8:11]
    ds_read_b128 v[48:51], v2 offset:10240
    v_mfma_f32_16x16x32_bf16 v[8:11], a[144:147], v[44:47], v[8:11]
    buffer_load_dwordx4 v1, s[8:11], s33 offen offset:1024 sc1 lds
    v_mfma_f32_16x16x32_bf16 v[12:15], a[148:151], v[44:47], v[12:15]
    ds_read_b128 v[52:55], v2 offset:11264
    v_mfma_f32_16x16x32_bf16 v[12:15], a[132:135], v[40:43], v[12:15]
    v_mfma_f32_16x16x32_bf16 v[16:19], a[136:139], v[40:43], v[16:19]
    v_mfma_f32_16x16x32_bf16 v[16:19], a[152:155], v[44:47], v[16:19]
    s_barrier
    v_mfma_f32_16x16x32_bf16 v[20:23], a[156:159], v[44:47], v[20:23]
    buffer_load_dwordx4 v1, s[8:11], s33 offen offset:2048 sc1 lds
    v_mfma_f32_16x16x32_bf16 v[20:23], a[140:143], v[40:43], v[20:23]
    s_waitcnt lgkmcnt(0)
    s_add_u32 s16, s16, 8192
    s_add_u32 m0, s34, s3
    v_mfma_f32_16x16x32_bf16 v[20:23], a[172:175], v[48:51], v[20:23]
    ds_read_b128 v[56:59], v2 offset:12288
    s_add_u32 s37, s33, s3
    v_mfma_f32_16x16x32_bf16 v[20:23], a[188:191], v[52:55], v[20:23]
    v_mfma_f32_16x16x32_bf16 v[16:19], a[184:187], v[52:55], v[16:19]
    ds_read_b128 v[60:63], v2 offset:13312
    v_mfma_f32_16x16x32_bf16 v[16:19], a[168:171], v[48:51], v[16:19]
    buffer_load_dwordx4 v1, s[8:11], s37 offen offset:0 sc1 lds
    v_mfma_f32_16x16x32_bf16 v[12:15], a[164:167], v[48:51], v[12:15]
    v_mfma_f32_16x16x32_bf16 v[12:15], a[180:183], v[52:55], v[12:15]
    v_mfma_f32_16x16x32_bf16 v[8:11], a[176:179], v[52:55], v[8:11]
    v_mfma_f32_16x16x32_bf16 v[8:11], a[160:163], v[48:51], v[8:11]
    s_waitcnt lgkmcnt(0)
    buffer_load_dwordx4 v1, s[8:11], s37 offen offset:1024 sc1 lds
    v_mfma_f32_16x16x32_bf16 v[8:11], a[192:195], v[56:59], v[8:11]
    ds_read_b128 v[64:67], v2 offset:14336
    v_mfma_f32_16x16x32_bf16 v[8:11], a[208:211], v[60:63], v[8:11]
    v_mfma_f32_16x16x32_bf16 v[12:15], a[212:215], v[60:63], v[12:15]
    ds_read_b128 v[68:71], v2 offset:15360
    v_mfma_f32_16x16x32_bf16 v[12:15], a[196:199], v[56:59], v[12:15]
    buffer_load_dwordx4 v1, s[8:11], s37 offen offset:2048 sc1 lds
    v_mfma_f32_16x16x32_bf16 v[16:19], a[200:203], v[56:59], v[16:19]
    s_add_u32 s32, s32, 1
    s_add_u32 s33, s33, 116736
    s_add_u32 s34, s34, 36864
    v_mfma_f32_16x16x32_bf16 v[16:19], a[216:219], v[60:63], v[16:19]
    s_cmp_ge_u32 s34, 147456
    s_cselect_b32 s38, 147456, 0
    s_sub_u32 s34, s34, s38
    v_mfma_f32_16x16x32_bf16 v[20:23], a[220:223], v[60:63], v[20:23]
    s_waitcnt vmcnt(6)
    buffer_store_dword v6, v80, s[12:15], s17 offen sc1
    v_mfma_f32_16x16x32_bf16 v[20:23], a[204:207], v[56:59], v[20:23]
    s_waitcnt lgkmcnt(0)
    s_mov_b32 s14, s6
    s_add_u32 s17, s17, 8192
    v_mfma_f32_16x16x32_bf16 v[20:23], a[236:239], v[64:67], v[20:23]
    ds_read_b128 v[40:43], v2 offset:16384
    v_mfma_f32_16x16x32_bf16 v[20:23], a[252:255], v[68:71], v[20:23]
    v_mfma_f32_16x16x32_bf16 v[16:19], a[248:251], v[68:71], v[16:19]
    ds_read_b128 v[44:47], v2 offset:17408
    v_mfma_f32_16x16x32_bf16 v[16:19], a[232:235], v[64:67], v[16:19]
    v_mfma_f32_16x16x32_bf16 v[12:15], a[228:231], v[64:67], v[12:15]
    v_mfma_f32_16x16x32_bf16 v[12:15], a[244:247], v[68:71], v[12:15]
    v_mfma_f32_16x16x32_bf16 v[8:11], a[240:243], v[68:71], v[8:11]
    v_mfma_f32_16x16x32_bf16 v[8:11], a[224:227], v[64:67], v[8:11]
    s_waitcnt lgkmcnt(0)
    v_mfma_f32_16x16x32_bf16 v[8:11], v[128:131], v[40:43], v[8:11]
    ds_read_b128 v[48:51], v2 offset:18432
    v_mfma_f32_16x16x32_bf16 v[8:11], v[144:147], v[44:47], v[8:11]
    v_mfma_f32_16x16x32_bf16 v[12:15], v[148:151], v[44:47], v[12:15]
    ds_read_b128 v[52:55], v2 offset:19456
    v_mfma_f32_16x16x32_bf16 v[12:15], v[132:135], v[40:43], v[12:15]
    v_mfma_f32_16x16x32_bf16 v[16:19], v[136:139], v[40:43], v[16:19]
    v_mfma_f32_16x16x32_bf16 v[16:19], v[152:155], v[44:47], v[16:19]
    v_mfma_f32_16x16x32_bf16 v[20:23], v[156:159], v[44:47], v[20:23]
    v_mfma_f32_16x16x32_bf16 v[20:23], v[140:143], v[40:43], v[20:23]
    s_waitcnt lgkmcnt(0)
    v_mfma_f32_16x16x32_bf16 v[20:23], v[172:175], v[48:51], v[20:23]
    ds_read_b128 v[56:59], v2 offset:20480
    v_mfma_f32_16x16x32_bf16 v[20:23], v[188:191], v[52:55], v[20:23]
    v_mfma_f32_16x16x32_bf16 v[16:19], v[184:187], v[52:55], v[16:19]
    ds_read_b128 v[60:63], v2 offset:21504
    v_mfma_f32_16x16x32_bf16 v[16:19], v[168:171], v[48:51], v[16:19]
    v_mfma_f32_16x16x32_bf16 v[12:15], v[164:167], v[48:51], v[12:15]
    v_mfma_f32_16x16x32_bf16 v[12:15], v[180:183], v[52:55], v[12:15]
    v_mfma_f32_16x16x32_bf16 v[8:11], v[176:179], v[52:55], v[8:11]
    buffer_load_dword v5, v4, s[4:7], s16 offen sc1
    v_mfma_f32_16x16x32_bf16 v[8:11], v[160:163], v[48:51], v[8:11]
    s_waitcnt lgkmcnt(0)
    v_mfma_f32_16x16x32_bf16 v[8:11], v[192:195], v[56:59], v[8:11]
    ds_read_b128 v[64:67], v2 offset:22528
    v_mfma_f32_16x16x32_bf16 v[8:11], v[208:211], v[60:63], v[8:11]
    v_mfma_f32_16x16x32_bf16 v[12:15], v[212:215], v[60:63], v[12:15]
    ds_read_b128 v[68:71], v2 offset:23552
    v_mfma_f32_16x16x32_bf16 v[12:15], v[196:199], v[56:59], v[12:15]
    v_mfma_f32_16x16x32_bf16 v[16:19], v[200:203], v[56:59], v[16:19]
    s_waitcnt vmcnt(5)
    v_mfma_f32_16x16x32_bf16 v[16:19], v[216:219], v[60:63], v[16:19]
    s_barrier
    v_mfma_f32_16x16x32_bf16 v[20:23], v[220:223], v[60:63], v[20:23]
    v_mfma_f32_16x16x32_bf16 v[20:23], v[204:207], v[56:59], v[20:23]
    s_waitcnt lgkmcnt(0)
    v_mfma_f32_16x16x32_bf16 v[20:23], v[236:239], v[64:67], v[20:23]
    ds_read_b128 v[40:43], v3 offset:0
    v_mfma_f32_16x16x32_bf16 v[20:23], v[252:255], v[68:71], v[20:23]
    v_mfma_f32_16x16x32_bf16 v[16:19], v[248:251], v[68:71], v[16:19]
    ds_read_b128 v[44:47], v3 offset:1024
    v_mfma_f32_16x16x32_bf16 v[16:19], v[232:235], v[64:67], v[16:19]
    v_mfma_f32_16x16x32_bf16 v[12:15], v[228:231], v[64:67], v[12:15]
    v_mfma_f32_16x16x32_bf16 v[12:15], v[244:247], v[68:71], v[12:15]
    v_mfma_f32_16x16x32_bf16 v[8:11], v[240:243], v[68:71], v[8:11]
    v_mfma_f32_16x16x32_bf16 v[8:11], v[224:227], v[64:67], v[8:11]
Lffb_body11:
    s_waitcnt lgkmcnt(0)
    v_mfma_f32_16x16x32_bf16 v[24:27], a[0:3], v[40:43], 0
    ds_read_b128 v[48:51], v3 offset:2048
    s_add_u32 m0, s34, 0
    v_mfma_f32_16x16x32_bf16 v[24:27], a[16:19], v[44:47], v[24:27]
    s_add_u32 s31, s31, 1
    v_mov_b32 v6, s31
    s_add_u32 s35, s35, 36864
    v_mfma_f32_16x16x32_bf16 v[28:31], a[20:23], v[44:47], 0
    ds_read_b128 v[52:55], v3 offset:3072
    v_cvt_pk_bf16_f32 v72, v8, v9
    v_mfma_f32_16x16x32_bf16 v[28:31], a[4:7], v[40:43], v[28:31]
    s_cmp_eq_u32 s35, 147456
    s_cselect_b32 s35, 0, s35
    v_cvt_pk_bf16_f32 v73, v10, v11
    v_mfma_f32_16x16x32_bf16 v[32:35], a[8:11], v[40:43], 0
    v_cvt_pk_bf16_f32 v74, v12, v13
    v_cvt_pk_bf16_f32 v75, v14, v15
    v_mfma_f32_16x16x32_bf16 v[32:35], a[24:27], v[44:47], v[32:35]
    buffer_store_dwordx4 v[72:75], v1, s[12:15], s36 offen offset:0 sc1
    v_cvt_pk_bf16_f32 v76, v16, v17
    v_mfma_f32_16x16x32_bf16 v[36:39], a[28:31], v[44:47], 0
    v_cvt_pk_bf16_f32 v77, v18, v19
    v_cvt_pk_bf16_f32 v78, v20, v21
    v_mfma_f32_16x16x32_bf16 v[36:39], a[12:15], v[40:43], v[36:39]
    s_waitcnt lgkmcnt(0)
    v_cvt_pk_bf16_f32 v79, v22, v23
    v_add_u32 v2, s35, v1
    v_mfma_f32_16x16x32_bf16 v[36:39], a[44:47], v[48:51], v[36:39]
    ds_read_b128 v[56:59], v3 offset:4096
    v_mfma_f32_16x16x32_bf16 v[36:39], a[60:63], v[52:55], v[36:39]
    buffer_store_dwordx4 v[76:79], v1, s[12:15], s36 offen offset:1024 sc1
    s_add_u32 s36, s36, 131072
    v_mfma_f32_16x16x32_bf16 v[32:35], a[56:59], v[52:55], v[32:35]
    ds_read_b128 v[60:63], v3 offset:5120
    v_mfma_f32_16x16x32_bf16 v[32:35], a[40:43], v[48:51], v[32:35]
    v_mfma_f32_16x16x32_bf16 v[28:31], a[36:39], v[48:51], v[28:31]
    v_mfma_f32_16x16x32_bf16 v[28:31], a[52:55], v[52:55], v[28:31]
    v_mfma_f32_16x16x32_bf16 v[24:27], a[48:51], v[52:55], v[24:27]
    v_mfma_f32_16x16x32_bf16 v[24:27], a[32:35], v[48:51], v[24:27]
    s_waitcnt lgkmcnt(0)
    v_mfma_f32_16x16x32_bf16 v[24:27], a[64:67], v[56:59], v[24:27]
    ds_read_b128 v[64:67], v3 offset:6144
    v_mfma_f32_16x16x32_bf16 v[24:27], a[80:83], v[60:63], v[24:27]
    v_mfma_f32_16x16x32_bf16 v[28:31], a[84:87], v[60:63], v[28:31]
    ds_read_b128 v[68:71], v3 offset:7168
    v_mfma_f32_16x16x32_bf16 v[28:31], a[68:71], v[56:59], v[28:31]
    v_mfma_f32_16x16x32_bf16 v[32:35], a[72:75], v[56:59], v[32:35]
    v_mfma_f32_16x16x32_bf16 v[32:35], a[88:91], v[60:63], v[32:35]
    v_mfma_f32_16x16x32_bf16 v[36:39], a[92:95], v[60:63], v[36:39]
    v_mfma_f32_16x16x32_bf16 v[36:39], a[76:79], v[56:59], v[36:39]
    s_waitcnt lgkmcnt(0)
    v_mfma_f32_16x16x32_bf16 v[36:39], a[108:111], v[64:67], v[36:39]
    ds_read_b128 v[40:43], v3 offset:8192
    s_waitcnt vmcnt(2)
    v_mfma_f32_16x16x32_bf16 v[36:39], a[124:127], v[68:71], v[36:39]
    v_cmp_gt_i32 vcc, s32, v5
    v_mfma_f32_16x16x32_bf16 v[32:35], a[120:123], v[68:71], v[32:35]
    ds_read_b128 v[44:47], v3 offset:9216
    v_mfma_f32_16x16x32_bf16 v[32:35], a[104:107], v[64:67], v[32:35]
    s_and_b64 vcc, vcc, s[18:19]
    s_cbranch_scc1 Lffb_v11
    v_mfma_f32_16x16x32_bf16 v[28:31], a[100:103], v[64:67], v[28:31]
    buffer_load_dwordx4 v1, s[8:11], s33 offen offset:0 sc1 lds
    v_mfma_f32_16x16x32_bf16 v[28:31], a[116:119], v[68:71], v[28:31]
    v_mfma_f32_16x16x32_bf16 v[24:27], a[112:115], v[68:71], v[24:27]
    v_mfma_f32_16x16x32_bf16 v[24:27], a[96:99], v[64:67], v[24:27]
    s_waitcnt lgkmcnt(0)
    v_mfma_f32_16x16x32_bf16 v[24:27], a[128:131], v[40:43], v[24:27]
    ds_read_b128 v[48:51], v3 offset:10240
    v_mfma_f32_16x16x32_bf16 v[24:27], a[144:147], v[44:47], v[24:27]
    buffer_load_dwordx4 v1, s[8:11], s33 offen offset:1024 sc1 lds
    v_mfma_f32_16x16x32_bf16 v[28:31], a[148:151], v[44:47], v[28:31]
    ds_read_b128 v[52:55], v3 offset:11264
    v_mfma_f32_16x16x32_bf16 v[28:31], a[132:135], v[40:43], v[28:31]
    v_mfma_f32_16x16x32_bf16 v[32:35], a[136:139], v[40:43], v[32:35]
    v_mfma_f32_16x16x32_bf16 v[32:35], a[152:155], v[44:47], v[32:35]
    s_barrier
    v_mfma_f32_16x16x32_bf16 v[36:39], a[156:159], v[44:47], v[36:39]
    buffer_load_dwordx4 v1, s[8:11], s33 offen offset:2048 sc1 lds
    v_mfma_f32_16x16x32_bf16 v[36:39], a[140:143], v[40:43], v[36:39]
    s_waitcnt lgkmcnt(0)
    s_add_u32 s16, s16, 8192
    s_add_u32 m0, s34, s3
    v_mfma_f32_16x16x32_bf16 v[36:39], a[172:175], v[48:51], v[36:39]
    ds_read_b128 v[56:59], v3 offset:12288
    s_add_u32 s37, s33, s3
    v_mfma_f32_16x16x32_bf16 v[36:39], a[188:191], v[52:55], v[36:39]
    v_mfma_f32_16x16x32_bf16 v[32:35], a[184:187], v[52:55], v[32:35]
    ds_read_b128 v[60:63], v3 offset:13312
    v_mfma_f32_16x16x32_bf16 v[32:35], a[168:171], v[48:51], v[32:35]
    buffer_load_dwordx4 v1, s[8:11], s37 offen offset:0 sc1 lds
    v_mfma_f32_16x16x32_bf16 v[28:31], a[164:167], v[48:51], v[28:31]
    v_mfma_f32_16x16x32_bf16 v[28:31], a[180:183], v[52:55], v[28:31]
    v_mfma_f32_16x16x32_bf16 v[24:27], a[176:179], v[52:55], v[24:27]
    v_mfma_f32_16x16x32_bf16 v[24:27], a[160:163], v[48:51], v[24:27]
    s_waitcnt lgkmcnt(0)
    buffer_load_dwordx4 v1, s[8:11], s37 offen offset:1024 sc1 lds
    v_mfma_f32_16x16x32_bf16 v[24:27], a[192:195], v[56:59], v[24:27]
    ds_read_b128 v[64:67], v3 offset:14336
    v_mfma_f32_16x16x32_bf16 v[24:27], a[208:211], v[60:63], v[24:27]
    v_mfma_f32_16x16x32_bf16 v[28:31], a[212:215], v[60:63], v[28:31]
    ds_read_b128 v[68:71], v3 offset:15360
    v_mfma_f32_16x16x32_bf16 v[28:31], a[196:199], v[56:59], v[28:31]
    buffer_load_dwordx4 v1, s[8:11], s37 offen offset:2048 sc1 lds
    v_mfma_f32_16x16x32_bf16 v[32:35], a[200:203], v[56:59], v[32:35]
    s_add_u32 s32, s32, 1
    s_add_u32 s33, s33, 116736
    s_add_u32 s34, s34, 36864
    v_mfma_f32_16x16x32_bf16 v[32:35], a[216:219], v[60:63], v[32:35]
    s_cmp_ge_u32 s34, 147456
    s_cselect_b32 s38, 147456, 0
    s_sub_u32 s34, s34, s38
    v_mfma_f32_16x16x32_bf16 v[36:39], a[220:223], v[60:63], v[36:39]
    s_waitcnt vmcnt(6)
    buffer_store_dword v6, v80, s[12:15], s17 offen sc1
    v_mfma_f32_16x16x32_bf16 v[36:39], a[204:207], v[56:59], v[36:39]
    s_waitcnt lgkmcnt(0)
    s_mov_b32 s14, s6
    s_add_u32 s17, s17, 8192
    v_mfma_f32_16x16x32_bf16 v[36:39], a[236:239], v[64:67], v[36:39]
    ds_read_b128 v[40:43], v3 offset:16384
    v_mfma_f32_16x16x32_bf16 v[36:39], a[252:255], v[68:71], v[36:39]
    v_mfma_f32_16x16x32_bf16 v[32:35], a[248:251], v[68:71], v[32:35]
    ds_read_b128 v[44:47], v3 offset:17408
    v_mfma_f32_16x16x32_bf16 v[32:35], a[232:235], v[64:67], v[32:35]
    v_mfma_f32_16x16x32_bf16 v[28:31], a[228:231], v[64:67], v[28:31]
    v_mfma_f32_16x16x32_bf16 v[28:31], a[244:247], v[68:71], v[28:31]
    v_mfma_f32_16x16x32_bf16 v[24:27], a[240:243], v[68:71], v[24:27]
    v_mfma_f32_16x16x32_bf16 v[24:27], a[224:227], v[64:67], v[24:27]
    s_waitcnt lgkmcnt(0)
    v_mfma_f32_16x16x32_bf16 v[24:27], v[128:131], v[40:43], v[24:27]
    ds_read_b128 v[48:51], v3 offset:18432
    v_mfma_f32_16x16x32_bf16 v[24:27], v[144:147], v[44:47], v[24:27]
    v_mfma_f32_16x16x32_bf16 v[28:31], v[148:151], v[44:47], v[28:31]
    ds_read_b128 v[52:55], v3 offset:19456
    v_mfma_f32_16x16x32_bf16 v[28:31], v[132:135], v[40:43], v[28:31]
    v_mfma_f32_16x16x32_bf16 v[32:35], v[136:139], v[40:43], v[32:35]
    v_mfma_f32_16x16x32_bf16 v[32:35], v[152:155], v[44:47], v[32:35]
    v_mfma_f32_16x16x32_bf16 v[36:39], v[156:159], v[44:47], v[36:39]
    v_mfma_f32_16x16x32_bf16 v[36:39], v[140:143], v[40:43], v[36:39]
    s_waitcnt lgkmcnt(0)
    v_mfma_f32_16x16x32_bf16 v[36:39], v[172:175], v[48:51], v[36:39]
    ds_read_b128 v[56:59], v3 offset:20480
    v_mfma_f32_16x16x32_bf16 v[36:39], v[188:191], v[52:55], v[36:39]
    v_mfma_f32_16x16x32_bf16 v[32:35], v[184:187], v[52:55], v[32:35]
    ds_read_b128 v[60:63], v3 offset:21504
    v_mfma_f32_16x16x32_bf16 v[32:35], v[168:171], v[48:51], v[32:35]
    v_mfma_f32_16x16x32_bf16 v[28:31], v[164:167], v[48:51], v[28:31]
    v_mfma_f32_16x16x32_bf16 v[28:31], v[180:183], v[52:55], v[28:31]
    v_mfma_f32_16x16x32_bf16 v[24:27], v[176:179], v[52:55], v[24:27]
    buffer_load_dword v5, v4, s[4:7], s16 offen sc1
    v_mfma_f32_16x16x32_bf16 v[24:27], v[160:163], v[48:51], v[24:27]
    s_waitcnt lgkmcnt(0)
    v_mfma_f32_16x16x32_bf16 v[24:27], v[192:195], v[56:59], v[24:27]
    ds_read_b128 v[64:67], v3 offset:22528
    v_mfma_f32_16x16x32_bf16 v[24:27], v[208:211], v[60:63], v[24:27]
    v_mfma_f32_16x16x32_bf16 v[28:31], v[212:215], v[60:63], v[28:31]
    ds_read_b128 v[68:71], v3 offset:23552
    v_mfma_f32_16x16x32_bf16 v[28:31], v[196:199], v[56:59], v[28:31]
    v_mfma_f32_16x16x32_bf16 v[32:35], v[200:203], v[56:59], v[32:35]
    s_waitcnt vmcnt(5)
    v_mfma_f32_16x16x32_bf16 v[32:35], v[216:219], v[60:63], v[32:35]
    s_barrier
    v_mfma_f32_16x16x32_bf16 v[36:39], v[220:223], v[60:63], v[36:39]
    v_mfma_f32_16x16x32_bf16 v[36:39], v[204:207], v[56:59], v[36:39]
    s_waitcnt lgkmcnt(0)
    v_mfma_f32_16x16x32_bf16 v[36:39], v[236:239], v[64:67], v[36:39]
    ds_read_b128 v[40:43], v2 offset:0
    v_mfma_f32_16x16x32_bf16 v[36:39], v[252:255], v[68:71], v[36:39]
    v_mfma_f32_16x16x32_bf16 v[32:35], v[248:251], v[68:71], v[32:35]
    ds_read_b128 v[44:47], v2 offset:1024
    v_mfma_f32_16x16x32_bf16 v[32:35], v[232:235], v[64:67], v[32:35]
    v_mfma_f32_16x16x32_bf16 v[28:31], v[228:231], v[64:67], v[28:31]
    v_mfma_f32_16x16x32_bf16 v[28:31], v[244:247], v[68:71], v[28:31]
    v_mfma_f32_16x16x32_bf16 v[24:27], v[240:243], v[68:71], v[24:27]
    v_mfma_f32_16x16x32_bf16 v[24:27], v[224:227], v[64:67], v[24:27]
    s_cmp_lt_i32 s31, 63
    s_cbranch_scc1 Lffb_body01
    s_branch L_exit
    .p2align 6
Lffb_body02:
    s_waitcnt lgkmcnt(0)
    v_mfma_f32_16x16x32_bf16 v[8:11], a[0:3], v[40:43], 0
    ds_read_b128 v[48:51], v2 offset:2048
    s_add_u32 m0, s34, 0
    v_mfma_f32_16x16x32_bf16 v[8:11], a[16:19], v[44:47], v[8:11]
    s_add_u32 s31, s31, 1
    v_mov_b32 v6, s31
    s_add_u32 s35, s35, 36864
    v_mfma_f32_16x16x32_bf16 v[12:15], a[20:23], v[44:47], 0
    ds_read_b128 v[52:55], v2 offset:3072
    v_cvt_pk_bf16_f32 v72, v24, v25
    v_mfma_f32_16x16x32_bf16 v[12:15], a[4:7], v[40:43], v[12:15]
    s_cmp_eq_u32 s35, 147456
    s_cselect_b32 s35, 0, s35
    v_cvt_pk_bf16_f32 v73, v26, v27
    v_mfma_f32_16x16x32_bf16 v[16:19], a[8:11], v[40:43], 0
    v_cvt_pk_bf16_f32 v74, v28, v29
    v_cvt_pk_bf16_f32 v75, v30, v31
    v_mfma_f32_16x16x32_bf16 v[16:19], a[24:27], v[44:47], v[16:19]
    buffer_store_dwordx4 v[72:75], v1, s[12:15], s36 offen offset:0 sc1
    v_cvt_pk_bf16_f32 v76, v32, v33
    v_mfma_f32_16x16x32_bf16 v[20:23], a[28:31], v[44:47], 0
    v_cvt_pk_bf16_f32 v77, v34, v35
    v_cvt_pk_bf16_f32 v78, v36, v37
    v_mfma_f32_16x16x32_bf16 v[20:23], a[12:15], v[40:43], v[20:23]
    s_waitcnt lgkmcnt(0)
    v_cvt_pk_bf16_f32 v79, v38, v39
    v_add_u32 v3, s35, v1
    v_mfma_f32_16x16x32_bf16 v[20:23], a[44:47], v[48:51], v[20:23]
    ds_read_b128 v[56:59], v2 offset:4096
    v_mfma_f32_16x16x32_bf16 v[20:23], a[60:63], v[52:55], v[20:23]
    buffer_store_dwordx4 v[76:79], v1, s[12:15], s36 offen offset:1024 sc1
    s_add_u32 s36, s36, 131072
    v_mfma_f32_16x16x32_bf16 v[16:19], a[56:59], v[52:55], v[16:19]
    ds_read_b128 v[60:63], v2 offset:5120
    v_mfma_f32_16x16x32_bf16 v[16:19], a[40:43], v[48:51], v[16:19]
    v_mfma_f32_16x16x32_bf16 v[12:15], a[36:39], v[48:51], v[12:15]
    v_mfma_f32_16x16x32_bf16 v[12:15], a[52:55], v[52:55], v[12:15]
    v_mfma_f32_16x16x32_bf16 v[8:11], a[48:51], v[52:55], v[8:11]
    v_mfma_f32_16x16x32_bf16 v[8:11], a[32:35], v[48:51], v[8:11]
    s_waitcnt lgkmcnt(0)
    v_mfma_f32_16x16x32_bf16 v[8:11], a[64:67], v[56:59], v[8:11]
    ds_read_b128 v[64:67], v2 offset:6144
    v_mfma_f32_16x16x32_bf16 v[8:11], a[80:83], v[60:63], v[8:11]
    v_mfma_f32_16x16x32_bf16 v[12:15], a[84:87], v[60:63], v[12:15]
    ds_read_b128 v[68:71], v2 offset:7168
    v_mfma_f32_16x16x32_bf16 v[12:15], a[68:71], v[56:59], v[12:15]
    v_mfma_f32_16x16x32_bf16 v[16:19], a[72:75], v[56:59], v[16:19]
    v_mfma_f32_16x16x32_bf16 v[16:19], a[88:91], v[60:63], v[16:19]
    v_mfma_f32_16x16x32_bf16 v[20:23], a[92:95], v[60:63], v[20:23]
    v_mfma_f32_16x16x32_bf16 v[20:23], a[76:79], v[56:59], v[20:23]
    s_waitcnt lgkmcnt(0)
    v_mfma_f32_16x16x32_bf16 v[20:23], a[108:111], v[64:67], v[20:23]
    ds_read_b128 v[40:43], v2 offset:8192
    s_waitcnt vmcnt(2)
    v_mfma_f32_16x16x32_bf16 v[20:23], a[124:127], v[68:71], v[20:23]
    v_cmp_gt_i32 vcc, s32, v5
    v_mfma_f32_16x16x32_bf16 v[16:19], a[120:123], v[68:71], v[16:19]
    ds_read_b128 v[44:47], v2 offset:9216
    v_mfma_f32_16x16x32_bf16 v[16:19], a[104:107], v[64:67], v[16:19]
    s_and_b64 vcc, vcc, s[18:19]
    s_cbranch_scc1 Lffb_v01
    v_mfma_f32_16x16x32_bf16 v[12:15], a[100:103], v[64:67], v[12:15]
    buffer_load_dwordx4 v1, s[8:11], s33 offen offset:0 sc1 lds
    v_mfma_f32_16x16x32_bf16 v[12:15], a[116:119], v[68:71], v[12:15]
    v_mfma_f32_16x16x32_bf16 v[8:11], a[112:115], v[68:71], v[8:11]
    v_mfma_f32_16x16x32_bf16 v[8:11], a[96:99], v[64:67], v[8:11]
    s_waitcnt lgkmcnt(0)
    v_mfma_f32_16x16x32_bf16 v[8:11], a[128:131], v[40:43], v[8:11]
    ds_read_b128 v[48:51], v2 offset:10240
    v_mfma_f32_16x16x32_bf16 v[8:11], a[144:147], v[44:47], v[8:11]
    buffer_load_dwordx4 v1, s[8:11], s33 offen offset:1024 sc1 lds
    v_mfma_f32_16x16x32_bf16 v[12:15], a[148:151], v[44:47], v[12:15]
    ds_read_b128 v[52:55], v2 offset:11264
    v_mfma_f32_16x16x32_bf16 v[12:15], a[132:135], v[40:43], v[12:15]
    v_mfma_f32_16x16x32_bf16 v[16:19], a[136:139], v[40:43], v[16:19]
    v_mfma_f32_16x16x32_bf16 v[16:19], a[152:155], v[44:47], v[16:19]
    buffer_load_dwordx4 v1, s[8:11], s33 offen offset:2048 sc1 lds
    v_mfma_f32_16x16x32_bf16 v[20:23], a[156:159], v[44:47], v[20:23]
    s_barrier
    v_mfma_f32_16x16x32_bf16 v[20:23], a[140:143], v[40:43], v[20:23]
    s_waitcnt lgkmcnt(0)
    s_add_u32 s16, s16, 8192
    s_add_u32 m0, s34, s3
    v_mfma_f32_16x16x32_bf16 v[20:23], a[172:175], v[48:51], v[20:23]
    ds_read_b128 v[56:59], v2 offset:12288
    s_add_u32 s37, s33, s3
    v_mfma_f32_16x16x32_bf16 v[20:23], a[188:191], v[52:55], v[20:23]
    buffer_load_dwordx4 v1, s[8:11], s37 offen offset:0 sc1 lds
    v_mfma_f32_16x16x32_bf16 v[16:19], a[184:187], v[52:55], v[16:19]
    ds_read_b128 v[60:63], v2 offset:13312
    v_mfma_f32_16x16x32_bf16 v[16:19], a[168:171], v[48:51], v[16:19]
    v_mfma_f32_16x16x32_bf16 v[12:15], a[164:167], v[48:51], v[12:15]
    v_mfma_f32_16x16x32_bf16 v[12:15], a[180:183], v[52:55], v[12:15]
    buffer_load_dwordx4 v1, s[8:11], s37 offen offset:1024 sc1 lds
    v_mfma_f32_16x16x32_bf16 v[8:11], a[176:179], v[52:55], v[8:11]
    v_mfma_f32_16x16x32_bf16 v[8:11], a[160:163], v[48:51], v[8:11]
    s_waitcnt lgkmcnt(0)
    v_mfma_f32_16x16x32_bf16 v[8:11], a[192:195], v[56:59], v[8:11]
    ds_read_b128 v[64:67], v2 offset:14336
    v_mfma_f32_16x16x32_bf16 v[8:11], a[208:211], v[60:63], v[8:11]
    buffer_load_dwordx4 v1, s[8:11], s37 offen offset:2048 sc1 lds
    v_mfma_f32_16x16x32_bf16 v[12:15], a[212:215], v[60:63], v[12:15]
    ds_read_b128 v[68:71], v2 offset:15360
    s_add_u32 s32, s32, 1
    v_mfma_f32_16x16x32_bf16 v[12:15], a[196:199], v[56:59], v[12:15]
    s_add_u32 s33, s33, 116736
    s_add_u32 s34, s34, 36864
    s_waitcnt vmcnt(6)
    v_mfma_f32_16x16x32_bf16 v[16:19], a[200:203], v[56:59], v[16:19]
    s_cmp_ge_u32 s34, 147456
    s_cselect_b32 s38, 147456, 0
    s_sub_u32 s34, s34, s38
    v_mfma_f32_16x16x32_bf16 v[16:19], a[216:219], v[60:63], v[16:19]
    buffer_store_dword v6, v80, s[12:15], s17 offen sc1
    s_mov_b32 s14, s6
    v_mfma_f32_16x16x32_bf16 v[20:23], a[220:223], v[60:63], v[20:23]
    s_add_u32 s17, s17, 8192
    v_mfma_f32_16x16x32_bf16 v[20:23], a[204:207], v[56:59], v[20:23]
    s_waitcnt lgkmcnt(0)
    v_mfma_f32_16x16x32_bf16 v[20:23], a[236:239], v[64:67], v[20:23]
    ds_read_b128 v[40:43], v2 offset:16384
    v_mfma_f32_16x16x32_bf16 v[20:23], a[252:255], v[68:71], v[20:23]
    v_mfma_f32_16x16x32_bf16 v[16:19], a[248:251], v[68:71], v[16:19]
    ds_read_b128 v[44:47], v2 offset:17408
    v_mfma_f32_16x16x32_bf16 v[16:19], a[232:235], v[64:67], v[16:19]
    v_mfma_f32_16x16x32_bf16 v[12:15], a[228:231], v[64:67], v[12:15]
    v_mfma_f32_16x16x32_bf16 v[12:15], a[244:247], v[68:71], v[12:15]
    v_mfma_f32_16x16x32_bf16 v[8:11], a[240:243], v[68:71], v[8:11]
    v_mfma_f32_16x16x32_bf16 v[8:11], a[224:227], v[64:67], v[8:11]
    s_waitcnt lgkmcnt(0)
    v_mfma_f32_16x16x32_bf16 v[8:11], v[128:131], v[40:43], v[8:11]
    ds_read_b128 v[48:51], v2 offset:18432
    v_mfma_f32_16x16x32_bf16 v[8:11], v[144:147], v[44:47], v[8:11]
    v_mfma_f32_16x16x32_bf16 v[12:15], v[148:151], v[44:47], v[12:15]
    ds_read_b128 v[52:55], v2 offset:19456
    v_mfma_f32_16x16x32_bf16 v[12:15], v[132:135], v[40:43], v[12:15]
    v_mfma_f32_16x16x32_bf16 v[16:19], v[136:139], v[40:43], v[16:19]
    v_mfma_f32_16x16x32_bf16 v[16:19], v[152:155], v[44:47], v[16:19]
    v_mfma_f32_16x16x32_bf16 v[20:23], v[156:159], v[44:47], v[20:23]
    v_mfma_f32_16x16x32_bf16 v[20:23], v[140:143], v[40:43], v[20:23]
    s_waitcnt lgkmcnt(0)
    v_mfma_f32_16x16x32_bf16 v[20:23], v[172:175], v[48:51], v[20:23]
    ds_read_b128 v[56:59], v2 offset:20480
    v_mfma_f32_16x16x32_bf16 v[20:23], v[188:191], v[52:55], v[20:23]
    v_mfma_f32_16x16x32_bf16 v[16:19], v[184:187], v[52:55], v[16:19]
    ds_read_b128 v[60:63], v2 offset:21504
    v_mfma_f32_16x16x32_bf16 v[16:19], v[168:171], v[48:51], v[16:19]
    v_mfma_f32_16x16x32_bf16 v[12:15], v[164:167], v[48:51], v[12:15]
    v_mfma_f32_16x16x32_bf16 v[12:15], v[180:183], v[52:55], v[12:15]
    v_mfma_f32_16x16x32_bf16 v[8:11], v[176:179], v[52:55], v[8:11]
    buffer_load_dword v5, v4, s[4:7], s16 offen sc1
    v_mfma_f32_16x16x32_bf16 v[8:11], v[160:163], v[48:51], v[8:11]
    s_waitcnt lgkmcnt(0)
    v_mfma_f32_16x16x32_bf16 v[8:11], v[192:195], v[56:59], v[8:11]
    ds_read_b128 v[64:67], v2 offset:22528
    v_mfma_f32_16x16x32_bf16 v[8:11], v[208:211], v[60:63], v[8:11]
    v_mfma_f32_16x16x32_bf16 v[12:15], v[212:215], v[60:63], v[12:15]
    ds_read_b128 v[68:71], v2 offset:23552
    v_mfma_f32_16x16x32_bf16 v[12:15], v[196:199], v[56:59], v[12:15]
    v_mfma_f32_16x16x32_bf16 v[16:19], v[200:203], v[56:59], v[16:19]
    s_waitcnt vmcnt(5)
    v_mfma_f32_16x16x32_bf16 v[16:19], v[216:219], v[60:63], v[16:19]
    v_mfma_f32_16x16x32_bf16 v[20:23], v[220:223], v[60:63], v[20:23]
    s_barrier
    v_mfma_f32_16x16x32_bf16 v[20:23], v[204:207], v[56:59], v[20:23]
    s_waitcnt lgkmcnt(0)
    v_mfma_f32_16x16x32_bf16 v[20:23], v[236:239], v[64:67], v[20:23]
    ds_read_b128 v[40:43], v3 offset:0
    v_mfma_f32_16x16x32_bf16 v[20:23], v[252:255], v[68:71], v[20:23]
    v_mfma_f32_16x16x32_bf16 v[16:19], v[248:251], v[68:71], v[16:19]
    ds_read_b128 v[44:47], v3 offset:1024
    v_mfma_f32_16x16x32_bf16 v[16:19], v[232:235], v[64:67], v[16:19]
    v_mfma_f32_16x16x32_bf16 v[12:15], v[228:231], v[64:67], v[12:15]
    v_mfma_f32_16x16x32_bf16 v[12:15], v[244:247], v[68:71], v[12:15]
    v_mfma_f32_16x16x32_bf16 v[8:11], v[240:243], v[68:71], v[8:11]
    v_mfma_f32_16x16x32_bf16 v[8:11], v[224:227], v[64:67], v[8:11]
Lffb_body12:
    s_waitcnt lgkmcnt(0)
    v_mfma_f32_16x16x32_bf16 v[24:27], a[0:3], v[40:43], 0
    ds_read_b128 v[48:51], v3 offset:2048
    s_add_u32 m0, s34, 0
    v_mfma_f32_16x16x32_bf16 v[24:27], a[16:19], v[44:47], v[24:27]
    s_add_u32 s31, s31, 1
    v_mov_b32 v6, s31
    s_add_u32 s35, s35, 36864
    v_mfma_f32_16x16x32_bf16 v[28:31], a[20:23], v[44:47], 0
    ds_read_b128 v[52:55], v3 offset:3072
    v_cvt_pk_bf16_f32 v72, v8, v9
    v_mfma_f32_16x16x32_bf16 v[28:31], a[4:7], v[40:43], v[28:31]
    s_cmp_eq_u32 s35, 147456
    s_cselect_b32 s35, 0, s35
    v_cvt_pk_bf16_f32 v73, v10, v11
    v_mfma_f32_16x16x32_bf16 v[32:35], a[8:11], v[40:43], 0
    v_cvt_pk_bf16_f32 v74, v12, v13
    v_cvt_pk_bf16_f32 v75, v14, v15
    v_mfma_f32_16x16x32_bf16 v[32:35], a[24:27], v[44:47], v[32:35]
    buffer_store_dwordx4 v[72:75], v1, s[12:15], s36 offen offset:0 sc1
    v_cvt_pk_bf16_f32 v76, v16, v17
    v_mfma_f32_16x16x32_bf16 v[36:39], a[28:31], v[44:47], 0
    v_cvt_pk_bf16_f32 v77, v18, v19
    v_cvt_pk_bf16_f32 v78, v20, v21
    v_mfma_f32_16x16x32_bf16 v[36:39], a[12:15], v[40:43], v[36:39]
    s_waitcnt lgkmcnt(0)
    v_cvt_pk_bf16_f32 v79, v22, v23
    v_add_u32 v2, s35, v1
    v_mfma_f32_16x16x32_bf16 v[36:39], a[44:47], v[48:51], v[36:39]
    ds_read_b128 v[56:59], v3 offset:4096
    v_mfma_f32_16x16x32_bf16 v[36:39], a[60:63], v[52:55], v[36:39]
    buffer_store_dwordx4 v[76:79], v1, s[12:15], s36 offen offset:1024 sc1
    s_add_u32 s36, s36, 131072
    v_mfma_f32_16x16x32_bf16 v[32:35], a[56:59], v[52:55], v[32:35]
    ds_read_b128 v[60:63], v3 offset:5120
    v_mfma_f32_16x16x32_bf16 v[32:35], a[40:43], v[48:51], v[32:35]
    v_mfma_f32_16x16x32_bf16 v[28:31], a[36:39], v[48:51], v[28:31]
    v_mfma_f32_16x16x32_bf16 v[28:31], a[52:55], v[52:55], v[28:31]
    v_mfma_f32_16x16x32_bf16 v[24:27], a[48:51], v[52:55], v[24:27]
    v_mfma_f32_16x16x32_bf16 v[24:27], a[32:35], v[48:51], v[24:27]
    s_waitcnt lgkmcnt(0)
    v_mfma_f32_16x16x32_bf16 v[24:27], a[64:67], v[56:59], v[24:27]
    ds_read_b128 v[64:67], v3 offset:6144
    v_mfma_f32_16x16x32_bf16 v[24:27], a[80:83], v[60:63], v[24:27]
    v_mfma_f32_16x16x32_bf16 v[28:31], a[84:87], v[60:63], v[28:31]
    ds_read_b128 v[68:71], v3 offset:7168
    v_mfma_f32_16x16x32_bf16 v[28:31], a[68:71], v[56:59], v[28:31]
    v_mfma_f32_16x16x32_bf16 v[32:35], a[72:75], v[56:59], v[32:35]
    v_mfma_f32_16x16x32_bf16 v[32:35], a[88:91], v[60:63], v[32:35]
    v_mfma_f32_16x16x32_bf16 v[36:39], a[92:95], v[60:63], v[36:39]
    v_mfma_f32_16x16x32_bf16 v[36:39], a[76:79], v[56:59], v[36:39]
    s_waitcnt lgkmcnt(0)
    v_mfma_f32_16x16x32_bf16 v[36:39], a[108:111], v[64:67], v[36:39]
    ds_read_b128 v[40:43], v3 offset:8192
    s_waitcnt vmcnt(2)
    v_mfma_f32_16x16x32_bf16 v[36:39], a[124:127], v[68:71], v[36:39]
    v_cmp_gt_i32 vcc, s32, v5
    v_mfma_f32_16x16x32_bf16 v[32:35], a[120:123], v[68:71], v[32:35]
    ds_read_b128 v[44:47], v3 offset:9216
    v_mfma_f32_16x16x32_bf16 v[32:35], a[104:107], v[64:67], v[32:35]
    s_and_b64 vcc, vcc, s[18:19]
    s_cbranch_scc1 Lffb_v11
    v_mfma_f32_16x16x32_bf16 v[28:31], a[100:103], v[64:67], v[28:31]
    buffer_load_dwordx4 v1, s[8:11], s33 offen offset:0 sc1 lds
    v_mfma_f32_16x16x32_bf16 v[28:31], a[116:119], v[68:71], v[28:31]
    v_mfma_f32_16x16x32_bf16 v[24:27], a[112:115], v[68:71], v[24:27]
    v_mfma_f32_16x16x32_bf16 v[24:27], a[96:99], v[64:67], v[24:27]
    s_waitcnt lgkmcnt(0)
    v_mfma_f32_16x16x32_bf16 v[24:27], a[128:131], v[40:43], v[24:27]
    ds_read_b128 v[48:51], v3 offset:10240
    v_mfma_f32_16x16x32_bf16 v[24:27], a[144:147], v[44:47], v[24:27]
    buffer_load_dwordx4 v1, s[8:11], s33 offen offset:1024 sc1 lds
    v_mfma_f32_16x16x32_bf16 v[28:31], a[148:151], v[44:47], v[28:31]
    ds_read_b128 v[52:55], v3 offset:11264
    v_mfma_f32_16x16x32_bf16 v[28:31], a[132:135], v[40:43], v[28:31]
    v_mfma_f32_16x16x32_bf16 v[32:35], a[136:139], v[40:43], v[32:35]
    v_mfma_f32_16x16x32_bf16 v[32:35], a[152:155], v[44:47], v[32:35]
    buffer_load_dwordx4 v1, s[8:11], s33 offen offset:2048 sc1 lds
    v_mfma_f32_16x16x32_bf16 v[36:39], a[156:159], v[44:47], v[36:39]
    s_barrier
    v_mfma_f32_16x16x32_bf16 v[36:39], a[140:143], v[40:43], v[36:39]
    s_waitcnt lgkmcnt(0)
    s_add_u32 s16, s16, 8192
    s_add_u32 m0, s34, s3
    v_mfma_f32_16x16x32_bf16 v[36:39], a[172:175], v[48:51], v[36:39]
    ds_read_b128 v[56:59], v3 offset:12288
    s_add_u32 s37, s33, s3
    v_mfma_f32_16x16x32_bf16 v[36:39], a[188:191], v[52:55], v[36:39]
    buffer_load_dwordx4 v1, s[8:11], s37 offen offset:0 sc1 lds
    v_mfma_f32_16x16x32_bf16 v[32:35], a[184:187], v[52:55], v[32:35]
    ds_read_b128 v[60:63], v3 offset:13312
    v_mfma_f32_16x16x32_bf16 v[32:35], a[168:171], v[48:51], v[32:35]
    v_mfma_f32_16x16x32_bf16 v[28:31], a[164:167], v[48:51], v[28:31]
    v_mfma_f32_16x16x32_bf16 v[28:31], a[180:183], v[52:55], v[28:31]
    buffer_load_dwordx4 v1, s[8:11], s37 offen offset:1024 sc1 lds
    v_mfma_f32_16x16x32_bf16 v[24:27], a[176:179], v[52:55], v[24:27]
    v_mfma_f32_16x16x32_bf16 v[24:27], a[160:163], v[48:51], v[24:27]
    s_waitcnt lgkmcnt(0)
    v_mfma_f32_16x16x32_bf16 v[24:27], a[192:195], v[56:59], v[24:27]
    ds_read_b128 v[64:67], v3 offset:14336
    v_mfma_f32_16x16x32_bf16 v[24:27], a[208:211], v[60:63], v[24:27]
    buffer_load_dwordx4 v1, s[8:11], s37 offen offset:2048 sc1 lds
    v_mfma_f32_16x16x32_bf16 v[28:31], a[212:215], v[60:63], v[28:31]
    ds_read_b128 v[68:71], v3 offset:15360
    s_add_u32 s32, s32, 1
    v_mfma_f32_16x16x32_bf16 v[28:31], a[196:199], v[56:59], v[28:31]
    s_add_u32 s33, s33, 116736
    s_add_u32 s34, s34, 36864
    s_waitcnt vmcnt(6)
    v_mfma_f32_16x16x32_bf16 v[32:35], a[200:203], v[56:59], v[32:35]
    s_cmp_ge_u32 s34, 147456
    s_cselect_b32 s38, 147456, 0
    s_sub_u32 s34, s34, s38
    v_mfma_f32_16x16x32_bf16 v[32:35], a[216:219], v[60:63], v[32:35]
    buffer_store_dword v6, v80, s[12:15], s17 offen sc1
    s_mov_b32 s14, s6
    v_mfma_f32_16x16x32_bf16 v[36:39], a[220:223], v[60:63], v[36:39]
    s_add_u32 s17, s17, 8192
    v_mfma_f32_16x16x32_bf16 v[36:39], a[204:207], v[56:59], v[36:39]
    s_waitcnt lgkmcnt(0)
    v_mfma_f32_16x16x32_bf16 v[36:39], a[236:239], v[64:67], v[36:39]
    ds_read_b128 v[40:43], v3 offset:16384
    v_mfma_f32_16x16x32_bf16 v[36:39], a[252:255], v[68:71], v[36:39]
    v_mfma_f32_16x16x32_bf16 v[32:35], a[248:251], v[68:71], v[32:35]
    ds_read_b128 v[44:47], v3 offset:17408
    v_mfma_f32_16x16x32_bf16 v[32:35], a[232:235], v[64:67], v[32:35]
    v_mfma_f32_16x16x32_bf16 v[28:31], a[228:231], v[64:67], v[28:31]
    v_mfma_f32_16x16x32_bf16 v[28:31], a[244:247], v[68:71], v[28:31]
    v_mfma_f32_16x16x32_bf16 v[24:27], a[240:243], v[68:71], v[24:27]
    v_mfma_f32_16x16x32_bf16 v[24:27], a[224:227], v[64:67], v[24:27]
    s_waitcnt lgkmcnt(0)
    v_mfma_f32_16x16x32_bf16 v[24:27], v[128:131], v[40:43], v[24:27]
    ds_read_b128 v[48:51], v3 offset:18432
    v_mfma_f32_16x16x32_bf16 v[24:27], v[144:147], v[44:47], v[24:27]
    v_mfma_f32_16x16x32_bf16 v[28:31], v[148:151], v[44:47], v[28:31]
    ds_read_b128 v[52:55], v3 offset:19456
    v_mfma_f32_16x16x32_bf16 v[28:31], v[132:135], v[40:43], v[28:31]
    v_mfma_f32_16x16x32_bf16 v[32:35], v[136:139], v[40:43], v[32:35]
    v_mfma_f32_16x16x32_bf16 v[32:35], v[152:155], v[44:47], v[32:35]
    v_mfma_f32_16x16x32_bf16 v[36:39], v[156:159], v[44:47], v[36:39]
    v_mfma_f32_16x16x32_bf16 v[36:39], v[140:143], v[40:43], v[36:39]
    s_waitcnt lgkmcnt(0)
    v_mfma_f32_16x16x32_bf16 v[36:39], v[172:175], v[48:51], v[36:39]
    ds_read_b128 v[56:59], v3 offset:20480
    v_mfma_f32_16x16x32_bf16 v[36:39], v[188:191], v[52:55], v[36:39]
    v_mfma_f32_16x16x32_bf16 v[32:35], v[184:187], v[52:55], v[32:35]
    ds_read_b128 v[60:63], v3 offset:21504
    v_mfma_f32_16x16x32_bf16 v[32:35], v[168:171], v[48:51], v[32:35]
    v_mfma_f32_16x16x32_bf16 v[28:31], v[164:167], v[48:51], v[28:31]
    v_mfma_f32_16x16x32_bf16 v[28:31], v[180:183], v[52:55], v[28:31]
    v_mfma_f32_16x16x32_bf16 v[24:27], v[176:179], v[52:55], v[24:27]
    buffer_load_dword v5, v4, s[4:7], s16 offen sc1
    v_mfma_f32_16x16x32_bf16 v[24:27], v[160:163], v[48:51], v[24:27]
    s_waitcnt lgkmcnt(0)
    v_mfma_f32_16x16x32_bf16 v[24:27], v[192:195], v[56:59], v[24:27]
    ds_read_b128 v[64:67], v3 offset:22528
    v_mfma_f32_16x16x32_bf16 v[24:27], v[208:211], v[60:63], v[24:27]
    v_mfma_f32_16x16x32_bf16 v[28:31], v[212:215], v[60:63], v[28:31]
    ds_read_b128 v[68:71], v3 offset:23552
    v_mfma_f32_16x16x32_bf16 v[28:31], v[196:199], v[56:59], v[28:31]
    v_mfma_f32_16x16x32_bf16 v[32:35], v[200:203], v[56:59], v[32:35]
    s_waitcnt vmcnt(5)
    v_mfma_f32_16x16x32_bf16 v[32:35], v[216:219], v[60:63], v[32:35]
    v_mfma_f32_16x16x32_bf16 v[36:39], v[220:223], v[60:63], v[36:39]
    s_barrier
    v_mfma_f32_16x16x32_bf16 v[36:39], v[204:207], v[56:59], v[36:39]
    s_waitcnt lgkmcnt(0)
    v_mfma_f32_16x16x32_bf16 v[36:39], v[236:239], v[64:67], v[36:39]
    ds_read_b128 v[40:43], v2 offset:0
    v_mfma_f32_16x16x32_bf16 v[36:39], v[252:255], v[68:71], v[36:39]
    v_mfma_f32_16x16x32_bf16 v[32:35], v[248:251], v[68:71], v[32:35]
    ds_read_b128 v[44:47], v2 offset:1024
    v_mfma_f32_16x16x32_bf16 v[32:35], v[232:235], v[64:67], v[32:35]
    v_mfma_f32_16x16x32_bf16 v[28:31], v[228:231], v[64:67], v[28:31]
    v_mfma_f32_16x16x32_bf16 v[28:31], v[244:247], v[68:71], v[28:31]
    v_mfma_f32_16x16x32_bf16 v[24:27], v[240:243], v[68:71], v[24:27]
    v_mfma_f32_16x16x32_bf16 v[24:27], v[224:227], v[64:67], v[24:27]
    s_cmp_lt_i32 s31, 63
    s_cbranch_scc1 Lffb_body02
    s_branch L_exit
    .p2align 6
Lffb_body03:
    s_waitcnt lgkmcnt(0)
    v_mfma_f32_16x16x32_bf16 v[8:11], a[0:3], v[40:43], 0
    ds_read_b128 v[48:51], v2 offset:2048
    s_add_u32 m0, s34, 0
    v_mfma_f32_16x16x32_bf16 v[8:11], a[16:19], v[44:47], v[8:11]
    s_add_u32 s31, s31, 1
    v_mov_b32 v6, s31
    s_add_u32 s35, s35, 36864
    v_mfma_f32_16x16x32_bf16 v[12:15], a[20:23], v[44:47], 0
    ds_read_b128 v[52:55], v2 offset:3072
    v_cvt_pk_bf16_f32 v72, v24, v25
    v_mfma_f32_16x16x32_bf16 v[12:15], a[4:7], v[40:43], v[12:15]
    s_cmp_eq_u32 s35, 147456
    s_cselect_b32 s35, 0, s35
    v_cvt_pk_bf16_f32 v73, v26, v27
    v_mfma_f32_16x16x32_bf16 v[16:19], a[8:11], v[40:43], 0
    v_cvt_pk_bf16_f32 v74, v28, v29
    v_cvt_pk_bf16_f32 v75, v30, v31
    v_mfma_f32_16x16x32_bf16 v[16:19], a[24:27], v[44:47], v[16:19]
    buffer_store_dwordx4 v[72:75], v1, s[12:15], s36 offen offset:0 sc1
    v_cvt_pk_bf16_f32 v76, v32, v33
    v_mfma_f32_16x16x32_bf16 v[20:23], a[28:31], v[44:47], 0
    v_cvt_pk_bf16_f32 v77, v34, v35
    v_cvt_pk_bf16_f32 v78, v36, v37
    v_mfma_f32_16x16x32_bf16 v[20:23], a[12:15], v[40:43], v[20:23]
    s_waitcnt lgkmcnt(0)
    v_cvt_pk_bf16_f32 v79, v38, v39
    v_add_u32 v3, s35, v1
    v_mfma_f32_16x16x32_bf16 v[20:23], a[44:47], v[48:51], v[20:23]
    ds_read_b128 v[56:59], v2 offset:4096
    v_mfma_f32_16x16x32_bf16 v[20:23], a[60:63], v[52:55], v[20:23]
    buffer_store_dwordx4 v[76:79], v1, s[12:15], s36 offen offset:1024 sc1
    s_add_u32 s36, s36, 131072
    v_mfma_f32_16x16x32_bf16 v[16:19], a[56:59], v[52:55], v[16:19]
    ds_read_b128 v[60:63], v2 offset:5120
    v_mfma_f32_16x16x32_bf16 v[16:19], a[40:43], v[48:51], v[16:19]
    v_mfma_f32_16x16x32_bf16 v[12:15], a[36:39], v[48:51], v[12:15]
    v_mfma_f32_16x16x32_bf16 v[12:15], a[52:55], v[52:55], v[12:15]
    v_mfma_f32_16x16x32_bf16 v[8:11], a[48:51], v[52:55], v[8:11]
    v_mfma_f32_16x16x32_bf16 v[8:11], a[32:35], v[48:51], v[8:11]
    s_waitcnt lgkmcnt(0)
    v_mfma_f32_16x16x32_bf16 v[8:11], a[64:67], v[56:59], v[8:11]
    ds_read_b128 v[64:67], v2 offset:6144
    v_mfma_f32_16x16x32_bf16 v[8:11], a[80:83], v[60:63], v[8:11]
    v_mfma_f32_16x16x32_bf16 v[12:15], a[84:87], v[60:63], v[12:15]
    ds_read_b128 v[68:71], v2 offset:7168
    v_mfma_f32_16x16x32_bf16 v[12:15], a[68:71], v[56:59], v[12:15]
    v_mfma_f32_16x16x32_bf16 v[16:19], a[72:75], v[56:59], v[16:19]
    v_mfma_f32_16x16x32_bf16 v[16:19], a[88:91], v[60:63], v[16:19]
    v_mfma_f32_16x16x32_bf16 v[20:23], a[92:95], v[60:63], v[20:23]
    v_mfma_f32_16x16x32_bf16 v[20:23], a[76:79], v[56:59], v[20:23]
    s_waitcnt lgkmcnt(0)
    v_mfma_f32_16x16x32_bf16 v[20:23], a[108:111], v[64:67], v[20:23]
    ds_read_b128 v[40:43], v2 offset:8192
    s_waitcnt vmcnt(2)
    v_mfma_f32_16x16x32_bf16 v[20:23], a[124:127], v[68:71], v[20:23]
    v_cmp_gt_i32 vcc, s32, v5
    v_mfma_f32_16x16x32_bf16 v[16:19], a[120:123], v[68:71], v[16:19]
    ds_read_b128 v[44:47], v2 offset:9216
    v_mfma_f32_16x16x32_bf16 v[16:19], a[104:107], v[64:67], v[16:19]
    s_and_b64 vcc, vcc, s[18:19]
    s_cbranch_scc1 Lffb_v01
    v_mfma_f32_16x16x32_bf16 v[12:15], a[100:103], v[64:67], v[12:15]
    buffer_load_dwordx4 v1, s[8:11], s33 offen offset:0 sc1 lds
    v_mfma_f32_16x16x32_bf16 v[12:15], a[116:119], v[68:71], v[12:15]
    v_mfma_f32_16x16x32_bf16 v[8:11], a[112:115], v[68:71], v[8:11]
    v_mfma_f32_16x16x32_bf16 v[8:11], a[96:99], v[64:67], v[8:11]
    s_waitcnt lgkmcnt(0)
    v_mfma_f32_16x16x32_bf16 v[8:11], a[128:131], v[40:43], v[8:11]
    ds_read_b128 v[48:51], v2 offset:10240
    v_mfma_f32_16x16x32_bf16 v[8:11], a[144:147], v[44:47], v[8:11]
    buffer_load_dwordx4 v1, s[8:11], s33 offen offset:1024 sc1 lds
    v_mfma_f32_16x16x32_bf16 v[12:15], a[148:151], v[44:47], v[12:15]
    ds_read_b128 v[52:55], v2 offset:11264
    v_mfma_f32_16x16x32_bf16 v[12:15], a[132:135], v[40:43], v[12:15]
    v_mfma_f32_16x16x32_bf16 v[16:19], a[136:139], v[40:43], v[16:19]
    v_mfma_f32_16x16x32_bf16 v[16:19], a[152:155], v[44:47], v[16:19]
    buffer_load_dwordx4 v1, s[8:11], s33 offen offset:2048 sc1 lds
    v_mfma_f32_16x16x32_bf16 v[20:23], a[156:159], v[44:47], v[20:23]
    s_add_u32 s16, s16, 8192
    s_add_u32 m0, s34, s3
    s_add_u32 s37, s33, s3
    v_mfma_f32_16x16x32_bf16 v[20:23], a[140:143], v[40:43], v[20:23]
    s_waitcnt lgkmcnt(0)
    s_barrier
    v_mfma_f32_16x16x32_bf16 v[20:23], a[172:175], v[48:51], v[20:23]
    ds_read_b128 v[56:59], v2 offset:12288
    v_mfma_f32_16x16x32_bf16 v[20:23], a[188:191], v[52:55], v[20:23]
    buffer_load_dwordx4 v1, s[8:11], s37 offen offset:0 sc1 lds
    v_mfma_f32_16x16x32_bf16 v[16:19], a[184:187], v[52:55], v[16:19]
    ds_read_b128 v[60:63], v2 offset:13312
    v_mfma_f32_16x16x32_bf16 v[16:19], a[168:171], v[48:51], v[16:19]
    v_mfma_f32_16x16x32_bf16 v[12:15], a[164:167], v[48:51], v[12:15]
    v_mfma_f32_16x16x32_bf16 v[12:15], a[180:183], v[52:55], v[12:15]
    buffer_load_dwordx4 v1, s[8:11], s37 offen offset:1024 sc1 lds
    v_mfma_f32_16x16x32_bf16 v[8:11], a[176:179], v[52:55], v[8:11]
    v_mfma_f32_16x16x32_bf16 v[8:11], a[160:163], v[48:51], v[8:11]
    s_waitcnt lgkmcnt(0)
    v_mfma_f32_16x16x32_bf16 v[8:11], a[192:195], v[56:59], v[8:11]
    ds_read_b128 v[64:67], v2 offset:14336
    v_mfma_f32_16x16x32_bf16 v[8:11], a[208:211], v[60:63], v[8:11]
    buffer_load_dwordx4 v1, s[8:11], s37 offen offset:2048 sc1 lds
    v_mfma_f32_16x16x32_bf16 v[12:15], a[212:215], v[60:63], v[12:15]
    ds_read_b128 v[68:71], v2 offset:15360
    s_add_u32 s32, s32, 1
    v_mfma_f32_16x16x32_bf16 v[12:15], a[196:199], v[56:59], v[12:15]
    s_add_u32 s33, s33, 116736
    s_add_u32 s34, s34, 36864
    s_waitcnt vmcnt(6)
    v_mfma_f32_16x16x32_bf16 v[16:19], a[200:203], v[56:59], v[16:19]
    s_cmp_ge_u32 s34, 147456
    s_cselect_b32 s38, 147456, 0
    s_sub_u32 s34, s34, s38
    v_mfma_f32_16x16x32_bf16 v[16:19], a[216:219], v[60:63], v[16:19]
    buffer_store_dword v6, v80, s[12:15], s17 offen sc1
    s_mov_b32 s14, s6
    v_mfma_f32_16x16x32_bf16 v[20:23], a[220:223], v[60:63], v[20:23]
    s_add_u32 s17, s17, 8192
    v_mfma_f32_16x16x32_bf16 v[20:23], a[204:207], v[56:59], v[20:23]
    s_waitcnt lgkmcnt(0)
    v_mfma_f32_16x16x32_bf16 v[20:23], a[236:239], v[64:67], v[20:23]
    ds_read_b128 v[40:43], v2 offset:16384
    v_mfma_f32_16x16x32_bf16 v[20:23], a[252:255], v[68:71], v[20:23]
    v_mfma_f32_16x16x32_bf16 v[16:19], a[248:251], v[68:71], v[16:19]
    ds_read_b128 v[44:47], v2 offset:17408
    v_mfma_f32_16x16x32_bf16 v[16:19], a[232:235], v[64:67], v[16:19]
    v_mfma_f32_16x16x32_bf16 v[12:15], a[228:231], v[64:67], v[12:15]
    v_mfma_f32_16x16x32_bf16 v[12:15], a[244:247], v[68:71], v[12:15]
    v_mfma_f32_16x16x32_bf16 v[8:11], a[240:243], v[68:71], v[8:11]
    v_mfma_f32_16x16x32_bf16 v[8:11], a[224:227], v[64:67], v[8:11]
    s_waitcnt lgkmcnt(0)
    v_mfma_f32_16x16x32_bf16 v[8:11], v[128:131], v[40:43], v[8:11]
    ds_read_b128 v[48:51], v2 offset:18432
    v_mfma_f32_16x16x32_bf16 v[8:11], v[144:147], v[44:47], v[8:11]
    v_mfma_f32_16x16x32_bf16 v[12:15], v[148:151], v[44:47], v[12:15]
    ds_read_b128 v[52:55], v2 offset:19456
    v_mfma_f32_16x16x32_bf16 v[12:15], v[132:135], v[40:43], v[12:15]
    v_mfma_f32_16x16x32_bf16 v[16:19], v[136:139], v[40:43], v[16:19]
    v_mfma_f32_16x16x32_bf16 v[16:19], v[152:155], v[44:47], v[16:19]
    v_mfma_f32_16x16x32_bf16 v[20:23], v[156:159], v[44:47], v[20:23]
    v_mfma_f32_16x16x32_bf16 v[20:23], v[140:143], v[40:43], v[20:23]
    s_waitcnt lgkmcnt(0)
    v_mfma_f32_16x16x32_bf16 v[20:23], v[172:175], v[48:51], v[20:23]
    ds_read_b128 v[56:59], v2 offset:20480
    v_mfma_f32_16x16x32_bf16 v[20:23], v[188:191], v[52:55], v[20:23]
    v_mfma_f32_16x16x32_bf16 v[16:19], v[184:187], v[52:55], v[16:19]
    ds_read_b128 v[60:63], v2 offset:21504
    v_mfma_f32_16x16x32_bf16 v[16:19], v[168:171], v[48:51], v[16:19]
    v_mfma_f32_16x16x32_bf16 v[12:15], v[164:167], v[48:51], v[12:15]
    v_mfma_f32_16x16x32_bf16 v[12:15], v[180:183], v[52:55], v[12:15]
    v_mfma_f32_16x16x32_bf16 v[8:11], v[176:179], v[52:55], v[8:11]
    buffer_load_dword v5, v4, s[4:7], s16 offen sc1
    v_mfma_f32_16x16x32_bf16 v[8:11], v[160:163], v[48:51], v[8:11]
    s_waitcnt lgkmcnt(0)
    v_mfma_f32_16x16x32_bf16 v[8:11], v[192:195], v[56:59], v[8:11]
    ds_read_b128 v[64:67], v2 offset:22528
    v_mfma_f32_16x16x32_bf16 v[8:11], v[208:211], v[60:63], v[8:11]
    v_mfma_f32_16x16x32_bf16 v[12:15], v[212:215], v[60:63], v[12:15]
    ds_read_b128 v[68:71], v2 offset:23552
    v_mfma_f32_16x16x32_bf16 v[12:15], v[196:199], v[56:59], v[12:15]
    v_mfma_f32_16x16x32_bf16 v[16:19], v[200:203], v[56:59], v[16:19]
    s_waitcnt vmcnt(5)
    v_mfma_f32_16x16x32_bf16 v[16:19], v[216:219], v[60:63], v[16:19]
    v_mfma_f32_16x16x32_bf16 v[20:23], v[220:223], v[60:63], v[20:23]
    v_mfma_f32_16x16x32_bf16 v[20:23], v[204:207], v[56:59], v[20:23]
    s_waitcnt lgkmcnt(0)
    s_barrier
    v_mfma_f32_16x16x32_bf16 v[20:23], v[236:239], v[64:67], v[20:23]
    ds_read_b128 v[40:43], v3 offset:0
    v_mfma_f32_16x16x32_bf16 v[20:23], v[252:255], v[68:71], v[20:23]
    v_mfma_f32_16x16x32_bf16 v[16:19], v[248:251], v[68:71], v[16:19]
    ds_read_b128 v[44:47], v3 offset:1024
    v_mfma_f32_16x16x32_bf16 v[16:19], v[232:235], v[64:67], v[16:19]
    v_mfma_f32_16x16x32_bf16 v[12:15], v[228:231], v[64:67], v[12:15]
    v_mfma_f32_16x16x32_bf16 v[12:15], v[244:247], v[68:71], v[12:15]
    v_mfma_f32_16x16x32_bf16 v[8:11], v[240:243], v[68:71], v[8:11]
    v_mfma_f32_16x16x32_bf16 v[8:11], v[224:227], v[64:67], v[8:11]
Lffb_body13:
    s_waitcnt lgkmcnt(0)
    v_mfma_f32_16x16x32_bf16 v[24:27], a[0:3], v[40:43], 0
    ds_read_b128 v[48:51], v3 offset:2048
    s_add_u32 m0, s34, 0
    v_mfma_f32_16x16x32_bf16 v[24:27], a[16:19], v[44:47], v[24:27]
    s_add_u32 s31, s31, 1
    v_mov_b32 v6, s31
    s_add_u32 s35, s35, 36864
    v_mfma_f32_16x16x32_bf16 v[28:31], a[20:23], v[44:47], 0
    ds_read_b128 v[52:55], v3 offset:3072
    v_cvt_pk_bf16_f32 v72, v8, v9
    v_mfma_f32_16x16x32_bf16 v[28:31], a[4:7], v[40:43], v[28:31]
    s_cmp_eq_u32 s35, 147456
    s_cselect_b32 s35, 0, s35
    v_cvt_pk_bf16_f32 v73, v10, v11
    v_mfma_f32_16x16x32_bf16 v[32:35], a[8:11], v[40:43], 0
    v_cvt_pk_bf16_f32 v74, v12, v13
    v_cvt_pk_bf16_f32 v75, v14, v15
    v_mfma_f32_16x16x32_bf16 v[32:35], a[24:27], v[44:47], v[32:35]
    buffer_store_dwordx4 v[72:75], v1, s[12:15], s36 offen offset:0 sc1
    v_cvt_pk_bf16_f32 v76, v16, v17
    v_mfma_f32_16x16x32_bf16 v[36:39], a[28:31], v[44:47], 0
    v_cvt_pk_bf16_f32 v77, v18, v19
    v_cvt_pk_bf16_f32 v78, v20, v21
    v_mfma_f32_16x16x32_bf16 v[36:39], a[12:15], v[40:43], v[36:39]
    s_waitcnt lgkmcnt(0)
    v_cvt_pk_bf16_f32 v79, v22, v23
    v_add_u32 v2, s35, v1
    v_mfma_f32_16x16x32_bf16 v[36:39], a[44:47], v[48:51], v[36:39]
    ds_read_b128 v[56:59], v3 offset:4096
    v_mfma_f32_16x16x32_bf16 v[36:39], a[60:63], v[52:55], v[36:39]
    buffer_store_dwordx4 v[76:79], v1, s[12:15], s36 offen offset:1024 sc1
    s_add_u32 s36, s36, 131072
    v_mfma_f32_16x16x32_bf16 v[32:35], a[56:59], v[52:55], v[32:35]
    ds_read_b128 v[60:63], v3 offset:5120
    v_mfma_f32_16x16x32_bf16 v[32:35], a[40:43], v[48:51], v[32:35]
    v_mfma_f32_16x16x32_bf16 v[28:31], a[36:39], v[48:51], v[28:31]
    v_mfma_f32_16x16x32_bf16 v[28:31], a[52:55], v[52:55], v[28:31]
    v_mfma_f32_16x16x32_bf16 v[24:27], a[48:51], v[52:55], v[24:27]
    v_mfma_f32_16x16x32_bf16 v[24:27], a[32:35], v[48:51], v[24:27]
    s_waitcnt lgkmcnt(0)
    v_mfma_f32_16x16x32_bf16 v[24:27], a[64:67], v[56:59], v[24:27]
    ds_read_b128 v[64:67], v3 offset:6144
    v_mfma_f32_16x16x32_bf16 v[24:27], a[80:83], v[60:63], v[24:27]
    v_mfma_f32_16x16x32_bf16 v[28:31], a[84:87], v[60:63], v[28:31]
    ds_read_b128 v[68:71], v3 offset:7168
    v_mfma_f32_16x16x32_bf16 v[28:31], a[68:71], v[56:59], v[28:31]
    v_mfma_f32_16x16x32_bf16 v[32:35], a[72:75], v[56:59], v[32:35]
    v_mfma_f32_16x16x32_bf16 v[32:35], a[88:91], v[60:63], v[32:35]
    v_mfma_f32_16x16x32_bf16 v[36:39], a[92:95], v[60:63], v[36:39]
    v_mfma_f32_16x16x32_bf16 v[36:39], a[76:79], v[56:59], v[36:39]
    s_waitcnt lgkmcnt(0)
    v_mfma_f32_16x16x32_bf16 v[36:39], a[108:111], v[64:67], v[36:39]
    ds_read_b128 v[40:43], v3 offset:8192
    s_waitcnt vmcnt(2)
    v_mfma_f32_16x16x32_bf16 v[36:39], a[124:127], v[68:71], v[36:39]
    v_cmp_gt_i32 vcc, s32, v5
    v_mfma_f32_16x16x32_bf16 v[32:35], a[120:123], v[68:71], v[32:35]
    ds_read_b128 v[44:47], v3 offset:9216
    v_mfma_f32_16x16x32_bf16 v[32:35], a[104:107], v[64:67], v[32:35]
    s_and_b64 vcc, vcc, s[18:19]
    s_cbranch_scc1 Lffb_v11
    v_mfma_f32_16x16x32_bf16 v[28:31], a[100:103], v[64:67], v[28:31]
    buffer_load_dwordx4 v1, s[8:11], s33 offen offset:0 sc1 lds
    v_mfma_f32_16x16x32_bf16 v[28:31], a[116:119], v[68:71], v[28:31]
    v_mfma_f32_16x16x32_bf16 v[24:27], a[112:115], v[68:71], v[24:27]
    v_mfma_f32_16x16x32_bf16 v[24:27], a[96:99], v[64:67], v[24:27]
    s_waitcnt lgkmcnt(0)
    v_mfma_f32_16x16x32_bf16 v[24:27], a[128:131], v[40:43], v[24:27]
    ds_read_b128 v[48:51], v3 offset:10240
    v_mfma_f32_16x16x32_bf16 v[24:27], a[144:147], v[44:47], v[24:27]
    buffer_load_dwordx4 v1, s[8:11], s33 offen offset:1024 sc1 lds
    v_mfma_f32_16x16x32_bf16 v[28:31], a[148:151], v[44:47], v[28:31]
    ds_read_b128 v[52:55], v3 offset:11264
    v_mfma_f32_16x16x32_bf16 v[28:31], a[132:135], v[40:43], v[28:31]
    v_mfma_f32_16x16x32_bf16 v[32:35], a[136:139], v[40:43], v[32:35]
    v_mfma_f32_16x16x32_bf16 v[32:35], a[152:155], v[44:47], v[32:35]
    buffer_load_dwordx4 v1, s[8:11], s33 offen offset:2048 sc1 lds
    v_mfma_f32_16x16x32_bf16 v[36:39], a[156:159], v[44:47], v[36:39]
    s_add_u32 s16, s16, 8192
    s_add_u32 m0, s34, s3
    s_add_u32 s37, s33, s3
    v_mfma_f32_16x16x32_bf16 v[36:39], a[140:143], v[40:43], v[36:39]
    s_waitcnt lgkmcnt(0)
    s_barrier
    v_mfma_f32_16x16x32_bf16 v[36:39], a[172:175], v[48:51], v[36:39]
    ds_read_b128 v[56:59], v3 offset:12288
    v_mfma_f32_16x16x32_bf16 v[36:39], a[188:191], v[52:55], v[36:39]
    buffer_load_dwordx4 v1, s[8:11], s37 offen offset:0 sc1 lds
    v_mfma_f32_16x16x32_bf16 v[32:35], a[184:187], v[52:55], v[32:35]
    ds_read_b128 v[60:63], v3 offset:13312
    v_mfma_f32_16x16x32_bf16 v[32:35], a[168:171], v[48:51], v[32:35]
    v_mfma_f32_16x16x32_bf16 v[28:31], a[164:167], v[48:51], v[28:31]
    v_mfma_f32_16x16x32_bf16 v[28:31], a[180:183], v[52:55], v[28:31]
    buffer_load_dwordx4 v1, s[8:11], s37 offen offset:1024 sc1 lds
    v_mfma_f32_16x16x32_bf16 v[24:27], a[176:179], v[52:55], v[24:27]
    v_mfma_f32_16x16x32_bf16 v[24:27], a[160:163], v[48:51], v[24:27]
    s_waitcnt lgkmcnt(0)
    v_mfma_f32_16x16x32_bf16 v[24:27], a[192:195], v[56:59], v[24:27]
    ds_read_b128 v[64:67], v3 offset:14336
    v_mfma_f32_16x16x32_bf16 v[24:27], a[208:211], v[60:63], v[24:27]
    buffer_load_dwordx4 v1, s[8:11], s37 offen offset:2048 sc1 lds
    v_mfma_f32_16x16x32_bf16 v[28:31], a[212:215], v[60:63], v[28:31]
    ds_read_b128 v[68:71], v3 offset:15360
    s_add_u32 s32, s32, 1
    v_mfma_f32_16x16x32_bf16 v[28:31], a[196:199], v[56:59], v[28:31]
    s_add_u32 s33, s33, 116736
    s_add_u32 s34, s34, 36864
    s_waitcnt vmcnt(6)
    v_mfma_f32_16x16x32_bf16 v[32:35], a[200:203], v[56:59], v[32:35]
    s_cmp_ge_u32 s34, 147456
    s_cselect_b32 s38, 147456, 0
    s_sub_u32 s34, s34, s38
    v_mfma_f32_16x16x32_bf16 v[32:35], a[216:219], v[60:63], v[32:35]
    buffer_store_dword v6, v80, s[12:15], s17 offen sc1
    s_mov_b32 s14, s6
    v_mfma_f32_16x16x32_bf16 v[36:39], a[220:223], v[60:63], v[36:39]
    s_add_u32 s17, s17, 8192
    v_mfma_f32_16x16x32_bf16 v[36:39], a[204:207], v[56:59], v[36:39]
    s_waitcnt lgkmcnt(0)
    v_mfma_f32_16x16x32_bf16 v[36:39], a[236:239], v[64:67], v[36:39]
    ds_read_b128 v[40:43], v3 offset:16384
    v_mfma_f32_16x16x32_bf16 v[36:39], a[252:255], v[68:71], v[36:39]
    v_mfma_f32_16x16x32_bf16 v[32:35], a[248:251], v[68:71], v[32:35]
    ds_read_b128 v[44:47], v3 offset:17408
    v_mfma_f32_16x16x32_bf16 v[32:35], a[232:235], v[64:67], v[32:35]
    v_mfma_f32_16x16x32_bf16 v[28:31], a[228:231], v[64:67], v[28:31]
    v_mfma_f32_16x16x32_bf16 v[28:31], a[244:247], v[68:71], v[28:31]
    v_mfma_f32_16x16x32_bf16 v[24:27], a[240:243], v[68:71], v[24:27]
    v_mfma_f32_16x16x32_bf16 v[24:27], a[224:227], v[64:67], v[24:27]
    s_waitcnt lgkmcnt(0)
    v_mfma_f32_16x16x32_bf16 v[24:27], v[128:131], v[40:43], v[24:27]
    ds_read_b128 v[48:51], v3 offset:18432
    v_mfma_f32_16x16x32_bf16 v[24:27], v[144:147], v[44:47], v[24:27]
    v_mfma_f32_16x16x32_bf16 v[28:31], v[148:151], v[44:47], v[28:31]
    ds_read_b128 v[52:55], v3 offset:19456
    v_mfma_f32_16x16x32_bf16 v[28:31], v[132:135], v[40:43], v[28:31]
    v_mfma_f32_16x16x32_bf16 v[32:35], v[136:139], v[40:43], v[32:35]
    v_mfma_f32_16x16x32_bf16 v[32:35], v[152:155], v[44:47], v[32:35]
    v_mfma_f32_16x16x32_bf16 v[36:39], v[156:159], v[44:47], v[36:39]
    v_mfma_f32_16x16x32_bf16 v[36:39], v[140:143], v[40:43], v[36:39]
    s_waitcnt lgkmcnt(0)
    v_mfma_f32_16x16x32_bf16 v[36:39], v[172:175], v[48:51], v[36:39]
    ds_read_b128 v[56:59], v3 offset:20480
    v_mfma_f32_16x16x32_bf16 v[36:39], v[188:191], v[52:55], v[36:39]
    v_mfma_f32_16x16x32_bf16 v[32:35], v[184:187], v[52:55], v[32:35]
    ds_read_b128 v[60:63], v3 offset:21504
    v_mfma_f32_16x16x32_bf16 v[32:35], v[168:171], v[48:51], v[32:35]
    v_mfma_f32_16x16x32_bf16 v[28:31], v[164:167], v[48:51], v[28:31]
    v_mfma_f32_16x16x32_bf16 v[28:31], v[180:183], v[52:55], v[28:31]
    v_mfma_f32_16x16x32_bf16 v[24:27], v[176:179], v[52:55], v[24:27]
    buffer_load_dword v5, v4, s[4:7], s16 offen sc1
    v_mfma_f32_16x16x32_bf16 v[24:27], v[160:163], v[48:51], v[24:27]
    s_waitcnt lgkmcnt(0)
    v_mfma_f32_16x16x32_bf16 v[24:27], v[192:195], v[56:59], v[24:27]
    ds_read_b128 v[64:67], v3 offset:22528
    v_mfma_f32_16x16x32_bf16 v[24:27], v[208:211], v[60:63], v[24:27]
    v_mfma_f32_16x16x32_bf16 v[28:31], v[212:215], v[60:63], v[28:31]
    ds_read_b128 v[68:71], v3 offset:23552
    v_mfma_f32_16x16x32_bf16 v[28:31], v[196:199], v[56:59], v[28:31]
    v_mfma_f32_16x16x32_bf16 v[32:35], v[200:203], v[56:59], v[32:35]
    s_waitcnt vmcnt(5)
    v_mfma_f32_16x16x32_bf16 v[32:35], v[216:219], v[60:63], v[32:35]
    v_mfma_f32_16x16x32_bf16 v[36:39], v[220:223], v[60:63], v[36:39]
    v_mfma_f32_16x16x32_bf16 v[36:39], v[204:207], v[56:59], v[36:39]
    s_waitcnt lgkmcnt(0)
    s_barrier
    v_mfma_f32_16x16x32_bf16 v[36:39], v[236:239], v[64:67], v[36:39]
    ds_read_b128 v[40:43], v2 offset:0
    v_mfma_f32_16x16x32_bf16 v[36:39], v[252:255], v[68:71], v[36:39]
    v_mfma_f32_16x16x32_bf16 v[32:35], v[248:251], v[68:71], v[32:35]
    ds_read_b128 v[44:47], v2 offset:1024
    v_mfma_f32_16x16x32_bf16 v[32:35], v[232:235], v[64:67], v[32:35]
    v_mfma_f32_16x16x32_bf16 v[28:31], v[228:231], v[64:67], v[28:31]
    v_mfma_f32_16x16x32_bf16 v[28:31], v[244:247], v[68:71], v[28:31]
    v_mfma_f32_16x16x32_bf16 v[24:27], v[240:243], v[68:71], v[24:27]
    v_mfma_f32_16x16x32_bf16 v[24:27], v[224:227], v[64:67], v[24:27]
    s_cmp_lt_i32 s31, 63
    s_cbranch_scc1 Lffb_body03
    s_branch L_exit
Lffb_v01:
    v_mfma_f32_16x16x32_bf16 v[12:15], a[100:103], v[64:67], v[12:15]
    buffer_load_dword v5, v4, s[4:7], s16 offen sc1
    v_mfma_f32_16x16x32_bf16 v[12:15], a[116:119], v[68:71], v[12:15]
    v_mfma_f32_16x16x32_bf16 v[8:11], a[112:115], v[68:71], v[8:11]
    v_mfma_f32_16x16x32_bf16 v[8:11], a[96:99], v[64:67], v[8:11]
    s_waitcnt lgkmcnt(0)
    v_mfma_f32_16x16x32_bf16 v[8:11], a[128:131], v[40:43], v[8:11]
    ds_read_b128 v[48:51], v2 offset:10240
    v_mfma_f32_16x16x32_bf16 v[8:11], a[144:147], v[44:47], v[8:11]
    v_mfma_f32_16x16x32_bf16 v[12:15], a[148:151], v[44:47], v[12:15]
    ds_read_b128 v[52:55], v2 offset:11264
    v_mfma_f32_16x16x32_bf16 v[12:15], a[132:135], v[40:43], v[12:15]
    v_mfma_f32_16x16x32_bf16 v[16:19], a[136:139], v[40:43], v[16:19]
    v_mfma_f32_16x16x32_bf16 v[16:19], a[152:155], v[44:47], v[16:19]
    v_mfma_f32_16x16x32_bf16 v[20:23], a[156:159], v[44:47], v[20:23]
    s_barrier
    v_mfma_f32_16x16x32_bf16 v[20:23], a[140:143], v[40:43], v[20:23]
    s_waitcnt lgkmcnt(0)
    v_mfma_f32_16x16x32_bf16 v[20:23], a[172:175], v[48:51], v[20:23]
    ds_read_b128 v[56:59], v2 offset:12288
    v_mfma_f32_16x16x32_bf16 v[20:23], a[188:191], v[52:55], v[20:23]
    v_mfma_f32_16x16x32_bf16 v[16:19], a[184:187], v[52:55], v[16:19]
    ds_read_b128 v[60:63], v2 offset:13312
    v_mfma_f32_16x16x32_bf16 v[16:19], a[168:171], v[48:51], v[16:19]
    v_mfma_f32_16x16x32_bf16 v[12:15], a[164:167], v[48:51], v[12:15]
    v_mfma_f32_16x16x32_bf16 v[12:15], a[180:183], v[52:55], v[12:15]
    v_mfma_f32_16x16x32_bf16 v[8:11], a[176:179], v[52:55], v[8:11]
    v_mfma_f32_16x16x32_bf16 v[8:11], a[160:163], v[48:51], v[8:11]
    s_waitcnt lgkmcnt(0)
    v_mfma_f32_16x16x32_bf16 v[8:11], a[192:195], v[56:59], v[8:11]
    ds_read_b128 v[64:67], v2 offset:14336
    v_mfma_f32_16x16x32_bf16 v[8:11], a[208:211], v[60:63], v[8:11]
    v_mfma_f32_16x16x32_bf16 v[12:15], a[212:215], v[60:63], v[12:15]
    ds_read_b128 v[68:71], v2 offset:15360
    v_mfma_f32_16x16x32_bf16 v[12:15], a[196:199], v[56:59], v[12:15]
    s_waitcnt vmcnt(1)
    buffer_store_dword v6, v80, s[12:15], s17 offen sc1
    v_mfma_f32_16x16x32_bf16 v[16:19], a[200:203], v[56:59], v[16:19]
    s_mov_b32 s14, s6
    s_add_u32 s17, s17, 8192
    v_mfma_f32_16x16x32_bf16 v[16:19], a[216:219], v[60:63], v[16:19]
    v_mfma_f32_16x16x32_bf16 v[20:23], a[220:223], v[60:63], v[20:23]
    v_mfma_f32_16x16x32_bf16 v[20:23], a[204:207], v[56:59], v[20:23]
    s_waitcnt lgkmcnt(0)
    v_mfma_f32_16x16x32_bf16 v[20:23], a[236:239], v[64:67], v[20:23]
    ds_read_b128 v[40:43], v2 offset:16384
    v_mfma_f32_16x16x32_bf16 v[20:23], a[252:255], v[68:71], v[20:23]
    v_mfma_f32_16x16x32_bf16 v[16:19], a[248:251], v[68:71], v[16:19]
    ds_read_b128 v[44:47], v2 offset:17408
    s_waitcnt vmcnt(1)
    v_mfma_f32_16x16x32_bf16 v[16:19], a[232:235], v[64:67], v[16:19]
    v_cmp_gt_i32 vcc, s32, v5
    v_mfma_f32_16x16x32_bf16 v[12:15], a[228:231], v[64:67], v[12:15]
    v_mfma_f32_16x16x32_bf16 v[12:15], a[244:247], v[68:71], v[12:15]
    s_and_b64 vcc, vcc, s[18:19]
    s_cbranch_scc1 Lffb_v02
    v_mfma_f32_16x16x32_bf16 v[8:11], a[240:243], v[68:71], v[8:11]
    buffer_load_dwordx4 v1, s[8:11], s33 offen offset:0 sc1 lds
    v_mfma_f32_16x16x32_bf16 v[8:11], a[224:227], v[64:67], v[8:11]
    s_waitcnt lgkmcnt(0)
    v_mfma_f32_16x16x32_bf16 v[8:11], v[128:131], v[40:43], v[8:11]
    ds_read_b128 v[48:51], v2 offset:18432
    v_mfma_f32_16x16x32_bf16 v[8:11], v[144:147], v[44:47], v[8:11]
    v_mfma_f32_16x16x32_bf16 v[12:15], v[148:151], v[44:47], v[12:15]
    ds_read_b128 v[52:55], v2 offset:19456
    v_mfma_f32_16x16x32_bf16 v[12:15], v[132:135], v[40:43], v[12:15]
    buffer_load_dwordx4 v1, s[8:11], s33 offen offset:1024 sc1 lds
    v_mfma_f32_16x16x32_bf16 v[16:19], v[136:139], v[40:43], v[16:19]
    v_mfma_f32_16x16x32_bf16 v[16:19], v[152:155], v[44:47], v[16:19]
    v_mfma_f32_16x16x32_bf16 v[20:23], v[156:159], v[44:47], v[20:23]
    v_mfma_f32_16x16x32_bf16 v[20:23], v[140:143], v[40:43], v[20:23]
    s_waitcnt lgkmcnt(0)
    buffer_load_dwordx4 v1, s[8:11], s33 offen offset:2048 sc1 lds
    v_mfma_f32_16x16x32_bf16 v[20:23], v[172:175], v[48:51], v[20:23]
    ds_read_b128 v[56:59], v2 offset:20480
    s_add_u32 s16, s16, 8192
    v_mfma_f32_16x16x32_bf16 v[20:23], v[188:191], v[52:55], v[20:23]
    s_add_u32 m0, s34, s3
    s_add_u32 s37, s33, s3
    v_mfma_f32_16x16x32_bf16 v[16:19], v[184:187], v[52:55], v[16:19]
    ds_read_b128 v[60:63], v2 offset:21504
    v_mfma_f32_16x16x32_bf16 v[16:19], v[168:171], v[48:51], v[16:19]
    buffer_load_dwordx4 v1, s[8:11], s37 offen offset:0 sc1 lds
    v_mfma_f32_16x16x32_bf16 v[12:15], v[164:167], v[48:51], v[12:15]
    v_mfma_f32_16x16x32_bf16 v[12:15], v[180:183], v[52:55], v[12:15]
    v_mfma_f32_16x16x32_bf16 v[8:11], v[176:179], v[52:55], v[8:11]
    v_mfma_f32_16x16x32_bf16 v[8:11], v[160:163], v[48:51], v[8:11]
    s_waitcnt lgkmcnt(0)
    buffer_load_dword v5, v4, s[4:7], s16 offen sc1
    v_mfma_f32_16x16x32_bf16 v[8:11], v[192:195], v[56:59], v[8:11]
    ds_read_b128 v[64:67], v2 offset:22528
    v_mfma_f32_16x16x32_bf16 v[8:11], v[208:211], v[60:63], v[8:11]
    v_mfma_f32_16x16x32_bf16 v[12:15], v[212:215], v[60:63], v[12:15]
    ds_read_b128 v[68:71], v2 offset:23552
    v_mfma_f32_16x16x32_bf16 v[12:15], v[196:199], v[56:59], v[12:15]
    buffer_load_dwordx4 v1, s[8:11], s37 offen offset:1024 sc1 lds
    v_mfma_f32_16x16x32_bf16 v[16:19], v[200:203], v[56:59], v[16:19]
    v_mfma_f32_16x16x32_bf16 v[16:19], v[216:219], v[60:63], v[16:19]
    v_mfma_f32_16x16x32_bf16 v[20:23], v[220:223], v[60:63], v[20:23]
    s_waitcnt vmcnt(3)
    s_barrier
    v_mfma_f32_16x16x32_bf16 v[20:23], v[204:207], v[56:59], v[20:23]
    s_waitcnt lgkmcnt(0)
    buffer_load_dwordx4 v1, s[8:11], s37 offen offset:2048 sc1 lds
    v_mfma_f32_16x16x32_bf16 v[20:23], v[236:239], v[64:67], v[20:23]
    ds_read_b128 v[40:43], v3 offset:0
    s_add_u32 s32, s32, 1
    v_mfma_f32_16x16x32_bf16 v[20:23], v[252:255], v[68:71], v[20:23]
    s_add_u32 s33, s33, 116736
    s_add_u32 s34, s34, 36864
    v_mfma_f32_16x16x32_bf16 v[16:19], v[248:251], v[68:71], v[16:19]
    ds_read_b128 v[44:47], v3 offset:1024
    v_mfma_f32_16x16x32_bf16 v[16:19], v[232:235], v[64:67], v[16:19]
    s_cmp_ge_u32 s34, 147456
    s_cselect_b32 s38, 147456, 0
    s_sub_u32 s34, s34, s38
    v_mfma_f32_16x16x32_bf16 v[12:15], v[228:231], v[64:67], v[12:15]
    v_mfma_f32_16x16x32_bf16 v[12:15], v[244:247], v[68:71], v[12:15]
    v_mfma_f32_16x16x32_bf16 v[8:11], v[240:243], v[68:71], v[8:11]
    v_mfma_f32_16x16x32_bf16 v[8:11], v[224:227], v[64:67], v[8:11]
    s_cmp_ge_i32 s31, 63
    s_cbranch_scc1 L_exit
    s_cmp_eq_u32 s30, 1
    s_cbranch_scc1 Lffb_body11
    s_cmp_eq_u32 s30, 2
    s_cbranch_scc1 Lffb_body12
    s_cmp_eq_u32 s30, 3
    s_cbranch_scc1 Lffb_body13
    s_branch Lffb_body10
Lffb_v02:
    v_mfma_f32_16x16x32_bf16 v[8:11], a[240:243], v[68:71], v[8:11]
    v_mfma_f32_16x16x32_bf16 v[8:11], a[224:227], v[64:67], v[8:11]
    s_waitcnt lgkmcnt(0)
    v_mfma_f32_16x16x32_bf16 v[8:11], v[128:131], v[40:43], v[8:11]
    ds_read_b128 v[48:51], v2 offset:18432
    v_mfma_f32_16x16x32_bf16 v[8:11], v[144:147], v[44:47], v[8:11]
    v_mfma_f32_16x16x32_bf16 v[12:15], v[148:151], v[44:47], v[12:15]
    ds_read_b128 v[52:55], v2 offset:19456
    v_mfma_f32_16x16x32_bf16 v[12:15], v[132:135], v[40:43], v[12:15]
    v_mfma_f32_16x16x32_bf16 v[16:19], v[136:139], v[40:43], v[16:19]
    v_mfma_f32_16x16x32_bf16 v[16:19], v[152:155], v[44:47], v[16:19]
    v_mfma_f32_16x16x32_bf16 v[20:23], v[156:159], v[44:47], v[20:23]
    v_mfma_f32_16x16x32_bf16 v[20:23], v[140:143], v[40:43], v[20:23]
    s_waitcnt lgkmcnt(0)
    v_mfma_f32_16x16x32_bf16 v[20:23], v[172:175], v[48:51], v[20:23]
    ds_read_b128 v[56:59], v2 offset:20480
    v_mfma_f32_16x16x32_bf16 v[20:23], v[188:191], v[52:55], v[20:23]
    v_mfma_f32_16x16x32_bf16 v[16:19], v[184:187], v[52:55], v[16:19]
    ds_read_b128 v[60:63], v2 offset:21504
    v_mfma_f32_16x16x32_bf16 v[16:19], v[168:171], v[48:51], v[16:19]
    v_mfma_f32_16x16x32_bf16 v[12:15], v[164:167], v[48:51], v[12:15]
    v_mfma_f32_16x16x32_bf16 v[12:15], v[180:183], v[52:55], v[12:15]
    v_mfma_f32_16x16x32_bf16 v[8:11], v[176:179], v[52:55], v[8:11]
    v_mfma_f32_16x16x32_bf16 v[8:11], v[160:163], v[48:51], v[8:11]
    s_waitcnt lgkmcnt(0)
    v_mfma_f32_16x16x32_bf16 v[8:11], v[192:195], v[56:59], v[8:11]
    ds_read_b128 v[64:67], v2 offset:22528
    v_mfma_f32_16x16x32_bf16 v[8:11], v[208:211], v[60:63], v[8:11]
    v_mfma_f32_16x16x32_bf16 v[12:15], v[212:215], v[60:63], v[12:15]
    ds_read_b128 v[68:71], v2 offset:23552
    v_mfma_f32_16x16x32_bf16 v[12:15], v[196:199], v[56:59], v[12:15]
    buffer_load_dword v5, v4, s[4:7], s16 offen sc1
    v_mfma_f32_16x16x32_bf16 v[16:19], v[200:203], v[56:59], v[16:19]
    v_mfma_f32_16x16x32_bf16 v[16:19], v[216:219], v[60:63], v[16:19]
    v_mfma_f32_16x16x32_bf16 v[20:23], v[220:223], v[60:63], v[20:23]
    v_mfma_f32_16x16x32_bf16 v[20:23], v[204:207], v[56:59], v[20:23]
    s_waitcnt lgkmcnt(0)
    v_mfma_f32_16x16x32_bf16 v[20:23], v[236:239], v[64:67], v[20:23]
    v_mfma_f32_16x16x32_bf16 v[20:23], v[252:255], v[68:71], v[20:23]
    v_mfma_f32_16x16x32_bf16 v[16:19], v[248:251], v[68:71], v[16:19]
    v_mfma_f32_16x16x32_bf16 v[16:19], v[232:235], v[64:67], v[16:19]
    v_mfma_f32_16x16x32_bf16 v[12:15], v[228:231], v[64:67], v[12:15]
    v_mfma_f32_16x16x32_bf16 v[12:15], v[244:247], v[68:71], v[12:15]
    v_mfma_f32_16x16x32_bf16 v[8:11], v[240:243], v[68:71], v[8:11]
    v_mfma_f32_16x16x32_bf16 v[8:11], v[224:227], v[64:67], v[8:11]
    s_nop 7
    v_cvt_pk_bf16_f32 v72, v8, v9
    v_cvt_pk_bf16_f32 v73, v10, v11
    v_cvt_pk_bf16_f32 v74, v12, v13
    v_cvt_pk_bf16_f32 v75, v14, v15
    buffer_store_dwordx4 v[72:75], v1, s[12:15], s36 offen offset:0 sc1
    v_cvt_pk_bf16_f32 v76, v16, v17
    v_cvt_pk_bf16_f32 v77, v18, v19
    v_cvt_pk_bf16_f32 v78, v20, v21
    v_cvt_pk_bf16_f32 v79, v22, v23
    buffer_store_dwordx4 v[76:79], v1, s[12:15], s36 offen offset:1024 sc1
    s_add_u32 s54, s31, 1
    v_mov_b32 v6, s54
    s_waitcnt vmcnt(2)
    s_cmp_ge_i32 s31, 63
    s_cbranch_scc1 Lffb_late0
    v_cmp_gt_i32 vcc, s32, v5
    s_sub_u32 s43, s43, 1
    s_cmp_lt_i32 s43, 0
    s_cbranch_scc1 Lffb_rdy0
    s_and_b64 vcc, vcc, s[18:19]
    s_cbranch_scc0 Lffb_rdy0
Lffb_late0:
    buffer_load_dword v5, v4, s[4:7], s16 offen sc1
    s_waitcnt vmcnt(1)
    buffer_store_dword v6, v80, s[12:15], s17 offen sc1
    s_mov_b32 s14, 0
    s_cmp_ge_i32 s31, 63
    s_cbranch_scc1 L_exit
    s_waitcnt vmcnt(1)
    v_cmp_gt_i32 vcc, s32, v5
    s_sub_u32 s43, s43, 1
    s_cmp_lt_i32 s43, 0
    s_cbranch_scc1 Lffb_rdy0
    s_and_b64 vcc, vcc, s[18:19]
    s_cbranch_scc0 Lffb_rdy0
Lffb_spin0:
    buffer_load_dword v5, v4, s[4:7], s16 offen sc1
    s_waitcnt vmcnt(0)
    v_cmp_gt_i32 vcc, s32, v5
    s_sub_u32 s43, s43, 1
    s_cmp_lt_i32 s43, 0
    s_cbranch_scc1 Lffb_rdy0
    s_and_b64 vcc, vcc, s[18:19]
    s_cbranch_scc0 Lffb_rdy0
    s_sleep 8
    s_branch Lffb_spin0
Lffb_rdy0:
    s_add_u32 m0, s34, 0
    s_nop 0
    buffer_load_dwordx4 v1, s[8:11], s33 offen offset:0 sc1 lds
    buffer_load_dwordx4 v1, s[8:11], s33 offen offset:1024 sc1 lds
    buffer_load_dwordx4 v1, s[8:11], s33 offen offset:2048 sc1 lds
    s_add_u32 s16, s16, 8192
    buffer_load_dword v5, v4, s[4:7], s16 offen sc1
    s_add_u32 m0, s34, s3
    s_add_u32 s37, s33, s3
    buffer_load_dwordx4 v1, s[8:11], s37 offen offset:0 sc1 lds
    buffer_load_dwordx4 v1, s[8:11], s37 offen offset:1024 sc1 lds
    buffer_load_dwordx4 v1, s[8:11], s37 offen offset:2048 sc1 lds
    s_add_u32 s32, s32, 1
    s_add_u32 s33, s33, 116736
    s_add_u32 s34, s34, 36864
    s_cmp_ge_u32 s34, 147456
    s_cselect_b32 s38, 147456, 0
    s_sub_u32 s34, s34, s38
    s_waitcnt vmcnt(4)
    buffer_store_dword v6, v80, s[12:15], s17 offen sc1
Lffb_go0:
    s_mov_b32 s14, 0
    s_barrier
    ds_read_b128 v[40:43], v3 offset:0
    ds_read_b128 v[44:47], v3 offset:1024
    s_cmp_eq_u32 s30, 1
    s_cbranch_scc1 Lffb_body11
    s_cmp_eq_u32 s30, 2
    s_cbranch_scc1 Lffb_body12
    s_cmp_eq_u32 s30, 3
    s_cbranch_scc1 Lffb_body13
    s_branch Lffb_body10
Lffb_v11:
    v_mfma_f32_16x16x32_bf16 v[28:31], a[100:103], v[64:67], v[28:31]
    buffer_load_dword v5, v4, s[4:7], s16 offen sc1
    v_mfma_f32_16x16x32_bf16 v[28:31], a[116:119], v[68:71], v[28:31]
    v_mfma_f32_16x16x32_bf16 v[24:27], a[112:115], v[68:71], v[24:27]
    v_mfma_f32_16x16x32_bf16 v[24:27], a[96:99], v[64:67], v[24:27]
    s_waitcnt lgkmcnt(0)
    v_mfma_f32_16x16x32_bf16 v[24:27], a[128:131], v[40:43], v[24:27]
    ds_read_b128 v[48:51], v3 offset:10240
    v_mfma_f32_16x16x32_bf16 v[24:27], a[144:147], v[44:47], v[24:27]
    v_mfma_f32_16x16x32_bf16 v[28:31], a[148:151], v[44:47], v[28:31]
    ds_read_b128 v[52:55], v3 offset:11264
    v_mfma_f32_16x16x32_bf16 v[28:31], a[132:135], v[40:43], v[28:31]
    v_mfma_f32_16x16x32_bf16 v[32:35], a[136:139], v[40:43], v[32:35]
    v_mfma_f32_16x16x32_bf16 v[32:35], a[152:155], v[44:47], v[32:35]
    v_mfma_f32_16x16x32_bf16 v[36:39], a[156:159], v[44:47], v[36:39]
    s_barrier
    v_mfma_f32_16x16x32_bf16 v[36:39], a[140:143], v[40:43], v[36:39]
    s_waitcnt lgkmcnt(0)
    v_mfma_f32_16x16x32_bf16 v[36:39], a[172:175], v[48:51], v[36:39]
    ds_read_b128 v[56:59], v3 offset:12288
    v_mfma_f32_16x16x32_bf16 v[36:39], a[188:191], v[52:55], v[36:39]
    v_mfma_f32_16x16x32_bf16 v[32:35], a[184:187], v[52:55], v[32:35]
    ds_read_b128 v[60:63], v3 offset:13312
    v_mfma_f32_16x16x32_bf16 v[32:35], a[168:171], v[48:51], v[32:35]
    v_mfma_f32_16x16x32_bf16 v[28:31], a[164:167], v[48:51], v[28:31]
    v_mfma_f32_16x16x32_bf16 v[28:31], a[180:183], v[52:55], v[28:31]
    v_mfma_f32_16x16x32_bf16 v[24:27], a[176:179], v[52:55], v[24:27]
    v_mfma_f32_16x16x32_bf16 v[24:27], a[160:163], v[48:51], v[24:27]
    s_waitcnt lgkmcnt(0)
    v_mfma_f32_16x16x32_bf16 v[24:27], a[192:195], v[56:59], v[24:27]
    ds_read_b128 v[64:67], v3 offset:14336
    v_mfma_f32_16x16x32_bf16 v[24:27], a[208:211], v[60:63], v[24:27]
    v_mfma_f32_16x16x32_bf16 v[28:31], a[212:215], v[60:63], v[28:31]
    ds_read_b128 v[68:71], v3 offset:15360
    v_mfma_f32_16x16x32_bf16 v[28:31], a[196:199], v[56:59], v[28:31]
    s_waitcnt vmcnt(1)
    buffer_store_dword v6, v80, s[12:15], s17 offen sc1
    v_mfma_f32_16x16x32_bf16 v[32:35], a[200:203], v[56:59], v[32:35]
    s_mov_b32 s14, s6
    s_add_u32 s17, s17, 8192
    v_mfma_f32_16x16x32_bf16 v[32:35], a[216:219], v[60:63], v[32:35]
    v_mfma_f32_16x16x32_bf16 v[36:39], a[220:223], v[60:63], v[36:39]
    v_mfma_f32_16x16x32_bf16 v[36:39], a[204:207], v[56:59], v[36:39]
    s_waitcnt lgkmcnt(0)
    v_mfma_f32_16x16x32_bf16 v[36:39], a[236:239], v[64:67], v[36:39]
    ds_read_b128 v[40:43], v3 offset:16384
    v_mfma_f32_16x16x32_bf16 v[36:39], a[252:255], v[68:71], v[36:39]
    v_mfma_f32_16x16x32_bf16 v[32:35], a[248:251], v[68:71], v[32:35]
    ds_read_b128 v[44:47], v3 offset:17408
    s_waitcnt vmcnt(1)
    v_mfma_f32_16x16x32_bf16 v[32:35], a[232:235], v[64:67], v[32:35]
    v_cmp_gt_i32 vcc, s32, v5
    v_mfma_f32_16x16x32_bf16 v[28:31], a[228:231], v[64:67], v[28:31]
    v_mfma_f32_16x16x32_bf16 v[28:31], a[244:247], v[68:71], v[28:31]
    s_and_b64 vcc, vcc, s[18:19]
    s_cbranch_scc1 Lffb_v12
    v_mfma_f32_16x16x32_bf16 v[24:27], a[240:243], v[68:71], v[24:27]
    buffer_load_dwordx4 v1, s[8:11], s33 offen offset:0 sc1 lds
    v_mfma_f32_16x16x32_bf16 v[24:27], a[224:227], v[64:67], v[24:27]
    s_waitcnt lgkmcnt(0)
    v_mfma_f32_16x16x32_bf16 v[24:27], v[128:131], v[40:43], v[24:27]
    ds_read_b128 v[48:51], v3 offset:18432
    v_mfma_f32_16x16x32_bf16 v[24:27], v[144:147], v[44:47], v[24:27]
    v_mfma_f32_16x16x32_bf16 v[28:31], v[148:151], v[44:47], v[28:31]
    ds_read_b128 v[52:55], v3 offset:19456
    v_mfma_f32_16x16x32_bf16 v[28:31], v[132:135], v[40:43], v[28:31]
    buffer_load_dwordx4 v1, s[8:11], s33 offen offset:1024 sc1 lds
    v_mfma_f32_16x16x32_bf16 v[32:35], v[136:139], v[40:43], v[32:35]
    v_mfma_f32_16x16x32_bf16 v[32:35], v[152:155], v[44:47], v[32:35]
    v_mfma_f32_16x16x32_bf16 v[36:39], v[156:159], v[44:47], v[36:39]
    v_mfma_f32_16x16x32_bf16 v[36:39], v[140:143], v[40:43], v[36:39]
    s_waitcnt lgkmcnt(0)
    buffer_load_dwordx4 v1, s[8:11], s33 offen offset:2048 sc1 lds
    v_mfma_f32_16x16x32_bf16 v[36:39], v[172:175], v[48:51], v[36:39]
    ds_read_b128 v[56:59], v3 offset:20480
    s_add_u32 s16, s16, 8192
    v_mfma_f32_16x16x32_bf16 v[36:39], v[188:191], v[52:55], v[36:39]
    s_add_u32 m0, s34, s3
    s_add_u32 s37, s33, s3
    v_mfma_f32_16x16x32_bf16 v[32:35], v[184:187], v[52:55], v[32:35]
    ds_read_b128 v[60:63], v3 offset:21504
    v_mfma_f32_16x16x32_bf16 v[32:35], v[168:171], v[48:51], v[32:35]
    buffer_load_dwordx4 v1, s[8:11], s37 offen offset:0 sc1 lds
    v_mfma_f32_16x16x32_bf16 v[28:31], v[164:167], v[48:51], v[28:31]
    v_mfma_f32_16x16x32_bf16 v[28:31], v[180:183], v[52:55], v[28:31]
    v_mfma_f32_16x16x32_bf16 v[24:27], v[176:179], v[52:55], v[24:27]
    v_mfma_f32_16x16x32_bf16 v[24:27], v[160:163], v[48:51], v[24:27]
    s_waitcnt lgkmcnt(0)
    buffer_load_dword v5, v4, s[4:7], s16 offen sc1
    v_mfma_f32_16x16x32_bf16 v[24:27], v[192:195], v[56:59], v[24:27]
    ds_read_b128 v[64:67], v3 offset:22528
    v_mfma_f32_16x16x32_bf16 v[24:27], v[208:211], v[60:63], v[24:27]
    v_mfma_f32_16x16x32_bf16 v[28:31], v[212:215], v[60:63], v[28:31]
    ds_read_b128 v[68:71], v3 offset:23552
    v_mfma_f32_16x16x32_bf16 v[28:31], v[196:199], v[56:59], v[28:31]
    buffer_load_dwordx4 v1, s[8:11], s37 offen offset:1024 sc1 lds
    v_mfma_f32_16x16x32_bf16 v[32:35], v[200:203], v[56:59], v[32:35]
    v_mfma_f32_16x16x32_bf16 v[32:35], v[216:219], v[60:63], v[32:35]
    v_mfma_f32_16x16x32_bf16 v[36:39], v[220:223], v[60:63], v[36:39]
    s_waitcnt vmcnt(3)
    s_barrier
    v_mfma_f32_16x16x32_bf16 v[36:39], v[204:207], v[56:59], v[36:39]
    s_waitcnt lgkmcnt(0)
    buffer_load_dwordx4 v1, s[8:11], s37 offen offset:2048 sc1 lds
    v_mfma_f32_16x16x32_bf16 v[36:39], v[236:239], v[64:67], v[36:39]
    ds_read_b128 v[40:43], v2 offset:0
    s_add_u32 s32, s32, 1
    v_mfma_f32_16x16x32_bf16 v[36:39], v[252:255], v[68:71], v[36:39]
    s_add_u32 s33, s33, 116736
    s_add_u32 s34, s34, 36864
    v_mfma_f32_16x16x32_bf16 v[32:35], v[248:251], v[68:71], v[32:35]
    ds_read_b128 v[44:47], v2 offset:1024
    v_mfma_f32_16x16x32_bf16 v[32:35], v[232:235], v[64:67], v[32:35]
    s_cmp_ge_u32 s34, 147456
    s_cselect_b32 s38, 147456, 0
    s_sub_u32 s34, s34, s38
    v_mfma_f32_16x16x32_bf16 v[28:31], v[228:231], v[64:67], v[28:31]
    v_mfma_f32_16x16x32_bf16 v[28:31], v[244:247], v[68:71], v[28:31]
    v_mfma_f32_16x16x32_bf16 v[24:27], v[240:243], v[68:71], v[24:27]
    v_mfma_f32_16x16x32_bf16 v[24:27], v[224:227], v[64:67], v[24:27]
    s_cmp_ge_i32 s31, 63
    s_cbranch_scc1 L_exit
    s_cmp_eq_u32 s30, 1
    s_cbranch_scc1 Lffb_body01
    s_cmp_eq_u32 s30, 2
    s_cbranch_scc1 Lffb_body02
    s_cmp_eq_u32 s30, 3
    s_cbranch_scc1 Lffb_body03
    s_branch Lffb_body00
Lffb_v12:
    v_mfma_f32_16x16x32_bf16 v[24:27], a[240:243], v[68:71], v[24:27]
    v_mfma_f32_16x16x32_bf16 v[24:27], a[224:227], v[64:67], v[24:27]
    s_waitcnt lgkmcnt(0)
    v_mfma_f32_16x16x32_bf16 v[24:27], v[128:131], v[40:43], v[24:27]
    ds_read_b128 v[48:51], v3 offset:18432
    v_mfma_f32_16x16x32_bf16 v[24:27], v[144:147], v[44:47], v[24:27]
    v_mfma_f32_16x16x32_bf16 v[28:31], v[148:151], v[44:47], v[28:31]
    ds_read_b128 v[52:55], v3 offset:19456
    v_mfma_f32_16x16x32_bf16 v[28:31], v[132:135], v[40:43], v[28:31]
    v_mfma_f32_16x16x32_bf16 v[32:35], v[136:139], v[40:43], v[32:35]
    v_mfma_f32_16x16x32_bf16 v[32:35], v[152:155], v[44:47], v[32:35]
    v_mfma_f32_16x16x32_bf16 v[36:39], v[156:159], v[44:47], v[36:39]
    v_mfma_f32_16x16x32_bf16 v[36:39], v[140:143], v[40:43], v[36:39]
    s_waitcnt lgkmcnt(0)
    v_mfma_f32_16x16x32_bf16 v[36:39], v[172:175], v[48:51], v[36:39]
    ds_read_b128 v[56:59], v3 offset:20480
    v_mfma_f32_16x16x32_bf16 v[36:39], v[188:191], v[52:55], v[36:39]
    v_mfma_f32_16x16x32_bf16 v[32:35], v[184:187], v[52:55], v[32:35]
    ds_read_b128 v[60:63], v3 offset:21504
    v_mfma_f32_16x16x32_bf16 v[32:35], v[168:171], v[48:51], v[32:35]
    v_mfma_f32_16x16x32_bf16 v[28:31], v[164:167], v[48:51], v[28:31]
    v_mfma_f32_16x16x32_bf16 v[28:31], v[180:183], v[52:55], v[28:31]
    v_mfma_f32_16x16x32_bf16 v[24:27], v[176:179], v[52:55], v[24:27]
    v_mfma_f32_16x16x32_bf16 v[24:27], v[160:163], v[48:51], v[24:27]
    s_waitcnt lgkmcnt(0)
    v_mfma_f32_16x16x32_bf16 v[24:27], v[192:195], v[56:59], v[24:27]
    ds_read_b128 v[64:67], v3 offset:22528
    v_mfma_f32_16x16x32_bf16 v[24:27], v[208:211], v[60:63], v[24:27]
    v_mfma_f32_16x16x32_bf16 v[28:31], v[212:215], v[60:63], v[28:31]
    ds_read_b128 v[68:71], v3 offset:23552
    v_mfma_f32_16x16x32_bf16 v[28:31], v[196:199], v[56:59], v[28:31]
    buffer_load_dword v5, v4, s[4:7], s16 offen sc1
    v_mfma_f32_16x16x32_bf16 v[32:35], v[200:203], v[56:59], v[32:35]
    v_mfma_f32_16x16x32_bf16 v[32:35], v[216:219], v[60:63], v[32:35]
    v_mfma_f32_16x16x32_bf16 v[36:39], v[220:223], v[60:63], v[36:39]
    v_mfma_f32_16x16x32_bf16 v[36:39], v[204:207], v[56:59], v[36:39]
    s_waitcnt lgkmcnt(0)
    v_mfma_f32_16x16x32_bf16 v[36:39], v[236:239], v[64:67], v[36:39]
    v_mfma_f32_16x16x32_bf16 v[36:39], v[252:255], v[68:71], v[36:39]
    v_mfma_f32_16x16x32_bf16 v[32:35], v[248:251], v[68:71], v[32:35]
    v_mfma_f32_16x16x32_bf16 v[32:35], v[232:235], v[64:67], v[32:35]
    v_mfma_f32_16x16x32_bf16 v[28:31], v[228:231], v[64:67], v[28:31]
    v_mfma_f32_16x16x32_bf16 v[28:31], v[244:247], v[68:71], v[28:31]
    v_mfma_f32_16x16x32_bf16 v[24:27], v[240:243], v[68:71], v[24:27]
    v_mfma_f32_16x16x32_bf16 v[24:27], v[224:227], v[64:67], v[24:27]
    s_nop 7
    v_cvt_pk_bf16_f32 v72, v24, v25
    v_cvt_pk_bf16_f32 v73, v26, v27
    v_cvt_pk_bf16_f32 v74, v28, v29
    v_cvt_pk_bf16_f32 v75, v30, v31
    buffer_store_dwordx4 v[72:75], v1, s[12:15], s36 offen offset:0 sc1
    v_cvt_pk_bf16_f32 v76, v32, v33
    v_cvt_pk_bf16_f32 v77, v34, v35
    v_cvt_pk_bf16_f32 v78, v36, v37
    v_cvt_pk_bf16_f32 v79, v38, v39
    buffer_store_dwordx4 v[76:79], v1, s[12:15], s36 offen offset:1024 sc1
    s_add_u32 s54, s31, 1
    v_mov_b32 v6, s54
    s_waitcnt vmcnt(2)
    s_cmp_ge_i32 s31, 63
    s_cbranch_scc1 Lffb_late1
    v_cmp_gt_i32 vcc, s32, v5
    s_sub_u32 s43, s43, 1
    s_cmp_lt_i32 s43, 0
    s_cbranch_scc1 Lffb_rdy1
    s_and_b64 vcc, vcc, s[18:19]
    s_cbranch_scc0 Lffb_rdy1
Lffb_late1:
    buffer_load_dword v5, v4, s[4:7], s16 offen sc1
    s_waitcnt vmcnt(1)
    buffer_store_dword v6, v80, s[12:15], s17 offen sc1
    s_mov_b32 s14, 0
    s_cmp_ge_i32 s31, 63
    s_cbranch_scc1 L_exit
    s_waitcnt vmcnt(1)
    v_cmp_gt_i32 vcc, s32, v5
    s_sub_u32 s43, s43, 1
    s_cmp_lt_i32 s43, 0
    s_cbranch_scc1 Lffb_rdy1
    s_and_b64 vcc, vcc, s[18:19]
    s_cbranch_scc0 Lffb_rdy1
Lffb_spin1:
    buffer_load_dword v5, v4, s[4:7], s16 offen sc1
    s_waitcnt vmcnt(0)
    v_cmp_gt_i32 vcc, s32, v5
    s_sub_u32 s43, s43, 1
    s_cmp_lt_i32 s43, 0
    s_cbranch_scc1 Lffb_rdy1
    s_and_b64 vcc, vcc, s[18:19]
    s_cbranch_scc0 Lffb_rdy1
    s_sleep 8
    s_branch Lffb_spin1
Lffb_rdy1:
    s_add_u32 m0, s34, 0
    s_nop 0
    buffer_load_dwordx4 v1, s[8:11], s33 offen offset:0 sc1 lds
    buffer_load_dwordx4 v1, s[8:11], s33 offen offset:1024 sc1 lds
    buffer_load_dwordx4 v1, s[8:11], s33 offen offset:2048 sc1 lds
    s_add_u32 s16, s16, 8192
    buffer_load_dword v5, v4, s[4:7], s16 offen sc1
    s_add_u32 m0, s34, s3
    s_add_u32 s37, s33, s3
    buffer_load_dwordx4 v1, s[8:11], s37 offen offset:0 sc1 lds
    buffer_load_dwordx4 v1, s[8:11], s37 offen offset:1024 sc1 lds
    buffer_load_dwordx4 v1, s[8:11], s37 offen offset:2048 sc1 lds
    s_add_u32 s32, s32, 1
    s_add_u32 s33, s33, 116736
    s_add_u32 s34, s34, 36864
    s_cmp_ge_u32 s34, 147456
    s_cselect_b32 s38, 147456, 0
    s_sub_u32 s34, s34, s38
    s_waitcnt vmcnt(4)
    buffer_store_dword v6, v80, s[12:15], s17 offen sc1
Lffb_go1:
    s_mov_b32 s14, 0
    s_barrier
    ds_read_b128 v[40:43], v2 offset:0
    ds_read_b128 v[44:47], v2 offset:1024
    s_cmp_eq_u32 s30, 1
    s_cbranch_scc1 Lffb_body01
    s_cmp_eq_u32 s30, 2
    s_cbranch_scc1 Lffb_body02
    s_cmp_eq_u32 s30, 3
    s_cbranch_scc1 Lffb_body03
    s_branch Lffb_body00
L_exit:
L_end:
    s_endpgm
.section .rodata,"a"
.p2align 6
.amdhsa_kernel interleave_layers__sliding_local_dilated__dense_activation_squared_relu__prompt_kernel
  .amdhsa_next_free_vgpr 512
  .amdhsa_next_free_sgpr 102
  .amdhsa_accum_offset 256
  .amdhsa_group_segment_fixed_size 0
  .amdhsa_kernarg_size 88
  .amdhsa_user_sgpr_count 2
  .amdhsa_user_sgpr_kernarg_segment_ptr 1
  .amdhsa_system_sgpr_workgroup_id_x 1
.end_amdhsa_kernel
```

```asm
; @launch grid=(256,1,1) block=(256,1,1) lds=163840
.amdgcn_target "amdgcn-amd-amdhsa--gfx950"
.text
.globl interleave_layers__sliding_local_dilated__dense_activation_squared_relu__prompt_kernel
.p2align 8
.type interleave_layers__sliding_local_dilated__dense_activation_squared_relu__prompt_kernel,@function
interleave_layers__sliding_local_dilated__dense_activation_squared_relu__prompt_kernel:
    s_load_dwordx16 s[64:79], s[0:1], 0x0
    s_load_dwordx4 s[80:83], s[0:1], 0x40
    s_load_dwordx2 s[84:85], s[0:1], 0x50
    s_cmp_ge_u32 s2, 256
    s_cbranch_scc1 L_end
    v_lshrrev_b32 v1, 6, v0
    s_nop 0
    v_readfirstlane_b32 s30, v1
    v_and_b32 v0, 63, v0
    v_lshlrev_b32 v1, 4, v0
    s_lshr_b32 s38, s2, 4
    s_cmp_lg_u32 s38, 15
    s_cbranch_scc1 L_nocp
    s_getpc_b64 s[24:25]
L_pc0:
    s_sub_u32 s24, s24, L_pc0-interleave_layers__sliding_local_dilated__dense_activation_squared_relu__prompt_kernel
    s_subb_u32 s25, s25, 0
    s_mov_b32 s26, L_end-interleave_layers__sliding_local_dilated__dense_activation_squared_relu__prompt_kernel
    s_mov_b32 s27, 0x00020000
    s_bfe_u32 s38, s2, 0x10003
    s_mul_i32 s37, s38, 0x200
    s_mul_i32 s53, s30, 0x80
    s_add_u32 s37, s37, s53
    v_lshlrev_b32 v12, 10, v0
    buffer_load_dword v52, v12, s[24:27], s37 offen
    s_add_u32 s37, s37, 65536
    buffer_load_dword v53, v12, s[24:27], s37 offen
    s_add_u32 s37, s37, 65536
    buffer_load_dword v54, v12, s[24:27], s37 offen
    s_add_u32 s37, s37, 65536
L_nocp:
    s_lshr_b32 s89, s2, 3
    s_and_b32 s99, s2, 3
    s_bfe_u32 s99, s2, 0x20001
    s_and_b32 s37, s2, 7
    s_cmp_lg_u32 s37, 0
    s_cbranch_scc1 L_x1
    s_mov_b32 s4, 0xc0804000
    s_mov_b32 s5, 0xc1814101
    s_mov_b32 s6, 0xc2824202
    s_mov_b32 s7, 0xc3834303
    s_mov_b32 s8, 0xecac6c2c
    s_mov_b32 s9, 0xedad6d2d
    s_mov_b32 s10, 0xeeae6e2e
    s_mov_b32 s11, 0xefaf6f2f
    s_branch L_xt
L_x1:
    s_cmp_lg_u32 s37, 1
    s_cbranch_scc1 L_x2
    s_mov_b32 s4, 0x99199818
    s_mov_b32 s5, 0x9b1b9a1a
    s_mov_b32 s6, 0x9d1d9c1c
    s_mov_b32 s7, 0x9f1f9e1e
    s_mov_b32 s8, 0xab2aa020
    s_mov_b32 s9, 0xd151d050
    s_mov_b32 s10, 0xd353d252
    s_mov_b32 s11, 0xfd7dfc7c
    s_branch L_xt
L_x2:
    s_cmp_lg_u32 s37, 2
    s_cbranch_scc1 L_x3
    s_mov_b32 s4, 0xc4844404
    s_mov_b32 s5, 0xc5854505
    s_mov_b32 s6, 0xc6864606
    s_mov_b32 s7, 0xc7874707
    s_mov_b32 s8, 0xf0b07030
    s_mov_b32 s9, 0xf1b17131
    s_mov_b32 s10, 0xf2b27232
    s_mov_b32 s11, 0xf3b37333
    s_branch L_xt
L_x3:
    s_cmp_lg_u32 s37, 3
    s_cbranch_scc1 L_x4
    s_mov_b32 s4, 0xa222a121
    s_mov_b32 s5, 0xa424a323
    s_mov_b32 s6, 0xa626a525
    s_mov_b32 s7, 0xa828a727
    s_mov_b32 s8, 0xaa2ba929
    s_mov_b32 s9, 0xd555d454
    s_mov_b32 s10, 0xd757d656
    s_mov_b32 s11, 0xff7ffe7e
    s_branch L_xt
L_x4:
    s_cmp_lg_u32 s37, 4
    s_cbranch_scc1 L_x5
    s_mov_b32 s4, 0xc8884808
    s_mov_b32 s5, 0xc9894909
    s_mov_b32 s6, 0xca8a4a0a
    s_mov_b32 s7, 0xcb8b4b0b
    s_mov_b32 s8, 0xf4b47434
    s_mov_b32 s9, 0xf5b57535
    s_mov_b32 s10, 0xf6b67636
    s_mov_b32 s11, 0xf7b77737
    s_branch L_xt
L_x5:
    s_cmp_lg_u32 s37, 5
    s_cbranch_scc1 L_x6
    s_mov_b32 s4, 0xd959d858
    s_mov_b32 s5, 0xdb5bda5a
    s_mov_b32 s6, 0xdd5ddc5c
    s_mov_b32 s7, 0xdf5fde5e
    s_mov_b32 s8, 0xeb6ae060
    s_mov_b32 s9, 0x91119010
    s_mov_b32 s10, 0x93139212
    s_mov_b32 s11, 0xbd3dbc3c
    s_branch L_xt
L_x6:
    s_cmp_lg_u32 s37, 6
    s_cbranch_scc1 L_x7
    s_mov_b32 s4, 0xcc8c4c0c
    s_mov_b32 s5, 0xcd8d4d0d
    s_mov_b32 s6, 0xce8e4e0e
    s_mov_b32 s7, 0xcf8f4f0f
    s_mov_b32 s8, 0xf8b87838
    s_mov_b32 s9, 0xf9b97939
    s_mov_b32 s10, 0xfaba7a3a
    s_mov_b32 s11, 0xfbbb7b3b
    s_branch L_xt
L_x7:
    s_mov_b32 s4, 0xe262e161
    s_mov_b32 s5, 0xe464e363
    s_mov_b32 s6, 0xe666e565
    s_mov_b32 s7, 0xe868e767
    s_mov_b32 s8, 0xea6be969
    s_mov_b32 s9, 0x95159414
    s_mov_b32 s10, 0x97179616
    s_mov_b32 s11, 0xbf3fbe3e
L_xt:
    s_bitcmp1_b32 s89, 4
    s_cselect_b64 s[4:5], s[8:9], s[4:5]
    s_cselect_b64 s[6:7], s[10:11], s[6:7]
    s_bitcmp1_b32 s89, 3
    s_cselect_b64 s[4:5], s[6:7], s[4:5]
    s_lshl_b32 s37, s89, 3
    s_lshr_b64 s[4:5], s[4:5], s37
    s_and_b32 s29, s4, 63
    s_bfe_u32 s28, s4, 0x20006
    s_bitcmp1_b32 s2, 0
    s_cselect_b32 s39, 128, 0
    s_lshr_b32 s37, s89, 2
    s_and_b32 s38, s89, 3
    s_mul_i32 s2, s37, 0x10
    s_mul_i32 s53, s99, 0x4
    s_add_u32 s2, s2, s53
    s_mul_i32 s53, s38, 0x1
    s_add_u32 s2, s2, s53
    s_mul_i32 s53, s39, 0x1
    s_add_u32 s2, s2, s53
    s_mov_b32 s43, 0x40000
    s_mov_b32 s55, 0
    s_waitcnt lgkmcnt(0)
    s_mov_b32 s4, s84
    s_mov_b32 s5, s85
    s_mov_b32 s6, 0x6200000
    s_mov_b32 s7, 0x00020000
    s_mov_b32 s8, s84
    s_mov_b32 s9, s85
    s_mov_b32 s10, 0x6200000
    s_mov_b32 s11, 0x00020000
    s_cmp_lt_u32 s29, 16
    s_cbranch_scc1 Lqkv_start
    s_cmp_ge_u32 s2, 128
    s_cbranch_scc1 L_prep
    s_cmp_ge_u32 s2, 112
    s_cbranch_scc1 L_touch
    s_bfe_u32 s33, s2, 0x20002
    s_xor_b32 s33, s33, 1
    s_bfe_u32 s34, s2, 0x20004
    s_and_b32 s35, s2, 3
    s_mov_b32 s24, s64
    s_mov_b32 s25, s65
    s_mov_b32 s26, 0x400000
    s_mov_b32 s27, 0x00020000
    v_bfe_u32 v8, v0, 4, 1
    v_lshlrev_b32 v8, 5, v8
    v_lshrrev_b32 v10, 5, v0
    v_lshl_add_u32 v8, v10, 4, v8
    v_and_b32 v10, 15, v0
    v_lshl_add_u32 v8, v10, 11, v8
    s_mul_i32 s37, s33, 0x100000
    s_mul_i32 s53, s34, 0xffff8000
    s_add_u32 s37, s37, s53
    s_mul_i32 s53, s35, 0x200
    s_add_u32 s37, s37, s53
    s_mul_i32 s53, s30, 0x80
    s_add_u32 s37, s37, s53
    s_add_u32 s37, s37, 0xf8000
    buffer_load_dwordx4 v[16:19], v8, s[24:27], s37 offen offset:0
    buffer_load_dwordx4 v[20:23], v8, s[24:27], s37 offen offset:64
    v_mov_b32 v56, 0x3f803f80
    v_mov_b32 v57, 0x3f803f80
    v_mov_b32 v58, 0x3f803f80
    v_mov_b32 v59, 0x3f803f80
    s_mov_b32 s44, 0xaaaaaaaa
    s_mov_b32 s45, 0xaaaaaaaa
    s_mov_b32 s46, 0xcccccccc
    s_mov_b32 s47, 0xcccccccc
    s_mov_b32 s38, 0xf0000f
    s_mov_b32 s39, 0xf0000f00
    v_and_b32 v10, 15, v0
    v_lshlrev_b32 v10, 3, v10
    v_mov_b32 v9, 0x40000000
    v_cndmask_b32 v9, v9, v10, s[38:39]
    s_mul_i32 s36, s33, 0x220000
    s_mul_i32 s53, s34, 0x8800
    s_add_u32 s36, s36, s53
    s_mul_i32 s53, s35, 0x2000
    s_add_u32 s36, s36, s53
    s_mul_i32 s53, s30, 0x800
    s_add_u32 s36, s36, s53
    s_mul_i32 s40, s33, 0x220000
    s_mul_i32 s53, s34, 0x8800
    s_add_u32 s40, s40, s53
    s_mul_i32 s53, s35, 0x200
    s_add_u32 s40, s40, s53
    s_mul_i32 s53, s30, 0x80
    s_add_u32 s40, s40, s53
    s_add_u32 s40, s40, 0x8000
    s_mov_b32 s24, s66
    s_mov_b32 s25, s67
    s_mov_b32 s26, 0x600000
    s_mov_b32 s27, 0x00020000
    v_min_u32 v12, 59, v0
    v_lshrrev_b32 v14, 2, v12
    v_lshlrev_b32 v14, 11, v14
    v_and_b32 v12, 3, v12
    v_lshl_add_u32 v12, v12, 7, v14
    s_mul_i32 s37, s89, 0x1e000
    s_mul_i32 s53, s30, 0x7800
    s_add_u32 s37, s37, s53
    s_mul_i32 s53, s99, 0x200
    s_add_u32 s37, s37, s53
    s_add_u32 s37, s37, 0xffe80000
    buffer_load_dword v13, v12, s[24:27], s37 offen
    s_mul_i32 s37, s89, 0x1e000
    s_mul_i32 s53, s30, 0x7800
    s_add_u32 s37, s37, s53
    s_mul_i32 s53, s99, 0x200
    s_add_u32 s37, s37, s53
    s_add_u32 s37, s37, 0x60000
    buffer_load_dword v14, v12, s[24:27], s37 offen
    s_waitcnt vmcnt(2)
    v_permlane16_swap_b32 v16, v18
    v_permlane16_swap_b32 v17, v19
    buffer_store_dwordx4 v[16:19], v1, s[4:7], s36 offen offset:0 sc1
    v_permlane16_swap_b32 v20, v22
    v_permlane16_swap_b32 v21, v23
    buffer_store_dwordx4 v[20:23], v1, s[4:7], s36 offen offset:1024 sc1
    v_mfma_f32_16x16x32_bf16 v[68:71], v[16:19], v[16:19], 0
    v_mfma_f32_16x16x32_bf16 v[64:67], v[56:59], v[16:19], 0
    v_mfma_f32_16x16x32_bf16 v[68:71], v[20:23], v[20:23], v[68:71]
    v_mfma_f32_16x16x32_bf16 v[64:67], v[56:59], v[20:23], v[64:67]
    s_nop 6
    v_cndmask_b32 v68, v68, v69, s[44:45]
    v_cndmask_b32 v70, v70, v71, s[44:45]
    v_cndmask_b32 v65, v68, v70, s[46:47]
    buffer_store_dwordx2 v[64:65], v9, s[4:7], s40 offen offset:0 sc1
    s_mov_b32 s24, s66
    s_mov_b32 s25, s67
    s_mov_b32 s26, 0x600000
    s_mov_b32 s27, 0x00020000
    v_min_u32 v12, 59, v0
    v_lshrrev_b32 v14, 2, v12
    v_lshlrev_b32 v14, 11, v14
    v_and_b32 v12, 3, v12
    v_lshl_add_u32 v12, v12, 7, v14
    s_mul_i32 s37, s89, 0x1e000
    s_mul_i32 s53, s30, 0x7800
    s_add_u32 s37, s37, s53
    s_mul_i32 s53, s99, 0x200
    s_add_u32 s37, s37, s53
    s_add_u32 s37, s37, 0x240000
    buffer_load_dword v15, v12, s[24:27], s37 offen
    s_waitcnt vmcnt(1)
    s_barrier
    s_mov_b32 s20, s82
    s_mov_b32 s21, s83
    s_mov_b32 s22, 0x100
    s_mov_b32 s23, 0x00020000
    s_cmp_eq_u32 s30, 0
    s_cselect_b32 s22, 256, 0
    s_mul_i32 s37, s33, 0x40
    s_add_u32 s37, s37, 0x4
    v_mov_b32 v6, 1
    v_lshlrev_b32 v5, 8, v0
    buffer_atomic_add v6, v5, s[20:23], s37 offen
    s_branch L_p2
L_touch:
    s_mov_b32 s24, s66
    s_mov_b32 s25, s67
    s_mov_b32 s26, 0x600000
    s_mov_b32 s27, 0x00020000
    v_min_u32 v12, 59, v0
    v_lshrrev_b32 v14, 2, v12
    v_lshlrev_b32 v14, 11, v14
    v_and_b32 v12, 3, v12
    v_lshl_add_u32 v12, v12, 7, v14
    s_mul_i32 s37, s89, 0x1e000
    s_mul_i32 s53, s30, 0x7800
    s_add_u32 s37, s37, s53
    s_mul_i32 s53, s99, 0x200
    s_add_u32 s37, s37, s53
    s_add_u32 s37, s37, 0xffe80000
    buffer_load_dword v13, v12, s[24:27], s37 offen
    s_mul_i32 s37, s89, 0x1e000
    s_mul_i32 s53, s30, 0x7800
    s_add_u32 s37, s37, s53
    s_mul_i32 s53, s99, 0x200
    s_add_u32 s37, s37, s53
    s_add_u32 s37, s37, 0x60000
    buffer_load_dword v14, v12, s[24:27], s37 offen
    s_mul_i32 s37, s89, 0x1e000
    s_mul_i32 s53, s30, 0x7800
    s_add_u32 s37, s37, s53
    s_mul_i32 s53, s99, 0x200
    s_add_u32 s37, s37, s53
    s_add_u32 s37, s37, 0x240000
    buffer_load_dword v15, v12, s[24:27], s37 offen
    s_waitcnt vmcnt(0)
    s_branch L_noprep
L_prep:
    s_bfe_u32 s33, s2, 0x20002
    s_xor_b32 s33, s33, 1
    s_bfe_u32 s34, s2, 0x30004
    s_lshl_b32 s34, s34, 2
    s_and_b32 s37, s2, 3
    s_add_u32 s34, s34, s37
    s_mul_i32 s37, s33, 0x80000
    s_mul_i32 s53, s34, 0x2000
    s_add_u32 s37, s37, s53
    s_mul_i32 s53, s30, 0x800
    s_add_u32 s37, s37, s53
    s_add_u32 s37, s37, 0x6000000
    s_add_u32 s38, s37, 262144
    v_mov_b32 v60, 0
    v_mov_b32 v61, 0
    v_mov_b32 v62, 0
    v_mov_b32 v63, 0
    buffer_store_dwordx4 v[60:63], v1, s[4:7], s37 offen offset:0 sc1
    buffer_store_dwordx4 v[60:63], v1, s[4:7], s37 offen offset:1024 sc1
    buffer_store_dwordx4 v[60:63], v1, s[4:7], s38 offen offset:0 sc1
    buffer_store_dwordx4 v[60:63], v1, s[4:7], s38 offen offset:1024 sc1
    s_mov_b32 s24, s64
    s_mov_b32 s25, s65
    s_mov_b32 s26, 0x400000
    s_mov_b32 s27, 0x00020000
    v_bfe_u32 v8, v0, 4, 1
    v_lshlrev_b32 v8, 5, v8
    v_lshrrev_b32 v10, 5, v0
    v_lshl_add_u32 v8, v10, 4, v8
    v_and_b32 v10, 15, v0
    v_lshl_add_u32 v8, v10, 11, v8
    s_mul_i32 s37, s33, 0x100000
    s_mul_i32 s53, s34, 0xffff8000
    s_add_u32 s37, s37, s53
    s_mul_i32 s53, s30, 0x200
    s_add_u32 s37, s37, s53
    s_add_u32 s37, s37, 0xf8000
    buffer_load_dwordx4 v[16:19], v8, s[24:27], s37 offen offset:0
    buffer_load_dwordx4 v[20:23], v8, s[24:27], s37 offen offset:64
    buffer_load_dwordx4 v[24:27], v8, s[24:27], s37 offen offset:128
    buffer_load_dwordx4 v[28:31], v8, s[24:27], s37 offen offset:192
    buffer_load_dwordx4 v[32:35], v8, s[24:27], s37 offen offset:256
    buffer_load_dwordx4 v[36:39], v8, s[24:27], s37 offen offset:320
    buffer_load_dwordx4 v[40:43], v8, s[24:27], s37 offen offset:384
    buffer_load_dwordx4 v[44:47], v8, s[24:27], s37 offen offset:448
    s_mov_b32 s24, s66
    s_mov_b32 s25, s67
    s_mov_b32 s26, 0x600000
    s_mov_b32 s27, 0x00020000
    v_min_u32 v12, 59, v0
    v_lshrrev_b32 v14, 2, v12
    v_lshlrev_b32 v14, 11, v14
    v_and_b32 v12, 3, v12
    v_lshl_add_u32 v12, v12, 7, v14
    v_mov_b32 v56, 0x3f803f80
    v_mov_b32 v57, 0x3f803f80
    v_mov_b32 v58, 0x3f803f80
    v_mov_b32 v59, 0x3f803f80
    s_mov_b32 s44, 0xaaaaaaaa
    s_mov_b32 s45, 0xaaaaaaaa
    s_mov_b32 s46, 0xcccccccc
    s_mov_b32 s47, 0xcccccccc
    s_mov_b32 s38, 0xf0000f
    s_mov_b32 s39, 0xf0000f00
    v_and_b32 v10, 15, v0
    v_lshlrev_b32 v10, 3, v10
    v_mov_b32 v9, 0x40000000
    v_cndmask_b32 v9, v9, v10, s[38:39]
    s_mul_i32 s36, s33, 0x220000
    s_mul_i32 s53, s34, 0x8800
    s_add_u32 s36, s36, s53
    s_mul_i32 s53, s30, 0x2000
    s_add_u32 s36, s36, s53
    s_add_u32 s42, s36, 4096
    s_mul_i32 s40, s33, 0x220000
    s_mul_i32 s53, s34, 0x8800
    s_add_u32 s40, s40, s53
    s_mul_i32 s53, s30, 0x200
    s_add_u32 s40, s40, s53
    s_add_u32 s40, s40, 0x8000
    s_mul_i32 s17, s33, 0x80000
    s_mul_i32 s53, s34, 0x2000
    s_add_u32 s17, s17, s53
    s_mul_i32 s53, s30, 0x80
    s_add_u32 s17, s17, s53
    s_add_u32 s17, s17, 0x6041e00
    s_waitcnt vmcnt(8)
    s_barrier
    s_mov_b32 s20, s82
    s_mov_b32 s21, s83
    s_mov_b32 s22, 0x100
    s_mov_b32 s23, 0x00020000
    s_cmp_eq_u32 s30, 0
    s_cselect_b32 s22, 256, 0
    s_and_b32 s37, s2, 15
    s_lshl_b32 s37, s37, 4
    v_mov_b32 v6, 1
    v_lshlrev_b32 v5, 8, v0
    buffer_atomic_add v6, v5, s[20:23], s37 offen
    s_cmp_lt_u32 s34, 3
    s_cselect_b32 s10, 0, s10
    s_waitcnt vmcnt(1)
    v_permlane16_swap_b32 v16, v18
    v_permlane16_swap_b32 v17, v19
    buffer_store_dwordx4 v[16:19], v1, s[8:11], s36 offen offset:0 sc1
    v_permlane16_swap_b32 v20, v22
    v_permlane16_swap_b32 v21, v23
    buffer_store_dwordx4 v[20:23], v1, s[8:11], s36 offen offset:1024 sc1
    v_permlane16_swap_b32 v24, v26
    v_permlane16_swap_b32 v25, v27
    buffer_store_dwordx4 v[24:27], v1, s[8:11], s36 offen offset:2048 sc1
    v_permlane16_swap_b32 v28, v30
    v_permlane16_swap_b32 v29, v31
    buffer_store_dwordx4 v[28:31], v1, s[8:11], s36 offen offset:3072 sc1
    v_permlane16_swap_b32 v32, v34
    v_permlane16_swap_b32 v33, v35
    buffer_store_dwordx4 v[32:35], v1, s[8:11], s42 offen offset:0 sc1
    v_permlane16_swap_b32 v36, v38
    v_permlane16_swap_b32 v37, v39
    buffer_store_dwordx4 v[36:39], v1, s[8:11], s42 offen offset:1024 sc1
    v_permlane16_swap_b32 v40, v42
    v_permlane16_swap_b32 v41, v43
    buffer_store_dwordx4 v[40:43], v1, s[8:11], s42 offen offset:2048 sc1
    v_permlane16_swap_b32 v44, v46
    v_permlane16_swap_b32 v45, v47
    buffer_store_dwordx4 v[44:47], v1, s[8:11], s42 offen offset:3072 sc1
    v_mfma_f32_16x16x32_bf16 v[68:71], v[16:19], v[16:19], 0
    v_mfma_f32_16x16x32_bf16 v[76:79], v[24:27], v[24:27], 0
    v_mfma_f32_16x16x32_bf16 v[84:87], v[32:35], v[32:35], 0
    v_mfma_f32_16x16x32_bf16 v[92:95], v[40:43], v[40:43], 0
    v_mfma_f32_16x16x32_bf16 v[64:67], v[56:59], v[16:19], 0
    v_mfma_f32_16x16x32_bf16 v[72:75], v[56:59], v[24:27], 0
    v_mfma_f32_16x16x32_bf16 v[80:83], v[56:59], v[32:35], 0
    v_mfma_f32_16x16x32_bf16 v[88:91], v[56:59], v[40:43], 0
    v_mfma_f32_16x16x32_bf16 v[68:71], v[20:23], v[20:23], v[68:71]
    v_mfma_f32_16x16x32_bf16 v[76:79], v[28:31], v[28:31], v[76:79]
    v_mfma_f32_16x16x32_bf16 v[84:87], v[36:39], v[36:39], v[84:87]
    v_mfma_f32_16x16x32_bf16 v[92:95], v[44:47], v[44:47], v[92:95]
    v_mfma_f32_16x16x32_bf16 v[64:67], v[56:59], v[20:23], v[64:67]
    v_mfma_f32_16x16x32_bf16 v[72:75], v[56:59], v[28:31], v[72:75]
    v_mfma_f32_16x16x32_bf16 v[80:83], v[56:59], v[36:39], v[80:83]
    v_mfma_f32_16x16x32_bf16 v[88:91], v[56:59], v[44:47], v[88:91]
    s_nop 0
    v_cndmask_b32 v68, v68, v69, s[44:45]
    v_cndmask_b32 v76, v76, v77, s[44:45]
    v_cndmask_b32 v84, v84, v85, s[44:45]
    v_cndmask_b32 v92, v92, v93, s[44:45]
    v_cndmask_b32 v70, v70, v71, s[44:45]
    v_cndmask_b32 v78, v78, v79, s[44:45]
    v_cndmask_b32 v86, v86, v87, s[44:45]
    v_cndmask_b32 v94, v94, v95, s[44:45]
    v_cndmask_b32 v65, v68, v70, s[46:47]
    v_cndmask_b32 v73, v76, v78, s[46:47]
    v_cndmask_b32 v81, v84, v86, s[46:47]
    v_cndmask_b32 v89, v92, v94, s[46:47]
    buffer_store_dwordx2 v[64:65], v9, s[8:11], s40 offen offset:0 sc1
    buffer_store_dwordx2 v[72:73], v9, s[8:11], s40 offen offset:128 sc1
    buffer_store_dwordx2 v[80:81], v9, s[8:11], s40 offen offset:256 sc1
    buffer_store_dwordx2 v[88:89], v9, s[8:11], s40 offen offset:384 sc1
    v_and_b32 v10, 3, v0
    v_lshlrev_b32 v10, 5, v10
    s_waitcnt vmcnt(0)
    s_mov_b64 exec, 15
    buffer_store_dword v6, v10, s[4:7], s17 offen sc1
    s_mov_b64 exec, -1
    s_mov_b32 s10, s6
L_p2:
    s_waitcnt vmcnt(1)
L_noprep:
    s_cmp_lt_u32 s29, 24
    s_cbranch_scc1 Lwo_start
    s_cmp_lt_u32 s29, 43
    s_cbranch_scc1 Lffa_start
    s_cmp_lt_u32 s29, 44
    s_cbranch_scc1 L_end
    s_cmp_lt_u32 s29, 60
    s_cbranch_scc1 Lffb_start
    s_branch Lred_start
Lqkv_start:
    s_mov_b32 s12, s66
    s_mov_b32 s13, s67
    s_mov_b32 s14, 0x600000
    s_mov_b32 s15, 0x00020000
    v_lshrrev_b32 v24, 3, v0
    v_mul_u32_u24 v24, 6144, v24
    v_bfe_u32 v25, v0, 4, 2
    v_lshlrev_b32 v25, 1, v25
    v_and_b32 v26, 7, v0
    v_xor_b32 v25, v25, v26
    v_lshl_add_u32 v40, v25, 4, v24
    v_add_u32 v41, 48128, v40
    s_mul_i32 s86, s29, 0x80
    s_mul_i32 s37, s30, 98304
    s_add_u32 s86, s86, s37
    s_lshl_b32 s87, s30, 11
    s_add_u32 m0, s87, 73728
    s_add_u32 s37, s86, 0
    buffer_load_dwordx4 v40, s[12:15], s37 offen offset:0 lds
    buffer_load_dwordx4 v41, s[12:15], s37 offen offset:1024 lds
    s_add_u32 m0, s87, 81920
    s_add_u32 s37, s86, 2048
    buffer_load_dwordx4 v40, s[12:15], s37 offen offset:0 lds
    buffer_load_dwordx4 v41, s[12:15], s37 offen offset:1024 lds
    s_add_u32 m0, s87, 90112
    s_add_u32 s37, s86, 4096
    buffer_load_dwordx4 v40, s[12:15], s37 offen offset:0 lds
    buffer_load_dwordx4 v41, s[12:15], s37 offen offset:1024 lds
    s_add_u32 m0, s87, 98304
    s_add_u32 s37, s86, 393216
    buffer_load_dwordx4 v40, s[12:15], s37 offen offset:0 lds
    buffer_load_dwordx4 v41, s[12:15], s37 offen offset:1024 lds
    s_add_u32 m0, s87, 106496
    s_add_u32 s37, s86, 395264
    buffer_load_dwordx4 v40, s[12:15], s37 offen offset:0 lds
    buffer_load_dwordx4 v41, s[12:15], s37 offen offset:1024 lds
    s_add_u32 m0, s87, 114688
    s_add_u32 s37, s86, 397312
    buffer_load_dwordx4 v40, s[12:15], s37 offen offset:0 lds
    buffer_load_dwordx4 v41, s[12:15], s37 offen offset:1024 lds
    v_bfe_u32 v24, v0, 3, 2
    v_and_b32 v25, 3, v0
    v_lshlrev_b32 v25, 3, v25
    v_lshrrev_b32 v26, 2, v0
    v_lshl_add_u32 v26, v26, 7, v25
    v_lshrrev_b32 v27, 5, v0
    v_lshl_add_u32 v27, v27, 10, v26
    s_mov_b32 s37, 0
    s_mov_b32 s38, s30
    s_lshl_b32 s37, s37, 13
    v_xor_b32 v28, s38, v24
    v_lshl_add_u32 v28, v28, 5, s37
    v_add_u32 v42, v28, v26
    v_add_u32 v46, v28, v27
    s_mov_b32 s37, 1
    s_mov_b32 s38, s30
    s_lshl_b32 s37, s37, 13
    v_xor_b32 v28, s38, v24
    v_lshl_add_u32 v28, v28, 5, s37
    v_add_u32 v43, v28, v26
    v_add_u32 v47, v28, v27
    s_mov_b32 s37, 2
    s_mov_b32 s38, s30
    s_lshl_b32 s37, s37, 13
    v_xor_b32 v28, s38, v24
    v_lshl_add_u32 v28, v28, 5, s37
    v_add_u32 v44, v28, v26
    v_add_u32 v48, v28, v27
    v_mov_b32 v28, 0x3f803f80
    v_mov_b32 v29, 0x3f803f80
    v_mov_b32 v30, 0x3f803f80
    v_mov_b32 v31, 0x3f803f80
    s_mul_i32 s37, s28, 0x80000
    s_add_u32 s37, s37, 0x6001e00
    v_min_u32 v4, 15, v0
    v_lshl_add_u32 v4, v4, 5, s37
    s_mul_i32 s37, s28, 0x80000
    s_mul_i32 s53, s29, 0x80
    s_add_u32 s37, s37, s53
    s_mul_i32 s53, s30, 0x20
    s_add_u32 s37, s37, s53
    s_add_u32 s37, s37, 0x5f80000
    v_mov_b32 v8, s37
    s_cmp_eq_u32 s28, 0
    s_cselect_b32 s37, 64, 16
    v_cmp_le_u32 vcc, s37, v0
    s_nop 1
    v_cndmask_b32 v4, v4, v8, vcc
    s_mul_i32 s33, s28, 0x220000
    s_lshr_b32 s38, s30, 1
    s_mul_i32 s36, s28, 0x200000
    s_mul_i32 s53, s29, 0x800
    s_add_u32 s36, s36, s53
    s_mul_i32 s53, s38, 0x400
    s_add_u32 s36, s36, s53
    s_add_u32 s36, s36, 0x9f0000
    s_and_b32 s38, s30, 1
    v_lshrrev_b32 v8, 5, v0
    v_cmp_eq_u32 vcc, s38, v8
    v_add_u32 v8, 0, v1
    v_mov_b32 v7, 0x40000000
    v_cndmask_b32 v7, v7, v8, vcc
    s_mul_i32 s40, s28, 0x10000
    s_mul_i32 s53, s29, 0x1000
    s_add_u32 s40, s40, s53
    s_mul_i32 s53, s30, 0x400
    s_add_u32 s40, s40, s53
    s_add_u32 s40, s40, 0x1c00000
    s_sub_u32 s41, s40, 327680
    s_mov_b32 s24, s84
    s_mov_b32 s25, s85
    s_mov_b32 s26, 0x6200000
    s_mov_b32 s27, 0x00020000
    s_cmp_eq_u32 s28, 0
    s_cselect_b32 s26, 0, s26
    s_cselect_b32 s42, 0xf149f2ca, 0
    v_mov_b32 v86, 0
    v_mov_b32 v87, 0
    v_mov_b32 v90, 0
    v_mov_b32 v91, 0
    s_lshl_b32 s37, s30, 9
    s_add_u32 s38, s37, 147456
    v_lshl_add_u32 v36, v0, 3, s38
    v_xor_b32 v37, 512, v36
    v_add_u32 v39, 4096, v36
    s_add_u32 s38, s37, 151552
    v_and_b32 v8, 15, v0
    v_lshl_add_u32 v8, v8, 5, s38
    v_lshrrev_b32 v9, 4, v0
    v_lshl_add_u32 v38, v9, 3, v8
    s_mov_b32 s44, 0xaaaaaaaa
    s_mov_b32 s45, 0xaaaaaaaa
    s_mov_b32 s48, 0xfff0ffff
    s_mov_b32 s49, 0xf000ff00
    s_mov_b32 s50, 0xffc0fffc
    s_mov_b32 s51, 0xc000fc00
    s_mov_b32 s52, 0x3e8293ee
    v_mov_b32 v10, 0x0c0c0c0c
    v_mov_b32 v8, 0xc0c0100
    v_mov_b32 v9, 0x1000c0c
    v_cndmask_b32 v8, v8, v9, s[44:45]
    v_cndmask_b32 v102, v8, v10, s[48:49]
    v_cndmask_b32 v104, v10, v8, s[48:49]
    v_mov_b32 v8, 0xc0c0302
    v_mov_b32 v9, 0x3020c0c
    v_cndmask_b32 v8, v8, v9, s[44:45]
    v_cndmask_b32 v103, v8, v10, s[50:51]
    v_cndmask_b32 v105, v10, v8, s[50:51]
    s_mov_b32 s31, -1
    s_mov_b32 s35, 0
    s_mov_b32 s16, 0
    v_mov_b32 v5, 0
    s_mul_i32 s17, s28, 0x80000
    s_mul_i32 s53, s29, 0x80
    s_add_u32 s17, s17, s53
    s_mul_i32 s53, s30, 0x20
    s_add_u32 s17, s17, s53
    s_add_u32 s17, s17, 0x5ffa000
    v_cmp_eq_u32 vcc, 0, v0
    v_mov_b32 v21, 0x40000000
    s_nop 0
    v_cndmask_b32 v21, v21, v0, vcc
    v_mov_b32 v2, v1
    s_mul_i32 s34, s30, 9216
    s_min_u32 s34, s34, 25600
    s_add_u32 s33, s33, s34
    v_lshlrev_b32 v20, 3, v0
    s_mov_b64 s[18:19], 0x1ffff
    v_mov_b32 v8, 0x40000000
    v_cndmask_b32 v4, v8, v4, s[18:19]
    v_add_u32 v12, 73728, v42
    v_add_u32 v13, 73728, v43
    v_add_u32 v14, 73728, v44
    s_waitcnt vmcnt(6) lgkmcnt(0)
    s_barrier
    s_add_u32 m0, s87, 122880
    s_add_u32 s37, s86, 786432
    buffer_load_dwordx4 v40, s[12:15], s37 offen offset:0 lds
    ds_read_b64_tr_b16 a[0:1], v12 offset:0
    ds_read_b64_tr_b16 a[2:3], v12 offset:2048
    ds_read_b64_tr_b16 a[4:5], v13 offset:0
    buffer_load_dwordx4 v41, s[12:15], s37 offen offset:1024 lds
    ds_read_b64_tr_b16 a[6:7], v13 offset:2048
    ds_read_b64_tr_b16 a[8:9], v14 offset:0
    ds_read_b64_tr_b16 a[10:11], v14 offset:2048
    s_add_u32 m0, s87, 131072
    s_add_u32 s37, s86, 788480
    buffer_load_dwordx4 v40, s[12:15], s37 offen offset:0 lds
    ds_read_b64_tr_b16 a[12:13], v12 offset:4096
    ds_read_b64_tr_b16 a[14:15], v12 offset:6144
    ds_read_b64_tr_b16 a[16:17], v13 offset:4096
    buffer_load_dwordx4 v41, s[12:15], s37 offen offset:1024 lds
    ds_read_b64_tr_b16 a[18:19], v13 offset:6144
    ds_read_b64_tr_b16 a[20:21], v14 offset:4096
    ds_read_b64_tr_b16 a[22:23], v14 offset:6144
    s_add_u32 m0, s87, 139264
    s_add_u32 s37, s86, 790528
    buffer_load_dwordx4 v40, s[12:15], s37 offen offset:0 lds
    v_add_u32 v16, 98304, v42
    v_add_u32 v17, 98304, v43
    v_add_u32 v18, 98304, v44
    buffer_load_dwordx4 v41, s[12:15], s37 offen offset:1024 lds
    s_waitcnt vmcnt(6) lgkmcnt(0)
    s_barrier
    s_add_u32 m0, s87, 73728
    s_add_u32 s37, s86, 1179648
    buffer_load_dwordx4 v40, s[12:15], s37 offen offset:0 lds
    ds_read_b64_tr_b16 a[24:25], v16 offset:0
    ds_read_b64_tr_b16 a[26:27], v16 offset:2048
    ds_read_b64_tr_b16 a[28:29], v17 offset:0
    ds_read_b64_tr_b16 a[30:31], v17 offset:2048
    buffer_load_dwordx4 v41, s[12:15], s37 offen offset:1024 lds
    ds_read_b64_tr_b16 a[32:33], v18 offset:0
    ds_read_b64_tr_b16 a[34:35], v18 offset:2048
    ds_read_b64_tr_b16 a[36:37], v16 offset:4096
    ds_read_b64_tr_b16 a[38:39], v16 offset:6144
    s_add_u32 m0, s87, 81920
    s_add_u32 s37, s86, 1181696
    buffer_load_dwordx4 v40, s[12:15], s37 offen offset:0 lds
    ds_read_b64_tr_b16 a[40:41], v17 offset:4096
    ds_read_b64_tr_b16 a[42:43], v17 offset:6144
    ds_read_b64_tr_b16 a[44:45], v18 offset:4096
    ds_read_b64_tr_b16 a[46:47], v18 offset:6144
    buffer_load_dwordx4 v41, s[12:15], s37 offen offset:1024 lds
    v_mfma_f32_16x16x32_bf16 v[56:59], a[0:3], v[28:31], 0
    v_mfma_f32_16x16x32_bf16 v[60:63], a[4:7], v[28:31], 0
    v_mfma_f32_16x16x32_bf16 v[64:67], a[8:11], v[28:31], 0
    v_mfma_f32_16x16x32_bf16 v[56:59], a[12:15], v[28:31], v[56:59]
    s_add_u32 m0, s87, 90112
    s_add_u32 s37, s86, 1183744
    buffer_load_dwordx4 v40, s[12:15], s37 offen offset:0 lds
    v_mfma_f32_16x16x32_bf16 v[60:63], a[16:19], v[28:31], v[60:63]
    v_mfma_f32_16x16x32_bf16 v[64:67], a[20:23], v[28:31], v[64:67]
    v_add_u32 v12, 122880, v42
    v_add_u32 v13, 122880, v43
    buffer_load_dwordx4 v41, s[12:15], s37 offen offset:1024 lds
    v_add_u32 v14, 122880, v44
    s_waitcnt vmcnt(6) lgkmcnt(0)
    s_barrier
    s_add_u32 m0, s87, 98304
    s_add_u32 s37, s86, 1572864
    buffer_load_dwordx4 v40, s[12:15], s37 offen offset:0 lds
    ds_read_b64_tr_b16 a[48:49], v12 offset:0
    ds_read_b64_tr_b16 a[50:51], v12 offset:2048
    ds_read_b64_tr_b16 a[52:53], v13 offset:0
    ds_read_b64_tr_b16 a[54:55], v13 offset:2048
    buffer_load_dwordx4 v41, s[12:15], s37 offen offset:1024 lds
    ds_read_b64_tr_b16 a[56:57], v14 offset:0
    ds_read_b64_tr_b16 a[58:59], v14 offset:2048
    ds_read_b64_tr_b16 a[60:61], v12 offset:4096
    ds_read_b64_tr_b16 a[62:63], v12 offset:6144
    s_add_u32 m0, s87, 106496
    s_add_u32 s37, s86, 1574912
    buffer_load_dwordx4 v40, s[12:15], s37 offen offset:0 lds
    ds_read_b64_tr_b16 a[64:65], v13 offset:4096
    ds_read_b64_tr_b16 a[66:67], v13 offset:6144
    ds_read_b64_tr_b16 a[68:69], v14 offset:4096
    ds_read_b64_tr_b16 a[70:71], v14 offset:6144
    buffer_load_dwordx4 v41, s[12:15], s37 offen offset:1024 lds
    v_mfma_f32_16x16x32_bf16 v[56:59], a[24:27], v[28:31], v[56:59]
    v_mfma_f32_16x16x32_bf16 v[60:63], a[28:31], v[28:31], v[60:63]
    v_mfma_f32_16x16x32_bf16 v[64:67], a[32:35], v[28:31], v[64:67]
    v_mfma_f32_16x16x32_bf16 v[56:59], a[36:39], v[28:31], v[56:59]
    s_add_u32 m0, s87, 114688
    s_add_u32 s37, s86, 1576960
    buffer_load_dwordx4 v40, s[12:15], s37 offen offset:0 lds
    v_mfma_f32_16x16x32_bf16 v[60:63], a[40:43], v[28:31], v[60:63]
    v_mfma_f32_16x16x32_bf16 v[64:67], a[44:47], v[28:31], v[64:67]
    v_add_u32 v16, 73728, v42
    v_add_u32 v17, 73728, v43
    buffer_load_dwordx4 v41, s[12:15], s37 offen offset:1024 lds
    v_add_u32 v18, 73728, v44
    s_waitcnt vmcnt(6) lgkmcnt(0)
    s_barrier
    s_add_u32 m0, s87, 122880
    s_add_u32 s37, s86, 1966080
    buffer_load_dwordx4 v40, s[12:15], s37 offen offset:0 lds
    ds_read_b64_tr_b16 a[72:73], v16 offset:0
    ds_read_b64_tr_b16 a[74:75], v16 offset:2048
    ds_read_b64_tr_b16 a[76:77], v17 offset:0
    ds_read_b64_tr_b16 a[78:79], v17 offset:2048
    buffer_load_dwordx4 v41, s[12:15], s37 offen offset:1024 lds
    ds_read_b64_tr_b16 a[80:81], v18 offset:0
    ds_read_b64_tr_b16 a[82:83], v18 offset:2048
    ds_read_b64_tr_b16 a[84:85], v16 offset:4096
    ds_read_b64_tr_b16 a[86:87], v16 offset:6144
    s_add_u32 m0, s87, 131072
    s_add_u32 s37, s86, 1968128
    buffer_load_dwordx4 v40, s[12:15], s37 offen offset:0 lds
    ds_read_b64_tr_b16 a[88:89], v17 offset:4096
    ds_read_b64_tr_b16 a[90:91], v17 offset:6144
    ds_read_b64_tr_b16 a[92:93], v18 offset:4096
    ds_read_b64_tr_b16 a[94:95], v18 offset:6144
    buffer_load_dwordx4 v41, s[12:15], s37 offen offset:1024 lds
    v_mfma_f32_16x16x32_bf16 v[56:59], a[48:51], v[28:31], v[56:59]
    v_mfma_f32_16x16x32_bf16 v[60:63], a[52:55], v[28:31], v[60:63]
    v_mfma_f32_16x16x32_bf16 v[64:67], a[56:59], v[28:31], v[64:67]
    v_mfma_f32_16x16x32_bf16 v[56:59], a[60:63], v[28:31], v[56:59]
    s_add_u32 m0, s87, 139264
    s_add_u32 s37, s86, 1970176
    buffer_load_dwordx4 v40, s[12:15], s37 offen offset:0 lds
    v_mfma_f32_16x16x32_bf16 v[60:63], a[64:67], v[28:31], v[60:63]
    v_mfma_f32_16x16x32_bf16 v[64:67], a[68:71], v[28:31], v[64:67]
    v_add_u32 v12, 98304, v42
    v_add_u32 v13, 98304, v43
    buffer_load_dwordx4 v41, s[12:15], s37 offen offset:1024 lds
    v_add_u32 v14, 98304, v44
    s_waitcnt vmcnt(6) lgkmcnt(0)
    s_barrier
    s_add_u32 m0, s87, 73728
    s_add_u32 s37, s86, 2359296
    buffer_load_dwordx4 v40, s[12:15], s37 offen offset:0 lds
    ds_read_b64_tr_b16 a[96:97], v12 offset:0
    ds_read_b64_tr_b16 a[98:99], v12 offset:2048
    ds_read_b64_tr_b16 a[100:101], v13 offset:0
    ds_read_b64_tr_b16 a[102:103], v13 offset:2048
    buffer_load_dwordx4 v41, s[12:15], s37 offen offset:1024 lds
    ds_read_b64_tr_b16 a[104:105], v14 offset:0
    ds_read_b64_tr_b16 a[106:107], v14 offset:2048
    ds_read_b64_tr_b16 a[108:109], v12 offset:4096
    ds_read_b64_tr_b16 a[110:111], v12 offset:6144
    s_add_u32 m0, s87, 81920
    s_add_u32 s37, s86, 2361344
    buffer_load_dwordx4 v40, s[12:15], s37 offen offset:0 lds
    ds_read_b64_tr_b16 a[112:113], v13 offset:4096
    ds_read_b64_tr_b16 a[114:115], v13 offset:6144
    ds_read_b64_tr_b16 a[116:117], v14 offset:4096
    ds_read_b64_tr_b16 a[118:119], v14 offset:6144
    buffer_load_dwordx4 v41, s[12:15], s37 offen offset:1024 lds
    v_mfma_f32_16x16x32_bf16 v[56:59], a[72:75], v[28:31], v[56:59]
    v_mfma_f32_16x16x32_bf16 v[60:63], a[76:79], v[28:31], v[60:63]
    v_mfma_f32_16x16x32_bf16 v[64:67], a[80:83], v[28:31], v[64:67]
    v_mfma_f32_16x16x32_bf16 v[56:59], a[84:87], v[28:31], v[56:59]
    s_add_u32 m0, s87, 90112
    s_add_u32 s37, s86, 2363392
    buffer_load_dwordx4 v40, s[12:15], s37 offen offset:0 lds
    v_mfma_f32_16x16x32_bf16 v[60:63], a[88:91], v[28:31], v[60:63]
    v_mfma_f32_16x16x32_bf16 v[64:67], a[92:95], v[28:31], v[64:67]
    v_add_u32 v16, 122880, v42
    v_add_u32 v17, 122880, v43
    buffer_load_dwordx4 v41, s[12:15], s37 offen offset:1024 lds
    v_add_u32 v18, 122880, v44
    s_waitcnt vmcnt(6) lgkmcnt(0)
    s_barrier
    s_add_u32 m0, s87, 98304
    s_add_u32 s37, s86, 2752512
    buffer_load_dwordx4 v40, s[12:15], s37 offen offset:0 lds
    ds_read_b64_tr_b16 a[120:121], v16 offset:0
    ds_read_b64_tr_b16 a[122:123], v16 offset:2048
    ds_read_b64_tr_b16 a[124:125], v17 offset:0
    ds_read_b64_tr_b16 a[126:127], v17 offset:2048
    buffer_load_dwordx4 v41, s[12:15], s37 offen offset:1024 lds
    ds_read_b64_tr_b16 a[128:129], v18 offset:0
    ds_read_b64_tr_b16 a[130:131], v18 offset:2048
    ds_read_b64_tr_b16 a[132:133], v16 offset:4096
    ds_read_b64_tr_b16 a[134:135], v16 offset:6144
    s_add_u32 m0, s87, 106496
    s_add_u32 s37, s86, 2754560
    buffer_load_dwordx4 v40, s[12:15], s37 offen offset:0 lds
    ds_read_b64_tr_b16 a[136:137], v17 offset:4096
    ds_read_b64_tr_b16 a[138:139], v17 offset:6144
    ds_read_b64_tr_b16 a[140:141], v18 offset:4096
    ds_read_b64_tr_b16 a[142:143], v18 offset:6144
    buffer_load_dwordx4 v41, s[12:15], s37 offen offset:1024 lds
    v_mfma_f32_16x16x32_bf16 v[56:59], a[96:99], v[28:31], v[56:59]
    v_mfma_f32_16x16x32_bf16 v[60:63], a[100:103], v[28:31], v[60:63]
    v_mfma_f32_16x16x32_bf16 v[64:67], a[104:107], v[28:31], v[64:67]
    v_mfma_f32_16x16x32_bf16 v[56:59], a[108:111], v[28:31], v[56:59]
    s_add_u32 m0, s87, 114688
    s_add_u32 s37, s86, 2756608
    buffer_load_dwordx4 v40, s[12:15], s37 offen offset:0 lds
    v_mfma_f32_16x16x32_bf16 v[60:63], a[112:115], v[28:31], v[60:63]
    v_mfma_f32_16x16x32_bf16 v[64:67], a[116:119], v[28:31], v[64:67]
    v_add_u32 v12, 73728, v42
    v_add_u32 v13, 73728, v43
    buffer_load_dwordx4 v41, s[12:15], s37 offen offset:1024 lds
    v_add_u32 v14, 73728, v44
    s_waitcnt vmcnt(6) lgkmcnt(0)
    s_barrier
    s_add_u32 m0, s87, 122880
    s_add_u32 s37, s86, 3145728
    buffer_load_dwordx4 v40, s[12:15], s37 offen offset:0 lds
    ds_read_b64_tr_b16 a[144:145], v12 offset:0
    ds_read_b64_tr_b16 a[146:147], v12 offset:2048
    ds_read_b64_tr_b16 a[148:149], v13 offset:0
    ds_read_b64_tr_b16 a[150:151], v13 offset:2048
    buffer_load_dwordx4 v41, s[12:15], s37 offen offset:1024 lds
    ds_read_b64_tr_b16 a[152:153], v14 offset:0
    ds_read_b64_tr_b16 a[154:155], v14 offset:2048
    ds_read_b64_tr_b16 a[156:157], v12 offset:4096
    ds_read_b64_tr_b16 a[158:159], v12 offset:6144
    s_add_u32 m0, s87, 131072
    s_add_u32 s37, s86, 3147776
    buffer_load_dwordx4 v40, s[12:15], s37 offen offset:0 lds
    ds_read_b64_tr_b16 a[160:161], v13 offset:4096
    ds_read_b64_tr_b16 a[162:163], v13 offset:6144
    ds_read_b64_tr_b16 a[164:165], v14 offset:4096
    ds_read_b64_tr_b16 a[166:167], v14 offset:6144
    buffer_load_dwordx4 v41, s[12:15], s37 offen offset:1024 lds
    v_mfma_f32_16x16x32_bf16 v[56:59], a[120:123], v[28:31], v[56:59]
    v_mfma_f32_16x16x32_bf16 v[60:63], a[124:127], v[28:31], v[60:63]
    v_mfma_f32_16x16x32_bf16 v[64:67], a[128:131], v[28:31], v[64:67]
    v_mfma_f32_16x16x32_bf16 v[56:59], a[132:135], v[28:31], v[56:59]
    s_add_u32 m0, s87, 139264
    s_add_u32 s37, s86, 3149824
    buffer_load_dwordx4 v40, s[12:15], s37 offen offset:0 lds
    v_mfma_f32_16x16x32_bf16 v[60:63], a[136:139], v[28:31], v[60:63]
    v_mfma_f32_16x16x32_bf16 v[64:67], a[140:143], v[28:31], v[64:67]
    v_add_u32 v16, 98304, v42
    v_add_u32 v17, 98304, v43
    buffer_load_dwordx4 v41, s[12:15], s37 offen offset:1024 lds
    v_add_u32 v18, 98304, v44
    s_waitcnt vmcnt(6) lgkmcnt(0)
    s_barrier
    s_add_u32 m0, s87, 73728
    s_add_u32 s37, s86, 3538944
    buffer_load_dwordx4 v40, s[12:15], s37 offen offset:0 lds
    ds_read_b64_tr_b16 a[168:169], v16 offset:0
    ds_read_b64_tr_b16 a[170:171], v16 offset:2048
    ds_read_b64_tr_b16 a[172:173], v17 offset:0
    ds_read_b64_tr_b16 a[174:175], v17 offset:2048
    buffer_load_dwordx4 v41, s[12:15], s37 offen offset:1024 lds
    ds_read_b64_tr_b16 a[176:177], v18 offset:0
    ds_read_b64_tr_b16 a[178:179], v18 offset:2048
    ds_read_b64_tr_b16 a[180:181], v16 offset:4096
    ds_read_b64_tr_b16 a[182:183], v16 offset:6144
    s_add_u32 m0, s87, 81920
    s_add_u32 s37, s86, 3540992
    buffer_load_dwordx4 v40, s[12:15], s37 offen offset:0 lds
    ds_read_b64_tr_b16 a[184:185], v17 offset:4096
    ds_read_b64_tr_b16 a[186:187], v17 offset:6144
    ds_read_b64_tr_b16 a[188:189], v18 offset:4096
    ds_read_b64_tr_b16 a[190:191], v18 offset:6144
    buffer_load_dwordx4 v41, s[12:15], s37 offen offset:1024 lds
    v_mfma_f32_16x16x32_bf16 v[56:59], a[144:147], v[28:31], v[56:59]
    v_mfma_f32_16x16x32_bf16 v[60:63], a[148:151], v[28:31], v[60:63]
    v_mfma_f32_16x16x32_bf16 v[64:67], a[152:155], v[28:31], v[64:67]
    v_mfma_f32_16x16x32_bf16 v[56:59], a[156:159], v[28:31], v[56:59]
    s_add_u32 m0, s87, 90112
    s_add_u32 s37, s86, 3543040
    buffer_load_dwordx4 v40, s[12:15], s37 offen offset:0 lds
    v_mfma_f32_16x16x32_bf16 v[60:63], a[160:163], v[28:31], v[60:63]
    v_mfma_f32_16x16x32_bf16 v[64:67], a[164:167], v[28:31], v[64:67]
    v_add_u32 v12, 122880, v42
    v_add_u32 v13, 122880, v43
    buffer_load_dwordx4 v41, s[12:15], s37 offen offset:1024 lds
    v_add_u32 v14, 122880, v44
    s_waitcnt vmcnt(6) lgkmcnt(0)
    s_barrier
    s_add_u32 m0, s87, 98304
    s_add_u32 s37, s86, 3932160
    buffer_load_dwordx4 v40, s[12:15], s37 offen offset:0 lds
    ds_read_b64_tr_b16 a[192:193], v12 offset:0
    ds_read_b64_tr_b16 a[194:195], v12 offset:2048
    ds_read_b64_tr_b16 a[196:197], v13 offset:0
    ds_read_b64_tr_b16 a[198:199], v13 offset:2048
    buffer_load_dwordx4 v41, s[12:15], s37 offen offset:1024 lds
    ds_read_b64_tr_b16 a[200:201], v14 offset:0
    ds_read_b64_tr_b16 a[202:203], v14 offset:2048
    ds_read_b64_tr_b16 a[204:205], v12 offset:4096
    ds_read_b64_tr_b16 a[206:207], v12 offset:6144
    s_add_u32 m0, s87, 106496
    s_add_u32 s37, s86, 3934208
    buffer_load_dwordx4 v40, s[12:15], s37 offen offset:0 lds
    ds_read_b64_tr_b16 a[208:209], v13 offset:4096
    ds_read_b64_tr_b16 a[210:211], v13 offset:6144
    ds_read_b64_tr_b16 a[212:213], v14 offset:4096
    ds_read_b64_tr_b16 a[214:215], v14 offset:6144
    buffer_load_dwordx4 v41, s[12:15], s37 offen offset:1024 lds
    v_mfma_f32_16x16x32_bf16 v[56:59], a[168:171], v[28:31], v[56:59]
    v_mfma_f32_16x16x32_bf16 v[60:63], a[172:175], v[28:31], v[60:63]
    v_mfma_f32_16x16x32_bf16 v[64:67], a[176:179], v[28:31], v[64:67]
    v_mfma_f32_16x16x32_bf16 v[56:59], a[180:183], v[28:31], v[56:59]
    s_add_u32 m0, s87, 114688
    s_add_u32 s37, s86, 3936256
    buffer_load_dwordx4 v40, s[12:15], s37 offen offset:0 lds
    v_mfma_f32_16x16x32_bf16 v[60:63], a[184:187], v[28:31], v[60:63]
    v_mfma_f32_16x16x32_bf16 v[64:67], a[188:191], v[28:31], v[64:67]
    v_add_u32 v16, 73728, v42
    v_add_u32 v17, 73728, v43
    buffer_load_dwordx4 v41, s[12:15], s37 offen offset:1024 lds
    v_add_u32 v18, 73728, v44
    s_waitcnt vmcnt(6) lgkmcnt(0)
    s_barrier
    s_add_u32 m0, s87, 122880
    s_add_u32 s37, s86, 4325376
    buffer_load_dwordx4 v40, s[12:15], s37 offen offset:0 lds
    ds_read_b64_tr_b16 a[216:217], v16 offset:0
    ds_read_b64_tr_b16 a[218:219], v16 offset:2048
    ds_read_b64_tr_b16 a[220:221], v17 offset:0
    ds_read_b64_tr_b16 a[222:223], v17 offset:2048
    buffer_load_dwordx4 v41, s[12:15], s37 offen offset:1024 lds
    ds_read_b64_tr_b16 a[224:225], v18 offset:0
    ds_read_b64_tr_b16 a[226:227], v18 offset:2048
    ds_read_b64_tr_b16 a[228:229], v16 offset:4096
    ds_read_b64_tr_b16 a[230:231], v16 offset:6144
    s_add_u32 m0, s87, 131072
    s_add_u32 s37, s86, 4327424
    buffer_load_dwordx4 v40, s[12:15], s37 offen offset:0 lds
    ds_read_b64_tr_b16 a[232:233], v17 offset:4096
    ds_read_b64_tr_b16 a[234:235], v17 offset:6144
    ds_read_b64_tr_b16 a[236:237], v18 offset:4096
    ds_read_b64_tr_b16 a[238:239], v18 offset:6144
    buffer_load_dwordx4 v41, s[12:15], s37 offen offset:1024 lds
    v_mfma_f32_16x16x32_bf16 v[56:59], a[192:195], v[28:31], v[56:59]
    v_mfma_f32_16x16x32_bf16 v[60:63], a[196:199], v[28:31], v[60:63]
    v_mfma_f32_16x16x32_bf16 v[64:67], a[200:203], v[28:31], v[64:67]
    v_mfma_f32_16x16x32_bf16 v[56:59], a[204:207], v[28:31], v[56:59]
    s_add_u32 m0, s87, 139264
    s_add_u32 s37, s86, 4329472
    buffer_load_dwordx4 v40, s[12:15], s37 offen offset:0 lds
    v_mfma_f32_16x16x32_bf16 v[60:63], a[208:211], v[28:31], v[60:63]
    v_mfma_f32_16x16x32_bf16 v[64:67], a[212:215], v[28:31], v[64:67]
    v_add_u32 v12, 98304, v42
    v_add_u32 v13, 98304, v43
    buffer_load_dwordx4 v41, s[12:15], s37 offen offset:1024 lds
    v_add_u32 v14, 98304, v44
    s_waitcnt vmcnt(6) lgkmcnt(0)
    s_barrier
    s_add_u32 m0, s87, 73728
    s_add_u32 s37, s86, 4718592
    buffer_load_dwordx4 v40, s[12:15], s37 offen offset:0 lds
    ds_read_b64_tr_b16 a[240:241], v12 offset:0
    ds_read_b64_tr_b16 a[242:243], v12 offset:2048
    ds_read_b64_tr_b16 a[244:245], v13 offset:0
    ds_read_b64_tr_b16 a[246:247], v13 offset:2048
    buffer_load_dwordx4 v41, s[12:15], s37 offen offset:1024 lds
    ds_read_b64_tr_b16 a[248:249], v14 offset:0
    ds_read_b64_tr_b16 a[250:251], v14 offset:2048
    ds_read_b64_tr_b16 a[252:253], v12 offset:4096
    ds_read_b64_tr_b16 a[254:255], v12 offset:6144
    s_add_u32 m0, s87, 81920
    s_add_u32 s37, s86, 4720640
    buffer_load_dwordx4 v40, s[12:15], s37 offen offset:0 lds
    ds_read_b64_tr_b16 v[128:129], v13 offset:4096
    ds_read_b64_tr_b16 v[130:131], v13 offset:6144
    ds_read_b64_tr_b16 v[132:133], v14 offset:4096
    ds_read_b64_tr_b16 v[134:135], v14 offset:6144
    buffer_load_dwordx4 v41, s[12:15], s37 offen offset:1024 lds
    v_mfma_f32_16x16x32_bf16 v[56:59], a[216:219], v[28:31], v[56:59]
    v_mfma_f32_16x16x32_bf16 v[60:63], a[220:223], v[28:31], v[60:63]
    v_mfma_f32_16x16x32_bf16 v[64:67], a[224:227], v[28:31], v[64:67]
    v_mfma_f32_16x16x32_bf16 v[56:59], a[228:231], v[28:31], v[56:59]
    s_add_u32 m0, s87, 90112
    s_add_u32 s37, s86, 4722688
    buffer_load_dwordx4 v40, s[12:15], s37 offen offset:0 lds
    v_mfma_f32_16x16x32_bf16 v[60:63], a[232:235], v[28:31], v[60:63]
    v_mfma_f32_16x16x32_bf16 v[64:67], a[236:239], v[28:31], v[64:67]
    v_add_u32 v16, 122880, v42
    v_add_u32 v17, 122880, v43
    buffer_load_dwordx4 v41, s[12:15], s37 offen offset:1024 lds
    v_add_u32 v18, 122880, v44
    s_waitcnt vmcnt(6) lgkmcnt(0)
    s_barrier
    s_mov_b32 s20, s82
    s_mov_b32 s21, s83
    s_mov_b32 s22, 0x100
    s_mov_b32 s23, 0x00020000
    v_and_b32 v8, 15, v0
    v_lshlrev_b32 v8, 4, v8
    v_mov_b32 v10, 8
    s_mul_i32 s38, s28, 0x40
    s_add_u32 s38, s38, 0x4
    v_writelane_b32 v8, s38, 16
    v_writelane_b32 v10, 12, 16
    buffer_load_dword v9, v8, s[20:23], 0 offen sc1
    s_add_u32 m0, s87, 98304
    s_add_u32 s37, s86, 5111808
    buffer_load_dwordx4 v40, s[12:15], s37 offen offset:0 lds
    ds_read_b64_tr_b16 v[136:137], v16 offset:0
    ds_read_b64_tr_b16 v[138:139], v16 offset:2048
    ds_read_b64_tr_b16 v[140:141], v17 offset:0
    ds_read_b64_tr_b16 v[142:143], v17 offset:2048
    buffer_load_dwordx4 v41, s[12:15], s37 offen offset:1024 lds
    ds_read_b64_tr_b16 v[144:145], v18 offset:0
    ds_read_b64_tr_b16 v[146:147], v18 offset:2048
    ds_read_b64_tr_b16 v[148:149], v16 offset:4096
    ds_read_b64_tr_b16 v[150:151], v16 offset:6144
    s_add_u32 m0, s87, 106496
    s_add_u32 s37, s86, 5113856
    buffer_load_dwordx4 v40, s[12:15], s37 offen offset:0 lds
    ds_read_b64_tr_b16 v[152:153], v17 offset:4096
    ds_read_b64_tr_b16 v[154:155], v17 offset:6144
    ds_read_b64_tr_b16 v[156:157], v18 offset:4096
    ds_read_b64_tr_b16 v[158:159], v18 offset:6144
    buffer_load_dwordx4 v41, s[12:15], s37 offen offset:1024 lds
    v_mfma_f32_16x16x32_bf16 v[56:59], a[240:243], v[28:31], v[56:59]
    v_mfma_f32_16x16x32_bf16 v[60:63], a[244:247], v[28:31], v[60:63]
    v_mfma_f32_16x16x32_bf16 v[64:67], a[248:251], v[28:31], v[64:67]
    v_mfma_f32_16x16x32_bf16 v[56:59], a[252:255], v[28:31], v[56:59]
    s_add_u32 m0, s87, 114688
    s_add_u32 s37, s86, 5115904
    buffer_load_dwordx4 v40, s[12:15], s37 offen offset:0 lds
    v_mfma_f32_16x16x32_bf16 v[60:63], v[128:131], v[28:31], v[60:63]
    v_mfma_f32_16x16x32_bf16 v[64:67], v[132:135], v[28:31], v[64:67]
    v_add_u32 v12, 73728, v42
    v_add_u32 v13, 73728, v43
    buffer_load_dwordx4 v41, s[12:15], s37 offen offset:1024 lds
    v_add_u32 v14, 73728, v44
    s_waitcnt vmcnt(7) lgkmcnt(0)
    s_barrier
    s_add_u32 m0, s87, 122880
    s_add_u32 s37, s86, 5505024
    buffer_load_dwordx4 v40, s[12:15], s37 offen offset:0 lds
    ds_read_b64_tr_b16 v[160:161], v12 offset:0
    ds_read_b64_tr_b16 v[162:163], v12 offset:2048
    ds_read_b64_tr_b16 v[164:165], v13 offset:0
    ds_read_b64_tr_b16 v[166:167], v13 offset:2048
    buffer_load_dwordx4 v41, s[12:15], s37 offen offset:1024 lds
    ds_read_b64_tr_b16 v[168:169], v14 offset:0
    ds_read_b64_tr_b16 v[170:171], v14 offset:2048
    ds_read_b64_tr_b16 v[172:173], v12 offset:4096
    ds_read_b64_tr_b16 v[174:175], v12 offset:6144
    s_add_u32 m0, s87, 131072
    s_add_u32 s37, s86, 5507072
    buffer_load_dwordx4 v40, s[12:15], s37 offen offset:0 lds
    ds_read_b64_tr_b16 v[176:177], v13 offset:4096
    ds_read_b64_tr_b16 v[178:179], v13 offset:6144
    ds_read_b64_tr_b16 v[180:181], v14 offset:4096
    ds_read_b64_tr_b16 v[182:183], v14 offset:6144
    buffer_load_dwordx4 v41, s[12:15], s37 offen offset:1024 lds
    v_mfma_f32_16x16x32_bf16 v[56:59], v[136:139], v[28:31], v[56:59]
    v_mfma_f32_16x16x32_bf16 v[60:63], v[140:143], v[28:31], v[60:63]
    v_mfma_f32_16x16x32_bf16 v[64:67], v[144:147], v[28:31], v[64:67]
    v_mfma_f32_16x16x32_bf16 v[56:59], v[148:151], v[28:31], v[56:59]
    s_add_u32 m0, s87, 139264
    s_add_u32 s37, s86, 5509120
    buffer_load_dwordx4 v40, s[12:15], s37 offen offset:0 lds
    v_mfma_f32_16x16x32_bf16 v[60:63], v[152:155], v[28:31], v[60:63]
    v_mfma_f32_16x16x32_bf16 v[64:67], v[156:159], v[28:31], v[64:67]
    v_add_u32 v16, 98304, v42
    v_add_u32 v17, 98304, v43
    buffer_load_dwordx4 v41, s[12:15], s37 offen offset:1024 lds
    v_add_u32 v18, 98304, v44
    s_waitcnt vmcnt(6) lgkmcnt(0)
    s_barrier
    s_add_u32 m0, s87, 73728
    s_add_u32 s37, s86, 5898240
    buffer_load_dwordx4 v40, s[12:15], s37 offen offset:0 lds
    ds_read_b64_tr_b16 v[184:185], v16 offset:0
    ds_read_b64_tr_b16 v[186:187], v16 offset:2048
    ds_read_b64_tr_b16 v[188:189], v17 offset:0
    ds_read_b64_tr_b16 v[190:191], v17 offset:2048
    buffer_load_dwordx4 v41, s[12:15], s37 offen offset:1024 lds
    ds_read_b64_tr_b16 v[192:193], v18 offset:0
    ds_read_b64_tr_b16 v[194:195], v18 offset:2048
    ds_read_b64_tr_b16 v[196:197], v16 offset:4096
    ds_read_b64_tr_b16 v[198:199], v16 offset:6144
    s_add_u32 m0, s87, 81920
    s_add_u32 s37, s86, 5900288
    buffer_load_dwordx4 v40, s[12:15], s37 offen offset:0 lds
    ds_read_b64_tr_b16 v[200:201], v17 offset:4096
    ds_read_b64_tr_b16 v[202:203], v17 offset:6144
    ds_read_b64_tr_b16 v[204:205], v18 offset:4096
    ds_read_b64_tr_b16 v[206:207], v18 offset:6144
    buffer_load_dwordx4 v41, s[12:15], s37 offen offset:1024 lds
    v_mfma_f32_16x16x32_bf16 v[56:59], v[160:163], v[28:31], v[56:59]
    v_mfma_f32_16x16x32_bf16 v[60:63], v[164:167], v[28:31], v[60:63]
    v_mfma_f32_16x16x32_bf16 v[64:67], v[168:171], v[28:31], v[64:67]
    v_mfma_f32_16x16x32_bf16 v[56:59], v[172:175], v[28:31], v[56:59]
    s_add_u32 m0, s87, 90112
    s_add_u32 s37, s86, 5902336
    buffer_load_dwordx4 v40, s[12:15], s37 offen offset:0 lds
    v_mfma_f32_16x16x32_bf16 v[60:63], v[176:179], v[28:31], v[60:63]
    v_mfma_f32_16x16x32_bf16 v[64:67], v[180:183], v[28:31], v[64:67]
    v_add_u32 v12, 122880, v42
    v_add_u32 v13, 122880, v43
    buffer_load_dwordx4 v41, s[12:15], s37 offen offset:1024 lds
    v_add_u32 v14, 122880, v44
Lqkv_wa:
    v_cmp_gt_u32 vcc, v10, v9
    s_sub_u32 s43, s43, 1
    s_cmp_lt_i32 s43, 0
    s_cbranch_scc1 Lqkv_all
    s_cbranch_vccz Lqkv_all
    s_sleep 2
    buffer_load_dword v9, v8, s[20:23], 0 offen sc1
    s_waitcnt vmcnt(0)
    s_branch Lqkv_wa
Lqkv_all:
    s_mov_b32 s18, 0xffff
    s_mov_b32 s32, 1
    s_mov_b32 s16, 278528
    s_mov_b32 s10, s6
    s_add_u32 m0, s34, 0
    s_nop 0
    buffer_load_dwordx4 v1, s[8:11], s33 offen offset:0 sc1 lds
    buffer_load_dwordx4 v1, s[8:11], s33 offen offset:1024 sc1 lds
    buffer_load_dwordx4 v1, s[8:11], s33 offen offset:2048 sc1 lds
    buffer_load_dwordx4 v1, s[8:11], s33 offen offset:3072 sc1 lds
    s_add_u32 m0, s34, 4096
    s_add_u32 s37, s33, 4096
    buffer_load_dwordx4 v1, s[8:11], s37 offen offset:0 sc1 lds
    buffer_load_dwordx4 v1, s[8:11], s37 offen offset:1024 sc1 lds
    buffer_load_dwordx4 v1, s[8:11], s37 offen offset:2048 sc1 lds
    buffer_load_dwordx4 v1, s[8:11], s37 offen offset:3072 sc1 lds
    s_add_u32 m0, s34, 8192
    s_add_u32 s37, s33, 8192
    buffer_load_dwordx4 v1, s[8:11], s37 offen offset:0 sc1 lds
    s_add_u32 s33, s33, 34816
    s_add_u32 s34, s34, 36864
    s_cmp_ge_u32 s34, 147456
    s_cselect_b32 s38, 147456, 0
    s_sub_u32 s34, s34, s38
    s_mov_b32 s10, s6
    s_add_u32 m0, s34, 0
    s_nop 0
    buffer_load_dwordx4 v1, s[8:11], s33 offen offset:0 sc1 lds
    buffer_load_dwordx4 v1, s[8:11], s33 offen offset:1024 sc1 lds
    buffer_load_dwordx4 v1, s[8:11], s33 offen offset:2048 sc1 lds
    buffer_load_dwordx4 v1, s[8:11], s33 offen offset:3072 sc1 lds
    s_add_u32 m0, s34, 4096
    s_add_u32 s37, s33, 4096
    buffer_load_dwordx4 v1, s[8:11], s37 offen offset:0 sc1 lds
    buffer_load_dwordx4 v1, s[8:11], s37 offen offset:1024 sc1 lds
    buffer_load_dwordx4 v1, s[8:11], s37 offen offset:2048 sc1 lds
    buffer_load_dwordx4 v1, s[8:11], s37 offen offset:3072 sc1 lds
    s_add_u32 m0, s34, 8192
    s_add_u32 s37, s33, 8192
    buffer_load_dwordx4 v1, s[8:11], s37 offen offset:0 sc1 lds
    s_add_u32 s16, s16, 8192
    s_and_b32 s16, s16, 524287
    buffer_load_dword v5, v4, s[4:7], s16 offen sc1
    s_add_u32 s31, s31, 1
    s_sub_u32 s54, s31, 2
    v_mov_b32 v6, s54
    s_cmp_ge_i32 s31, 30
    s_cselect_b32 s18, 0x1ffff, s18
    s_add_u32 s33, s33, 34816
    s_add_u32 s34, s34, 36864
    s_cmp_ge_u32 s34, 147456
    s_cselect_b32 s38, 147456, 0
    s_sub_u32 s34, s34, s38
    s_waitcnt vmcnt(25) lgkmcnt(0)
    s_barrier
    ds_read_b64_tr_b16 v[208:209], v12 offset:0
    ds_read_b64_tr_b16 v[210:211], v12 offset:2048
    ds_read_b64_tr_b16 v[212:213], v13 offset:0
    ds_read_b64_tr_b16 v[214:215], v13 offset:2048
    ds_read_b64_tr_b16 v[216:217], v14 offset:0
    ds_read_b64_tr_b16 v[218:219], v14 offset:2048
    ds_read_b64_tr_b16 v[220:221], v12 offset:4096
    ds_read_b64_tr_b16 v[222:223], v12 offset:6144
    ds_read_b64_tr_b16 v[224:225], v13 offset:4096
    ds_read_b64_tr_b16 v[226:227], v13 offset:6144
    ds_read_b64_tr_b16 v[228:229], v14 offset:4096
    ds_read_b64_tr_b16 v[230:231], v14 offset:6144
    v_mfma_f32_16x16x32_bf16 v[56:59], v[184:187], v[28:31], v[56:59]
    v_mfma_f32_16x16x32_bf16 v[60:63], v[188:191], v[28:31], v[60:63]
    v_mfma_f32_16x16x32_bf16 v[64:67], v[192:195], v[28:31], v[64:67]
    v_mfma_f32_16x16x32_bf16 v[56:59], v[196:199], v[28:31], v[56:59]
    v_mfma_f32_16x16x32_bf16 v[60:63], v[200:203], v[28:31], v[60:63]
    v_mfma_f32_16x16x32_bf16 v[64:67], v[204:207], v[28:31], v[64:67]
    v_add_u32 v16, 73728, v42
    v_add_u32 v17, 73728, v43
    v_add_u32 v18, 73728, v44
    s_waitcnt vmcnt(19) lgkmcnt(0)
    s_barrier
    ds_read_b64_tr_b16 v[232:233], v16 offset:0
    ds_read_b64_tr_b16 v[234:235], v16 offset:2048
    ds_read_b64_tr_b16 v[236:237], v17 offset:0
    ds_read_b64_tr_b16 v[238:239], v17 offset:2048
    ds_read_b64_tr_b16 v[240:241], v18 offset:0
    ds_read_b64_tr_b16 v[242:243], v18 offset:2048
    ds_read_b64_tr_b16 v[244:245], v16 offset:4096
    ds_read_b64_tr_b16 v[246:247], v16 offset:6144
    ds_read_b64_tr_b16 v[248:249], v17 offset:4096
    ds_read_b64_tr_b16 v[250:251], v17 offset:6144
    ds_read_b64_tr_b16 v[252:253], v18 offset:4096
    ds_read_b64_tr_b16 v[254:255], v18 offset:6144
    v_mfma_f32_16x16x32_bf16 v[56:59], v[208:211], v[28:31], v[56:59]
    v_mfma_f32_16x16x32_bf16 v[60:63], v[212:215], v[28:31], v[60:63]
    v_mfma_f32_16x16x32_bf16 v[64:67], v[216:219], v[28:31], v[64:67]
    v_mfma_f32_16x16x32_bf16 v[56:59], v[220:223], v[28:31], v[56:59]
    v_mfma_f32_16x16x32_bf16 v[60:63], v[224:227], v[28:31], v[60:63]
    v_mfma_f32_16x16x32_bf16 v[64:67], v[228:231], v[28:31], v[64:67]
    s_waitcnt lgkmcnt(0)
    v_mfma_f32_16x16x32_bf16 v[56:59], v[232:235], v[28:31], v[56:59]
    v_mfma_f32_16x16x32_bf16 v[60:63], v[236:239], v[28:31], v[60:63]
    v_mfma_f32_16x16x32_bf16 v[64:67], v[240:243], v[28:31], v[64:67]
    v_mfma_f32_16x16x32_bf16 v[56:59], v[244:247], v[28:31], v[56:59]
    v_mfma_f32_16x16x32_bf16 v[60:63], v[248:251], v[28:31], v[60:63]
    v_mfma_f32_16x16x32_bf16 v[64:67], v[252:255], v[28:31], v[64:67]
    s_mov_b32 s12, s84
    s_mov_b32 s13, s85
    s_mov_b32 s14, 0x6200000
    s_mov_b32 s15, 0x00020000
    s_waitcnt vmcnt(10)
    s_barrier
    ds_read_b128 v[40:43], v2 offset:0
    ds_read_b128 v[44:47], v2 offset:1024
    ds_read_b128 v[48:51], v2 offset:2048
    ds_read_b128 v[52:55], v2 offset:3072
    s_mov_b32 s14, 0
    buffer_store_dword v6, v21, s[12:15], s17 offen sc1
    buffer_store_dword v6, v21, s[12:15], s17 offen sc1
    s_cmp_eq_u32 s30, 1
    s_cbranch_scc1 Lqkv_g01
    s_cmp_eq_u32 s30, 2
    s_cbranch_scc1 Lqkv_g02
    s_cmp_eq_u32 s30, 3
    s_cbranch_scc1 Lqkv_g03
    s_branch Lqkv_g00
Lqkv_s10:
    s_waitcnt lgkmcnt(2)
    v_mfma_f32_16x16x32_bf16 v[24:27], a[0:3], v[40:43], 0
    s_add_u32 m0, s34, 0
    v_mul_f32 v124, s52, v71
    v_mov_b32 v106, s42
    v_mfma_f32_16x16x32_bf16 v[24:27], a[12:15], v[44:47], v[24:27]
    s_add_u32 s35, s35, 36864
    v_mov_b32 v107, s42
    v_mov_b32 v108, s42
    v_mfma_f32_16x16x32_bf16 v[28:31], a[16:19], v[44:47], 0
    s_cmp_eq_u32 s35, 147456
    s_cselect_b32 s35, 0, s35
    v_mov_b32 v109, s42
    v_mfma_f32_16x16x32_bf16 v[28:31], a[4:7], v[40:43], v[28:31]
    s_waitcnt vmcnt(1)
    v_fma_f32 v16, -v68, v64, v16
    v_fma_f32 v17, -v68, v65, v17
    v_mfma_f32_16x16x32_bf16 v[106:109], v[96:99], v[88:91], v[106:109]
    v_fma_f32 v18, -v68, v66, v18
    v_fma_f32 v19, -v68, v67, v19
    v_mfma_f32_16x16x32_bf16 v[32:35], a[8:11], v[40:43], 0
    ds_read_b128 v[40:43], v3 offset:4096
    v_mul_f32 v16, v16, v69
    v_mfma_f32_16x16x32_bf16 v[32:35], a[20:23], v[44:47], v[32:35]
    ds_read_b128 v[44:47], v3 offset:5120
    s_waitcnt lgkmcnt(2)
    v_mfma_f32_16x16x32_bf16 v[32:35], a[32:35], v[48:51], v[32:35]
    v_cndmask_b32 v106, v106, v107, s[44:45]
    v_cndmask_b32 v108, v108, v109, s[44:45]
    v_mfma_f32_16x16x32_bf16 v[32:35], a[44:47], v[52:55], v[32:35]
    v_cndmask_b32 v120, v106, v118, s[48:49]
    v_cndmask_b32 v121, v108, v119, s[50:51]
    v_mfma_f32_16x16x32_bf16 v[28:31], a[40:43], v[52:55], v[28:31]
    v_mul_f32 v17, v17, v69
    v_mul_f32 v18, v18, v69
    v_mfma_f32_16x16x32_bf16 v[28:31], a[28:31], v[48:51], v[28:31]
    ds_write_b64 v36, v[120:121] offset:2048
    v_mfma_f32_16x16x32_bf16 v[24:27], a[24:27], v[48:51], v[24:27]
    ds_read_b128 v[48:51], v3 offset:6144
    v_mul_f32 v19, v19, v69
    v_mfma_f32_16x16x32_bf16 v[24:27], a[36:39], v[52:55], v[24:27]
    ds_read_b128 v[52:55], v3 offset:7168
    s_waitcnt lgkmcnt(3)
    v_mfma_f32_16x16x32_bf16 v[24:27], a[48:51], v[40:43], v[24:27]
    v_cvt_pk_bf16_f32 v16, v16, v17
    v_cvt_pk_bf16_f32 v17, v18, v19
    v_mfma_f32_16x16x32_bf16 v[24:27], a[60:63], v[44:47], v[24:27]
    s_waitcnt lgkmcnt(2)
    ds_write_b64 v38, v[16:17]
    v_mfma_f32_16x16x32_bf16 v[28:31], a[64:67], v[44:47], v[28:31]
    ds_read_b64_tr_b16 v[92:93], v39
    v_fma_f32 v12, -v68, v60, v12
    v_mfma_f32_16x16x32_bf16 v[28:31], a[52:55], v[40:43], v[28:31]
    s_barrier
    v_mfma_f32_16x16x32_bf16 v[32:35], a[56:59], v[40:43], v[32:35]
    ds_read_b128 v[40:43], v3 offset:8192
    v_fma_f32 v13, -v68, v61, v13
    v_mfma_f32_16x16x32_bf16 v[32:35], a[68:71], v[44:47], v[32:35]
    ds_read_b128 v[44:47], v3 offset:9216
    s_waitcnt lgkmcnt(4)
    v_mfma_f32_16x16x32_bf16 v[32:35], a[80:83], v[48:51], v[32:35]
    buffer_load_dwordx4 v1, s[8:11], s33 offen offset:0 sc1 lds
    v_mfma_f32_16x16x32_bf16 v[32:35], a[92:95], v[52:55], v[32:35]
    ds_read_b64 v[122:123], v37 offset:2048
    v_fma_f32 v14, -v68, v62, v14
    v_mfma_f32_16x16x32_bf16 v[28:31], a[88:91], v[52:55], v[28:31]
    v_fma_f32 v15, -v68, v63, v15
    v_mul_f32 v12, v12, v69
    v_mfma_f32_16x16x32_bf16 v[28:31], a[76:79], v[48:51], v[28:31]
    v_mul_f32 v13, v13, v69
    v_mul_f32 v14, v14, v69
    v_mfma_f32_16x16x32_bf16 v[24:27], a[72:75], v[48:51], v[24:27]
    ds_read_b128 v[48:51], v3 offset:10240
    v_mul_f32 v15, v15, v69
    v_mfma_f32_16x16x32_bf16 v[24:27], a[84:87], v[52:55], v[24:27]
    ds_read_b128 v[52:55], v3 offset:11264
    s_waitcnt lgkmcnt(3)
    v_mfma_f32_16x16x32_bf16 v[24:27], a[96:99], v[40:43], v[24:27]
    buffer_store_dword v6, v21, s[12:15], s17 offen sc1
    s_waitcnt lgkmcnt(2)
    v_mfma_f32_16x16x32_bf16 v[24:27], a[108:111], v[44:47], v[24:27]
    s_cmp_ge_i32 s54, 0
    s_cselect_b32 s14, s6, 0
    v_add_f32 v122, v122, v120
    v_mfma_f32_16x16x32_bf16 v[28:31], a[112:115], v[44:47], v[28:31]
    s_add_u32 s17, s17, 8192
    v_add_f32 v123, v123, v121
    v_max_f32 v22, v122, v123
    v_mfma_f32_16x16x32_bf16 v[28:31], a[100:103], v[40:43], v[28:31]
    buffer_load_dwordx4 v1, s[8:11], s33 offen offset:1024 sc1 lds
    v_mfma_f32_16x16x32_bf16 v[32:35], a[104:107], v[40:43], v[32:35]
    ds_read_b128 v[40:43], v3 offset:12288
    v_mov_b32 v23, v22
    v_mfma_f32_16x16x32_bf16 v[32:35], a[116:119], v[44:47], v[32:35]
    ds_read_b128 v[44:47], v3 offset:13312
    s_waitcnt lgkmcnt(2)
    v_mfma_f32_16x16x32_bf16 v[32:35], a[128:131], v[48:51], v[32:35]
    v_permlane16_swap_b32 v22, v23
    v_mfma_f32_16x16x32_bf16 v[32:35], a[140:143], v[52:55], v[32:35]
    v_max_f32 v22, v22, v23
    v_mov_b32 v23, v22
    v_mfma_f32_16x16x32_bf16 v[28:31], a[136:139], v[52:55], v[28:31]
    buffer_load_dwordx4 v1, s[8:11], s33 offen offset:2048 sc1 lds
    v_mfma_f32_16x16x32_bf16 v[28:31], a[124:127], v[48:51], v[28:31]
    v_permlane32_swap_b32 v22, v23
    v_mfma_f32_16x16x32_bf16 v[24:27], a[120:123], v[48:51], v[24:27]
    ds_read_b128 v[48:51], v3 offset:14336
    v_max_f32 v22, v22, v23
    v_mfma_f32_16x16x32_bf16 v[24:27], a[132:135], v[52:55], v[24:27]
    ds_read_b128 v[52:55], v3 offset:15360
    s_waitcnt lgkmcnt(2)
    v_mfma_f32_16x16x32_bf16 v[24:27], a[144:147], v[40:43], v[24:27]
    v_mul_f32 v22, v124, v22
    v_fma_f32 v122, v122, v124, -v22
    v_mfma_f32_16x16x32_bf16 v[24:27], a[156:159], v[44:47], v[24:27]
    buffer_load_dwordx4 v1, s[8:11], s33 offen offset:3072 sc1 lds
    v_mfma_f32_16x16x32_bf16 v[28:31], a[160:163], v[44:47], v[28:31]
    s_add_u32 m0, s34, 4096
    v_fma_f32 v123, v123, v124, -v22
    v_sub_u32 v76, v3, v20
    v_mfma_f32_16x16x32_bf16 v[28:31], a[148:151], v[40:43], v[28:31]
    s_add_u32 s37, s33, 4096
    v_exp_f32 v122, v122
    v_mfma_f32_16x16x32_bf16 v[32:35], a[152:155], v[40:43], v[32:35]
    ds_read_b128 v[40:43], v3 offset:16384
    v_cvt_pk_bf16_f32 v84, v12, v13
    v_mfma_f32_16x16x32_bf16 v[32:35], a[164:167], v[44:47], v[32:35]
    ds_read_b128 v[44:47], v3 offset:17408
    s_waitcnt lgkmcnt(2)
    v_mfma_f32_16x16x32_bf16 v[32:35], a[176:179], v[48:51], v[32:35]
    buffer_load_dwordx4 v1, s[8:11], s37 offen offset:0 sc1 lds
    v_mfma_f32_16x16x32_bf16 v[32:35], a[188:191], v[52:55], v[32:35]
    ds_read2st64_b64 v[80:83], v76 offset0:66 offset1:67
    v_cvt_pk_bf16_f32 v85, v14, v15
    v_mfma_f32_16x16x32_bf16 v[28:31], a[184:187], v[52:55], v[28:31]
    ds_read2st64_b64 v[76:79], v76 offset0:64 offset1:65
    v_fma_f32 v8, -v68, v56, v8
    v_mfma_f32_16x16x32_bf16 v[28:31], a[172:175], v[48:51], v[28:31]
    v_exp_f32 v123, v123
    v_mfma_f32_16x16x32_bf16 v[24:27], a[168:171], v[48:51], v[24:27]
    ds_read_b128 v[48:51], v3 offset:18432
    v_add_f32 v22, v122, v123
    v_mfma_f32_16x16x32_bf16 v[24:27], a[180:183], v[52:55], v[24:27]
    ds_read_b128 v[52:55], v3 offset:19456
    s_waitcnt lgkmcnt(4)
    v_mfma_f32_16x16x32_bf16 v[24:27], a[192:195], v[40:43], v[24:27]
    buffer_load_dwordx4 v1, s[8:11], s37 offen offset:1024 sc1 lds
    v_mfma_f32_16x16x32_bf16 v[24:27], a[204:207], v[44:47], v[24:27]
    v_mov_b32 v23, v22
    v_fma_f32 v9, -v68, v57, v9
    v_mfma_f32_16x16x32_bf16 v[28:31], a[208:211], v[44:47], v[28:31]
    v_permlane16_swap_b32 v22, v23
    v_mfma_f32_16x16x32_bf16 v[28:31], a[196:199], v[40:43], v[28:31]
    v_add_f32 v22, v22, v23
    v_mov_b32 v23, v22
    v_mfma_f32_16x16x32_bf16 v[32:35], a[200:203], v[40:43], v[32:35]
    ds_read_b128 v[40:43], v3 offset:20480
    v_fma_f32 v10, -v68, v58, v10
    v_mfma_f32_16x16x32_bf16 v[32:35], a[212:215], v[44:47], v[32:35]
    ds_read_b128 v[44:47], v3 offset:21504
    s_waitcnt lgkmcnt(2)
    v_mfma_f32_16x16x32_bf16 v[32:35], a[224:227], v[48:51], v[32:35]
    buffer_load_dwordx4 v1, s[8:11], s37 offen offset:2048 sc1 lds
    v_mfma_f32_16x16x32_bf16 v[32:35], a[236:239], v[52:55], v[32:35]
    v_permlane32_swap_b32 v22, v23
    v_mfma_f32_16x16x32_bf16 v[28:31], a[232:235], v[52:55], v[28:31]
    v_add_f32 v22, v22, v23
    v_fma_f32 v11, -v68, v59, v11
    v_mfma_f32_16x16x32_bf16 v[28:31], a[220:223], v[48:51], v[28:31]
    v_rcp_f32 v22, v22
    v_mfma_f32_16x16x32_bf16 v[24:27], a[216:219], v[48:51], v[24:27]
    ds_read_b128 v[48:51], v3 offset:22528
    v_mul_f32 v122, v122, v22
    v_mfma_f32_16x16x32_bf16 v[24:27], a[228:231], v[52:55], v[24:27]
    ds_read_b128 v[52:55], v3 offset:23552
    s_waitcnt lgkmcnt(2)
    v_mfma_f32_16x16x32_bf16 v[24:27], a[240:243], v[40:43], v[24:27]
    buffer_load_dwordx4 v1, s[8:11], s37 offen offset:3072 sc1 lds
    v_mfma_f32_16x16x32_bf16 v[24:27], a[252:255], v[44:47], v[24:27]
    s_add_u32 m0, s34, 8192
    v_mul_f32 v123, v123, v22
    v_cvt_pk_bf16_f32 v23, v122, v123
    v_mfma_f32_16x16x32_bf16 v[28:31], v[128:131], v[44:47], v[28:31]
    s_add_u32 s37, s33, 8192
    v_perm_b32 v114, v23, v23, v102
    v_perm_b32 v115, v23, v23, v103
    v_mfma_f32_16x16x32_bf16 v[28:31], a[244:247], v[40:43], v[28:31]
    v_perm_b32 v116, v23, v23, v104
    v_perm_b32 v117, v23, v23, v105
    v_mfma_f32_16x16x32_bf16 v[32:35], a[248:251], v[40:43], v[32:35]
    ds_read_b128 v[40:43], v3 offset:24576
    v_mov_b32 v100, v94
    v_mfma_f32_16x16x32_bf16 v[32:35], v[132:135], v[44:47], v[32:35]
    ds_read_b128 v[44:47], v3 offset:25600
    s_waitcnt lgkmcnt(2)
    v_mfma_f32_16x16x32_bf16 v[32:35], v[144:147], v[48:51], v[32:35]
    buffer_load_dwordx4 v1, s[8:11], s37 offen offset:0 sc1 lds
    v_mfma_f32_16x16x32_bf16 v[32:35], v[156:159], v[52:55], v[32:35]
    v_mov_b32 v101, v95
    v_cvt_pk_bf16_f32 v88, v8, v9
    v_mfma_f32_16x16x32_bf16 v[28:31], v[152:155], v[52:55], v[28:31]
    v_cvt_pk_bf16_f32 v89, v10, v11
    v_add_f32 v76, v76, v80
    v_mfma_f32_16x16x32_bf16 v[72:75], v[98:101], v[114:117], 0
    v_add_f32 v77, v77, v81
    v_add_f32 v78, v78, v82
    v_mfma_f32_16x16x32_bf16 v[110:113], v[84:87], v[88:91], 0
    v_mov_b32 v8, v84
    v_mov_b32 v9, v85
    v_mfma_f32_16x16x32_bf16 v[28:31], v[140:143], v[48:51], v[28:31]
    v_add_f32 v79, v79, v83
    v_add_f32 v70, v76, v78
    v_mfma_f32_16x16x32_bf16 v[24:27], v[136:139], v[48:51], v[24:27]
    ds_read_b128 v[48:51], v3 offset:26624
    v_cvt_pk_bf16_f32 v114, v72, v73
    v_mfma_f32_16x16x32_bf16 v[24:27], v[148:151], v[52:55], v[24:27]
    ds_read_b128 v[52:55], v3 offset:27648
    s_waitcnt lgkmcnt(2)
    v_mfma_f32_16x16x32_bf16 v[24:27], v[160:163], v[40:43], v[24:27]
    v_mov_b32 v10, v92
    v_mov_b32 v11, v93
    v_mfma_f32_16x16x32_bf16 v[24:27], v[172:175], v[44:47], v[24:27]
    buffer_store_dwordx4 v[8:11], v1, s[4:7], s40 offen sc1
    v_cvt_pk_bf16_f32 v115, v74, v75
    v_mfma_f32_16x16x32_bf16 v[28:31], v[176:179], v[44:47], v[28:31]
    s_add_u32 s40, s40, 262144
    v_cvt_pk_bf16_f32 v116, v72, v73
    v_cvt_pk_bf16_f32 v117, v74, v75
    v_mfma_f32_16x16x32_bf16 v[28:31], v[164:167], v[40:43], v[28:31]
    s_add_u32 s41, s41, 262144
    v_permlane32_swap_b32 v114, v116
    v_mfma_f32_16x16x32_bf16 v[32:35], v[168:171], v[40:43], v[32:35]
    ds_read_b128 v[40:43], v3 offset:28672
    v_cndmask_b32 v118, v110, v111, s[44:45]
    v_mfma_f32_16x16x32_bf16 v[32:35], v[180:183], v[44:47], v[32:35]
    ds_read_b128 v[44:47], v3 offset:29696
    s_waitcnt lgkmcnt(2)
    v_mfma_f32_16x16x32_bf16 v[32:35], v[192:195], v[48:51], v[32:35]
    s_add_u32 s31, s31, 1
    v_permlane32_swap_b32 v115, v117
    v_mfma_f32_16x16x32_bf16 v[32:35], v[204:207], v[52:55], v[32:35]
    buffer_store_dwordx4 v[114:117], v7, s[12:15], s36 offen sc1
    v_cndmask_b32 v119, v112, v113, s[44:45]
    v_mfma_f32_16x16x32_bf16 v[28:31], v[200:203], v[52:55], v[28:31]
    s_add_u32 s36, s36, 32768
    v_add_f32 v71, v77, v79
    v_add_u32 v2, s35, v1
    v_mfma_f32_16x16x32_bf16 v[28:31], v[188:191], v[48:51], v[28:31]
    s_sub_u32 s54, s31, 2
    v_mov_b32 v6, s54
    v_mfma_f32_16x16x32_bf16 v[24:27], v[184:187], v[48:51], v[24:27]
    ds_read_b128 v[48:51], v3 offset:30720
    v_mfma_f32_16x16x32_bf16 v[24:27], v[196:199], v[52:55], v[24:27]
    ds_read_b128 v[52:55], v3 offset:31744
    s_waitcnt lgkmcnt(2)
    v_mfma_f32_16x16x32_bf16 v[24:27], v[208:211], v[40:43], v[24:27]
    s_cmp_ge_i32 s31, 30
    s_cselect_b32 s18, 0x1ffff, s18
    s_add_u32 s33, s33, 34816
    v_mfma_f32_16x16x32_bf16 v[24:27], v[220:223], v[44:47], v[24:27]
    s_add_u32 s34, s34, 36864
    v_permlane16_swap_b32 v70, v71
    v_mfma_f32_16x16x32_bf16 v[28:31], v[224:227], v[44:47], v[28:31]
    s_cmp_ge_u32 s34, 147456
    s_cselect_b32 s38, 147456, 0
    v_add_f32 v70, v70, v71
    v_mfma_f32_16x16x32_bf16 v[28:31], v[212:215], v[40:43], v[28:31]
    s_sub_u32 s34, s34, s38
    s_waitcnt vmcnt(12)
    v_cmp_gt_i32 vcc, s32, v5
    v_mfma_f32_16x16x32_bf16 v[32:35], v[216:219], v[40:43], v[32:35]
    ds_read_b128 v[40:43], v2 offset:0
    v_mov_b32 v71, v70
    v_mfma_f32_16x16x32_bf16 v[32:35], v[228:231], v[44:47], v[32:35]
    ds_read_b128 v[44:47], v2 offset:1024
    s_waitcnt lgkmcnt(2)
    v_mfma_f32_16x16x32_bf16 v[32:35], v[240:243], v[48:51], v[32:35]
    s_and_b64 vcc, vcc, s[18:19]
    s_cbranch_scc1 Lqkv_slows10
Lqkv_backs10:
    v_mfma_f32_16x16x32_bf16 v[32:35], v[252:255], v[52:55], v[32:35]
    s_add_u32 s16, s16, 8192
    v_permlane32_swap_b32 v70, v71
    v_mfma_f32_16x16x32_bf16 v[28:31], v[248:251], v[52:55], v[28:31]
    s_and_b32 s16, s16, 524287
    v_add_f32 v70, v70, v71
    v_mul_f32 v70, 0x3a800000, v70
    v_mfma_f32_16x16x32_bf16 v[28:31], v[236:239], v[48:51], v[28:31]
    buffer_load_dword v5, v4, s[4:7], s16 offen sc1
    v_mfma_f32_16x16x32_bf16 v[24:27], v[232:235], v[48:51], v[24:27]
    ds_read_b128 v[48:51], v2 offset:2048
    v_mov_b32 v71, v70
    v_mfma_f32_16x16x32_bf16 v[24:27], v[244:247], v[52:55], v[24:27]
    ds_read_b128 v[52:55], v2 offset:3072
    v_permlane16_swap_b32 v70, v71
    v_fma_f32 v71, -v70, v70, v71
    v_max_f32 v71, 0, v71
    v_add_f32 v71, 0x3727c5ac, v71
    v_rsq_f32 v71, v71
    s_nop 1
    s_branch Lqkv_g00
    .p2align 6
Lqkv_g10:
    s_waitcnt lgkmcnt(2)
    v_mfma_f32_16x16x32_bf16 v[24:27], a[0:3], v[40:43], 0
    s_add_u32 m0, s34, 0
    v_mul_f32 v124, s52, v71
    v_fma_f32 v16, -v68, v64, v16
    v_mfma_f32_16x16x32_bf16 v[24:27], a[12:15], v[44:47], v[24:27]
    s_add_u32 s35, s35, 36864
    v_fma_f32 v12, -v68, v60, v12
    v_fma_f32 v13, -v68, v61, v13
    v_mfma_f32_16x16x32_bf16 v[28:31], a[16:19], v[44:47], 0
    s_cmp_eq_u32 s35, 147456
    s_cselect_b32 s35, 0, s35
    v_fma_f32 v14, -v68, v62, v14
    v_mfma_f32_16x16x32_bf16 v[28:31], a[4:7], v[40:43], v[28:31]
    v_fma_f32 v15, -v68, v63, v15
    v_mul_f32 v12, v12, v69
    v_mfma_f32_16x16x32_bf16 v[32:35], a[8:11], v[40:43], 0
    ds_read_b128 v[40:43], v3 offset:4096
    v_mul_f32 v13, v13, v69
    v_mfma_f32_16x16x32_bf16 v[32:35], a[20:23], v[44:47], v[32:35]
    ds_read_b128 v[44:47], v3 offset:5120
    s_waitcnt lgkmcnt(2)
    v_mfma_f32_16x16x32_bf16 v[32:35], a[32:35], v[48:51], v[32:35]
    v_mul_f32 v14, v14, v69
    v_mul_f32 v15, v15, v69
    v_mfma_f32_16x16x32_bf16 v[32:35], a[44:47], v[52:55], v[32:35]
    v_cvt_pk_bf16_f32 v84, v12, v13
    v_cvt_pk_bf16_f32 v85, v14, v15
    v_mfma_f32_16x16x32_bf16 v[28:31], a[40:43], v[52:55], v[28:31]
    v_fma_f32 v17, -v68, v65, v17
    v_fma_f32 v18, -v68, v66, v18
    v_mfma_f32_16x16x32_bf16 v[106:109], v[84:87], v[88:91], 0
    v_fma_f32 v19, -v68, v67, v19
    v_mul_f32 v16, v16, v69
    v_mfma_f32_16x16x32_bf16 v[28:31], a[28:31], v[48:51], v[28:31]
    v_mul_f32 v17, v17, v69
    v_mul_f32 v18, v18, v69
    v_mfma_f32_16x16x32_bf16 v[24:27], a[24:27], v[48:51], v[24:27]
    ds_read_b128 v[48:51], v3 offset:6144
    v_mul_f32 v19, v19, v69
    v_mfma_f32_16x16x32_bf16 v[24:27], a[36:39], v[52:55], v[24:27]
    ds_read_b128 v[52:55], v3 offset:7168
    s_waitcnt lgkmcnt(2)
    v_mfma_f32_16x16x32_bf16 v[24:27], a[48:51], v[40:43], v[24:27]
    v_cndmask_b32 v106, v106, v107, s[44:45]
    v_cndmask_b32 v108, v108, v109, s[44:45]
    v_mfma_f32_16x16x32_bf16 v[24:27], a[60:63], v[44:47], v[24:27]
    v_cndmask_b32 v120, v106, v118, s[48:49]
    v_cndmask_b32 v121, v108, v119, s[50:51]
    v_mfma_f32_16x16x32_bf16 v[28:31], a[64:67], v[44:47], v[28:31]
    ds_write_b64 v36, v[120:121] offset:2048
    v_mfma_f32_16x16x32_bf16 v[28:31], a[52:55], v[40:43], v[28:31]
    v_cvt_pk_bf16_f32 v16, v16, v17
    v_cvt_pk_bf16_f32 v17, v18, v19
    v_mfma_f32_16x16x32_bf16 v[32:35], a[56:59], v[40:43], v[32:35]
    ds_read_b128 v[40:43], v3 offset:8192
    v_fma_f32 v8, -v68, v56, v8
    v_mfma_f32_16x16x32_bf16 v[32:35], a[68:71], v[44:47], v[32:35]
    ds_read_b128 v[44:47], v3 offset:9216
    s_waitcnt lgkmcnt(3)
    v_mfma_f32_16x16x32_bf16 v[32:35], a[80:83], v[48:51], v[32:35]
    s_waitcnt vmcnt(3) lgkmcnt(2)
    s_barrier
    v_mfma_f32_16x16x32_bf16 v[32:35], a[92:95], v[52:55], v[32:35]
    ds_write_b64 v38, v[16:17]
    v_mfma_f32_16x16x32_bf16 v[28:31], a[88:91], v[52:55], v[28:31]
    ds_read_b64_tr_b16 v[92:93], v39
    v_fma_f32 v9, -v68, v57, v9
    v_mfma_f32_16x16x32_bf16 v[28:31], a[76:79], v[48:51], v[28:31]
    buffer_load_dwordx4 v1, s[8:11], s33 offen offset:0 sc1 lds
    v_mfma_f32_16x16x32_bf16 v[24:27], a[72:75], v[48:51], v[24:27]
    ds_read_b128 v[48:51], v3 offset:10240
    v_fma_f32 v10, -v68, v58, v10
    v_mfma_f32_16x16x32_bf16 v[24:27], a[84:87], v[52:55], v[24:27]
    ds_read_b128 v[52:55], v3 offset:11264
    s_waitcnt lgkmcnt(4)
    v_mfma_f32_16x16x32_bf16 v[24:27], a[96:99], v[40:43], v[24:27]
    s_waitcnt vmcnt(3)
    buffer_store_dword v6, v21, s[12:15], s17 offen sc1
    v_mfma_f32_16x16x32_bf16 v[24:27], a[108:111], v[44:47], v[24:27]
    ds_read_b64 v[122:123], v37 offset:2048
    v_fma_f32 v11, -v68, v59, v11
    v_mfma_f32_16x16x32_bf16 v[28:31], a[112:115], v[44:47], v[28:31]
    s_cmp_ge_i32 s54, 0
    s_cselect_b32 s14, s6, 0
    v_cvt_pk_bf16_f32 v88, v8, v9
    v_mfma_f32_16x16x32_bf16 v[28:31], a[100:103], v[40:43], v[28:31]
    s_add_u32 s17, s17, 8192
    v_sub_u32 v76, v3, v20
    v_cvt_pk_bf16_f32 v89, v10, v11
    v_mfma_f32_16x16x32_bf16 v[32:35], a[104:107], v[40:43], v[32:35]
    ds_read_b128 v[40:43], v3 offset:12288
    v_add_u32 v2, s35, v1
    v_mfma_f32_16x16x32_bf16 v[110:113], v[84:87], v[88:91], 0
    buffer_load_dwordx4 v1, s[8:11], s33 offen offset:1024 sc1 lds
    v_mfma_f32_16x16x32_bf16 v[32:35], a[116:119], v[44:47], v[32:35]
    ds_read_b128 v[44:47], v3 offset:13312
    s_waitcnt lgkmcnt(2)
    v_mfma_f32_16x16x32_bf16 v[32:35], a[128:131], v[48:51], v[32:35]
    ds_read2st64_b64 v[80:83], v76 offset0:66 offset1:67
    v_add_f32 v122, v122, v120
    v_mfma_f32_16x16x32_bf16 v[32:35], a[140:143], v[52:55], v[32:35]
    ds_read2st64_b64 v[76:79], v76 offset0:64 offset1:65
    v_add_f32 v123, v123, v121
    v_mfma_f32_16x16x32_bf16 v[28:31], a[136:139], v[52:55], v[28:31]
    v_max_f32 v22, v122, v123
    v_mov_b32 v23, v22
    v_mfma_f32_16x16x32_bf16 v[28:31], a[124:127], v[48:51], v[28:31]
    buffer_load_dwordx4 v1, s[8:11], s33 offen offset:2048 sc1 lds
    v_mfma_f32_16x16x32_bf16 v[24:27], a[120:123], v[48:51], v[24:27]
    ds_read_b128 v[48:51], v3 offset:14336
    v_cndmask_b32 v118, v110, v111, s[44:45]
    v_mfma_f32_16x16x32_bf16 v[24:27], a[132:135], v[52:55], v[24:27]
    ds_read_b128 v[52:55], v3 offset:15360
    s_waitcnt lgkmcnt(4)
    v_mfma_f32_16x16x32_bf16 v[24:27], a[144:147], v[40:43], v[24:27]
    v_permlane16_swap_b32 v22, v23
    v_mfma_f32_16x16x32_bf16 v[24:27], a[156:159], v[44:47], v[24:27]
    v_max_f32 v22, v22, v23
    v_mov_b32 v23, v22
    v_mfma_f32_16x16x32_bf16 v[28:31], a[160:163], v[44:47], v[28:31]
    buffer_load_dwordx4 v1, s[8:11], s33 offen offset:3072 sc1 lds
    v_mfma_f32_16x16x32_bf16 v[28:31], a[148:151], v[40:43], v[28:31]
    s_add_u32 m0, s34, 4096
    v_permlane32_swap_b32 v22, v23
    v_mfma_f32_16x16x32_bf16 v[32:35], a[152:155], v[40:43], v[32:35]
    ds_read_b128 v[40:43], v3 offset:16384
    v_max_f32 v22, v22, v23
    v_mfma_f32_16x16x32_bf16 v[32:35], a[164:167], v[44:47], v[32:35]
    ds_read_b128 v[44:47], v3 offset:17408
    s_waitcnt lgkmcnt(2)
    v_mfma_f32_16x16x32_bf16 v[32:35], a[176:179], v[48:51], v[32:35]
    s_add_u32 s37, s33, 4096
    v_mul_f32 v22, v124, v22
    v_fma_f32 v122, v122, v124, -v22
    v_mfma_f32_16x16x32_bf16 v[32:35], a[188:191], v[52:55], v[32:35]
    buffer_load_dwordx4 v1, s[8:11], s37 offen offset:0 sc1 lds
    v_mfma_f32_16x16x32_bf16 v[28:31], a[184:187], v[52:55], v[28:31]
    v_fma_f32 v123, v123, v124, -v22
    v_cndmask_b32 v119, v112, v113, s[44:45]
    v_mfma_f32_16x16x32_bf16 v[28:31], a[172:175], v[48:51], v[28:31]
    v_exp_f32 v122, v122
    v_mfma_f32_16x16x32_bf16 v[24:27], a[168:171], v[48:51], v[24:27]
    ds_read_b128 v[48:51], v3 offset:18432
    v_add_f32 v76, v76, v80
    v_mfma_f32_16x16x32_bf16 v[24:27], a[180:183], v[52:55], v[24:27]
    ds_read_b128 v[52:55], v3 offset:19456
    s_waitcnt lgkmcnt(2)
    v_mfma_f32_16x16x32_bf16 v[24:27], a[192:195], v[40:43], v[24:27]
    buffer_load_dwordx4 v1, s[8:11], s37 offen offset:1024 sc1 lds
    v_mfma_f32_16x16x32_bf16 v[24:27], a[204:207], v[44:47], v[24:27]
    v_exp_f32 v123, v123
    v_mfma_f32_16x16x32_bf16 v[28:31], a[208:211], v[44:47], v[28:31]
    v_add_f32 v22, v122, v123
    v_mov_b32 v23, v22
    v_mfma_f32_16x16x32_bf16 v[28:31], a[196:199], v[40:43], v[28:31]
    s_nop 0
    v_permlane16_swap_b32 v22, v23
    v_mfma_f32_16x16x32_bf16 v[32:35], a[200:203], v[40:43], v[32:35]
    ds_read_b128 v[40:43], v3 offset:20480
    v_add_f32 v22, v22, v23
    v_mfma_f32_16x16x32_bf16 v[32:35], a[212:215], v[44:47], v[32:35]
    ds_read_b128 v[44:47], v3 offset:21504
    s_waitcnt lgkmcnt(2)
    v_mfma_f32_16x16x32_bf16 v[32:35], a[224:227], v[48:51], v[32:35]
    buffer_load_dwordx4 v1, s[8:11], s37 offen offset:2048 sc1 lds
    v_mfma_f32_16x16x32_bf16 v[32:35], a[236:239], v[52:55], v[32:35]
    v_mov_b32 v23, v22
    v_add_f32 v77, v77, v81
    v_mfma_f32_16x16x32_bf16 v[28:31], a[232:235], v[52:55], v[28:31]
    v_permlane32_swap_b32 v22, v23
    v_mfma_f32_16x16x32_bf16 v[28:31], a[220:223], v[48:51], v[28:31]
    v_add_f32 v22, v22, v23
    v_add_f32 v78, v78, v82
    v_mfma_f32_16x16x32_bf16 v[24:27], a[216:219], v[48:51], v[24:27]
    ds_read_b128 v[48:51], v3 offset:22528
    v_add_f32 v79, v79, v83
    v_mfma_f32_16x16x32_bf16 v[24:27], a[228:231], v[52:55], v[24:27]
    ds_read_b128 v[52:55], v3 offset:23552
    s_waitcnt lgkmcnt(2)
    v_mfma_f32_16x16x32_bf16 v[24:27], a[240:243], v[40:43], v[24:27]
    buffer_load_dwordx4 v1, s[8:11], s37 offen offset:3072 sc1 lds
    v_mfma_f32_16x16x32_bf16 v[24:27], a[252:255], v[44:47], v[24:27]
    s_add_u32 m0, s34, 8192
    v_rcp_f32 v22, v22
    v_mfma_f32_16x16x32_bf16 v[28:31], v[128:131], v[44:47], v[28:31]
    s_add_u32 s37, s33, 8192
    v_mul_f32 v122, v122, v22
    v_mul_f32 v123, v123, v22
    v_mfma_f32_16x16x32_bf16 v[28:31], a[244:247], v[40:43], v[28:31]
    v_cvt_pk_bf16_f32 v23, v122, v123
    v_perm_b32 v114, v23, v23, v102
    v_mfma_f32_16x16x32_bf16 v[32:35], a[248:251], v[40:43], v[32:35]
    ds_read_b128 v[40:43], v3 offset:24576
    v_perm_b32 v115, v23, v23, v103
    v_mfma_f32_16x16x32_bf16 v[32:35], v[132:135], v[44:47], v[32:35]
    ds_read_b128 v[44:47], v3 offset:25600
    s_waitcnt lgkmcnt(2)
    v_mfma_f32_16x16x32_bf16 v[32:35], v[144:147], v[48:51], v[32:35]
    buffer_load_dwordx4 v1, s[8:11], s37 offen offset:0 sc1 lds
    v_mfma_f32_16x16x32_bf16 v[32:35], v[156:159], v[52:55], v[32:35]
    v_perm_b32 v116, v23, v23, v104
    v_perm_b32 v117, v23, v23, v105
    v_mfma_f32_16x16x32_bf16 v[28:31], v[152:155], v[52:55], v[28:31]
    v_add_f32 v70, v76, v78
    v_add_f32 v71, v77, v79
    v_mfma_f32_16x16x32_bf16 v[72:75], v[92:95], v[114:117], 0
    s_nop 0
    v_permlane16_swap_b32 v70, v71
    v_mfma_f32_16x16x32_bf16 v[28:31], v[140:143], v[48:51], v[28:31]
    v_add_f32 v70, v70, v71
    v_mov_b32 v71, v70
    v_mfma_f32_16x16x32_bf16 v[24:27], v[136:139], v[48:51], v[24:27]
    ds_read_b128 v[48:51], v3 offset:26624
    v_mfma_f32_16x16x32_bf16 v[24:27], v[148:151], v[52:55], v[24:27]
    ds_read_b128 v[52:55], v3 offset:27648
    s_waitcnt lgkmcnt(2)
    v_mfma_f32_16x16x32_bf16 v[24:27], v[160:163], v[40:43], v[24:27]
    v_cvt_pk_bf16_f32 v114, v72, v73
    v_cvt_pk_bf16_f32 v115, v74, v75
    v_mfma_f32_16x16x32_bf16 v[24:27], v[172:175], v[44:47], v[24:27]
    v_cvt_pk_bf16_f32 v116, v72, v73
    v_cvt_pk_bf16_f32 v117, v74, v75
    v_mfma_f32_16x16x32_bf16 v[28:31], v[176:179], v[44:47], v[28:31]
    v_permlane32_swap_b32 v114, v116
    v_mfma_f32_16x16x32_bf16 v[28:31], v[164:167], v[40:43], v[28:31]
    s_add_u32 s31, s31, 1
    v_permlane32_swap_b32 v115, v117
    v_mfma_f32_16x16x32_bf16 v[32:35], v[168:171], v[40:43], v[32:35]
    ds_read_b128 v[40:43], v3 offset:28672
    s_sub_u32 s54, s31, 2
    v_mfma_f32_16x16x32_bf16 v[32:35], v[180:183], v[44:47], v[32:35]
    ds_read_b128 v[44:47], v3 offset:29696
    s_waitcnt lgkmcnt(2)
    v_mfma_f32_16x16x32_bf16 v[32:35], v[192:195], v[48:51], v[32:35]
    buffer_store_dwordx4 v[114:117], v7, s[12:15], s36 offen sc1
    v_mov_b32 v6, s54
    v_mfma_f32_16x16x32_bf16 v[32:35], v[204:207], v[52:55], v[32:35]
    s_add_u32 s36, s36, 32768
    v_permlane32_swap_b32 v70, v71
    v_mfma_f32_16x16x32_bf16 v[28:31], v[200:203], v[52:55], v[28:31]
    s_cmp_ge_i32 s31, 30
    s_cselect_b32 s18, 0x1ffff, s18
    v_add_f32 v70, v70, v71
    v_mfma_f32_16x16x32_bf16 v[28:31], v[188:191], v[48:51], v[28:31]
    s_add_u32 s33, s33, 34816
    v_mul_f32 v70, 0x3a800000, v70
    v_mov_b32 v71, v70
    v_mfma_f32_16x16x32_bf16 v[24:27], v[184:187], v[48:51], v[24:27]
    ds_read_b128 v[48:51], v3 offset:30720
    s_add_u32 s34, s34, 36864
    v_mfma_f32_16x16x32_bf16 v[24:27], v[196:199], v[52:55], v[24:27]
    ds_read_b128 v[52:55], v3 offset:31744
    s_waitcnt lgkmcnt(2)
    v_mfma_f32_16x16x32_bf16 v[24:27], v[208:211], v[40:43], v[24:27]
    s_cmp_ge_u32 s34, 147456
    s_cselect_b32 s38, 147456, 0
    s_sub_u32 s34, s34, s38
    v_mfma_f32_16x16x32_bf16 v[24:27], v[220:223], v[44:47], v[24:27]
    s_waitcnt vmcnt(11)
    v_cmp_gt_i32 vcc, s32, v5
    v_mfma_f32_16x16x32_bf16 v[28:31], v[224:227], v[44:47], v[28:31]
    v_permlane16_swap_b32 v70, v71
    v_mfma_f32_16x16x32_bf16 v[28:31], v[212:215], v[40:43], v[28:31]
    s_and_b64 vcc, vcc, s[18:19]
    s_cbranch_scc1 Lqkv_slowg10
Lqkv_backg10:
    v_mfma_f32_16x16x32_bf16 v[32:35], v[216:219], v[40:43], v[32:35]
    ds_read_b128 v[40:43], v2 offset:0
    v_fma_f32 v71, -v70, v70, v71
    v_mfma_f32_16x16x32_bf16 v[32:35], v[228:231], v[44:47], v[32:35]
    ds_read_b128 v[44:47], v2 offset:1024
    s_waitcnt lgkmcnt(2)
    v_mfma_f32_16x16x32_bf16 v[32:35], v[240:243], v[48:51], v[32:35]
    s_add_u32 s16, s16, 8192
    v_max_f32 v71, 0, v71
    v_add_f32 v71, 0x3727c5ac, v71
    v_mfma_f32_16x16x32_bf16 v[32:35], v[252:255], v[52:55], v[32:35]
    s_and_b32 s16, s16, 524287
    v_rsq_f32 v71, v71
    v_mfma_f32_16x16x32_bf16 v[28:31], v[248:251], v[52:55], v[28:31]
    buffer_load_dword v5, v4, s[4:7], s16 offen sc1
    v_mfma_f32_16x16x32_bf16 v[28:31], v[236:239], v[48:51], v[28:31]
    v_mfma_f32_16x16x32_bf16 v[24:27], v[232:235], v[48:51], v[24:27]
    ds_read_b128 v[48:51], v2 offset:2048
    v_mfma_f32_16x16x32_bf16 v[24:27], v[244:247], v[52:55], v[24:27]
    ds_read_b128 v[52:55], v2 offset:3072
    s_cmp_eq_u32 s31, 64
    s_cbranch_scc1 Lqkv_tail
Lqkv_g00:
    s_waitcnt lgkmcnt(2)
    v_mfma_f32_16x16x32_bf16 v[8:11], a[0:3], v[40:43], 0
    s_add_u32 m0, s34, 0
    v_mul_f32 v124, s52, v69
    v_fma_f32 v32, -v70, v64, v32
    v_mfma_f32_16x16x32_bf16 v[8:11], a[12:15], v[44:47], v[8:11]
    s_add_u32 s35, s35, 36864
    v_fma_f32 v28, -v70, v60, v28
    v_fma_f32 v29, -v70, v61, v29
    v_mfma_f32_16x16x32_bf16 v[12:15], a[16:19], v[44:47], 0
    s_cmp_eq_u32 s35, 147456
    s_cselect_b32 s35, 0, s35
    v_fma_f32 v30, -v70, v62, v30
    v_mfma_f32_16x16x32_bf16 v[12:15], a[4:7], v[40:43], v[12:15]
    v_fma_f32 v31, -v70, v63, v31
    v_mul_f32 v28, v28, v71
    v_mfma_f32_16x16x32_bf16 v[16:19], a[8:11], v[40:43], 0
    ds_read_b128 v[40:43], v2 offset:4096
    v_mul_f32 v29, v29, v71
    v_mfma_f32_16x16x32_bf16 v[16:19], a[20:23], v[44:47], v[16:19]
    ds_read_b128 v[44:47], v2 offset:5120
    s_waitcnt lgkmcnt(2)
    v_mfma_f32_16x16x32_bf16 v[16:19], a[32:35], v[48:51], v[16:19]
    v_mul_f32 v30, v30, v71
    v_mul_f32 v31, v31, v71
    v_mfma_f32_16x16x32_bf16 v[16:19], a[44:47], v[52:55], v[16:19]
    v_cvt_pk_bf16_f32 v84, v28, v29
    v_cvt_pk_bf16_f32 v85, v30, v31
    v_mfma_f32_16x16x32_bf16 v[12:15], a[40:43], v[52:55], v[12:15]
    v_fma_f32 v33, -v70, v65, v33
    v_fma_f32 v34, -v70, v66, v34
    v_mfma_f32_16x16x32_bf16 v[106:109], v[84:87], v[88:91], 0
    v_fma_f32 v35, -v70, v67, v35
    v_mul_f32 v32, v32, v71
    v_mfma_f32_16x16x32_bf16 v[12:15], a[28:31], v[48:51], v[12:15]
    v_mul_f32 v33, v33, v71
    v_mul_f32 v34, v34, v71
    v_mfma_f32_16x16x32_bf16 v[8:11], a[24:27], v[48:51], v[8:11]
    ds_read_b128 v[48:51], v2 offset:6144
    v_mul_f32 v35, v35, v71
    v_mfma_f32_16x16x32_bf16 v[8:11], a[36:39], v[52:55], v[8:11]
    ds_read_b128 v[52:55], v2 offset:7168
    s_waitcnt lgkmcnt(2)
    v_mfma_f32_16x16x32_bf16 v[8:11], a[48:51], v[40:43], v[8:11]
    v_cndmask_b32 v106, v106, v107, s[44:45]
    v_cndmask_b32 v108, v108, v109, s[44:45]
    v_mfma_f32_16x16x32_bf16 v[8:11], a[60:63], v[44:47], v[8:11]
    v_cndmask_b32 v120, v106, v118, s[48:49]
    v_cndmask_b32 v121, v108, v119, s[50:51]
    v_mfma_f32_16x16x32_bf16 v[12:15], a[64:67], v[44:47], v[12:15]
    ds_write_b64 v36, v[120:121] offset:0
    v_mfma_f32_16x16x32_bf16 v[12:15], a[52:55], v[40:43], v[12:15]
    v_cvt_pk_bf16_f32 v32, v32, v33
    v_cvt_pk_bf16_f32 v33, v34, v35
    v_mfma_f32_16x16x32_bf16 v[16:19], a[56:59], v[40:43], v[16:19]
    ds_read_b128 v[40:43], v2 offset:8192
    v_fma_f32 v24, -v70, v56, v24
    v_mfma_f32_16x16x32_bf16 v[16:19], a[68:71], v[44:47], v[16:19]
    ds_read_b128 v[44:47], v2 offset:9216
    s_waitcnt lgkmcnt(3)
    v_mfma_f32_16x16x32_bf16 v[16:19], a[80:83], v[48:51], v[16:19]
    s_waitcnt vmcnt(2) lgkmcnt(2)
    s_barrier
    v_mfma_f32_16x16x32_bf16 v[16:19], a[92:95], v[52:55], v[16:19]
    ds_write_b64 v38, v[32:33]
    v_mfma_f32_16x16x32_bf16 v[12:15], a[88:91], v[52:55], v[12:15]
    ds_read_b64_tr_b16 v[94:95], v39
    v_fma_f32 v25, -v70, v57, v25
    v_mfma_f32_16x16x32_bf16 v[12:15], a[76:79], v[48:51], v[12:15]
    buffer_load_dwordx4 v1, s[8:11], s33 offen offset:0 sc1 lds
    v_mfma_f32_16x16x32_bf16 v[8:11], a[72:75], v[48:51], v[8:11]
    ds_read_b128 v[48:51], v2 offset:10240
    v_fma_f32 v26, -v70, v58, v26
    v_mfma_f32_16x16x32_bf16 v[8:11], a[84:87], v[52:55], v[8:11]
    ds_read_b128 v[52:55], v2 offset:11264
    s_waitcnt lgkmcnt(4)
    v_mfma_f32_16x16x32_bf16 v[8:11], a[96:99], v[40:43], v[8:11]
    s_waitcnt vmcnt(2)
    buffer_store_dword v6, v21, s[12:15], s17 offen sc1
    v_mfma_f32_16x16x32_bf16 v[8:11], a[108:111], v[44:47], v[8:11]
    ds_read_b64 v[122:123], v37 offset:0
    v_fma_f32 v27, -v70, v59, v27
    v_mfma_f32_16x16x32_bf16 v[12:15], a[112:115], v[44:47], v[12:15]
    s_cmp_ge_i32 s54, 0
    s_cselect_b32 s14, s6, 0
    v_cvt_pk_bf16_f32 v88, v24, v25
    v_mfma_f32_16x16x32_bf16 v[12:15], a[100:103], v[40:43], v[12:15]
    s_add_u32 s17, s17, 8192
    v_sub_u32 v76, v2, v20
    v_cvt_pk_bf16_f32 v89, v26, v27
    v_mfma_f32_16x16x32_bf16 v[16:19], a[104:107], v[40:43], v[16:19]
    ds_read_b128 v[40:43], v2 offset:12288
    v_add_u32 v3, s35, v1
    v_mfma_f32_16x16x32_bf16 v[110:113], v[84:87], v[88:91], 0
    buffer_load_dwordx4 v1, s[8:11], s33 offen offset:1024 sc1 lds
    v_mfma_f32_16x16x32_bf16 v[16:19], a[116:119], v[44:47], v[16:19]
    ds_read_b128 v[44:47], v2 offset:13312
    s_waitcnt lgkmcnt(2)
    v_mfma_f32_16x16x32_bf16 v[16:19], a[128:131], v[48:51], v[16:19]
    ds_read2st64_b64 v[80:83], v76 offset0:66 offset1:67
    v_add_f32 v122, v122, v120
    v_mfma_f32_16x16x32_bf16 v[16:19], a[140:143], v[52:55], v[16:19]
    ds_read2st64_b64 v[76:79], v76 offset0:64 offset1:65
    v_add_f32 v123, v123, v121
    v_mfma_f32_16x16x32_bf16 v[12:15], a[136:139], v[52:55], v[12:15]
    v_max_f32 v22, v122, v123
    v_mov_b32 v23, v22
    v_mfma_f32_16x16x32_bf16 v[12:15], a[124:127], v[48:51], v[12:15]
    buffer_load_dwordx4 v1, s[8:11], s33 offen offset:2048 sc1 lds
    v_mfma_f32_16x16x32_bf16 v[8:11], a[120:123], v[48:51], v[8:11]
    ds_read_b128 v[48:51], v2 offset:14336
    v_cndmask_b32 v118, v110, v111, s[44:45]
    v_mfma_f32_16x16x32_bf16 v[8:11], a[132:135], v[52:55], v[8:11]
    ds_read_b128 v[52:55], v2 offset:15360
    s_waitcnt lgkmcnt(4)
    v_mfma_f32_16x16x32_bf16 v[8:11], a[144:147], v[40:43], v[8:11]
    v_permlane16_swap_b32 v22, v23
    v_mfma_f32_16x16x32_bf16 v[8:11], a[156:159], v[44:47], v[8:11]
    v_max_f32 v22, v22, v23
    v_mov_b32 v23, v22
    v_mfma_f32_16x16x32_bf16 v[12:15], a[160:163], v[44:47], v[12:15]
    buffer_load_dwordx4 v1, s[8:11], s33 offen offset:3072 sc1 lds
    v_mfma_f32_16x16x32_bf16 v[12:15], a[148:151], v[40:43], v[12:15]
    s_add_u32 m0, s34, 4096
    v_permlane32_swap_b32 v22, v23
    v_mfma_f32_16x16x32_bf16 v[16:19], a[152:155], v[40:43], v[16:19]
    ds_read_b128 v[40:43], v2 offset:16384
    v_max_f32 v22, v22, v23
    v_mfma_f32_16x16x32_bf16 v[16:19], a[164:167], v[44:47], v[16:19]
    ds_read_b128 v[44:47], v2 offset:17408
    s_waitcnt lgkmcnt(2)
    v_mfma_f32_16x16x32_bf16 v[16:19], a[176:179], v[48:51], v[16:19]
    s_add_u32 s37, s33, 4096
    v_mul_f32 v22, v124, v22
    v_fma_f32 v122, v122, v124, -v22
    v_mfma_f32_16x16x32_bf16 v[16:19], a[188:191], v[52:55], v[16:19]
    buffer_load_dwordx4 v1, s[8:11], s37 offen offset:0 sc1 lds
    v_mfma_f32_16x16x32_bf16 v[12:15], a[184:187], v[52:55], v[12:15]
    v_fma_f32 v123, v123, v124, -v22
    v_cndmask_b32 v119, v112, v113, s[44:45]
    v_mfma_f32_16x16x32_bf16 v[12:15], a[172:175], v[48:51], v[12:15]
    v_exp_f32 v122, v122
    v_mfma_f32_16x16x32_bf16 v[8:11], a[168:171], v[48:51], v[8:11]
    ds_read_b128 v[48:51], v2 offset:18432
    v_add_f32 v76, v76, v80
    v_mfma_f32_16x16x32_bf16 v[8:11], a[180:183], v[52:55], v[8:11]
    ds_read_b128 v[52:55], v2 offset:19456
    s_waitcnt lgkmcnt(2)
    v_mfma_f32_16x16x32_bf16 v[8:11], a[192:195], v[40:43], v[8:11]
    buffer_load_dwordx4 v1, s[8:11], s37 offen offset:1024 sc1 lds
    v_mfma_f32_16x16x32_bf16 v[8:11], a[204:207], v[44:47], v[8:11]
    v_exp_f32 v123, v123
    v_mfma_f32_16x16x32_bf16 v[12:15], a[208:211], v[44:47], v[12:15]
    v_add_f32 v22, v122, v123
    v_mov_b32 v23, v22
    v_mfma_f32_16x16x32_bf16 v[12:15], a[196:199], v[40:43], v[12:15]
    s_nop 0
    v_permlane16_swap_b32 v22, v23
    v_mfma_f32_16x16x32_bf16 v[16:19], a[200:203], v[40:43], v[16:19]
    ds_read_b128 v[40:43], v2 offset:20480
    v_add_f32 v22, v22, v23
    v_mfma_f32_16x16x32_bf16 v[16:19], a[212:215], v[44:47], v[16:19]
    ds_read_b128 v[44:47], v2 offset:21504
    s_waitcnt lgkmcnt(2)
    v_mfma_f32_16x16x32_bf16 v[16:19], a[224:227], v[48:51], v[16:19]
    buffer_load_dwordx4 v1, s[8:11], s37 offen offset:2048 sc1 lds
    v_mfma_f32_16x16x32_bf16 v[16:19], a[236:239], v[52:55], v[16:19]
    v_mov_b32 v23, v22
    v_add_f32 v77, v77, v81
    v_mfma_f32_16x16x32_bf16 v[12:15], a[232:235], v[52:55], v[12:15]
    v_permlane32_swap_b32 v22, v23
    v_mfma_f32_16x16x32_bf16 v[12:15], a[220:223], v[48:51], v[12:15]
    v_add_f32 v22, v22, v23
    v_add_f32 v78, v78, v82
    v_mfma_f32_16x16x32_bf16 v[8:11], a[216:219], v[48:51], v[8:11]
    ds_read_b128 v[48:51], v2 offset:22528
    v_add_f32 v79, v79, v83
    v_mfma_f32_16x16x32_bf16 v[8:11], a[228:231], v[52:55], v[8:11]
    ds_read_b128 v[52:55], v2 offset:23552
    s_waitcnt lgkmcnt(2)
    v_mfma_f32_16x16x32_bf16 v[8:11], a[240:243], v[40:43], v[8:11]
    buffer_load_dwordx4 v1, s[8:11], s37 offen offset:3072 sc1 lds
    v_mfma_f32_16x16x32_bf16 v[8:11], a[252:255], v[44:47], v[8:11]
    s_add_u32 m0, s34, 8192
    v_rcp_f32 v22, v22
    v_mfma_f32_16x16x32_bf16 v[12:15], v[128:131], v[44:47], v[12:15]
    s_add_u32 s37, s33, 8192
    v_mul_f32 v122, v122, v22
    v_mul_f32 v123, v123, v22
    v_mfma_f32_16x16x32_bf16 v[12:15], a[244:247], v[40:43], v[12:15]
    v_cvt_pk_bf16_f32 v23, v122, v123
    v_perm_b32 v116, v23, v23, v102
    v_mfma_f32_16x16x32_bf16 v[16:19], a[248:251], v[40:43], v[16:19]
    ds_read_b128 v[40:43], v2 offset:24576
    v_perm_b32 v117, v23, v23, v103
    v_mfma_f32_16x16x32_bf16 v[16:19], v[132:135], v[44:47], v[16:19]
    ds_read_b128 v[44:47], v2 offset:25600
    s_waitcnt lgkmcnt(2)
    v_mfma_f32_16x16x32_bf16 v[16:19], v[144:147], v[48:51], v[16:19]
    buffer_load_dwordx4 v1, s[8:11], s37 offen offset:0 sc1 lds
    v_mfma_f32_16x16x32_bf16 v[16:19], v[156:159], v[52:55], v[16:19]
    v_perm_b32 v114, v23, v23, v104
    v_perm_b32 v115, v23, v23, v105
    v_mfma_f32_16x16x32_bf16 v[12:15], v[152:155], v[52:55], v[12:15]
    v_add_f32 v68, v76, v78
    v_add_f32 v69, v77, v79
    v_mfma_f32_16x16x32_bf16 v[72:75], v[92:95], v[114:117], 0
    s_nop 0
    v_permlane16_swap_b32 v68, v69
    v_mfma_f32_16x16x32_bf16 v[12:15], v[140:143], v[48:51], v[12:15]
    v_add_f32 v68, v68, v69
    v_mov_b32 v69, v68
    v_mfma_f32_16x16x32_bf16 v[8:11], v[136:139], v[48:51], v[8:11]
    ds_read_b128 v[48:51], v2 offset:26624
    v_mfma_f32_16x16x32_bf16 v[8:11], v[148:151], v[52:55], v[8:11]
    ds_read_b128 v[52:55], v2 offset:27648
    s_waitcnt lgkmcnt(2)
    v_mfma_f32_16x16x32_bf16 v[8:11], v[160:163], v[40:43], v[8:11]
    v_cvt_pk_bf16_f32 v114, v72, v73
    v_cvt_pk_bf16_f32 v115, v74, v75
    v_mfma_f32_16x16x32_bf16 v[8:11], v[172:175], v[44:47], v[8:11]
    v_cvt_pk_bf16_f32 v116, v72, v73
    v_cvt_pk_bf16_f32 v117, v74, v75
    v_mfma_f32_16x16x32_bf16 v[12:15], v[176:179], v[44:47], v[12:15]
    v_permlane32_swap_b32 v114, v116
    v_mfma_f32_16x16x32_bf16 v[12:15], v[164:167], v[40:43], v[12:15]
    s_add_u32 s31, s31, 1
    v_permlane32_swap_b32 v115, v117
    v_mfma_f32_16x16x32_bf16 v[16:19], v[168:171], v[40:43], v[16:19]
    ds_read_b128 v[40:43], v2 offset:28672
    s_sub_u32 s54, s31, 2
    v_mfma_f32_16x16x32_bf16 v[16:19], v[180:183], v[44:47], v[16:19]
    ds_read_b128 v[44:47], v2 offset:29696
    s_waitcnt lgkmcnt(2)
    v_mfma_f32_16x16x32_bf16 v[16:19], v[192:195], v[48:51], v[16:19]
    buffer_store_dwordx4 v[114:117], v7, s[12:15], s36 offen sc1
    v_mov_b32 v6, s54
    v_mfma_f32_16x16x32_bf16 v[16:19], v[204:207], v[52:55], v[16:19]
    s_add_u32 s36, s36, 32768
    v_permlane32_swap_b32 v68, v69
    v_mfma_f32_16x16x32_bf16 v[12:15], v[200:203], v[52:55], v[12:15]
    s_cmp_ge_i32 s31, 30
    s_cselect_b32 s18, 0x1ffff, s18
    v_add_f32 v68, v68, v69
    v_mfma_f32_16x16x32_bf16 v[12:15], v[188:191], v[48:51], v[12:15]
    s_add_u32 s33, s33, 34816
    v_mul_f32 v68, 0x3a800000, v68
    v_mov_b32 v69, v68
    v_mfma_f32_16x16x32_bf16 v[8:11], v[184:187], v[48:51], v[8:11]
    ds_read_b128 v[48:51], v2 offset:30720
    s_add_u32 s34, s34, 36864
    v_mfma_f32_16x16x32_bf16 v[8:11], v[196:199], v[52:55], v[8:11]
    ds_read_b128 v[52:55], v2 offset:31744
    s_waitcnt lgkmcnt(2)
    v_mfma_f32_16x16x32_bf16 v[8:11], v[208:211], v[40:43], v[8:11]
    s_cmp_ge_u32 s34, 147456
    s_cselect_b32 s38, 147456, 0
    s_sub_u32 s34, s34, s38
    v_mfma_f32_16x16x32_bf16 v[8:11], v[220:223], v[44:47], v[8:11]
    buffer_load_dwordx4 v[96:99], v1, s[24:27], s41 offen sc1
    v_mfma_f32_16x16x32_bf16 v[12:15], v[224:227], v[44:47], v[12:15]
    s_waitcnt vmcnt(12)
    v_cmp_gt_i32 vcc, s32, v5
    v_mfma_f32_16x16x32_bf16 v[12:15], v[212:215], v[40:43], v[12:15]
    v_permlane16_swap_b32 v68, v69
    v_mfma_f32_16x16x32_bf16 v[16:19], v[216:219], v[40:43], v[16:19]
    ds_read_b128 v[40:43], v3 offset:0
    v_fma_f32 v69, -v68, v68, v69
    v_mfma_f32_16x16x32_bf16 v[16:19], v[228:231], v[44:47], v[16:19]
    ds_read_b128 v[44:47], v3 offset:1024
    s_waitcnt lgkmcnt(2)
    v_mfma_f32_16x16x32_bf16 v[16:19], v[240:243], v[48:51], v[16:19]
    s_and_b64 vcc, vcc, s[18:19]
    s_cbranch_scc1 Lqkv_slowg00
Lqkv_backg00:
    v_mfma_f32_16x16x32_bf16 v[16:19], v[252:255], v[52:55], v[16:19]
    s_add_u32 s16, s16, 8192
    v_max_f32 v69, 0, v69
    v_add_f32 v69, 0x3727c5ac, v69
    v_mfma_f32_16x16x32_bf16 v[12:15], v[248:251], v[52:55], v[12:15]
    s_and_b32 s16, s16, 524287
    v_rsq_f32 v69, v69
    v_mfma_f32_16x16x32_bf16 v[12:15], v[236:239], v[48:51], v[12:15]
    buffer_load_dword v5, v4, s[4:7], s16 offen sc1
    v_mfma_f32_16x16x32_bf16 v[8:11], v[232:235], v[48:51], v[8:11]
    ds_read_b128 v[48:51], v3 offset:2048
    v_mfma_f32_16x16x32_bf16 v[8:11], v[244:247], v[52:55], v[8:11]
    ds_read_b128 v[52:55], v3 offset:3072
    s_and_b32 s37, s31, 30
    s_cbranch_scc1 Lqkv_g10
    s_branch Lqkv_s10
Lqkv_slows10:
Lqkv_spins10:
    buffer_load_dword v5, v4, s[4:7], s16 offen sc1
    s_waitcnt vmcnt(0)
    v_cmp_gt_i32 vcc, s32, v5
    s_sub_u32 s43, s43, 1
    s_cmp_lt_i32 s43, 0
    s_cbranch_scc1 Lqkv_backs10
    s_and_b64 vcc, vcc, s[18:19]
    s_cbranch_scc0 Lqkv_backs10
    s_sleep 8
    s_branch Lqkv_spins10
Lqkv_slowg10:
Lqkv_sping10:
    buffer_load_dword v5, v4, s[4:7], s16 offen sc1
    s_waitcnt vmcnt(0)
    v_cmp_gt_i32 vcc, s32, v5
    s_sub_u32 s43, s43, 1
    s_cmp_lt_i32 s43, 0
    s_cbranch_scc1 Lqkv_backg10
    s_and_b64 vcc, vcc, s[18:19]
    s_cbranch_scc0 Lqkv_backg10
    s_sleep 8
    s_branch Lqkv_sping10
Lqkv_slowg00:
Lqkv_sping00:
    buffer_load_dword v5, v4, s[4:7], s16 offen sc1
    s_waitcnt vmcnt(0)
    v_cmp_gt_i32 vcc, s32, v5
    s_sub_u32 s43, s43, 1
    s_cmp_lt_i32 s43, 0
    s_cbranch_scc1 Lqkv_backg00
    s_and_b64 vcc, vcc, s[18:19]
    s_cbranch_scc0 Lqkv_backg00
    s_sleep 8
    s_branch Lqkv_sping00
Lqkv_s11:
    s_waitcnt lgkmcnt(2)
    v_mfma_f32_16x16x32_bf16 v[24:27], a[0:3], v[40:43], 0
    s_add_u32 m0, s34, 0
    v_mul_f32 v124, s52, v71
    v_mov_b32 v106, s42
    v_mfma_f32_16x16x32_bf16 v[24:27], a[12:15], v[44:47], v[24:27]
    s_add_u32 s35, s35, 36864
    v_mov_b32 v107, s42
    v_mov_b32 v108, s42
    v_mfma_f32_16x16x32_bf16 v[28:31], a[16:19], v[44:47], 0
    s_cmp_eq_u32 s35, 147456
    s_cselect_b32 s35, 0, s35
    v_mov_b32 v109, s42
    v_mfma_f32_16x16x32_bf16 v[28:31], a[4:7], v[40:43], v[28:31]
    s_waitcnt vmcnt(1)
    v_fma_f32 v16, -v68, v64, v16
    v_fma_f32 v17, -v68, v65, v17
    v_mfma_f32_16x16x32_bf16 v[106:109], v[96:99], v[88:91], v[106:109]
    v_fma_f32 v18, -v68, v66, v18
    v_fma_f32 v19, -v68, v67, v19
    v_mfma_f32_16x16x32_bf16 v[32:35], a[8:11], v[40:43], 0
    ds_read_b128 v[40:43], v3 offset:4096
    v_mul_f32 v16, v16, v69
    v_mfma_f32_16x16x32_bf16 v[32:35], a[20:23], v[44:47], v[32:35]
    ds_read_b128 v[44:47], v3 offset:5120
    s_waitcnt lgkmcnt(2)
    v_mfma_f32_16x16x32_bf16 v[32:35], a[32:35], v[48:51], v[32:35]
    v_cndmask_b32 v106, v106, v107, s[44:45]
    v_cndmask_b32 v108, v108, v109, s[44:45]
    v_mfma_f32_16x16x32_bf16 v[32:35], a[44:47], v[52:55], v[32:35]
    v_cndmask_b32 v120, v106, v118, s[48:49]
    v_cndmask_b32 v121, v108, v119, s[50:51]
    v_mfma_f32_16x16x32_bf16 v[28:31], a[40:43], v[52:55], v[28:31]
    v_mul_f32 v17, v17, v69
    v_mul_f32 v18, v18, v69
    v_mfma_f32_16x16x32_bf16 v[28:31], a[28:31], v[48:51], v[28:31]
    ds_write_b64 v36, v[120:121] offset:2048
    v_mfma_f32_16x16x32_bf16 v[24:27], a[24:27], v[48:51], v[24:27]
    ds_read_b128 v[48:51], v3 offset:6144
    v_mul_f32 v19, v19, v69
    v_mfma_f32_16x16x32_bf16 v[24:27], a[36:39], v[52:55], v[24:27]
    ds_read_b128 v[52:55], v3 offset:7168
    s_waitcnt lgkmcnt(3)
    v_mfma_f32_16x16x32_bf16 v[24:27], a[48:51], v[40:43], v[24:27]
    v_cvt_pk_bf16_f32 v16, v16, v17
    v_cvt_pk_bf16_f32 v17, v18, v19
    v_mfma_f32_16x16x32_bf16 v[24:27], a[60:63], v[44:47], v[24:27]
    s_waitcnt lgkmcnt(2)
    ds_write_b64 v38, v[16:17]
    v_mfma_f32_16x16x32_bf16 v[28:31], a[64:67], v[44:47], v[28:31]
    ds_read_b64_tr_b16 v[92:93], v39
    v_fma_f32 v12, -v68, v60, v12
    v_mfma_f32_16x16x32_bf16 v[28:31], a[52:55], v[40:43], v[28:31]
    buffer_load_dwordx4 v1, s[8:11], s33 offen offset:0 sc1 lds
    v_mfma_f32_16x16x32_bf16 v[32:35], a[56:59], v[40:43], v[32:35]
    ds_read_b128 v[40:43], v3 offset:8192
    v_fma_f32 v13, -v68, v61, v13
    v_mfma_f32_16x16x32_bf16 v[32:35], a[68:71], v[44:47], v[32:35]
    ds_read_b128 v[44:47], v3 offset:9216
    s_waitcnt lgkmcnt(4)
    v_mfma_f32_16x16x32_bf16 v[32:35], a[80:83], v[48:51], v[32:35]
    s_barrier
    v_mfma_f32_16x16x32_bf16 v[32:35], a[92:95], v[52:55], v[32:35]
    ds_read_b64 v[122:123], v37 offset:2048
    v_fma_f32 v14, -v68, v62, v14
    v_mfma_f32_16x16x32_bf16 v[28:31], a[88:91], v[52:55], v[28:31]
    buffer_load_dwordx4 v1, s[8:11], s33 offen offset:1024 sc1 lds
    v_mfma_f32_16x16x32_bf16 v[28:31], a[76:79], v[48:51], v[28:31]
    v_fma_f32 v15, -v68, v63, v15
    v_mul_f32 v12, v12, v69
    v_mfma_f32_16x16x32_bf16 v[24:27], a[72:75], v[48:51], v[24:27]
    ds_read_b128 v[48:51], v3 offset:10240
    v_mul_f32 v13, v13, v69
    v_mfma_f32_16x16x32_bf16 v[24:27], a[84:87], v[52:55], v[24:27]
    ds_read_b128 v[52:55], v3 offset:11264
    s_waitcnt lgkmcnt(3)
    v_mfma_f32_16x16x32_bf16 v[24:27], a[96:99], v[40:43], v[24:27]
    buffer_store_dword v6, v21, s[12:15], s17 offen sc1
    s_waitcnt lgkmcnt(2)
    v_mfma_f32_16x16x32_bf16 v[24:27], a[108:111], v[44:47], v[24:27]
    s_cmp_ge_i32 s54, 0
    s_cselect_b32 s14, s6, 0
    v_add_f32 v122, v122, v120
    v_mfma_f32_16x16x32_bf16 v[28:31], a[112:115], v[44:47], v[28:31]
    s_add_u32 s17, s17, 8192
    v_add_f32 v123, v123, v121
    v_max_f32 v22, v122, v123
    v_mfma_f32_16x16x32_bf16 v[28:31], a[100:103], v[40:43], v[28:31]
    buffer_load_dwordx4 v1, s[8:11], s33 offen offset:2048 sc1 lds
    v_mfma_f32_16x16x32_bf16 v[32:35], a[104:107], v[40:43], v[32:35]
    ds_read_b128 v[40:43], v3 offset:12288
    v_mov_b32 v23, v22
    v_mfma_f32_16x16x32_bf16 v[32:35], a[116:119], v[44:47], v[32:35]
    ds_read_b128 v[44:47], v3 offset:13312
    s_waitcnt lgkmcnt(2)
    v_mfma_f32_16x16x32_bf16 v[32:35], a[128:131], v[48:51], v[32:35]
    v_permlane16_swap_b32 v22, v23
    v_mfma_f32_16x16x32_bf16 v[32:35], a[140:143], v[52:55], v[32:35]
    v_max_f32 v22, v22, v23
    v_mov_b32 v23, v22
    v_mfma_f32_16x16x32_bf16 v[28:31], a[136:139], v[52:55], v[28:31]
    buffer_load_dwordx4 v1, s[8:11], s33 offen offset:3072 sc1 lds
    v_mfma_f32_16x16x32_bf16 v[28:31], a[124:127], v[48:51], v[28:31]
    s_add_u32 m0, s34, 4096
    v_permlane32_swap_b32 v22, v23
    v_mfma_f32_16x16x32_bf16 v[24:27], a[120:123], v[48:51], v[24:27]
    ds_read_b128 v[48:51], v3 offset:14336
    v_max_f32 v22, v22, v23
    v_mfma_f32_16x16x32_bf16 v[24:27], a[132:135], v[52:55], v[24:27]
    ds_read_b128 v[52:55], v3 offset:15360
    s_waitcnt lgkmcnt(2)
    v_mfma_f32_16x16x32_bf16 v[24:27], a[144:147], v[40:43], v[24:27]
    s_add_u32 s37, s33, 4096
    v_mul_f32 v22, v124, v22
    v_fma_f32 v122, v122, v124, -v22
    v_mfma_f32_16x16x32_bf16 v[24:27], a[156:159], v[44:47], v[24:27]
    buffer_load_dwordx4 v1, s[8:11], s37 offen offset:0 sc1 lds
    v_mfma_f32_16x16x32_bf16 v[28:31], a[160:163], v[44:47], v[28:31]
    v_fma_f32 v123, v123, v124, -v22
    v_sub_u32 v76, v3, v20
    v_mfma_f32_16x16x32_bf16 v[28:31], a[148:151], v[40:43], v[28:31]
    ds_read2st64_b64 v[80:83], v76 offset0:66 offset1:67
    v_mul_f32 v14, v14, v69
    v_mfma_f32_16x16x32_bf16 v[32:35], a[152:155], v[40:43], v[32:35]
    ds_read_b128 v[40:43], v3 offset:16384
    v_mul_f32 v15, v15, v69
    v_mfma_f32_16x16x32_bf16 v[32:35], a[164:167], v[44:47], v[32:35]
    ds_read_b128 v[44:47], v3 offset:17408
    s_waitcnt lgkmcnt(3)
    v_mfma_f32_16x16x32_bf16 v[32:35], a[176:179], v[48:51], v[32:35]
    buffer_load_dwordx4 v1, s[8:11], s37 offen offset:1024 sc1 lds
    v_mfma_f32_16x16x32_bf16 v[32:35], a[188:191], v[52:55], v[32:35]
    ds_read2st64_b64 v[76:79], v76 offset0:64 offset1:65
    v_cvt_pk_bf16_f32 v84, v12, v13
    v_mfma_f32_16x16x32_bf16 v[28:31], a[184:187], v[52:55], v[28:31]
    v_exp_f32 v122, v122
    v_mfma_f32_16x16x32_bf16 v[28:31], a[172:175], v[48:51], v[28:31]
    v_exp_f32 v123, v123
    v_mfma_f32_16x16x32_bf16 v[24:27], a[168:171], v[48:51], v[24:27]
    ds_read_b128 v[48:51], v3 offset:18432
    v_add_f32 v22, v122, v123
    v_mfma_f32_16x16x32_bf16 v[24:27], a[180:183], v[52:55], v[24:27]
    ds_read_b128 v[52:55], v3 offset:19456
    s_waitcnt lgkmcnt(3)
    v_mfma_f32_16x16x32_bf16 v[24:27], a[192:195], v[40:43], v[24:27]
    buffer_load_dwordx4 v1, s[8:11], s37 offen offset:2048 sc1 lds
    v_mfma_f32_16x16x32_bf16 v[24:27], a[204:207], v[44:47], v[24:27]
    v_mov_b32 v23, v22
    v_cvt_pk_bf16_f32 v85, v14, v15
    v_mfma_f32_16x16x32_bf16 v[28:31], a[208:211], v[44:47], v[28:31]
    v_permlane16_swap_b32 v22, v23
    v_mfma_f32_16x16x32_bf16 v[28:31], a[196:199], v[40:43], v[28:31]
    v_add_f32 v22, v22, v23
    v_mov_b32 v23, v22
    v_mfma_f32_16x16x32_bf16 v[32:35], a[200:203], v[40:43], v[32:35]
    ds_read_b128 v[40:43], v3 offset:20480
    v_fma_f32 v8, -v68, v56, v8
    v_mfma_f32_16x16x32_bf16 v[32:35], a[212:215], v[44:47], v[32:35]
    ds_read_b128 v[44:47], v3 offset:21504
    s_waitcnt lgkmcnt(2)
    v_mfma_f32_16x16x32_bf16 v[32:35], a[224:227], v[48:51], v[32:35]
    buffer_load_dwordx4 v1, s[8:11], s37 offen offset:3072 sc1 lds
    v_mfma_f32_16x16x32_bf16 v[32:35], a[236:239], v[52:55], v[32:35]
    s_add_u32 m0, s34, 8192
    v_permlane32_swap_b32 v22, v23
    v_mfma_f32_16x16x32_bf16 v[28:31], a[232:235], v[52:55], v[28:31]
    s_add_u32 s37, s33, 8192
    v_add_f32 v22, v22, v23
    v_fma_f32 v9, -v68, v57, v9
    v_mfma_f32_16x16x32_bf16 v[28:31], a[220:223], v[48:51], v[28:31]
    v_rcp_f32 v22, v22
    v_mfma_f32_16x16x32_bf16 v[24:27], a[216:219], v[48:51], v[24:27]
    ds_read_b128 v[48:51], v3 offset:22528
    v_mul_f32 v122, v122, v22
    v_mfma_f32_16x16x32_bf16 v[24:27], a[228:231], v[52:55], v[24:27]
    ds_read_b128 v[52:55], v3 offset:23552
    s_waitcnt lgkmcnt(2)
    v_mfma_f32_16x16x32_bf16 v[24:27], a[240:243], v[40:43], v[24:27]
    buffer_load_dwordx4 v1, s[8:11], s37 offen offset:0 sc1 lds
    v_mfma_f32_16x16x32_bf16 v[24:27], a[252:255], v[44:47], v[24:27]
    v_mul_f32 v123, v123, v22
    v_cvt_pk_bf16_f32 v23, v122, v123
    v_mfma_f32_16x16x32_bf16 v[28:31], v[128:131], v[44:47], v[28:31]
    v_perm_b32 v114, v23, v23, v102
    v_perm_b32 v115, v23, v23, v103
    v_mfma_f32_16x16x32_bf16 v[28:31], a[244:247], v[40:43], v[28:31]
    v_perm_b32 v116, v23, v23, v104
    v_perm_b32 v117, v23, v23, v105
    v_mfma_f32_16x16x32_bf16 v[32:35], a[248:251], v[40:43], v[32:35]
    ds_read_b128 v[40:43], v3 offset:24576
    v_mov_b32 v100, v94
    v_mfma_f32_16x16x32_bf16 v[32:35], v[132:135], v[44:47], v[32:35]
    ds_read_b128 v[44:47], v3 offset:25600
    s_waitcnt lgkmcnt(2)
    v_mfma_f32_16x16x32_bf16 v[32:35], v[144:147], v[48:51], v[32:35]
    v_mov_b32 v101, v95
    v_fma_f32 v10, -v68, v58, v10
    v_mfma_f32_16x16x32_bf16 v[32:35], v[156:159], v[52:55], v[32:35]
    v_fma_f32 v11, -v68, v59, v11
    v_cvt_pk_bf16_f32 v88, v8, v9
    v_mfma_f32_16x16x32_bf16 v[72:75], v[98:101], v[114:117], 0
    v_cvt_pk_bf16_f32 v89, v10, v11
    v_add_f32 v76, v76, v80
    v_mfma_f32_16x16x32_bf16 v[28:31], v[152:155], v[52:55], v[28:31]
    v_add_f32 v77, v77, v81
    v_add_f32 v78, v78, v82
    v_mfma_f32_16x16x32_bf16 v[110:113], v[84:87], v[88:91], 0
    v_mov_b32 v8, v84
    v_mov_b32 v9, v85
    v_mfma_f32_16x16x32_bf16 v[28:31], v[140:143], v[48:51], v[28:31]
    v_cvt_pk_bf16_f32 v114, v72, v73
    v_cvt_pk_bf16_f32 v115, v74, v75
    v_mfma_f32_16x16x32_bf16 v[24:27], v[136:139], v[48:51], v[24:27]
    ds_read_b128 v[48:51], v3 offset:26624
    v_cvt_pk_bf16_f32 v116, v72, v73
    v_mfma_f32_16x16x32_bf16 v[24:27], v[148:151], v[52:55], v[24:27]
    ds_read_b128 v[52:55], v3 offset:27648
    s_waitcnt lgkmcnt(2)
    v_mfma_f32_16x16x32_bf16 v[24:27], v[160:163], v[40:43], v[24:27]
    v_mov_b32 v10, v92
    v_mov_b32 v11, v93
    v_mfma_f32_16x16x32_bf16 v[24:27], v[172:175], v[44:47], v[24:27]
    buffer_store_dwordx4 v[8:11], v1, s[4:7], s40 offen sc1
    v_cvt_pk_bf16_f32 v117, v74, v75
    v_mfma_f32_16x16x32_bf16 v[28:31], v[176:179], v[44:47], v[28:31]
    s_add_u32 s40, s40, 262144
    v_permlane32_swap_b32 v114, v116
    v_mfma_f32_16x16x32_bf16 v[28:31], v[164:167], v[40:43], v[28:31]
    s_add_u32 s41, s41, 262144
    v_permlane32_swap_b32 v115, v117
    v_mfma_f32_16x16x32_bf16 v[32:35], v[168:171], v[40:43], v[32:35]
    ds_read_b128 v[40:43], v3 offset:28672
    v_cndmask_b32 v118, v110, v111, s[44:45]
    v_mfma_f32_16x16x32_bf16 v[32:35], v[180:183], v[44:47], v[32:35]
    ds_read_b128 v[44:47], v3 offset:29696
    s_waitcnt lgkmcnt(2)
    v_mfma_f32_16x16x32_bf16 v[32:35], v[192:195], v[48:51], v[32:35]
    buffer_store_dwordx4 v[114:117], v7, s[12:15], s36 offen sc1
    v_cndmask_b32 v119, v112, v113, s[44:45]
    v_mfma_f32_16x16x32_bf16 v[32:35], v[204:207], v[52:55], v[32:35]
    s_add_u32 s36, s36, 32768
    v_add_f32 v79, v79, v83
    v_add_f32 v70, v76, v78
    v_mfma_f32_16x16x32_bf16 v[28:31], v[200:203], v[52:55], v[28:31]
    s_add_u32 s31, s31, 1
    v_add_f32 v71, v77, v79
    v_add_u32 v2, s35, v1
    v_mfma_f32_16x16x32_bf16 v[28:31], v[188:191], v[48:51], v[28:31]
    s_sub_u32 s54, s31, 2
    v_mov_b32 v6, s54
    v_mfma_f32_16x16x32_bf16 v[24:27], v[184:187], v[48:51], v[24:27]
    ds_read_b128 v[48:51], v3 offset:30720
    v_mfma_f32_16x16x32_bf16 v[24:27], v[196:199], v[52:55], v[24:27]
    ds_read_b128 v[52:55], v3 offset:31744
    s_waitcnt lgkmcnt(2)
    v_mfma_f32_16x16x32_bf16 v[24:27], v[208:211], v[40:43], v[24:27]
    s_cmp_ge_i32 s31, 30
    s_cselect_b32 s18, 0x1ffff, s18
    s_add_u32 s33, s33, 34816
    v_mfma_f32_16x16x32_bf16 v[24:27], v[220:223], v[44:47], v[24:27]
    s_add_u32 s34, s34, 36864
    v_permlane16_swap_b32 v70, v71
    v_mfma_f32_16x16x32_bf16 v[28:31], v[224:227], v[44:47], v[28:31]
    s_cmp_ge_u32 s34, 147456
    s_cselect_b32 s38, 147456, 0
    v_add_f32 v70, v70, v71
    v_mfma_f32_16x16x32_bf16 v[28:31], v[212:215], v[40:43], v[28:31]
    s_sub_u32 s34, s34, s38
    s_waitcnt vmcnt(12)
    v_cmp_gt_i32 vcc, s32, v5
    v_mfma_f32_16x16x32_bf16 v[32:35], v[216:219], v[40:43], v[32:35]
    ds_read_b128 v[40:43], v2 offset:0
    v_mov_b32 v71, v70
    v_mfma_f32_16x16x32_bf16 v[32:35], v[228:231], v[44:47], v[32:35]
    ds_read_b128 v[44:47], v2 offset:1024
    s_waitcnt lgkmcnt(2)
    v_mfma_f32_16x16x32_bf16 v[32:35], v[240:243], v[48:51], v[32:35]
    s_and_b64 vcc, vcc, s[18:19]
    s_cbranch_scc1 Lqkv_slows11
Lqkv_backs11:
    v_mfma_f32_16x16x32_bf16 v[32:35], v[252:255], v[52:55], v[32:35]
    s_add_u32 s16, s16, 8192
    v_permlane32_swap_b32 v70, v71
    v_mfma_f32_16x16x32_bf16 v[28:31], v[248:251], v[52:55], v[28:31]
    s_and_b32 s16, s16, 524287
    v_add_f32 v70, v70, v71
    v_mul_f32 v70, 0x3a800000, v70
    v_mfma_f32_16x16x32_bf16 v[28:31], v[236:239], v[48:51], v[28:31]
    buffer_load_dword v5, v4, s[4:7], s16 offen sc1
    v_mfma_f32_16x16x32_bf16 v[24:27], v[232:235], v[48:51], v[24:27]
    ds_read_b128 v[48:51], v2 offset:2048
    v_mov_b32 v71, v70
    v_mfma_f32_16x16x32_bf16 v[24:27], v[244:247], v[52:55], v[24:27]
    ds_read_b128 v[52:55], v2 offset:3072
    v_permlane16_swap_b32 v70, v71
    v_fma_f32 v71, -v70, v70, v71
    v_max_f32 v71, 0, v71
    v_add_f32 v71, 0x3727c5ac, v71
    v_rsq_f32 v71, v71
    s_nop 1
    s_branch Lqkv_g01
    .p2align 6
Lqkv_g11:
    s_waitcnt lgkmcnt(2)
    v_mfma_f32_16x16x32_bf16 v[24:27], a[0:3], v[40:43], 0
    s_add_u32 m0, s34, 0
    v_mul_f32 v124, s52, v71
    v_fma_f32 v16, -v68, v64, v16
    v_mfma_f32_16x16x32_bf16 v[24:27], a[12:15], v[44:47], v[24:27]
    s_add_u32 s35, s35, 36864
    v_fma_f32 v12, -v68, v60, v12
    v_fma_f32 v13, -v68, v61, v13
    v_mfma_f32_16x16x32_bf16 v[28:31], a[16:19], v[44:47], 0
    s_cmp_eq_u32 s35, 147456
    s_cselect_b32 s35, 0, s35
    v_fma_f32 v14, -v68, v62, v14
    v_mfma_f32_16x16x32_bf16 v[28:31], a[4:7], v[40:43], v[28:31]
    v_fma_f32 v15, -v68, v63, v15
    v_mul_f32 v12, v12, v69
    v_mfma_f32_16x16x32_bf16 v[32:35], a[8:11], v[40:43], 0
    ds_read_b128 v[40:43], v3 offset:4096
    v_mul_f32 v13, v13, v69
    v_mfma_f32_16x16x32_bf16 v[32:35], a[20:23], v[44:47], v[32:35]
    ds_read_b128 v[44:47], v3 offset:5120
    s_waitcnt lgkmcnt(2)
    v_mfma_f32_16x16x32_bf16 v[32:35], a[32:35], v[48:51], v[32:35]
    v_mul_f32 v14, v14, v69
    v_mul_f32 v15, v15, v69
    v_mfma_f32_16x16x32_bf16 v[32:35], a[44:47], v[52:55], v[32:35]
    v_cvt_pk_bf16_f32 v84, v12, v13
    v_cvt_pk_bf16_f32 v85, v14, v15
    v_mfma_f32_16x16x32_bf16 v[28:31], a[40:43], v[52:55], v[28:31]
    v_fma_f32 v17, -v68, v65, v17
    v_fma_f32 v18, -v68, v66, v18
    v_mfma_f32_16x16x32_bf16 v[106:109], v[84:87], v[88:91], 0
    v_fma_f32 v19, -v68, v67, v19
    v_mul_f32 v16, v16, v69
    v_mfma_f32_16x16x32_bf16 v[28:31], a[28:31], v[48:51], v[28:31]
    v_mul_f32 v17, v17, v69
    v_mul_f32 v18, v18, v69
    v_mfma_f32_16x16x32_bf16 v[24:27], a[24:27], v[48:51], v[24:27]
    ds_read_b128 v[48:51], v3 offset:6144
    v_mul_f32 v19, v19, v69
    v_mfma_f32_16x16x32_bf16 v[24:27], a[36:39], v[52:55], v[24:27]
    ds_read_b128 v[52:55], v3 offset:7168
    s_waitcnt lgkmcnt(2)
    v_mfma_f32_16x16x32_bf16 v[24:27], a[48:51], v[40:43], v[24:27]
    v_cndmask_b32 v106, v106, v107, s[44:45]
    v_cndmask_b32 v108, v108, v109, s[44:45]
    v_mfma_f32_16x16x32_bf16 v[24:27], a[60:63], v[44:47], v[24:27]
    v_cndmask_b32 v120, v106, v118, s[48:49]
    v_cndmask_b32 v121, v108, v119, s[50:51]
    v_mfma_f32_16x16x32_bf16 v[28:31], a[64:67], v[44:47], v[28:31]
    ds_write_b64 v36, v[120:121] offset:2048
    v_mfma_f32_16x16x32_bf16 v[28:31], a[52:55], v[40:43], v[28:31]
    v_cvt_pk_bf16_f32 v16, v16, v17
    v_cvt_pk_bf16_f32 v17, v18, v19
    v_mfma_f32_16x16x32_bf16 v[32:35], a[56:59], v[40:43], v[32:35]
    ds_read_b128 v[40:43], v3 offset:8192
    v_fma_f32 v8, -v68, v56, v8
    v_mfma_f32_16x16x32_bf16 v[32:35], a[68:71], v[44:47], v[32:35]
    ds_read_b128 v[44:47], v3 offset:9216
    s_waitcnt lgkmcnt(3)
    v_mfma_f32_16x16x32_bf16 v[32:35], a[80:83], v[48:51], v[32:35]
    s_waitcnt vmcnt(3) lgkmcnt(2)
    ds_write_b64 v38, v[16:17]
    v_mfma_f32_16x16x32_bf16 v[32:35], a[92:95], v[52:55], v[32:35]
    s_barrier
    v_mfma_f32_16x16x32_bf16 v[28:31], a[88:91], v[52:55], v[28:31]
    ds_read_b64_tr_b16 v[92:93], v39
    v_fma_f32 v9, -v68, v57, v9
    v_mfma_f32_16x16x32_bf16 v[28:31], a[76:79], v[48:51], v[28:31]
    buffer_load_dwordx4 v1, s[8:11], s33 offen offset:0 sc1 lds
    v_mfma_f32_16x16x32_bf16 v[24:27], a[72:75], v[48:51], v[24:27]
    ds_read_b128 v[48:51], v3 offset:10240
    v_fma_f32 v10, -v68, v58, v10
    v_mfma_f32_16x16x32_bf16 v[24:27], a[84:87], v[52:55], v[24:27]
    ds_read_b128 v[52:55], v3 offset:11264
    s_waitcnt lgkmcnt(4)
    v_mfma_f32_16x16x32_bf16 v[24:27], a[96:99], v[40:43], v[24:27]
    s_waitcnt vmcnt(3)
    buffer_store_dword v6, v21, s[12:15], s17 offen sc1
    v_mfma_f32_16x16x32_bf16 v[24:27], a[108:111], v[44:47], v[24:27]
    ds_read_b64 v[122:123], v37 offset:2048
    v_fma_f32 v11, -v68, v59, v11
    v_mfma_f32_16x16x32_bf16 v[28:31], a[112:115], v[44:47], v[28:31]
    s_cmp_ge_i32 s54, 0
    s_cselect_b32 s14, s6, 0
    v_cvt_pk_bf16_f32 v88, v8, v9
    v_mfma_f32_16x16x32_bf16 v[28:31], a[100:103], v[40:43], v[28:31]
    s_add_u32 s17, s17, 8192
    v_sub_u32 v76, v3, v20
    v_cvt_pk_bf16_f32 v89, v10, v11
    v_mfma_f32_16x16x32_bf16 v[32:35], a[104:107], v[40:43], v[32:35]
    ds_read_b128 v[40:43], v3 offset:12288
    v_add_u32 v2, s35, v1
    v_mfma_f32_16x16x32_bf16 v[110:113], v[84:87], v[88:91], 0
    buffer_load_dwordx4 v1, s[8:11], s33 offen offset:1024 sc1 lds
    v_mfma_f32_16x16x32_bf16 v[32:35], a[116:119], v[44:47], v[32:35]
    ds_read_b128 v[44:47], v3 offset:13312
    s_waitcnt lgkmcnt(2)
    v_mfma_f32_16x16x32_bf16 v[32:35], a[128:131], v[48:51], v[32:35]
    ds_read2st64_b64 v[80:83], v76 offset0:66 offset1:67
    v_add_f32 v122, v122, v120
    v_mfma_f32_16x16x32_bf16 v[32:35], a[140:143], v[52:55], v[32:35]
    ds_read2st64_b64 v[76:79], v76 offset0:64 offset1:65
    v_add_f32 v123, v123, v121
    v_mfma_f32_16x16x32_bf16 v[28:31], a[136:139], v[52:55], v[28:31]
    v_max_f32 v22, v122, v123
    v_mov_b32 v23, v22
    v_mfma_f32_16x16x32_bf16 v[28:31], a[124:127], v[48:51], v[28:31]
    buffer_load_dwordx4 v1, s[8:11], s33 offen offset:2048 sc1 lds
    v_mfma_f32_16x16x32_bf16 v[24:27], a[120:123], v[48:51], v[24:27]
    ds_read_b128 v[48:51], v3 offset:14336
    v_cndmask_b32 v118, v110, v111, s[44:45]
    v_mfma_f32_16x16x32_bf16 v[24:27], a[132:135], v[52:55], v[24:27]
    ds_read_b128 v[52:55], v3 offset:15360
    s_waitcnt lgkmcnt(4)
    v_mfma_f32_16x16x32_bf16 v[24:27], a[144:147], v[40:43], v[24:27]
    v_permlane16_swap_b32 v22, v23
    v_mfma_f32_16x16x32_bf16 v[24:27], a[156:159], v[44:47], v[24:27]
    v_max_f32 v22, v22, v23
    v_mov_b32 v23, v22
    v_mfma_f32_16x16x32_bf16 v[28:31], a[160:163], v[44:47], v[28:31]
    buffer_load_dwordx4 v1, s[8:11], s33 offen offset:3072 sc1 lds
    v_mfma_f32_16x16x32_bf16 v[28:31], a[148:151], v[40:43], v[28:31]
    s_add_u32 m0, s34, 4096
    v_permlane32_swap_b32 v22, v23
    v_mfma_f32_16x16x32_bf16 v[32:35], a[152:155], v[40:43], v[32:35]
    ds_read_b128 v[40:43], v3 offset:16384
    v_max_f32 v22, v22, v23
    v_mfma_f32_16x16x32_bf16 v[32:35], a[164:167], v[44:47], v[32:35]
    ds_read_b128 v[44:47], v3 offset:17408
    s_waitcnt lgkmcnt(2)
    v_mfma_f32_16x16x32_bf16 v[32:35], a[176:179], v[48:51], v[32:35]
    s_add_u32 s37, s33, 4096
    v_mul_f32 v22, v124, v22
    v_fma_f32 v122, v122, v124, -v22
    v_mfma_f32_16x16x32_bf16 v[32:35], a[188:191], v[52:55], v[32:35]
    buffer_load_dwordx4 v1, s[8:11], s37 offen offset:0 sc1 lds
    v_mfma_f32_16x16x32_bf16 v[28:31], a[184:187], v[52:55], v[28:31]
    v_fma_f32 v123, v123, v124, -v22
    v_cndmask_b32 v119, v112, v113, s[44:45]
    v_mfma_f32_16x16x32_bf16 v[28:31], a[172:175], v[48:51], v[28:31]
    v_exp_f32 v122, v122
    v_mfma_f32_16x16x32_bf16 v[24:27], a[168:171], v[48:51], v[24:27]
    ds_read_b128 v[48:51], v3 offset:18432
    v_add_f32 v76, v76, v80
    v_mfma_f32_16x16x32_bf16 v[24:27], a[180:183], v[52:55], v[24:27]
    ds_read_b128 v[52:55], v3 offset:19456
    s_waitcnt lgkmcnt(2)
    v_mfma_f32_16x16x32_bf16 v[24:27], a[192:195], v[40:43], v[24:27]
    buffer_load_dwordx4 v1, s[8:11], s37 offen offset:1024 sc1 lds
    v_mfma_f32_16x16x32_bf16 v[24:27], a[204:207], v[44:47], v[24:27]
    v_exp_f32 v123, v123
    v_mfma_f32_16x16x32_bf16 v[28:31], a[208:211], v[44:47], v[28:31]
    v_add_f32 v22, v122, v123
    v_mov_b32 v23, v22
    v_mfma_f32_16x16x32_bf16 v[28:31], a[196:199], v[40:43], v[28:31]
    s_nop 0
    v_permlane16_swap_b32 v22, v23
    v_mfma_f32_16x16x32_bf16 v[32:35], a[200:203], v[40:43], v[32:35]
    ds_read_b128 v[40:43], v3 offset:20480
    v_add_f32 v22, v22, v23
    v_mfma_f32_16x16x32_bf16 v[32:35], a[212:215], v[44:47], v[32:35]
    ds_read_b128 v[44:47], v3 offset:21504
    s_waitcnt lgkmcnt(2)
    v_mfma_f32_16x16x32_bf16 v[32:35], a[224:227], v[48:51], v[32:35]
    buffer_load_dwordx4 v1, s[8:11], s37 offen offset:2048 sc1 lds
    v_mfma_f32_16x16x32_bf16 v[32:35], a[236:239], v[52:55], v[32:35]
    v_mov_b32 v23, v22
    v_add_f32 v77, v77, v81
    v_mfma_f32_16x16x32_bf16 v[28:31], a[232:235], v[52:55], v[28:31]
    v_permlane32_swap_b32 v22, v23
    v_mfma_f32_16x16x32_bf16 v[28:31], a[220:223], v[48:51], v[28:31]
    v_add_f32 v22, v22, v23
    v_add_f32 v78, v78, v82
    v_mfma_f32_16x16x32_bf16 v[24:27], a[216:219], v[48:51], v[24:27]
    ds_read_b128 v[48:51], v3 offset:22528
    v_add_f32 v79, v79, v83
    v_mfma_f32_16x16x32_bf16 v[24:27], a[228:231], v[52:55], v[24:27]
    ds_read_b128 v[52:55], v3 offset:23552
    s_waitcnt lgkmcnt(2)
    v_mfma_f32_16x16x32_bf16 v[24:27], a[240:243], v[40:43], v[24:27]
    buffer_load_dwordx4 v1, s[8:11], s37 offen offset:3072 sc1 lds
    v_mfma_f32_16x16x32_bf16 v[24:27], a[252:255], v[44:47], v[24:27]
    s_add_u32 m0, s34, 8192
    v_rcp_f32 v22, v22
    v_mfma_f32_16x16x32_bf16 v[28:31], v[128:131], v[44:47], v[28:31]
    s_add_u32 s37, s33, 8192
    v_mul_f32 v122, v122, v22
    v_mul_f32 v123, v123, v22
    v_mfma_f32_16x16x32_bf16 v[28:31], a[244:247], v[40:43], v[28:31]
    v_cvt_pk_bf16_f32 v23, v122, v123
    v_perm_b32 v114, v23, v23, v102
    v_mfma_f32_16x16x32_bf16 v[32:35], a[248:251], v[40:43], v[32:35]
    ds_read_b128 v[40:43], v3 offset:24576
    v_perm_b32 v115, v23, v23, v103
    v_mfma_f32_16x16x32_bf16 v[32:35], v[132:135], v[44:47], v[32:35]
    ds_read_b128 v[44:47], v3 offset:25600
    s_waitcnt lgkmcnt(2)
    v_mfma_f32_16x16x32_bf16 v[32:35], v[144:147], v[48:51], v[32:35]
    buffer_load_dwordx4 v1, s[8:11], s37 offen offset:0 sc1 lds
    v_mfma_f32_16x16x32_bf16 v[32:35], v[156:159], v[52:55], v[32:35]
    v_perm_b32 v116, v23, v23, v104
    v_perm_b32 v117, v23, v23, v105
    v_mfma_f32_16x16x32_bf16 v[28:31], v[152:155], v[52:55], v[28:31]
    v_add_f32 v70, v76, v78
    v_add_f32 v71, v77, v79
    v_mfma_f32_16x16x32_bf16 v[72:75], v[92:95], v[114:117], 0
    s_nop 0
    v_permlane16_swap_b32 v70, v71
    v_mfma_f32_16x16x32_bf16 v[28:31], v[140:143], v[48:51], v[28:31]
    v_add_f32 v70, v70, v71
    v_mov_b32 v71, v70
    v_mfma_f32_16x16x32_bf16 v[24:27], v[136:139], v[48:51], v[24:27]
    ds_read_b128 v[48:51], v3 offset:26624
    v_mfma_f32_16x16x32_bf16 v[24:27], v[148:151], v[52:55], v[24:27]
    ds_read_b128 v[52:55], v3 offset:27648
    s_waitcnt lgkmcnt(2)
    v_mfma_f32_16x16x32_bf16 v[24:27], v[160:163], v[40:43], v[24:27]
    v_cvt_pk_bf16_f32 v114, v72, v73
    v_cvt_pk_bf16_f32 v115, v74, v75
    v_mfma_f32_16x16x32_bf16 v[24:27], v[172:175], v[44:47], v[24:27]
    v_cvt_pk_bf16_f32 v116, v72, v73
    v_cvt_pk_bf16_f32 v117, v74, v75
    v_mfma_f32_16x16x32_bf16 v[28:31], v[176:179], v[44:47], v[28:31]
    v_permlane32_swap_b32 v114, v116
    v_mfma_f32_16x16x32_bf16 v[28:31], v[164:167], v[40:43], v[28:31]
    s_add_u32 s31, s31, 1
    v_permlane32_swap_b32 v115, v117
    v_mfma_f32_16x16x32_bf16 v[32:35], v[168:171], v[40:43], v[32:35]
    ds_read_b128 v[40:43], v3 offset:28672
    s_sub_u32 s54, s31, 2
    v_mfma_f32_16x16x32_bf16 v[32:35], v[180:183], v[44:47], v[32:35]
    ds_read_b128 v[44:47], v3 offset:29696
    s_waitcnt lgkmcnt(2)
    v_mfma_f32_16x16x32_bf16 v[32:35], v[192:195], v[48:51], v[32:35]
    buffer_store_dwordx4 v[114:117], v7, s[12:15], s36 offen sc1
    v_mov_b32 v6, s54
    v_mfma_f32_16x16x32_bf16 v[32:35], v[204:207], v[52:55], v[32:35]
    s_add_u32 s36, s36, 32768
    v_permlane32_swap_b32 v70, v71
    v_mfma_f32_16x16x32_bf16 v[28:31], v[200:203], v[52:55], v[28:31]
    s_cmp_ge_i32 s31, 30
    s_cselect_b32 s18, 0x1ffff, s18
    v_add_f32 v70, v70, v71
    v_mfma_f32_16x16x32_bf16 v[28:31], v[188:191], v[48:51], v[28:31]
    s_add_u32 s33, s33, 34816
    v_mul_f32 v70, 0x3a800000, v70
    v_mov_b32 v71, v70
    v_mfma_f32_16x16x32_bf16 v[24:27], v[184:187], v[48:51], v[24:27]
    ds_read_b128 v[48:51], v3 offset:30720
    s_add_u32 s34, s34, 36864
    v_mfma_f32_16x16x32_bf16 v[24:27], v[196:199], v[52:55], v[24:27]
    ds_read_b128 v[52:55], v3 offset:31744
    s_waitcnt lgkmcnt(2)
    v_mfma_f32_16x16x32_bf16 v[24:27], v[208:211], v[40:43], v[24:27]
    s_cmp_ge_u32 s34, 147456
    s_cselect_b32 s38, 147456, 0
    s_sub_u32 s34, s34, s38
    v_mfma_f32_16x16x32_bf16 v[24:27], v[220:223], v[44:47], v[24:27]
    s_waitcnt vmcnt(11)
    v_cmp_gt_i32 vcc, s32, v5
    v_mfma_f32_16x16x32_bf16 v[28:31], v[224:227], v[44:47], v[28:31]
    v_permlane16_swap_b32 v70, v71
    v_mfma_f32_16x16x32_bf16 v[28:31], v[212:215], v[40:43], v[28:31]
    s_and_b64 vcc, vcc, s[18:19]
    s_cbranch_scc1 Lqkv_slowg11
Lqkv_backg11:
    v_mfma_f32_16x16x32_bf16 v[32:35], v[216:219], v[40:43], v[32:35]
    ds_read_b128 v[40:43], v2 offset:0
    v_fma_f32 v71, -v70, v70, v71
    v_mfma_f32_16x16x32_bf16 v[32:35], v[228:231], v[44:47], v[32:35]
    ds_read_b128 v[44:47], v2 offset:1024
    s_waitcnt lgkmcnt(2)
    v_mfma_f32_16x16x32_bf16 v[32:35], v[240:243], v[48:51], v[32:35]
    s_add_u32 s16, s16, 8192
    v_max_f32 v71, 0, v71
    v_add_f32 v71, 0x3727c5ac, v71
    v_mfma_f32_16x16x32_bf16 v[32:35], v[252:255], v[52:55], v[32:35]
    s_and_b32 s16, s16, 524287
    v_rsq_f32 v71, v71
    v_mfma_f32_16x16x32_bf16 v[28:31], v[248:251], v[52:55], v[28:31]
    buffer_load_dword v5, v4, s[4:7], s16 offen sc1
    v_mfma_f32_16x16x32_bf16 v[28:31], v[236:239], v[48:51], v[28:31]
    v_mfma_f32_16x16x32_bf16 v[24:27], v[232:235], v[48:51], v[24:27]
    ds_read_b128 v[48:51], v2 offset:2048
    v_mfma_f32_16x16x32_bf16 v[24:27], v[244:247], v[52:55], v[24:27]
    ds_read_b128 v[52:55], v2 offset:3072
    s_cmp_eq_u32 s31, 64
    s_cbranch_scc1 Lqkv_tail
Lqkv_g01:
    s_waitcnt lgkmcnt(2)
    v_mfma_f32_16x16x32_bf16 v[8:11], a[0:3], v[40:43], 0
    s_add_u32 m0, s34, 0
    v_mul_f32 v124, s52, v69
    v_fma_f32 v32, -v70, v64, v32
    v_mfma_f32_16x16x32_bf16 v[8:11], a[12:15], v[44:47], v[8:11]
    s_add_u32 s35, s35, 36864
    v_fma_f32 v28, -v70, v60, v28
    v_fma_f32 v29, -v70, v61, v29
    v_mfma_f32_16x16x32_bf16 v[12:15], a[16:19], v[44:47], 0
    s_cmp_eq_u32 s35, 147456
    s_cselect_b32 s35, 0, s35
    v_fma_f32 v30, -v70, v62, v30
    v_mfma_f32_16x16x32_bf16 v[12:15], a[4:7], v[40:43], v[12:15]
    v_fma_f32 v31, -v70, v63, v31
    v_mul_f32 v28, v28, v71
    v_mfma_f32_16x16x32_bf16 v[16:19], a[8:11], v[40:43], 0
    ds_read_b128 v[40:43], v2 offset:4096
    v_mul_f32 v29, v29, v71
    v_mfma_f32_16x16x32_bf16 v[16:19], a[20:23], v[44:47], v[16:19]
    ds_read_b128 v[44:47], v2 offset:5120
    s_waitcnt lgkmcnt(2)
    v_mfma_f32_16x16x32_bf16 v[16:19], a[32:35], v[48:51], v[16:19]
    v_mul_f32 v30, v30, v71
    v_mul_f32 v31, v31, v71
    v_mfma_f32_16x16x32_bf16 v[16:19], a[44:47], v[52:55], v[16:19]
    v_cvt_pk_bf16_f32 v84, v28, v29
    v_cvt_pk_bf16_f32 v85, v30, v31
    v_mfma_f32_16x16x32_bf16 v[12:15], a[40:43], v[52:55], v[12:15]
    v_fma_f32 v33, -v70, v65, v33
    v_fma_f32 v34, -v70, v66, v34
    v_mfma_f32_16x16x32_bf16 v[106:109], v[84:87], v[88:91], 0
    v_fma_f32 v35, -v70, v67, v35
    v_mul_f32 v32, v32, v71
    v_mfma_f32_16x16x32_bf16 v[12:15], a[28:31], v[48:51], v[12:15]
    v_mul_f32 v33, v33, v71
    v_mul_f32 v34, v34, v71
    v_mfma_f32_16x16x32_bf16 v[8:11], a[24:27], v[48:51], v[8:11]
    ds_read_b128 v[48:51], v2 offset:6144
    v_mul_f32 v35, v35, v71
    v_mfma_f32_16x16x32_bf16 v[8:11], a[36:39], v[52:55], v[8:11]
    ds_read_b128 v[52:55], v2 offset:7168
    s_waitcnt lgkmcnt(2)
    v_mfma_f32_16x16x32_bf16 v[8:11], a[48:51], v[40:43], v[8:11]
    v_cndmask_b32 v106, v106, v107, s[44:45]
    v_cndmask_b32 v108, v108, v109, s[44:45]
    v_mfma_f32_16x16x32_bf16 v[8:11], a[60:63], v[44:47], v[8:11]
    v_cndmask_b32 v120, v106, v118, s[48:49]
    v_cndmask_b32 v121, v108, v119, s[50:51]
    v_mfma_f32_16x16x32_bf16 v[12:15], a[64:67], v[44:47], v[12:15]
    ds_write_b64 v36, v[120:121] offset:0
    v_mfma_f32_16x16x32_bf16 v[12:15], a[52:55], v[40:43], v[12:15]
    v_cvt_pk_bf16_f32 v32, v32, v33
    v_cvt_pk_bf16_f32 v33, v34, v35
    v_mfma_f32_16x16x32_bf16 v[16:19], a[56:59], v[40:43], v[16:19]
    ds_read_b128 v[40:43], v2 offset:8192
    v_fma_f32 v24, -v70, v56, v24
    v_mfma_f32_16x16x32_bf16 v[16:19], a[68:71], v[44:47], v[16:19]
    ds_read_b128 v[44:47], v2 offset:9216
    s_waitcnt lgkmcnt(3)
    v_mfma_f32_16x16x32_bf16 v[16:19], a[80:83], v[48:51], v[16:19]
    s_waitcnt vmcnt(2) lgkmcnt(2)
    ds_write_b64 v38, v[32:33]
    v_mfma_f32_16x16x32_bf16 v[16:19], a[92:95], v[52:55], v[16:19]
    s_barrier
    v_mfma_f32_16x16x32_bf16 v[12:15], a[88:91], v[52:55], v[12:15]
    ds_read_b64_tr_b16 v[94:95], v39
    v_fma_f32 v25, -v70, v57, v25
    v_mfma_f32_16x16x32_bf16 v[12:15], a[76:79], v[48:51], v[12:15]
    buffer_load_dwordx4 v1, s[8:11], s33 offen offset:0 sc1 lds
    v_mfma_f32_16x16x32_bf16 v[8:11], a[72:75], v[48:51], v[8:11]
    ds_read_b128 v[48:51], v2 offset:10240
    v_fma_f32 v26, -v70, v58, v26
    v_mfma_f32_16x16x32_bf16 v[8:11], a[84:87], v[52:55], v[8:11]
    ds_read_b128 v[52:55], v2 offset:11264
    s_waitcnt lgkmcnt(4)
    v_mfma_f32_16x16x32_bf16 v[8:11], a[96:99], v[40:43], v[8:11]
    s_waitcnt vmcnt(2)
    buffer_store_dword v6, v21, s[12:15], s17 offen sc1
    v_mfma_f32_16x16x32_bf16 v[8:11], a[108:111], v[44:47], v[8:11]
    ds_read_b64 v[122:123], v37 offset:0
    v_fma_f32 v27, -v70, v59, v27
    v_mfma_f32_16x16x32_bf16 v[12:15], a[112:115], v[44:47], v[12:15]
    s_cmp_ge_i32 s54, 0
    s_cselect_b32 s14, s6, 0
    v_cvt_pk_bf16_f32 v88, v24, v25
    v_mfma_f32_16x16x32_bf16 v[12:15], a[100:103], v[40:43], v[12:15]
    s_add_u32 s17, s17, 8192
    v_sub_u32 v76, v2, v20
    v_cvt_pk_bf16_f32 v89, v26, v27
    v_mfma_f32_16x16x32_bf16 v[16:19], a[104:107], v[40:43], v[16:19]
    ds_read_b128 v[40:43], v2 offset:12288
    v_add_u32 v3, s35, v1
    v_mfma_f32_16x16x32_bf16 v[110:113], v[84:87], v[88:91], 0
    buffer_load_dwordx4 v1, s[8:11], s33 offen offset:1024 sc1 lds
    v_mfma_f32_16x16x32_bf16 v[16:19], a[116:119], v[44:47], v[16:19]
    ds_read_b128 v[44:47], v2 offset:13312
    s_waitcnt lgkmcnt(2)
    v_mfma_f32_16x16x32_bf16 v[16:19], a[128:131], v[48:51], v[16:19]
    ds_read2st64_b64 v[80:83], v76 offset0:66 offset1:67
    v_add_f32 v122, v122, v120
    v_mfma_f32_16x16x32_bf16 v[16:19], a[140:143], v[52:55], v[16:19]
    ds_read2st64_b64 v[76:79], v76 offset0:64 offset1:65
    v_add_f32 v123, v123, v121
    v_mfma_f32_16x16x32_bf16 v[12:15], a[136:139], v[52:55], v[12:15]
    v_max_f32 v22, v122, v123
    v_mov_b32 v23, v22
    v_mfma_f32_16x16x32_bf16 v[12:15], a[124:127], v[48:51], v[12:15]
    buffer_load_dwordx4 v1, s[8:11], s33 offen offset:2048 sc1 lds
    v_mfma_f32_16x16x32_bf16 v[8:11], a[120:123], v[48:51], v[8:11]
    ds_read_b128 v[48:51], v2 offset:14336
    v_cndmask_b32 v118, v110, v111, s[44:45]
    v_mfma_f32_16x16x32_bf16 v[8:11], a[132:135], v[52:55], v[8:11]
    ds_read_b128 v[52:55], v2 offset:15360
    s_waitcnt lgkmcnt(4)
    v_mfma_f32_16x16x32_bf16 v[8:11], a[144:147], v[40:43], v[8:11]
    v_permlane16_swap_b32 v22, v23
    v_mfma_f32_16x16x32_bf16 v[8:11], a[156:159], v[44:47], v[8:11]
    v_max_f32 v22, v22, v23
    v_mov_b32 v23, v22
    v_mfma_f32_16x16x32_bf16 v[12:15], a[160:163], v[44:47], v[12:15]
    buffer_load_dwordx4 v1, s[8:11], s33 offen offset:3072 sc1 lds
    v_mfma_f32_16x16x32_bf16 v[12:15], a[148:151], v[40:43], v[12:15]
    s_add_u32 m0, s34, 4096
    v_permlane32_swap_b32 v22, v23
    v_mfma_f32_16x16x32_bf16 v[16:19], a[152:155], v[40:43], v[16:19]
    ds_read_b128 v[40:43], v2 offset:16384
    v_max_f32 v22, v22, v23
    v_mfma_f32_16x16x32_bf16 v[16:19], a[164:167], v[44:47], v[16:19]
    ds_read_b128 v[44:47], v2 offset:17408
    s_waitcnt lgkmcnt(2)
    v_mfma_f32_16x16x32_bf16 v[16:19], a[176:179], v[48:51], v[16:19]
    s_add_u32 s37, s33, 4096
    v_mul_f32 v22, v124, v22
    v_fma_f32 v122, v122, v124, -v22
    v_mfma_f32_16x16x32_bf16 v[16:19], a[188:191], v[52:55], v[16:19]
    buffer_load_dwordx4 v1, s[8:11], s37 offen offset:0 sc1 lds
    v_mfma_f32_16x16x32_bf16 v[12:15], a[184:187], v[52:55], v[12:15]
    v_fma_f32 v123, v123, v124, -v22
    v_cndmask_b32 v119, v112, v113, s[44:45]
    v_mfma_f32_16x16x32_bf16 v[12:15], a[172:175], v[48:51], v[12:15]
    v_exp_f32 v122, v122
    v_mfma_f32_16x16x32_bf16 v[8:11], a[168:171], v[48:51], v[8:11]
    ds_read_b128 v[48:51], v2 offset:18432
    v_add_f32 v76, v76, v80
    v_mfma_f32_16x16x32_bf16 v[8:11], a[180:183], v[52:55], v[8:11]
    ds_read_b128 v[52:55], v2 offset:19456
    s_waitcnt lgkmcnt(2)
    v_mfma_f32_16x16x32_bf16 v[8:11], a[192:195], v[40:43], v[8:11]
    buffer_load_dwordx4 v1, s[8:11], s37 offen offset:1024 sc1 lds
    v_mfma_f32_16x16x32_bf16 v[8:11], a[204:207], v[44:47], v[8:11]
    v_exp_f32 v123, v123
    v_mfma_f32_16x16x32_bf16 v[12:15], a[208:211], v[44:47], v[12:15]
    v_add_f32 v22, v122, v123
    v_mov_b32 v23, v22
    v_mfma_f32_16x16x32_bf16 v[12:15], a[196:199], v[40:43], v[12:15]
    s_nop 0
    v_permlane16_swap_b32 v22, v23
    v_mfma_f32_16x16x32_bf16 v[16:19], a[200:203], v[40:43], v[16:19]
    ds_read_b128 v[40:43], v2 offset:20480
    v_add_f32 v22, v22, v23
    v_mfma_f32_16x16x32_bf16 v[16:19], a[212:215], v[44:47], v[16:19]
    ds_read_b128 v[44:47], v2 offset:21504
    s_waitcnt lgkmcnt(2)
    v_mfma_f32_16x16x32_bf16 v[16:19], a[224:227], v[48:51], v[16:19]
    buffer_load_dwordx4 v1, s[8:11], s37 offen offset:2048 sc1 lds
    v_mfma_f32_16x16x32_bf16 v[16:19], a[236:239], v[52:55], v[16:19]
    v_mov_b32 v23, v22
    v_add_f32 v77, v77, v81
    v_mfma_f32_16x16x32_bf16 v[12:15], a[232:235], v[52:55], v[12:15]
    v_permlane32_swap_b32 v22, v23
    v_mfma_f32_16x16x32_bf16 v[12:15], a[220:223], v[48:51], v[12:15]
    v_add_f32 v22, v22, v23
    v_add_f32 v78, v78, v82
    v_mfma_f32_16x16x32_bf16 v[8:11], a[216:219], v[48:51], v[8:11]
    ds_read_b128 v[48:51], v2 offset:22528
    v_add_f32 v79, v79, v83
    v_mfma_f32_16x16x32_bf16 v[8:11], a[228:231], v[52:55], v[8:11]
    ds_read_b128 v[52:55], v2 offset:23552
    s_waitcnt lgkmcnt(2)
    v_mfma_f32_16x16x32_bf16 v[8:11], a[240:243], v[40:43], v[8:11]
    buffer_load_dwordx4 v1, s[8:11], s37 offen offset:3072 sc1 lds
    v_mfma_f32_16x16x32_bf16 v[8:11], a[252:255], v[44:47], v[8:11]
    s_add_u32 m0, s34, 8192
    v_rcp_f32 v22, v22
    v_mfma_f32_16x16x32_bf16 v[12:15], v[128:131], v[44:47], v[12:15]
    s_add_u32 s37, s33, 8192
    v_mul_f32 v122, v122, v22
    v_mul_f32 v123, v123, v22
    v_mfma_f32_16x16x32_bf16 v[12:15], a[244:247], v[40:43], v[12:15]
    v_cvt_pk_bf16_f32 v23, v122, v123
    v_perm_b32 v116, v23, v23, v102
    v_mfma_f32_16x16x32_bf16 v[16:19], a[248:251], v[40:43], v[16:19]
    ds_read_b128 v[40:43], v2 offset:24576
    v_perm_b32 v117, v23, v23, v103
    v_mfma_f32_16x16x32_bf16 v[16:19], v[132:135], v[44:47], v[16:19]
    ds_read_b128 v[44:47], v2 offset:25600
    s_waitcnt lgkmcnt(2)
    v_mfma_f32_16x16x32_bf16 v[16:19], v[144:147], v[48:51], v[16:19]
    buffer_load_dwordx4 v1, s[8:11], s37 offen offset:0 sc1 lds
    v_mfma_f32_16x16x32_bf16 v[16:19], v[156:159], v[52:55], v[16:19]
    v_perm_b32 v114, v23, v23, v104
    v_perm_b32 v115, v23, v23, v105
    v_mfma_f32_16x16x32_bf16 v[12:15], v[152:155], v[52:55], v[12:15]
    v_add_f32 v68, v76, v78
    v_add_f32 v69, v77, v79
    v_mfma_f32_16x16x32_bf16 v[72:75], v[92:95], v[114:117], 0
    s_nop 0
    v_permlane16_swap_b32 v68, v69
    v_mfma_f32_16x16x32_bf16 v[12:15], v[140:143], v[48:51], v[12:15]
    v_add_f32 v68, v68, v69
    v_mov_b32 v69, v68
    v_mfma_f32_16x16x32_bf16 v[8:11], v[136:139], v[48:51], v[8:11]
    ds_read_b128 v[48:51], v2 offset:26624
    v_mfma_f32_16x16x32_bf16 v[8:11], v[148:151], v[52:55], v[8:11]
    ds_read_b128 v[52:55], v2 offset:27648
    s_waitcnt lgkmcnt(2)
    v_mfma_f32_16x16x32_bf16 v[8:11], v[160:163], v[40:43], v[8:11]
    v_cvt_pk_bf16_f32 v114, v72, v73
    v_cvt_pk_bf16_f32 v115, v74, v75
    v_mfma_f32_16x16x32_bf16 v[8:11], v[172:175], v[44:47], v[8:11]
    v_cvt_pk_bf16_f32 v116, v72, v73
    v_cvt_pk_bf16_f32 v117, v74, v75
    v_mfma_f32_16x16x32_bf16 v[12:15], v[176:179], v[44:47], v[12:15]
    v_permlane32_swap_b32 v114, v116
    v_mfma_f32_16x16x32_bf16 v[12:15], v[164:167], v[40:43], v[12:15]
    s_add_u32 s31, s31, 1
    v_permlane32_swap_b32 v115, v117
    v_mfma_f32_16x16x32_bf16 v[16:19], v[168:171], v[40:43], v[16:19]
    ds_read_b128 v[40:43], v2 offset:28672
    s_sub_u32 s54, s31, 2
    v_mfma_f32_16x16x32_bf16 v[16:19], v[180:183], v[44:47], v[16:19]
    ds_read_b128 v[44:47], v2 offset:29696
    s_waitcnt lgkmcnt(2)
    v_mfma_f32_16x16x32_bf16 v[16:19], v[192:195], v[48:51], v[16:19]
    buffer_store_dwordx4 v[114:117], v7, s[12:15], s36 offen sc1
    v_mov_b32 v6, s54
    v_mfma_f32_16x16x32_bf16 v[16:19], v[204:207], v[52:55], v[16:19]
    s_add_u32 s36, s36, 32768
    v_permlane32_swap_b32 v68, v69
    v_mfma_f32_16x16x32_bf16 v[12:15], v[200:203], v[52:55], v[12:15]
    s_cmp_ge_i32 s31, 30
    s_cselect_b32 s18, 0x1ffff, s18
    v_add_f32 v68, v68, v69
    v_mfma_f32_16x16x32_bf16 v[12:15], v[188:191], v[48:51], v[12:15]
    s_add_u32 s33, s33, 34816
    v_mul_f32 v68, 0x3a800000, v68
    v_mov_b32 v69, v68
    v_mfma_f32_16x16x32_bf16 v[8:11], v[184:187], v[48:51], v[8:11]
    ds_read_b128 v[48:51], v2 offset:30720
    s_add_u32 s34, s34, 36864
    v_mfma_f32_16x16x32_bf16 v[8:11], v[196:199], v[52:55], v[8:11]
    ds_read_b128 v[52:55], v2 offset:31744
    s_waitcnt lgkmcnt(2)
    v_mfma_f32_16x16x32_bf16 v[8:11], v[208:211], v[40:43], v[8:11]
    s_cmp_ge_u32 s34, 147456
    s_cselect_b32 s38, 147456, 0
    s_sub_u32 s34, s34, s38
    v_mfma_f32_16x16x32_bf16 v[8:11], v[220:223], v[44:47], v[8:11]
    buffer_load_dwordx4 v[96:99], v1, s[24:27], s41 offen sc1
    v_mfma_f32_16x16x32_bf16 v[12:15], v[224:227], v[44:47], v[12:15]
    s_waitcnt vmcnt(12)
    v_cmp_gt_i32 vcc, s32, v5
    v_mfma_f32_16x16x32_bf16 v[12:15], v[212:215], v[40:43], v[12:15]
    v_permlane16_swap_b32 v68, v69
    v_mfma_f32_16x16x32_bf16 v[16:19], v[216:219], v[40:43], v[16:19]
    ds_read_b128 v[40:43], v3 offset:0
    v_fma_f32 v69, -v68, v68, v69
    v_mfma_f32_16x16x32_bf16 v[16:19], v[228:231], v[44:47], v[16:19]
    ds_read_b128 v[44:47], v3 offset:1024
    s_waitcnt lgkmcnt(2)
    v_mfma_f32_16x16x32_bf16 v[16:19], v[240:243], v[48:51], v[16:19]
    s_and_b64 vcc, vcc, s[18:19]
    s_cbranch_scc1 Lqkv_slowg01
Lqkv_backg01:
    v_mfma_f32_16x16x32_bf16 v[16:19], v[252:255], v[52:55], v[16:19]
    s_add_u32 s16, s16, 8192
    v_max_f32 v69, 0, v69
    v_add_f32 v69, 0x3727c5ac, v69
    v_mfma_f32_16x16x32_bf16 v[12:15], v[248:251], v[52:55], v[12:15]
    s_and_b32 s16, s16, 524287
    v_rsq_f32 v69, v69
    v_mfma_f32_16x16x32_bf16 v[12:15], v[236:239], v[48:51], v[12:15]
    buffer_load_dword v5, v4, s[4:7], s16 offen sc1
    v_mfma_f32_16x16x32_bf16 v[8:11], v[232:235], v[48:51], v[8:11]
    ds_read_b128 v[48:51], v3 offset:2048
    v_mfma_f32_16x16x32_bf16 v[8:11], v[244:247], v[52:55], v[8:11]
    ds_read_b128 v[52:55], v3 offset:3072
    s_and_b32 s37, s31, 30
    s_cbranch_scc1 Lqkv_g11
    s_branch Lqkv_s11
Lqkv_slows11:
Lqkv_spins11:
    buffer_load_dword v5, v4, s[4:7], s16 offen sc1
    s_waitcnt vmcnt(0)
    v_cmp_gt_i32 vcc, s32, v5
    s_sub_u32 s43, s43, 1
    s_cmp_lt_i32 s43, 0
    s_cbranch_scc1 Lqkv_backs11
    s_and_b64 vcc, vcc, s[18:19]
    s_cbranch_scc0 Lqkv_backs11
    s_sleep 8
    s_branch Lqkv_spins11
Lqkv_slowg11:
Lqkv_sping11:
    buffer_load_dword v5, v4, s[4:7], s16 offen sc1
    s_waitcnt vmcnt(0)
    v_cmp_gt_i32 vcc, s32, v5
    s_sub_u32 s43, s43, 1
    s_cmp_lt_i32 s43, 0
    s_cbranch_scc1 Lqkv_backg11
    s_and_b64 vcc, vcc, s[18:19]
    s_cbranch_scc0 Lqkv_backg11
    s_sleep 8
    s_branch Lqkv_sping11
Lqkv_slowg01:
Lqkv_sping01:
    buffer_load_dword v5, v4, s[4:7], s16 offen sc1
    s_waitcnt vmcnt(0)
    v_cmp_gt_i32 vcc, s32, v5
    s_sub_u32 s43, s43, 1
    s_cmp_lt_i32 s43, 0
    s_cbranch_scc1 Lqkv_backg01
    s_and_b64 vcc, vcc, s[18:19]
    s_cbranch_scc0 Lqkv_backg01
    s_sleep 8
    s_branch Lqkv_sping01
Lqkv_s12:
    s_waitcnt lgkmcnt(2)
    v_mfma_f32_16x16x32_bf16 v[24:27], a[0:3], v[40:43], 0
    s_add_u32 m0, s34, 0
    v_mul_f32 v124, s52, v71
    v_mov_b32 v106, s42
    v_mfma_f32_16x16x32_bf16 v[24:27], a[12:15], v[44:47], v[24:27]
    s_add_u32 s35, s35, 36864
    v_mov_b32 v107, s42
    v_mov_b32 v108, s42
    v_mfma_f32_16x16x32_bf16 v[28:31], a[16:19], v[44:47], 0
    s_cmp_eq_u32 s35, 147456
    s_cselect_b32 s35, 0, s35
    v_mov_b32 v109, s42
    v_mfma_f32_16x16x32_bf16 v[28:31], a[4:7], v[40:43], v[28:31]
    s_waitcnt vmcnt(1)
    v_fma_f32 v16, -v68, v64, v16
    v_fma_f32 v17, -v68, v65, v17
    v_mfma_f32_16x16x32_bf16 v[106:109], v[96:99], v[88:91], v[106:109]
    v_fma_f32 v18, -v68, v66, v18
    v_fma_f32 v19, -v68, v67, v19
    v_mfma_f32_16x16x32_bf16 v[32:35], a[8:11], v[40:43], 0
    ds_read_b128 v[40:43], v3 offset:4096
    v_mul_f32 v16, v16, v69
    v_mfma_f32_16x16x32_bf16 v[32:35], a[20:23], v[44:47], v[32:35]
    ds_read_b128 v[44:47], v3 offset:5120
    s_waitcnt lgkmcnt(2)
    v_mfma_f32_16x16x32_bf16 v[32:35], a[32:35], v[48:51], v[32:35]
    v_cndmask_b32 v106, v106, v107, s[44:45]
    v_cndmask_b32 v108, v108, v109, s[44:45]
    v_mfma_f32_16x16x32_bf16 v[32:35], a[44:47], v[52:55], v[32:35]
    v_cndmask_b32 v120, v106, v118, s[48:49]
    v_cndmask_b32 v121, v108, v119, s[50:51]
    v_mfma_f32_16x16x32_bf16 v[28:31], a[40:43], v[52:55], v[28:31]
    v_mul_f32 v17, v17, v69
    v_mul_f32 v18, v18, v69
    v_mfma_f32_16x16x32_bf16 v[28:31], a[28:31], v[48:51], v[28:31]
    ds_write_b64 v36, v[120:121] offset:2048
    v_mfma_f32_16x16x32_bf16 v[24:27], a[24:27], v[48:51], v[24:27]
    ds_read_b128 v[48:51], v3 offset:6144
    v_mul_f32 v19, v19, v69
    v_mfma_f32_16x16x32_bf16 v[24:27], a[36:39], v[52:55], v[24:27]
    ds_read_b128 v[52:55], v3 offset:7168
    s_waitcnt lgkmcnt(3)
    v_mfma_f32_16x16x32_bf16 v[24:27], a[48:51], v[40:43], v[24:27]
    v_cvt_pk_bf16_f32 v16, v16, v17
    v_cvt_pk_bf16_f32 v17, v18, v19
    v_mfma_f32_16x16x32_bf16 v[24:27], a[60:63], v[44:47], v[24:27]
    s_waitcnt lgkmcnt(2)
    ds_write_b64 v38, v[16:17]
    v_mfma_f32_16x16x32_bf16 v[28:31], a[64:67], v[44:47], v[28:31]
    ds_read_b64_tr_b16 v[92:93], v39
    v_fma_f32 v12, -v68, v60, v12
    v_mfma_f32_16x16x32_bf16 v[28:31], a[52:55], v[40:43], v[28:31]
    buffer_load_dwordx4 v1, s[8:11], s33 offen offset:0 sc1 lds
    v_mfma_f32_16x16x32_bf16 v[32:35], a[56:59], v[40:43], v[32:35]
    ds_read_b128 v[40:43], v3 offset:8192
    v_fma_f32 v13, -v68, v61, v13
    v_mfma_f32_16x16x32_bf16 v[32:35], a[68:71], v[44:47], v[32:35]
    ds_read_b128 v[44:47], v3 offset:9216
    s_waitcnt lgkmcnt(4)
    v_mfma_f32_16x16x32_bf16 v[32:35], a[80:83], v[48:51], v[32:35]
    v_fma_f32 v14, -v68, v62, v14
    v_fma_f32 v15, -v68, v63, v15
    v_mfma_f32_16x16x32_bf16 v[32:35], a[92:95], v[52:55], v[32:35]
    s_barrier
    v_mfma_f32_16x16x32_bf16 v[28:31], a[88:91], v[52:55], v[28:31]
    buffer_load_dwordx4 v1, s[8:11], s33 offen offset:1024 sc1 lds
    v_mfma_f32_16x16x32_bf16 v[28:31], a[76:79], v[48:51], v[28:31]
    ds_read_b64 v[122:123], v37 offset:2048
    v_mul_f32 v12, v12, v69
    v_mfma_f32_16x16x32_bf16 v[24:27], a[72:75], v[48:51], v[24:27]
    ds_read_b128 v[48:51], v3 offset:10240
    v_mul_f32 v13, v13, v69
    v_mfma_f32_16x16x32_bf16 v[24:27], a[84:87], v[52:55], v[24:27]
    ds_read_b128 v[52:55], v3 offset:11264
    s_waitcnt lgkmcnt(3)
    v_mfma_f32_16x16x32_bf16 v[24:27], a[96:99], v[40:43], v[24:27]
    buffer_store_dword v6, v21, s[12:15], s17 offen sc1
    v_mul_f32 v14, v14, v69
    v_mfma_f32_16x16x32_bf16 v[24:27], a[108:111], v[44:47], v[24:27]
    s_cmp_ge_i32 s54, 0
    s_cselect_b32 s14, s6, 0
    v_mul_f32 v15, v15, v69
    v_mfma_f32_16x16x32_bf16 v[28:31], a[112:115], v[44:47], v[28:31]
    s_waitcnt lgkmcnt(2)
    buffer_load_dwordx4 v1, s[8:11], s33 offen offset:2048 sc1 lds
    v_mfma_f32_16x16x32_bf16 v[28:31], a[100:103], v[40:43], v[28:31]
    s_add_u32 s17, s17, 8192
    v_add_f32 v122, v122, v120
    v_add_f32 v123, v123, v121
    v_mfma_f32_16x16x32_bf16 v[32:35], a[104:107], v[40:43], v[32:35]
    ds_read_b128 v[40:43], v3 offset:12288
    v_max_f32 v22, v122, v123
    v_mfma_f32_16x16x32_bf16 v[32:35], a[116:119], v[44:47], v[32:35]
    ds_read_b128 v[44:47], v3 offset:13312
    s_waitcnt lgkmcnt(2)
    v_mfma_f32_16x16x32_bf16 v[32:35], a[128:131], v[48:51], v[32:35]
    v_mov_b32 v23, v22
    v_sub_u32 v76, v3, v20
    v_mfma_f32_16x16x32_bf16 v[32:35], a[140:143], v[52:55], v[32:35]
    buffer_load_dwordx4 v1, s[8:11], s33 offen offset:3072 sc1 lds
    v_mfma_f32_16x16x32_bf16 v[28:31], a[136:139], v[52:55], v[28:31]
    s_add_u32 m0, s34, 4096
    v_permlane16_swap_b32 v22, v23
    v_mfma_f32_16x16x32_bf16 v[28:31], a[124:127], v[48:51], v[28:31]
    s_add_u32 s37, s33, 4096
    v_max_f32 v22, v22, v23
    v_mov_b32 v23, v22
    v_mfma_f32_16x16x32_bf16 v[24:27], a[120:123], v[48:51], v[24:27]
    ds_read_b128 v[48:51], v3 offset:14336
    v_cvt_pk_bf16_f32 v84, v12, v13
    v_mfma_f32_16x16x32_bf16 v[24:27], a[132:135], v[52:55], v[24:27]
    ds_read_b128 v[52:55], v3 offset:15360
    s_waitcnt lgkmcnt(2)
    v_mfma_f32_16x16x32_bf16 v[24:27], a[144:147], v[40:43], v[24:27]
    buffer_load_dwordx4 v1, s[8:11], s37 offen offset:0 sc1 lds
    v_mfma_f32_16x16x32_bf16 v[24:27], a[156:159], v[44:47], v[24:27]
    ds_read2st64_b64 v[80:83], v76 offset0:66 offset1:67
    v_cvt_pk_bf16_f32 v85, v14, v15
    v_mfma_f32_16x16x32_bf16 v[28:31], a[160:163], v[44:47], v[28:31]
    ds_read2st64_b64 v[76:79], v76 offset0:64 offset1:65
    v_fma_f32 v8, -v68, v56, v8
    v_mfma_f32_16x16x32_bf16 v[28:31], a[148:151], v[40:43], v[28:31]
    v_permlane32_swap_b32 v22, v23
    v_mfma_f32_16x16x32_bf16 v[32:35], a[152:155], v[40:43], v[32:35]
    ds_read_b128 v[40:43], v3 offset:16384
    v_max_f32 v22, v22, v23
    v_mfma_f32_16x16x32_bf16 v[32:35], a[164:167], v[44:47], v[32:35]
    ds_read_b128 v[44:47], v3 offset:17408
    s_waitcnt lgkmcnt(4)
    v_mfma_f32_16x16x32_bf16 v[32:35], a[176:179], v[48:51], v[32:35]
    buffer_load_dwordx4 v1, s[8:11], s37 offen offset:1024 sc1 lds
    v_mfma_f32_16x16x32_bf16 v[32:35], a[188:191], v[52:55], v[32:35]
    v_mul_f32 v22, v124, v22
    v_fma_f32 v122, v122, v124, -v22
    v_mfma_f32_16x16x32_bf16 v[28:31], a[184:187], v[52:55], v[28:31]
    v_fma_f32 v123, v123, v124, -v22
    v_fma_f32 v9, -v68, v57, v9
    v_mfma_f32_16x16x32_bf16 v[28:31], a[172:175], v[48:51], v[28:31]
    v_exp_f32 v122, v122
    v_mfma_f32_16x16x32_bf16 v[24:27], a[168:171], v[48:51], v[24:27]
    ds_read_b128 v[48:51], v3 offset:18432
    v_fma_f32 v10, -v68, v58, v10
    v_mfma_f32_16x16x32_bf16 v[24:27], a[180:183], v[52:55], v[24:27]
    ds_read_b128 v[52:55], v3 offset:19456
    s_waitcnt lgkmcnt(2)
    v_mfma_f32_16x16x32_bf16 v[24:27], a[192:195], v[40:43], v[24:27]
    buffer_load_dwordx4 v1, s[8:11], s37 offen offset:2048 sc1 lds
    v_mfma_f32_16x16x32_bf16 v[24:27], a[204:207], v[44:47], v[24:27]
    v_exp_f32 v123, v123
    v_mfma_f32_16x16x32_bf16 v[28:31], a[208:211], v[44:47], v[28:31]
    v_add_f32 v22, v122, v123
    v_mov_b32 v23, v22
    v_mfma_f32_16x16x32_bf16 v[28:31], a[196:199], v[40:43], v[28:31]
    s_nop 0
    v_permlane16_swap_b32 v22, v23
    v_mfma_f32_16x16x32_bf16 v[32:35], a[200:203], v[40:43], v[32:35]
    ds_read_b128 v[40:43], v3 offset:20480
    v_add_f32 v22, v22, v23
    v_mfma_f32_16x16x32_bf16 v[32:35], a[212:215], v[44:47], v[32:35]
    ds_read_b128 v[44:47], v3 offset:21504
    s_waitcnt lgkmcnt(2)
    v_mfma_f32_16x16x32_bf16 v[32:35], a[224:227], v[48:51], v[32:35]
    buffer_load_dwordx4 v1, s[8:11], s37 offen offset:3072 sc1 lds
    v_mfma_f32_16x16x32_bf16 v[32:35], a[236:239], v[52:55], v[32:35]
    s_add_u32 m0, s34, 8192
    v_mov_b32 v23, v22
    v_fma_f32 v11, -v68, v59, v11
    v_mfma_f32_16x16x32_bf16 v[28:31], a[232:235], v[52:55], v[28:31]
    s_add_u32 s37, s33, 8192
    v_permlane32_swap_b32 v22, v23
    v_mfma_f32_16x16x32_bf16 v[28:31], a[220:223], v[48:51], v[28:31]
    v_add_f32 v22, v22, v23
    v_cvt_pk_bf16_f32 v88, v8, v9
    v_mfma_f32_16x16x32_bf16 v[24:27], a[216:219], v[48:51], v[24:27]
    ds_read_b128 v[48:51], v3 offset:22528
    v_cvt_pk_bf16_f32 v89, v10, v11
    v_mfma_f32_16x16x32_bf16 v[24:27], a[228:231], v[52:55], v[24:27]
    ds_read_b128 v[52:55], v3 offset:23552
    s_waitcnt lgkmcnt(2)
    v_mfma_f32_16x16x32_bf16 v[110:113], v[84:87], v[88:91], 0
    buffer_load_dwordx4 v1, s[8:11], s37 offen offset:0 sc1 lds
    v_mfma_f32_16x16x32_bf16 v[24:27], a[240:243], v[40:43], v[24:27]
    v_mov_b32 v8, v84
    v_mov_b32 v9, v85
    v_mfma_f32_16x16x32_bf16 v[24:27], a[252:255], v[44:47], v[24:27]
    v_rcp_f32 v22, v22
    v_mfma_f32_16x16x32_bf16 v[28:31], v[128:131], v[44:47], v[28:31]
    v_mul_f32 v122, v122, v22
    v_mul_f32 v123, v123, v22
    v_mfma_f32_16x16x32_bf16 v[28:31], a[244:247], v[40:43], v[28:31]
    v_cvt_pk_bf16_f32 v23, v122, v123
    v_perm_b32 v114, v23, v23, v102
    v_mfma_f32_16x16x32_bf16 v[32:35], a[248:251], v[40:43], v[32:35]
    ds_read_b128 v[40:43], v3 offset:24576
    v_mov_b32 v10, v92
    v_mfma_f32_16x16x32_bf16 v[32:35], v[132:135], v[44:47], v[32:35]
    ds_read_b128 v[44:47], v3 offset:25600
    s_waitcnt lgkmcnt(2)
    v_mfma_f32_16x16x32_bf16 v[32:35], v[144:147], v[48:51], v[32:35]
    v_mov_b32 v11, v93
    v_perm_b32 v115, v23, v23, v103
    v_mfma_f32_16x16x32_bf16 v[32:35], v[156:159], v[52:55], v[32:35]
    buffer_store_dwordx4 v[8:11], v1, s[4:7], s40 offen sc1
    v_perm_b32 v116, v23, v23, v104
    v_mfma_f32_16x16x32_bf16 v[28:31], v[152:155], v[52:55], v[28:31]
    s_add_u32 s40, s40, 262144
    v_perm_b32 v117, v23, v23, v105
    v_mov_b32 v100, v94
    v_mfma_f32_16x16x32_bf16 v[28:31], v[140:143], v[48:51], v[28:31]
    s_add_u32 s41, s41, 262144
    v_mov_b32 v101, v95
    v_cndmask_b32 v118, v110, v111, s[44:45]
    v_mfma_f32_16x16x32_bf16 v[24:27], v[136:139], v[48:51], v[24:27]
    ds_read_b128 v[48:51], v3 offset:26624
    v_cndmask_b32 v119, v112, v113, s[44:45]
    v_mfma_f32_16x16x32_bf16 v[72:75], v[98:101], v[114:117], 0
    v_add_f32 v76, v76, v80
    v_add_f32 v77, v77, v81
    v_mfma_f32_16x16x32_bf16 v[24:27], v[148:151], v[52:55], v[24:27]
    ds_read_b128 v[52:55], v3 offset:27648
    s_waitcnt lgkmcnt(2)
    v_mfma_f32_16x16x32_bf16 v[24:27], v[160:163], v[40:43], v[24:27]
    v_add_f32 v78, v78, v82
    v_add_f32 v79, v79, v83
    v_mfma_f32_16x16x32_bf16 v[24:27], v[172:175], v[44:47], v[24:27]
    v_cvt_pk_bf16_f32 v114, v72, v73
    v_cvt_pk_bf16_f32 v115, v74, v75
    v_mfma_f32_16x16x32_bf16 v[28:31], v[176:179], v[44:47], v[28:31]
    v_cvt_pk_bf16_f32 v116, v72, v73
    v_cvt_pk_bf16_f32 v117, v74, v75
    v_mfma_f32_16x16x32_bf16 v[28:31], v[164:167], v[40:43], v[28:31]
    s_add_u32 s31, s31, 1
    v_permlane32_swap_b32 v114, v116
    v_mfma_f32_16x16x32_bf16 v[32:35], v[168:171], v[40:43], v[32:35]
    ds_read_b128 v[40:43], v3 offset:28672
    v_add_f32 v70, v76, v78
    v_mfma_f32_16x16x32_bf16 v[32:35], v[180:183], v[44:47], v[32:35]
    ds_read_b128 v[44:47], v3 offset:29696
    s_waitcnt lgkmcnt(2)
    v_mfma_f32_16x16x32_bf16 v[32:35], v[192:195], v[48:51], v[32:35]
    s_sub_u32 s54, s31, 2
    v_permlane32_swap_b32 v115, v117
    v_mfma_f32_16x16x32_bf16 v[32:35], v[204:207], v[52:55], v[32:35]
    buffer_store_dwordx4 v[114:117], v7, s[12:15], s36 offen sc1
    v_mov_b32 v6, s54
    v_mfma_f32_16x16x32_bf16 v[28:31], v[200:203], v[52:55], v[28:31]
    s_add_u32 s36, s36, 32768
    v_add_f32 v71, v77, v79
    v_add_u32 v2, s35, v1
    v_mfma_f32_16x16x32_bf16 v[28:31], v[188:191], v[48:51], v[28:31]
    s_cmp_ge_i32 s31, 30
    s_cselect_b32 s18, 0x1ffff, s18
    s_add_u32 s33, s33, 34816
    v_mfma_f32_16x16x32_bf16 v[24:27], v[184:187], v[48:51], v[24:27]
    ds_read_b128 v[48:51], v3 offset:30720
    s_add_u32 s34, s34, 36864
    v_mfma_f32_16x16x32_bf16 v[24:27], v[196:199], v[52:55], v[24:27]
    ds_read_b128 v[52:55], v3 offset:31744
    s_waitcnt lgkmcnt(2)
    v_mfma_f32_16x16x32_bf16 v[24:27], v[208:211], v[40:43], v[24:27]
    s_cmp_ge_u32 s34, 147456
    s_cselect_b32 s38, 147456, 0
    s_sub_u32 s34, s34, s38
    v_mfma_f32_16x16x32_bf16 v[24:27], v[220:223], v[44:47], v[24:27]
    s_waitcnt vmcnt(12)
    v_cmp_gt_i32 vcc, s32, v5
    v_mfma_f32_16x16x32_bf16 v[28:31], v[224:227], v[44:47], v[28:31]
    v_permlane16_swap_b32 v70, v71
    v_mfma_f32_16x16x32_bf16 v[28:31], v[212:215], v[40:43], v[28:31]
    s_and_b64 vcc, vcc, s[18:19]
    s_cbranch_scc1 Lqkv_slows12
Lqkv_backs12:
    v_mfma_f32_16x16x32_bf16 v[32:35], v[216:219], v[40:43], v[32:35]
    ds_read_b128 v[40:43], v2 offset:0
    v_add_f32 v70, v70, v71
    v_mfma_f32_16x16x32_bf16 v[32:35], v[228:231], v[44:47], v[32:35]
    ds_read_b128 v[44:47], v2 offset:1024
    s_waitcnt lgkmcnt(2)
    v_mfma_f32_16x16x32_bf16 v[32:35], v[240:243], v[48:51], v[32:35]
    s_add_u32 s16, s16, 8192
    v_mov_b32 v71, v70
    s_and_b32 s16, s16, 524287
    v_mfma_f32_16x16x32_bf16 v[32:35], v[252:255], v[52:55], v[32:35]
    buffer_load_dword v5, v4, s[4:7], s16 offen sc1
    v_mfma_f32_16x16x32_bf16 v[28:31], v[248:251], v[52:55], v[28:31]
    v_permlane32_swap_b32 v70, v71
    v_mfma_f32_16x16x32_bf16 v[28:31], v[236:239], v[48:51], v[28:31]
    v_add_f32 v70, v70, v71
    v_mul_f32 v70, 0x3a800000, v70
    v_mfma_f32_16x16x32_bf16 v[24:27], v[232:235], v[48:51], v[24:27]
    ds_read_b128 v[48:51], v2 offset:2048
    v_mov_b32 v71, v70
    v_mfma_f32_16x16x32_bf16 v[24:27], v[244:247], v[52:55], v[24:27]
    ds_read_b128 v[52:55], v2 offset:3072
    v_permlane16_swap_b32 v70, v71
    v_fma_f32 v71, -v70, v70, v71
    v_max_f32 v71, 0, v71
    v_add_f32 v71, 0x3727c5ac, v71
    v_rsq_f32 v71, v71
    s_nop 1
    s_branch Lqkv_g02
    .p2align 6
Lqkv_g12:
    s_waitcnt lgkmcnt(2)
    v_mfma_f32_16x16x32_bf16 v[24:27], a[0:3], v[40:43], 0
    s_add_u32 m0, s34, 0
    v_mul_f32 v124, s52, v71
    v_fma_f32 v16, -v68, v64, v16
    v_mfma_f32_16x16x32_bf16 v[24:27], a[12:15], v[44:47], v[24:27]
    s_add_u32 s35, s35, 36864
    v_fma_f32 v12, -v68, v60, v12
    v_fma_f32 v13, -v68, v61, v13
    v_mfma_f32_16x16x32_bf16 v[28:31], a[16:19], v[44:47], 0
    s_cmp_eq_u32 s35, 147456
    s_cselect_b32 s35, 0, s35
    v_fma_f32 v14, -v68, v62, v14
    v_mfma_f32_16x16x32_bf16 v[28:31], a[4:7], v[40:43], v[28:31]
    v_fma_f32 v15, -v68, v63, v15
    v_mul_f32 v12, v12, v69
    v_mfma_f32_16x16x32_bf16 v[32:35], a[8:11], v[40:43], 0
    ds_read_b128 v[40:43], v3 offset:4096
    v_mul_f32 v13, v13, v69
    v_mfma_f32_16x16x32_bf16 v[32:35], a[20:23], v[44:47], v[32:35]
    ds_read_b128 v[44:47], v3 offset:5120
    s_waitcnt lgkmcnt(2)
    v_mfma_f32_16x16x32_bf16 v[32:35], a[32:35], v[48:51], v[32:35]
    v_mul_f32 v14, v14, v69
    v_mul_f32 v15, v15, v69
    v_mfma_f32_16x16x32_bf16 v[32:35], a[44:47], v[52:55], v[32:35]
    v_cvt_pk_bf16_f32 v84, v12, v13
    v_cvt_pk_bf16_f32 v85, v14, v15
    v_mfma_f32_16x16x32_bf16 v[28:31], a[40:43], v[52:55], v[28:31]
    v_fma_f32 v17, -v68, v65, v17
    v_fma_f32 v18, -v68, v66, v18
    v_mfma_f32_16x16x32_bf16 v[106:109], v[84:87], v[88:91], 0
    v_fma_f32 v19, -v68, v67, v19
    v_mul_f32 v16, v16, v69
    v_mfma_f32_16x16x32_bf16 v[28:31], a[28:31], v[48:51], v[28:31]
    v_mul_f32 v17, v17, v69
    v_mul_f32 v18, v18, v69
    v_mfma_f32_16x16x32_bf16 v[24:27], a[24:27], v[48:51], v[24:27]
    ds_read_b128 v[48:51], v3 offset:6144
    v_mul_f32 v19, v19, v69
    v_mfma_f32_16x16x32_bf16 v[24:27], a[36:39], v[52:55], v[24:27]
    ds_read_b128 v[52:55], v3 offset:7168
    s_waitcnt lgkmcnt(2)
    v_mfma_f32_16x16x32_bf16 v[24:27], a[48:51], v[40:43], v[24:27]
    v_cndmask_b32 v106, v106, v107, s[44:45]
    v_cndmask_b32 v108, v108, v109, s[44:45]
    v_mfma_f32_16x16x32_bf16 v[24:27], a[60:63], v[44:47], v[24:27]
    v_cndmask_b32 v120, v106, v118, s[48:49]
    v_cndmask_b32 v121, v108, v119, s[50:51]
    v_mfma_f32_16x16x32_bf16 v[28:31], a[64:67], v[44:47], v[28:31]
    ds_write_b64 v36, v[120:121] offset:2048
    v_mfma_f32_16x16x32_bf16 v[28:31], a[52:55], v[40:43], v[28:31]
    v_cvt_pk_bf16_f32 v16, v16, v17
    v_cvt_pk_bf16_f32 v17, v18, v19
    v_mfma_f32_16x16x32_bf16 v[32:35], a[56:59], v[40:43], v[32:35]
    ds_read_b128 v[40:43], v3 offset:8192
    v_fma_f32 v8, -v68, v56, v8
    v_mfma_f32_16x16x32_bf16 v[32:35], a[68:71], v[44:47], v[32:35]
    ds_read_b128 v[44:47], v3 offset:9216
    s_waitcnt lgkmcnt(3)
    v_mfma_f32_16x16x32_bf16 v[32:35], a[80:83], v[48:51], v[32:35]
    s_waitcnt vmcnt(3) lgkmcnt(2)
    ds_write_b64 v38, v[16:17]
    v_mfma_f32_16x16x32_bf16 v[32:35], a[92:95], v[52:55], v[32:35]
    ds_read_b64_tr_b16 v[92:93], v39
    v_fma_f32 v9, -v68, v57, v9
    v_mfma_f32_16x16x32_bf16 v[28:31], a[88:91], v[52:55], v[28:31]
    s_barrier
    v_mfma_f32_16x16x32_bf16 v[28:31], a[76:79], v[48:51], v[28:31]
    buffer_load_dwordx4 v1, s[8:11], s33 offen offset:0 sc1 lds
    v_mfma_f32_16x16x32_bf16 v[24:27], a[72:75], v[48:51], v[24:27]
    ds_read_b128 v[48:51], v3 offset:10240
    v_fma_f32 v10, -v68, v58, v10
    v_mfma_f32_16x16x32_bf16 v[24:27], a[84:87], v[52:55], v[24:27]
    ds_read_b128 v[52:55], v3 offset:11264
    s_waitcnt lgkmcnt(4)
    v_mfma_f32_16x16x32_bf16 v[24:27], a[96:99], v[40:43], v[24:27]
    s_waitcnt vmcnt(3)
    buffer_store_dword v6, v21, s[12:15], s17 offen sc1
    v_mfma_f32_16x16x32_bf16 v[24:27], a[108:111], v[44:47], v[24:27]
    ds_read_b64 v[122:123], v37 offset:2048
    v_fma_f32 v11, -v68, v59, v11
    v_mfma_f32_16x16x32_bf16 v[28:31], a[112:115], v[44:47], v[28:31]
    s_cmp_ge_i32 s54, 0
    s_cselect_b32 s14, s6, 0
    v_cvt_pk_bf16_f32 v88, v8, v9
    v_mfma_f32_16x16x32_bf16 v[28:31], a[100:103], v[40:43], v[28:31]
    s_add_u32 s17, s17, 8192
    v_sub_u32 v76, v3, v20
    v_cvt_pk_bf16_f32 v89, v10, v11
    v_mfma_f32_16x16x32_bf16 v[32:35], a[104:107], v[40:43], v[32:35]
    ds_read_b128 v[40:43], v3 offset:12288
    v_add_u32 v2, s35, v1
    v_mfma_f32_16x16x32_bf16 v[110:113], v[84:87], v[88:91], 0
    buffer_load_dwordx4 v1, s[8:11], s33 offen offset:1024 sc1 lds
    v_mfma_f32_16x16x32_bf16 v[32:35], a[116:119], v[44:47], v[32:35]
    ds_read_b128 v[44:47], v3 offset:13312
    s_waitcnt lgkmcnt(2)
    v_mfma_f32_16x16x32_bf16 v[32:35], a[128:131], v[48:51], v[32:35]
    ds_read2st64_b64 v[80:83], v76 offset0:66 offset1:67
    v_add_f32 v122, v122, v120
    v_mfma_f32_16x16x32_bf16 v[32:35], a[140:143], v[52:55], v[32:35]
    ds_read2st64_b64 v[76:79], v76 offset0:64 offset1:65
    v_add_f32 v123, v123, v121
    v_mfma_f32_16x16x32_bf16 v[28:31], a[136:139], v[52:55], v[28:31]
    v_max_f32 v22, v122, v123
    v_mov_b32 v23, v22
    v_mfma_f32_16x16x32_bf16 v[28:31], a[124:127], v[48:51], v[28:31]
    buffer_load_dwordx4 v1, s[8:11], s33 offen offset:2048 sc1 lds
    v_mfma_f32_16x16x32_bf16 v[24:27], a[120:123], v[48:51], v[24:27]
    ds_read_b128 v[48:51], v3 offset:14336
    v_cndmask_b32 v118, v110, v111, s[44:45]
    v_mfma_f32_16x16x32_bf16 v[24:27], a[132:135], v[52:55], v[24:27]
    ds_read_b128 v[52:55], v3 offset:15360
    s_waitcnt lgkmcnt(4)
    v_mfma_f32_16x16x32_bf16 v[24:27], a[144:147], v[40:43], v[24:27]
    v_permlane16_swap_b32 v22, v23
    v_mfma_f32_16x16x32_bf16 v[24:27], a[156:159], v[44:47], v[24:27]
    v_max_f32 v22, v22, v23
    v_mov_b32 v23, v22
    v_mfma_f32_16x16x32_bf16 v[28:31], a[160:163], v[44:47], v[28:31]
    buffer_load_dwordx4 v1, s[8:11], s33 offen offset:3072 sc1 lds
    v_mfma_f32_16x16x32_bf16 v[28:31], a[148:151], v[40:43], v[28:31]
    s_add_u32 m0, s34, 4096
    v_permlane32_swap_b32 v22, v23
    v_mfma_f32_16x16x32_bf16 v[32:35], a[152:155], v[40:43], v[32:35]
    ds_read_b128 v[40:43], v3 offset:16384
    v_max_f32 v22, v22, v23
    v_mfma_f32_16x16x32_bf16 v[32:35], a[164:167], v[44:47], v[32:35]
    ds_read_b128 v[44:47], v3 offset:17408
    s_waitcnt lgkmcnt(2)
    v_mfma_f32_16x16x32_bf16 v[32:35], a[176:179], v[48:51], v[32:35]
    s_add_u32 s37, s33, 4096
    v_mul_f32 v22, v124, v22
    v_fma_f32 v122, v122, v124, -v22
    v_mfma_f32_16x16x32_bf16 v[32:35], a[188:191], v[52:55], v[32:35]
    buffer_load_dwordx4 v1, s[8:11], s37 offen offset:0 sc1 lds
    v_mfma_f32_16x16x32_bf16 v[28:31], a[184:187], v[52:55], v[28:31]
    v_fma_f32 v123, v123, v124, -v22
    v_cndmask_b32 v119, v112, v113, s[44:45]
    v_mfma_f32_16x16x32_bf16 v[28:31], a[172:175], v[48:51], v[28:31]
    v_exp_f32 v122, v122
    v_mfma_f32_16x16x32_bf16 v[24:27], a[168:171], v[48:51], v[24:27]
    ds_read_b128 v[48:51], v3 offset:18432
    v_add_f32 v76, v76, v80
    v_mfma_f32_16x16x32_bf16 v[24:27], a[180:183], v[52:55], v[24:27]
    ds_read_b128 v[52:55], v3 offset:19456
    s_waitcnt lgkmcnt(2)
    v_mfma_f32_16x16x32_bf16 v[24:27], a[192:195], v[40:43], v[24:27]
    buffer_load_dwordx4 v1, s[8:11], s37 offen offset:1024 sc1 lds
    v_mfma_f32_16x16x32_bf16 v[24:27], a[204:207], v[44:47], v[24:27]
    v_exp_f32 v123, v123
    v_mfma_f32_16x16x32_bf16 v[28:31], a[208:211], v[44:47], v[28:31]
    v_add_f32 v22, v122, v123
    v_mov_b32 v23, v22
    v_mfma_f32_16x16x32_bf16 v[28:31], a[196:199], v[40:43], v[28:31]
    s_nop 0
    v_permlane16_swap_b32 v22, v23
    v_mfma_f32_16x16x32_bf16 v[32:35], a[200:203], v[40:43], v[32:35]
    ds_read_b128 v[40:43], v3 offset:20480
    v_add_f32 v22, v22, v23
    v_mfma_f32_16x16x32_bf16 v[32:35], a[212:215], v[44:47], v[32:35]
    ds_read_b128 v[44:47], v3 offset:21504
    s_waitcnt lgkmcnt(2)
    v_mfma_f32_16x16x32_bf16 v[32:35], a[224:227], v[48:51], v[32:35]
    buffer_load_dwordx4 v1, s[8:11], s37 offen offset:2048 sc1 lds
    v_mfma_f32_16x16x32_bf16 v[32:35], a[236:239], v[52:55], v[32:35]
    v_mov_b32 v23, v22
    v_add_f32 v77, v77, v81
    v_mfma_f32_16x16x32_bf16 v[28:31], a[232:235], v[52:55], v[28:31]
    v_permlane32_swap_b32 v22, v23
    v_mfma_f32_16x16x32_bf16 v[28:31], a[220:223], v[48:51], v[28:31]
    v_add_f32 v22, v22, v23
    v_add_f32 v78, v78, v82
    v_mfma_f32_16x16x32_bf16 v[24:27], a[216:219], v[48:51], v[24:27]
    ds_read_b128 v[48:51], v3 offset:22528
    v_add_f32 v79, v79, v83
    v_mfma_f32_16x16x32_bf16 v[24:27], a[228:231], v[52:55], v[24:27]
    ds_read_b128 v[52:55], v3 offset:23552
    s_waitcnt lgkmcnt(2)
    v_mfma_f32_16x16x32_bf16 v[24:27], a[240:243], v[40:43], v[24:27]
    buffer_load_dwordx4 v1, s[8:11], s37 offen offset:3072 sc1 lds
    v_mfma_f32_16x16x32_bf16 v[24:27], a[252:255], v[44:47], v[24:27]
    s_add_u32 m0, s34, 8192
    v_rcp_f32 v22, v22
    v_mfma_f32_16x16x32_bf16 v[28:31], v[128:131], v[44:47], v[28:31]
    s_add_u32 s37, s33, 8192
    v_mul_f32 v122, v122, v22
    v_mul_f32 v123, v123, v22
    v_mfma_f32_16x16x32_bf16 v[28:31], a[244:247], v[40:43], v[28:31]
    v_cvt_pk_bf16_f32 v23, v122, v123
    v_perm_b32 v114, v23, v23, v102
    v_mfma_f32_16x16x32_bf16 v[32:35], a[248:251], v[40:43], v[32:35]
    ds_read_b128 v[40:43], v3 offset:24576
    v_perm_b32 v115, v23, v23, v103
    v_mfma_f32_16x16x32_bf16 v[32:35], v[132:135], v[44:47], v[32:35]
    ds_read_b128 v[44:47], v3 offset:25600
    s_waitcnt lgkmcnt(2)
    v_mfma_f32_16x16x32_bf16 v[32:35], v[144:147], v[48:51], v[32:35]
    buffer_load_dwordx4 v1, s[8:11], s37 offen offset:0 sc1 lds
    v_mfma_f32_16x16x32_bf16 v[32:35], v[156:159], v[52:55], v[32:35]
    v_perm_b32 v116, v23, v23, v104
    v_perm_b32 v117, v23, v23, v105
    v_mfma_f32_16x16x32_bf16 v[28:31], v[152:155], v[52:55], v[28:31]
    v_add_f32 v70, v76, v78
    v_add_f32 v71, v77, v79
    v_mfma_f32_16x16x32_bf16 v[72:75], v[92:95], v[114:117], 0
    s_nop 0
    v_permlane16_swap_b32 v70, v71
    v_mfma_f32_16x16x32_bf16 v[28:31], v[140:143], v[48:51], v[28:31]
    v_add_f32 v70, v70, v71
    v_mov_b32 v71, v70
    v_mfma_f32_16x16x32_bf16 v[24:27], v[136:139], v[48:51], v[24:27]
    ds_read_b128 v[48:51], v3 offset:26624
    v_mfma_f32_16x16x32_bf16 v[24:27], v[148:151], v[52:55], v[24:27]
    ds_read_b128 v[52:55], v3 offset:27648
    s_waitcnt lgkmcnt(2)
    v_mfma_f32_16x16x32_bf16 v[24:27], v[160:163], v[40:43], v[24:27]
    v_cvt_pk_bf16_f32 v114, v72, v73
    v_cvt_pk_bf16_f32 v115, v74, v75
    v_mfma_f32_16x16x32_bf16 v[24:27], v[172:175], v[44:47], v[24:27]
    v_cvt_pk_bf16_f32 v116, v72, v73
    v_cvt_pk_bf16_f32 v117, v74, v75
    v_mfma_f32_16x16x32_bf16 v[28:31], v[176:179], v[44:47], v[28:31]
    v_permlane32_swap_b32 v114, v116
    v_mfma_f32_16x16x32_bf16 v[28:31], v[164:167], v[40:43], v[28:31]
    s_add_u32 s31, s31, 1
    v_permlane32_swap_b32 v115, v117
    v_mfma_f32_16x16x32_bf16 v[32:35], v[168:171], v[40:43], v[32:35]
    ds_read_b128 v[40:43], v3 offset:28672
    s_sub_u32 s54, s31, 2
    v_mfma_f32_16x16x32_bf16 v[32:35], v[180:183], v[44:47], v[32:35]
    ds_read_b128 v[44:47], v3 offset:29696
    s_waitcnt lgkmcnt(2)
    v_mfma_f32_16x16x32_bf16 v[32:35], v[192:195], v[48:51], v[32:35]
    buffer_store_dwordx4 v[114:117], v7, s[12:15], s36 offen sc1
    v_mov_b32 v6, s54
    v_mfma_f32_16x16x32_bf16 v[32:35], v[204:207], v[52:55], v[32:35]
    s_add_u32 s36, s36, 32768
    v_permlane32_swap_b32 v70, v71
    v_mfma_f32_16x16x32_bf16 v[28:31], v[200:203], v[52:55], v[28:31]
    s_cmp_ge_i32 s31, 30
    s_cselect_b32 s18, 0x1ffff, s18
    v_add_f32 v70, v70, v71
    v_mfma_f32_16x16x32_bf16 v[28:31], v[188:191], v[48:51], v[28:31]
    s_add_u32 s33, s33, 34816
    v_mul_f32 v70, 0x3a800000, v70
    v_mov_b32 v71, v70
    v_mfma_f32_16x16x32_bf16 v[24:27], v[184:187], v[48:51], v[24:27]
    ds_read_b128 v[48:51], v3 offset:30720
    s_add_u32 s34, s34, 36864
    v_mfma_f32_16x16x32_bf16 v[24:27], v[196:199], v[52:55], v[24:27]
    ds_read_b128 v[52:55], v3 offset:31744
    s_waitcnt lgkmcnt(2)
    v_mfma_f32_16x16x32_bf16 v[24:27], v[208:211], v[40:43], v[24:27]
    s_cmp_ge_u32 s34, 147456
    s_cselect_b32 s38, 147456, 0
    s_sub_u32 s34, s34, s38
    v_mfma_f32_16x16x32_bf16 v[24:27], v[220:223], v[44:47], v[24:27]
    s_waitcnt vmcnt(11)
    v_cmp_gt_i32 vcc, s32, v5
    v_mfma_f32_16x16x32_bf16 v[28:31], v[224:227], v[44:47], v[28:31]
    v_permlane16_swap_b32 v70, v71
    v_mfma_f32_16x16x32_bf16 v[28:31], v[212:215], v[40:43], v[28:31]
    s_and_b64 vcc, vcc, s[18:19]
    s_cbranch_scc1 Lqkv_slowg12
Lqkv_backg12:
    v_mfma_f32_16x16x32_bf16 v[32:35], v[216:219], v[40:43], v[32:35]
    ds_read_b128 v[40:43], v2 offset:0
    v_fma_f32 v71, -v70, v70, v71
    v_mfma_f32_16x16x32_bf16 v[32:35], v[228:231], v[44:47], v[32:35]
    ds_read_b128 v[44:47], v2 offset:1024
    s_waitcnt lgkmcnt(2)
    v_mfma_f32_16x16x32_bf16 v[32:35], v[240:243], v[48:51], v[32:35]
    s_add_u32 s16, s16, 8192
    v_max_f32 v71, 0, v71
    v_add_f32 v71, 0x3727c5ac, v71
    v_mfma_f32_16x16x32_bf16 v[32:35], v[252:255], v[52:55], v[32:35]
    s_and_b32 s16, s16, 524287
    v_rsq_f32 v71, v71
    v_mfma_f32_16x16x32_bf16 v[28:31], v[248:251], v[52:55], v[28:31]
    buffer_load_dword v5, v4, s[4:7], s16 offen sc1
    v_mfma_f32_16x16x32_bf16 v[28:31], v[236:239], v[48:51], v[28:31]
    v_mfma_f32_16x16x32_bf16 v[24:27], v[232:235], v[48:51], v[24:27]
    ds_read_b128 v[48:51], v2 offset:2048
    v_mfma_f32_16x16x32_bf16 v[24:27], v[244:247], v[52:55], v[24:27]
    ds_read_b128 v[52:55], v2 offset:3072
    s_cmp_eq_u32 s31, 64
    s_cbranch_scc1 Lqkv_tail
Lqkv_g02:
    s_waitcnt lgkmcnt(2)
    v_mfma_f32_16x16x32_bf16 v[8:11], a[0:3], v[40:43], 0
    s_add_u32 m0, s34, 0
    v_mul_f32 v124, s52, v69
    v_fma_f32 v32, -v70, v64, v32
    v_mfma_f32_16x16x32_bf16 v[8:11], a[12:15], v[44:47], v[8:11]
    s_add_u32 s35, s35, 36864
    v_fma_f32 v28, -v70, v60, v28
    v_fma_f32 v29, -v70, v61, v29
    v_mfma_f32_16x16x32_bf16 v[12:15], a[16:19], v[44:47], 0
    s_cmp_eq_u32 s35, 147456
    s_cselect_b32 s35, 0, s35
    v_fma_f32 v30, -v70, v62, v30
    v_mfma_f32_16x16x32_bf16 v[12:15], a[4:7], v[40:43], v[12:15]
    v_fma_f32 v31, -v70, v63, v31
    v_mul_f32 v28, v28, v71
    v_mfma_f32_16x16x32_bf16 v[16:19], a[8:11], v[40:43], 0
    ds_read_b128 v[40:43], v2 offset:4096
    v_mul_f32 v29, v29, v71
    v_mfma_f32_16x16x32_bf16 v[16:19], a[20:23], v[44:47], v[16:19]
    ds_read_b128 v[44:47], v2 offset:5120
    s_waitcnt lgkmcnt(2)
    v_mfma_f32_16x16x32_bf16 v[16:19], a[32:35], v[48:51], v[16:19]
    v_mul_f32 v30, v30, v71
    v_mul_f32 v31, v31, v71
    v_mfma_f32_16x16x32_bf16 v[16:19], a[44:47], v[52:55], v[16:19]
    v_cvt_pk_bf16_f32 v84, v28, v29
    v_cvt_pk_bf16_f32 v85, v30, v31
    v_mfma_f32_16x16x32_bf16 v[12:15], a[40:43], v[52:55], v[12:15]
    v_fma_f32 v33, -v70, v65, v33
    v_fma_f32 v34, -v70, v66, v34
    v_mfma_f32_16x16x32_bf16 v[106:109], v[84:87], v[88:91], 0
    v_fma_f32 v35, -v70, v67, v35
    v_mul_f32 v32, v32, v71
    v_mfma_f32_16x16x32_bf16 v[12:15], a[28:31], v[48:51], v[12:15]
    v_mul_f32 v33, v33, v71
    v_mul_f32 v34, v34, v71
    v_mfma_f32_16x16x32_bf16 v[8:11], a[24:27], v[48:51], v[8:11]
    ds_read_b128 v[48:51], v2 offset:6144
    v_mul_f32 v35, v35, v71
    v_mfma_f32_16x16x32_bf16 v[8:11], a[36:39], v[52:55], v[8:11]
    ds_read_b128 v[52:55], v2 offset:7168
    s_waitcnt lgkmcnt(2)
    v_mfma_f32_16x16x32_bf16 v[8:11], a[48:51], v[40:43], v[8:11]
    v_cndmask_b32 v106, v106, v107, s[44:45]
    v_cndmask_b32 v108, v108, v109, s[44:45]
    v_mfma_f32_16x16x32_bf16 v[8:11], a[60:63], v[44:47], v[8:11]
    v_cndmask_b32 v120, v106, v118, s[48:49]
    v_cndmask_b32 v121, v108, v119, s[50:51]
    v_mfma_f32_16x16x32_bf16 v[12:15], a[64:67], v[44:47], v[12:15]
    ds_write_b64 v36, v[120:121] offset:0
    v_mfma_f32_16x16x32_bf16 v[12:15], a[52:55], v[40:43], v[12:15]
    v_cvt_pk_bf16_f32 v32, v32, v33
    v_cvt_pk_bf16_f32 v33, v34, v35
    v_mfma_f32_16x16x32_bf16 v[16:19], a[56:59], v[40:43], v[16:19]
    ds_read_b128 v[40:43], v2 offset:8192
    v_fma_f32 v24, -v70, v56, v24
    v_mfma_f32_16x16x32_bf16 v[16:19], a[68:71], v[44:47], v[16:19]
    ds_read_b128 v[44:47], v2 offset:9216
    s_waitcnt lgkmcnt(3)
    v_mfma_f32_16x16x32_bf16 v[16:19], a[80:83], v[48:51], v[16:19]
    s_waitcnt vmcnt(2) lgkmcnt(2)
    ds_write_b64 v38, v[32:33]
    v_mfma_f32_16x16x32_bf16 v[16:19], a[92:95], v[52:55], v[16:19]
    ds_read_b64_tr_b16 v[94:95], v39
    v_fma_f32 v25, -v70, v57, v25
    v_mfma_f32_16x16x32_bf16 v[12:15], a[88:91], v[52:55], v[12:15]
    s_barrier
    v_mfma_f32_16x16x32_bf16 v[12:15], a[76:79], v[48:51], v[12:15]
    buffer_load_dwordx4 v1, s[8:11], s33 offen offset:0 sc1 lds
    v_mfma_f32_16x16x32_bf16 v[8:11], a[72:75], v[48:51], v[8:11]
    ds_read_b128 v[48:51], v2 offset:10240
    v_fma_f32 v26, -v70, v58, v26
    v_mfma_f32_16x16x32_bf16 v[8:11], a[84:87], v[52:55], v[8:11]
    ds_read_b128 v[52:55], v2 offset:11264
    s_waitcnt lgkmcnt(4)
    v_mfma_f32_16x16x32_bf16 v[8:11], a[96:99], v[40:43], v[8:11]
    s_waitcnt vmcnt(2)
    buffer_store_dword v6, v21, s[12:15], s17 offen sc1
    v_mfma_f32_16x16x32_bf16 v[8:11], a[108:111], v[44:47], v[8:11]
    ds_read_b64 v[122:123], v37 offset:0
    v_fma_f32 v27, -v70, v59, v27
    v_mfma_f32_16x16x32_bf16 v[12:15], a[112:115], v[44:47], v[12:15]
    s_cmp_ge_i32 s54, 0
    s_cselect_b32 s14, s6, 0
    v_cvt_pk_bf16_f32 v88, v24, v25
    v_mfma_f32_16x16x32_bf16 v[12:15], a[100:103], v[40:43], v[12:15]
    s_add_u32 s17, s17, 8192
    v_sub_u32 v76, v2, v20
    v_cvt_pk_bf16_f32 v89, v26, v27
    v_mfma_f32_16x16x32_bf16 v[16:19], a[104:107], v[40:43], v[16:19]
    ds_read_b128 v[40:43], v2 offset:12288
    v_add_u32 v3, s35, v1
    v_mfma_f32_16x16x32_bf16 v[110:113], v[84:87], v[88:91], 0
    buffer_load_dwordx4 v1, s[8:11], s33 offen offset:1024 sc1 lds
    v_mfma_f32_16x16x32_bf16 v[16:19], a[116:119], v[44:47], v[16:19]
    ds_read_b128 v[44:47], v2 offset:13312
    s_waitcnt lgkmcnt(2)
    v_mfma_f32_16x16x32_bf16 v[16:19], a[128:131], v[48:51], v[16:19]
    ds_read2st64_b64 v[80:83], v76 offset0:66 offset1:67
    v_add_f32 v122, v122, v120
    v_mfma_f32_16x16x32_bf16 v[16:19], a[140:143], v[52:55], v[16:19]
    ds_read2st64_b64 v[76:79], v76 offset0:64 offset1:65
    v_add_f32 v123, v123, v121
    v_mfma_f32_16x16x32_bf16 v[12:15], a[136:139], v[52:55], v[12:15]
    v_max_f32 v22, v122, v123
    v_mov_b32 v23, v22
    v_mfma_f32_16x16x32_bf16 v[12:15], a[124:127], v[48:51], v[12:15]
    buffer_load_dwordx4 v1, s[8:11], s33 offen offset:2048 sc1 lds
    v_mfma_f32_16x16x32_bf16 v[8:11], a[120:123], v[48:51], v[8:11]
    ds_read_b128 v[48:51], v2 offset:14336
    v_cndmask_b32 v118, v110, v111, s[44:45]
    v_mfma_f32_16x16x32_bf16 v[8:11], a[132:135], v[52:55], v[8:11]
    ds_read_b128 v[52:55], v2 offset:15360
    s_waitcnt lgkmcnt(4)
    v_mfma_f32_16x16x32_bf16 v[8:11], a[144:147], v[40:43], v[8:11]
    v_permlane16_swap_b32 v22, v23
    v_mfma_f32_16x16x32_bf16 v[8:11], a[156:159], v[44:47], v[8:11]
    v_max_f32 v22, v22, v23
    v_mov_b32 v23, v22
    v_mfma_f32_16x16x32_bf16 v[12:15], a[160:163], v[44:47], v[12:15]
    buffer_load_dwordx4 v1, s[8:11], s33 offen offset:3072 sc1 lds
    v_mfma_f32_16x16x32_bf16 v[12:15], a[148:151], v[40:43], v[12:15]
    s_add_u32 m0, s34, 4096
    v_permlane32_swap_b32 v22, v23
    v_mfma_f32_16x16x32_bf16 v[16:19], a[152:155], v[40:43], v[16:19]
    ds_read_b128 v[40:43], v2 offset:16384
    v_max_f32 v22, v22, v23
    v_mfma_f32_16x16x32_bf16 v[16:19], a[164:167], v[44:47], v[16:19]
    ds_read_b128 v[44:47], v2 offset:17408
    s_waitcnt lgkmcnt(2)
    v_mfma_f32_16x16x32_bf16 v[16:19], a[176:179], v[48:51], v[16:19]
    s_add_u32 s37, s33, 4096
    v_mul_f32 v22, v124, v22
    v_fma_f32 v122, v122, v124, -v22
    v_mfma_f32_16x16x32_bf16 v[16:19], a[188:191], v[52:55], v[16:19]
    buffer_load_dwordx4 v1, s[8:11], s37 offen offset:0 sc1 lds
    v_mfma_f32_16x16x32_bf16 v[12:15], a[184:187], v[52:55], v[12:15]
    v_fma_f32 v123, v123, v124, -v22
    v_cndmask_b32 v119, v112, v113, s[44:45]
    v_mfma_f32_16x16x32_bf16 v[12:15], a[172:175], v[48:51], v[12:15]
    v_exp_f32 v122, v122
    v_mfma_f32_16x16x32_bf16 v[8:11], a[168:171], v[48:51], v[8:11]
    ds_read_b128 v[48:51], v2 offset:18432
    v_add_f32 v76, v76, v80
    v_mfma_f32_16x16x32_bf16 v[8:11], a[180:183], v[52:55], v[8:11]
    ds_read_b128 v[52:55], v2 offset:19456
    s_waitcnt lgkmcnt(2)
    v_mfma_f32_16x16x32_bf16 v[8:11], a[192:195], v[40:43], v[8:11]
    buffer_load_dwordx4 v1, s[8:11], s37 offen offset:1024 sc1 lds
    v_mfma_f32_16x16x32_bf16 v[8:11], a[204:207], v[44:47], v[8:11]
    v_exp_f32 v123, v123
    v_mfma_f32_16x16x32_bf16 v[12:15], a[208:211], v[44:47], v[12:15]
    v_add_f32 v22, v122, v123
    v_mov_b32 v23, v22
    v_mfma_f32_16x16x32_bf16 v[12:15], a[196:199], v[40:43], v[12:15]
    s_nop 0
    v_permlane16_swap_b32 v22, v23
    v_mfma_f32_16x16x32_bf16 v[16:19], a[200:203], v[40:43], v[16:19]
    ds_read_b128 v[40:43], v2 offset:20480
    v_add_f32 v22, v22, v23
    v_mfma_f32_16x16x32_bf16 v[16:19], a[212:215], v[44:47], v[16:19]
    ds_read_b128 v[44:47], v2 offset:21504
    s_waitcnt lgkmcnt(2)
    v_mfma_f32_16x16x32_bf16 v[16:19], a[224:227], v[48:51], v[16:19]
    buffer_load_dwordx4 v1, s[8:11], s37 offen offset:2048 sc1 lds
    v_mfma_f32_16x16x32_bf16 v[16:19], a[236:239], v[52:55], v[16:19]
    v_mov_b32 v23, v22
    v_add_f32 v77, v77, v81
    v_mfma_f32_16x16x32_bf16 v[12:15], a[232:235], v[52:55], v[12:15]
    v_permlane32_swap_b32 v22, v23
    v_mfma_f32_16x16x32_bf16 v[12:15], a[220:223], v[48:51], v[12:15]
    v_add_f32 v22, v22, v23
    v_add_f32 v78, v78, v82
    v_mfma_f32_16x16x32_bf16 v[8:11], a[216:219], v[48:51], v[8:11]
    ds_read_b128 v[48:51], v2 offset:22528
    v_add_f32 v79, v79, v83
    v_mfma_f32_16x16x32_bf16 v[8:11], a[228:231], v[52:55], v[8:11]
    ds_read_b128 v[52:55], v2 offset:23552
    s_waitcnt lgkmcnt(2)
    v_mfma_f32_16x16x32_bf16 v[8:11], a[240:243], v[40:43], v[8:11]
    buffer_load_dwordx4 v1, s[8:11], s37 offen offset:3072 sc1 lds
    v_mfma_f32_16x16x32_bf16 v[8:11], a[252:255], v[44:47], v[8:11]
    s_add_u32 m0, s34, 8192
    v_rcp_f32 v22, v22
    v_mfma_f32_16x16x32_bf16 v[12:15], v[128:131], v[44:47], v[12:15]
    s_add_u32 s37, s33, 8192
    v_mul_f32 v122, v122, v22
    v_mul_f32 v123, v123, v22
    v_mfma_f32_16x16x32_bf16 v[12:15], a[244:247], v[40:43], v[12:15]
    v_cvt_pk_bf16_f32 v23, v122, v123
    v_perm_b32 v116, v23, v23, v102
    v_mfma_f32_16x16x32_bf16 v[16:19], a[248:251], v[40:43], v[16:19]
    ds_read_b128 v[40:43], v2 offset:24576
    v_perm_b32 v117, v23, v23, v103
    v_mfma_f32_16x16x32_bf16 v[16:19], v[132:135], v[44:47], v[16:19]
    ds_read_b128 v[44:47], v2 offset:25600
    s_waitcnt lgkmcnt(2)
    v_mfma_f32_16x16x32_bf16 v[16:19], v[144:147], v[48:51], v[16:19]
    buffer_load_dwordx4 v1, s[8:11], s37 offen offset:0 sc1 lds
    v_mfma_f32_16x16x32_bf16 v[16:19], v[156:159], v[52:55], v[16:19]
    v_perm_b32 v114, v23, v23, v104
    v_perm_b32 v115, v23, v23, v105
    v_mfma_f32_16x16x32_bf16 v[12:15], v[152:155], v[52:55], v[12:15]
    v_add_f32 v68, v76, v78
    v_add_f32 v69, v77, v79
    v_mfma_f32_16x16x32_bf16 v[72:75], v[92:95], v[114:117], 0
    s_nop 0
    v_permlane16_swap_b32 v68, v69
    v_mfma_f32_16x16x32_bf16 v[12:15], v[140:143], v[48:51], v[12:15]
    v_add_f32 v68, v68, v69
    v_mov_b32 v69, v68
    v_mfma_f32_16x16x32_bf16 v[8:11], v[136:139], v[48:51], v[8:11]
    ds_read_b128 v[48:51], v2 offset:26624
    v_mfma_f32_16x16x32_bf16 v[8:11], v[148:151], v[52:55], v[8:11]
    ds_read_b128 v[52:55], v2 offset:27648
    s_waitcnt lgkmcnt(2)
    v_mfma_f32_16x16x32_bf16 v[8:11], v[160:163], v[40:43], v[8:11]
    v_cvt_pk_bf16_f32 v114, v72, v73
    v_cvt_pk_bf16_f32 v115, v74, v75
    v_mfma_f32_16x16x32_bf16 v[8:11], v[172:175], v[44:47], v[8:11]
    v_cvt_pk_bf16_f32 v116, v72, v73
    v_cvt_pk_bf16_f32 v117, v74, v75
    v_mfma_f32_16x16x32_bf16 v[12:15], v[176:179], v[44:47], v[12:15]
    v_permlane32_swap_b32 v114, v116
    v_mfma_f32_16x16x32_bf16 v[12:15], v[164:167], v[40:43], v[12:15]
    s_add_u32 s31, s31, 1
    v_permlane32_swap_b32 v115, v117
    v_mfma_f32_16x16x32_bf16 v[16:19], v[168:171], v[40:43], v[16:19]
    ds_read_b128 v[40:43], v2 offset:28672
    s_sub_u32 s54, s31, 2
    v_mfma_f32_16x16x32_bf16 v[16:19], v[180:183], v[44:47], v[16:19]
    ds_read_b128 v[44:47], v2 offset:29696
    s_waitcnt lgkmcnt(2)
    v_mfma_f32_16x16x32_bf16 v[16:19], v[192:195], v[48:51], v[16:19]
    buffer_store_dwordx4 v[114:117], v7, s[12:15], s36 offen sc1
    v_mov_b32 v6, s54
    v_mfma_f32_16x16x32_bf16 v[16:19], v[204:207], v[52:55], v[16:19]
    s_add_u32 s36, s36, 32768
    v_permlane32_swap_b32 v68, v69
    v_mfma_f32_16x16x32_bf16 v[12:15], v[200:203], v[52:55], v[12:15]
    s_cmp_ge_i32 s31, 30
    s_cselect_b32 s18, 0x1ffff, s18
    v_add_f32 v68, v68, v69
    v_mfma_f32_16x16x32_bf16 v[12:15], v[188:191], v[48:51], v[12:15]
    s_add_u32 s33, s33, 34816
    v_mul_f32 v68, 0x3a800000, v68
    v_mov_b32 v69, v68
    v_mfma_f32_16x16x32_bf16 v[8:11], v[184:187], v[48:51], v[8:11]
    ds_read_b128 v[48:51], v2 offset:30720
    s_add_u32 s34, s34, 36864
    v_mfma_f32_16x16x32_bf16 v[8:11], v[196:199], v[52:55], v[8:11]
    ds_read_b128 v[52:55], v2 offset:31744
    s_waitcnt lgkmcnt(2)
    v_mfma_f32_16x16x32_bf16 v[8:11], v[208:211], v[40:43], v[8:11]
    s_cmp_ge_u32 s34, 147456
    s_cselect_b32 s38, 147456, 0
    s_sub_u32 s34, s34, s38
    v_mfma_f32_16x16x32_bf16 v[8:11], v[220:223], v[44:47], v[8:11]
    buffer_load_dwordx4 v[96:99], v1, s[24:27], s41 offen sc1
    v_mfma_f32_16x16x32_bf16 v[12:15], v[224:227], v[44:47], v[12:15]
    s_waitcnt vmcnt(12)
    v_cmp_gt_i32 vcc, s32, v5
    v_mfma_f32_16x16x32_bf16 v[12:15], v[212:215], v[40:43], v[12:15]
    v_permlane16_swap_b32 v68, v69
    v_mfma_f32_16x16x32_bf16 v[16:19], v[216:219], v[40:43], v[16:19]
    ds_read_b128 v[40:43], v3 offset:0
    v_fma_f32 v69, -v68, v68, v69
    v_mfma_f32_16x16x32_bf16 v[16:19], v[228:231], v[44:47], v[16:19]
    ds_read_b128 v[44:47], v3 offset:1024
    s_waitcnt lgkmcnt(2)
    v_mfma_f32_16x16x32_bf16 v[16:19], v[240:243], v[48:51], v[16:19]
    s_and_b64 vcc, vcc, s[18:19]
    s_cbranch_scc1 Lqkv_slowg02
Lqkv_backg02:
    v_mfma_f32_16x16x32_bf16 v[16:19], v[252:255], v[52:55], v[16:19]
    s_add_u32 s16, s16, 8192
    v_max_f32 v69, 0, v69
    v_add_f32 v69, 0x3727c5ac, v69
    v_mfma_f32_16x16x32_bf16 v[12:15], v[248:251], v[52:55], v[12:15]
    s_and_b32 s16, s16, 524287
    v_rsq_f32 v69, v69
    v_mfma_f32_16x16x32_bf16 v[12:15], v[236:239], v[48:51], v[12:15]
    buffer_load_dword v5, v4, s[4:7], s16 offen sc1
    v_mfma_f32_16x16x32_bf16 v[8:11], v[232:235], v[48:51], v[8:11]
    ds_read_b128 v[48:51], v3 offset:2048
    v_mfma_f32_16x16x32_bf16 v[8:11], v[244:247], v[52:55], v[8:11]
    ds_read_b128 v[52:55], v3 offset:3072
    s_and_b32 s37, s31, 30
    s_cbranch_scc1 Lqkv_g12
    s_branch Lqkv_s12
Lqkv_slows12:
Lqkv_spins12:
    buffer_load_dword v5, v4, s[4:7], s16 offen sc1
    s_waitcnt vmcnt(0)
    v_cmp_gt_i32 vcc, s32, v5
    s_sub_u32 s43, s43, 1
    s_cmp_lt_i32 s43, 0
    s_cbranch_scc1 Lqkv_backs12
    s_and_b64 vcc, vcc, s[18:19]
    s_cbranch_scc0 Lqkv_backs12
    s_sleep 8
    s_branch Lqkv_spins12
Lqkv_slowg12:
Lqkv_sping12:
    buffer_load_dword v5, v4, s[4:7], s16 offen sc1
    s_waitcnt vmcnt(0)
    v_cmp_gt_i32 vcc, s32, v5
    s_sub_u32 s43, s43, 1
    s_cmp_lt_i32 s43, 0
    s_cbranch_scc1 Lqkv_backg12
    s_and_b64 vcc, vcc, s[18:19]
    s_cbranch_scc0 Lqkv_backg12
    s_sleep 8
    s_branch Lqkv_sping12
Lqkv_slowg02:
Lqkv_sping02:
    buffer_load_dword v5, v4, s[4:7], s16 offen sc1
    s_waitcnt vmcnt(0)
    v_cmp_gt_i32 vcc, s32, v5
    s_sub_u32 s43, s43, 1
    s_cmp_lt_i32 s43, 0
    s_cbranch_scc1 Lqkv_backg02
    s_and_b64 vcc, vcc, s[18:19]
    s_cbranch_scc0 Lqkv_backg02
    s_sleep 8
    s_branch Lqkv_sping02
Lqkv_s13:
    s_waitcnt lgkmcnt(2)
    v_mfma_f32_16x16x32_bf16 v[24:27], a[0:3], v[40:43], 0
    s_add_u32 m0, s34, 0
    v_mul_f32 v124, s52, v71
    v_mov_b32 v106, s42
    v_mfma_f32_16x16x32_bf16 v[24:27], a[12:15], v[44:47], v[24:27]
    s_add_u32 s35, s35, 36864
    v_mov_b32 v107, s42
    v_mov_b32 v108, s42
    v_mfma_f32_16x16x32_bf16 v[28:31], a[16:19], v[44:47], 0
    s_cmp_eq_u32 s35, 147456
    s_cselect_b32 s35, 0, s35
    v_mov_b32 v109, s42
    v_mfma_f32_16x16x32_bf16 v[28:31], a[4:7], v[40:43], v[28:31]
    s_waitcnt vmcnt(1)
    v_fma_f32 v16, -v68, v64, v16
    v_fma_f32 v17, -v68, v65, v17
    v_mfma_f32_16x16x32_bf16 v[106:109], v[96:99], v[88:91], v[106:109]
    v_fma_f32 v18, -v68, v66, v18
    v_fma_f32 v19, -v68, v67, v19
    v_mfma_f32_16x16x32_bf16 v[32:35], a[8:11], v[40:43], 0
    ds_read_b128 v[40:43], v3 offset:4096
    v_mul_f32 v16, v16, v69
    v_mfma_f32_16x16x32_bf16 v[32:35], a[20:23], v[44:47], v[32:35]
    ds_read_b128 v[44:47], v3 offset:5120
    s_waitcnt lgkmcnt(2)
    v_mfma_f32_16x16x32_bf16 v[32:35], a[32:35], v[48:51], v[32:35]
    v_cndmask_b32 v106, v106, v107, s[44:45]
    v_cndmask_b32 v108, v108, v109, s[44:45]
    v_mfma_f32_16x16x32_bf16 v[32:35], a[44:47], v[52:55], v[32:35]
    v_cndmask_b32 v120, v106, v118, s[48:49]
    v_cndmask_b32 v121, v108, v119, s[50:51]
    v_mfma_f32_16x16x32_bf16 v[28:31], a[40:43], v[52:55], v[28:31]
    v_mul_f32 v17, v17, v69
    v_mul_f32 v18, v18, v69
    v_mfma_f32_16x16x32_bf16 v[28:31], a[28:31], v[48:51], v[28:31]
    ds_write_b64 v36, v[120:121] offset:2048
    v_mfma_f32_16x16x32_bf16 v[24:27], a[24:27], v[48:51], v[24:27]
    ds_read_b128 v[48:51], v3 offset:6144
    v_mul_f32 v19, v19, v69
    v_mfma_f32_16x16x32_bf16 v[24:27], a[36:39], v[52:55], v[24:27]
    ds_read_b128 v[52:55], v3 offset:7168
    s_waitcnt lgkmcnt(3)
    v_mfma_f32_16x16x32_bf16 v[24:27], a[48:51], v[40:43], v[24:27]
    v_cvt_pk_bf16_f32 v16, v16, v17
    v_cvt_pk_bf16_f32 v17, v18, v19
    v_mfma_f32_16x16x32_bf16 v[24:27], a[60:63], v[44:47], v[24:27]
    s_waitcnt lgkmcnt(2)
    ds_write_b64 v38, v[16:17]
    v_mfma_f32_16x16x32_bf16 v[28:31], a[64:67], v[44:47], v[28:31]
    ds_read_b64_tr_b16 v[92:93], v39
    v_fma_f32 v12, -v68, v60, v12
    v_mfma_f32_16x16x32_bf16 v[28:31], a[52:55], v[40:43], v[28:31]
    buffer_load_dwordx4 v1, s[8:11], s33 offen offset:0 sc1 lds
    v_mfma_f32_16x16x32_bf16 v[32:35], a[56:59], v[40:43], v[32:35]
    ds_read_b128 v[40:43], v3 offset:8192
    v_fma_f32 v13, -v68, v61, v13
    v_mfma_f32_16x16x32_bf16 v[32:35], a[68:71], v[44:47], v[32:35]
    ds_read_b128 v[44:47], v3 offset:9216
    s_waitcnt lgkmcnt(4)
    v_mfma_f32_16x16x32_bf16 v[32:35], a[80:83], v[48:51], v[32:35]
    v_fma_f32 v14, -v68, v62, v14
    v_fma_f32 v15, -v68, v63, v15
    v_mfma_f32_16x16x32_bf16 v[32:35], a[92:95], v[52:55], v[32:35]
    v_mul_f32 v12, v12, v69
    v_mul_f32 v13, v13, v69
    v_mfma_f32_16x16x32_bf16 v[28:31], a[88:91], v[52:55], v[28:31]
    s_barrier
    v_mfma_f32_16x16x32_bf16 v[28:31], a[76:79], v[48:51], v[28:31]
    buffer_load_dwordx4 v1, s[8:11], s33 offen offset:1024 sc1 lds
    v_mfma_f32_16x16x32_bf16 v[24:27], a[72:75], v[48:51], v[24:27]
    ds_read_b128 v[48:51], v3 offset:10240
    v_mul_f32 v14, v14, v69
    v_mfma_f32_16x16x32_bf16 v[24:27], a[84:87], v[52:55], v[24:27]
    ds_read_b128 v[52:55], v3 offset:11264
    s_waitcnt lgkmcnt(2)
    v_mfma_f32_16x16x32_bf16 v[24:27], a[96:99], v[40:43], v[24:27]
    buffer_store_dword v6, v21, s[12:15], s17 offen sc1
    v_mul_f32 v15, v15, v69
    v_mfma_f32_16x16x32_bf16 v[24:27], a[108:111], v[44:47], v[24:27]
    ds_read_b64 v[122:123], v37 offset:2048
    v_cvt_pk_bf16_f32 v84, v12, v13
    v_mfma_f32_16x16x32_bf16 v[28:31], a[112:115], v[44:47], v[28:31]
    s_cmp_ge_i32 s54, 0
    s_cselect_b32 s14, s6, 0
    v_cvt_pk_bf16_f32 v85, v14, v15
    v_mfma_f32_16x16x32_bf16 v[28:31], a[100:103], v[40:43], v[28:31]
    s_add_u32 s17, s17, 8192
    v_sub_u32 v76, v3, v20
    v_fma_f32 v8, -v68, v56, v8
    v_mfma_f32_16x16x32_bf16 v[32:35], a[104:107], v[40:43], v[32:35]
    ds_read_b128 v[40:43], v3 offset:12288
    v_fma_f32 v9, -v68, v57, v9
    v_mfma_f32_16x16x32_bf16 v[32:35], a[116:119], v[44:47], v[32:35]
    ds_read_b128 v[44:47], v3 offset:13312
    s_waitcnt lgkmcnt(3)
    v_mfma_f32_16x16x32_bf16 v[32:35], a[128:131], v[48:51], v[32:35]
    buffer_load_dwordx4 v1, s[8:11], s33 offen offset:2048 sc1 lds
    v_mfma_f32_16x16x32_bf16 v[32:35], a[140:143], v[52:55], v[32:35]
    s_waitcnt lgkmcnt(2)
    v_add_f32 v122, v122, v120
    v_add_f32 v123, v123, v121
    v_mfma_f32_16x16x32_bf16 v[28:31], a[136:139], v[52:55], v[28:31]
    ds_read2st64_b64 v[80:83], v76 offset0:66 offset1:67
    v_max_f32 v22, v122, v123
    v_mfma_f32_16x16x32_bf16 v[28:31], a[124:127], v[48:51], v[28:31]
    ds_read2st64_b64 v[76:79], v76 offset0:64 offset1:65
    v_mov_b32 v23, v22
    v_mfma_f32_16x16x32_bf16 v[24:27], a[120:123], v[48:51], v[24:27]
    ds_read_b128 v[48:51], v3 offset:14336
    v_fma_f32 v10, -v68, v58, v10
    v_mfma_f32_16x16x32_bf16 v[24:27], a[132:135], v[52:55], v[24:27]
    ds_read_b128 v[52:55], v3 offset:15360
    s_waitcnt lgkmcnt(4)
    v_mfma_f32_16x16x32_bf16 v[24:27], a[144:147], v[40:43], v[24:27]
    buffer_load_dwordx4 v1, s[8:11], s33 offen offset:3072 sc1 lds
    v_mfma_f32_16x16x32_bf16 v[24:27], a[156:159], v[44:47], v[24:27]
    s_add_u32 m0, s34, 4096
    v_permlane16_swap_b32 v22, v23
    v_mfma_f32_16x16x32_bf16 v[28:31], a[160:163], v[44:47], v[28:31]
    s_add_u32 s37, s33, 4096
    v_max_f32 v22, v22, v23
    v_mov_b32 v23, v22
    v_mfma_f32_16x16x32_bf16 v[28:31], a[148:151], v[40:43], v[28:31]
    s_nop 0
    v_permlane32_swap_b32 v22, v23
    v_mfma_f32_16x16x32_bf16 v[32:35], a[152:155], v[40:43], v[32:35]
    ds_read_b128 v[40:43], v3 offset:16384
    v_max_f32 v22, v22, v23
    v_mfma_f32_16x16x32_bf16 v[32:35], a[164:167], v[44:47], v[32:35]
    ds_read_b128 v[44:47], v3 offset:17408
    s_waitcnt lgkmcnt(2)
    v_mfma_f32_16x16x32_bf16 v[32:35], a[176:179], v[48:51], v[32:35]
    buffer_load_dwordx4 v1, s[8:11], s37 offen offset:0 sc1 lds
    v_mfma_f32_16x16x32_bf16 v[32:35], a[188:191], v[52:55], v[32:35]
    v_mul_f32 v22, v124, v22
    v_fma_f32 v122, v122, v124, -v22
    v_mfma_f32_16x16x32_bf16 v[28:31], a[184:187], v[52:55], v[28:31]
    v_fma_f32 v123, v123, v124, -v22
    v_fma_f32 v11, -v68, v59, v11
    v_mfma_f32_16x16x32_bf16 v[28:31], a[172:175], v[48:51], v[28:31]
    v_exp_f32 v122, v122
    v_mfma_f32_16x16x32_bf16 v[24:27], a[168:171], v[48:51], v[24:27]
    ds_read_b128 v[48:51], v3 offset:18432
    v_cvt_pk_bf16_f32 v88, v8, v9
    v_mfma_f32_16x16x32_bf16 v[24:27], a[180:183], v[52:55], v[24:27]
    ds_read_b128 v[52:55], v3 offset:19456
    s_waitcnt lgkmcnt(2)
    v_mfma_f32_16x16x32_bf16 v[24:27], a[192:195], v[40:43], v[24:27]
    buffer_load_dwordx4 v1, s[8:11], s37 offen offset:1024 sc1 lds
    v_mfma_f32_16x16x32_bf16 v[24:27], a[204:207], v[44:47], v[24:27]
    v_exp_f32 v123, v123
    v_mfma_f32_16x16x32_bf16 v[28:31], a[208:211], v[44:47], v[28:31]
    v_add_f32 v22, v122, v123
    v_mov_b32 v23, v22
    v_mfma_f32_16x16x32_bf16 v[28:31], a[196:199], v[40:43], v[28:31]
    s_nop 0
    v_permlane16_swap_b32 v22, v23
    v_mfma_f32_16x16x32_bf16 v[32:35], a[200:203], v[40:43], v[32:35]
    ds_read_b128 v[40:43], v3 offset:20480
    v_add_f32 v22, v22, v23
    v_mfma_f32_16x16x32_bf16 v[32:35], a[212:215], v[44:47], v[32:35]
    ds_read_b128 v[44:47], v3 offset:21504
    s_waitcnt lgkmcnt(2)
    v_mfma_f32_16x16x32_bf16 v[32:35], a[224:227], v[48:51], v[32:35]
    buffer_load_dwordx4 v1, s[8:11], s37 offen offset:2048 sc1 lds
    v_mfma_f32_16x16x32_bf16 v[32:35], a[236:239], v[52:55], v[32:35]
    v_mov_b32 v23, v22
    v_cvt_pk_bf16_f32 v89, v10, v11
    v_mfma_f32_16x16x32_bf16 v[28:31], a[232:235], v[52:55], v[28:31]
    v_permlane32_swap_b32 v22, v23
    v_mfma_f32_16x16x32_bf16 v[110:113], v[84:87], v[88:91], 0
    v_mov_b32 v8, v84
    v_mov_b32 v9, v85
    v_mfma_f32_16x16x32_bf16 v[28:31], a[220:223], v[48:51], v[28:31]
    v_add_f32 v22, v22, v23
    v_add_f32 v76, v76, v80
    v_mfma_f32_16x16x32_bf16 v[24:27], a[216:219], v[48:51], v[24:27]
    ds_read_b128 v[48:51], v3 offset:22528
    v_add_f32 v77, v77, v81
    v_mfma_f32_16x16x32_bf16 v[24:27], a[228:231], v[52:55], v[24:27]
    ds_read_b128 v[52:55], v3 offset:23552
    s_waitcnt lgkmcnt(2)
    v_mfma_f32_16x16x32_bf16 v[24:27], a[240:243], v[40:43], v[24:27]
    buffer_load_dwordx4 v1, s[8:11], s37 offen offset:3072 sc1 lds
    v_mfma_f32_16x16x32_bf16 v[24:27], a[252:255], v[44:47], v[24:27]
    s_add_u32 m0, s34, 8192
    v_mov_b32 v10, v92
    v_mov_b32 v11, v93
    v_mfma_f32_16x16x32_bf16 v[28:31], v[128:131], v[44:47], v[28:31]
    s_add_u32 s37, s33, 8192
    v_rcp_f32 v22, v22
    v_mfma_f32_16x16x32_bf16 v[28:31], a[244:247], v[40:43], v[28:31]
    v_mul_f32 v122, v122, v22
    v_mul_f32 v123, v123, v22
    v_mfma_f32_16x16x32_bf16 v[32:35], a[248:251], v[40:43], v[32:35]
    ds_read_b128 v[40:43], v3 offset:24576
    v_cvt_pk_bf16_f32 v23, v122, v123
    v_mfma_f32_16x16x32_bf16 v[32:35], v[132:135], v[44:47], v[32:35]
    ds_read_b128 v[44:47], v3 offset:25600
    s_waitcnt lgkmcnt(2)
    v_mfma_f32_16x16x32_bf16 v[32:35], v[144:147], v[48:51], v[32:35]
    buffer_store_dwordx4 v[8:11], v1, s[4:7], s40 offen sc1
    v_perm_b32 v114, v23, v23, v102
    v_mfma_f32_16x16x32_bf16 v[32:35], v[156:159], v[52:55], v[32:35]
    s_add_u32 s40, s40, 262144
    v_perm_b32 v115, v23, v23, v103
    v_perm_b32 v116, v23, v23, v104
    v_mfma_f32_16x16x32_bf16 v[28:31], v[152:155], v[52:55], v[28:31]
    s_add_u32 s41, s41, 262144
    v_perm_b32 v117, v23, v23, v105
    v_mov_b32 v100, v94
    v_mfma_f32_16x16x32_bf16 v[28:31], v[140:143], v[48:51], v[28:31]
    v_mov_b32 v101, v95
    v_cndmask_b32 v118, v110, v111, s[44:45]
    v_mfma_f32_16x16x32_bf16 v[24:27], v[136:139], v[48:51], v[24:27]
    ds_read_b128 v[48:51], v3 offset:26624
    v_cndmask_b32 v119, v112, v113, s[44:45]
    v_mfma_f32_16x16x32_bf16 v[72:75], v[98:101], v[114:117], 0
    buffer_load_dwordx4 v1, s[8:11], s37 offen offset:0 sc1 lds
    v_mfma_f32_16x16x32_bf16 v[24:27], v[148:151], v[52:55], v[24:27]
    ds_read_b128 v[52:55], v3 offset:27648
    s_waitcnt lgkmcnt(2)
    v_mfma_f32_16x16x32_bf16 v[24:27], v[160:163], v[40:43], v[24:27]
    v_add_f32 v78, v78, v82
    v_add_f32 v79, v79, v83
    v_mfma_f32_16x16x32_bf16 v[24:27], v[172:175], v[44:47], v[24:27]
    v_cvt_pk_bf16_f32 v114, v72, v73
    v_cvt_pk_bf16_f32 v115, v74, v75
    v_mfma_f32_16x16x32_bf16 v[28:31], v[176:179], v[44:47], v[28:31]
    v_cvt_pk_bf16_f32 v116, v72, v73
    v_cvt_pk_bf16_f32 v117, v74, v75
    v_mfma_f32_16x16x32_bf16 v[28:31], v[164:167], v[40:43], v[28:31]
    s_add_u32 s31, s31, 1
    v_permlane32_swap_b32 v114, v116
    v_mfma_f32_16x16x32_bf16 v[32:35], v[168:171], v[40:43], v[32:35]
    ds_read_b128 v[40:43], v3 offset:28672
    v_add_f32 v70, v76, v78
    v_mfma_f32_16x16x32_bf16 v[32:35], v[180:183], v[44:47], v[32:35]
    ds_read_b128 v[44:47], v3 offset:29696
    s_waitcnt lgkmcnt(2)
    v_mfma_f32_16x16x32_bf16 v[32:35], v[192:195], v[48:51], v[32:35]
    s_sub_u32 s54, s31, 2
    v_permlane32_swap_b32 v115, v117
    v_mfma_f32_16x16x32_bf16 v[32:35], v[204:207], v[52:55], v[32:35]
    buffer_store_dwordx4 v[114:117], v7, s[12:15], s36 offen sc1
    v_mov_b32 v6, s54
    v_mfma_f32_16x16x32_bf16 v[28:31], v[200:203], v[52:55], v[28:31]
    s_add_u32 s36, s36, 32768
    v_add_f32 v71, v77, v79
    v_add_u32 v2, s35, v1
    v_mfma_f32_16x16x32_bf16 v[28:31], v[188:191], v[48:51], v[28:31]
    s_cmp_ge_i32 s31, 30
    s_cselect_b32 s18, 0x1ffff, s18
    s_add_u32 s33, s33, 34816
    v_mfma_f32_16x16x32_bf16 v[24:27], v[184:187], v[48:51], v[24:27]
    ds_read_b128 v[48:51], v3 offset:30720
    s_add_u32 s34, s34, 36864
    v_mfma_f32_16x16x32_bf16 v[24:27], v[196:199], v[52:55], v[24:27]
    ds_read_b128 v[52:55], v3 offset:31744
    s_waitcnt lgkmcnt(2)
    v_mfma_f32_16x16x32_bf16 v[24:27], v[208:211], v[40:43], v[24:27]
    s_cmp_ge_u32 s34, 147456
    s_cselect_b32 s38, 147456, 0
    s_sub_u32 s34, s34, s38
    v_mfma_f32_16x16x32_bf16 v[24:27], v[220:223], v[44:47], v[24:27]
    s_waitcnt vmcnt(12)
    v_cmp_gt_i32 vcc, s32, v5
    v_mfma_f32_16x16x32_bf16 v[28:31], v[224:227], v[44:47], v[28:31]
    v_permlane16_swap_b32 v70, v71
    v_mfma_f32_16x16x32_bf16 v[28:31], v[212:215], v[40:43], v[28:31]
    s_and_b64 vcc, vcc, s[18:19]
    s_cbranch_scc1 Lqkv_slows13
Lqkv_backs13:
    v_mfma_f32_16x16x32_bf16 v[32:35], v[216:219], v[40:43], v[32:35]
    ds_read_b128 v[40:43], v2 offset:0
    v_add_f32 v70, v70, v71
    v_mfma_f32_16x16x32_bf16 v[32:35], v[228:231], v[44:47], v[32:35]
    ds_read_b128 v[44:47], v2 offset:1024
    s_waitcnt lgkmcnt(2)
    v_mfma_f32_16x16x32_bf16 v[32:35], v[240:243], v[48:51], v[32:35]
    s_add_u32 s16, s16, 8192
    v_mov_b32 v71, v70
    s_and_b32 s16, s16, 524287
    v_mfma_f32_16x16x32_bf16 v[32:35], v[252:255], v[52:55], v[32:35]
    buffer_load_dword v5, v4, s[4:7], s16 offen sc1
    v_mfma_f32_16x16x32_bf16 v[28:31], v[248:251], v[52:55], v[28:31]
    v_permlane32_swap_b32 v70, v71
    v_mfma_f32_16x16x32_bf16 v[28:31], v[236:239], v[48:51], v[28:31]
    v_add_f32 v70, v70, v71
    v_mul_f32 v70, 0x3a800000, v70
    v_mfma_f32_16x16x32_bf16 v[24:27], v[232:235], v[48:51], v[24:27]
    ds_read_b128 v[48:51], v2 offset:2048
    v_mov_b32 v71, v70
    v_mfma_f32_16x16x32_bf16 v[24:27], v[244:247], v[52:55], v[24:27]
    ds_read_b128 v[52:55], v2 offset:3072
    v_permlane16_swap_b32 v70, v71
    v_fma_f32 v71, -v70, v70, v71
    v_max_f32 v71, 0, v71
    v_add_f32 v71, 0x3727c5ac, v71
    v_rsq_f32 v71, v71
    s_nop 1
    s_branch Lqkv_g03
    .p2align 6
Lqkv_g13:
    s_waitcnt lgkmcnt(2)
    v_mfma_f32_16x16x32_bf16 v[24:27], a[0:3], v[40:43], 0
    s_add_u32 m0, s34, 0
    v_mul_f32 v124, s52, v71
    v_fma_f32 v16, -v68, v64, v16
    v_mfma_f32_16x16x32_bf16 v[24:27], a[12:15], v[44:47], v[24:27]
    s_add_u32 s35, s35, 36864
    v_fma_f32 v12, -v68, v60, v12
    v_fma_f32 v13, -v68, v61, v13
    v_mfma_f32_16x16x32_bf16 v[28:31], a[16:19], v[44:47], 0
    s_cmp_eq_u32 s35, 147456
    s_cselect_b32 s35, 0, s35
    v_fma_f32 v14, -v68, v62, v14
    v_mfma_f32_16x16x32_bf16 v[28:31], a[4:7], v[40:43], v[28:31]
    v_fma_f32 v15, -v68, v63, v15
    v_mul_f32 v12, v12, v69
    v_mfma_f32_16x16x32_bf16 v[32:35], a[8:11], v[40:43], 0
    ds_read_b128 v[40:43], v3 offset:4096
    v_mul_f32 v13, v13, v69
    v_mfma_f32_16x16x32_bf16 v[32:35], a[20:23], v[44:47], v[32:35]
    ds_read_b128 v[44:47], v3 offset:5120
    s_waitcnt lgkmcnt(2)
    v_mfma_f32_16x16x32_bf16 v[32:35], a[32:35], v[48:51], v[32:35]
    v_mul_f32 v14, v14, v69
    v_mul_f32 v15, v15, v69
    v_mfma_f32_16x16x32_bf16 v[32:35], a[44:47], v[52:55], v[32:35]
    v_cvt_pk_bf16_f32 v84, v12, v13
    v_cvt_pk_bf16_f32 v85, v14, v15
    v_mfma_f32_16x16x32_bf16 v[28:31], a[40:43], v[52:55], v[28:31]
    v_fma_f32 v17, -v68, v65, v17
    v_fma_f32 v18, -v68, v66, v18
    v_mfma_f32_16x16x32_bf16 v[106:109], v[84:87], v[88:91], 0
    v_fma_f32 v19, -v68, v67, v19
    v_mul_f32 v16, v16, v69
    v_mfma_f32_16x16x32_bf16 v[28:31], a[28:31], v[48:51], v[28:31]
    v_mul_f32 v17, v17, v69
    v_mul_f32 v18, v18, v69
    v_mfma_f32_16x16x32_bf16 v[24:27], a[24:27], v[48:51], v[24:27]
    ds_read_b128 v[48:51], v3 offset:6144
    v_mul_f32 v19, v19, v69
    v_mfma_f32_16x16x32_bf16 v[24:27], a[36:39], v[52:55], v[24:27]
    ds_read_b128 v[52:55], v3 offset:7168
    s_waitcnt lgkmcnt(2)
    v_mfma_f32_16x16x32_bf16 v[24:27], a[48:51], v[40:43], v[24:27]
    v_cndmask_b32 v106, v106, v107, s[44:45]
    v_cndmask_b32 v108, v108, v109, s[44:45]
    v_mfma_f32_16x16x32_bf16 v[24:27], a[60:63], v[44:47], v[24:27]
    v_cndmask_b32 v120, v106, v118, s[48:49]
    v_cndmask_b32 v121, v108, v119, s[50:51]
    v_mfma_f32_16x16x32_bf16 v[28:31], a[64:67], v[44:47], v[28:31]
    ds_write_b64 v36, v[120:121] offset:2048
    v_mfma_f32_16x16x32_bf16 v[28:31], a[52:55], v[40:43], v[28:31]
    v_cvt_pk_bf16_f32 v16, v16, v17
    v_cvt_pk_bf16_f32 v17, v18, v19
    v_mfma_f32_16x16x32_bf16 v[32:35], a[56:59], v[40:43], v[32:35]
    ds_read_b128 v[40:43], v3 offset:8192
    v_fma_f32 v8, -v68, v56, v8
    v_mfma_f32_16x16x32_bf16 v[32:35], a[68:71], v[44:47], v[32:35]
    ds_read_b128 v[44:47], v3 offset:9216
    s_waitcnt lgkmcnt(3)
    v_mfma_f32_16x16x32_bf16 v[32:35], a[80:83], v[48:51], v[32:35]
    s_waitcnt vmcnt(3) lgkmcnt(2)
    ds_write_b64 v38, v[16:17]
    v_mfma_f32_16x16x32_bf16 v[32:35], a[92:95], v[52:55], v[32:35]
    ds_read_b64_tr_b16 v[92:93], v39
    v_fma_f32 v9, -v68, v57, v9
    v_mfma_f32_16x16x32_bf16 v[28:31], a[88:91], v[52:55], v[28:31]
    buffer_load_dwordx4 v1, s[8:11], s33 offen offset:0 sc1 lds
    v_mfma_f32_16x16x32_bf16 v[28:31], a[76:79], v[48:51], v[28:31]
    s_barrier
    v_mfma_f32_16x16x32_bf16 v[24:27], a[72:75], v[48:51], v[24:27]
    ds_read_b128 v[48:51], v3 offset:10240
    v_fma_f32 v10, -v68, v58, v10
    v_mfma_f32_16x16x32_bf16 v[24:27], a[84:87], v[52:55], v[24:27]
    ds_read_b128 v[52:55], v3 offset:11264
    s_waitcnt lgkmcnt(4)
    v_mfma_f32_16x16x32_bf16 v[24:27], a[96:99], v[40:43], v[24:27]
    s_waitcnt vmcnt(3)
    buffer_store_dword v6, v21, s[12:15], s17 offen sc1
    v_mfma_f32_16x16x32_bf16 v[24:27], a[108:111], v[44:47], v[24:27]
    ds_read_b64 v[122:123], v37 offset:2048
    v_fma_f32 v11, -v68, v59, v11
    v_mfma_f32_16x16x32_bf16 v[28:31], a[112:115], v[44:47], v[28:31]
    s_cmp_ge_i32 s54, 0
    s_cselect_b32 s14, s6, 0
    v_cvt_pk_bf16_f32 v88, v8, v9
    v_mfma_f32_16x16x32_bf16 v[28:31], a[100:103], v[40:43], v[28:31]
    s_add_u32 s17, s17, 8192
    v_sub_u32 v76, v3, v20
    v_cvt_pk_bf16_f32 v89, v10, v11
    v_mfma_f32_16x16x32_bf16 v[32:35], a[104:107], v[40:43], v[32:35]
    ds_read_b128 v[40:43], v3 offset:12288
    v_add_u32 v2, s35, v1
    v_mfma_f32_16x16x32_bf16 v[110:113], v[84:87], v[88:91], 0
    buffer_load_dwordx4 v1, s[8:11], s33 offen offset:1024 sc1 lds
    v_mfma_f32_16x16x32_bf16 v[32:35], a[116:119], v[44:47], v[32:35]
    ds_read_b128 v[44:47], v3 offset:13312
    s_waitcnt lgkmcnt(2)
    v_mfma_f32_16x16x32_bf16 v[32:35], a[128:131], v[48:51], v[32:35]
    ds_read2st64_b64 v[80:83], v76 offset0:66 offset1:67
    v_add_f32 v122, v122, v120
    v_mfma_f32_16x16x32_bf16 v[32:35], a[140:143], v[52:55], v[32:35]
    ds_read2st64_b64 v[76:79], v76 offset0:64 offset1:65
    v_add_f32 v123, v123, v121
    v_mfma_f32_16x16x32_bf16 v[28:31], a[136:139], v[52:55], v[28:31]
    v_max_f32 v22, v122, v123
    v_mov_b32 v23, v22
    v_mfma_f32_16x16x32_bf16 v[28:31], a[124:127], v[48:51], v[28:31]
    buffer_load_dwordx4 v1, s[8:11], s33 offen offset:2048 sc1 lds
    v_mfma_f32_16x16x32_bf16 v[24:27], a[120:123], v[48:51], v[24:27]
    ds_read_b128 v[48:51], v3 offset:14336
    v_cndmask_b32 v118, v110, v111, s[44:45]
    v_mfma_f32_16x16x32_bf16 v[24:27], a[132:135], v[52:55], v[24:27]
    ds_read_b128 v[52:55], v3 offset:15360
    s_waitcnt lgkmcnt(4)
    v_mfma_f32_16x16x32_bf16 v[24:27], a[144:147], v[40:43], v[24:27]
    v_permlane16_swap_b32 v22, v23
    v_mfma_f32_16x16x32_bf16 v[24:27], a[156:159], v[44:47], v[24:27]
    v_max_f32 v22, v22, v23
    v_mov_b32 v23, v22
    v_mfma_f32_16x16x32_bf16 v[28:31], a[160:163], v[44:47], v[28:31]
    buffer_load_dwordx4 v1, s[8:11], s33 offen offset:3072 sc1 lds
    v_mfma_f32_16x16x32_bf16 v[28:31], a[148:151], v[40:43], v[28:31]
    s_add_u32 m0, s34, 4096
    v_permlane32_swap_b32 v22, v23
    v_mfma_f32_16x16x32_bf16 v[32:35], a[152:155], v[40:43], v[32:35]
    ds_read_b128 v[40:43], v3 offset:16384
    v_max_f32 v22, v22, v23
    v_mfma_f32_16x16x32_bf16 v[32:35], a[164:167], v[44:47], v[32:35]
    ds_read_b128 v[44:47], v3 offset:17408
    s_waitcnt lgkmcnt(2)
    v_mfma_f32_16x16x32_bf16 v[32:35], a[176:179], v[48:51], v[32:35]
    s_add_u32 s37, s33, 4096
    v_mul_f32 v22, v124, v22
    v_fma_f32 v122, v122, v124, -v22
    v_mfma_f32_16x16x32_bf16 v[32:35], a[188:191], v[52:55], v[32:35]
    buffer_load_dwordx4 v1, s[8:11], s37 offen offset:0 sc1 lds
    v_mfma_f32_16x16x32_bf16 v[28:31], a[184:187], v[52:55], v[28:31]
    v_fma_f32 v123, v123, v124, -v22
    v_cndmask_b32 v119, v112, v113, s[44:45]
    v_mfma_f32_16x16x32_bf16 v[28:31], a[172:175], v[48:51], v[28:31]
    v_exp_f32 v122, v122
    v_mfma_f32_16x16x32_bf16 v[24:27], a[168:171], v[48:51], v[24:27]
    ds_read_b128 v[48:51], v3 offset:18432
    v_add_f32 v76, v76, v80
    v_mfma_f32_16x16x32_bf16 v[24:27], a[180:183], v[52:55], v[24:27]
    ds_read_b128 v[52:55], v3 offset:19456
    s_waitcnt lgkmcnt(2)
    v_mfma_f32_16x16x32_bf16 v[24:27], a[192:195], v[40:43], v[24:27]
    buffer_load_dwordx4 v1, s[8:11], s37 offen offset:1024 sc1 lds
    v_mfma_f32_16x16x32_bf16 v[24:27], a[204:207], v[44:47], v[24:27]
    v_exp_f32 v123, v123
    v_mfma_f32_16x16x32_bf16 v[28:31], a[208:211], v[44:47], v[28:31]
    v_add_f32 v22, v122, v123
    v_mov_b32 v23, v22
    v_mfma_f32_16x16x32_bf16 v[28:31], a[196:199], v[40:43], v[28:31]
    s_nop 0
    v_permlane16_swap_b32 v22, v23
    v_mfma_f32_16x16x32_bf16 v[32:35], a[200:203], v[40:43], v[32:35]
    ds_read_b128 v[40:43], v3 offset:20480
    v_add_f32 v22, v22, v23
    v_mfma_f32_16x16x32_bf16 v[32:35], a[212:215], v[44:47], v[32:35]
    ds_read_b128 v[44:47], v3 offset:21504
    s_waitcnt lgkmcnt(2)
    v_mfma_f32_16x16x32_bf16 v[32:35], a[224:227], v[48:51], v[32:35]
    buffer_load_dwordx4 v1, s[8:11], s37 offen offset:2048 sc1 lds
    v_mfma_f32_16x16x32_bf16 v[32:35], a[236:239], v[52:55], v[32:35]
    v_mov_b32 v23, v22
    v_add_f32 v77, v77, v81
    v_mfma_f32_16x16x32_bf16 v[28:31], a[232:235], v[52:55], v[28:31]
    v_permlane32_swap_b32 v22, v23
    v_mfma_f32_16x16x32_bf16 v[28:31], a[220:223], v[48:51], v[28:31]
    v_add_f32 v22, v22, v23
    v_add_f32 v78, v78, v82
    v_mfma_f32_16x16x32_bf16 v[24:27], a[216:219], v[48:51], v[24:27]
    ds_read_b128 v[48:51], v3 offset:22528
    v_add_f32 v79, v79, v83
    v_mfma_f32_16x16x32_bf16 v[24:27], a[228:231], v[52:55], v[24:27]
    ds_read_b128 v[52:55], v3 offset:23552
    s_waitcnt lgkmcnt(2)
    v_mfma_f32_16x16x32_bf16 v[24:27], a[240:243], v[40:43], v[24:27]
    buffer_load_dwordx4 v1, s[8:11], s37 offen offset:3072 sc1 lds
    v_mfma_f32_16x16x32_bf16 v[24:27], a[252:255], v[44:47], v[24:27]
    s_add_u32 m0, s34, 8192
    v_rcp_f32 v22, v22
    v_mfma_f32_16x16x32_bf16 v[28:31], v[128:131], v[44:47], v[28:31]
    s_add_u32 s37, s33, 8192
    v_mul_f32 v122, v122, v22
    v_mul_f32 v123, v123, v22
    v_mfma_f32_16x16x32_bf16 v[28:31], a[244:247], v[40:43], v[28:31]
    v_cvt_pk_bf16_f32 v23, v122, v123
    v_perm_b32 v114, v23, v23, v102
    v_mfma_f32_16x16x32_bf16 v[32:35], a[248:251], v[40:43], v[32:35]
    ds_read_b128 v[40:43], v3 offset:24576
    v_perm_b32 v115, v23, v23, v103
    v_mfma_f32_16x16x32_bf16 v[32:35], v[132:135], v[44:47], v[32:35]
    ds_read_b128 v[44:47], v3 offset:25600
    s_waitcnt lgkmcnt(2)
    v_mfma_f32_16x16x32_bf16 v[32:35], v[144:147], v[48:51], v[32:35]
    buffer_load_dwordx4 v1, s[8:11], s37 offen offset:0 sc1 lds
    v_mfma_f32_16x16x32_bf16 v[32:35], v[156:159], v[52:55], v[32:35]
    v_perm_b32 v116, v23, v23, v104
    v_perm_b32 v117, v23, v23, v105
    v_mfma_f32_16x16x32_bf16 v[28:31], v[152:155], v[52:55], v[28:31]
    v_add_f32 v70, v76, v78
    v_add_f32 v71, v77, v79
    v_mfma_f32_16x16x32_bf16 v[72:75], v[92:95], v[114:117], 0
    s_nop 0
    v_permlane16_swap_b32 v70, v71
    v_mfma_f32_16x16x32_bf16 v[28:31], v[140:143], v[48:51], v[28:31]
    v_add_f32 v70, v70, v71
    v_mov_b32 v71, v70
    v_mfma_f32_16x16x32_bf16 v[24:27], v[136:139], v[48:51], v[24:27]
    ds_read_b128 v[48:51], v3 offset:26624
    v_mfma_f32_16x16x32_bf16 v[24:27], v[148:151], v[52:55], v[24:27]
    ds_read_b128 v[52:55], v3 offset:27648
    s_waitcnt lgkmcnt(2)
    v_mfma_f32_16x16x32_bf16 v[24:27], v[160:163], v[40:43], v[24:27]
    v_cvt_pk_bf16_f32 v114, v72, v73
    v_cvt_pk_bf16_f32 v115, v74, v75
    v_mfma_f32_16x16x32_bf16 v[24:27], v[172:175], v[44:47], v[24:27]
    v_cvt_pk_bf16_f32 v116, v72, v73
    v_cvt_pk_bf16_f32 v117, v74, v75
    v_mfma_f32_16x16x32_bf16 v[28:31], v[176:179], v[44:47], v[28:31]
    v_permlane32_swap_b32 v114, v116
    v_mfma_f32_16x16x32_bf16 v[28:31], v[164:167], v[40:43], v[28:31]
    s_add_u32 s31, s31, 1
    v_permlane32_swap_b32 v115, v117
    v_mfma_f32_16x16x32_bf16 v[32:35], v[168:171], v[40:43], v[32:35]
    ds_read_b128 v[40:43], v3 offset:28672
    s_sub_u32 s54, s31, 2
    v_mfma_f32_16x16x32_bf16 v[32:35], v[180:183], v[44:47], v[32:35]
    ds_read_b128 v[44:47], v3 offset:29696
    s_waitcnt lgkmcnt(2)
    v_mfma_f32_16x16x32_bf16 v[32:35], v[192:195], v[48:51], v[32:35]
    buffer_store_dwordx4 v[114:117], v7, s[12:15], s36 offen sc1
    v_mov_b32 v6, s54
    v_mfma_f32_16x16x32_bf16 v[32:35], v[204:207], v[52:55], v[32:35]
    s_add_u32 s36, s36, 32768
    v_permlane32_swap_b32 v70, v71
    v_mfma_f32_16x16x32_bf16 v[28:31], v[200:203], v[52:55], v[28:31]
    s_cmp_ge_i32 s31, 30
    s_cselect_b32 s18, 0x1ffff, s18
    v_add_f32 v70, v70, v71
    v_mfma_f32_16x16x32_bf16 v[28:31], v[188:191], v[48:51], v[28:31]
    s_add_u32 s33, s33, 34816
    v_mul_f32 v70, 0x3a800000, v70
    v_mov_b32 v71, v70
    v_mfma_f32_16x16x32_bf16 v[24:27], v[184:187], v[48:51], v[24:27]
    ds_read_b128 v[48:51], v3 offset:30720
    s_add_u32 s34, s34, 36864
    v_mfma_f32_16x16x32_bf16 v[24:27], v[196:199], v[52:55], v[24:27]
    ds_read_b128 v[52:55], v3 offset:31744
    s_waitcnt lgkmcnt(2)
    v_mfma_f32_16x16x32_bf16 v[24:27], v[208:211], v[40:43], v[24:27]
    s_cmp_ge_u32 s34, 147456
    s_cselect_b32 s38, 147456, 0
    s_sub_u32 s34, s34, s38
    v_mfma_f32_16x16x32_bf16 v[24:27], v[220:223], v[44:47], v[24:27]
    s_waitcnt vmcnt(11)
    v_cmp_gt_i32 vcc, s32, v5
    v_mfma_f32_16x16x32_bf16 v[28:31], v[224:227], v[44:47], v[28:31]
    v_permlane16_swap_b32 v70, v71
    v_mfma_f32_16x16x32_bf16 v[28:31], v[212:215], v[40:43], v[28:31]
    s_and_b64 vcc, vcc, s[18:19]
    s_cbranch_scc1 Lqkv_slowg13
Lqkv_backg13:
    v_mfma_f32_16x16x32_bf16 v[32:35], v[216:219], v[40:43], v[32:35]
    ds_read_b128 v[40:43], v2 offset:0
    v_fma_f32 v71, -v70, v70, v71
    v_mfma_f32_16x16x32_bf16 v[32:35], v[228:231], v[44:47], v[32:35]
    ds_read_b128 v[44:47], v2 offset:1024
    s_waitcnt lgkmcnt(2)
    v_mfma_f32_16x16x32_bf16 v[32:35], v[240:243], v[48:51], v[32:35]
    s_add_u32 s16, s16, 8192
    v_max_f32 v71, 0, v71
    v_add_f32 v71, 0x3727c5ac, v71
    v_mfma_f32_16x16x32_bf16 v[32:35], v[252:255], v[52:55], v[32:35]
    s_and_b32 s16, s16, 524287
    v_rsq_f32 v71, v71
    v_mfma_f32_16x16x32_bf16 v[28:31], v[248:251], v[52:55], v[28:31]
    buffer_load_dword v5, v4, s[4:7], s16 offen sc1
    v_mfma_f32_16x16x32_bf16 v[28:31], v[236:239], v[48:51], v[28:31]
    v_mfma_f32_16x16x32_bf16 v[24:27], v[232:235], v[48:51], v[24:27]
    ds_read_b128 v[48:51], v2 offset:2048
    v_mfma_f32_16x16x32_bf16 v[24:27], v[244:247], v[52:55], v[24:27]
    ds_read_b128 v[52:55], v2 offset:3072
    s_cmp_eq_u32 s31, 64
    s_cbranch_scc1 Lqkv_tail
Lqkv_g03:
    s_waitcnt lgkmcnt(2)
    v_mfma_f32_16x16x32_bf16 v[8:11], a[0:3], v[40:43], 0
    s_add_u32 m0, s34, 0
    v_mul_f32 v124, s52, v69
    v_fma_f32 v32, -v70, v64, v32
    v_mfma_f32_16x16x32_bf16 v[8:11], a[12:15], v[44:47], v[8:11]
    s_add_u32 s35, s35, 36864
    v_fma_f32 v28, -v70, v60, v28
    v_fma_f32 v29, -v70, v61, v29
    v_mfma_f32_16x16x32_bf16 v[12:15], a[16:19], v[44:47], 0
    s_cmp_eq_u32 s35, 147456
    s_cselect_b32 s35, 0, s35
    v_fma_f32 v30, -v70, v62, v30
    v_mfma_f32_16x16x32_bf16 v[12:15], a[4:7], v[40:43], v[12:15]
    v_fma_f32 v31, -v70, v63, v31
    v_mul_f32 v28, v28, v71
    v_mfma_f32_16x16x32_bf16 v[16:19], a[8:11], v[40:43], 0
    ds_read_b128 v[40:43], v2 offset:4096
    v_mul_f32 v29, v29, v71
    v_mfma_f32_16x16x32_bf16 v[16:19], a[20:23], v[44:47], v[16:19]
    ds_read_b128 v[44:47], v2 offset:5120
    s_waitcnt lgkmcnt(2)
    v_mfma_f32_16x16x32_bf16 v[16:19], a[32:35], v[48:51], v[16:19]
    v_mul_f32 v30, v30, v71
    v_mul_f32 v31, v31, v71
    v_mfma_f32_16x16x32_bf16 v[16:19], a[44:47], v[52:55], v[16:19]
    v_cvt_pk_bf16_f32 v84, v28, v29
    v_cvt_pk_bf16_f32 v85, v30, v31
    v_mfma_f32_16x16x32_bf16 v[12:15], a[40:43], v[52:55], v[12:15]
    v_fma_f32 v33, -v70, v65, v33
    v_fma_f32 v34, -v70, v66, v34
    v_mfma_f32_16x16x32_bf16 v[106:109], v[84:87], v[88:91], 0
    v_fma_f32 v35, -v70, v67, v35
    v_mul_f32 v32, v32, v71
    v_mfma_f32_16x16x32_bf16 v[12:15], a[28:31], v[48:51], v[12:15]
    v_mul_f32 v33, v33, v71
    v_mul_f32 v34, v34, v71
    v_mfma_f32_16x16x32_bf16 v[8:11], a[24:27], v[48:51], v[8:11]
    ds_read_b128 v[48:51], v2 offset:6144
    v_mul_f32 v35, v35, v71
    v_mfma_f32_16x16x32_bf16 v[8:11], a[36:39], v[52:55], v[8:11]
    ds_read_b128 v[52:55], v2 offset:7168
    s_waitcnt lgkmcnt(2)
    v_mfma_f32_16x16x32_bf16 v[8:11], a[48:51], v[40:43], v[8:11]
    v_cndmask_b32 v106, v106, v107, s[44:45]
    v_cndmask_b32 v108, v108, v109, s[44:45]
    v_mfma_f32_16x16x32_bf16 v[8:11], a[60:63], v[44:47], v[8:11]
    v_cndmask_b32 v120, v106, v118, s[48:49]
    v_cndmask_b32 v121, v108, v119, s[50:51]
    v_mfma_f32_16x16x32_bf16 v[12:15], a[64:67], v[44:47], v[12:15]
    ds_write_b64 v36, v[120:121] offset:0
    v_mfma_f32_16x16x32_bf16 v[12:15], a[52:55], v[40:43], v[12:15]
    v_cvt_pk_bf16_f32 v32, v32, v33
    v_cvt_pk_bf16_f32 v33, v34, v35
    v_mfma_f32_16x16x32_bf16 v[16:19], a[56:59], v[40:43], v[16:19]
    ds_read_b128 v[40:43], v2 offset:8192
    v_fma_f32 v24, -v70, v56, v24
    v_mfma_f32_16x16x32_bf16 v[16:19], a[68:71], v[44:47], v[16:19]
    ds_read_b128 v[44:47], v2 offset:9216
    s_waitcnt lgkmcnt(3)
    v_mfma_f32_16x16x32_bf16 v[16:19], a[80:83], v[48:51], v[16:19]
    s_waitcnt vmcnt(2) lgkmcnt(2)
    ds_write_b64 v38, v[32:33]
    v_mfma_f32_16x16x32_bf16 v[16:19], a[92:95], v[52:55], v[16:19]
    ds_read_b64_tr_b16 v[94:95], v39
    v_fma_f32 v25, -v70, v57, v25
    v_mfma_f32_16x16x32_bf16 v[12:15], a[88:91], v[52:55], v[12:15]
    buffer_load_dwordx4 v1, s[8:11], s33 offen offset:0 sc1 lds
    v_mfma_f32_16x16x32_bf16 v[12:15], a[76:79], v[48:51], v[12:15]
    s_barrier
    v_mfma_f32_16x16x32_bf16 v[8:11], a[72:75], v[48:51], v[8:11]
    ds_read_b128 v[48:51], v2 offset:10240
    v_fma_f32 v26, -v70, v58, v26
    v_mfma_f32_16x16x32_bf16 v[8:11], a[84:87], v[52:55], v[8:11]
    ds_read_b128 v[52:55], v2 offset:11264
    s_waitcnt lgkmcnt(4)
    v_mfma_f32_16x16x32_bf16 v[8:11], a[96:99], v[40:43], v[8:11]
    s_waitcnt vmcnt(2)
    buffer_store_dword v6, v21, s[12:15], s17 offen sc1
    v_mfma_f32_16x16x32_bf16 v[8:11], a[108:111], v[44:47], v[8:11]
    ds_read_b64 v[122:123], v37 offset:0
    v_fma_f32 v27, -v70, v59, v27
    v_mfma_f32_16x16x32_bf16 v[12:15], a[112:115], v[44:47], v[12:15]
    s_cmp_ge_i32 s54, 0
    s_cselect_b32 s14, s6, 0
    v_cvt_pk_bf16_f32 v88, v24, v25
    v_mfma_f32_16x16x32_bf16 v[12:15], a[100:103], v[40:43], v[12:15]
    s_add_u32 s17, s17, 8192
    v_sub_u32 v76, v2, v20
    v_cvt_pk_bf16_f32 v89, v26, v27
    v_mfma_f32_16x16x32_bf16 v[16:19], a[104:107], v[40:43], v[16:19]
    ds_read_b128 v[40:43], v2 offset:12288
    v_add_u32 v3, s35, v1
    v_mfma_f32_16x16x32_bf16 v[110:113], v[84:87], v[88:91], 0
    buffer_load_dwordx4 v1, s[8:11], s33 offen offset:1024 sc1 lds
    v_mfma_f32_16x16x32_bf16 v[16:19], a[116:119], v[44:47], v[16:19]
    ds_read_b128 v[44:47], v2 offset:13312
    s_waitcnt lgkmcnt(2)
    v_mfma_f32_16x16x32_bf16 v[16:19], a[128:131], v[48:51], v[16:19]
    ds_read2st64_b64 v[80:83], v76 offset0:66 offset1:67
    v_add_f32 v122, v122, v120
    v_mfma_f32_16x16x32_bf16 v[16:19], a[140:143], v[52:55], v[16:19]
    ds_read2st64_b64 v[76:79], v76 offset0:64 offset1:65
    v_add_f32 v123, v123, v121
    v_mfma_f32_16x16x32_bf16 v[12:15], a[136:139], v[52:55], v[12:15]
    v_max_f32 v22, v122, v123
    v_mov_b32 v23, v22
    v_mfma_f32_16x16x32_bf16 v[12:15], a[124:127], v[48:51], v[12:15]
    buffer_load_dwordx4 v1, s[8:11], s33 offen offset:2048 sc1 lds
    v_mfma_f32_16x16x32_bf16 v[8:11], a[120:123], v[48:51], v[8:11]
    ds_read_b128 v[48:51], v2 offset:14336
    v_cndmask_b32 v118, v110, v111, s[44:45]
    v_mfma_f32_16x16x32_bf16 v[8:11], a[132:135], v[52:55], v[8:11]
    ds_read_b128 v[52:55], v2 offset:15360
    s_waitcnt lgkmcnt(4)
    v_mfma_f32_16x16x32_bf16 v[8:11], a[144:147], v[40:43], v[8:11]
    v_permlane16_swap_b32 v22, v23
    v_mfma_f32_16x16x32_bf16 v[8:11], a[156:159], v[44:47], v[8:11]
    v_max_f32 v22, v22, v23
    v_mov_b32 v23, v22
    v_mfma_f32_16x16x32_bf16 v[12:15], a[160:163], v[44:47], v[12:15]
    buffer_load_dwordx4 v1, s[8:11], s33 offen offset:3072 sc1 lds
    v_mfma_f32_16x16x32_bf16 v[12:15], a[148:151], v[40:43], v[12:15]
    s_add_u32 m0, s34, 4096
    v_permlane32_swap_b32 v22, v23
    v_mfma_f32_16x16x32_bf16 v[16:19], a[152:155], v[40:43], v[16:19]
    ds_read_b128 v[40:43], v2 offset:16384
    v_max_f32 v22, v22, v23
    v_mfma_f32_16x16x32_bf16 v[16:19], a[164:167], v[44:47], v[16:19]
    ds_read_b128 v[44:47], v2 offset:17408
    s_waitcnt lgkmcnt(2)
    v_mfma_f32_16x16x32_bf16 v[16:19], a[176:179], v[48:51], v[16:19]
    s_add_u32 s37, s33, 4096
    v_mul_f32 v22, v124, v22
    v_fma_f32 v122, v122, v124, -v22
    v_mfma_f32_16x16x32_bf16 v[16:19], a[188:191], v[52:55], v[16:19]
    buffer_load_dwordx4 v1, s[8:11], s37 offen offset:0 sc1 lds
    v_mfma_f32_16x16x32_bf16 v[12:15], a[184:187], v[52:55], v[12:15]
    v_fma_f32 v123, v123, v124, -v22
    v_cndmask_b32 v119, v112, v113, s[44:45]
    v_mfma_f32_16x16x32_bf16 v[12:15], a[172:175], v[48:51], v[12:15]
    v_exp_f32 v122, v122
    v_mfma_f32_16x16x32_bf16 v[8:11], a[168:171], v[48:51], v[8:11]
    ds_read_b128 v[48:51], v2 offset:18432
    v_add_f32 v76, v76, v80
    v_mfma_f32_16x16x32_bf16 v[8:11], a[180:183], v[52:55], v[8:11]
    ds_read_b128 v[52:55], v2 offset:19456
    s_waitcnt lgkmcnt(2)
    v_mfma_f32_16x16x32_bf16 v[8:11], a[192:195], v[40:43], v[8:11]
    buffer_load_dwordx4 v1, s[8:11], s37 offen offset:1024 sc1 lds
    v_mfma_f32_16x16x32_bf16 v[8:11], a[204:207], v[44:47], v[8:11]
    v_exp_f32 v123, v123
    v_mfma_f32_16x16x32_bf16 v[12:15], a[208:211], v[44:47], v[12:15]
    v_add_f32 v22, v122, v123
    v_mov_b32 v23, v22
    v_mfma_f32_16x16x32_bf16 v[12:15], a[196:199], v[40:43], v[12:15]
    s_nop 0
    v_permlane16_swap_b32 v22, v23
    v_mfma_f32_16x16x32_bf16 v[16:19], a[200:203], v[40:43], v[16:19]
    ds_read_b128 v[40:43], v2 offset:20480
    v_add_f32 v22, v22, v23
    v_mfma_f32_16x16x32_bf16 v[16:19], a[212:215], v[44:47], v[16:19]
    ds_read_b128 v[44:47], v2 offset:21504
    s_waitcnt lgkmcnt(2)
    v_mfma_f32_16x16x32_bf16 v[16:19], a[224:227], v[48:51], v[16:19]
    buffer_load_dwordx4 v1, s[8:11], s37 offen offset:2048 sc1 lds
    v_mfma_f32_16x16x32_bf16 v[16:19], a[236:239], v[52:55], v[16:19]
    v_mov_b32 v23, v22
    v_add_f32 v77, v77, v81
    v_mfma_f32_16x16x32_bf16 v[12:15], a[232:235], v[52:55], v[12:15]
    v_permlane32_swap_b32 v22, v23
    v_mfma_f32_16x16x32_bf16 v[12:15], a[220:223], v[48:51], v[12:15]
    v_add_f32 v22, v22, v23
    v_add_f32 v78, v78, v82
    v_mfma_f32_16x16x32_bf16 v[8:11], a[216:219], v[48:51], v[8:11]
    ds_read_b128 v[48:51], v2 offset:22528
    v_add_f32 v79, v79, v83
    v_mfma_f32_16x16x32_bf16 v[8:11], a[228:231], v[52:55], v[8:11]
    ds_read_b128 v[52:55], v2 offset:23552
    s_waitcnt lgkmcnt(2)
    v_mfma_f32_16x16x32_bf16 v[8:11], a[240:243], v[40:43], v[8:11]
    buffer_load_dwordx4 v1, s[8:11], s37 offen offset:3072 sc1 lds
    v_mfma_f32_16x16x32_bf16 v[8:11], a[252:255], v[44:47], v[8:11]
    s_add_u32 m0, s34, 8192
    v_rcp_f32 v22, v22
    v_mfma_f32_16x16x32_bf16 v[12:15], v[128:131], v[44:47], v[12:15]
    s_add_u32 s37, s33, 8192
    v_mul_f32 v122, v122, v22
    v_mul_f32 v123, v123, v22
    v_mfma_f32_16x16x32_bf16 v[12:15], a[244:247], v[40:43], v[12:15]
    v_cvt_pk_bf16_f32 v23, v122, v123
    v_perm_b32 v116, v23, v23, v102
    v_mfma_f32_16x16x32_bf16 v[16:19], a[248:251], v[40:43], v[16:19]
    ds_read_b128 v[40:43], v2 offset:24576
    v_perm_b32 v117, v23, v23, v103
    v_mfma_f32_16x16x32_bf16 v[16:19], v[132:135], v[44:47], v[16:19]
    ds_read_b128 v[44:47], v2 offset:25600
    s_waitcnt lgkmcnt(2)
    v_mfma_f32_16x16x32_bf16 v[16:19], v[144:147], v[48:51], v[16:19]
    buffer_load_dwordx4 v1, s[8:11], s37 offen offset:0 sc1 lds
    v_mfma_f32_16x16x32_bf16 v[16:19], v[156:159], v[52:55], v[16:19]
    v_perm_b32 v114, v23, v23, v104
    v_perm_b32 v115, v23, v23, v105
    v_mfma_f32_16x16x32_bf16 v[12:15], v[152:155], v[52:55], v[12:15]
    v_add_f32 v68, v76, v78
    v_add_f32 v69, v77, v79
    v_mfma_f32_16x16x32_bf16 v[72:75], v[92:95], v[114:117], 0
    s_nop 0
    v_permlane16_swap_b32 v68, v69
    v_mfma_f32_16x16x32_bf16 v[12:15], v[140:143], v[48:51], v[12:15]
    v_add_f32 v68, v68, v69
    v_mov_b32 v69, v68
    v_mfma_f32_16x16x32_bf16 v[8:11], v[136:139], v[48:51], v[8:11]
    ds_read_b128 v[48:51], v2 offset:26624
    v_mfma_f32_16x16x32_bf16 v[8:11], v[148:151], v[52:55], v[8:11]
    ds_read_b128 v[52:55], v2 offset:27648
    s_waitcnt lgkmcnt(2)
    v_mfma_f32_16x16x32_bf16 v[8:11], v[160:163], v[40:43], v[8:11]
    v_cvt_pk_bf16_f32 v114, v72, v73
    v_cvt_pk_bf16_f32 v115, v74, v75
    v_mfma_f32_16x16x32_bf16 v[8:11], v[172:175], v[44:47], v[8:11]
    v_cvt_pk_bf16_f32 v116, v72, v73
    v_cvt_pk_bf16_f32 v117, v74, v75
    v_mfma_f32_16x16x32_bf16 v[12:15], v[176:179], v[44:47], v[12:15]
    v_permlane32_swap_b32 v114, v116
    v_mfma_f32_16x16x32_bf16 v[12:15], v[164:167], v[40:43], v[12:15]
    s_add_u32 s31, s31, 1
    v_permlane32_swap_b32 v115, v117
    v_mfma_f32_16x16x32_bf16 v[16:19], v[168:171], v[40:43], v[16:19]
    ds_read_b128 v[40:43], v2 offset:28672
    s_sub_u32 s54, s31, 2
    v_mfma_f32_16x16x32_bf16 v[16:19], v[180:183], v[44:47], v[16:19]
    ds_read_b128 v[44:47], v2 offset:29696
    s_waitcnt lgkmcnt(2)
    v_mfma_f32_16x16x32_bf16 v[16:19], v[192:195], v[48:51], v[16:19]
    buffer_store_dwordx4 v[114:117], v7, s[12:15], s36 offen sc1
    v_mov_b32 v6, s54
    v_mfma_f32_16x16x32_bf16 v[16:19], v[204:207], v[52:55], v[16:19]
    s_add_u32 s36, s36, 32768
    v_permlane32_swap_b32 v68, v69
    v_mfma_f32_16x16x32_bf16 v[12:15], v[200:203], v[52:55], v[12:15]
    s_cmp_ge_i32 s31, 30
    s_cselect_b32 s18, 0x1ffff, s18
    v_add_f32 v68, v68, v69
    v_mfma_f32_16x16x32_bf16 v[12:15], v[188:191], v[48:51], v[12:15]
    s_add_u32 s33, s33, 34816
    v_mul_f32 v68, 0x3a800000, v68
    v_mov_b32 v69, v68
    v_mfma_f32_16x16x32_bf16 v[8:11], v[184:187], v[48:51], v[8:11]
    ds_read_b128 v[48:51], v2 offset:30720
    s_add_u32 s34, s34, 36864
    v_mfma_f32_16x16x32_bf16 v[8:11], v[196:199], v[52:55], v[8:11]
    ds_read_b128 v[52:55], v2 offset:31744
    s_waitcnt lgkmcnt(2)
    v_mfma_f32_16x16x32_bf16 v[8:11], v[208:211], v[40:43], v[8:11]
    s_cmp_ge_u32 s34, 147456
    s_cselect_b32 s38, 147456, 0
    s_sub_u32 s34, s34, s38
    v_mfma_f32_16x16x32_bf16 v[8:11], v[220:223], v[44:47], v[8:11]
    buffer_load_dwordx4 v[96:99], v1, s[24:27], s41 offen sc1
    v_mfma_f32_16x16x32_bf16 v[12:15], v[224:227], v[44:47], v[12:15]
    s_waitcnt vmcnt(12)
    v_cmp_gt_i32 vcc, s32, v5
    v_mfma_f32_16x16x32_bf16 v[12:15], v[212:215], v[40:43], v[12:15]
    v_permlane16_swap_b32 v68, v69
    v_mfma_f32_16x16x32_bf16 v[16:19], v[216:219], v[40:43], v[16:19]
    ds_read_b128 v[40:43], v3 offset:0
    v_fma_f32 v69, -v68, v68, v69
    v_mfma_f32_16x16x32_bf16 v[16:19], v[228:231], v[44:47], v[16:19]
    ds_read_b128 v[44:47], v3 offset:1024
    s_waitcnt lgkmcnt(2)
    v_mfma_f32_16x16x32_bf16 v[16:19], v[240:243], v[48:51], v[16:19]
    s_and_b64 vcc, vcc, s[18:19]
    s_cbranch_scc1 Lqkv_slowg03
Lqkv_backg03:
    v_mfma_f32_16x16x32_bf16 v[16:19], v[252:255], v[52:55], v[16:19]
    s_add_u32 s16, s16, 8192
    v_max_f32 v69, 0, v69
    v_add_f32 v69, 0x3727c5ac, v69
    v_mfma_f32_16x16x32_bf16 v[12:15], v[248:251], v[52:55], v[12:15]
    s_and_b32 s16, s16, 524287
    v_rsq_f32 v69, v69
    v_mfma_f32_16x16x32_bf16 v[12:15], v[236:239], v[48:51], v[12:15]
    buffer_load_dword v5, v4, s[4:7], s16 offen sc1
    v_mfma_f32_16x16x32_bf16 v[8:11], v[232:235], v[48:51], v[8:11]
    ds_read_b128 v[48:51], v3 offset:2048
    v_mfma_f32_16x16x32_bf16 v[8:11], v[244:247], v[52:55], v[8:11]
    ds_read_b128 v[52:55], v3 offset:3072
    s_and_b32 s37, s31, 30
    s_cbranch_scc1 Lqkv_g13
    s_branch Lqkv_s13
Lqkv_slows13:
Lqkv_spins13:
    buffer_load_dword v5, v4, s[4:7], s16 offen sc1
    s_waitcnt vmcnt(0)
    v_cmp_gt_i32 vcc, s32, v5
    s_sub_u32 s43, s43, 1
    s_cmp_lt_i32 s43, 0
    s_cbranch_scc1 Lqkv_backs13
    s_and_b64 vcc, vcc, s[18:19]
    s_cbranch_scc0 Lqkv_backs13
    s_sleep 8
    s_branch Lqkv_spins13
Lqkv_slowg13:
Lqkv_sping13:
    buffer_load_dword v5, v4, s[4:7], s16 offen sc1
    s_waitcnt vmcnt(0)
    v_cmp_gt_i32 vcc, s32, v5
    s_sub_u32 s43, s43, 1
    s_cmp_lt_i32 s43, 0
    s_cbranch_scc1 Lqkv_backg13
    s_and_b64 vcc, vcc, s[18:19]
    s_cbranch_scc0 Lqkv_backg13
    s_sleep 8
    s_branch Lqkv_sping13
Lqkv_slowg03:
Lqkv_sping03:
    buffer_load_dword v5, v4, s[4:7], s16 offen sc1
    s_waitcnt vmcnt(0)
    v_cmp_gt_i32 vcc, s32, v5
    s_sub_u32 s43, s43, 1
    s_cmp_lt_i32 s43, 0
    s_cbranch_scc1 Lqkv_backg03
    s_and_b64 vcc, vcc, s[18:19]
    s_cbranch_scc0 Lqkv_backg03
    s_sleep 8
    s_branch Lqkv_sping03
Lqkv_tail:
    v_mul_f32 v124, s52, v69
    v_mov_b32 v6, s54
    s_nop 3
    v_fma_f32 v28, -v70, v60, v28
    v_fma_f32 v29, -v70, v61, v29
    v_fma_f32 v30, -v70, v62, v30
    v_fma_f32 v31, -v70, v63, v31
    v_mul_f32 v28, v28, v71
    v_mul_f32 v29, v29, v71
    v_mul_f32 v30, v30, v71
    v_mul_f32 v31, v31, v71
    v_cvt_pk_bf16_f32 v84, v28, v29
    v_cvt_pk_bf16_f32 v85, v30, v31
    v_fma_f32 v32, -v70, v64, v32
    v_fma_f32 v33, -v70, v65, v33
    v_mfma_f32_16x16x32_bf16 v[106:109], v[84:87], v[88:91], 0
    v_fma_f32 v34, -v70, v66, v34
    v_fma_f32 v35, -v70, v67, v35
    v_mul_f32 v32, v32, v71
    v_mul_f32 v33, v33, v71
    v_mul_f32 v34, v34, v71
    v_mul_f32 v35, v35, v71
    v_cvt_pk_bf16_f32 v32, v32, v33
    v_cvt_pk_bf16_f32 v33, v34, v35
    v_cndmask_b32 v106, v106, v107, s[44:45]
    v_cndmask_b32 v108, v108, v109, s[44:45]
    v_cndmask_b32 v120, v106, v118, s[48:49]
    v_cndmask_b32 v121, v108, v119, s[50:51]
    ds_write_b64 v36, v[120:121] offset:0
    ds_write_b64 v38, v[32:33]
    ds_read_b64_tr_b16 v[94:95], v39
    v_fma_f32 v24, -v70, v56, v24
    v_fma_f32 v25, -v70, v57, v25
    v_fma_f32 v26, -v70, v58, v26
    v_fma_f32 v27, -v70, v59, v27
    v_cvt_pk_bf16_f32 v88, v24, v25
    v_cvt_pk_bf16_f32 v89, v26, v27
    s_nop 1
    v_mfma_f32_16x16x32_bf16 v[110:113], v[84:87], v[88:91], 0
    s_nop 7
    v_cndmask_b32 v118, v110, v111, s[44:45]
    v_cndmask_b32 v119, v112, v113, s[44:45]
    s_waitcnt lgkmcnt(2)
    s_barrier
    ds_read_b64 v[122:123], v37 offset:0
    s_waitcnt lgkmcnt(0)
    v_add_f32 v122, v122, v120
    v_add_f32 v123, v123, v121
    v_max_f32 v22, v122, v123
    v_mov_b32 v23, v22
    s_nop 1
    v_permlane16_swap_b32 v22, v23
    v_max_f32 v22, v22, v23
    v_mov_b32 v23, v22
    s_nop 1
    v_permlane32_swap_b32 v22, v23
    v_max_f32 v22, v22, v23
    v_mul_f32 v22, v124, v22
    v_fma_f32 v122, v122, v124, -v22
    v_fma_f32 v123, v123, v124, -v22
    v_exp_f32 v122, v122
    v_exp_f32 v123, v123
    s_nop 0
    v_add_f32 v22, v122, v123
    v_mov_b32 v23, v22
    s_nop 1
    v_permlane16_swap_b32 v22, v23
    v_add_f32 v22, v22, v23
    v_mov_b32 v23, v22
    s_nop 1
    v_permlane32_swap_b32 v22, v23
    v_add_f32 v22, v22, v23
    v_rcp_f32 v22, v22
    s_nop 0
    v_mul_f32 v122, v122, v22
    v_mul_f32 v123, v123, v22
    v_cvt_pk_bf16_f32 v23, v122, v123
    v_perm_b32 v116, v23, v23, v102
    v_perm_b32 v117, v23, v23, v103
    v_perm_b32 v114, v23, v23, v104
    v_perm_b32 v115, v23, v23, v105
    s_nop 1
    v_mfma_f32_16x16x32_bf16 v[72:75], v[92:95], v[114:117], 0
    s_nop 7
    v_cvt_pk_bf16_f32 v114, v72, v73
    v_cvt_pk_bf16_f32 v115, v74, v75
    v_cvt_pk_bf16_f32 v116, v72, v73
    v_cvt_pk_bf16_f32 v117, v74, v75
    s_nop 0
    v_permlane32_swap_b32 v114, v116
    v_permlane32_swap_b32 v115, v117
    s_waitcnt vmcnt(1)
    buffer_store_dword v6, v21, s[12:15], s17 offen sc1
    buffer_store_dwordx4 v[114:117], v7, s[12:15], s36 offen sc1
    s_add_u32 s36, s36, 32768
    v_mul_f32 v124, s52, v71
    v_mov_b32 v106, s42
    v_mov_b32 v107, s42
    v_mov_b32 v108, s42
    v_mov_b32 v109, s42
    s_nop 1
    v_mfma_f32_16x16x32_bf16 v[106:109], v[96:99], v[88:91], v[106:109]
    s_nop 7
    v_cndmask_b32 v106, v106, v107, s[44:45]
    v_cndmask_b32 v108, v108, v109, s[44:45]
    v_cndmask_b32 v120, v106, v118, s[48:49]
    v_cndmask_b32 v121, v108, v119, s[50:51]
    ds_write_b64 v36, v[120:121] offset:2048
    s_waitcnt lgkmcnt(0)
    s_barrier
    ds_read_b64 v[122:123], v37 offset:2048
    s_waitcnt lgkmcnt(0)
    v_add_f32 v122, v122, v120
    v_add_f32 v123, v123, v121
    v_max_f32 v22, v122, v123
    v_mov_b32 v23, v22
    s_nop 1
    v_permlane16_swap_b32 v22, v23
    v_max_f32 v22, v22, v23
    v_mov_b32 v23, v22
    s_nop 1
    v_permlane32_swap_b32 v22, v23
    v_max_f32 v22, v22, v23
    v_mul_f32 v22, v124, v22
    v_fma_f32 v122, v122, v124, -v22
    v_fma_f32 v123, v123, v124, -v22
    v_exp_f32 v122, v122
    v_exp_f32 v123, v123
    s_nop 0
    v_add_f32 v22, v122, v123
    v_mov_b32 v23, v22
    s_nop 1
    v_permlane16_swap_b32 v22, v23
    v_add_f32 v22, v22, v23
    v_mov_b32 v23, v22
    s_nop 1
    v_permlane32_swap_b32 v22, v23
    v_add_f32 v22, v22, v23
    v_rcp_f32 v22, v22
    s_nop 0
    v_mul_f32 v122, v122, v22
    v_mul_f32 v123, v123, v22
    v_cvt_pk_bf16_f32 v23, v122, v123
    v_perm_b32 v114, v23, v23, v102
    v_perm_b32 v115, v23, v23, v103
    v_perm_b32 v116, v23, v23, v104
    v_perm_b32 v117, v23, v23, v105
    v_mov_b32 v100, v94
    v_mov_b32 v101, v95
    s_nop 1
    v_mfma_f32_16x16x32_bf16 v[72:75], v[98:101], v[114:117], 0
    s_nop 7
    v_cvt_pk_bf16_f32 v114, v72, v73
    v_cvt_pk_bf16_f32 v115, v74, v75
    v_cvt_pk_bf16_f32 v116, v72, v73
    v_cvt_pk_bf16_f32 v117, v74, v75
    s_nop 0
    v_permlane32_swap_b32 v114, v116
    v_permlane32_swap_b32 v115, v117
    buffer_store_dwordx4 v[114:117], v7, s[12:15], s36 offen sc1
    s_add_u32 s36, s36, 32768
    v_mov_b32 v8, 63
    s_waitcnt vmcnt(1)
    s_add_u32 s17, s17, 8192
    buffer_store_dword v8, v21, s[12:15], s17 offen sc1
    v_mov_b32 v9, 64
    s_waitcnt vmcnt(1)
    s_add_u32 s17, s17, 8192
    buffer_store_dword v9, v21, s[12:15], s17 offen sc1
    s_branch L_exit
Lwo_start:
    s_mov_b32 s12, s68
    s_mov_b32 s13, s69
    s_mov_b32 s14, 0x200000
    s_mov_b32 s15, 0x00020000
    v_lshrrev_b32 v24, 3, v0
    v_mul_u32_u24 v24, 2048, v24
    v_bfe_u32 v25, v0, 4, 2
    v_lshlrev_b32 v25, 1, v25
    v_and_b32 v26, 7, v0
    v_xor_b32 v25, v25, v26
    v_lshl_add_u32 v40, v25, 4, v24
    v_add_u32 v41, 15360, v40
    s_mul_i32 s86, s29, 0x100
    s_add_u32 s86, s86, 0xfffff000
    s_mul_i32 s37, s30, 32768
    s_add_u32 s86, s86, s37
    s_lshl_b32 s87, s30, 11
    s_add_u32 m0, s87, 0
    s_add_u32 s37, s86, 0
    buffer_load_dwordx4 v40, s[12:15], s37 offen offset:0 lds
    buffer_load_dwordx4 v41, s[12:15], s37 offen offset:1024 lds
    s_add_u32 m0, s87, 8192
    s_add_u32 s37, s86, 128
    buffer_load_dwordx4 v40, s[12:15], s37 offen offset:0 lds
    buffer_load_dwordx4 v41, s[12:15], s37 offen offset:1024 lds
    s_add_u32 m0, s87, 16384
    s_add_u32 s37, s86, 131072
    buffer_load_dwordx4 v40, s[12:15], s37 offen offset:0 lds
    buffer_load_dwordx4 v41, s[12:15], s37 offen offset:1024 lds
    s_add_u32 m0, s87, 24576
    s_add_u32 s37, s86, 131200
    buffer_load_dwordx4 v40, s[12:15], s37 offen offset:0 lds
    buffer_load_dwordx4 v41, s[12:15], s37 offen offset:1024 lds
    s_add_u32 m0, s87, 32768
    s_add_u32 s37, s86, 262144
    buffer_load_dwordx4 v40, s[12:15], s37 offen offset:0 lds
    buffer_load_dwordx4 v41, s[12:15], s37 offen offset:1024 lds
    s_add_u32 m0, s87, 40960
    s_add_u32 s37, s86, 262272
    buffer_load_dwordx4 v40, s[12:15], s37 offen offset:0 lds
    buffer_load_dwordx4 v41, s[12:15], s37 offen offset:1024 lds
    s_add_u32 m0, s87, 49152
    s_add_u32 s37, s86, 393216
    buffer_load_dwordx4 v40, s[12:15], s37 offen offset:0 lds
    buffer_load_dwordx4 v41, s[12:15], s37 offen offset:1024 lds
    s_add_u32 m0, s87, 57344
    s_add_u32 s37, s86, 393344
    buffer_load_dwordx4 v40, s[12:15], s37 offen offset:0 lds
    buffer_load_dwordx4 v41, s[12:15], s37 offen offset:1024 lds
    s_add_u32 m0, s87, 65536
    s_add_u32 s37, s86, 524288
    buffer_load_dwordx4 v40, s[12:15], s37 offen offset:0 lds
    buffer_load_dwordx4 v41, s[12:15], s37 offen offset:1024 lds
    s_add_u32 m0, s87, 73728
    s_add_u32 s37, s86, 524416
    buffer_load_dwordx4 v40, s[12:15], s37 offen offset:0 lds
    buffer_load_dwordx4 v41, s[12:15], s37 offen offset:1024 lds
    s_add_u32 m0, s87, 81920
    s_add_u32 s37, s86, 655360
    buffer_load_dwordx4 v40, s[12:15], s37 offen offset:0 lds
    buffer_load_dwordx4 v41, s[12:15], s37 offen offset:1024 lds
    s_add_u32 m0, s87, 90112
    s_add_u32 s37, s86, 655488
    buffer_load_dwordx4 v40, s[12:15], s37 offen offset:0 lds
    buffer_load_dwordx4 v41, s[12:15], s37 offen offset:1024 lds
    s_add_u32 m0, s87, 98304
    s_add_u32 s37, s86, 786432
    buffer_load_dwordx4 v40, s[12:15], s37 offen offset:0 lds
    buffer_load_dwordx4 v41, s[12:15], s37 offen offset:1024 lds
    s_add_u32 m0, s87, 106496
    s_add_u32 s37, s86, 786560
    buffer_load_dwordx4 v40, s[12:15], s37 offen offset:0 lds
    buffer_load_dwordx4 v41, s[12:15], s37 offen offset:1024 lds
    s_add_u32 m0, s87, 114688
    s_add_u32 s37, s86, 917504
    buffer_load_dwordx4 v40, s[12:15], s37 offen offset:0 lds
    buffer_load_dwordx4 v41, s[12:15], s37 offen offset:1024 lds
    s_add_u32 m0, s87, 122880
    s_add_u32 s37, s86, 917632
    buffer_load_dwordx4 v40, s[12:15], s37 offen offset:0 lds
    buffer_load_dwordx4 v41, s[12:15], s37 offen offset:1024 lds
    s_add_u32 m0, s87, 131072
    s_add_u32 s37, s86, 1048576
    buffer_load_dwordx4 v40, s[12:15], s37 offen offset:0 lds
    buffer_load_dwordx4 v41, s[12:15], s37 offen offset:1024 lds
    s_add_u32 m0, s87, 139264
    s_add_u32 s37, s86, 1048704
    buffer_load_dwordx4 v40, s[12:15], s37 offen offset:0 lds
    buffer_load_dwordx4 v41, s[12:15], s37 offen offset:1024 lds
    v_bfe_u32 v24, v0, 3, 2
    v_and_b32 v25, 3, v0
    v_lshlrev_b32 v25, 3, v25
    v_lshrrev_b32 v26, 2, v0
    v_lshl_add_u32 v26, v26, 7, v25
    v_lshrrev_b32 v27, 5, v0
    v_lshl_add_u32 v27, v27, 10, v26
    s_lshr_b32 s37, s30, 1
    s_and_b32 s38, s30, 1
    s_lshl_b32 s38, s38, 1
    s_add_u32 s38, s38, 0
    s_lshl_b32 s37, s37, 13
    v_xor_b32 v28, s38, v24
    v_lshl_add_u32 v28, v28, 5, s37
    v_add_u32 v42, v28, v26
    v_add_u32 v46, v28, v27
    s_lshr_b32 s37, s30, 1
    s_and_b32 s38, s30, 1
    s_lshl_b32 s38, s38, 1
    s_add_u32 s38, s38, 1
    s_lshl_b32 s37, s37, 13
    v_xor_b32 v28, s38, v24
    v_lshl_add_u32 v28, v28, 5, s37
    v_add_u32 v43, v28, v26
    v_add_u32 v47, v28, v27
    v_mov_b32 v84, 0x3f803f80
    v_mov_b32 v85, 0x3f803f80
    v_mov_b32 v86, 0x3f803f80
    v_mov_b32 v87, 0x3f803f80
    s_mov_b32 s44, 0xaaaaaaaa
    s_mov_b32 s45, 0xaaaaaaaa
    s_mov_b32 s46, 0xcccccccc
    s_mov_b32 s47, 0xcccccccc
    s_mov_b32 s38, 0xf0000f
    s_mov_b32 s39, 0xf0000f00
    v_and_b32 v8, 15, v0
    v_lshlrev_b32 v8, 3, v8
    v_mov_b32 v7, 0x40000000
    v_cndmask_b32 v7, v7, v8, s[38:39]
    s_mul_i32 s37, s29, 0xfffff200
    s_mul_i32 s53, s30, 0xfffffc80
    s_add_u32 s37, s37, s53
    s_add_u32 s37, s37, 0x16000
    v_add_u32 v7, s37, v7
    v_mov_b32 v88, 0
    v_mov_b32 v89, 0
    v_mov_b32 v92, 0
    v_mov_b32 v93, 0
    v_mov_b32 v8, 0x3f80
    v_mov_b32 v9, 0x3f800000
    s_mov_b32 s38, 0x100001
    s_mov_b32 s39, 0x10000100
    v_cndmask_b32 v90, v88, v8, s[38:39]
    s_mov_b32 s38, 0x200002
    s_mov_b32 s39, 0x20000200
    v_cndmask_b32 v90, v90, v9, s[38:39]
    s_mov_b32 s38, 0x400004
    s_mov_b32 s39, 0x40000400
    v_cndmask_b32 v91, v88, v8, s[38:39]
    s_mov_b32 s38, 0x800008
    s_mov_b32 s39, 0x80000800
    v_cndmask_b32 v91, v91, v9, s[38:39]
    s_mul_i32 s37, s28, 0x80000
    s_add_u32 s37, s37, 0x6000000
    v_min_u32 v4, 63, v0
    v_lshl_add_u32 v4, v4, 5, s37
    s_mov_b32 s32, 1
    s_mul_i32 s33, s28, 0x200000
    s_add_u32 s33, s33, 0xa00000
    s_mul_i32 s40, s28, 0x220000
    s_mul_i32 s53, s29, 0x1000
    s_add_u32 s40, s40, s53
    s_mul_i32 s53, s30, 0x400
    s_add_u32 s40, s40, s53
    s_add_u32 s40, s40, 0xffff0000
    s_mul_i32 s36, s28, 0x240000
    s_mul_i32 s53, s29, 0x1000
    s_add_u32 s36, s36, s53
    s_mul_i32 s53, s30, 0x400
    s_add_u32 s36, s36, s53
    s_add_u32 s36, s36, 0x11e7000
    s_mov_b32 s31, -1
    s_mov_b32 s35, 0
    s_mov_b32 s16, 0
    v_mov_b32 v5, 0
    s_mul_i32 s17, s28, 0x80000
    s_mul_i32 s53, s29, 0x80
    s_add_u32 s17, s17, s53
    s_mul_i32 s53, s30, 0x20
    s_add_u32 s17, s17, s53
    s_add_u32 s17, s17, 0x5ffe000
    v_cmp_eq_u32 vcc, 0, v0
    v_mov_b32 v102, 0x40000000
    s_nop 0
    v_cndmask_b32 v102, v102, v0, vcc
    v_mov_b32 v2, v1
    s_mul_i32 s34, s30, 4096
    s_mul_i32 s3, s30, 0x0
    s_add_u32 s3, s3, 0x4000
    s_add_u32 s41, s3, 4096
    s_add_u32 s33, s33, s34
    s_mov_b64 s[18:19], -1
    v_mov_b32 v8, 0x40000000
    v_cndmask_b32 v4, v8, v4, s[18:19]
    v_add_u32 v12, 0, v46
    v_add_u32 v13, 0, v47
    s_waitcnt vmcnt(32) lgkmcnt(0)
    s_barrier
    s_add_u32 m0, s87, 147456
    s_add_u32 s37, s86, 1179648
    buffer_load_dwordx4 v40, s[12:15], s37 offen offset:0 lds
    ds_read_b64_tr_b16 a[0:1], v12 offset:0
    ds_read_b64_tr_b16 a[2:3], v12 offset:1024
    ds_read_b64_tr_b16 a[4:5], v13 offset:0
    buffer_load_dwordx4 v41, s[12:15], s37 offen offset:1024 lds
    ds_read_b64_tr_b16 a[6:7], v13 offset:1024
    ds_read_b64_tr_b16 a[8:9], v12 offset:4096
    ds_read_b64_tr_b16 a[10:11], v12 offset:5120
    s_add_u32 m0, s87, 155648
    s_add_u32 s37, s86, 1179776
    buffer_load_dwordx4 v40, s[12:15], s37 offen offset:0 lds
    ds_read_b64_tr_b16 a[12:13], v13 offset:4096
    ds_read_b64_tr_b16 a[14:15], v13 offset:5120
    v_add_u32 v16, 16384, v46
    buffer_load_dwordx4 v41, s[12:15], s37 offen offset:1024 lds
    v_add_u32 v17, 16384, v47
    s_waitcnt vmcnt(32) lgkmcnt(0)
    s_barrier
    s_add_u32 m0, s87, 0
    s_add_u32 s37, s86, 1310720
    buffer_load_dwordx4 v40, s[12:15], s37 offen offset:0 lds
    ds_read_b64_tr_b16 a[16:17], v16 offset:0
    ds_read_b64_tr_b16 a[18:19], v16 offset:1024
    ds_read_b64_tr_b16 a[20:21], v17 offset:0
    buffer_load_dwordx4 v41, s[12:15], s37 offen offset:1024 lds
    ds_read_b64_tr_b16 a[22:23], v17 offset:1024
    ds_read_b64_tr_b16 a[24:25], v16 offset:4096
    ds_read_b64_tr_b16 a[26:27], v16 offset:5120
    s_add_u32 m0, s87, 8192
    s_add_u32 s37, s86, 1310848
    buffer_load_dwordx4 v40, s[12:15], s37 offen offset:0 lds
    ds_read_b64_tr_b16 a[28:29], v17 offset:4096
    ds_read_b64_tr_b16 a[30:31], v17 offset:5120
    v_add_u32 v12, 32768, v46
    buffer_load_dwordx4 v41, s[12:15], s37 offen offset:1024 lds
    v_add_u32 v13, 32768, v47
    s_waitcnt vmcnt(32) lgkmcnt(0)
    s_barrier
    s_add_u32 m0, s87, 16384
    s_add_u32 s37, s86, 1441792
    buffer_load_dwordx4 v40, s[12:15], s37 offen offset:0 lds
    ds_read_b64_tr_b16 a[32:33], v12 offset:0
    ds_read_b64_tr_b16 a[34:35], v12 offset:1024
    ds_read_b64_tr_b16 a[36:37], v13 offset:0
    buffer_load_dwordx4 v41, s[12:15], s37 offen offset:1024 lds
    ds_read_b64_tr_b16 a[38:39], v13 offset:1024
    ds_read_b64_tr_b16 a[40:41], v12 offset:4096
    ds_read_b64_tr_b16 a[42:43], v12 offset:5120
    s_add_u32 m0, s87, 24576
    s_add_u32 s37, s86, 1441920
    buffer_load_dwordx4 v40, s[12:15], s37 offen offset:0 lds
    ds_read_b64_tr_b16 a[44:45], v13 offset:4096
    ds_read_b64_tr_b16 a[46:47], v13 offset:5120
    v_add_u32 v16, 49152, v46
    buffer_load_dwordx4 v41, s[12:15], s37 offen offset:1024 lds
    v_add_u32 v17, 49152, v47
    s_waitcnt vmcnt(32) lgkmcnt(0)
    s_barrier
    s_add_u32 m0, s87, 32768
    s_add_u32 s37, s86, 1572864
    buffer_load_dwordx4 v40, s[12:15], s37 offen offset:0 lds
    ds_read_b64_tr_b16 a[48:49], v16 offset:0
    ds_read_b64_tr_b16 a[50:51], v16 offset:1024
    ds_read_b64_tr_b16 a[52:53], v17 offset:0
    buffer_load_dwordx4 v41, s[12:15], s37 offen offset:1024 lds
    ds_read_b64_tr_b16 a[54:55], v17 offset:1024
    ds_read_b64_tr_b16 a[56:57], v16 offset:4096
    ds_read_b64_tr_b16 a[58:59], v16 offset:5120
    s_add_u32 m0, s87, 40960
    s_add_u32 s37, s86, 1572992
    buffer_load_dwordx4 v40, s[12:15], s37 offen offset:0 lds
    ds_read_b64_tr_b16 a[60:61], v17 offset:4096
    ds_read_b64_tr_b16 a[62:63], v17 offset:5120
    v_add_u32 v12, 65536, v46
    buffer_load_dwordx4 v41, s[12:15], s37 offen offset:1024 lds
    v_add_u32 v13, 65536, v47
    s_waitcnt vmcnt(32) lgkmcnt(0)
    s_barrier
    s_add_u32 m0, s87, 49152
    s_add_u32 s37, s86, 1703936
    buffer_load_dwordx4 v40, s[12:15], s37 offen offset:0 lds
    ds_read_b64_tr_b16 a[64:65], v12 offset:0
    ds_read_b64_tr_b16 a[66:67], v12 offset:1024
    ds_read_b64_tr_b16 a[68:69], v13 offset:0
    buffer_load_dwordx4 v41, s[12:15], s37 offen offset:1024 lds
    ds_read_b64_tr_b16 a[70:71], v13 offset:1024
    ds_read_b64_tr_b16 a[72:73], v12 offset:4096
    ds_read_b64_tr_b16 a[74:75], v12 offset:5120
    s_add_u32 m0, s87, 57344
    s_add_u32 s37, s86, 1704064
    buffer_load_dwordx4 v40, s[12:15], s37 offen offset:0 lds
    ds_read_b64_tr_b16 a[76:77], v13 offset:4096
    ds_read_b64_tr_b16 a[78:79], v13 offset:5120
    v_add_u32 v16, 81920, v46
    buffer_load_dwordx4 v41, s[12:15], s37 offen offset:1024 lds
    v_add_u32 v17, 81920, v47
    s_waitcnt vmcnt(32) lgkmcnt(0)
    s_barrier
    s_add_u32 m0, s87, 65536
    s_add_u32 s37, s86, 1835008
    buffer_load_dwordx4 v40, s[12:15], s37 offen offset:0 lds
    ds_read_b64_tr_b16 a[80:81], v16 offset:0
    ds_read_b64_tr_b16 a[82:83], v16 offset:1024
    ds_read_b64_tr_b16 a[84:85], v17 offset:0
    buffer_load_dwordx4 v41, s[12:15], s37 offen offset:1024 lds
    ds_read_b64_tr_b16 a[86:87], v17 offset:1024
    ds_read_b64_tr_b16 a[88:89], v16 offset:4096
    ds_read_b64_tr_b16 a[90:91], v16 offset:5120
    s_add_u32 m0, s87, 73728
    s_add_u32 s37, s86, 1835136
    buffer_load_dwordx4 v40, s[12:15], s37 offen offset:0 lds
    ds_read_b64_tr_b16 a[92:93], v17 offset:4096
    ds_read_b64_tr_b16 a[94:95], v17 offset:5120
    v_add_u32 v12, 98304, v46
    buffer_load_dwordx4 v41, s[12:15], s37 offen offset:1024 lds
    v_add_u32 v13, 98304, v47
    s_waitcnt vmcnt(32) lgkmcnt(0)
    s_barrier
    s_add_u32 m0, s87, 81920
    s_add_u32 s37, s86, 1966080
    buffer_load_dwordx4 v40, s[12:15], s37 offen offset:0 lds
    ds_read_b64_tr_b16 a[96:97], v12 offset:0
    ds_read_b64_tr_b16 a[98:99], v12 offset:1024
    ds_read_b64_tr_b16 a[100:101], v13 offset:0
    buffer_load_dwordx4 v41, s[12:15], s37 offen offset:1024 lds
    ds_read_b64_tr_b16 a[102:103], v13 offset:1024
    ds_read_b64_tr_b16 a[104:105], v12 offset:4096
    ds_read_b64_tr_b16 a[106:107], v12 offset:5120
    s_add_u32 m0, s87, 90112
    s_add_u32 s37, s86, 1966208
    buffer_load_dwordx4 v40, s[12:15], s37 offen offset:0 lds
    ds_read_b64_tr_b16 a[108:109], v13 offset:4096
    ds_read_b64_tr_b16 a[110:111], v13 offset:5120
    v_add_u32 v16, 114688, v46
    buffer_load_dwordx4 v41, s[12:15], s37 offen offset:1024 lds
    v_add_u32 v17, 114688, v47
    s_waitcnt vmcnt(32) lgkmcnt(0)
    s_barrier
    ds_read_b64_tr_b16 a[112:113], v16 offset:0
    ds_read_b64_tr_b16 a[114:115], v16 offset:1024
    ds_read_b64_tr_b16 a[116:117], v17 offset:0
    ds_read_b64_tr_b16 a[118:119], v17 offset:1024
    ds_read_b64_tr_b16 a[120:121], v16 offset:4096
    ds_read_b64_tr_b16 a[122:123], v16 offset:5120
    ds_read_b64_tr_b16 a[124:125], v17 offset:4096
    ds_read_b64_tr_b16 a[126:127], v17 offset:5120
    v_add_u32 v12, 131072, v46
    v_add_u32 v13, 131072, v47
    s_waitcnt vmcnt(28) lgkmcnt(0)
    s_barrier
    ds_read_b64_tr_b16 a[128:129], v12 offset:0
    ds_read_b64_tr_b16 a[130:131], v12 offset:1024
    ds_read_b64_tr_b16 a[132:133], v13 offset:0
    ds_read_b64_tr_b16 a[134:135], v13 offset:1024
    ds_read_b64_tr_b16 a[136:137], v12 offset:4096
    ds_read_b64_tr_b16 a[138:139], v12 offset:5120
    ds_read_b64_tr_b16 a[140:141], v13 offset:4096
    ds_read_b64_tr_b16 a[142:143], v13 offset:5120
    v_add_u32 v16, 147456, v46
    v_add_u32 v17, 147456, v47
    s_waitcnt vmcnt(24) lgkmcnt(0)
    s_barrier
    ds_read_b64_tr_b16 a[144:145], v16 offset:0
    ds_read_b64_tr_b16 a[146:147], v16 offset:1024
    ds_read_b64_tr_b16 a[148:149], v17 offset:0
    ds_read_b64_tr_b16 a[150:151], v17 offset:1024
    ds_read_b64_tr_b16 a[152:153], v16 offset:4096
    ds_read_b64_tr_b16 a[154:155], v16 offset:5120
    ds_read_b64_tr_b16 a[156:157], v17 offset:4096
    ds_read_b64_tr_b16 a[158:159], v17 offset:5120
    v_add_u32 v12, 0, v46
    v_add_u32 v13, 0, v47
    s_waitcnt vmcnt(20) lgkmcnt(0)
    s_barrier
    ds_read_b64_tr_b16 a[160:161], v12 offset:0
    ds_read_b64_tr_b16 a[162:163], v12 offset:1024
    ds_read_b64_tr_b16 a[164:165], v13 offset:0
    ds_read_b64_tr_b16 a[166:167], v13 offset:1024
    ds_read_b64_tr_b16 a[168:169], v12 offset:4096
    ds_read_b64_tr_b16 a[170:171], v12 offset:5120
    ds_read_b64_tr_b16 a[172:173], v13 offset:4096
    ds_read_b64_tr_b16 a[174:175], v13 offset:5120
    v_add_u32 v16, 16384, v46
    v_add_u32 v17, 16384, v47
    s_waitcnt vmcnt(16) lgkmcnt(0)
    s_barrier
    ds_read_b64_tr_b16 a[176:177], v16 offset:0
    ds_read_b64_tr_b16 a[178:179], v16 offset:1024
    ds_read_b64_tr_b16 a[180:181], v17 offset:0
    ds_read_b64_tr_b16 a[182:183], v17 offset:1024
    ds_read_b64_tr_b16 a[184:185], v16 offset:4096
    ds_read_b64_tr_b16 a[186:187], v16 offset:5120
    ds_read_b64_tr_b16 a[188:189], v17 offset:4096
    ds_read_b64_tr_b16 a[190:191], v17 offset:5120
    v_add_u32 v12, 32768, v46
    v_add_u32 v13, 32768, v47
    s_waitcnt vmcnt(12) lgkmcnt(0)
    s_barrier
    ds_read_b64_tr_b16 a[192:193], v12 offset:0
    ds_read_b64_tr_b16 a[194:195], v12 offset:1024
    ds_read_b64_tr_b16 a[196:197], v13 offset:0
    ds_read_b64_tr_b16 a[198:199], v13 offset:1024
    ds_read_b64_tr_b16 a[200:201], v12 offset:4096
    ds_read_b64_tr_b16 a[202:203], v12 offset:5120
    ds_read_b64_tr_b16 a[204:205], v13 offset:4096
    ds_read_b64_tr_b16 a[206:207], v13 offset:5120
    v_add_u32 v16, 49152, v46
    v_add_u32 v17, 49152, v47
    s_waitcnt vmcnt(8) lgkmcnt(0)
    s_barrier
    ds_read_b64_tr_b16 a[208:209], v16 offset:0
    ds_read_b64_tr_b16 a[210:211], v16 offset:1024
    ds_read_b64_tr_b16 a[212:213], v17 offset:0
    ds_read_b64_tr_b16 a[214:215], v17 offset:1024
    ds_read_b64_tr_b16 a[216:217], v16 offset:4096
    ds_read_b64_tr_b16 a[218:219], v16 offset:5120
    ds_read_b64_tr_b16 a[220:221], v17 offset:4096
    ds_read_b64_tr_b16 a[222:223], v17 offset:5120
    v_add_u32 v12, 65536, v46
    v_add_u32 v13, 65536, v47
    s_waitcnt vmcnt(4) lgkmcnt(0)
    s_barrier
    ds_read_b64_tr_b16 a[224:225], v12 offset:0
    ds_read_b64_tr_b16 a[226:227], v12 offset:1024
    ds_read_b64_tr_b16 a[228:229], v13 offset:0
    ds_read_b64_tr_b16 a[230:231], v13 offset:1024
    ds_read_b64_tr_b16 a[232:233], v12 offset:4096
    ds_read_b64_tr_b16 a[234:235], v12 offset:5120
    ds_read_b64_tr_b16 a[236:237], v13 offset:4096
    ds_read_b64_tr_b16 a[238:239], v13 offset:5120
    v_add_u32 v16, 81920, v46
    v_add_u32 v17, 81920, v47
    s_waitcnt vmcnt(0) lgkmcnt(0)
    s_barrier
    ds_read_b64_tr_b16 a[240:241], v16 offset:0
    ds_read_b64_tr_b16 a[242:243], v16 offset:1024
    ds_read_b64_tr_b16 a[244:245], v17 offset:0
    ds_read_b64_tr_b16 a[246:247], v17 offset:1024
    ds_read_b64_tr_b16 a[248:249], v16 offset:4096
    ds_read_b64_tr_b16 a[250:251], v16 offset:5120
    ds_read_b64_tr_b16 a[252:253], v17 offset:4096
    ds_read_b64_tr_b16 a[254:255], v17 offset:5120
    s_waitcnt lgkmcnt(0)
    s_mov_b32 s12, s84
    s_mov_b32 s13, s85
    s_mov_b32 s14, 0x6200000
    s_mov_b32 s15, 0x00020000
    s_barrier
    s_mov_b32 s20, s82
    s_mov_b32 s21, s83
    s_mov_b32 s22, 0x100
    s_mov_b32 s23, 0x00020000
    v_and_b32 v8, 15, v0
    v_lshlrev_b32 v8, 4, v8
    v_mov_b32 v10, 8
    buffer_load_dword v9, v8, s[20:23], 0 offen sc1
    s_waitcnt vmcnt(0)
Lwo_wa:
    v_cmp_gt_u32 vcc, v10, v9
    s_sub_u32 s43, s43, 1
    s_cmp_lt_i32 s43, 0
    s_cbranch_scc1 Lwo_all
    s_cbranch_vccz Lwo_all
    s_sleep 2
    buffer_load_dword v9, v8, s[20:23], 0 offen sc1
    s_waitcnt vmcnt(0)
    s_branch Lwo_wa
Lwo_all:
    s_mov_b32 s14, 0
    s_cmp_lg_u32 s30, 0
    s_cbranch_scc1 Lwo_fok
Lwo_fspin:
    buffer_load_dword v5, v4, s[4:7], s16 offen sc1
    s_waitcnt vmcnt(0)
    v_cmp_gt_i32 vcc, s32, v5
    s_sub_u32 s43, s43, 1
    s_cmp_lt_i32 s43, 0
    s_cbranch_scc1 Lwo_fok
    s_and_b64 vcc, vcc, s[18:19]
    s_cbranch_scc0 Lwo_fok
    s_sleep 2
    s_branch Lwo_fspin
Lwo_fok:
    s_barrier
    buffer_load_dwordx4 v[94:97], v1, s[4:7], s40 offen sc1
    s_add_u32 s40, s40, 34816
    s_branch Lwo_rdy1
    .p2align 6
Lwo_body00:
    s_waitcnt lgkmcnt(2)
    v_mfma_f32_16x16x32_bf16 v[8:11], a[0:3], v[40:43], 0
    ds_read_b128 v[56:59], v2 offset:4096
    s_add_u32 m0, s34, 0
    v_mfma_f32_16x16x32_bf16 v[8:11], a[8:11], v[44:47], v[8:11]
    s_waitcnt vmcnt(5)
    v_cmp_gt_i32 vcc, s32, v5
    v_cvt_pk_bf16_f32 v72, v24, v25
    v_mfma_f32_16x16x32_bf16 v[12:15], a[12:15], v[44:47], 0
    ds_read_b128 v[60:63], v2 offset:5120
    v_cvt_pk_bf16_f32 v73, v26, v27
    v_mfma_f32_16x16x32_bf16 v[12:15], a[4:7], v[40:43], v[12:15]
    s_waitcnt lgkmcnt(2)
    s_and_b64 vcc, vcc, s[18:19]
    s_cbranch_scc1 Lwo_v01
    v_mfma_f32_16x16x32_bf16 v[12:15], a[20:23], v[48:51], v[12:15]
    ds_read_b128 v[64:67], v2 offset:6144
    v_cvt_pk_bf16_f32 v74, v28, v29
    v_mfma_f32_16x16x32_bf16 v[12:15], a[28:31], v[52:55], v[12:15]
    buffer_load_dwordx4 v1, s[8:11], s33 offen offset:0 sc1 lds
    v_mfma_f32_16x16x32_bf16 v[8:11], a[24:27], v[52:55], v[8:11]
    ds_read_b128 v[68:71], v2 offset:7168
    v_cvt_pk_bf16_f32 v75, v30, v31
    v_mfma_f32_16x16x32_bf16 v[8:11], a[16:19], v[48:51], v[8:11]
    s_waitcnt lgkmcnt(2)
    s_add_u32 s31, s31, 1
    v_mov_b32 v6, s31
    v_mfma_f32_16x16x32_bf16 v[80:83], v[72:75], v[72:75], 0
    s_add_u32 s35, s35, 36864
    s_cmp_eq_u32 s35, 147456
    s_cselect_b32 s35, 0, s35
    v_mfma_f32_16x16x32_bf16 v[76:79], v[84:87], v[72:75], 0
    buffer_store_dwordx4 v[72:75], v1, s[12:15], s36 offen sc1
    v_add_u32 v3, s35, v1
    v_mfma_f32_16x16x32_bf16 v[8:11], a[32:35], v[56:59], v[8:11]
    ds_read_b128 v[40:43], v2 offset:8192
    v_cndmask_b32 v80, v80, v81, s[44:45]
    v_mfma_f32_16x16x32_bf16 v[8:11], a[40:43], v[60:63], v[8:11]
    v_cndmask_b32 v82, v82, v83, s[44:45]
    v_mfma_f32_16x16x32_bf16 v[12:15], a[44:47], v[60:63], v[12:15]
    ds_read_b128 v[44:47], v2 offset:9216
    v_cndmask_b32 v77, v80, v82, s[46:47]
    v_mfma_f32_16x16x32_bf16 v[12:15], a[36:39], v[56:59], v[12:15]
    s_waitcnt lgkmcnt(2)
    buffer_load_dwordx4 v1, s[8:11], s33 offen offset:1024 sc1 lds
    v_mfma_f32_16x16x32_bf16 v[12:15], a[52:55], v[64:67], v[12:15]
    ds_read_b128 v[48:51], v2 offset:10240
    v_mfma_f32_16x16x32_bf16 v[12:15], a[60:63], v[68:71], v[12:15]
    buffer_store_dwordx2 v[76:77], v7, s[12:15], s36 offen offset:0 sc1
    s_add_u32 s36, s36, 36864
    v_mfma_f32_16x16x32_bf16 v[8:11], a[56:59], v[68:71], v[8:11]
    ds_read_b128 v[52:55], v2 offset:11264
    v_mfma_f32_16x16x32_bf16 v[8:11], a[48:51], v[64:67], v[8:11]
    s_waitcnt lgkmcnt(2)
    buffer_load_dwordx4 v1, s[8:11], s33 offen offset:2048 sc1 lds
    v_mfma_f32_16x16x32_bf16 v[8:11], a[64:67], v[40:43], v[8:11]
    ds_read_b128 v[56:59], v2 offset:12288
    v_mfma_f32_16x16x32_bf16 v[8:11], a[72:75], v[44:47], v[8:11]
    v_mfma_f32_16x16x32_bf16 v[12:15], a[76:79], v[44:47], v[12:15]
    ds_read_b128 v[60:63], v2 offset:13312
    v_mfma_f32_16x16x32_bf16 v[12:15], a[68:71], v[40:43], v[12:15]
    s_waitcnt lgkmcnt(2)
    buffer_load_dwordx4 v1, s[8:11], s33 offen offset:3072 sc1 lds
    v_mfma_f32_16x16x32_bf16 v[12:15], a[84:87], v[48:51], v[12:15]
    ds_read_b128 v[64:67], v2 offset:14336
    s_waitcnt vmcnt(8)
    v_mfma_f32_16x16x32_bf16 v[12:15], a[92:95], v[52:55], v[12:15]
    s_barrier
    v_mfma_f32_16x16x32_bf16 v[8:11], a[88:91], v[52:55], v[8:11]
    ds_read_b128 v[68:71], v2 offset:15360
    s_add_u32 s16, s16, 8192
    v_mfma_f32_16x16x32_bf16 v[8:11], a[80:83], v[48:51], v[8:11]
    s_waitcnt lgkmcnt(2)
    s_add_u32 m0, s34, s3
    s_add_u32 s37, s33, s3
    v_mfma_f32_16x16x32_bf16 v[8:11], a[96:99], v[56:59], v[8:11]
    ds_read_b128 v[40:43], v2 offset:16384
    v_mfma_f32_16x16x32_bf16 v[8:11], a[104:107], v[60:63], v[8:11]
    buffer_load_dwordx4 v1, s[8:11], s37 offen offset:0 sc1 lds
    v_mfma_f32_16x16x32_bf16 v[12:15], a[108:111], v[60:63], v[12:15]
    ds_read_b128 v[44:47], v2 offset:17408
    v_mfma_f32_16x16x32_bf16 v[12:15], a[100:103], v[56:59], v[12:15]
    s_waitcnt lgkmcnt(2)
    v_mfma_f32_16x16x32_bf16 v[12:15], a[116:119], v[64:67], v[12:15]
    ds_read_b128 v[48:51], v2 offset:18432
    v_mfma_f32_16x16x32_bf16 v[12:15], a[124:127], v[68:71], v[12:15]
    buffer_load_dword v5, v4, s[4:7], s16 offen sc1
    v_mfma_f32_16x16x32_bf16 v[8:11], a[120:123], v[68:71], v[8:11]
    ds_read_b128 v[52:55], v2 offset:19456
    v_mfma_f32_16x16x32_bf16 v[8:11], a[112:115], v[64:67], v[8:11]
    s_waitcnt lgkmcnt(2)
    v_mfma_f32_16x16x32_bf16 v[8:11], a[128:131], v[40:43], v[8:11]
    ds_read_b128 v[56:59], v2 offset:20480
    v_mfma_f32_16x16x32_bf16 v[8:11], a[136:139], v[44:47], v[8:11]
    buffer_load_dwordx4 v1, s[8:11], s37 offen offset:1024 sc1 lds
    v_mfma_f32_16x16x32_bf16 v[12:15], a[140:143], v[44:47], v[12:15]
    ds_read_b128 v[60:63], v2 offset:21504
    v_mfma_f32_16x16x32_bf16 v[12:15], a[132:135], v[40:43], v[12:15]
    s_waitcnt lgkmcnt(2)
    v_mfma_f32_16x16x32_bf16 v[12:15], a[148:151], v[48:51], v[12:15]
    ds_read_b128 v[64:67], v2 offset:22528
    v_mfma_f32_16x16x32_bf16 v[12:15], a[156:159], v[52:55], v[12:15]
    buffer_load_dwordx4 v1, s[8:11], s37 offen offset:2048 sc1 lds
    v_mfma_f32_16x16x32_bf16 v[8:11], a[152:155], v[52:55], v[8:11]
    ds_read_b128 v[68:71], v2 offset:23552
    v_mfma_f32_16x16x32_bf16 v[8:11], a[144:147], v[48:51], v[8:11]
    s_waitcnt lgkmcnt(2)
    v_mfma_f32_16x16x32_bf16 v[8:11], a[160:163], v[56:59], v[8:11]
    ds_read_b128 v[40:43], v2 offset:24576
    v_mfma_f32_16x16x32_bf16 v[8:11], a[168:171], v[60:63], v[8:11]
    buffer_load_dwordx4 v1, s[8:11], s37 offen offset:3072 sc1 lds
    v_mfma_f32_16x16x32_bf16 v[12:15], a[172:175], v[60:63], v[12:15]
    ds_read_b128 v[44:47], v2 offset:25600
    s_add_u32 s32, s32, 1
    v_mfma_f32_16x16x32_bf16 v[12:15], a[164:167], v[56:59], v[12:15]
    s_waitcnt lgkmcnt(2)
    s_add_u32 s33, s33, 32768
    s_add_u32 s34, s34, 36864
    v_mfma_f32_16x16x32_bf16 v[12:15], a[180:183], v[64:67], v[12:15]
    ds_read_b128 v[48:51], v2 offset:26624
    v_mfma_f32_16x16x32_bf16 v[12:15], a[188:191], v[68:71], v[12:15]
    s_cmp_ge_u32 s34, 147456
    s_cselect_b32 s38, 147456, 0
    s_sub_u32 s34, s34, s38
    v_mfma_f32_16x16x32_bf16 v[8:11], a[184:187], v[68:71], v[8:11]
    ds_read_b128 v[52:55], v2 offset:27648
    v_mfma_f32_16x16x32_bf16 v[8:11], a[176:179], v[64:67], v[8:11]
    s_waitcnt lgkmcnt(2)
    buffer_load_dwordx4 v[98:101], v1, s[4:7], s40 offen sc1
    v_mfma_f32_16x16x32_bf16 v[8:11], a[192:195], v[40:43], v[8:11]
    ds_read_b128 v[56:59], v2 offset:28672
    s_add_u32 s40, s40, 34816
    v_mfma_f32_16x16x32_bf16 v[8:11], a[200:203], v[44:47], v[8:11]
    v_mfma_f32_16x16x32_bf16 v[12:15], a[204:207], v[44:47], v[12:15]
    ds_read_b128 v[60:63], v2 offset:29696
    v_mfma_f32_16x16x32_bf16 v[12:15], a[196:199], v[40:43], v[12:15]
    s_waitcnt lgkmcnt(2)
    v_mfma_f32_16x16x32_bf16 v[12:15], a[212:215], v[48:51], v[12:15]
    ds_read_b128 v[64:67], v2 offset:30720
    v_mfma_f32_16x16x32_bf16 v[12:15], a[220:223], v[52:55], v[12:15]
    s_waitcnt vmcnt(8)
    buffer_store_dword v6, v102, s[12:15], s17 offen sc1
    v_mfma_f32_16x16x32_bf16 v[8:11], a[216:219], v[52:55], v[8:11]
    ds_read_b128 v[68:71], v2 offset:31744
    s_mov_b32 s14, s6
    v_mfma_f32_16x16x32_bf16 v[8:11], a[208:211], v[48:51], v[8:11]
    s_waitcnt vmcnt(7) lgkmcnt(2)
    s_barrier
    v_mfma_f32_16x16x32_bf16 v[8:11], a[224:227], v[56:59], v[8:11]
    s_add_u32 s17, s17, 8192
    v_mfma_f32_16x16x32_bf16 v[8:11], a[232:235], v[60:63], v[8:11]
    v_mfma_f32_16x16x32_bf16 v[12:15], a[236:239], v[60:63], v[12:15]
    ds_read_b128 v[40:43], v3 offset:0
    v_mfma_f32_16x16x32_bf16 v[12:15], a[228:231], v[56:59], v[12:15]
    s_waitcnt lgkmcnt(1)
    v_mfma_f32_16x16x32_bf16 v[12:15], a[244:247], v[64:67], v[12:15]
    ds_read_b128 v[44:47], v3 offset:1024
    v_mfma_f32_16x16x32_bf16 v[12:15], a[252:255], v[68:71], v[12:15]
    v_mfma_f32_16x16x32_bf16 v[8:11], a[248:251], v[68:71], v[8:11]
    ds_read_b128 v[48:51], v3 offset:2048
    v_mfma_f32_16x16x32_bf16 v[8:11], a[240:243], v[64:67], v[8:11]
    v_mfma_f32_16x16x32_bf16 v[8:11], v[90:93], v[94:97], v[8:11]
    ds_read_b128 v[52:55], v3 offset:3072
    v_mfma_f32_16x16x32_bf16 v[12:15], v[88:91], v[94:97], v[12:15]
Lwo_body10:
    s_waitcnt lgkmcnt(2)
    v_mfma_f32_16x16x32_bf16 v[24:27], a[0:3], v[40:43], 0
    ds_read_b128 v[56:59], v3 offset:4096
    s_add_u32 m0, s34, 0
    v_mfma_f32_16x16x32_bf16 v[24:27], a[8:11], v[44:47], v[24:27]
    s_waitcnt vmcnt(5)
    v_cmp_gt_i32 vcc, s32, v5
    v_cvt_pk_bf16_f32 v72, v8, v9
    v_mfma_f32_16x16x32_bf16 v[28:31], a[12:15], v[44:47], 0
    ds_read_b128 v[60:63], v3 offset:5120
    v_cvt_pk_bf16_f32 v73, v10, v11
    v_mfma_f32_16x16x32_bf16 v[28:31], a[4:7], v[40:43], v[28:31]
    s_waitcnt lgkmcnt(2)
    s_and_b64 vcc, vcc, s[18:19]
    s_cbranch_scc1 Lwo_v11
    v_mfma_f32_16x16x32_bf16 v[28:31], a[20:23], v[48:51], v[28:31]
    ds_read_b128 v[64:67], v3 offset:6144
    v_cvt_pk_bf16_f32 v74, v12, v13
    v_mfma_f32_16x16x32_bf16 v[28:31], a[28:31], v[52:55], v[28:31]
    buffer_load_dwordx4 v1, s[8:11], s33 offen offset:0 sc1 lds
    v_mfma_f32_16x16x32_bf16 v[24:27], a[24:27], v[52:55], v[24:27]
    ds_read_b128 v[68:71], v3 offset:7168
    v_cvt_pk_bf16_f32 v75, v14, v15
    v_mfma_f32_16x16x32_bf16 v[24:27], a[16:19], v[48:51], v[24:27]
    s_waitcnt lgkmcnt(2)
    s_add_u32 s31, s31, 1
    v_mov_b32 v6, s31
    v_mfma_f32_16x16x32_bf16 v[80:83], v[72:75], v[72:75], 0
    s_add_u32 s35, s35, 36864
    s_cmp_eq_u32 s35, 147456
    s_cselect_b32 s35, 0, s35
    v_mfma_f32_16x16x32_bf16 v[76:79], v[84:87], v[72:75], 0
    buffer_store_dwordx4 v[72:75], v1, s[12:15], s36 offen sc1
    v_add_u32 v2, s35, v1
    v_mfma_f32_16x16x32_bf16 v[24:27], a[32:35], v[56:59], v[24:27]
    ds_read_b128 v[40:43], v3 offset:8192
    v_cndmask_b32 v80, v80, v81, s[44:45]
    v_mfma_f32_16x16x32_bf16 v[24:27], a[40:43], v[60:63], v[24:27]
    v_cndmask_b32 v82, v82, v83, s[44:45]
    v_mfma_f32_16x16x32_bf16 v[28:31], a[44:47], v[60:63], v[28:31]
    ds_read_b128 v[44:47], v3 offset:9216
    v_cndmask_b32 v77, v80, v82, s[46:47]
    v_mfma_f32_16x16x32_bf16 v[28:31], a[36:39], v[56:59], v[28:31]
    s_waitcnt lgkmcnt(2)
    buffer_load_dwordx4 v1, s[8:11], s33 offen offset:1024 sc1 lds
    v_mfma_f32_16x16x32_bf16 v[28:31], a[52:55], v[64:67], v[28:31]
    ds_read_b128 v[48:51], v3 offset:10240
    v_mfma_f32_16x16x32_bf16 v[28:31], a[60:63], v[68:71], v[28:31]
    buffer_store_dwordx2 v[76:77], v7, s[12:15], s36 offen offset:0 sc1
    s_add_u32 s36, s36, 36864
    v_mfma_f32_16x16x32_bf16 v[24:27], a[56:59], v[68:71], v[24:27]
    ds_read_b128 v[52:55], v3 offset:11264
    v_mfma_f32_16x16x32_bf16 v[24:27], a[48:51], v[64:67], v[24:27]
    s_waitcnt lgkmcnt(2)
    buffer_load_dwordx4 v1, s[8:11], s33 offen offset:2048 sc1 lds
    v_mfma_f32_16x16x32_bf16 v[24:27], a[64:67], v[40:43], v[24:27]
    ds_read_b128 v[56:59], v3 offset:12288
    v_mfma_f32_16x16x32_bf16 v[24:27], a[72:75], v[44:47], v[24:27]
    v_mfma_f32_16x16x32_bf16 v[28:31], a[76:79], v[44:47], v[28:31]
    ds_read_b128 v[60:63], v3 offset:13312
    v_mfma_f32_16x16x32_bf16 v[28:31], a[68:71], v[40:43], v[28:31]
    s_waitcnt lgkmcnt(2)
    buffer_load_dwordx4 v1, s[8:11], s33 offen offset:3072 sc1 lds
    v_mfma_f32_16x16x32_bf16 v[28:31], a[84:87], v[48:51], v[28:31]
    ds_read_b128 v[64:67], v3 offset:14336
    s_waitcnt vmcnt(8)
    v_mfma_f32_16x16x32_bf16 v[28:31], a[92:95], v[52:55], v[28:31]
    s_barrier
    v_mfma_f32_16x16x32_bf16 v[24:27], a[88:91], v[52:55], v[24:27]
    ds_read_b128 v[68:71], v3 offset:15360
    s_add_u32 s16, s16, 8192
    v_mfma_f32_16x16x32_bf16 v[24:27], a[80:83], v[48:51], v[24:27]
    s_waitcnt lgkmcnt(2)
    s_add_u32 m0, s34, s3
    s_add_u32 s37, s33, s3
    v_mfma_f32_16x16x32_bf16 v[24:27], a[96:99], v[56:59], v[24:27]
    ds_read_b128 v[40:43], v3 offset:16384
    v_mfma_f32_16x16x32_bf16 v[24:27], a[104:107], v[60:63], v[24:27]
    buffer_load_dwordx4 v1, s[8:11], s37 offen offset:0 sc1 lds
    v_mfma_f32_16x16x32_bf16 v[28:31], a[108:111], v[60:63], v[28:31]
    ds_read_b128 v[44:47], v3 offset:17408
    v_mfma_f32_16x16x32_bf16 v[28:31], a[100:103], v[56:59], v[28:31]
    s_waitcnt lgkmcnt(2)
    v_mfma_f32_16x16x32_bf16 v[28:31], a[116:119], v[64:67], v[28:31]
    ds_read_b128 v[48:51], v3 offset:18432
    v_mfma_f32_16x16x32_bf16 v[28:31], a[124:127], v[68:71], v[28:31]
    buffer_load_dword v5, v4, s[4:7], s16 offen sc1
    v_mfma_f32_16x16x32_bf16 v[24:27], a[120:123], v[68:71], v[24:27]
    ds_read_b128 v[52:55], v3 offset:19456
    v_mfma_f32_16x16x32_bf16 v[24:27], a[112:115], v[64:67], v[24:27]
    s_waitcnt lgkmcnt(2)
    v_mfma_f32_16x16x32_bf16 v[24:27], a[128:131], v[40:43], v[24:27]
    ds_read_b128 v[56:59], v3 offset:20480
    v_mfma_f32_16x16x32_bf16 v[24:27], a[136:139], v[44:47], v[24:27]
    buffer_load_dwordx4 v1, s[8:11], s37 offen offset:1024 sc1 lds
    v_mfma_f32_16x16x32_bf16 v[28:31], a[140:143], v[44:47], v[28:31]
    ds_read_b128 v[60:63], v3 offset:21504
    v_mfma_f32_16x16x32_bf16 v[28:31], a[132:135], v[40:43], v[28:31]
    s_waitcnt lgkmcnt(2)
    v_mfma_f32_16x16x32_bf16 v[28:31], a[148:151], v[48:51], v[28:31]
    ds_read_b128 v[64:67], v3 offset:22528
    v_mfma_f32_16x16x32_bf16 v[28:31], a[156:159], v[52:55], v[28:31]
    buffer_load_dwordx4 v1, s[8:11], s37 offen offset:2048 sc1 lds
    v_mfma_f32_16x16x32_bf16 v[24:27], a[152:155], v[52:55], v[24:27]
    ds_read_b128 v[68:71], v3 offset:23552
    v_mfma_f32_16x16x32_bf16 v[24:27], a[144:147], v[48:51], v[24:27]
    s_waitcnt lgkmcnt(2)
    v_mfma_f32_16x16x32_bf16 v[24:27], a[160:163], v[56:59], v[24:27]
    ds_read_b128 v[40:43], v3 offset:24576
    v_mfma_f32_16x16x32_bf16 v[24:27], a[168:171], v[60:63], v[24:27]
    buffer_load_dwordx4 v1, s[8:11], s37 offen offset:3072 sc1 lds
    v_mfma_f32_16x16x32_bf16 v[28:31], a[172:175], v[60:63], v[28:31]
    ds_read_b128 v[44:47], v3 offset:25600
    s_add_u32 s32, s32, 1
    v_mfma_f32_16x16x32_bf16 v[28:31], a[164:167], v[56:59], v[28:31]
    s_waitcnt lgkmcnt(2)
    s_add_u32 s33, s33, 32768
    s_add_u32 s34, s34, 36864
    v_mfma_f32_16x16x32_bf16 v[28:31], a[180:183], v[64:67], v[28:31]
    ds_read_b128 v[48:51], v3 offset:26624
    v_mfma_f32_16x16x32_bf16 v[28:31], a[188:191], v[68:71], v[28:31]
    s_cmp_ge_u32 s34, 147456
    s_cselect_b32 s38, 147456, 0
    s_sub_u32 s34, s34, s38
    v_mfma_f32_16x16x32_bf16 v[24:27], a[184:187], v[68:71], v[24:27]
    ds_read_b128 v[52:55], v3 offset:27648
    v_mfma_f32_16x16x32_bf16 v[24:27], a[176:179], v[64:67], v[24:27]
    s_waitcnt lgkmcnt(2)
    buffer_load_dwordx4 v[94:97], v1, s[4:7], s40 offen sc1
    v_mfma_f32_16x16x32_bf16 v[24:27], a[192:195], v[40:43], v[24:27]
    ds_read_b128 v[56:59], v3 offset:28672
    s_add_u32 s40, s40, 34816
    v_mfma_f32_16x16x32_bf16 v[24:27], a[200:203], v[44:47], v[24:27]
    v_mfma_f32_16x16x32_bf16 v[28:31], a[204:207], v[44:47], v[28:31]
    ds_read_b128 v[60:63], v3 offset:29696
    v_mfma_f32_16x16x32_bf16 v[28:31], a[196:199], v[40:43], v[28:31]
    s_waitcnt lgkmcnt(2)
    v_mfma_f32_16x16x32_bf16 v[28:31], a[212:215], v[48:51], v[28:31]
    ds_read_b128 v[64:67], v3 offset:30720
    v_mfma_f32_16x16x32_bf16 v[28:31], a[220:223], v[52:55], v[28:31]
    s_waitcnt vmcnt(8)
    buffer_store_dword v6, v102, s[12:15], s17 offen sc1
    v_mfma_f32_16x16x32_bf16 v[24:27], a[216:219], v[52:55], v[24:27]
    ds_read_b128 v[68:71], v3 offset:31744
    s_mov_b32 s14, s6
    v_mfma_f32_16x16x32_bf16 v[24:27], a[208:211], v[48:51], v[24:27]
    s_waitcnt vmcnt(7) lgkmcnt(2)
    s_barrier
    v_mfma_f32_16x16x32_bf16 v[24:27], a[224:227], v[56:59], v[24:27]
    s_add_u32 s17, s17, 8192
    v_mfma_f32_16x16x32_bf16 v[24:27], a[232:235], v[60:63], v[24:27]
    v_mfma_f32_16x16x32_bf16 v[28:31], a[236:239], v[60:63], v[28:31]
    ds_read_b128 v[40:43], v2 offset:0
    v_mfma_f32_16x16x32_bf16 v[28:31], a[228:231], v[56:59], v[28:31]
    s_waitcnt lgkmcnt(1)
    v_mfma_f32_16x16x32_bf16 v[28:31], a[244:247], v[64:67], v[28:31]
    ds_read_b128 v[44:47], v2 offset:1024
    v_mfma_f32_16x16x32_bf16 v[28:31], a[252:255], v[68:71], v[28:31]
    v_mfma_f32_16x16x32_bf16 v[24:27], a[248:251], v[68:71], v[24:27]
    ds_read_b128 v[48:51], v2 offset:2048
    v_mfma_f32_16x16x32_bf16 v[24:27], a[240:243], v[64:67], v[24:27]
    v_mfma_f32_16x16x32_bf16 v[24:27], v[90:93], v[98:101], v[24:27]
    ds_read_b128 v[52:55], v2 offset:3072
    v_mfma_f32_16x16x32_bf16 v[28:31], v[88:91], v[98:101], v[28:31]
    s_cmp_lt_i32 s31, 63
    s_cbranch_scc1 Lwo_body00
    s_branch L_exit
Lwo_v01:
    v_mfma_f32_16x16x32_bf16 v[12:15], a[20:23], v[48:51], v[12:15]
    ds_read_b128 v[64:67], v2 offset:6144
    v_cvt_pk_bf16_f32 v74, v28, v29
    v_mfma_f32_16x16x32_bf16 v[12:15], a[28:31], v[52:55], v[12:15]
    buffer_load_dword v5, v4, s[4:7], s16 offen sc1
    v_mfma_f32_16x16x32_bf16 v[8:11], a[24:27], v[52:55], v[8:11]
    ds_read_b128 v[68:71], v2 offset:7168
    v_cvt_pk_bf16_f32 v75, v30, v31
    v_mfma_f32_16x16x32_bf16 v[8:11], a[16:19], v[48:51], v[8:11]
    s_waitcnt lgkmcnt(2)
    s_add_u32 s31, s31, 1
    v_mov_b32 v6, s31
    v_mfma_f32_16x16x32_bf16 v[80:83], v[72:75], v[72:75], 0
    s_add_u32 s35, s35, 36864
    s_cmp_eq_u32 s35, 147456
    s_cselect_b32 s35, 0, s35
    v_mfma_f32_16x16x32_bf16 v[76:79], v[84:87], v[72:75], 0
    buffer_store_dwordx4 v[72:75], v1, s[12:15], s36 offen sc1
    v_add_u32 v3, s35, v1
    v_mfma_f32_16x16x32_bf16 v[8:11], a[32:35], v[56:59], v[8:11]
    ds_read_b128 v[40:43], v2 offset:8192
    v_cndmask_b32 v80, v80, v81, s[44:45]
    v_mfma_f32_16x16x32_bf16 v[8:11], a[40:43], v[60:63], v[8:11]
    v_cndmask_b32 v82, v82, v83, s[44:45]
    v_mfma_f32_16x16x32_bf16 v[12:15], a[44:47], v[60:63], v[12:15]
    ds_read_b128 v[44:47], v2 offset:9216
    v_cndmask_b32 v77, v80, v82, s[46:47]
    v_mfma_f32_16x16x32_bf16 v[12:15], a[36:39], v[56:59], v[12:15]
    s_waitcnt lgkmcnt(2)
    buffer_store_dwordx2 v[76:77], v7, s[12:15], s36 offen offset:0 sc1
    v_mfma_f32_16x16x32_bf16 v[12:15], a[52:55], v[64:67], v[12:15]
    ds_read_b128 v[48:51], v2 offset:10240
    s_add_u32 s36, s36, 36864
    v_mfma_f32_16x16x32_bf16 v[12:15], a[60:63], v[68:71], v[12:15]
    v_mfma_f32_16x16x32_bf16 v[8:11], a[56:59], v[68:71], v[8:11]
    ds_read_b128 v[52:55], v2 offset:11264
    v_mfma_f32_16x16x32_bf16 v[8:11], a[48:51], v[64:67], v[8:11]
    s_waitcnt lgkmcnt(2)
    v_mfma_f32_16x16x32_bf16 v[8:11], a[64:67], v[40:43], v[8:11]
    ds_read_b128 v[56:59], v2 offset:12288
    v_mfma_f32_16x16x32_bf16 v[8:11], a[72:75], v[44:47], v[8:11]
    v_mfma_f32_16x16x32_bf16 v[12:15], a[76:79], v[44:47], v[12:15]
    ds_read_b128 v[60:63], v2 offset:13312
    v_mfma_f32_16x16x32_bf16 v[12:15], a[68:71], v[40:43], v[12:15]
    s_waitcnt lgkmcnt(2)
    v_mfma_f32_16x16x32_bf16 v[12:15], a[84:87], v[48:51], v[12:15]
    ds_read_b128 v[64:67], v2 offset:14336
    s_waitcnt vmcnt(5)
    v_mfma_f32_16x16x32_bf16 v[12:15], a[92:95], v[52:55], v[12:15]
    s_barrier
    v_mfma_f32_16x16x32_bf16 v[8:11], a[88:91], v[52:55], v[8:11]
    ds_read_b128 v[68:71], v2 offset:15360
    v_mfma_f32_16x16x32_bf16 v[8:11], a[80:83], v[48:51], v[8:11]
    s_waitcnt lgkmcnt(2)
    v_mfma_f32_16x16x32_bf16 v[8:11], a[96:99], v[56:59], v[8:11]
    ds_read_b128 v[40:43], v2 offset:16384
    v_mfma_f32_16x16x32_bf16 v[8:11], a[104:107], v[60:63], v[8:11]
    v_mfma_f32_16x16x32_bf16 v[12:15], a[108:111], v[60:63], v[12:15]
    ds_read_b128 v[44:47], v2 offset:17408
    v_mfma_f32_16x16x32_bf16 v[12:15], a[100:103], v[56:59], v[12:15]
    s_waitcnt lgkmcnt(2)
    v_mfma_f32_16x16x32_bf16 v[12:15], a[116:119], v[64:67], v[12:15]
    ds_read_b128 v[48:51], v2 offset:18432
    v_mfma_f32_16x16x32_bf16 v[12:15], a[124:127], v[68:71], v[12:15]
    v_mfma_f32_16x16x32_bf16 v[8:11], a[120:123], v[68:71], v[8:11]
    ds_read_b128 v[52:55], v2 offset:19456
    v_mfma_f32_16x16x32_bf16 v[8:11], a[112:115], v[64:67], v[8:11]
    s_waitcnt lgkmcnt(2)
    v_mfma_f32_16x16x32_bf16 v[8:11], a[128:131], v[40:43], v[8:11]
    ds_read_b128 v[56:59], v2 offset:20480
    v_mfma_f32_16x16x32_bf16 v[8:11], a[136:139], v[44:47], v[8:11]
    s_waitcnt vmcnt(2)
    v_cmp_gt_i32 vcc, s32, v5
    v_mfma_f32_16x16x32_bf16 v[12:15], a[140:143], v[44:47], v[12:15]
    ds_read_b128 v[60:63], v2 offset:21504
    v_mfma_f32_16x16x32_bf16 v[12:15], a[132:135], v[40:43], v[12:15]
    s_waitcnt lgkmcnt(2)
    s_and_b64 vcc, vcc, s[18:19]
    s_cbranch_scc1 Lwo_v02
    v_mfma_f32_16x16x32_bf16 v[12:15], a[148:151], v[48:51], v[12:15]
    ds_read_b128 v[64:67], v2 offset:22528
    v_mfma_f32_16x16x32_bf16 v[12:15], a[156:159], v[52:55], v[12:15]
    buffer_load_dwordx4 v1, s[8:11], s33 offen offset:0 sc1 lds
    v_mfma_f32_16x16x32_bf16 v[8:11], a[152:155], v[52:55], v[8:11]
    ds_read_b128 v[68:71], v2 offset:23552
    v_mfma_f32_16x16x32_bf16 v[8:11], a[144:147], v[48:51], v[8:11]
    s_waitcnt lgkmcnt(2)
    v_mfma_f32_16x16x32_bf16 v[8:11], a[160:163], v[56:59], v[8:11]
    ds_read_b128 v[40:43], v2 offset:24576
    v_mfma_f32_16x16x32_bf16 v[8:11], a[168:171], v[60:63], v[8:11]
    buffer_load_dwordx4 v1, s[8:11], s33 offen offset:1024 sc1 lds
    v_mfma_f32_16x16x32_bf16 v[12:15], a[172:175], v[60:63], v[12:15]
    ds_read_b128 v[44:47], v2 offset:25600
    v_mfma_f32_16x16x32_bf16 v[12:15], a[164:167], v[56:59], v[12:15]
    s_waitcnt lgkmcnt(2)
    v_mfma_f32_16x16x32_bf16 v[12:15], a[180:183], v[64:67], v[12:15]
    ds_read_b128 v[48:51], v2 offset:26624
    v_mfma_f32_16x16x32_bf16 v[12:15], a[188:191], v[68:71], v[12:15]
    buffer_load_dwordx4 v1, s[8:11], s33 offen offset:2048 sc1 lds
    v_mfma_f32_16x16x32_bf16 v[8:11], a[184:187], v[68:71], v[8:11]
    ds_read_b128 v[52:55], v2 offset:27648
    v_mfma_f32_16x16x32_bf16 v[8:11], a[176:179], v[64:67], v[8:11]
    s_waitcnt lgkmcnt(2)
    v_mfma_f32_16x16x32_bf16 v[8:11], a[192:195], v[40:43], v[8:11]
    ds_read_b128 v[56:59], v2 offset:28672
    v_mfma_f32_16x16x32_bf16 v[8:11], a[200:203], v[44:47], v[8:11]
    buffer_load_dwordx4 v1, s[8:11], s33 offen offset:3072 sc1 lds
    v_mfma_f32_16x16x32_bf16 v[12:15], a[204:207], v[44:47], v[12:15]
    ds_read_b128 v[60:63], v2 offset:29696
    s_add_u32 s16, s16, 8192
    v_mfma_f32_16x16x32_bf16 v[12:15], a[196:199], v[40:43], v[12:15]
    s_waitcnt vmcnt(4) lgkmcnt(2)
    buffer_store_dword v6, v102, s[12:15], s17 offen sc1
    v_mfma_f32_16x16x32_bf16 v[12:15], a[212:215], v[48:51], v[12:15]
    ds_read_b128 v[64:67], v2 offset:30720
    s_add_u32 m0, s34, s3
    v_mfma_f32_16x16x32_bf16 v[12:15], a[220:223], v[52:55], v[12:15]
    buffer_load_dword v5, v4, s[4:7], s16 offen sc1
    v_mfma_f32_16x16x32_bf16 v[8:11], a[216:219], v[52:55], v[8:11]
    ds_read_b128 v[68:71], v2 offset:31744
    s_add_u32 s37, s33, s3
    v_mfma_f32_16x16x32_bf16 v[8:11], a[208:211], v[48:51], v[8:11]
    s_waitcnt vmcnt(2) lgkmcnt(2)
    s_barrier
    v_mfma_f32_16x16x32_bf16 v[8:11], a[224:227], v[56:59], v[8:11]
    s_mov_b32 s14, s6
    s_add_u32 s17, s17, 8192
    v_mfma_f32_16x16x32_bf16 v[8:11], a[232:235], v[60:63], v[8:11]
    buffer_load_dwordx4 v1, s[8:11], s37 offen offset:0 sc1 lds
    v_mfma_f32_16x16x32_bf16 v[12:15], a[236:239], v[60:63], v[12:15]
    ds_read_b128 v[40:43], v3 offset:0
    v_mfma_f32_16x16x32_bf16 v[12:15], a[228:231], v[56:59], v[12:15]
    s_waitcnt lgkmcnt(1)
    v_mfma_f32_16x16x32_bf16 v[12:15], a[244:247], v[64:67], v[12:15]
    ds_read_b128 v[44:47], v3 offset:1024
    v_mfma_f32_16x16x32_bf16 v[12:15], a[252:255], v[68:71], v[12:15]
    buffer_load_dwordx4 v1, s[8:11], s37 offen offset:1024 sc1 lds
    v_mfma_f32_16x16x32_bf16 v[8:11], a[248:251], v[68:71], v[8:11]
    ds_read_b128 v[48:51], v3 offset:2048
    v_mfma_f32_16x16x32_bf16 v[8:11], a[240:243], v[64:67], v[8:11]
    v_mfma_f32_16x16x32_bf16 v[8:11], v[90:93], v[94:97], v[8:11]
    ds_read_b128 v[52:55], v3 offset:3072
    v_mfma_f32_16x16x32_bf16 v[12:15], v[88:91], v[94:97], v[12:15]
    buffer_load_dwordx4 v1, s[8:11], s37 offen offset:2048 sc1 lds
    buffer_load_dwordx4 v1, s[8:11], s37 offen offset:3072 sc1 lds
    s_add_u32 s32, s32, 1
    s_add_u32 s33, s33, 32768
    s_add_u32 s34, s34, 36864
    s_cmp_ge_u32 s34, 147456
    s_cselect_b32 s38, 147456, 0
    s_sub_u32 s34, s34, s38
    buffer_load_dwordx4 v[98:101], v1, s[4:7], s40 offen sc1
    s_add_u32 s40, s40, 34816
    s_mov_b32 s39, 0x40000000
    buffer_store_dword v6, v1, s[4:7], s39 offen
    s_cmp_ge_i32 s31, 63
    s_cbranch_scc1 L_exit
    s_branch Lwo_body10
Lwo_v02:
    v_mfma_f32_16x16x32_bf16 v[12:15], a[148:151], v[48:51], v[12:15]
    ds_read_b128 v[64:67], v2 offset:22528
    v_mfma_f32_16x16x32_bf16 v[12:15], a[156:159], v[52:55], v[12:15]
    v_mfma_f32_16x16x32_bf16 v[8:11], a[152:155], v[52:55], v[8:11]
    ds_read_b128 v[68:71], v2 offset:23552
    v_mfma_f32_16x16x32_bf16 v[8:11], a[144:147], v[48:51], v[8:11]
    s_waitcnt lgkmcnt(2)
    buffer_load_dwordx4 v[98:101], v1, s[4:7], s40 offen sc1
    v_mfma_f32_16x16x32_bf16 v[8:11], a[160:163], v[56:59], v[8:11]
    ds_read_b128 v[40:43], v2 offset:24576
    s_add_u32 s40, s40, 34816
    v_mfma_f32_16x16x32_bf16 v[8:11], a[168:171], v[60:63], v[8:11]
    v_mfma_f32_16x16x32_bf16 v[12:15], a[172:175], v[60:63], v[12:15]
    ds_read_b128 v[44:47], v2 offset:25600
    v_mfma_f32_16x16x32_bf16 v[12:15], a[164:167], v[56:59], v[12:15]
    s_waitcnt lgkmcnt(2)
    v_mfma_f32_16x16x32_bf16 v[12:15], a[180:183], v[64:67], v[12:15]
    ds_read_b128 v[48:51], v2 offset:26624
    v_mfma_f32_16x16x32_bf16 v[12:15], a[188:191], v[68:71], v[12:15]
    v_mfma_f32_16x16x32_bf16 v[8:11], a[184:187], v[68:71], v[8:11]
    ds_read_b128 v[52:55], v2 offset:27648
    v_mfma_f32_16x16x32_bf16 v[8:11], a[176:179], v[64:67], v[8:11]
    s_waitcnt lgkmcnt(2)
    v_mfma_f32_16x16x32_bf16 v[8:11], a[192:195], v[40:43], v[8:11]
    ds_read_b128 v[56:59], v2 offset:28672
    v_mfma_f32_16x16x32_bf16 v[8:11], a[200:203], v[44:47], v[8:11]
    v_mfma_f32_16x16x32_bf16 v[12:15], a[204:207], v[44:47], v[12:15]
    ds_read_b128 v[60:63], v2 offset:29696
    v_mfma_f32_16x16x32_bf16 v[12:15], a[196:199], v[40:43], v[12:15]
    s_waitcnt vmcnt(1) lgkmcnt(2)
    buffer_store_dword v6, v102, s[12:15], s17 offen sc1
    v_mfma_f32_16x16x32_bf16 v[12:15], a[212:215], v[48:51], v[12:15]
    ds_read_b128 v[64:67], v2 offset:30720
    s_mov_b32 s14, s6
    v_mfma_f32_16x16x32_bf16 v[12:15], a[220:223], v[52:55], v[12:15]
    buffer_load_dword v5, v4, s[4:7], s16 offen sc1
    v_mfma_f32_16x16x32_bf16 v[8:11], a[216:219], v[52:55], v[8:11]
    ds_read_b128 v[68:71], v2 offset:31744
    s_add_u32 s17, s17, 8192
    v_mfma_f32_16x16x32_bf16 v[8:11], a[208:211], v[48:51], v[8:11]
    s_waitcnt lgkmcnt(2)
    v_mfma_f32_16x16x32_bf16 v[8:11], a[224:227], v[56:59], v[8:11]
    v_mfma_f32_16x16x32_bf16 v[8:11], a[232:235], v[60:63], v[8:11]
    v_mfma_f32_16x16x32_bf16 v[12:15], a[236:239], v[60:63], v[12:15]
    v_mfma_f32_16x16x32_bf16 v[12:15], a[228:231], v[56:59], v[12:15]
    s_waitcnt lgkmcnt(0)
    v_mfma_f32_16x16x32_bf16 v[12:15], a[244:247], v[64:67], v[12:15]
    v_mfma_f32_16x16x32_bf16 v[12:15], a[252:255], v[68:71], v[12:15]
    v_mfma_f32_16x16x32_bf16 v[8:11], a[248:251], v[68:71], v[8:11]
    v_mfma_f32_16x16x32_bf16 v[8:11], a[240:243], v[64:67], v[8:11]
    v_mfma_f32_16x16x32_bf16 v[8:11], v[90:93], v[94:97], v[8:11]
    v_mfma_f32_16x16x32_bf16 v[12:15], v[88:91], v[94:97], v[12:15]
    s_nop 6
    v_cvt_pk_bf16_f32 v72, v8, v9
    v_cvt_pk_bf16_f32 v73, v10, v11
    v_cvt_pk_bf16_f32 v74, v12, v13
    v_cvt_pk_bf16_f32 v75, v14, v15
    s_nop 1
    v_mfma_f32_16x16x32_bf16 v[80:83], v[72:75], v[72:75], 0
    v_mfma_f32_16x16x32_bf16 v[76:79], v[84:87], v[72:75], 0
    buffer_store_dwordx4 v[72:75], v1, s[12:15], s36 offen sc1
    s_nop 5
    v_cndmask_b32 v80, v80, v81, s[44:45]
    v_cndmask_b32 v82, v82, v83, s[44:45]
    v_cndmask_b32 v77, v80, v82, s[46:47]
    buffer_store_dwordx2 v[76:77], v7, s[12:15], s36 offen offset:0 sc1
    s_add_u32 s54, s31, 1
    v_mov_b32 v6, s54
    s_waitcnt vmcnt(2)
    s_cmp_ge_i32 s31, 63
    s_cbranch_scc1 Lwo_late0
    v_cmp_gt_i32 vcc, s32, v5
    s_sub_u32 s43, s43, 1
    s_cmp_lt_i32 s43, 0
    s_cbranch_scc1 Lwo_rdy0
    s_and_b64 vcc, vcc, s[18:19]
    s_cbranch_scc0 Lwo_rdy0
Lwo_late0:
    buffer_load_dword v5, v4, s[4:7], s16 offen sc1
    s_waitcnt vmcnt(1)
    buffer_store_dword v6, v102, s[12:15], s17 offen sc1
    s_mov_b32 s14, 0
    s_cmp_ge_i32 s31, 63
    s_cbranch_scc1 L_exit
    s_waitcnt vmcnt(1)
    v_cmp_gt_i32 vcc, s32, v5
    s_sub_u32 s43, s43, 1
    s_cmp_lt_i32 s43, 0
    s_cbranch_scc1 Lwo_rdy0
    s_and_b64 vcc, vcc, s[18:19]
    s_cbranch_scc0 Lwo_rdy0
Lwo_spin0:
    buffer_load_dword v5, v4, s[4:7], s16 offen sc1
    s_waitcnt vmcnt(0)
    v_cmp_gt_i32 vcc, s32, v5
    s_sub_u32 s43, s43, 1
    s_cmp_lt_i32 s43, 0
    s_cbranch_scc1 Lwo_rdy0
    s_and_b64 vcc, vcc, s[18:19]
    s_cbranch_scc0 Lwo_rdy0
    s_sleep 8
    s_branch Lwo_spin0
Lwo_rdy0:
    s_add_u32 m0, s34, 0
    s_nop 0
    buffer_load_dwordx4 v1, s[8:11], s33 offen offset:0 sc1 lds
    buffer_load_dwordx4 v1, s[8:11], s33 offen offset:1024 sc1 lds
    buffer_load_dwordx4 v1, s[8:11], s33 offen offset:2048 sc1 lds
    buffer_load_dwordx4 v1, s[8:11], s33 offen offset:3072 sc1 lds
    s_add_u32 s16, s16, 8192
    buffer_load_dword v5, v4, s[4:7], s16 offen sc1
    s_add_u32 m0, s34, s3
    s_add_u32 s37, s33, s3
    buffer_load_dwordx4 v1, s[8:11], s37 offen offset:0 sc1 lds
    buffer_load_dwordx4 v1, s[8:11], s37 offen offset:1024 sc1 lds
    buffer_load_dwordx4 v1, s[8:11], s37 offen offset:2048 sc1 lds
    buffer_load_dwordx4 v1, s[8:11], s37 offen offset:3072 sc1 lds
    s_add_u32 s32, s32, 1
    s_add_u32 s33, s33, 32768
    s_add_u32 s34, s34, 36864
    s_cmp_ge_u32 s34, 147456
    s_cselect_b32 s38, 147456, 0
    s_sub_u32 s34, s34, s38
    s_waitcnt vmcnt(5)
    buffer_store_dword v6, v102, s[12:15], s17 offen sc1
    s_mov_b32 s39, 0x40000000
    buffer_store_dword v6, v1, s[4:7], s39 offen
Lwo_go0:
    s_mov_b32 s14, 0
    s_barrier
    ds_read_b128 v[40:43], v3 offset:0
    ds_read_b128 v[44:47], v3 offset:1024
    ds_read_b128 v[48:51], v3 offset:2048
    ds_read_b128 v[52:55], v3 offset:3072
    s_branch Lwo_body10
Lwo_v11:
    v_mfma_f32_16x16x32_bf16 v[28:31], a[20:23], v[48:51], v[28:31]
    ds_read_b128 v[64:67], v3 offset:6144
    v_cvt_pk_bf16_f32 v74, v12, v13
    v_mfma_f32_16x16x32_bf16 v[28:31], a[28:31], v[52:55], v[28:31]
    buffer_load_dword v5, v4, s[4:7], s16 offen sc1
    v_mfma_f32_16x16x32_bf16 v[24:27], a[24:27], v[52:55], v[24:27]
    ds_read_b128 v[68:71], v3 offset:7168
    v_cvt_pk_bf16_f32 v75, v14, v15
    v_mfma_f32_16x16x32_bf16 v[24:27], a[16:19], v[48:51], v[24:27]
    s_waitcnt lgkmcnt(2)
    s_add_u32 s31, s31, 1
    v_mov_b32 v6, s31
    v_mfma_f32_16x16x32_bf16 v[80:83], v[72:75], v[72:75], 0
    s_add_u32 s35, s35, 36864
    s_cmp_eq_u32 s35, 147456
    s_cselect_b32 s35, 0, s35
    v_mfma_f32_16x16x32_bf16 v[76:79], v[84:87], v[72:75], 0
    buffer_store_dwordx4 v[72:75], v1, s[12:15], s36 offen sc1
    v_add_u32 v2, s35, v1
    v_mfma_f32_16x16x32_bf16 v[24:27], a[32:35], v[56:59], v[24:27]
    ds_read_b128 v[40:43], v3 offset:8192
    v_cndmask_b32 v80, v80, v81, s[44:45]
    v_mfma_f32_16x16x32_bf16 v[24:27], a[40:43], v[60:63], v[24:27]
    v_cndmask_b32 v82, v82, v83, s[44:45]
    v_mfma_f32_16x16x32_bf16 v[28:31], a[44:47], v[60:63], v[28:31]
    ds_read_b128 v[44:47], v3 offset:9216
    v_cndmask_b32 v77, v80, v82, s[46:47]
    v_mfma_f32_16x16x32_bf16 v[28:31], a[36:39], v[56:59], v[28:31]
    s_waitcnt lgkmcnt(2)
    buffer_store_dwordx2 v[76:77], v7, s[12:15], s36 offen offset:0 sc1
    v_mfma_f32_16x16x32_bf16 v[28:31], a[52:55], v[64:67], v[28:31]
    ds_read_b128 v[48:51], v3 offset:10240
    s_add_u32 s36, s36, 36864
    v_mfma_f32_16x16x32_bf16 v[28:31], a[60:63], v[68:71], v[28:31]
    v_mfma_f32_16x16x32_bf16 v[24:27], a[56:59], v[68:71], v[24:27]
    ds_read_b128 v[52:55], v3 offset:11264
    v_mfma_f32_16x16x32_bf16 v[24:27], a[48:51], v[64:67], v[24:27]
    s_waitcnt lgkmcnt(2)
    v_mfma_f32_16x16x32_bf16 v[24:27], a[64:67], v[40:43], v[24:27]
    ds_read_b128 v[56:59], v3 offset:12288
    v_mfma_f32_16x16x32_bf16 v[24:27], a[72:75], v[44:47], v[24:27]
    v_mfma_f32_16x16x32_bf16 v[28:31], a[76:79], v[44:47], v[28:31]
    ds_read_b128 v[60:63], v3 offset:13312
    v_mfma_f32_16x16x32_bf16 v[28:31], a[68:71], v[40:43], v[28:31]
    s_waitcnt lgkmcnt(2)
    v_mfma_f32_16x16x32_bf16 v[28:31], a[84:87], v[48:51], v[28:31]
    ds_read_b128 v[64:67], v3 offset:14336
    s_waitcnt vmcnt(5)
    v_mfma_f32_16x16x32_bf16 v[28:31], a[92:95], v[52:55], v[28:31]
    s_barrier
    v_mfma_f32_16x16x32_bf16 v[24:27], a[88:91], v[52:55], v[24:27]
    ds_read_b128 v[68:71], v3 offset:15360
    v_mfma_f32_16x16x32_bf16 v[24:27], a[80:83], v[48:51], v[24:27]
    s_waitcnt lgkmcnt(2)
    v_mfma_f32_16x16x32_bf16 v[24:27], a[96:99], v[56:59], v[24:27]
    ds_read_b128 v[40:43], v3 offset:16384
    v_mfma_f32_16x16x32_bf16 v[24:27], a[104:107], v[60:63], v[24:27]
    v_mfma_f32_16x16x32_bf16 v[28:31], a[108:111], v[60:63], v[28:31]
    ds_read_b128 v[44:47], v3 offset:17408
    v_mfma_f32_16x16x32_bf16 v[28:31], a[100:103], v[56:59], v[28:31]
    s_waitcnt lgkmcnt(2)
    v_mfma_f32_16x16x32_bf16 v[28:31], a[116:119], v[64:67], v[28:31]
    ds_read_b128 v[48:51], v3 offset:18432
    v_mfma_f32_16x16x32_bf16 v[28:31], a[124:127], v[68:71], v[28:31]
    v_mfma_f32_16x16x32_bf16 v[24:27], a[120:123], v[68:71], v[24:27]
    ds_read_b128 v[52:55], v3 offset:19456
    v_mfma_f32_16x16x32_bf16 v[24:27], a[112:115], v[64:67], v[24:27]
    s_waitcnt lgkmcnt(2)
    v_mfma_f32_16x16x32_bf16 v[24:27], a[128:131], v[40:43], v[24:27]
    ds_read_b128 v[56:59], v3 offset:20480
    v_mfma_f32_16x16x32_bf16 v[24:27], a[136:139], v[44:47], v[24:27]
    s_waitcnt vmcnt(2)
    v_cmp_gt_i32 vcc, s32, v5
    v_mfma_f32_16x16x32_bf16 v[28:31], a[140:143], v[44:47], v[28:31]
    ds_read_b128 v[60:63], v3 offset:21504
    v_mfma_f32_16x16x32_bf16 v[28:31], a[132:135], v[40:43], v[28:31]
    s_waitcnt lgkmcnt(2)
    s_and_b64 vcc, vcc, s[18:19]
    s_cbranch_scc1 Lwo_v12
    v_mfma_f32_16x16x32_bf16 v[28:31], a[148:151], v[48:51], v[28:31]
    ds_read_b128 v[64:67], v3 offset:22528
    v_mfma_f32_16x16x32_bf16 v[28:31], a[156:159], v[52:55], v[28:31]
    buffer_load_dwordx4 v1, s[8:11], s33 offen offset:0 sc1 lds
    v_mfma_f32_16x16x32_bf16 v[24:27], a[152:155], v[52:55], v[24:27]
    ds_read_b128 v[68:71], v3 offset:23552
    v_mfma_f32_16x16x32_bf16 v[24:27], a[144:147], v[48:51], v[24:27]
    s_waitcnt lgkmcnt(2)
    v_mfma_f32_16x16x32_bf16 v[24:27], a[160:163], v[56:59], v[24:27]
    ds_read_b128 v[40:43], v3 offset:24576
    v_mfma_f32_16x16x32_bf16 v[24:27], a[168:171], v[60:63], v[24:27]
    buffer_load_dwordx4 v1, s[8:11], s33 offen offset:1024 sc1 lds
    v_mfma_f32_16x16x32_bf16 v[28:31], a[172:175], v[60:63], v[28:31]
    ds_read_b128 v[44:47], v3 offset:25600
    v_mfma_f32_16x16x32_bf16 v[28:31], a[164:167], v[56:59], v[28:31]
    s_waitcnt lgkmcnt(2)
    v_mfma_f32_16x16x32_bf16 v[28:31], a[180:183], v[64:67], v[28:31]
    ds_read_b128 v[48:51], v3 offset:26624
    v_mfma_f32_16x16x32_bf16 v[28:31], a[188:191], v[68:71], v[28:31]
    buffer_load_dwordx4 v1, s[8:11], s33 offen offset:2048 sc1 lds
    v_mfma_f32_16x16x32_bf16 v[24:27], a[184:187], v[68:71], v[24:27]
    ds_read_b128 v[52:55], v3 offset:27648
    v_mfma_f32_16x16x32_bf16 v[24:27], a[176:179], v[64:67], v[24:27]
    s_waitcnt lgkmcnt(2)
    v_mfma_f32_16x16x32_bf16 v[24:27], a[192:195], v[40:43], v[24:27]
    ds_read_b128 v[56:59], v3 offset:28672
    v_mfma_f32_16x16x32_bf16 v[24:27], a[200:203], v[44:47], v[24:27]
    buffer_load_dwordx4 v1, s[8:11], s33 offen offset:3072 sc1 lds
    v_mfma_f32_16x16x32_bf16 v[28:31], a[204:207], v[44:47], v[28:31]
    ds_read_b128 v[60:63], v3 offset:29696
    s_add_u32 s16, s16, 8192
    v_mfma_f32_16x16x32_bf16 v[28:31], a[196:199], v[40:43], v[28:31]
    s_waitcnt vmcnt(4) lgkmcnt(2)
    buffer_store_dword v6, v102, s[12:15], s17 offen sc1
    v_mfma_f32_16x16x32_bf16 v[28:31], a[212:215], v[48:51], v[28:31]
    ds_read_b128 v[64:67], v3 offset:30720
    s_add_u32 m0, s34, s3
    v_mfma_f32_16x16x32_bf16 v[28:31], a[220:223], v[52:55], v[28:31]
    buffer_load_dword v5, v4, s[4:7], s16 offen sc1
    v_mfma_f32_16x16x32_bf16 v[24:27], a[216:219], v[52:55], v[24:27]
    ds_read_b128 v[68:71], v3 offset:31744
    s_add_u32 s37, s33, s3
    v_mfma_f32_16x16x32_bf16 v[24:27], a[208:211], v[48:51], v[24:27]
    s_waitcnt vmcnt(2) lgkmcnt(2)
    s_barrier
    v_mfma_f32_16x16x32_bf16 v[24:27], a[224:227], v[56:59], v[24:27]
    s_mov_b32 s14, s6
    s_add_u32 s17, s17, 8192
    v_mfma_f32_16x16x32_bf16 v[24:27], a[232:235], v[60:63], v[24:27]
    buffer_load_dwordx4 v1, s[8:11], s37 offen offset:0 sc1 lds
    v_mfma_f32_16x16x32_bf16 v[28:31], a[236:239], v[60:63], v[28:31]
    ds_read_b128 v[40:43], v2 offset:0
    v_mfma_f32_16x16x32_bf16 v[28:31], a[228:231], v[56:59], v[28:31]
    s_waitcnt lgkmcnt(1)
    v_mfma_f32_16x16x32_bf16 v[28:31], a[244:247], v[64:67], v[28:31]
    ds_read_b128 v[44:47], v2 offset:1024
    v_mfma_f32_16x16x32_bf16 v[28:31], a[252:255], v[68:71], v[28:31]
    buffer_load_dwordx4 v1, s[8:11], s37 offen offset:1024 sc1 lds
    v_mfma_f32_16x16x32_bf16 v[24:27], a[248:251], v[68:71], v[24:27]
    ds_read_b128 v[48:51], v2 offset:2048
    v_mfma_f32_16x16x32_bf16 v[24:27], a[240:243], v[64:67], v[24:27]
    v_mfma_f32_16x16x32_bf16 v[24:27], v[90:93], v[98:101], v[24:27]
    ds_read_b128 v[52:55], v2 offset:3072
    v_mfma_f32_16x16x32_bf16 v[28:31], v[88:91], v[98:101], v[28:31]
    buffer_load_dwordx4 v1, s[8:11], s37 offen offset:2048 sc1 lds
    buffer_load_dwordx4 v1, s[8:11], s37 offen offset:3072 sc1 lds
    s_add_u32 s32, s32, 1
    s_add_u32 s33, s33, 32768
    s_add_u32 s34, s34, 36864
    s_cmp_ge_u32 s34, 147456
    s_cselect_b32 s38, 147456, 0
    s_sub_u32 s34, s34, s38
    buffer_load_dwordx4 v[94:97], v1, s[4:7], s40 offen sc1
    s_add_u32 s40, s40, 34816
    s_mov_b32 s39, 0x40000000
    buffer_store_dword v6, v1, s[4:7], s39 offen
    s_cmp_ge_i32 s31, 63
    s_cbranch_scc1 L_exit
    s_branch Lwo_body00
Lwo_v12:
    v_mfma_f32_16x16x32_bf16 v[28:31], a[148:151], v[48:51], v[28:31]
    ds_read_b128 v[64:67], v3 offset:22528
    v_mfma_f32_16x16x32_bf16 v[28:31], a[156:159], v[52:55], v[28:31]
    v_mfma_f32_16x16x32_bf16 v[24:27], a[152:155], v[52:55], v[24:27]
    ds_read_b128 v[68:71], v3 offset:23552
    v_mfma_f32_16x16x32_bf16 v[24:27], a[144:147], v[48:51], v[24:27]
    s_waitcnt lgkmcnt(2)
    buffer_load_dwordx4 v[94:97], v1, s[4:7], s40 offen sc1
    v_mfma_f32_16x16x32_bf16 v[24:27], a[160:163], v[56:59], v[24:27]
    ds_read_b128 v[40:43], v3 offset:24576
    s_add_u32 s40, s40, 34816
    v_mfma_f32_16x16x32_bf16 v[24:27], a[168:171], v[60:63], v[24:27]
    v_mfma_f32_16x16x32_bf16 v[28:31], a[172:175], v[60:63], v[28:31]
    ds_read_b128 v[44:47], v3 offset:25600
    v_mfma_f32_16x16x32_bf16 v[28:31], a[164:167], v[56:59], v[28:31]
    s_waitcnt lgkmcnt(2)
    v_mfma_f32_16x16x32_bf16 v[28:31], a[180:183], v[64:67], v[28:31]
    ds_read_b128 v[48:51], v3 offset:26624
    v_mfma_f32_16x16x32_bf16 v[28:31], a[188:191], v[68:71], v[28:31]
    v_mfma_f32_16x16x32_bf16 v[24:27], a[184:187], v[68:71], v[24:27]
    ds_read_b128 v[52:55], v3 offset:27648
    v_mfma_f32_16x16x32_bf16 v[24:27], a[176:179], v[64:67], v[24:27]
    s_waitcnt lgkmcnt(2)
    v_mfma_f32_16x16x32_bf16 v[24:27], a[192:195], v[40:43], v[24:27]
    ds_read_b128 v[56:59], v3 offset:28672
    v_mfma_f32_16x16x32_bf16 v[24:27], a[200:203], v[44:47], v[24:27]
    v_mfma_f32_16x16x32_bf16 v[28:31], a[204:207], v[44:47], v[28:31]
    ds_read_b128 v[60:63], v3 offset:29696
    v_mfma_f32_16x16x32_bf16 v[28:31], a[196:199], v[40:43], v[28:31]
    s_waitcnt vmcnt(1) lgkmcnt(2)
    buffer_store_dword v6, v102, s[12:15], s17 offen sc1
    v_mfma_f32_16x16x32_bf16 v[28:31], a[212:215], v[48:51], v[28:31]
    ds_read_b128 v[64:67], v3 offset:30720
    s_mov_b32 s14, s6
    v_mfma_f32_16x16x32_bf16 v[28:31], a[220:223], v[52:55], v[28:31]
    buffer_load_dword v5, v4, s[4:7], s16 offen sc1
    v_mfma_f32_16x16x32_bf16 v[24:27], a[216:219], v[52:55], v[24:27]
    ds_read_b128 v[68:71], v3 offset:31744
    s_add_u32 s17, s17, 8192
    v_mfma_f32_16x16x32_bf16 v[24:27], a[208:211], v[48:51], v[24:27]
    s_waitcnt lgkmcnt(2)
    v_mfma_f32_16x16x32_bf16 v[24:27], a[224:227], v[56:59], v[24:27]
    v_mfma_f32_16x16x32_bf16 v[24:27], a[232:235], v[60:63], v[24:27]
    v_mfma_f32_16x16x32_bf16 v[28:31], a[236:239], v[60:63], v[28:31]
    v_mfma_f32_16x16x32_bf16 v[28:31], a[228:231], v[56:59], v[28:31]
    s_waitcnt lgkmcnt(0)
    v_mfma_f32_16x16x32_bf16 v[28:31], a[244:247], v[64:67], v[28:31]
    v_mfma_f32_16x16x32_bf16 v[28:31], a[252:255], v[68:71], v[28:31]
    v_mfma_f32_16x16x32_bf16 v[24:27], a[248:251], v[68:71], v[24:27]
    v_mfma_f32_16x16x32_bf16 v[24:27], a[240:243], v[64:67], v[24:27]
    v_mfma_f32_16x16x32_bf16 v[24:27], v[90:93], v[98:101], v[24:27]
    v_mfma_f32_16x16x32_bf16 v[28:31], v[88:91], v[98:101], v[28:31]
    s_nop 6
    v_cvt_pk_bf16_f32 v72, v24, v25
    v_cvt_pk_bf16_f32 v73, v26, v27
    v_cvt_pk_bf16_f32 v74, v28, v29
    v_cvt_pk_bf16_f32 v75, v30, v31
    s_nop 1
    v_mfma_f32_16x16x32_bf16 v[80:83], v[72:75], v[72:75], 0
    v_mfma_f32_16x16x32_bf16 v[76:79], v[84:87], v[72:75], 0
    buffer_store_dwordx4 v[72:75], v1, s[12:15], s36 offen sc1
    s_nop 5
    v_cndmask_b32 v80, v80, v81, s[44:45]
    v_cndmask_b32 v82, v82, v83, s[44:45]
    v_cndmask_b32 v77, v80, v82, s[46:47]
    buffer_store_dwordx2 v[76:77], v7, s[12:15], s36 offen offset:0 sc1
    s_add_u32 s54, s31, 1
    v_mov_b32 v6, s54
    s_waitcnt vmcnt(2)
    s_cmp_ge_i32 s31, 63
    s_cbranch_scc1 Lwo_late1
    v_cmp_gt_i32 vcc, s32, v5
    s_sub_u32 s43, s43, 1
    s_cmp_lt_i32 s43, 0
    s_cbranch_scc1 Lwo_rdy1
    s_and_b64 vcc, vcc, s[18:19]
    s_cbranch_scc0 Lwo_rdy1
Lwo_late1:
    buffer_load_dword v5, v4, s[4:7], s16 offen sc1
    s_waitcnt vmcnt(1)
    buffer_store_dword v6, v102, s[12:15], s17 offen sc1
    s_mov_b32 s14, 0
    s_cmp_ge_i32 s31, 63
    s_cbranch_scc1 L_exit
    s_waitcnt vmcnt(1)
    v_cmp_gt_i32 vcc, s32, v5
    s_sub_u32 s43, s43, 1
    s_cmp_lt_i32 s43, 0
    s_cbranch_scc1 Lwo_rdy1
    s_and_b64 vcc, vcc, s[18:19]
    s_cbranch_scc0 Lwo_rdy1
Lwo_spin1:
    buffer_load_dword v5, v4, s[4:7], s16 offen sc1
    s_waitcnt vmcnt(0)
    v_cmp_gt_i32 vcc, s32, v5
    s_sub_u32 s43, s43, 1
    s_cmp_lt_i32 s43, 0
    s_cbranch_scc1 Lwo_rdy1
    s_and_b64 vcc, vcc, s[18:19]
    s_cbranch_scc0 Lwo_rdy1
    s_sleep 8
    s_branch Lwo_spin1
Lwo_rdy1:
    s_add_u32 m0, s34, 0
    s_nop 0
    buffer_load_dwordx4 v1, s[8:11], s33 offen offset:0 sc1 lds
    buffer_load_dwordx4 v1, s[8:11], s33 offen offset:1024 sc1 lds
    buffer_load_dwordx4 v1, s[8:11], s33 offen offset:2048 sc1 lds
    buffer_load_dwordx4 v1, s[8:11], s33 offen offset:3072 sc1 lds
    s_add_u32 s16, s16, 8192
    buffer_load_dword v5, v4, s[4:7], s16 offen sc1
    s_add_u32 m0, s34, s3
    s_add_u32 s37, s33, s3
    buffer_load_dwordx4 v1, s[8:11], s37 offen offset:0 sc1 lds
    buffer_load_dwordx4 v1, s[8:11], s37 offen offset:1024 sc1 lds
    buffer_load_dwordx4 v1, s[8:11], s37 offen offset:2048 sc1 lds
    buffer_load_dwordx4 v1, s[8:11], s37 offen offset:3072 sc1 lds
    s_add_u32 s32, s32, 1
    s_add_u32 s33, s33, 32768
    s_add_u32 s34, s34, 36864
    s_cmp_ge_u32 s34, 147456
    s_cselect_b32 s38, 147456, 0
    s_sub_u32 s34, s34, s38
    s_waitcnt vmcnt(5)
    buffer_store_dword v6, v102, s[12:15], s17 offen sc1
    s_mov_b32 s39, 0x40000000
    buffer_store_dword v6, v1, s[4:7], s39 offen
Lwo_go1:
    s_mov_b32 s14, 0
    s_barrier
    ds_read_b128 v[40:43], v2 offset:0
    ds_read_b128 v[44:47], v2 offset:1024
    ds_read_b128 v[48:51], v2 offset:2048
    ds_read_b128 v[52:55], v2 offset:3072
    s_branch Lwo_body00
Lffa_start:
    s_mov_b32 s12, s72
    s_mov_b32 s13, s73
    s_mov_b32 s14, 0x700000
    s_mov_b32 s15, 0x00020000
    v_lshrrev_b32 v24, 3, v0
    v_mul_u32_u24 v24, 7168, v24
    v_bfe_u32 v25, v0, 4, 2
    v_lshlrev_b32 v25, 1, v25
    v_and_b32 v26, 7, v0
    v_xor_b32 v25, v25, v26
    v_lshl_add_u32 v40, v25, 4, v24
    v_add_u32 v41, 56320, v40
    s_mul_i32 s86, s29, 0x180
    s_add_u32 s86, s86, 0xffffdc00
    s_mul_i32 s37, s30, 114688
    s_add_u32 s86, s86, s37
    s_lshl_b32 s87, s30, 11
    s_cmp_eq_u32 s29, 42
    s_cselect_b32 s88, 0x40000000, s86
    s_add_u32 m0, s87, 0
    s_add_u32 s37, s86, 0
    buffer_load_dwordx4 v40, s[12:15], s37 offen offset:0 lds
    buffer_load_dwordx4 v41, s[12:15], s37 offen offset:1024 lds
    s_add_u32 m0, s87, 8192
    s_add_u32 s37, s86, 128
    buffer_load_dwordx4 v40, s[12:15], s37 offen offset:0 lds
    buffer_load_dwordx4 v41, s[12:15], s37 offen offset:1024 lds
    s_add_u32 m0, s87, 16384
    s_add_u32 s37, s88, 256
    buffer_load_dwordx4 v40, s[12:15], s37 offen offset:0 lds
    buffer_load_dwordx4 v41, s[12:15], s37 offen offset:1024 lds
    s_add_u32 m0, s87, 24576
    s_add_u32 s37, s86, 458752
    buffer_load_dwordx4 v40, s[12:15], s37 offen offset:0 lds
    buffer_load_dwordx4 v41, s[12:15], s37 offen offset:1024 lds
    s_add_u32 m0, s87, 32768
    s_add_u32 s37, s86, 458880
    buffer_load_dwordx4 v40, s[12:15], s37 offen offset:0 lds
    buffer_load_dwordx4 v41, s[12:15], s37 offen offset:1024 lds
    s_add_u32 m0, s87, 40960
    s_add_u32 s37, s88, 459008
    buffer_load_dwordx4 v40, s[12:15], s37 offen offset:0 lds
    buffer_load_dwordx4 v41, s[12:15], s37 offen offset:1024 lds
    s_add_u32 m0, s87, 49152
    s_add_u32 s37, s86, 917504
    buffer_load_dwordx4 v40, s[12:15], s37 offen offset:0 lds
    buffer_load_dwordx4 v41, s[12:15], s37 offen offset:1024 lds
    s_add_u32 m0, s87, 57344
    s_add_u32 s37, s86, 917632
    buffer_load_dwordx4 v40, s[12:15], s37 offen offset:0 lds
    buffer_load_dwordx4 v41, s[12:15], s37 offen offset:1024 lds
    s_add_u32 m0, s87, 65536
    s_add_u32 s37, s88, 917760
    buffer_load_dwordx4 v40, s[12:15], s37 offen offset:0 lds
    buffer_load_dwordx4 v41, s[12:15], s37 offen offset:1024 lds
    s_add_u32 m0, s87, 73728
    s_add_u32 s37, s86, 1376256
    buffer_load_dwordx4 v40, s[12:15], s37 offen offset:0 lds
    buffer_load_dwordx4 v41, s[12:15], s37 offen offset:1024 lds
    s_add_u32 m0, s87, 81920
    s_add_u32 s37, s86, 1376384
    buffer_load_dwordx4 v40, s[12:15], s37 offen offset:0 lds
    buffer_load_dwordx4 v41, s[12:15], s37 offen offset:1024 lds
    s_add_u32 m0, s87, 90112
    s_add_u32 s37, s88, 1376512
    buffer_load_dwordx4 v40, s[12:15], s37 offen offset:0 lds
    buffer_load_dwordx4 v41, s[12:15], s37 offen offset:1024 lds
    s_add_u32 m0, s87, 98304
    s_add_u32 s37, s86, 1835008
    buffer_load_dwordx4 v40, s[12:15], s37 offen offset:0 lds
    buffer_load_dwordx4 v41, s[12:15], s37 offen offset:1024 lds
    s_add_u32 m0, s87, 106496
    s_add_u32 s37, s86, 1835136
    buffer_load_dwordx4 v40, s[12:15], s37 offen offset:0 lds
    buffer_load_dwordx4 v41, s[12:15], s37 offen offset:1024 lds
    s_add_u32 m0, s87, 114688
    s_add_u32 s37, s88, 1835264
    buffer_load_dwordx4 v40, s[12:15], s37 offen offset:0 lds
    buffer_load_dwordx4 v41, s[12:15], s37 offen offset:1024 lds
    v_bfe_u32 v24, v0, 3, 2
    v_and_b32 v25, 3, v0
    v_lshlrev_b32 v25, 3, v25
    v_lshrrev_b32 v26, 2, v0
    v_lshl_add_u32 v26, v26, 7, v25
    v_lshrrev_b32 v27, 5, v0
    v_lshl_add_u32 v27, v27, 10, v26
    s_lshr_b32 s37, s30, 1
    s_and_b32 s38, s30, 1
    s_lshl_b32 s38, s38, 1
    s_add_u32 s38, s38, 0
    s_lshl_b32 s37, s37, 13
    v_xor_b32 v28, s38, v24
    v_lshl_add_u32 v28, v28, 5, s37
    v_add_u32 v42, v28, v26
    v_add_u32 v46, v28, v27
    s_lshr_b32 s37, s30, 1
    s_and_b32 s38, s30, 1
    s_lshl_b32 s38, s38, 1
    s_add_u32 s38, s38, 1
    s_lshl_b32 s37, s37, 13
    v_xor_b32 v28, s38, v24
    v_lshl_add_u32 v28, v28, 5, s37
    v_add_u32 v43, v28, v26
    v_add_u32 v47, v28, v27
    s_mov_b32 s37, 2
    s_mov_b32 s38, s30
    s_lshl_b32 s37, s37, 13
    v_xor_b32 v28, s38, v24
    v_lshl_add_u32 v28, v28, 5, s37
    v_add_u32 v44, v28, v26
    v_add_u32 v48, v28, v27
    v_mov_b32 v28, 0x3f803f80
    v_mov_b32 v29, 0x3f803f80
    v_mov_b32 v30, 0x3f803f80
    v_mov_b32 v31, 0x3f803f80
    s_mov_b32 s20, s74
    s_mov_b32 s21, s75
    s_mov_b32 s22, 0x1c00
    s_mov_b32 s23, 0x00020000
    v_lshrrev_b32 v8, 4, v0
    v_lshlrev_b32 v8, 3, v8
    s_mul_i32 s37, s29, 0x180
    s_mul_i32 s53, s30, 0x40
    s_add_u32 s37, s37, s53
    s_add_u32 s37, s37, 0xffffdc00
    buffer_load_dwordx2 v[10:11], v8, s[20:23], s37 offen
    s_mul_i32 s37, s29, 0x180
    s_mul_i32 s53, s30, 0x40
    s_add_u32 s37, s37, s53
    s_add_u32 s37, s37, 0xffffdc20
    buffer_load_dwordx2 v[12:13], v8, s[20:23], s37 offen
    s_mul_i32 s37, s29, 0x180
    s_mul_i32 s53, s30, 0x20
    s_add_u32 s37, s37, s53
    s_add_u32 s37, s37, 0xffffdd00
    buffer_load_dwordx2 v[14:15], v8, s[20:23], s37 offen
    s_waitcnt vmcnt(0)
    v_lshlrev_b32 v68, 16, v10
    v_and_b32 v69, 0xffff0000, v10
    v_lshlrev_b32 v70, 16, v11
    v_and_b32 v71, 0xffff0000, v11
    v_lshlrev_b32 v72, 16, v12
    v_and_b32 v73, 0xffff0000, v12
    v_lshlrev_b32 v74, 16, v13
    v_and_b32 v75, 0xffff0000, v13
    v_lshlrev_b32 v76, 16, v14
    v_and_b32 v77, 0xffff0000, v14
    v_lshlrev_b32 v78, 16, v15
    v_and_b32 v79, 0xffff0000, v15
    s_mul_i32 s37, s28, 0x80000
    s_add_u32 s37, s37, 0x6000800
    v_min_u32 v4, 31, v0
    v_lshl_add_u32 v4, v4, 5, s37
    s_mov_b32 s32, 1
    s_mul_i32 s33, s28, 0x240000
    s_add_u32 s33, s33, 0x1200000
    s_mul_i32 s36, s28, 0x720000
    s_mul_i32 s53, s29, 0x1800
    s_add_u32 s36, s36, s53
    s_mul_i32 s53, s30, 0x400
    s_add_u32 s36, s36, s53
    s_add_u32 s36, s36, 0x1fbf800
    s_lshr_b32 s37, s30, 1
    s_sub_u32 s37, s37, s30
    s_add_u32 s37, s37, 4
    s_lshl_b32 s37, s37, 10
    s_and_b32 s38, s30, 1
    v_lshrrev_b32 v8, 5, v0
    v_cmp_eq_u32 vcc, s38, v8
    v_add_u32 v8, s37, v1
    v_mov_b32 v7, 0x40000000
    v_cndmask_b32 v7, v7, v8, vcc
    s_mov_b32 s31, -1
    s_mov_b32 s35, 0
    s_mov_b32 s16, 0
    v_mov_b32 v5, 0
    s_mul_i32 s17, s28, 0x80000
    s_mul_i32 s53, s29, 0x80
    s_add_u32 s17, s17, s53
    s_mul_i32 s53, s30, 0x20
    s_add_u32 s17, s17, s53
    s_add_u32 s17, s17, 0x5ffe000
    v_cmp_eq_u32 vcc, 0, v0
    v_mov_b32 v22, 0x40000000
    s_nop 0
    v_cndmask_b32 v22, v22, v0, vcc
    v_mov_b32 v2, v1
    s_mul_i32 s34, s30, 4096
    s_mul_i32 s3, s30, 0xfffff400
    s_add_u32 s3, s3, 0x8000
    s_add_u32 s41, s3, 4096
    s_add_u32 s33, s33, s34
    v_lshlrev_b32 v20, 3, v0
    s_mov_b64 s[18:19], 0xffffffff
    s_mov_b32 s19, 0
    v_mov_b32 v8, 0x40000000
    v_cndmask_b32 v4, v8, v4, s[18:19]
    v_add_u32 v12, 0, v42
    v_add_u32 v13, 0, v43
    v_add_u32 v14, 0, v44
    s_waitcnt vmcnt(24) lgkmcnt(0)
    s_barrier
    s_add_u32 m0, s87, 122880
    s_add_u32 s37, s86, 2293760
    buffer_load_dwordx4 v40, s[12:15], s37 offen offset:0 lds
    ds_read_b64_tr_b16 a[0:1], v12 offset:0
    ds_read_b64_tr_b16 a[2:3], v12 offset:2048
    ds_read_b64_tr_b16 a[4:5], v13 offset:0
    buffer_load_dwordx4 v41, s[12:15], s37 offen offset:1024 lds
    ds_read_b64_tr_b16 a[6:7], v13 offset:2048
    ds_read_b64_tr_b16 a[8:9], v14 offset:0
    ds_read_b64_tr_b16 a[10:11], v14 offset:2048
    s_add_u32 m0, s87, 131072
    s_add_u32 s37, s86, 2293888
    buffer_load_dwordx4 v40, s[12:15], s37 offen offset:0 lds
    ds_read_b64_tr_b16 a[12:13], v12 offset:4096
    ds_read_b64_tr_b16 a[14:15], v12 offset:6144
    ds_read_b64_tr_b16 a[16:17], v13 offset:4096
    buffer_load_dwordx4 v41, s[12:15], s37 offen offset:1024 lds
    ds_read_b64_tr_b16 a[18:19], v13 offset:6144
    ds_read_b64_tr_b16 a[20:21], v14 offset:4096
    ds_read_b64_tr_b16 a[22:23], v14 offset:6144
    s_add_u32 m0, s87, 139264
    s_add_u32 s37, s88, 2294016
    buffer_load_dwordx4 v40, s[12:15], s37 offen offset:0 lds
    v_add_u32 v16, 24576, v42
    v_add_u32 v17, 24576, v43
    v_add_u32 v18, 24576, v44
    buffer_load_dwordx4 v41, s[12:15], s37 offen offset:1024 lds
    s_waitcnt vmcnt(24) lgkmcnt(0)
    s_barrier
    s_add_u32 m0, s87, 0
    s_add_u32 s37, s86, 2752512
    buffer_load_dwordx4 v40, s[12:15], s37 offen offset:0 lds
    ds_read_b64_tr_b16 a[24:25], v16 offset:0
    ds_read_b64_tr_b16 a[26:27], v16 offset:2048
    ds_read_b64_tr_b16 a[28:29], v17 offset:0
    ds_read_b64_tr_b16 a[30:31], v17 offset:2048
    buffer_load_dwordx4 v41, s[12:15], s37 offen offset:1024 lds
    ds_read_b64_tr_b16 a[32:33], v18 offset:0
    ds_read_b64_tr_b16 a[34:35], v18 offset:2048
    ds_read_b64_tr_b16 a[36:37], v16 offset:4096
    ds_read_b64_tr_b16 a[38:39], v16 offset:6144
    s_add_u32 m0, s87, 8192
    s_add_u32 s37, s86, 2752640
    buffer_load_dwordx4 v40, s[12:15], s37 offen offset:0 lds
    ds_read_b64_tr_b16 a[40:41], v17 offset:4096
    ds_read_b64_tr_b16 a[42:43], v17 offset:6144
    ds_read_b64_tr_b16 a[44:45], v18 offset:4096
    ds_read_b64_tr_b16 a[46:47], v18 offset:6144
    buffer_load_dwordx4 v41, s[12:15], s37 offen offset:1024 lds
    v_mfma_f32_16x16x32_bf16 v[56:59], a[0:3], v[28:31], 0
    v_mfma_f32_16x16x32_bf16 v[60:63], a[4:7], v[28:31], 0
    v_mfma_f32_16x16x32_bf16 v[64:67], a[8:11], v[28:31], 0
    v_mfma_f32_16x16x32_bf16 v[56:59], a[12:15], v[28:31], v[56:59]
    s_add_u32 m0, s87, 16384
    s_add_u32 s37, s88, 2752768
    buffer_load_dwordx4 v40, s[12:15], s37 offen offset:0 lds
    v_mfma_f32_16x16x32_bf16 v[60:63], a[16:19], v[28:31], v[60:63]
    v_mfma_f32_16x16x32_bf16 v[64:67], a[20:23], v[28:31], v[64:67]
    v_add_u32 v12, 49152, v42
    v_add_u32 v13, 49152, v43
    buffer_load_dwordx4 v41, s[12:15], s37 offen offset:1024 lds
    v_add_u32 v14, 49152, v44
    s_waitcnt vmcnt(24) lgkmcnt(0)
    s_barrier
    s_add_u32 m0, s87, 24576
    s_add_u32 s37, s86, 3211264
    buffer_load_dwordx4 v40, s[12:15], s37 offen offset:0 lds
    ds_read_b64_tr_b16 a[48:49], v12 offset:0
    ds_read_b64_tr_b16 a[50:51], v12 offset:2048
    ds_read_b64_tr_b16 a[52:53], v13 offset:0
    ds_read_b64_tr_b16 a[54:55], v13 offset:2048
    buffer_load_dwordx4 v41, s[12:15], s37 offen offset:1024 lds
    ds_read_b64_tr_b16 a[56:57], v14 offset:0
    ds_read_b64_tr_b16 a[58:59], v14 offset:2048
    ds_read_b64_tr_b16 a[60:61], v12 offset:4096
    ds_read_b64_tr_b16 a[62:63], v12 offset:6144
    s_add_u32 m0, s87, 32768
    s_add_u32 s37, s86, 3211392
    buffer_load_dwordx4 v40, s[12:15], s37 offen offset:0 lds
    ds_read_b64_tr_b16 a[64:65], v13 offset:4096
    ds_read_b64_tr_b16 a[66:67], v13 offset:6144
    ds_read_b64_tr_b16 a[68:69], v14 offset:4096
    ds_read_b64_tr_b16 a[70:71], v14 offset:6144
    buffer_load_dwordx4 v41, s[12:15], s37 offen offset:1024 lds
    v_mfma_f32_16x16x32_bf16 v[56:59], a[24:27], v[28:31], v[56:59]
    v_mfma_f32_16x16x32_bf16 v[60:63], a[28:31], v[28:31], v[60:63]
    v_mfma_f32_16x16x32_bf16 v[64:67], a[32:35], v[28:31], v[64:67]
    v_mfma_f32_16x16x32_bf16 v[56:59], a[36:39], v[28:31], v[56:59]
    s_add_u32 m0, s87, 40960
    s_add_u32 s37, s88, 3211520
    buffer_load_dwordx4 v40, s[12:15], s37 offen offset:0 lds
    v_mfma_f32_16x16x32_bf16 v[60:63], a[40:43], v[28:31], v[60:63]
    v_mfma_f32_16x16x32_bf16 v[64:67], a[44:47], v[28:31], v[64:67]
    v_add_u32 v16, 73728, v42
    v_add_u32 v17, 73728, v43
    buffer_load_dwordx4 v41, s[12:15], s37 offen offset:1024 lds
    v_add_u32 v18, 73728, v44
    s_waitcnt vmcnt(24) lgkmcnt(0)
    s_barrier
    s_add_u32 m0, s87, 49152
    s_add_u32 s37, s86, 3670016
    buffer_load_dwordx4 v40, s[12:15], s37 offen offset:0 lds
    ds_read_b64_tr_b16 a[72:73], v16 offset:0
    ds_read_b64_tr_b16 a[74:75], v16 offset:2048
    ds_read_b64_tr_b16 a[76:77], v17 offset:0
    ds_read_b64_tr_b16 a[78:79], v17 offset:2048
    buffer_load_dwordx4 v41, s[12:15], s37 offen offset:1024 lds
    ds_read_b64_tr_b16 a[80:81], v18 offset:0
    ds_read_b64_tr_b16 a[82:83], v18 offset:2048
    ds_read_b64_tr_b16 a[84:85], v16 offset:4096
    ds_read_b64_tr_b16 a[86:87], v16 offset:6144
    s_add_u32 m0, s87, 57344
    s_add_u32 s37, s86, 3670144
    buffer_load_dwordx4 v40, s[12:15], s37 offen offset:0 lds
    ds_read_b64_tr_b16 a[88:89], v17 offset:4096
    ds_read_b64_tr_b16 a[90:91], v17 offset:6144
    ds_read_b64_tr_b16 a[92:93], v18 offset:4096
    ds_read_b64_tr_b16 a[94:95], v18 offset:6144
    buffer_load_dwordx4 v41, s[12:15], s37 offen offset:1024 lds
    v_mfma_f32_16x16x32_bf16 v[56:59], a[48:51], v[28:31], v[56:59]
    v_mfma_f32_16x16x32_bf16 v[60:63], a[52:55], v[28:31], v[60:63]
    v_mfma_f32_16x16x32_bf16 v[64:67], a[56:59], v[28:31], v[64:67]
    v_mfma_f32_16x16x32_bf16 v[56:59], a[60:63], v[28:31], v[56:59]
    s_add_u32 m0, s87, 65536
    s_add_u32 s37, s88, 3670272
    buffer_load_dwordx4 v40, s[12:15], s37 offen offset:0 lds
    v_mfma_f32_16x16x32_bf16 v[60:63], a[64:67], v[28:31], v[60:63]
    v_mfma_f32_16x16x32_bf16 v[64:67], a[68:71], v[28:31], v[64:67]
    v_add_u32 v12, 98304, v42
    v_add_u32 v13, 98304, v43
    buffer_load_dwordx4 v41, s[12:15], s37 offen offset:1024 lds
    v_add_u32 v14, 98304, v44
    s_waitcnt vmcnt(24) lgkmcnt(0)
    s_barrier
    s_add_u32 m0, s87, 73728
    s_add_u32 s37, s86, 4128768
    buffer_load_dwordx4 v40, s[12:15], s37 offen offset:0 lds
    ds_read_b64_tr_b16 a[96:97], v12 offset:0
    ds_read_b64_tr_b16 a[98:99], v12 offset:2048
    ds_read_b64_tr_b16 a[100:101], v13 offset:0
    ds_read_b64_tr_b16 a[102:103], v13 offset:2048
    buffer_load_dwordx4 v41, s[12:15], s37 offen offset:1024 lds
    ds_read_b64_tr_b16 a[104:105], v14 offset:0
    ds_read_b64_tr_b16 a[106:107], v14 offset:2048
    ds_read_b64_tr_b16 a[108:109], v12 offset:4096
    ds_read_b64_tr_b16 a[110:111], v12 offset:6144
    s_add_u32 m0, s87, 81920
    s_add_u32 s37, s86, 4128896
    buffer_load_dwordx4 v40, s[12:15], s37 offen offset:0 lds
    ds_read_b64_tr_b16 a[112:113], v13 offset:4096
    ds_read_b64_tr_b16 a[114:115], v13 offset:6144
    ds_read_b64_tr_b16 a[116:117], v14 offset:4096
    ds_read_b64_tr_b16 a[118:119], v14 offset:6144
    buffer_load_dwordx4 v41, s[12:15], s37 offen offset:1024 lds
    v_mfma_f32_16x16x32_bf16 v[56:59], a[72:75], v[28:31], v[56:59]
    v_mfma_f32_16x16x32_bf16 v[60:63], a[76:79], v[28:31], v[60:63]
    v_mfma_f32_16x16x32_bf16 v[64:67], a[80:83], v[28:31], v[64:67]
    v_mfma_f32_16x16x32_bf16 v[56:59], a[84:87], v[28:31], v[56:59]
    s_add_u32 m0, s87, 90112
    s_add_u32 s37, s88, 4129024
    buffer_load_dwordx4 v40, s[12:15], s37 offen offset:0 lds
    v_mfma_f32_16x16x32_bf16 v[60:63], a[88:91], v[28:31], v[60:63]
    v_mfma_f32_16x16x32_bf16 v[64:67], a[92:95], v[28:31], v[64:67]
    v_add_u32 v16, 122880, v42
    v_add_u32 v17, 122880, v43
    buffer_load_dwordx4 v41, s[12:15], s37 offen offset:1024 lds
    v_add_u32 v18, 122880, v44
    s_waitcnt vmcnt(24) lgkmcnt(0)
    s_barrier
    s_add_u32 m0, s87, 98304
    s_add_u32 s37, s86, 4587520
    buffer_load_dwordx4 v40, s[12:15], s37 offen offset:0 lds
    ds_read_b64_tr_b16 a[120:121], v16 offset:0
    ds_read_b64_tr_b16 a[122:123], v16 offset:2048
    ds_read_b64_tr_b16 a[124:125], v17 offset:0
    ds_read_b64_tr_b16 a[126:127], v17 offset:2048
    buffer_load_dwordx4 v41, s[12:15], s37 offen offset:1024 lds
    ds_read_b64_tr_b16 a[128:129], v18 offset:0
    ds_read_b64_tr_b16 a[130:131], v18 offset:2048
    ds_read_b64_tr_b16 a[132:133], v16 offset:4096
    ds_read_b64_tr_b16 a[134:135], v16 offset:6144
    s_add_u32 m0, s87, 106496
    s_add_u32 s37, s86, 4587648
    buffer_load_dwordx4 v40, s[12:15], s37 offen offset:0 lds
    ds_read_b64_tr_b16 a[136:137], v17 offset:4096
    ds_read_b64_tr_b16 a[138:139], v17 offset:6144
    ds_read_b64_tr_b16 a[140:141], v18 offset:4096
    ds_read_b64_tr_b16 a[142:143], v18 offset:6144
    buffer_load_dwordx4 v41, s[12:15], s37 offen offset:1024 lds
    v_mfma_f32_16x16x32_bf16 v[56:59], a[96:99], v[28:31], v[56:59]
    v_mfma_f32_16x16x32_bf16 v[60:63], a[100:103], v[28:31], v[60:63]
    v_mfma_f32_16x16x32_bf16 v[64:67], a[104:107], v[28:31], v[64:67]
    v_mfma_f32_16x16x32_bf16 v[56:59], a[108:111], v[28:31], v[56:59]
    s_add_u32 m0, s87, 114688
    s_add_u32 s37, s88, 4587776
    buffer_load_dwordx4 v40, s[12:15], s37 offen offset:0 lds
    v_mfma_f32_16x16x32_bf16 v[60:63], a[112:115], v[28:31], v[60:63]
    v_mfma_f32_16x16x32_bf16 v[64:67], a[116:119], v[28:31], v[64:67]
    v_add_u32 v12, 0, v42
    v_add_u32 v13, 0, v43
    buffer_load_dwordx4 v41, s[12:15], s37 offen offset:1024 lds
    v_add_u32 v14, 0, v44
    s_waitcnt vmcnt(24) lgkmcnt(0)
    s_barrier
    s_add_u32 m0, s87, 122880
    s_add_u32 s37, s86, 5046272
    buffer_load_dwordx4 v40, s[12:15], s37 offen offset:0 lds
    ds_read_b64_tr_b16 a[144:145], v12 offset:0
    ds_read_b64_tr_b16 a[146:147], v12 offset:2048
    ds_read_b64_tr_b16 a[148:149], v13 offset:0
    ds_read_b64_tr_b16 a[150:151], v13 offset:2048
    buffer_load_dwordx4 v41, s[12:15], s37 offen offset:1024 lds
    ds_read_b64_tr_b16 a[152:153], v14 offset:0
    ds_read_b64_tr_b16 a[154:155], v14 offset:2048
    ds_read_b64_tr_b16 a[156:157], v12 offset:4096
    ds_read_b64_tr_b16 a[158:159], v12 offset:6144
    s_add_u32 m0, s87, 131072
    s_add_u32 s37, s86, 5046400
    buffer_load_dwordx4 v40, s[12:15], s37 offen offset:0 lds
    ds_read_b64_tr_b16 a[160:161], v13 offset:4096
    ds_read_b64_tr_b16 a[162:163], v13 offset:6144
    ds_read_b64_tr_b16 a[164:165], v14 offset:4096
    ds_read_b64_tr_b16 a[166:167], v14 offset:6144
    buffer_load_dwordx4 v41, s[12:15], s37 offen offset:1024 lds
    v_mfma_f32_16x16x32_bf16 v[56:59], a[120:123], v[28:31], v[56:59]
    v_mfma_f32_16x16x32_bf16 v[60:63], a[124:127], v[28:31], v[60:63]
    v_mfma_f32_16x16x32_bf16 v[64:67], a[128:131], v[28:31], v[64:67]
    v_mfma_f32_16x16x32_bf16 v[56:59], a[132:135], v[28:31], v[56:59]
    s_add_u32 m0, s87, 139264
    s_add_u32 s37, s88, 5046528
    buffer_load_dwordx4 v40, s[12:15], s37 offen offset:0 lds
    v_mfma_f32_16x16x32_bf16 v[60:63], a[136:139], v[28:31], v[60:63]
    v_mfma_f32_16x16x32_bf16 v[64:67], a[140:143], v[28:31], v[64:67]
    v_add_u32 v16, 24576, v42
    v_add_u32 v17, 24576, v43
    buffer_load_dwordx4 v41, s[12:15], s37 offen offset:1024 lds
    v_add_u32 v18, 24576, v44
    s_waitcnt vmcnt(24) lgkmcnt(0)
    s_barrier
    s_add_u32 m0, s87, 0
    s_add_u32 s37, s86, 5505024
    buffer_load_dwordx4 v40, s[12:15], s37 offen offset:0 lds
    ds_read_b64_tr_b16 a[168:169], v16 offset:0
    ds_read_b64_tr_b16 a[170:171], v16 offset:2048
    ds_read_b64_tr_b16 a[172:173], v17 offset:0
    ds_read_b64_tr_b16 a[174:175], v17 offset:2048
    buffer_load_dwordx4 v41, s[12:15], s37 offen offset:1024 lds
    ds_read_b64_tr_b16 a[176:177], v18 offset:0
    ds_read_b64_tr_b16 a[178:179], v18 offset:2048
    ds_read_b64_tr_b16 a[180:181], v16 offset:4096
    ds_read_b64_tr_b16 a[182:183], v16 offset:6144
    s_add_u32 m0, s87, 8192
    s_add_u32 s37, s86, 5505152
    buffer_load_dwordx4 v40, s[12:15], s37 offen offset:0 lds
    ds_read_b64_tr_b16 a[184:185], v17 offset:4096
    ds_read_b64_tr_b16 a[186:187], v17 offset:6144
    ds_read_b64_tr_b16 a[188:189], v18 offset:4096
    ds_read_b64_tr_b16 a[190:191], v18 offset:6144
    buffer_load_dwordx4 v41, s[12:15], s37 offen offset:1024 lds
    v_mfma_f32_16x16x32_bf16 v[56:59], a[144:147], v[28:31], v[56:59]
    v_mfma_f32_16x16x32_bf16 v[60:63], a[148:151], v[28:31], v[60:63]
    v_mfma_f32_16x16x32_bf16 v[64:67], a[152:155], v[28:31], v[64:67]
    v_mfma_f32_16x16x32_bf16 v[56:59], a[156:159], v[28:31], v[56:59]
    s_add_u32 m0, s87, 16384
    s_add_u32 s37, s88, 5505280
    buffer_load_dwordx4 v40, s[12:15], s37 offen offset:0 lds
    v_mfma_f32_16x16x32_bf16 v[60:63], a[160:163], v[28:31], v[60:63]
    v_mfma_f32_16x16x32_bf16 v[64:67], a[164:167], v[28:31], v[64:67]
    v_add_u32 v12, 49152, v42
    v_add_u32 v13, 49152, v43
    buffer_load_dwordx4 v41, s[12:15], s37 offen offset:1024 lds
    v_add_u32 v14, 49152, v44
    s_waitcnt vmcnt(24) lgkmcnt(0)
    s_barrier
    s_add_u32 m0, s87, 24576
    s_add_u32 s37, s86, 5963776
    buffer_load_dwordx4 v40, s[12:15], s37 offen offset:0 lds
    ds_read_b64_tr_b16 a[192:193], v12 offset:0
    ds_read_b64_tr_b16 a[194:195], v12 offset:2048
    ds_read_b64_tr_b16 a[196:197], v13 offset:0
    ds_read_b64_tr_b16 a[198:199], v13 offset:2048
    buffer_load_dwordx4 v41, s[12:15], s37 offen offset:1024 lds
    ds_read_b64_tr_b16 a[200:201], v14 offset:0
    ds_read_b64_tr_b16 a[202:203], v14 offset:2048
    ds_read_b64_tr_b16 a[204:205], v12 offset:4096
    ds_read_b64_tr_b16 a[206:207], v12 offset:6144
    s_add_u32 m0, s87, 32768
    s_add_u32 s37, s86, 5963904
    buffer_load_dwordx4 v40, s[12:15], s37 offen offset:0 lds
    ds_read_b64_tr_b16 a[208:209], v13 offset:4096
    ds_read_b64_tr_b16 a[210:211], v13 offset:6144
    ds_read_b64_tr_b16 a[212:213], v14 offset:4096
    ds_read_b64_tr_b16 a[214:215], v14 offset:6144
    buffer_load_dwordx4 v41, s[12:15], s37 offen offset:1024 lds
    v_mfma_f32_16x16x32_bf16 v[56:59], a[168:171], v[28:31], v[56:59]
    v_mfma_f32_16x16x32_bf16 v[60:63], a[172:175], v[28:31], v[60:63]
    v_mfma_f32_16x16x32_bf16 v[64:67], a[176:179], v[28:31], v[64:67]
    v_mfma_f32_16x16x32_bf16 v[56:59], a[180:183], v[28:31], v[56:59]
    s_add_u32 m0, s87, 40960
    s_add_u32 s37, s88, 5964032
    buffer_load_dwordx4 v40, s[12:15], s37 offen offset:0 lds
    v_mfma_f32_16x16x32_bf16 v[60:63], a[184:187], v[28:31], v[60:63]
    v_mfma_f32_16x16x32_bf16 v[64:67], a[188:191], v[28:31], v[64:67]
    v_add_u32 v16, 73728, v42
    v_add_u32 v17, 73728, v43
    buffer_load_dwordx4 v41, s[12:15], s37 offen offset:1024 lds
    v_add_u32 v18, 73728, v44
    s_waitcnt vmcnt(24) lgkmcnt(0)
    s_barrier
    s_add_u32 m0, s87, 49152
    s_add_u32 s37, s86, 6422528
    buffer_load_dwordx4 v40, s[12:15], s37 offen offset:0 lds
    ds_read_b64_tr_b16 a[216:217], v16 offset:0
    ds_read_b64_tr_b16 a[218:219], v16 offset:2048
    ds_read_b64_tr_b16 a[220:221], v17 offset:0
    ds_read_b64_tr_b16 a[222:223], v17 offset:2048
    buffer_load_dwordx4 v41, s[12:15], s37 offen offset:1024 lds
    ds_read_b64_tr_b16 a[224:225], v18 offset:0
    ds_read_b64_tr_b16 a[226:227], v18 offset:2048
    ds_read_b64_tr_b16 a[228:229], v16 offset:4096
    ds_read_b64_tr_b16 a[230:231], v16 offset:6144
    s_add_u32 m0, s87, 57344
    s_add_u32 s37, s86, 6422656
    buffer_load_dwordx4 v40, s[12:15], s37 offen offset:0 lds
    ds_read_b64_tr_b16 a[232:233], v17 offset:4096
    ds_read_b64_tr_b16 a[234:235], v17 offset:6144
    ds_read_b64_tr_b16 a[236:237], v18 offset:4096
    ds_read_b64_tr_b16 a[238:239], v18 offset:6144
    buffer_load_dwordx4 v41, s[12:15], s37 offen offset:1024 lds
    v_mfma_f32_16x16x32_bf16 v[56:59], a[192:195], v[28:31], v[56:59]
    v_mfma_f32_16x16x32_bf16 v[60:63], a[196:199], v[28:31], v[60:63]
    v_mfma_f32_16x16x32_bf16 v[64:67], a[200:203], v[28:31], v[64:67]
    v_mfma_f32_16x16x32_bf16 v[56:59], a[204:207], v[28:31], v[56:59]
    s_add_u32 m0, s87, 65536
    s_add_u32 s37, s88, 6422784
    buffer_load_dwordx4 v40, s[12:15], s37 offen offset:0 lds
    v_mfma_f32_16x16x32_bf16 v[60:63], a[208:211], v[28:31], v[60:63]
    v_mfma_f32_16x16x32_bf16 v[64:67], a[212:215], v[28:31], v[64:67]
    v_add_u32 v12, 98304, v42
    v_add_u32 v13, 98304, v43
    buffer_load_dwordx4 v41, s[12:15], s37 offen offset:1024 lds
    v_add_u32 v14, 98304, v44
    s_waitcnt vmcnt(24) lgkmcnt(0)
    s_barrier
    s_add_u32 m0, s87, 73728
    s_add_u32 s37, s86, 6881280
    buffer_load_dwordx4 v40, s[12:15], s37 offen offset:0 lds
    ds_read_b64_tr_b16 a[240:241], v12 offset:0
    ds_read_b64_tr_b16 a[242:243], v12 offset:2048
    ds_read_b64_tr_b16 a[244:245], v13 offset:0
    ds_read_b64_tr_b16 a[246:247], v13 offset:2048
    buffer_load_dwordx4 v41, s[12:15], s37 offen offset:1024 lds
    ds_read_b64_tr_b16 a[248:249], v14 offset:0
    ds_read_b64_tr_b16 a[250:251], v14 offset:2048
    ds_read_b64_tr_b16 a[252:253], v12 offset:4096
    ds_read_b64_tr_b16 a[254:255], v12 offset:6144
    s_add_u32 m0, s87, 81920
    s_add_u32 s37, s86, 6881408
    buffer_load_dwordx4 v40, s[12:15], s37 offen offset:0 lds
    ds_read_b64_tr_b16 v[128:129], v13 offset:4096
    ds_read_b64_tr_b16 v[130:131], v13 offset:6144
    ds_read_b64_tr_b16 v[132:133], v14 offset:4096
    ds_read_b64_tr_b16 v[134:135], v14 offset:6144
    buffer_load_dwordx4 v41, s[12:15], s37 offen offset:1024 lds
    v_mfma_f32_16x16x32_bf16 v[56:59], a[216:219], v[28:31], v[56:59]
    v_mfma_f32_16x16x32_bf16 v[60:63], a[220:223], v[28:31], v[60:63]
    v_mfma_f32_16x16x32_bf16 v[64:67], a[224:227], v[28:31], v[64:67]
    v_mfma_f32_16x16x32_bf16 v[56:59], a[228:231], v[28:31], v[56:59]
    s_add_u32 m0, s87, 90112
    s_add_u32 s37, s88, 6881536
    buffer_load_dwordx4 v40, s[12:15], s37 offen offset:0 lds
    v_mfma_f32_16x16x32_bf16 v[60:63], a[232:235], v[28:31], v[60:63]
    v_mfma_f32_16x16x32_bf16 v[64:67], a[236:239], v[28:31], v[64:67]
    v_add_u32 v16, 122880, v42
    v_add_u32 v17, 122880, v43
    buffer_load_dwordx4 v41, s[12:15], s37 offen offset:1024 lds
    v_add_u32 v18, 122880, v44
    s_waitcnt vmcnt(24) lgkmcnt(0)
    s_barrier
    ds_read_b64_tr_b16 v[136:137], v16 offset:0
    ds_read_b64_tr_b16 v[138:139], v16 offset:2048
    ds_read_b64_tr_b16 v[140:141], v17 offset:0
    ds_read_b64_tr_b16 v[142:143], v17 offset:2048
    ds_read_b64_tr_b16 v[144:145], v18 offset:0
    ds_read_b64_tr_b16 v[146:147], v18 offset:2048
    ds_read_b64_tr_b16 v[148:149], v16 offset:4096
    ds_read_b64_tr_b16 v[150:151], v16 offset:6144
    ds_read_b64_tr_b16 v[152:153], v17 offset:4096
    ds_read_b64_tr_b16 v[154:155], v17 offset:6144
    ds_read_b64_tr_b16 v[156:157], v18 offset:4096
    ds_read_b64_tr_b16 v[158:159], v18 offset:6144
    v_mfma_f32_16x16x32_bf16 v[56:59], a[240:243], v[28:31], v[56:59]
    v_mfma_f32_16x16x32_bf16 v[60:63], a[244:247], v[28:31], v[60:63]
    v_mfma_f32_16x16x32_bf16 v[64:67], a[248:251], v[28:31], v[64:67]
    v_mfma_f32_16x16x32_bf16 v[56:59], a[252:255], v[28:31], v[56:59]
    v_mfma_f32_16x16x32_bf16 v[60:63], v[128:131], v[28:31], v[60:63]
    v_mfma_f32_16x16x32_bf16 v[64:67], v[132:135], v[28:31], v[64:67]
    v_add_u32 v12, 0, v42
    v_add_u32 v13, 0, v43
    v_add_u32 v14, 0, v44
    s_waitcnt vmcnt(18) lgkmcnt(0)
    s_barrier
    ds_read_b64_tr_b16 v[160:161], v12 offset:0
    ds_read_b64_tr_b16 v[162:163], v12 offset:2048
    ds_read_b64_tr_b16 v[164:165], v13 offset:0
    ds_read_b64_tr_b16 v[166:167], v13 offset:2048
    ds_read_b64_tr_b16 v[168:169], v14 offset:0
    ds_read_b64_tr_b16 v[170:171], v14 offset:2048
    ds_read_b64_tr_b16 v[172:173], v12 offset:4096
    ds_read_b64_tr_b16 v[174:175], v12 offset:6144
    ds_read_b64_tr_b16 v[176:177], v13 offset:4096
    ds_read_b64_tr_b16 v[178:179], v13 offset:6144
    ds_read_b64_tr_b16 v[180:181], v14 offset:4096
    ds_read_b64_tr_b16 v[182:183], v14 offset:6144
    v_mfma_f32_16x16x32_bf16 v[56:59], v[136:139], v[28:31], v[56:59]
    v_mfma_f32_16x16x32_bf16 v[60:63], v[140:143], v[28:31], v[60:63]
    v_mfma_f32_16x16x32_bf16 v[64:67], v[144:147], v[28:31], v[64:67]
    v_mfma_f32_16x16x32_bf16 v[56:59], v[148:151], v[28:31], v[56:59]
    v_mfma_f32_16x16x32_bf16 v[60:63], v[152:155], v[28:31], v[60:63]
    v_mfma_f32_16x16x32_bf16 v[64:67], v[156:159], v[28:31], v[64:67]
    v_add_u32 v16, 24576, v42
    v_add_u32 v17, 24576, v43
    v_add_u32 v18, 24576, v44
    s_waitcnt vmcnt(12) lgkmcnt(0)
    s_barrier
    ds_read_b64_tr_b16 v[184:185], v16 offset:0
    ds_read_b64_tr_b16 v[186:187], v16 offset:2048
    ds_read_b64_tr_b16 v[188:189], v17 offset:0
    ds_read_b64_tr_b16 v[190:191], v17 offset:2048
    ds_read_b64_tr_b16 v[192:193], v18 offset:0
    ds_read_b64_tr_b16 v[194:195], v18 offset:2048
    ds_read_b64_tr_b16 v[196:197], v16 offset:4096
    ds_read_b64_tr_b16 v[198:199], v16 offset:6144
    ds_read_b64_tr_b16 v[200:201], v17 offset:4096
    ds_read_b64_tr_b16 v[202:203], v17 offset:6144
    ds_read_b64_tr_b16 v[204:205], v18 offset:4096
    ds_read_b64_tr_b16 v[206:207], v18 offset:6144
    v_mfma_f32_16x16x32_bf16 v[56:59], v[160:163], v[28:31], v[56:59]
    v_mfma_f32_16x16x32_bf16 v[60:63], v[164:167], v[28:31], v[60:63]
    v_mfma_f32_16x16x32_bf16 v[64:67], v[168:171], v[28:31], v[64:67]
    v_mfma_f32_16x16x32_bf16 v[56:59], v[172:175], v[28:31], v[56:59]
    v_mfma_f32_16x16x32_bf16 v[60:63], v[176:179], v[28:31], v[60:63]
    v_mfma_f32_16x16x32_bf16 v[64:67], v[180:183], v[28:31], v[64:67]
    v_add_u32 v12, 49152, v42
    v_add_u32 v13, 49152, v43
    v_add_u32 v14, 49152, v44
    s_waitcnt vmcnt(6) lgkmcnt(0)
    s_barrier
    ds_read_b64_tr_b16 v[208:209], v12 offset:0
    ds_read_b64_tr_b16 v[210:211], v12 offset:2048
    ds_read_b64_tr_b16 v[212:213], v13 offset:0
    ds_read_b64_tr_b16 v[214:215], v13 offset:2048
    ds_read_b64_tr_b16 v[216:217], v14 offset:0
    ds_read_b64_tr_b16 v[218:219], v14 offset:2048
    ds_read_b64_tr_b16 v[220:221], v12 offset:4096
    ds_read_b64_tr_b16 v[222:223], v12 offset:6144
    ds_read_b64_tr_b16 v[224:225], v13 offset:4096
    ds_read_b64_tr_b16 v[226:227], v13 offset:6144
    ds_read_b64_tr_b16 v[228:229], v14 offset:4096
    ds_read_b64_tr_b16 v[230:231], v14 offset:6144
    v_mfma_f32_16x16x32_bf16 v[56:59], v[184:187], v[28:31], v[56:59]
    v_mfma_f32_16x16x32_bf16 v[60:63], v[188:191], v[28:31], v[60:63]
    v_mfma_f32_16x16x32_bf16 v[64:67], v[192:195], v[28:31], v[64:67]
    v_mfma_f32_16x16x32_bf16 v[56:59], v[196:199], v[28:31], v[56:59]
    v_mfma_f32_16x16x32_bf16 v[60:63], v[200:203], v[28:31], v[60:63]
    v_mfma_f32_16x16x32_bf16 v[64:67], v[204:207], v[28:31], v[64:67]
    v_add_u32 v16, 73728, v42
    v_add_u32 v17, 73728, v43
    v_add_u32 v18, 73728, v44
    s_waitcnt vmcnt(0) lgkmcnt(0)
    s_barrier
    ds_read_b64_tr_b16 v[232:233], v16 offset:0
    ds_read_b64_tr_b16 v[234:235], v16 offset:2048
    ds_read_b64_tr_b16 v[236:237], v17 offset:0
    ds_read_b64_tr_b16 v[238:239], v17 offset:2048
    ds_read_b64_tr_b16 v[240:241], v18 offset:0
    ds_read_b64_tr_b16 v[242:243], v18 offset:2048
    ds_read_b64_tr_b16 v[244:245], v16 offset:4096
    ds_read_b64_tr_b16 v[246:247], v16 offset:6144
    ds_read_b64_tr_b16 v[248:249], v17 offset:4096
    ds_read_b64_tr_b16 v[250:251], v17 offset:6144
    ds_read_b64_tr_b16 v[252:253], v18 offset:4096
    ds_read_b64_tr_b16 v[254:255], v18 offset:6144
    v_mfma_f32_16x16x32_bf16 v[56:59], v[208:211], v[28:31], v[56:59]
    v_mfma_f32_16x16x32_bf16 v[60:63], v[212:215], v[28:31], v[60:63]
    v_mfma_f32_16x16x32_bf16 v[64:67], v[216:219], v[28:31], v[64:67]
    v_mfma_f32_16x16x32_bf16 v[56:59], v[220:223], v[28:31], v[56:59]
    v_mfma_f32_16x16x32_bf16 v[60:63], v[224:227], v[28:31], v[60:63]
    v_mfma_f32_16x16x32_bf16 v[64:67], v[228:231], v[28:31], v[64:67]
    s_waitcnt lgkmcnt(0)
    v_mfma_f32_16x16x32_bf16 v[56:59], v[232:235], v[28:31], v[56:59]
    v_mfma_f32_16x16x32_bf16 v[60:63], v[236:239], v[28:31], v[60:63]
    v_mfma_f32_16x16x32_bf16 v[64:67], v[240:243], v[28:31], v[64:67]
    v_mfma_f32_16x16x32_bf16 v[56:59], v[244:247], v[28:31], v[56:59]
    v_mfma_f32_16x16x32_bf16 v[60:63], v[248:251], v[28:31], v[60:63]
    v_mfma_f32_16x16x32_bf16 v[64:67], v[252:255], v[28:31], v[64:67]
    s_mov_b32 s12, s84
    s_mov_b32 s13, s85
    s_mov_b32 s14, 0x6200000
    s_mov_b32 s15, 0x00020000
    s_barrier
    s_mov_b32 s20, s82
    s_mov_b32 s21, s83
    s_mov_b32 s22, 0x100
    s_mov_b32 s23, 0x00020000
    v_and_b32 v8, 15, v0
    v_lshlrev_b32 v8, 4, v8
    v_mov_b32 v10, 8
    buffer_load_dword v9, v8, s[20:23], 0 offen sc1
    s_waitcnt vmcnt(0)
Lffa_wa:
    v_cmp_gt_u32 vcc, v10, v9
    s_sub_u32 s43, s43, 1
    s_cmp_lt_i32 s43, 0
    s_cbranch_scc1 Lffa_all
    s_cbranch_vccz Lffa_all
    s_sleep 2
    buffer_load_dword v9, v8, s[20:23], 0 offen sc1
    s_waitcnt vmcnt(0)
    s_branch Lffa_wa
Lffa_all:
    s_mov_b32 s14, 0
    s_cmp_lg_u32 s30, 0
    s_cbranch_scc1 Lffa_fok
Lffa_fspin:
    buffer_load_dword v5, v4, s[4:7], s16 offen sc1
    s_waitcnt vmcnt(0)
    v_cmp_gt_i32 vcc, s32, v5
    s_sub_u32 s43, s43, 1
    s_cmp_lt_i32 s43, 0
    s_cbranch_scc1 Lffa_fok
    s_and_b64 vcc, vcc, s[18:19]
    s_cbranch_scc0 Lffa_fok
    s_sleep 2
    s_branch Lffa_fspin
Lffa_fok:
    s_barrier
    s_branch Lffa_rdy1
    .p2align 6
Lffa_body00:
    s_waitcnt lgkmcnt(2)
    v_mfma_f32_16x16x32_bf16 v[8:11], a[0:3], v[40:43], 0
    s_add_u32 m0, s34, 0
    s_waitcnt vmcnt(5)
    v_cmp_gt_i32 vcc, s32, v5
    v_mfma_f32_16x16x32_bf16 v[8:11], a[12:15], v[44:47], v[8:11]
    s_add_u32 s31, s31, 1
    v_mov_b32 v6, s31
    v_fma_f32 v124, v32, v21, v88
    v_mfma_f32_16x16x32_bf16 v[12:15], a[16:19], v[44:47], 0
    s_and_b64 vcc, vcc, s[18:19]
    s_cbranch_scc1 Lffa_v01
    v_mfma_f32_16x16x32_bf16 v[12:15], a[4:7], v[40:43], v[12:15]
    buffer_load_dwordx4 v1, s[8:11], s33 offen offset:0 sc1 lds
    v_mfma_f32_16x16x32_bf16 v[16:19], a[8:11], v[40:43], 0
    ds_read_b128 v[40:43], v2 offset:4096
    v_fma_f32 v125, v33, v21, v89
    v_mfma_f32_16x16x32_bf16 v[16:19], a[20:23], v[44:47], v[16:19]
    ds_read_b128 v[44:47], v2 offset:5120
    s_waitcnt lgkmcnt(2)
    v_mfma_f32_16x16x32_bf16 v[16:19], a[32:35], v[48:51], v[16:19]
    buffer_load_dwordx4 v1, s[8:11], s33 offen offset:1024 sc1 lds
    v_mfma_f32_16x16x32_bf16 v[16:19], a[44:47], v[52:55], v[16:19]
    s_add_u32 s35, s35, 36864
    v_fma_f32 v126, v34, v21, v90
    v_fma_f32 v127, v35, v21, v91
    v_mfma_f32_16x16x32_bf16 v[12:15], a[40:43], v[52:55], v[12:15]
    s_cmp_eq_u32 s35, 147456
    s_cselect_b32 s35, 0, s35
    v_mul_f32 v124, v124, |v124|
    v_mfma_f32_16x16x32_bf16 v[12:15], a[28:31], v[48:51], v[12:15]
    buffer_load_dwordx4 v1, s[8:11], s33 offen offset:2048 sc1 lds
    v_mfma_f32_16x16x32_bf16 v[8:11], a[24:27], v[48:51], v[8:11]
    ds_read_b128 v[48:51], v2 offset:6144
    v_mul_f32 v125, v125, |v125|
    v_mfma_f32_16x16x32_bf16 v[8:11], a[36:39], v[52:55], v[8:11]
    ds_read_b128 v[52:55], v2 offset:7168
    s_waitcnt lgkmcnt(2)
    v_mfma_f32_16x16x32_bf16 v[8:11], a[48:51], v[40:43], v[8:11]
    buffer_load_dwordx4 v1, s[8:11], s33 offen offset:3072 sc1 lds
    v_mfma_f32_16x16x32_bf16 v[8:11], a[60:63], v[44:47], v[8:11]
    s_add_u32 m0, s34, s3
    v_mul_f32 v126, v126, |v126|
    v_mul_f32 v127, v127, |v127|
    v_mfma_f32_16x16x32_bf16 v[12:15], a[64:67], v[44:47], v[12:15]
    s_add_u32 s37, s33, s3
    v_cvt_pk_bf16_f32 v124, v124, v125
    v_cvt_pk_bf16_f32 v126, v126, v127
    v_mfma_f32_16x16x32_bf16 v[12:15], a[52:55], v[40:43], v[12:15]
    buffer_load_dwordx4 v1, s[8:11], s37 offen offset:0 sc1 lds
    v_mfma_f32_16x16x32_bf16 v[16:19], a[56:59], v[40:43], v[16:19]
    ds_read_b128 v[40:43], v2 offset:8192
    v_pk_max_i16 v96, v124, 0
    v_mfma_f32_16x16x32_bf16 v[16:19], a[68:71], v[44:47], v[16:19]
    ds_read_b128 v[44:47], v2 offset:9216
    s_waitcnt lgkmcnt(2)
    v_mfma_f32_16x16x32_bf16 v[16:19], a[80:83], v[48:51], v[16:19]
    s_add_u32 s16, s16, 8192
    v_pk_max_i16 v97, v126, 0
    v_pk_max_i16 v98, v124, 0
    v_mfma_f32_16x16x32_bf16 v[16:19], a[92:95], v[52:55], v[16:19]
    s_add_u32 m0, s34, 16384
    v_pk_max_i16 v99, v126, 0
    v_fma_f32 v116, v24, v21, v80
    v_mfma_f32_16x16x32_bf16 v[12:15], a[88:91], v[52:55], v[12:15]
    s_add_u32 s37, s33, 16384
    v_permlane32_swap_b32 v96, v98
    v_mfma_f32_16x16x32_bf16 v[12:15], a[76:79], v[48:51], v[12:15]
    v_permlane32_swap_b32 v97, v99
    v_mfma_f32_16x16x32_bf16 v[8:11], a[72:75], v[48:51], v[8:11]
    ds_read_b128 v[48:51], v2 offset:10240
    v_fma_f32 v117, v25, v21, v81
    v_mfma_f32_16x16x32_bf16 v[8:11], a[84:87], v[52:55], v[8:11]
    ds_read_b128 v[52:55], v2 offset:11264
    s_waitcnt lgkmcnt(2)
    v_mfma_f32_16x16x32_bf16 v[8:11], a[96:99], v[40:43], v[8:11]
    buffer_store_dwordx4 v[96:99], v7, s[12:15], s36 offen sc1
    v_fma_f32 v118, v26, v21, v82
    v_mfma_f32_16x16x32_bf16 v[8:11], a[108:111], v[44:47], v[8:11]
    v_fma_f32 v119, v27, v21, v83
    v_fma_f32 v120, v28, v21, v84
    v_mfma_f32_16x16x32_bf16 v[12:15], a[112:115], v[44:47], v[12:15]
    v_fma_f32 v121, v29, v21, v85
    v_fma_f32 v122, v30, v21, v86
    v_mfma_f32_16x16x32_bf16 v[12:15], a[100:103], v[40:43], v[12:15]
    v_fma_f32 v123, v31, v21, v87
    v_mul_f32 v116, v116, |v116|
    v_mfma_f32_16x16x32_bf16 v[16:19], a[104:107], v[40:43], v[16:19]
    ds_read_b128 v[40:43], v2 offset:12288
    v_mul_f32 v117, v117, |v117|
    v_mfma_f32_16x16x32_bf16 v[16:19], a[116:119], v[44:47], v[16:19]
    ds_read_b128 v[44:47], v2 offset:13312
    s_waitcnt lgkmcnt(2)
    v_mfma_f32_16x16x32_bf16 v[16:19], a[128:131], v[48:51], v[16:19]
    v_sub_u32 v100, v2, v20
    v_mul_f32 v118, v118, |v118|
    v_mfma_f32_16x16x32_bf16 v[16:19], a[140:143], v[52:55], v[16:19]
    ds_read2st64_b64 v[112:115], v100 offset0:70 offset1:71
    v_mul_f32 v119, v119, |v119|
    v_mfma_f32_16x16x32_bf16 v[12:15], a[136:139], v[52:55], v[12:15]
    ds_read2st64_b64 v[108:111], v100 offset0:68 offset1:69
    v_mul_f32 v120, v120, |v120|
    v_mfma_f32_16x16x32_bf16 v[12:15], a[124:127], v[48:51], v[12:15]
    ds_read2st64_b64 v[104:107], v100 offset0:66 offset1:67
    v_mul_f32 v121, v121, |v121|
    v_mfma_f32_16x16x32_bf16 v[8:11], a[120:123], v[48:51], v[8:11]
    ds_read_b128 v[48:51], v2 offset:14336
    v_mul_f32 v122, v122, |v122|
    v_mfma_f32_16x16x32_bf16 v[8:11], a[132:135], v[52:55], v[8:11]
    ds_read_b128 v[52:55], v2 offset:15360
    s_waitcnt lgkmcnt(5)
    v_mfma_f32_16x16x32_bf16 v[8:11], a[144:147], v[40:43], v[8:11]
    s_waitcnt vmcnt(7)
    s_barrier
    v_mfma_f32_16x16x32_bf16 v[8:11], a[156:159], v[44:47], v[8:11]
    ds_read2st64_b64 v[100:103], v100 offset0:64 offset1:65
    v_mul_f32 v123, v123, |v123|
    v_mfma_f32_16x16x32_bf16 v[12:15], a[160:163], v[44:47], v[12:15]
    v_cvt_pk_bf16_f32 v116, v116, v117
    v_cvt_pk_bf16_f32 v118, v118, v119
    v_mfma_f32_16x16x32_bf16 v[12:15], a[148:151], v[40:43], v[12:15]
    v_cvt_pk_bf16_f32 v120, v120, v121
    v_cvt_pk_bf16_f32 v122, v122, v123
    v_mfma_f32_16x16x32_bf16 v[16:19], a[152:155], v[40:43], v[16:19]
    ds_read_b128 v[40:43], v2 offset:16384
    v_pk_max_i16 v92, v116, 0
    v_mfma_f32_16x16x32_bf16 v[16:19], a[164:167], v[44:47], v[16:19]
    ds_read_b128 v[44:47], v2 offset:17408
    s_waitcnt lgkmcnt(3)
    v_mfma_f32_16x16x32_bf16 v[16:19], a[176:179], v[48:51], v[16:19]
    v_pk_max_i16 v93, v118, 0
    v_pk_max_i16 v94, v120, 0
    v_mfma_f32_16x16x32_bf16 v[16:19], a[188:191], v[52:55], v[16:19]
    v_pk_max_i16 v95, v122, 0
    v_add_u32 v3, s35, v1
    v_mfma_f32_16x16x32_bf16 v[12:15], a[184:187], v[52:55], v[12:15]
    buffer_store_dwordx4 v[92:95], v1, s[12:15], s36 offen sc1
    s_waitcnt lgkmcnt(2)
    v_mfma_f32_16x16x32_bf16 v[12:15], a[172:175], v[48:51], v[12:15]
    s_add_u32 s36, s36, 116736
    v_add_f32 v100, v100, v108
    v_add_f32 v101, v101, v109
    v_mfma_f32_16x16x32_bf16 v[8:11], a[168:171], v[48:51], v[8:11]
    ds_read_b128 v[48:51], v2 offset:18432
    v_add_f32 v102, v102, v110
    v_mfma_f32_16x16x32_bf16 v[8:11], a[180:183], v[52:55], v[8:11]
    ds_read_b128 v[52:55], v2 offset:19456
    s_waitcnt lgkmcnt(2)
    v_mfma_f32_16x16x32_bf16 v[8:11], a[192:195], v[40:43], v[8:11]
    buffer_load_dword v5, v4, s[4:7], s16 offen sc1
    v_mfma_f32_16x16x32_bf16 v[8:11], a[204:207], v[44:47], v[8:11]
    v_add_f32 v103, v103, v111
    v_add_f32 v104, v104, v112
    v_mfma_f32_16x16x32_bf16 v[12:15], a[208:211], v[44:47], v[12:15]
    v_add_f32 v105, v105, v113
    v_add_f32 v106, v106, v114
    v_mfma_f32_16x16x32_bf16 v[12:15], a[196:199], v[40:43], v[12:15]
    buffer_load_dwordx4 v1, s[8:11], s37 offen offset:0 sc1 lds
    v_mfma_f32_16x16x32_bf16 v[16:19], a[200:203], v[40:43], v[16:19]
    ds_read_b128 v[40:43], v2 offset:20480
    v_add_f32 v107, v107, v115
    v_mfma_f32_16x16x32_bf16 v[16:19], a[212:215], v[44:47], v[16:19]
    ds_read_b128 v[44:47], v2 offset:21504
    s_waitcnt lgkmcnt(2)
    v_mfma_f32_16x16x32_bf16 v[16:19], a[224:227], v[48:51], v[16:19]
    buffer_load_dwordx4 v1, s[8:11], s37 offen offset:1024 sc1 lds
    v_mfma_f32_16x16x32_bf16 v[16:19], a[236:239], v[52:55], v[16:19]
    v_add_f32 v100, v100, v104
    v_add_f32 v101, v101, v105
    v_mfma_f32_16x16x32_bf16 v[12:15], a[232:235], v[52:55], v[12:15]
    v_add_f32 v102, v102, v106
    v_add_f32 v103, v103, v107
    v_mfma_f32_16x16x32_bf16 v[12:15], a[220:223], v[48:51], v[12:15]
    buffer_load_dwordx4 v1, s[8:11], s37 offen offset:2048 sc1 lds
    v_mfma_f32_16x16x32_bf16 v[8:11], a[216:219], v[48:51], v[8:11]
    ds_read_b128 v[48:51], v2 offset:22528
    v_add_f32 v100, v100, v102
    v_mfma_f32_16x16x32_bf16 v[8:11], a[228:231], v[52:55], v[8:11]
    ds_read_b128 v[52:55], v2 offset:23552
    s_waitcnt lgkmcnt(2)
    v_mfma_f32_16x16x32_bf16 v[8:11], a[240:243], v[40:43], v[8:11]
    buffer_load_dwordx4 v1, s[8:11], s37 offen offset:3072 sc1 lds
    v_mfma_f32_16x16x32_bf16 v[8:11], a[252:255], v[44:47], v[8:11]
    s_add_u32 s32, s32, 1
    v_add_f32 v101, v101, v103
    s_add_u32 s33, s33, 36864
    v_mfma_f32_16x16x32_bf16 v[12:15], v[128:131], v[44:47], v[12:15]
    s_add_u32 s34, s34, 36864
    v_permlane16_swap_b32 v100, v101
    v_mfma_f32_16x16x32_bf16 v[12:15], a[244:247], v[40:43], v[12:15]
    s_cmp_ge_u32 s34, 147456
    s_cselect_b32 s38, 147456, 0
    v_add_f32 v100, v100, v101
    v_mfma_f32_16x16x32_bf16 v[16:19], a[248:251], v[40:43], v[16:19]
    ds_read_b128 v[40:43], v2 offset:24576
    v_mov_b32 v101, v100
    v_mfma_f32_16x16x32_bf16 v[16:19], v[132:135], v[44:47], v[16:19]
    ds_read_b128 v[44:47], v2 offset:25600
    s_waitcnt lgkmcnt(2)
    v_mfma_f32_16x16x32_bf16 v[16:19], v[144:147], v[48:51], v[16:19]
    s_sub_u32 s34, s34, s38
    v_permlane32_swap_b32 v100, v101
    v_mfma_f32_16x16x32_bf16 v[16:19], v[156:159], v[52:55], v[16:19]
    v_add_f32 v100, v100, v101
    v_mul_f32 v100, 0x3a800000, v100
    v_mfma_f32_16x16x32_bf16 v[12:15], v[152:155], v[52:55], v[12:15]
    v_mov_b32 v101, v100
    v_mfma_f32_16x16x32_bf16 v[12:15], v[140:143], v[48:51], v[12:15]
    s_nop 0
    v_permlane16_swap_b32 v100, v101
    v_mfma_f32_16x16x32_bf16 v[8:11], v[136:139], v[48:51], v[8:11]
    ds_read_b128 v[48:51], v2 offset:26624
    v_fma_f32 v101, -v100, v100, v101
    v_mfma_f32_16x16x32_bf16 v[8:11], v[148:151], v[52:55], v[8:11]
    ds_read_b128 v[52:55], v2 offset:27648
    s_waitcnt lgkmcnt(2)
    v_mfma_f32_16x16x32_bf16 v[8:11], v[160:163], v[40:43], v[8:11]
    v_max_f32 v101, 0, v101
    v_add_f32 v101, 0x3727c5ac, v101
    v_mfma_f32_16x16x32_bf16 v[8:11], v[172:175], v[44:47], v[8:11]
    v_rsq_f32 v21, v101
    v_mfma_f32_16x16x32_bf16 v[12:15], v[176:179], v[44:47], v[12:15]
    v_mul_f32 v100, v100, v21
    v_fma_f32 v80, -v100, v56, v68
    v_mfma_f32_16x16x32_bf16 v[12:15], v[164:167], v[40:43], v[12:15]
    v_fma_f32 v81, -v100, v57, v69
    v_fma_f32 v82, -v100, v58, v70
    v_mfma_f32_16x16x32_bf16 v[16:19], v[168:171], v[40:43], v[16:19]
    ds_read_b128 v[40:43], v2 offset:28672
    v_fma_f32 v83, -v100, v59, v71
    v_mfma_f32_16x16x32_bf16 v[16:19], v[180:183], v[44:47], v[16:19]
    ds_read_b128 v[44:47], v2 offset:29696
    s_waitcnt lgkmcnt(2)
    v_mfma_f32_16x16x32_bf16 v[16:19], v[192:195], v[48:51], v[16:19]
    v_fma_f32 v84, -v100, v60, v72
    v_fma_f32 v85, -v100, v61, v73
    v_mfma_f32_16x16x32_bf16 v[16:19], v[204:207], v[52:55], v[16:19]
    v_fma_f32 v86, -v100, v62, v74
    v_fma_f32 v87, -v100, v63, v75
    v_mfma_f32_16x16x32_bf16 v[12:15], v[200:203], v[52:55], v[12:15]
    v_fma_f32 v88, -v100, v64, v76
    v_fma_f32 v89, -v100, v65, v77
    v_mfma_f32_16x16x32_bf16 v[12:15], v[188:191], v[48:51], v[12:15]
    v_fma_f32 v90, -v100, v66, v78
    v_fma_f32 v91, -v100, v67, v79
    v_mfma_f32_16x16x32_bf16 v[8:11], v[184:187], v[48:51], v[8:11]
    ds_read_b128 v[48:51], v2 offset:30720
    v_mfma_f32_16x16x32_bf16 v[8:11], v[196:199], v[52:55], v[8:11]
    ds_read_b128 v[52:55], v2 offset:31744
    s_waitcnt lgkmcnt(2)
    v_mfma_f32_16x16x32_bf16 v[8:11], v[208:211], v[40:43], v[8:11]
    s_waitcnt vmcnt(7)
    s_barrier
    v_mfma_f32_16x16x32_bf16 v[8:11], v[220:223], v[44:47], v[8:11]
    v_mfma_f32_16x16x32_bf16 v[12:15], v[224:227], v[44:47], v[12:15]
    v_mfma_f32_16x16x32_bf16 v[12:15], v[212:215], v[40:43], v[12:15]
    v_mfma_f32_16x16x32_bf16 v[16:19], v[216:219], v[40:43], v[16:19]
    ds_read_b128 v[40:43], v3 offset:0
    v_mfma_f32_16x16x32_bf16 v[16:19], v[228:231], v[44:47], v[16:19]
    ds_read_b128 v[44:47], v3 offset:1024
    s_waitcnt vmcnt(5) lgkmcnt(2)
    v_mfma_f32_16x16x32_bf16 v[16:19], v[240:243], v[48:51], v[16:19]
    buffer_store_dword v6, v22, s[12:15], s17 offen sc1
    s_mov_b32 s14, s6
    v_mfma_f32_16x16x32_bf16 v[16:19], v[252:255], v[52:55], v[16:19]
    s_add_u32 s17, s17, 8192
    v_mfma_f32_16x16x32_bf16 v[12:15], v[248:251], v[52:55], v[12:15]
    v_mfma_f32_16x16x32_bf16 v[12:15], v[236:239], v[48:51], v[12:15]
    v_mfma_f32_16x16x32_bf16 v[8:11], v[232:235], v[48:51], v[8:11]
    ds_read_b128 v[48:51], v3 offset:2048
    v_mfma_f32_16x16x32_bf16 v[8:11], v[244:247], v[52:55], v[8:11]
    ds_read_b128 v[52:55], v3 offset:3072
Lffa_body10:
    s_waitcnt lgkmcnt(2)
    v_mfma_f32_16x16x32_bf16 v[24:27], a[0:3], v[40:43], 0
    s_add_u32 m0, s34, 0
    s_waitcnt vmcnt(5)
    v_cmp_gt_i32 vcc, s32, v5
    v_mfma_f32_16x16x32_bf16 v[24:27], a[12:15], v[44:47], v[24:27]
    s_add_u32 s31, s31, 1
    v_mov_b32 v6, s31
    v_fma_f32 v124, v16, v21, v88
    v_mfma_f32_16x16x32_bf16 v[28:31], a[16:19], v[44:47], 0
    s_and_b64 vcc, vcc, s[18:19]
    s_cbranch_scc1 Lffa_v11
    v_mfma_f32_16x16x32_bf16 v[28:31], a[4:7], v[40:43], v[28:31]
    buffer_load_dwordx4 v1, s[8:11], s33 offen offset:0 sc1 lds
    v_mfma_f32_16x16x32_bf16 v[32:35], a[8:11], v[40:43], 0
    ds_read_b128 v[40:43], v3 offset:4096
    v_fma_f32 v125, v17, v21, v89
    v_mfma_f32_16x16x32_bf16 v[32:35], a[20:23], v[44:47], v[32:35]
    ds_read_b128 v[44:47], v3 offset:5120
    s_waitcnt lgkmcnt(2)
    v_mfma_f32_16x16x32_bf16 v[32:35], a[32:35], v[48:51], v[32:35]
    buffer_load_dwordx4 v1, s[8:11], s33 offen offset:1024 sc1 lds
    v_mfma_f32_16x16x32_bf16 v[32:35], a[44:47], v[52:55], v[32:35]
    s_add_u32 s35, s35, 36864
    v_fma_f32 v126, v18, v21, v90
    v_fma_f32 v127, v19, v21, v91
    v_mfma_f32_16x16x32_bf16 v[28:31], a[40:43], v[52:55], v[28:31]
    s_cmp_eq_u32 s35, 147456
    s_cselect_b32 s35, 0, s35
    v_mul_f32 v124, v124, |v124|
    v_mfma_f32_16x16x32_bf16 v[28:31], a[28:31], v[48:51], v[28:31]
    buffer_load_dwordx4 v1, s[8:11], s33 offen offset:2048 sc1 lds
    v_mfma_f32_16x16x32_bf16 v[24:27], a[24:27], v[48:51], v[24:27]
    ds_read_b128 v[48:51], v3 offset:6144
    v_mul_f32 v125, v125, |v125|
    v_mfma_f32_16x16x32_bf16 v[24:27], a[36:39], v[52:55], v[24:27]
    ds_read_b128 v[52:55], v3 offset:7168
    s_waitcnt lgkmcnt(2)
    v_mfma_f32_16x16x32_bf16 v[24:27], a[48:51], v[40:43], v[24:27]
    buffer_load_dwordx4 v1, s[8:11], s33 offen offset:3072 sc1 lds
    v_mfma_f32_16x16x32_bf16 v[24:27], a[60:63], v[44:47], v[24:27]
    s_add_u32 m0, s34, s3
    v_mul_f32 v126, v126, |v126|
    v_mul_f32 v127, v127, |v127|
    v_mfma_f32_16x16x32_bf16 v[28:31], a[64:67], v[44:47], v[28:31]
    s_add_u32 s37, s33, s3
    v_cvt_pk_bf16_f32 v124, v124, v125
    v_cvt_pk_bf16_f32 v126, v126, v127
    v_mfma_f32_16x16x32_bf16 v[28:31], a[52:55], v[40:43], v[28:31]
    buffer_load_dwordx4 v1, s[8:11], s37 offen offset:0 sc1 lds
    v_mfma_f32_16x16x32_bf16 v[32:35], a[56:59], v[40:43], v[32:35]
    ds_read_b128 v[40:43], v3 offset:8192
    v_pk_max_i16 v96, v124, 0
    v_mfma_f32_16x16x32_bf16 v[32:35], a[68:71], v[44:47], v[32:35]
    ds_read_b128 v[44:47], v3 offset:9216
    s_waitcnt lgkmcnt(2)
    v_mfma_f32_16x16x32_bf16 v[32:35], a[80:83], v[48:51], v[32:35]
    s_add_u32 s16, s16, 8192
    v_pk_max_i16 v97, v126, 0
    v_pk_max_i16 v98, v124, 0
    v_mfma_f32_16x16x32_bf16 v[32:35], a[92:95], v[52:55], v[32:35]
    s_add_u32 m0, s34, 16384
    v_pk_max_i16 v99, v126, 0
    v_fma_f32 v116, v8, v21, v80
    v_mfma_f32_16x16x32_bf16 v[28:31], a[88:91], v[52:55], v[28:31]
    s_add_u32 s37, s33, 16384
    v_permlane32_swap_b32 v96, v98
    v_mfma_f32_16x16x32_bf16 v[28:31], a[76:79], v[48:51], v[28:31]
    v_permlane32_swap_b32 v97, v99
    v_mfma_f32_16x16x32_bf16 v[24:27], a[72:75], v[48:51], v[24:27]
    ds_read_b128 v[48:51], v3 offset:10240
    v_fma_f32 v117, v9, v21, v81
    v_mfma_f32_16x16x32_bf16 v[24:27], a[84:87], v[52:55], v[24:27]
    ds_read_b128 v[52:55], v3 offset:11264
    s_waitcnt lgkmcnt(2)
    v_mfma_f32_16x16x32_bf16 v[24:27], a[96:99], v[40:43], v[24:27]
    buffer_store_dwordx4 v[96:99], v7, s[12:15], s36 offen sc1
    v_fma_f32 v118, v10, v21, v82
    v_mfma_f32_16x16x32_bf16 v[24:27], a[108:111], v[44:47], v[24:27]
    v_fma_f32 v119, v11, v21, v83
    v_fma_f32 v120, v12, v21, v84
    v_mfma_f32_16x16x32_bf16 v[28:31], a[112:115], v[44:47], v[28:31]
    v_fma_f32 v121, v13, v21, v85
    v_fma_f32 v122, v14, v21, v86
    v_mfma_f32_16x16x32_bf16 v[28:31], a[100:103], v[40:43], v[28:31]
    v_fma_f32 v123, v15, v21, v87
    v_mul_f32 v116, v116, |v116|
    v_mfma_f32_16x16x32_bf16 v[32:35], a[104:107], v[40:43], v[32:35]
    ds_read_b128 v[40:43], v3 offset:12288
    v_mul_f32 v117, v117, |v117|
    v_mfma_f32_16x16x32_bf16 v[32:35], a[116:119], v[44:47], v[32:35]
    ds_read_b128 v[44:47], v3 offset:13312
    s_waitcnt lgkmcnt(2)
    v_mfma_f32_16x16x32_bf16 v[32:35], a[128:131], v[48:51], v[32:35]
    v_sub_u32 v100, v3, v20
    v_mul_f32 v118, v118, |v118|
    v_mfma_f32_16x16x32_bf16 v[32:35], a[140:143], v[52:55], v[32:35]
    ds_read2st64_b64 v[112:115], v100 offset0:70 offset1:71
    v_mul_f32 v119, v119, |v119|
    v_mfma_f32_16x16x32_bf16 v[28:31], a[136:139], v[52:55], v[28:31]
    ds_read2st64_b64 v[108:111], v100 offset0:68 offset1:69
    v_mul_f32 v120, v120, |v120|
    v_mfma_f32_16x16x32_bf16 v[28:31], a[124:127], v[48:51], v[28:31]
    ds_read2st64_b64 v[104:107], v100 offset0:66 offset1:67
    v_mul_f32 v121, v121, |v121|
    v_mfma_f32_16x16x32_bf16 v[24:27], a[120:123], v[48:51], v[24:27]
    ds_read_b128 v[48:51], v3 offset:14336
    v_mul_f32 v122, v122, |v122|
    v_mfma_f32_16x16x32_bf16 v[24:27], a[132:135], v[52:55], v[24:27]
    ds_read_b128 v[52:55], v3 offset:15360
    s_waitcnt lgkmcnt(5)
    v_mfma_f32_16x16x32_bf16 v[24:27], a[144:147], v[40:43], v[24:27]
    s_waitcnt vmcnt(7)
    s_barrier
    v_mfma_f32_16x16x32_bf16 v[24:27], a[156:159], v[44:47], v[24:27]
    ds_read2st64_b64 v[100:103], v100 offset0:64 offset1:65
    v_mul_f32 v123, v123, |v123|
    v_mfma_f32_16x16x32_bf16 v[28:31], a[160:163], v[44:47], v[28:31]
    v_cvt_pk_bf16_f32 v116, v116, v117
    v_cvt_pk_bf16_f32 v118, v118, v119
    v_mfma_f32_16x16x32_bf16 v[28:31], a[148:151], v[40:43], v[28:31]
    v_cvt_pk_bf16_f32 v120, v120, v121
    v_cvt_pk_bf16_f32 v122, v122, v123
    v_mfma_f32_16x16x32_bf16 v[32:35], a[152:155], v[40:43], v[32:35]
    ds_read_b128 v[40:43], v3 offset:16384
    v_pk_max_i16 v92, v116, 0
    v_mfma_f32_16x16x32_bf16 v[32:35], a[164:167], v[44:47], v[32:35]
    ds_read_b128 v[44:47], v3 offset:17408
    s_waitcnt lgkmcnt(3)
    v_mfma_f32_16x16x32_bf16 v[32:35], a[176:179], v[48:51], v[32:35]
    v_pk_max_i16 v93, v118, 0
    v_pk_max_i16 v94, v120, 0
    v_mfma_f32_16x16x32_bf16 v[32:35], a[188:191], v[52:55], v[32:35]
    v_pk_max_i16 v95, v122, 0
    v_add_u32 v2, s35, v1
    v_mfma_f32_16x16x32_bf16 v[28:31], a[184:187], v[52:55], v[28:31]
    buffer_store_dwordx4 v[92:95], v1, s[12:15], s36 offen sc1
    s_waitcnt lgkmcnt(2)
    v_mfma_f32_16x16x32_bf16 v[28:31], a[172:175], v[48:51], v[28:31]
    s_add_u32 s36, s36, 116736
    v_add_f32 v100, v100, v108
    v_add_f32 v101, v101, v109
    v_mfma_f32_16x16x32_bf16 v[24:27], a[168:171], v[48:51], v[24:27]
    ds_read_b128 v[48:51], v3 offset:18432
    v_add_f32 v102, v102, v110
    v_mfma_f32_16x16x32_bf16 v[24:27], a[180:183], v[52:55], v[24:27]
    ds_read_b128 v[52:55], v3 offset:19456
    s_waitcnt lgkmcnt(2)
    v_mfma_f32_16x16x32_bf16 v[24:27], a[192:195], v[40:43], v[24:27]
    buffer_load_dword v5, v4, s[4:7], s16 offen sc1
    v_mfma_f32_16x16x32_bf16 v[24:27], a[204:207], v[44:47], v[24:27]
    v_add_f32 v103, v103, v111
    v_add_f32 v104, v104, v112
    v_mfma_f32_16x16x32_bf16 v[28:31], a[208:211], v[44:47], v[28:31]
    v_add_f32 v105, v105, v113
    v_add_f32 v106, v106, v114
    v_mfma_f32_16x16x32_bf16 v[28:31], a[196:199], v[40:43], v[28:31]
    buffer_load_dwordx4 v1, s[8:11], s37 offen offset:0 sc1 lds
    v_mfma_f32_16x16x32_bf16 v[32:35], a[200:203], v[40:43], v[32:35]
    ds_read_b128 v[40:43], v3 offset:20480
    v_add_f32 v107, v107, v115
    v_mfma_f32_16x16x32_bf16 v[32:35], a[212:215], v[44:47], v[32:35]
    ds_read_b128 v[44:47], v3 offset:21504
    s_waitcnt lgkmcnt(2)
    v_mfma_f32_16x16x32_bf16 v[32:35], a[224:227], v[48:51], v[32:35]
    buffer_load_dwordx4 v1, s[8:11], s37 offen offset:1024 sc1 lds
    v_mfma_f32_16x16x32_bf16 v[32:35], a[236:239], v[52:55], v[32:35]
    v_add_f32 v100, v100, v104
    v_add_f32 v101, v101, v105
    v_mfma_f32_16x16x32_bf16 v[28:31], a[232:235], v[52:55], v[28:31]
    v_add_f32 v102, v102, v106
    v_add_f32 v103, v103, v107
    v_mfma_f32_16x16x32_bf16 v[28:31], a[220:223], v[48:51], v[28:31]
    buffer_load_dwordx4 v1, s[8:11], s37 offen offset:2048 sc1 lds
    v_mfma_f32_16x16x32_bf16 v[24:27], a[216:219], v[48:51], v[24:27]
    ds_read_b128 v[48:51], v3 offset:22528
    v_add_f32 v100, v100, v102
    v_mfma_f32_16x16x32_bf16 v[24:27], a[228:231], v[52:55], v[24:27]
    ds_read_b128 v[52:55], v3 offset:23552
    s_waitcnt lgkmcnt(2)
    v_mfma_f32_16x16x32_bf16 v[24:27], a[240:243], v[40:43], v[24:27]
    buffer_load_dwordx4 v1, s[8:11], s37 offen offset:3072 sc1 lds
    v_mfma_f32_16x16x32_bf16 v[24:27], a[252:255], v[44:47], v[24:27]
    s_add_u32 s32, s32, 1
    v_add_f32 v101, v101, v103
    s_add_u32 s33, s33, 36864
    v_mfma_f32_16x16x32_bf16 v[28:31], v[128:131], v[44:47], v[28:31]
    s_add_u32 s34, s34, 36864
    v_permlane16_swap_b32 v100, v101
    v_mfma_f32_16x16x32_bf16 v[28:31], a[244:247], v[40:43], v[28:31]
    s_cmp_ge_u32 s34, 147456
    s_cselect_b32 s38, 147456, 0
    v_add_f32 v100, v100, v101
    v_mfma_f32_16x16x32_bf16 v[32:35], a[248:251], v[40:43], v[32:35]
    ds_read_b128 v[40:43], v3 offset:24576
    v_mov_b32 v101, v100
    v_mfma_f32_16x16x32_bf16 v[32:35], v[132:135], v[44:47], v[32:35]
    ds_read_b128 v[44:47], v3 offset:25600
    s_waitcnt lgkmcnt(2)
    v_mfma_f32_16x16x32_bf16 v[32:35], v[144:147], v[48:51], v[32:35]
    s_sub_u32 s34, s34, s38
    v_permlane32_swap_b32 v100, v101
    v_mfma_f32_16x16x32_bf16 v[32:35], v[156:159], v[52:55], v[32:35]
    v_add_f32 v100, v100, v101
    v_mul_f32 v100, 0x3a800000, v100
    v_mfma_f32_16x16x32_bf16 v[28:31], v[152:155], v[52:55], v[28:31]
    v_mov_b32 v101, v100
    v_mfma_f32_16x16x32_bf16 v[28:31], v[140:143], v[48:51], v[28:31]
    s_nop 0
    v_permlane16_swap_b32 v100, v101
    v_mfma_f32_16x16x32_bf16 v[24:27], v[136:139], v[48:51], v[24:27]
    ds_read_b128 v[48:51], v3 offset:26624
    v_fma_f32 v101, -v100, v100, v101
    v_mfma_f32_16x16x32_bf16 v[24:27], v[148:151], v[52:55], v[24:27]
    ds_read_b128 v[52:55], v3 offset:27648
    s_waitcnt lgkmcnt(2)
    v_mfma_f32_16x16x32_bf16 v[24:27], v[160:163], v[40:43], v[24:27]
    v_max_f32 v101, 0, v101
    v_add_f32 v101, 0x3727c5ac, v101
    v_mfma_f32_16x16x32_bf16 v[24:27], v[172:175], v[44:47], v[24:27]
    v_rsq_f32 v21, v101
    v_mfma_f32_16x16x32_bf16 v[28:31], v[176:179], v[44:47], v[28:31]
    v_mul_f32 v100, v100, v21
    v_fma_f32 v80, -v100, v56, v68
    v_mfma_f32_16x16x32_bf16 v[28:31], v[164:167], v[40:43], v[28:31]
    v_fma_f32 v81, -v100, v57, v69
    v_fma_f32 v82, -v100, v58, v70
    v_mfma_f32_16x16x32_bf16 v[32:35], v[168:171], v[40:43], v[32:35]
    ds_read_b128 v[40:43], v3 offset:28672
    v_fma_f32 v83, -v100, v59, v71
    v_mfma_f32_16x16x32_bf16 v[32:35], v[180:183], v[44:47], v[32:35]
    ds_read_b128 v[44:47], v3 offset:29696
    s_waitcnt lgkmcnt(2)
    v_mfma_f32_16x16x32_bf16 v[32:35], v[192:195], v[48:51], v[32:35]
    v_fma_f32 v84, -v100, v60, v72
    v_fma_f32 v85, -v100, v61, v73
    v_mfma_f32_16x16x32_bf16 v[32:35], v[204:207], v[52:55], v[32:35]
    v_fma_f32 v86, -v100, v62, v74
    v_fma_f32 v87, -v100, v63, v75
    v_mfma_f32_16x16x32_bf16 v[28:31], v[200:203], v[52:55], v[28:31]
    v_fma_f32 v88, -v100, v64, v76
    v_fma_f32 v89, -v100, v65, v77
    v_mfma_f32_16x16x32_bf16 v[28:31], v[188:191], v[48:51], v[28:31]
    v_fma_f32 v90, -v100, v66, v78
    v_fma_f32 v91, -v100, v67, v79
    v_mfma_f32_16x16x32_bf16 v[24:27], v[184:187], v[48:51], v[24:27]
    ds_read_b128 v[48:51], v3 offset:30720
    v_mfma_f32_16x16x32_bf16 v[24:27], v[196:199], v[52:55], v[24:27]
    ds_read_b128 v[52:55], v3 offset:31744
    s_waitcnt lgkmcnt(2)
    v_mfma_f32_16x16x32_bf16 v[24:27], v[208:211], v[40:43], v[24:27]
    s_waitcnt vmcnt(7)
    s_barrier
    v_mfma_f32_16x16x32_bf16 v[24:27], v[220:223], v[44:47], v[24:27]
    v_mfma_f32_16x16x32_bf16 v[28:31], v[224:227], v[44:47], v[28:31]
    v_mfma_f32_16x16x32_bf16 v[28:31], v[212:215], v[40:43], v[28:31]
    v_mfma_f32_16x16x32_bf16 v[32:35], v[216:219], v[40:43], v[32:35]
    ds_read_b128 v[40:43], v2 offset:0
    v_mfma_f32_16x16x32_bf16 v[32:35], v[228:231], v[44:47], v[32:35]
    ds_read_b128 v[44:47], v2 offset:1024
    s_waitcnt vmcnt(5) lgkmcnt(2)
    v_mfma_f32_16x16x32_bf16 v[32:35], v[240:243], v[48:51], v[32:35]
    buffer_store_dword v6, v22, s[12:15], s17 offen sc1
    s_mov_b32 s14, s6
    v_mfma_f32_16x16x32_bf16 v[32:35], v[252:255], v[52:55], v[32:35]
    s_add_u32 s17, s17, 8192
    v_mfma_f32_16x16x32_bf16 v[28:31], v[248:251], v[52:55], v[28:31]
    v_mfma_f32_16x16x32_bf16 v[28:31], v[236:239], v[48:51], v[28:31]
    v_mfma_f32_16x16x32_bf16 v[24:27], v[232:235], v[48:51], v[24:27]
    ds_read_b128 v[48:51], v2 offset:2048
    v_mfma_f32_16x16x32_bf16 v[24:27], v[244:247], v[52:55], v[24:27]
    ds_read_b128 v[52:55], v2 offset:3072
    s_cmp_lt_i32 s31, 63
    s_cbranch_scc1 Lffa_body00
    s_branch L_exit
    .p2align 6
Lffa_body01:
    s_waitcnt lgkmcnt(2)
    v_mfma_f32_16x16x32_bf16 v[8:11], a[0:3], v[40:43], 0
    s_add_u32 m0, s34, 0
    s_waitcnt vmcnt(5)
    v_cmp_gt_i32 vcc, s32, v5
    v_mfma_f32_16x16x32_bf16 v[8:11], a[12:15], v[44:47], v[8:11]
    s_add_u32 s31, s31, 1
    v_mov_b32 v6, s31
    v_fma_f32 v124, v32, v21, v88
    v_mfma_f32_16x16x32_bf16 v[12:15], a[16:19], v[44:47], 0
    s_and_b64 vcc, vcc, s[18:19]
    s_cbranch_scc1 Lffa_v01
    v_mfma_f32_16x16x32_bf16 v[12:15], a[4:7], v[40:43], v[12:15]
    buffer_load_dwordx4 v1, s[8:11], s33 offen offset:0 sc1 lds
    v_mfma_f32_16x16x32_bf16 v[16:19], a[8:11], v[40:43], 0
    ds_read_b128 v[40:43], v2 offset:4096
    v_fma_f32 v125, v33, v21, v89
    v_mfma_f32_16x16x32_bf16 v[16:19], a[20:23], v[44:47], v[16:19]
    ds_read_b128 v[44:47], v2 offset:5120
    s_waitcnt lgkmcnt(2)
    v_mfma_f32_16x16x32_bf16 v[16:19], a[32:35], v[48:51], v[16:19]
    buffer_load_dwordx4 v1, s[8:11], s33 offen offset:1024 sc1 lds
    v_mfma_f32_16x16x32_bf16 v[16:19], a[44:47], v[52:55], v[16:19]
    s_add_u32 s35, s35, 36864
    v_fma_f32 v126, v34, v21, v90
    v_fma_f32 v127, v35, v21, v91
    v_mfma_f32_16x16x32_bf16 v[12:15], a[40:43], v[52:55], v[12:15]
    s_cmp_eq_u32 s35, 147456
    s_cselect_b32 s35, 0, s35
    v_mul_f32 v124, v124, |v124|
    v_mfma_f32_16x16x32_bf16 v[12:15], a[28:31], v[48:51], v[12:15]
    buffer_load_dwordx4 v1, s[8:11], s33 offen offset:2048 sc1 lds
    v_mfma_f32_16x16x32_bf16 v[8:11], a[24:27], v[48:51], v[8:11]
    ds_read_b128 v[48:51], v2 offset:6144
    v_mul_f32 v125, v125, |v125|
    v_mfma_f32_16x16x32_bf16 v[8:11], a[36:39], v[52:55], v[8:11]
    ds_read_b128 v[52:55], v2 offset:7168
    s_waitcnt lgkmcnt(2)
    v_mfma_f32_16x16x32_bf16 v[8:11], a[48:51], v[40:43], v[8:11]
    buffer_load_dwordx4 v1, s[8:11], s33 offen offset:3072 sc1 lds
    v_mfma_f32_16x16x32_bf16 v[8:11], a[60:63], v[44:47], v[8:11]
    s_add_u32 m0, s34, s3
    v_mul_f32 v126, v126, |v126|
    v_mul_f32 v127, v127, |v127|
    v_mfma_f32_16x16x32_bf16 v[12:15], a[64:67], v[44:47], v[12:15]
    s_add_u32 s37, s33, s3
    v_cvt_pk_bf16_f32 v124, v124, v125
    v_cvt_pk_bf16_f32 v126, v126, v127
    v_mfma_f32_16x16x32_bf16 v[12:15], a[52:55], v[40:43], v[12:15]
    buffer_load_dwordx4 v1, s[8:11], s37 offen offset:0 sc1 lds
    v_mfma_f32_16x16x32_bf16 v[16:19], a[56:59], v[40:43], v[16:19]
    ds_read_b128 v[40:43], v2 offset:8192
    v_pk_max_i16 v96, v124, 0
    v_mfma_f32_16x16x32_bf16 v[16:19], a[68:71], v[44:47], v[16:19]
    ds_read_b128 v[44:47], v2 offset:9216
    s_waitcnt lgkmcnt(2)
    v_mfma_f32_16x16x32_bf16 v[16:19], a[80:83], v[48:51], v[16:19]
    s_add_u32 s16, s16, 8192
    v_pk_max_i16 v97, v126, 0
    v_pk_max_i16 v98, v124, 0
    v_mfma_f32_16x16x32_bf16 v[16:19], a[92:95], v[52:55], v[16:19]
    s_add_u32 m0, s34, 16384
    v_pk_max_i16 v99, v126, 0
    v_fma_f32 v116, v24, v21, v80
    v_mfma_f32_16x16x32_bf16 v[12:15], a[88:91], v[52:55], v[12:15]
    s_add_u32 s37, s33, 16384
    v_permlane32_swap_b32 v96, v98
    v_mfma_f32_16x16x32_bf16 v[12:15], a[76:79], v[48:51], v[12:15]
    v_permlane32_swap_b32 v97, v99
    v_mfma_f32_16x16x32_bf16 v[8:11], a[72:75], v[48:51], v[8:11]
    ds_read_b128 v[48:51], v2 offset:10240
    v_fma_f32 v117, v25, v21, v81
    v_mfma_f32_16x16x32_bf16 v[8:11], a[84:87], v[52:55], v[8:11]
    ds_read_b128 v[52:55], v2 offset:11264
    s_waitcnt lgkmcnt(2)
    v_mfma_f32_16x16x32_bf16 v[8:11], a[96:99], v[40:43], v[8:11]
    buffer_store_dwordx4 v[96:99], v7, s[12:15], s36 offen sc1
    v_fma_f32 v118, v26, v21, v82
    v_mfma_f32_16x16x32_bf16 v[8:11], a[108:111], v[44:47], v[8:11]
    v_fma_f32 v119, v27, v21, v83
    v_fma_f32 v120, v28, v21, v84
    v_mfma_f32_16x16x32_bf16 v[12:15], a[112:115], v[44:47], v[12:15]
    v_fma_f32 v121, v29, v21, v85
    v_fma_f32 v122, v30, v21, v86
    v_mfma_f32_16x16x32_bf16 v[12:15], a[100:103], v[40:43], v[12:15]
    v_fma_f32 v123, v31, v21, v87
    v_mul_f32 v116, v116, |v116|
    v_mfma_f32_16x16x32_bf16 v[16:19], a[104:107], v[40:43], v[16:19]
    ds_read_b128 v[40:43], v2 offset:12288
    v_mul_f32 v117, v117, |v117|
    v_mfma_f32_16x16x32_bf16 v[16:19], a[116:119], v[44:47], v[16:19]
    ds_read_b128 v[44:47], v2 offset:13312
    s_waitcnt lgkmcnt(2)
    v_mfma_f32_16x16x32_bf16 v[16:19], a[128:131], v[48:51], v[16:19]
    v_sub_u32 v100, v2, v20
    v_mul_f32 v118, v118, |v118|
    v_mfma_f32_16x16x32_bf16 v[16:19], a[140:143], v[52:55], v[16:19]
    ds_read2st64_b64 v[112:115], v100 offset0:70 offset1:71
    v_mul_f32 v119, v119, |v119|
    v_mfma_f32_16x16x32_bf16 v[12:15], a[136:139], v[52:55], v[12:15]
    ds_read2st64_b64 v[108:111], v100 offset0:68 offset1:69
    v_mul_f32 v120, v120, |v120|
    v_mfma_f32_16x16x32_bf16 v[12:15], a[124:127], v[48:51], v[12:15]
    ds_read2st64_b64 v[104:107], v100 offset0:66 offset1:67
    v_mul_f32 v121, v121, |v121|
    v_mfma_f32_16x16x32_bf16 v[8:11], a[120:123], v[48:51], v[8:11]
    ds_read_b128 v[48:51], v2 offset:14336
    v_mul_f32 v122, v122, |v122|
    v_mfma_f32_16x16x32_bf16 v[8:11], a[132:135], v[52:55], v[8:11]
    ds_read_b128 v[52:55], v2 offset:15360
    s_waitcnt lgkmcnt(5)
    v_mfma_f32_16x16x32_bf16 v[8:11], a[144:147], v[40:43], v[8:11]
    s_waitcnt vmcnt(7)
    ds_read2st64_b64 v[100:103], v100 offset0:64 offset1:65
    v_mfma_f32_16x16x32_bf16 v[8:11], a[156:159], v[44:47], v[8:11]
    s_barrier
    v_mfma_f32_16x16x32_bf16 v[12:15], a[160:163], v[44:47], v[12:15]
    v_mul_f32 v123, v123, |v123|
    v_cvt_pk_bf16_f32 v116, v116, v117
    v_mfma_f32_16x16x32_bf16 v[12:15], a[148:151], v[40:43], v[12:15]
    v_cvt_pk_bf16_f32 v118, v118, v119
    v_cvt_pk_bf16_f32 v120, v120, v121
    v_mfma_f32_16x16x32_bf16 v[16:19], a[152:155], v[40:43], v[16:19]
    ds_read_b128 v[40:43], v2 offset:16384
    v_cvt_pk_bf16_f32 v122, v122, v123
    v_mfma_f32_16x16x32_bf16 v[16:19], a[164:167], v[44:47], v[16:19]
    ds_read_b128 v[44:47], v2 offset:17408
    s_waitcnt lgkmcnt(3)
    v_mfma_f32_16x16x32_bf16 v[16:19], a[176:179], v[48:51], v[16:19]
    v_pk_max_i16 v92, v116, 0
    v_pk_max_i16 v93, v118, 0
    v_mfma_f32_16x16x32_bf16 v[16:19], a[188:191], v[52:55], v[16:19]
    s_waitcnt lgkmcnt(2)
    v_pk_max_i16 v94, v120, 0
    v_pk_max_i16 v95, v122, 0
    v_mfma_f32_16x16x32_bf16 v[12:15], a[184:187], v[52:55], v[12:15]
    buffer_store_dwordx4 v[92:95], v1, s[12:15], s36 offen sc1
    v_add_u32 v3, s35, v1
    v_mfma_f32_16x16x32_bf16 v[12:15], a[172:175], v[48:51], v[12:15]
    s_add_u32 s36, s36, 116736
    v_add_f32 v100, v100, v108
    v_add_f32 v101, v101, v109
    v_mfma_f32_16x16x32_bf16 v[8:11], a[168:171], v[48:51], v[8:11]
    ds_read_b128 v[48:51], v2 offset:18432
    v_add_f32 v102, v102, v110
    v_mfma_f32_16x16x32_bf16 v[8:11], a[180:183], v[52:55], v[8:11]
    ds_read_b128 v[52:55], v2 offset:19456
    s_waitcnt lgkmcnt(2)
    v_mfma_f32_16x16x32_bf16 v[8:11], a[192:195], v[40:43], v[8:11]
    buffer_load_dword v5, v4, s[4:7], s16 offen sc1
    v_mfma_f32_16x16x32_bf16 v[8:11], a[204:207], v[44:47], v[8:11]
    v_add_f32 v103, v103, v111
    v_add_f32 v104, v104, v112
    v_mfma_f32_16x16x32_bf16 v[12:15], a[208:211], v[44:47], v[12:15]
    v_add_f32 v105, v105, v113
    v_add_f32 v106, v106, v114
    v_mfma_f32_16x16x32_bf16 v[12:15], a[196:199], v[40:43], v[12:15]
    buffer_load_dwordx4 v1, s[8:11], s37 offen offset:0 sc1 lds
    v_mfma_f32_16x16x32_bf16 v[16:19], a[200:203], v[40:43], v[16:19]
    ds_read_b128 v[40:43], v2 offset:20480
    v_add_f32 v107, v107, v115
    v_mfma_f32_16x16x32_bf16 v[16:19], a[212:215], v[44:47], v[16:19]
    ds_read_b128 v[44:47], v2 offset:21504
    s_waitcnt lgkmcnt(2)
    v_mfma_f32_16x16x32_bf16 v[16:19], a[224:227], v[48:51], v[16:19]
    buffer_load_dwordx4 v1, s[8:11], s37 offen offset:1024 sc1 lds
    v_mfma_f32_16x16x32_bf16 v[16:19], a[236:239], v[52:55], v[16:19]
    v_add_f32 v100, v100, v104
    v_add_f32 v101, v101, v105
    v_mfma_f32_16x16x32_bf16 v[12:15], a[232:235], v[52:55], v[12:15]
    v_add_f32 v102, v102, v106
    v_add_f32 v103, v103, v107
    v_mfma_f32_16x16x32_bf16 v[12:15], a[220:223], v[48:51], v[12:15]
    buffer_load_dwordx4 v1, s[8:11], s37 offen offset:2048 sc1 lds
    v_mfma_f32_16x16x32_bf16 v[8:11], a[216:219], v[48:51], v[8:11]
    ds_read_b128 v[48:51], v2 offset:22528
    v_add_f32 v100, v100, v102
    v_mfma_f32_16x16x32_bf16 v[8:11], a[228:231], v[52:55], v[8:11]
    ds_read_b128 v[52:55], v2 offset:23552
    s_waitcnt lgkmcnt(2)
    v_mfma_f32_16x16x32_bf16 v[8:11], a[240:243], v[40:43], v[8:11]
    buffer_load_dwordx4 v1, s[8:11], s37 offen offset:3072 sc1 lds
    v_mfma_f32_16x16x32_bf16 v[8:11], a[252:255], v[44:47], v[8:11]
    s_add_u32 s32, s32, 1
    v_add_f32 v101, v101, v103
    s_add_u32 s33, s33, 36864
    v_mfma_f32_16x16x32_bf16 v[12:15], v[128:131], v[44:47], v[12:15]
    s_add_u32 s34, s34, 36864
    v_permlane16_swap_b32 v100, v101
    v_mfma_f32_16x16x32_bf16 v[12:15], a[244:247], v[40:43], v[12:15]
    s_cmp_ge_u32 s34, 147456
    s_cselect_b32 s38, 147456, 0
    v_add_f32 v100, v100, v101
    v_mfma_f32_16x16x32_bf16 v[16:19], a[248:251], v[40:43], v[16:19]
    ds_read_b128 v[40:43], v2 offset:24576
    v_mov_b32 v101, v100
    v_mfma_f32_16x16x32_bf16 v[16:19], v[132:135], v[44:47], v[16:19]
    ds_read_b128 v[44:47], v2 offset:25600
    s_waitcnt lgkmcnt(2)
    v_mfma_f32_16x16x32_bf16 v[16:19], v[144:147], v[48:51], v[16:19]
    s_sub_u32 s34, s34, s38
    v_permlane32_swap_b32 v100, v101
    v_mfma_f32_16x16x32_bf16 v[16:19], v[156:159], v[52:55], v[16:19]
    v_add_f32 v100, v100, v101
    v_mul_f32 v100, 0x3a800000, v100
    v_mfma_f32_16x16x32_bf16 v[12:15], v[152:155], v[52:55], v[12:15]
    v_mov_b32 v101, v100
    v_mfma_f32_16x16x32_bf16 v[12:15], v[140:143], v[48:51], v[12:15]
    s_nop 0
    v_permlane16_swap_b32 v100, v101
    v_mfma_f32_16x16x32_bf16 v[8:11], v[136:139], v[48:51], v[8:11]
    ds_read_b128 v[48:51], v2 offset:26624
    v_fma_f32 v101, -v100, v100, v101
    v_mfma_f32_16x16x32_bf16 v[8:11], v[148:151], v[52:55], v[8:11]
    ds_read_b128 v[52:55], v2 offset:27648
    s_waitcnt lgkmcnt(2)
    v_mfma_f32_16x16x32_bf16 v[8:11], v[160:163], v[40:43], v[8:11]
    v_max_f32 v101, 0, v101
    v_add_f32 v101, 0x3727c5ac, v101
    v_mfma_f32_16x16x32_bf16 v[8:11], v[172:175], v[44:47], v[8:11]
    v_rsq_f32 v21, v101
    v_mfma_f32_16x16x32_bf16 v[12:15], v[176:179], v[44:47], v[12:15]
    v_mul_f32 v100, v100, v21
    v_fma_f32 v80, -v100, v56, v68
    v_mfma_f32_16x16x32_bf16 v[12:15], v[164:167], v[40:43], v[12:15]
    v_fma_f32 v81, -v100, v57, v69
    v_fma_f32 v82, -v100, v58, v70
    v_mfma_f32_16x16x32_bf16 v[16:19], v[168:171], v[40:43], v[16:19]
    ds_read_b128 v[40:43], v2 offset:28672
    v_fma_f32 v83, -v100, v59, v71
    v_mfma_f32_16x16x32_bf16 v[16:19], v[180:183], v[44:47], v[16:19]
    ds_read_b128 v[44:47], v2 offset:29696
    s_waitcnt lgkmcnt(2)
    v_mfma_f32_16x16x32_bf16 v[16:19], v[192:195], v[48:51], v[16:19]
    v_fma_f32 v84, -v100, v60, v72
    v_fma_f32 v85, -v100, v61, v73
    v_mfma_f32_16x16x32_bf16 v[16:19], v[204:207], v[52:55], v[16:19]
    v_fma_f32 v86, -v100, v62, v74
    v_fma_f32 v87, -v100, v63, v75
    v_mfma_f32_16x16x32_bf16 v[12:15], v[200:203], v[52:55], v[12:15]
    v_fma_f32 v88, -v100, v64, v76
    v_fma_f32 v89, -v100, v65, v77
    v_mfma_f32_16x16x32_bf16 v[12:15], v[188:191], v[48:51], v[12:15]
    v_fma_f32 v90, -v100, v66, v78
    v_fma_f32 v91, -v100, v67, v79
    v_mfma_f32_16x16x32_bf16 v[8:11], v[184:187], v[48:51], v[8:11]
    ds_read_b128 v[48:51], v2 offset:30720
    v_mfma_f32_16x16x32_bf16 v[8:11], v[196:199], v[52:55], v[8:11]
    ds_read_b128 v[52:55], v2 offset:31744
    s_waitcnt lgkmcnt(2)
    v_mfma_f32_16x16x32_bf16 v[8:11], v[208:211], v[40:43], v[8:11]
    s_waitcnt vmcnt(7)
    v_mfma_f32_16x16x32_bf16 v[8:11], v[220:223], v[44:47], v[8:11]
    s_barrier
    v_mfma_f32_16x16x32_bf16 v[12:15], v[224:227], v[44:47], v[12:15]
    v_mfma_f32_16x16x32_bf16 v[12:15], v[212:215], v[40:43], v[12:15]
    v_mfma_f32_16x16x32_bf16 v[16:19], v[216:219], v[40:43], v[16:19]
    ds_read_b128 v[40:43], v3 offset:0
    v_mfma_f32_16x16x32_bf16 v[16:19], v[228:231], v[44:47], v[16:19]
    ds_read_b128 v[44:47], v3 offset:1024
    s_waitcnt vmcnt(5) lgkmcnt(2)
    v_mfma_f32_16x16x32_bf16 v[16:19], v[240:243], v[48:51], v[16:19]
    buffer_store_dword v6, v22, s[12:15], s17 offen sc1
    s_mov_b32 s14, s6
    v_mfma_f32_16x16x32_bf16 v[16:19], v[252:255], v[52:55], v[16:19]
    s_add_u32 s17, s17, 8192
    v_mfma_f32_16x16x32_bf16 v[12:15], v[248:251], v[52:55], v[12:15]
    v_mfma_f32_16x16x32_bf16 v[12:15], v[236:239], v[48:51], v[12:15]
    v_mfma_f32_16x16x32_bf16 v[8:11], v[232:235], v[48:51], v[8:11]
    ds_read_b128 v[48:51], v3 offset:2048
    v_mfma_f32_16x16x32_bf16 v[8:11], v[244:247], v[52:55], v[8:11]
    ds_read_b128 v[52:55], v3 offset:3072
Lffa_body11:
    s_waitcnt lgkmcnt(2)
    v_mfma_f32_16x16x32_bf16 v[24:27], a[0:3], v[40:43], 0
    s_add_u32 m0, s34, 0
    s_waitcnt vmcnt(5)
    v_cmp_gt_i32 vcc, s32, v5
    v_mfma_f32_16x16x32_bf16 v[24:27], a[12:15], v[44:47], v[24:27]
    s_add_u32 s31, s31, 1
    v_mov_b32 v6, s31
    v_fma_f32 v124, v16, v21, v88
    v_mfma_f32_16x16x32_bf16 v[28:31], a[16:19], v[44:47], 0
    s_and_b64 vcc, vcc, s[18:19]
    s_cbranch_scc1 Lffa_v11
    v_mfma_f32_16x16x32_bf16 v[28:31], a[4:7], v[40:43], v[28:31]
    buffer_load_dwordx4 v1, s[8:11], s33 offen offset:0 sc1 lds
    v_mfma_f32_16x16x32_bf16 v[32:35], a[8:11], v[40:43], 0
    ds_read_b128 v[40:43], v3 offset:4096
    v_fma_f32 v125, v17, v21, v89
    v_mfma_f32_16x16x32_bf16 v[32:35], a[20:23], v[44:47], v[32:35]
    ds_read_b128 v[44:47], v3 offset:5120
    s_waitcnt lgkmcnt(2)
    v_mfma_f32_16x16x32_bf16 v[32:35], a[32:35], v[48:51], v[32:35]
    buffer_load_dwordx4 v1, s[8:11], s33 offen offset:1024 sc1 lds
    v_mfma_f32_16x16x32_bf16 v[32:35], a[44:47], v[52:55], v[32:35]
    s_add_u32 s35, s35, 36864
    v_fma_f32 v126, v18, v21, v90
    v_fma_f32 v127, v19, v21, v91
    v_mfma_f32_16x16x32_bf16 v[28:31], a[40:43], v[52:55], v[28:31]
    s_cmp_eq_u32 s35, 147456
    s_cselect_b32 s35, 0, s35
    v_mul_f32 v124, v124, |v124|
    v_mfma_f32_16x16x32_bf16 v[28:31], a[28:31], v[48:51], v[28:31]
    buffer_load_dwordx4 v1, s[8:11], s33 offen offset:2048 sc1 lds
    v_mfma_f32_16x16x32_bf16 v[24:27], a[24:27], v[48:51], v[24:27]
    ds_read_b128 v[48:51], v3 offset:6144
    v_mul_f32 v125, v125, |v125|
    v_mfma_f32_16x16x32_bf16 v[24:27], a[36:39], v[52:55], v[24:27]
    ds_read_b128 v[52:55], v3 offset:7168
    s_waitcnt lgkmcnt(2)
    v_mfma_f32_16x16x32_bf16 v[24:27], a[48:51], v[40:43], v[24:27]
    buffer_load_dwordx4 v1, s[8:11], s33 offen offset:3072 sc1 lds
    v_mfma_f32_16x16x32_bf16 v[24:27], a[60:63], v[44:47], v[24:27]
    s_add_u32 m0, s34, s3
    v_mul_f32 v126, v126, |v126|
    v_mul_f32 v127, v127, |v127|
    v_mfma_f32_16x16x32_bf16 v[28:31], a[64:67], v[44:47], v[28:31]
    s_add_u32 s37, s33, s3
    v_cvt_pk_bf16_f32 v124, v124, v125
    v_cvt_pk_bf16_f32 v126, v126, v127
    v_mfma_f32_16x16x32_bf16 v[28:31], a[52:55], v[40:43], v[28:31]
    buffer_load_dwordx4 v1, s[8:11], s37 offen offset:0 sc1 lds
    v_mfma_f32_16x16x32_bf16 v[32:35], a[56:59], v[40:43], v[32:35]
    ds_read_b128 v[40:43], v3 offset:8192
    v_pk_max_i16 v96, v124, 0
    v_mfma_f32_16x16x32_bf16 v[32:35], a[68:71], v[44:47], v[32:35]
    ds_read_b128 v[44:47], v3 offset:9216
    s_waitcnt lgkmcnt(2)
    v_mfma_f32_16x16x32_bf16 v[32:35], a[80:83], v[48:51], v[32:35]
    s_add_u32 s16, s16, 8192
    v_pk_max_i16 v97, v126, 0
    v_pk_max_i16 v98, v124, 0
    v_mfma_f32_16x16x32_bf16 v[32:35], a[92:95], v[52:55], v[32:35]
    s_add_u32 m0, s34, 16384
    v_pk_max_i16 v99, v126, 0
    v_fma_f32 v116, v8, v21, v80
    v_mfma_f32_16x16x32_bf16 v[28:31], a[88:91], v[52:55], v[28:31]
    s_add_u32 s37, s33, 16384
    v_permlane32_swap_b32 v96, v98
    v_mfma_f32_16x16x32_bf16 v[28:31], a[76:79], v[48:51], v[28:31]
    v_permlane32_swap_b32 v97, v99
    v_mfma_f32_16x16x32_bf16 v[24:27], a[72:75], v[48:51], v[24:27]
    ds_read_b128 v[48:51], v3 offset:10240
    v_fma_f32 v117, v9, v21, v81
    v_mfma_f32_16x16x32_bf16 v[24:27], a[84:87], v[52:55], v[24:27]
    ds_read_b128 v[52:55], v3 offset:11264
    s_waitcnt lgkmcnt(2)
    v_mfma_f32_16x16x32_bf16 v[24:27], a[96:99], v[40:43], v[24:27]
    buffer_store_dwordx4 v[96:99], v7, s[12:15], s36 offen sc1
    v_fma_f32 v118, v10, v21, v82
    v_mfma_f32_16x16x32_bf16 v[24:27], a[108:111], v[44:47], v[24:27]
    v_fma_f32 v119, v11, v21, v83
    v_fma_f32 v120, v12, v21, v84
    v_mfma_f32_16x16x32_bf16 v[28:31], a[112:115], v[44:47], v[28:31]
    v_fma_f32 v121, v13, v21, v85
    v_fma_f32 v122, v14, v21, v86
    v_mfma_f32_16x16x32_bf16 v[28:31], a[100:103], v[40:43], v[28:31]
    v_fma_f32 v123, v15, v21, v87
    v_mul_f32 v116, v116, |v116|
    v_mfma_f32_16x16x32_bf16 v[32:35], a[104:107], v[40:43], v[32:35]
    ds_read_b128 v[40:43], v3 offset:12288
    v_mul_f32 v117, v117, |v117|
    v_mfma_f32_16x16x32_bf16 v[32:35], a[116:119], v[44:47], v[32:35]
    ds_read_b128 v[44:47], v3 offset:13312
    s_waitcnt lgkmcnt(2)
    v_mfma_f32_16x16x32_bf16 v[32:35], a[128:131], v[48:51], v[32:35]
    v_sub_u32 v100, v3, v20
    v_mul_f32 v118, v118, |v118|
    v_mfma_f32_16x16x32_bf16 v[32:35], a[140:143], v[52:55], v[32:35]
    ds_read2st64_b64 v[112:115], v100 offset0:70 offset1:71
    v_mul_f32 v119, v119, |v119|
    v_mfma_f32_16x16x32_bf16 v[28:31], a[136:139], v[52:55], v[28:31]
    ds_read2st64_b64 v[108:111], v100 offset0:68 offset1:69
    v_mul_f32 v120, v120, |v120|
    v_mfma_f32_16x16x32_bf16 v[28:31], a[124:127], v[48:51], v[28:31]
    ds_read2st64_b64 v[104:107], v100 offset0:66 offset1:67
    v_mul_f32 v121, v121, |v121|
    v_mfma_f32_16x16x32_bf16 v[24:27], a[120:123], v[48:51], v[24:27]
    ds_read_b128 v[48:51], v3 offset:14336
    v_mul_f32 v122, v122, |v122|
    v_mfma_f32_16x16x32_bf16 v[24:27], a[132:135], v[52:55], v[24:27]
    ds_read_b128 v[52:55], v3 offset:15360
    s_waitcnt lgkmcnt(5)
    v_mfma_f32_16x16x32_bf16 v[24:27], a[144:147], v[40:43], v[24:27]
    s_waitcnt vmcnt(7)
    ds_read2st64_b64 v[100:103], v100 offset0:64 offset1:65
    v_mfma_f32_16x16x32_bf16 v[24:27], a[156:159], v[44:47], v[24:27]
    s_barrier
    v_mfma_f32_16x16x32_bf16 v[28:31], a[160:163], v[44:47], v[28:31]
    v_mul_f32 v123, v123, |v123|
    v_cvt_pk_bf16_f32 v116, v116, v117
    v_mfma_f32_16x16x32_bf16 v[28:31], a[148:151], v[40:43], v[28:31]
    v_cvt_pk_bf16_f32 v118, v118, v119
    v_cvt_pk_bf16_f32 v120, v120, v121
    v_mfma_f32_16x16x32_bf16 v[32:35], a[152:155], v[40:43], v[32:35]
    ds_read_b128 v[40:43], v3 offset:16384
    v_cvt_pk_bf16_f32 v122, v122, v123
    v_mfma_f32_16x16x32_bf16 v[32:35], a[164:167], v[44:47], v[32:35]
    ds_read_b128 v[44:47], v3 offset:17408
    s_waitcnt lgkmcnt(3)
    v_mfma_f32_16x16x32_bf16 v[32:35], a[176:179], v[48:51], v[32:35]
    v_pk_max_i16 v92, v116, 0
    v_pk_max_i16 v93, v118, 0
    v_mfma_f32_16x16x32_bf16 v[32:35], a[188:191], v[52:55], v[32:35]
    s_waitcnt lgkmcnt(2)
    v_pk_max_i16 v94, v120, 0
    v_pk_max_i16 v95, v122, 0
    v_mfma_f32_16x16x32_bf16 v[28:31], a[184:187], v[52:55], v[28:31]
    buffer_store_dwordx4 v[92:95], v1, s[12:15], s36 offen sc1
    v_add_u32 v2, s35, v1
    v_mfma_f32_16x16x32_bf16 v[28:31], a[172:175], v[48:51], v[28:31]
    s_add_u32 s36, s36, 116736
    v_add_f32 v100, v100, v108
    v_add_f32 v101, v101, v109
    v_mfma_f32_16x16x32_bf16 v[24:27], a[168:171], v[48:51], v[24:27]
    ds_read_b128 v[48:51], v3 offset:18432
    v_add_f32 v102, v102, v110
    v_mfma_f32_16x16x32_bf16 v[24:27], a[180:183], v[52:55], v[24:27]
    ds_read_b128 v[52:55], v3 offset:19456
    s_waitcnt lgkmcnt(2)
    v_mfma_f32_16x16x32_bf16 v[24:27], a[192:195], v[40:43], v[24:27]
    buffer_load_dword v5, v4, s[4:7], s16 offen sc1
    v_mfma_f32_16x16x32_bf16 v[24:27], a[204:207], v[44:47], v[24:27]
    v_add_f32 v103, v103, v111
    v_add_f32 v104, v104, v112
    v_mfma_f32_16x16x32_bf16 v[28:31], a[208:211], v[44:47], v[28:31]
    v_add_f32 v105, v105, v113
    v_add_f32 v106, v106, v114
    v_mfma_f32_16x16x32_bf16 v[28:31], a[196:199], v[40:43], v[28:31]
    buffer_load_dwordx4 v1, s[8:11], s37 offen offset:0 sc1 lds
    v_mfma_f32_16x16x32_bf16 v[32:35], a[200:203], v[40:43], v[32:35]
    ds_read_b128 v[40:43], v3 offset:20480
    v_add_f32 v107, v107, v115
    v_mfma_f32_16x16x32_bf16 v[32:35], a[212:215], v[44:47], v[32:35]
    ds_read_b128 v[44:47], v3 offset:21504
    s_waitcnt lgkmcnt(2)
    v_mfma_f32_16x16x32_bf16 v[32:35], a[224:227], v[48:51], v[32:35]
    buffer_load_dwordx4 v1, s[8:11], s37 offen offset:1024 sc1 lds
    v_mfma_f32_16x16x32_bf16 v[32:35], a[236:239], v[52:55], v[32:35]
    v_add_f32 v100, v100, v104
    v_add_f32 v101, v101, v105
    v_mfma_f32_16x16x32_bf16 v[28:31], a[232:235], v[52:55], v[28:31]
    v_add_f32 v102, v102, v106
    v_add_f32 v103, v103, v107
    v_mfma_f32_16x16x32_bf16 v[28:31], a[220:223], v[48:51], v[28:31]
    buffer_load_dwordx4 v1, s[8:11], s37 offen offset:2048 sc1 lds
    v_mfma_f32_16x16x32_bf16 v[24:27], a[216:219], v[48:51], v[24:27]
    ds_read_b128 v[48:51], v3 offset:22528
    v_add_f32 v100, v100, v102
    v_mfma_f32_16x16x32_bf16 v[24:27], a[228:231], v[52:55], v[24:27]
    ds_read_b128 v[52:55], v3 offset:23552
    s_waitcnt lgkmcnt(2)
    v_mfma_f32_16x16x32_bf16 v[24:27], a[240:243], v[40:43], v[24:27]
    buffer_load_dwordx4 v1, s[8:11], s37 offen offset:3072 sc1 lds
    v_mfma_f32_16x16x32_bf16 v[24:27], a[252:255], v[44:47], v[24:27]
    s_add_u32 s32, s32, 1
    v_add_f32 v101, v101, v103
    s_add_u32 s33, s33, 36864
    v_mfma_f32_16x16x32_bf16 v[28:31], v[128:131], v[44:47], v[28:31]
    s_add_u32 s34, s34, 36864
    v_permlane16_swap_b32 v100, v101
    v_mfma_f32_16x16x32_bf16 v[28:31], a[244:247], v[40:43], v[28:31]
    s_cmp_ge_u32 s34, 147456
    s_cselect_b32 s38, 147456, 0
    v_add_f32 v100, v100, v101
    v_mfma_f32_16x16x32_bf16 v[32:35], a[248:251], v[40:43], v[32:35]
    ds_read_b128 v[40:43], v3 offset:24576
    v_mov_b32 v101, v100
    v_mfma_f32_16x16x32_bf16 v[32:35], v[132:135], v[44:47], v[32:35]
    ds_read_b128 v[44:47], v3 offset:25600
    s_waitcnt lgkmcnt(2)
    v_mfma_f32_16x16x32_bf16 v[32:35], v[144:147], v[48:51], v[32:35]
    s_sub_u32 s34, s34, s38
    v_permlane32_swap_b32 v100, v101
    v_mfma_f32_16x16x32_bf16 v[32:35], v[156:159], v[52:55], v[32:35]
    v_add_f32 v100, v100, v101
    v_mul_f32 v100, 0x3a800000, v100
    v_mfma_f32_16x16x32_bf16 v[28:31], v[152:155], v[52:55], v[28:31]
    v_mov_b32 v101, v100
    v_mfma_f32_16x16x32_bf16 v[28:31], v[140:143], v[48:51], v[28:31]
    s_nop 0
    v_permlane16_swap_b32 v100, v101
    v_mfma_f32_16x16x32_bf16 v[24:27], v[136:139], v[48:51], v[24:27]
    ds_read_b128 v[48:51], v3 offset:26624
    v_fma_f32 v101, -v100, v100, v101
    v_mfma_f32_16x16x32_bf16 v[24:27], v[148:151], v[52:55], v[24:27]
    ds_read_b128 v[52:55], v3 offset:27648
    s_waitcnt lgkmcnt(2)
    v_mfma_f32_16x16x32_bf16 v[24:27], v[160:163], v[40:43], v[24:27]
    v_max_f32 v101, 0, v101
    v_add_f32 v101, 0x3727c5ac, v101
    v_mfma_f32_16x16x32_bf16 v[24:27], v[172:175], v[44:47], v[24:27]
    v_rsq_f32 v21, v101
    v_mfma_f32_16x16x32_bf16 v[28:31], v[176:179], v[44:47], v[28:31]
    v_mul_f32 v100, v100, v21
    v_fma_f32 v80, -v100, v56, v68
    v_mfma_f32_16x16x32_bf16 v[28:31], v[164:167], v[40:43], v[28:31]
    v_fma_f32 v81, -v100, v57, v69
    v_fma_f32 v82, -v100, v58, v70
    v_mfma_f32_16x16x32_bf16 v[32:35], v[168:171], v[40:43], v[32:35]
    ds_read_b128 v[40:43], v3 offset:28672
    v_fma_f32 v83, -v100, v59, v71
    v_mfma_f32_16x16x32_bf16 v[32:35], v[180:183], v[44:47], v[32:35]
    ds_read_b128 v[44:47], v3 offset:29696
    s_waitcnt lgkmcnt(2)
    v_mfma_f32_16x16x32_bf16 v[32:35], v[192:195], v[48:51], v[32:35]
    v_fma_f32 v84, -v100, v60, v72
    v_fma_f32 v85, -v100, v61, v73
    v_mfma_f32_16x16x32_bf16 v[32:35], v[204:207], v[52:55], v[32:35]
    v_fma_f32 v86, -v100, v62, v74
    v_fma_f32 v87, -v100, v63, v75
    v_mfma_f32_16x16x32_bf16 v[28:31], v[200:203], v[52:55], v[28:31]
    v_fma_f32 v88, -v100, v64, v76
    v_fma_f32 v89, -v100, v65, v77
    v_mfma_f32_16x16x32_bf16 v[28:31], v[188:191], v[48:51], v[28:31]
    v_fma_f32 v90, -v100, v66, v78
    v_fma_f32 v91, -v100, v67, v79
    v_mfma_f32_16x16x32_bf16 v[24:27], v[184:187], v[48:51], v[24:27]
    ds_read_b128 v[48:51], v3 offset:30720
    v_mfma_f32_16x16x32_bf16 v[24:27], v[196:199], v[52:55], v[24:27]
    ds_read_b128 v[52:55], v3 offset:31744
    s_waitcnt lgkmcnt(2)
    v_mfma_f32_16x16x32_bf16 v[24:27], v[208:211], v[40:43], v[24:27]
    s_waitcnt vmcnt(7)
    v_mfma_f32_16x16x32_bf16 v[24:27], v[220:223], v[44:47], v[24:27]
    s_barrier
    v_mfma_f32_16x16x32_bf16 v[28:31], v[224:227], v[44:47], v[28:31]
    v_mfma_f32_16x16x32_bf16 v[28:31], v[212:215], v[40:43], v[28:31]
    v_mfma_f32_16x16x32_bf16 v[32:35], v[216:219], v[40:43], v[32:35]
    ds_read_b128 v[40:43], v2 offset:0
    v_mfma_f32_16x16x32_bf16 v[32:35], v[228:231], v[44:47], v[32:35]
    ds_read_b128 v[44:47], v2 offset:1024
    s_waitcnt vmcnt(5) lgkmcnt(2)
    v_mfma_f32_16x16x32_bf16 v[32:35], v[240:243], v[48:51], v[32:35]
    buffer_store_dword v6, v22, s[12:15], s17 offen sc1
    s_mov_b32 s14, s6
    v_mfma_f32_16x16x32_bf16 v[32:35], v[252:255], v[52:55], v[32:35]
    s_add_u32 s17, s17, 8192
    v_mfma_f32_16x16x32_bf16 v[28:31], v[248:251], v[52:55], v[28:31]
    v_mfma_f32_16x16x32_bf16 v[28:31], v[236:239], v[48:51], v[28:31]
    v_mfma_f32_16x16x32_bf16 v[24:27], v[232:235], v[48:51], v[24:27]
    ds_read_b128 v[48:51], v2 offset:2048
    v_mfma_f32_16x16x32_bf16 v[24:27], v[244:247], v[52:55], v[24:27]
    ds_read_b128 v[52:55], v2 offset:3072
    s_cmp_lt_i32 s31, 63
    s_cbranch_scc1 Lffa_body01
    s_branch L_exit
    .p2align 6
Lffa_body02:
    s_waitcnt lgkmcnt(2)
    v_mfma_f32_16x16x32_bf16 v[8:11], a[0:3], v[40:43], 0
    s_add_u32 m0, s34, 0
    s_waitcnt vmcnt(5)
    v_cmp_gt_i32 vcc, s32, v5
    v_mfma_f32_16x16x32_bf16 v[8:11], a[12:15], v[44:47], v[8:11]
    s_add_u32 s31, s31, 1
    v_mov_b32 v6, s31
    v_fma_f32 v124, v32, v21, v88
    v_mfma_f32_16x16x32_bf16 v[12:15], a[16:19], v[44:47], 0
    s_and_b64 vcc, vcc, s[18:19]
    s_cbranch_scc1 Lffa_v01
    v_mfma_f32_16x16x32_bf16 v[12:15], a[4:7], v[40:43], v[12:15]
    buffer_load_dwordx4 v1, s[8:11], s33 offen offset:0 sc1 lds
    v_mfma_f32_16x16x32_bf16 v[16:19], a[8:11], v[40:43], 0
    ds_read_b128 v[40:43], v2 offset:4096
    v_fma_f32 v125, v33, v21, v89
    v_mfma_f32_16x16x32_bf16 v[16:19], a[20:23], v[44:47], v[16:19]
    ds_read_b128 v[44:47], v2 offset:5120
    s_waitcnt lgkmcnt(2)
    v_mfma_f32_16x16x32_bf16 v[16:19], a[32:35], v[48:51], v[16:19]
    buffer_load_dwordx4 v1, s[8:11], s33 offen offset:1024 sc1 lds
    v_mfma_f32_16x16x32_bf16 v[16:19], a[44:47], v[52:55], v[16:19]
    s_add_u32 s35, s35, 36864
    v_fma_f32 v126, v34, v21, v90
    v_fma_f32 v127, v35, v21, v91
    v_mfma_f32_16x16x32_bf16 v[12:15], a[40:43], v[52:55], v[12:15]
    s_cmp_eq_u32 s35, 147456
    s_cselect_b32 s35, 0, s35
    v_mul_f32 v124, v124, |v124|
    v_mfma_f32_16x16x32_bf16 v[12:15], a[28:31], v[48:51], v[12:15]
    buffer_load_dwordx4 v1, s[8:11], s33 offen offset:2048 sc1 lds
    v_mfma_f32_16x16x32_bf16 v[8:11], a[24:27], v[48:51], v[8:11]
    ds_read_b128 v[48:51], v2 offset:6144
    v_mul_f32 v125, v125, |v125|
    v_mfma_f32_16x16x32_bf16 v[8:11], a[36:39], v[52:55], v[8:11]
    ds_read_b128 v[52:55], v2 offset:7168
    s_waitcnt lgkmcnt(2)
    v_mfma_f32_16x16x32_bf16 v[8:11], a[48:51], v[40:43], v[8:11]
    buffer_load_dwordx4 v1, s[8:11], s33 offen offset:3072 sc1 lds
    v_mfma_f32_16x16x32_bf16 v[8:11], a[60:63], v[44:47], v[8:11]
    s_add_u32 m0, s34, s3
    v_mul_f32 v126, v126, |v126|
    v_mul_f32 v127, v127, |v127|
    v_mfma_f32_16x16x32_bf16 v[12:15], a[64:67], v[44:47], v[12:15]
    s_add_u32 s37, s33, s3
    v_cvt_pk_bf16_f32 v124, v124, v125
    v_cvt_pk_bf16_f32 v126, v126, v127
    v_mfma_f32_16x16x32_bf16 v[12:15], a[52:55], v[40:43], v[12:15]
    buffer_load_dwordx4 v1, s[8:11], s37 offen offset:0 sc1 lds
    v_mfma_f32_16x16x32_bf16 v[16:19], a[56:59], v[40:43], v[16:19]
    ds_read_b128 v[40:43], v2 offset:8192
    v_pk_max_i16 v96, v124, 0
    v_mfma_f32_16x16x32_bf16 v[16:19], a[68:71], v[44:47], v[16:19]
    ds_read_b128 v[44:47], v2 offset:9216
    s_waitcnt lgkmcnt(2)
    v_mfma_f32_16x16x32_bf16 v[16:19], a[80:83], v[48:51], v[16:19]
    s_add_u32 s16, s16, 8192
    v_pk_max_i16 v97, v126, 0
    v_pk_max_i16 v98, v124, 0
    v_mfma_f32_16x16x32_bf16 v[16:19], a[92:95], v[52:55], v[16:19]
    s_add_u32 m0, s34, 16384
    v_pk_max_i16 v99, v126, 0
    v_fma_f32 v116, v24, v21, v80
    v_mfma_f32_16x16x32_bf16 v[12:15], a[88:91], v[52:55], v[12:15]
    s_add_u32 s37, s33, 16384
    v_permlane32_swap_b32 v96, v98
    v_mfma_f32_16x16x32_bf16 v[12:15], a[76:79], v[48:51], v[12:15]
    v_permlane32_swap_b32 v97, v99
    v_mfma_f32_16x16x32_bf16 v[8:11], a[72:75], v[48:51], v[8:11]
    ds_read_b128 v[48:51], v2 offset:10240
    v_fma_f32 v117, v25, v21, v81
    v_mfma_f32_16x16x32_bf16 v[8:11], a[84:87], v[52:55], v[8:11]
    ds_read_b128 v[52:55], v2 offset:11264
    s_waitcnt lgkmcnt(2)
    v_mfma_f32_16x16x32_bf16 v[8:11], a[96:99], v[40:43], v[8:11]
    buffer_store_dwordx4 v[96:99], v7, s[12:15], s36 offen sc1
    v_fma_f32 v118, v26, v21, v82
    v_mfma_f32_16x16x32_bf16 v[8:11], a[108:111], v[44:47], v[8:11]
    v_fma_f32 v119, v27, v21, v83
    v_fma_f32 v120, v28, v21, v84
    v_mfma_f32_16x16x32_bf16 v[12:15], a[112:115], v[44:47], v[12:15]
    v_fma_f32 v121, v29, v21, v85
    v_fma_f32 v122, v30, v21, v86
    v_mfma_f32_16x16x32_bf16 v[12:15], a[100:103], v[40:43], v[12:15]
    v_fma_f32 v123, v31, v21, v87
    v_mul_f32 v116, v116, |v116|
    v_mfma_f32_16x16x32_bf16 v[16:19], a[104:107], v[40:43], v[16:19]
    ds_read_b128 v[40:43], v2 offset:12288
    v_mul_f32 v117, v117, |v117|
    v_mfma_f32_16x16x32_bf16 v[16:19], a[116:119], v[44:47], v[16:19]
    ds_read_b128 v[44:47], v2 offset:13312
    s_waitcnt lgkmcnt(2)
    v_mfma_f32_16x16x32_bf16 v[16:19], a[128:131], v[48:51], v[16:19]
    v_sub_u32 v100, v2, v20
    v_mul_f32 v118, v118, |v118|
    v_mfma_f32_16x16x32_bf16 v[16:19], a[140:143], v[52:55], v[16:19]
    ds_read2st64_b64 v[112:115], v100 offset0:70 offset1:71
    v_mul_f32 v119, v119, |v119|
    v_mfma_f32_16x16x32_bf16 v[12:15], a[136:139], v[52:55], v[12:15]
    ds_read2st64_b64 v[108:111], v100 offset0:68 offset1:69
    v_mul_f32 v120, v120, |v120|
    v_mfma_f32_16x16x32_bf16 v[12:15], a[124:127], v[48:51], v[12:15]
    ds_read2st64_b64 v[104:107], v100 offset0:66 offset1:67
    v_mul_f32 v121, v121, |v121|
    v_mfma_f32_16x16x32_bf16 v[8:11], a[120:123], v[48:51], v[8:11]
    ds_read_b128 v[48:51], v2 offset:14336
    v_mul_f32 v122, v122, |v122|
    v_mfma_f32_16x16x32_bf16 v[8:11], a[132:135], v[52:55], v[8:11]
    ds_read_b128 v[52:55], v2 offset:15360
    s_waitcnt lgkmcnt(5)
    v_mfma_f32_16x16x32_bf16 v[8:11], a[144:147], v[40:43], v[8:11]
    s_waitcnt vmcnt(7)
    ds_read2st64_b64 v[100:103], v100 offset0:64 offset1:65
    v_mfma_f32_16x16x32_bf16 v[8:11], a[156:159], v[44:47], v[8:11]
    v_mul_f32 v123, v123, |v123|
    v_cvt_pk_bf16_f32 v116, v116, v117
    v_mfma_f32_16x16x32_bf16 v[12:15], a[160:163], v[44:47], v[12:15]
    s_barrier
    v_mfma_f32_16x16x32_bf16 v[12:15], a[148:151], v[40:43], v[12:15]
    v_cvt_pk_bf16_f32 v118, v118, v119
    v_cvt_pk_bf16_f32 v120, v120, v121
    v_mfma_f32_16x16x32_bf16 v[16:19], a[152:155], v[40:43], v[16:19]
    ds_read_b128 v[40:43], v2 offset:16384
    v_cvt_pk_bf16_f32 v122, v122, v123
    v_mfma_f32_16x16x32_bf16 v[16:19], a[164:167], v[44:47], v[16:19]
    ds_read_b128 v[44:47], v2 offset:17408
    s_waitcnt lgkmcnt(3)
    v_mfma_f32_16x16x32_bf16 v[16:19], a[176:179], v[48:51], v[16:19]
    v_pk_max_i16 v92, v116, 0
    v_pk_max_i16 v93, v118, 0
    v_mfma_f32_16x16x32_bf16 v[16:19], a[188:191], v[52:55], v[16:19]
    s_waitcnt lgkmcnt(2)
    v_pk_max_i16 v94, v120, 0
    v_pk_max_i16 v95, v122, 0
    v_mfma_f32_16x16x32_bf16 v[12:15], a[184:187], v[52:55], v[12:15]
    buffer_store_dwordx4 v[92:95], v1, s[12:15], s36 offen sc1
    v_add_u32 v3, s35, v1
    v_mfma_f32_16x16x32_bf16 v[12:15], a[172:175], v[48:51], v[12:15]
    s_add_u32 s36, s36, 116736
    v_add_f32 v100, v100, v108
    v_add_f32 v101, v101, v109
    v_mfma_f32_16x16x32_bf16 v[8:11], a[168:171], v[48:51], v[8:11]
    ds_read_b128 v[48:51], v2 offset:18432
    v_add_f32 v102, v102, v110
    v_mfma_f32_16x16x32_bf16 v[8:11], a[180:183], v[52:55], v[8:11]
    ds_read_b128 v[52:55], v2 offset:19456
    s_waitcnt lgkmcnt(2)
    v_mfma_f32_16x16x32_bf16 v[8:11], a[192:195], v[40:43], v[8:11]
    buffer_load_dword v5, v4, s[4:7], s16 offen sc1
    v_mfma_f32_16x16x32_bf16 v[8:11], a[204:207], v[44:47], v[8:11]
    v_add_f32 v103, v103, v111
    v_add_f32 v104, v104, v112
    v_mfma_f32_16x16x32_bf16 v[12:15], a[208:211], v[44:47], v[12:15]
    v_add_f32 v105, v105, v113
    v_add_f32 v106, v106, v114
    v_mfma_f32_16x16x32_bf16 v[12:15], a[196:199], v[40:43], v[12:15]
    buffer_load_dwordx4 v1, s[8:11], s37 offen offset:0 sc1 lds
    v_mfma_f32_16x16x32_bf16 v[16:19], a[200:203], v[40:43], v[16:19]
    ds_read_b128 v[40:43], v2 offset:20480
    v_add_f32 v107, v107, v115
    v_mfma_f32_16x16x32_bf16 v[16:19], a[212:215], v[44:47], v[16:19]
    ds_read_b128 v[44:47], v2 offset:21504
    s_waitcnt lgkmcnt(2)
    v_mfma_f32_16x16x32_bf16 v[16:19], a[224:227], v[48:51], v[16:19]
    buffer_load_dwordx4 v1, s[8:11], s37 offen offset:1024 sc1 lds
    v_mfma_f32_16x16x32_bf16 v[16:19], a[236:239], v[52:55], v[16:19]
    v_add_f32 v100, v100, v104
    v_add_f32 v101, v101, v105
    v_mfma_f32_16x16x32_bf16 v[12:15], a[232:235], v[52:55], v[12:15]
    v_add_f32 v102, v102, v106
    v_add_f32 v103, v103, v107
    v_mfma_f32_16x16x32_bf16 v[12:15], a[220:223], v[48:51], v[12:15]
    buffer_load_dwordx4 v1, s[8:11], s37 offen offset:2048 sc1 lds
    v_mfma_f32_16x16x32_bf16 v[8:11], a[216:219], v[48:51], v[8:11]
    ds_read_b128 v[48:51], v2 offset:22528
    v_add_f32 v100, v100, v102
    v_mfma_f32_16x16x32_bf16 v[8:11], a[228:231], v[52:55], v[8:11]
    ds_read_b128 v[52:55], v2 offset:23552
    s_waitcnt lgkmcnt(2)
    v_mfma_f32_16x16x32_bf16 v[8:11], a[240:243], v[40:43], v[8:11]
    buffer_load_dwordx4 v1, s[8:11], s37 offen offset:3072 sc1 lds
    v_mfma_f32_16x16x32_bf16 v[8:11], a[252:255], v[44:47], v[8:11]
    s_add_u32 s32, s32, 1
    v_add_f32 v101, v101, v103
    s_add_u32 s33, s33, 36864
    v_mfma_f32_16x16x32_bf16 v[12:15], v[128:131], v[44:47], v[12:15]
    s_add_u32 s34, s34, 36864
    v_permlane16_swap_b32 v100, v101
    v_mfma_f32_16x16x32_bf16 v[12:15], a[244:247], v[40:43], v[12:15]
    s_cmp_ge_u32 s34, 147456
    s_cselect_b32 s38, 147456, 0
    v_add_f32 v100, v100, v101
    v_mfma_f32_16x16x32_bf16 v[16:19], a[248:251], v[40:43], v[16:19]
    ds_read_b128 v[40:43], v2 offset:24576
    v_mov_b32 v101, v100
    v_mfma_f32_16x16x32_bf16 v[16:19], v[132:135], v[44:47], v[16:19]
    ds_read_b128 v[44:47], v2 offset:25600
    s_waitcnt lgkmcnt(2)
    v_mfma_f32_16x16x32_bf16 v[16:19], v[144:147], v[48:51], v[16:19]
    s_sub_u32 s34, s34, s38
    v_permlane32_swap_b32 v100, v101
    v_mfma_f32_16x16x32_bf16 v[16:19], v[156:159], v[52:55], v[16:19]
    v_add_f32 v100, v100, v101
    v_mul_f32 v100, 0x3a800000, v100
    v_mfma_f32_16x16x32_bf16 v[12:15], v[152:155], v[52:55], v[12:15]
    v_mov_b32 v101, v100
    v_mfma_f32_16x16x32_bf16 v[12:15], v[140:143], v[48:51], v[12:15]
    s_nop 0
    v_permlane16_swap_b32 v100, v101
    v_mfma_f32_16x16x32_bf16 v[8:11], v[136:139], v[48:51], v[8:11]
    ds_read_b128 v[48:51], v2 offset:26624
    v_fma_f32 v101, -v100, v100, v101
    v_mfma_f32_16x16x32_bf16 v[8:11], v[148:151], v[52:55], v[8:11]
    ds_read_b128 v[52:55], v2 offset:27648
    s_waitcnt lgkmcnt(2)
    v_mfma_f32_16x16x32_bf16 v[8:11], v[160:163], v[40:43], v[8:11]
    v_max_f32 v101, 0, v101
    v_add_f32 v101, 0x3727c5ac, v101
    v_mfma_f32_16x16x32_bf16 v[8:11], v[172:175], v[44:47], v[8:11]
    v_rsq_f32 v21, v101
    v_mfma_f32_16x16x32_bf16 v[12:15], v[176:179], v[44:47], v[12:15]
    v_mul_f32 v100, v100, v21
    v_fma_f32 v80, -v100, v56, v68
    v_mfma_f32_16x16x32_bf16 v[12:15], v[164:167], v[40:43], v[12:15]
    v_fma_f32 v81, -v100, v57, v69
    v_fma_f32 v82, -v100, v58, v70
    v_mfma_f32_16x16x32_bf16 v[16:19], v[168:171], v[40:43], v[16:19]
    ds_read_b128 v[40:43], v2 offset:28672
    v_fma_f32 v83, -v100, v59, v71
    v_mfma_f32_16x16x32_bf16 v[16:19], v[180:183], v[44:47], v[16:19]
    ds_read_b128 v[44:47], v2 offset:29696
    s_waitcnt lgkmcnt(2)
    v_mfma_f32_16x16x32_bf16 v[16:19], v[192:195], v[48:51], v[16:19]
    v_fma_f32 v84, -v100, v60, v72
    v_fma_f32 v85, -v100, v61, v73
    v_mfma_f32_16x16x32_bf16 v[16:19], v[204:207], v[52:55], v[16:19]
    v_fma_f32 v86, -v100, v62, v74
    v_fma_f32 v87, -v100, v63, v75
    v_mfma_f32_16x16x32_bf16 v[12:15], v[200:203], v[52:55], v[12:15]
    v_fma_f32 v88, -v100, v64, v76
    v_fma_f32 v89, -v100, v65, v77
    v_mfma_f32_16x16x32_bf16 v[12:15], v[188:191], v[48:51], v[12:15]
    v_fma_f32 v90, -v100, v66, v78
    v_fma_f32 v91, -v100, v67, v79
    v_mfma_f32_16x16x32_bf16 v[8:11], v[184:187], v[48:51], v[8:11]
    ds_read_b128 v[48:51], v2 offset:30720
    v_mfma_f32_16x16x32_bf16 v[8:11], v[196:199], v[52:55], v[8:11]
    ds_read_b128 v[52:55], v2 offset:31744
    s_waitcnt lgkmcnt(2)
    v_mfma_f32_16x16x32_bf16 v[8:11], v[208:211], v[40:43], v[8:11]
    s_waitcnt vmcnt(7)
    v_mfma_f32_16x16x32_bf16 v[8:11], v[220:223], v[44:47], v[8:11]
    v_mfma_f32_16x16x32_bf16 v[12:15], v[224:227], v[44:47], v[12:15]
    s_barrier
    v_mfma_f32_16x16x32_bf16 v[12:15], v[212:215], v[40:43], v[12:15]
    v_mfma_f32_16x16x32_bf16 v[16:19], v[216:219], v[40:43], v[16:19]
    ds_read_b128 v[40:43], v3 offset:0
    v_mfma_f32_16x16x32_bf16 v[16:19], v[228:231], v[44:47], v[16:19]
    ds_read_b128 v[44:47], v3 offset:1024
    s_waitcnt vmcnt(5) lgkmcnt(2)
    v_mfma_f32_16x16x32_bf16 v[16:19], v[240:243], v[48:51], v[16:19]
    buffer_store_dword v6, v22, s[12:15], s17 offen sc1
    s_mov_b32 s14, s6
    v_mfma_f32_16x16x32_bf16 v[16:19], v[252:255], v[52:55], v[16:19]
    s_add_u32 s17, s17, 8192
    v_mfma_f32_16x16x32_bf16 v[12:15], v[248:251], v[52:55], v[12:15]
    v_mfma_f32_16x16x32_bf16 v[12:15], v[236:239], v[48:51], v[12:15]
    v_mfma_f32_16x16x32_bf16 v[8:11], v[232:235], v[48:51], v[8:11]
    ds_read_b128 v[48:51], v3 offset:2048
    v_mfma_f32_16x16x32_bf16 v[8:11], v[244:247], v[52:55], v[8:11]
    ds_read_b128 v[52:55], v3 offset:3072
Lffa_body12:
    s_waitcnt lgkmcnt(2)
    v_mfma_f32_16x16x32_bf16 v[24:27], a[0:3], v[40:43], 0
    s_add_u32 m0, s34, 0
    s_waitcnt vmcnt(5)
    v_cmp_gt_i32 vcc, s32, v5
    v_mfma_f32_16x16x32_bf16 v[24:27], a[12:15], v[44:47], v[24:27]
    s_add_u32 s31, s31, 1
    v_mov_b32 v6, s31
    v_fma_f32 v124, v16, v21, v88
    v_mfma_f32_16x16x32_bf16 v[28:31], a[16:19], v[44:47], 0
    s_and_b64 vcc, vcc, s[18:19]
    s_cbranch_scc1 Lffa_v11
    v_mfma_f32_16x16x32_bf16 v[28:31], a[4:7], v[40:43], v[28:31]
    buffer_load_dwordx4 v1, s[8:11], s33 offen offset:0 sc1 lds
    v_mfma_f32_16x16x32_bf16 v[32:35], a[8:11], v[40:43], 0
    ds_read_b128 v[40:43], v3 offset:4096
    v_fma_f32 v125, v17, v21, v89
    v_mfma_f32_16x16x32_bf16 v[32:35], a[20:23], v[44:47], v[32:35]
    ds_read_b128 v[44:47], v3 offset:5120
    s_waitcnt lgkmcnt(2)
    v_mfma_f32_16x16x32_bf16 v[32:35], a[32:35], v[48:51], v[32:35]
    buffer_load_dwordx4 v1, s[8:11], s33 offen offset:1024 sc1 lds
    v_mfma_f32_16x16x32_bf16 v[32:35], a[44:47], v[52:55], v[32:35]
    s_add_u32 s35, s35, 36864
    v_fma_f32 v126, v18, v21, v90
    v_fma_f32 v127, v19, v21, v91
    v_mfma_f32_16x16x32_bf16 v[28:31], a[40:43], v[52:55], v[28:31]
    s_cmp_eq_u32 s35, 147456
    s_cselect_b32 s35, 0, s35
    v_mul_f32 v124, v124, |v124|
    v_mfma_f32_16x16x32_bf16 v[28:31], a[28:31], v[48:51], v[28:31]
    buffer_load_dwordx4 v1, s[8:11], s33 offen offset:2048 sc1 lds
    v_mfma_f32_16x16x32_bf16 v[24:27], a[24:27], v[48:51], v[24:27]
    ds_read_b128 v[48:51], v3 offset:6144
    v_mul_f32 v125, v125, |v125|
    v_mfma_f32_16x16x32_bf16 v[24:27], a[36:39], v[52:55], v[24:27]
    ds_read_b128 v[52:55], v3 offset:7168
    s_waitcnt lgkmcnt(2)
    v_mfma_f32_16x16x32_bf16 v[24:27], a[48:51], v[40:43], v[24:27]
    buffer_load_dwordx4 v1, s[8:11], s33 offen offset:3072 sc1 lds
    v_mfma_f32_16x16x32_bf16 v[24:27], a[60:63], v[44:47], v[24:27]
    s_add_u32 m0, s34, s3
    v_mul_f32 v126, v126, |v126|
    v_mul_f32 v127, v127, |v127|
    v_mfma_f32_16x16x32_bf16 v[28:31], a[64:67], v[44:47], v[28:31]
    s_add_u32 s37, s33, s3
    v_cvt_pk_bf16_f32 v124, v124, v125
    v_cvt_pk_bf16_f32 v126, v126, v127
    v_mfma_f32_16x16x32_bf16 v[28:31], a[52:55], v[40:43], v[28:31]
    buffer_load_dwordx4 v1, s[8:11], s37 offen offset:0 sc1 lds
    v_mfma_f32_16x16x32_bf16 v[32:35], a[56:59], v[40:43], v[32:35]
    ds_read_b128 v[40:43], v3 offset:8192
    v_pk_max_i16 v96, v124, 0
    v_mfma_f32_16x16x32_bf16 v[32:35], a[68:71], v[44:47], v[32:35]
    ds_read_b128 v[44:47], v3 offset:9216
    s_waitcnt lgkmcnt(2)
    v_mfma_f32_16x16x32_bf16 v[32:35], a[80:83], v[48:51], v[32:35]
    s_add_u32 s16, s16, 8192
    v_pk_max_i16 v97, v126, 0
    v_pk_max_i16 v98, v124, 0
    v_mfma_f32_16x16x32_bf16 v[32:35], a[92:95], v[52:55], v[32:35]
    s_add_u32 m0, s34, 16384
    v_pk_max_i16 v99, v126, 0
    v_fma_f32 v116, v8, v21, v80
    v_mfma_f32_16x16x32_bf16 v[28:31], a[88:91], v[52:55], v[28:31]
    s_add_u32 s37, s33, 16384
    v_permlane32_swap_b32 v96, v98
    v_mfma_f32_16x16x32_bf16 v[28:31], a[76:79], v[48:51], v[28:31]
    v_permlane32_swap_b32 v97, v99
    v_mfma_f32_16x16x32_bf16 v[24:27], a[72:75], v[48:51], v[24:27]
    ds_read_b128 v[48:51], v3 offset:10240
    v_fma_f32 v117, v9, v21, v81
    v_mfma_f32_16x16x32_bf16 v[24:27], a[84:87], v[52:55], v[24:27]
    ds_read_b128 v[52:55], v3 offset:11264
    s_waitcnt lgkmcnt(2)
    v_mfma_f32_16x16x32_bf16 v[24:27], a[96:99], v[40:43], v[24:27]
    buffer_store_dwordx4 v[96:99], v7, s[12:15], s36 offen sc1
    v_fma_f32 v118, v10, v21, v82
    v_mfma_f32_16x16x32_bf16 v[24:27], a[108:111], v[44:47], v[24:27]
    v_fma_f32 v119, v11, v21, v83
    v_fma_f32 v120, v12, v21, v84
    v_mfma_f32_16x16x32_bf16 v[28:31], a[112:115], v[44:47], v[28:31]
    v_fma_f32 v121, v13, v21, v85
    v_fma_f32 v122, v14, v21, v86
    v_mfma_f32_16x16x32_bf16 v[28:31], a[100:103], v[40:43], v[28:31]
    v_fma_f32 v123, v15, v21, v87
    v_mul_f32 v116, v116, |v116|
    v_mfma_f32_16x16x32_bf16 v[32:35], a[104:107], v[40:43], v[32:35]
    ds_read_b128 v[40:43], v3 offset:12288
    v_mul_f32 v117, v117, |v117|
    v_mfma_f32_16x16x32_bf16 v[32:35], a[116:119], v[44:47], v[32:35]
    ds_read_b128 v[44:47], v3 offset:13312
    s_waitcnt lgkmcnt(2)
    v_mfma_f32_16x16x32_bf16 v[32:35], a[128:131], v[48:51], v[32:35]
    v_sub_u32 v100, v3, v20
    v_mul_f32 v118, v118, |v118|
    v_mfma_f32_16x16x32_bf16 v[32:35], a[140:143], v[52:55], v[32:35]
    ds_read2st64_b64 v[112:115], v100 offset0:70 offset1:71
    v_mul_f32 v119, v119, |v119|
    v_mfma_f32_16x16x32_bf16 v[28:31], a[136:139], v[52:55], v[28:31]
    ds_read2st64_b64 v[108:111], v100 offset0:68 offset1:69
    v_mul_f32 v120, v120, |v120|
    v_mfma_f32_16x16x32_bf16 v[28:31], a[124:127], v[48:51], v[28:31]
    ds_read2st64_b64 v[104:107], v100 offset0:66 offset1:67
    v_mul_f32 v121, v121, |v121|
    v_mfma_f32_16x16x32_bf16 v[24:27], a[120:123], v[48:51], v[24:27]
    ds_read_b128 v[48:51], v3 offset:14336
    v_mul_f32 v122, v122, |v122|
    v_mfma_f32_16x16x32_bf16 v[24:27], a[132:135], v[52:55], v[24:27]
    ds_read_b128 v[52:55], v3 offset:15360
    s_waitcnt lgkmcnt(5)
    v_mfma_f32_16x16x32_bf16 v[24:27], a[144:147], v[40:43], v[24:27]
    s_waitcnt vmcnt(7)
    ds_read2st64_b64 v[100:103], v100 offset0:64 offset1:65
    v_mfma_f32_16x16x32_bf16 v[24:27], a[156:159], v[44:47], v[24:27]
    v_mul_f32 v123, v123, |v123|
    v_cvt_pk_bf16_f32 v116, v116, v117
    v_mfma_f32_16x16x32_bf16 v[28:31], a[160:163], v[44:47], v[28:31]
    s_barrier
    v_mfma_f32_16x16x32_bf16 v[28:31], a[148:151], v[40:43], v[28:31]
    v_cvt_pk_bf16_f32 v118, v118, v119
    v_cvt_pk_bf16_f32 v120, v120, v121
    v_mfma_f32_16x16x32_bf16 v[32:35], a[152:155], v[40:43], v[32:35]
    ds_read_b128 v[40:43], v3 offset:16384
    v_cvt_pk_bf16_f32 v122, v122, v123
    v_mfma_f32_16x16x32_bf16 v[32:35], a[164:167], v[44:47], v[32:35]
    ds_read_b128 v[44:47], v3 offset:17408
    s_waitcnt lgkmcnt(3)
    v_mfma_f32_16x16x32_bf16 v[32:35], a[176:179], v[48:51], v[32:35]
    v_pk_max_i16 v92, v116, 0
    v_pk_max_i16 v93, v118, 0
    v_mfma_f32_16x16x32_bf16 v[32:35], a[188:191], v[52:55], v[32:35]
    s_waitcnt lgkmcnt(2)
    v_pk_max_i16 v94, v120, 0
    v_pk_max_i16 v95, v122, 0
    v_mfma_f32_16x16x32_bf16 v[28:31], a[184:187], v[52:55], v[28:31]
    buffer_store_dwordx4 v[92:95], v1, s[12:15], s36 offen sc1
    v_add_u32 v2, s35, v1
    v_mfma_f32_16x16x32_bf16 v[28:31], a[172:175], v[48:51], v[28:31]
    s_add_u32 s36, s36, 116736
    v_add_f32 v100, v100, v108
    v_add_f32 v101, v101, v109
    v_mfma_f32_16x16x32_bf16 v[24:27], a[168:171], v[48:51], v[24:27]
    ds_read_b128 v[48:51], v3 offset:18432
    v_add_f32 v102, v102, v110
    v_mfma_f32_16x16x32_bf16 v[24:27], a[180:183], v[52:55], v[24:27]
    ds_read_b128 v[52:55], v3 offset:19456
    s_waitcnt lgkmcnt(2)
    v_mfma_f32_16x16x32_bf16 v[24:27], a[192:195], v[40:43], v[24:27]
    buffer_load_dword v5, v4, s[4:7], s16 offen sc1
    v_mfma_f32_16x16x32_bf16 v[24:27], a[204:207], v[44:47], v[24:27]
    v_add_f32 v103, v103, v111
    v_add_f32 v104, v104, v112
    v_mfma_f32_16x16x32_bf16 v[28:31], a[208:211], v[44:47], v[28:31]
    v_add_f32 v105, v105, v113
    v_add_f32 v106, v106, v114
    v_mfma_f32_16x16x32_bf16 v[28:31], a[196:199], v[40:43], v[28:31]
    buffer_load_dwordx4 v1, s[8:11], s37 offen offset:0 sc1 lds
    v_mfma_f32_16x16x32_bf16 v[32:35], a[200:203], v[40:43], v[32:35]
    ds_read_b128 v[40:43], v3 offset:20480
    v_add_f32 v107, v107, v115
    v_mfma_f32_16x16x32_bf16 v[32:35], a[212:215], v[44:47], v[32:35]
    ds_read_b128 v[44:47], v3 offset:21504
    s_waitcnt lgkmcnt(2)
    v_mfma_f32_16x16x32_bf16 v[32:35], a[224:227], v[48:51], v[32:35]
    buffer_load_dwordx4 v1, s[8:11], s37 offen offset:1024 sc1 lds
    v_mfma_f32_16x16x32_bf16 v[32:35], a[236:239], v[52:55], v[32:35]
    v_add_f32 v100, v100, v104
    v_add_f32 v101, v101, v105
    v_mfma_f32_16x16x32_bf16 v[28:31], a[232:235], v[52:55], v[28:31]
    v_add_f32 v102, v102, v106
    v_add_f32 v103, v103, v107
    v_mfma_f32_16x16x32_bf16 v[28:31], a[220:223], v[48:51], v[28:31]
    buffer_load_dwordx4 v1, s[8:11], s37 offen offset:2048 sc1 lds
    v_mfma_f32_16x16x32_bf16 v[24:27], a[216:219], v[48:51], v[24:27]
    ds_read_b128 v[48:51], v3 offset:22528
    v_add_f32 v100, v100, v102
    v_mfma_f32_16x16x32_bf16 v[24:27], a[228:231], v[52:55], v[24:27]
    ds_read_b128 v[52:55], v3 offset:23552
    s_waitcnt lgkmcnt(2)
    v_mfma_f32_16x16x32_bf16 v[24:27], a[240:243], v[40:43], v[24:27]
    buffer_load_dwordx4 v1, s[8:11], s37 offen offset:3072 sc1 lds
    v_mfma_f32_16x16x32_bf16 v[24:27], a[252:255], v[44:47], v[24:27]
    s_add_u32 s32, s32, 1
    v_add_f32 v101, v101, v103
    s_add_u32 s33, s33, 36864
    v_mfma_f32_16x16x32_bf16 v[28:31], v[128:131], v[44:47], v[28:31]
    s_add_u32 s34, s34, 36864
    v_permlane16_swap_b32 v100, v101
    v_mfma_f32_16x16x32_bf16 v[28:31], a[244:247], v[40:43], v[28:31]
    s_cmp_ge_u32 s34, 147456
    s_cselect_b32 s38, 147456, 0
    v_add_f32 v100, v100, v101
    v_mfma_f32_16x16x32_bf16 v[32:35], a[248:251], v[40:43], v[32:35]
    ds_read_b128 v[40:43], v3 offset:24576
    v_mov_b32 v101, v100
    v_mfma_f32_16x16x32_bf16 v[32:35], v[132:135], v[44:47], v[32:35]
    ds_read_b128 v[44:47], v3 offset:25600
    s_waitcnt lgkmcnt(2)
    v_mfma_f32_16x16x32_bf16 v[32:35], v[144:147], v[48:51], v[32:35]
    s_sub_u32 s34, s34, s38
    v_permlane32_swap_b32 v100, v101
    v_mfma_f32_16x16x32_bf16 v[32:35], v[156:159], v[52:55], v[32:35]
    v_add_f32 v100, v100, v101
    v_mul_f32 v100, 0x3a800000, v100
    v_mfma_f32_16x16x32_bf16 v[28:31], v[152:155], v[52:55], v[28:31]
    v_mov_b32 v101, v100
    v_mfma_f32_16x16x32_bf16 v[28:31], v[140:143], v[48:51], v[28:31]
    s_nop 0
    v_permlane16_swap_b32 v100, v101
    v_mfma_f32_16x16x32_bf16 v[24:27], v[136:139], v[48:51], v[24:27]
    ds_read_b128 v[48:51], v3 offset:26624
    v_fma_f32 v101, -v100, v100, v101
    v_mfma_f32_16x16x32_bf16 v[24:27], v[148:151], v[52:55], v[24:27]
    ds_read_b128 v[52:55], v3 offset:27648
    s_waitcnt lgkmcnt(2)
    v_mfma_f32_16x16x32_bf16 v[24:27], v[160:163], v[40:43], v[24:27]
    v_max_f32 v101, 0, v101
    v_add_f32 v101, 0x3727c5ac, v101
    v_mfma_f32_16x16x32_bf16 v[24:27], v[172:175], v[44:47], v[24:27]
    v_rsq_f32 v21, v101
    v_mfma_f32_16x16x32_bf16 v[28:31], v[176:179], v[44:47], v[28:31]
    v_mul_f32 v100, v100, v21
    v_fma_f32 v80, -v100, v56, v68
    v_mfma_f32_16x16x32_bf16 v[28:31], v[164:167], v[40:43], v[28:31]
    v_fma_f32 v81, -v100, v57, v69
    v_fma_f32 v82, -v100, v58, v70
    v_mfma_f32_16x16x32_bf16 v[32:35], v[168:171], v[40:43], v[32:35]
    ds_read_b128 v[40:43], v3 offset:28672
    v_fma_f32 v83, -v100, v59, v71
    v_mfma_f32_16x16x32_bf16 v[32:35], v[180:183], v[44:47], v[32:35]
    ds_read_b128 v[44:47], v3 offset:29696
    s_waitcnt lgkmcnt(2)
    v_mfma_f32_16x16x32_bf16 v[32:35], v[192:195], v[48:51], v[32:35]
    v_fma_f32 v84, -v100, v60, v72
    v_fma_f32 v85, -v100, v61, v73
    v_mfma_f32_16x16x32_bf16 v[32:35], v[204:207], v[52:55], v[32:35]
    v_fma_f32 v86, -v100, v62, v74
    v_fma_f32 v87, -v100, v63, v75
    v_mfma_f32_16x16x32_bf16 v[28:31], v[200:203], v[52:55], v[28:31]
    v_fma_f32 v88, -v100, v64, v76
    v_fma_f32 v89, -v100, v65, v77
    v_mfma_f32_16x16x32_bf16 v[28:31], v[188:191], v[48:51], v[28:31]
    v_fma_f32 v90, -v100, v66, v78
    v_fma_f32 v91, -v100, v67, v79
    v_mfma_f32_16x16x32_bf16 v[24:27], v[184:187], v[48:51], v[24:27]
    ds_read_b128 v[48:51], v3 offset:30720
    v_mfma_f32_16x16x32_bf16 v[24:27], v[196:199], v[52:55], v[24:27]
    ds_read_b128 v[52:55], v3 offset:31744
    s_waitcnt lgkmcnt(2)
    v_mfma_f32_16x16x32_bf16 v[24:27], v[208:211], v[40:43], v[24:27]
    s_waitcnt vmcnt(7)
    v_mfma_f32_16x16x32_bf16 v[24:27], v[220:223], v[44:47], v[24:27]
    v_mfma_f32_16x16x32_bf16 v[28:31], v[224:227], v[44:47], v[28:31]
    s_barrier
    v_mfma_f32_16x16x32_bf16 v[28:31], v[212:215], v[40:43], v[28:31]
    v_mfma_f32_16x16x32_bf16 v[32:35], v[216:219], v[40:43], v[32:35]
    ds_read_b128 v[40:43], v2 offset:0
    v_mfma_f32_16x16x32_bf16 v[32:35], v[228:231], v[44:47], v[32:35]
    ds_read_b128 v[44:47], v2 offset:1024
    s_waitcnt vmcnt(5) lgkmcnt(2)
    v_mfma_f32_16x16x32_bf16 v[32:35], v[240:243], v[48:51], v[32:35]
    buffer_store_dword v6, v22, s[12:15], s17 offen sc1
    s_mov_b32 s14, s6
    v_mfma_f32_16x16x32_bf16 v[32:35], v[252:255], v[52:55], v[32:35]
    s_add_u32 s17, s17, 8192
    v_mfma_f32_16x16x32_bf16 v[28:31], v[248:251], v[52:55], v[28:31]
    v_mfma_f32_16x16x32_bf16 v[28:31], v[236:239], v[48:51], v[28:31]
    v_mfma_f32_16x16x32_bf16 v[24:27], v[232:235], v[48:51], v[24:27]
    ds_read_b128 v[48:51], v2 offset:2048
    v_mfma_f32_16x16x32_bf16 v[24:27], v[244:247], v[52:55], v[24:27]
    ds_read_b128 v[52:55], v2 offset:3072
    s_cmp_lt_i32 s31, 63
    s_cbranch_scc1 Lffa_body02
    s_branch L_exit
    .p2align 6
Lffa_body03:
    s_waitcnt lgkmcnt(2)
    v_mfma_f32_16x16x32_bf16 v[8:11], a[0:3], v[40:43], 0
    s_add_u32 m0, s34, 0
    s_waitcnt vmcnt(5)
    v_cmp_gt_i32 vcc, s32, v5
    v_mfma_f32_16x16x32_bf16 v[8:11], a[12:15], v[44:47], v[8:11]
    s_add_u32 s31, s31, 1
    v_mov_b32 v6, s31
    v_fma_f32 v124, v32, v21, v88
    v_mfma_f32_16x16x32_bf16 v[12:15], a[16:19], v[44:47], 0
    s_and_b64 vcc, vcc, s[18:19]
    s_cbranch_scc1 Lffa_v01
    v_mfma_f32_16x16x32_bf16 v[12:15], a[4:7], v[40:43], v[12:15]
    buffer_load_dwordx4 v1, s[8:11], s33 offen offset:0 sc1 lds
    v_mfma_f32_16x16x32_bf16 v[16:19], a[8:11], v[40:43], 0
    ds_read_b128 v[40:43], v2 offset:4096
    v_fma_f32 v125, v33, v21, v89
    v_mfma_f32_16x16x32_bf16 v[16:19], a[20:23], v[44:47], v[16:19]
    ds_read_b128 v[44:47], v2 offset:5120
    s_waitcnt lgkmcnt(2)
    v_mfma_f32_16x16x32_bf16 v[16:19], a[32:35], v[48:51], v[16:19]
    buffer_load_dwordx4 v1, s[8:11], s33 offen offset:1024 sc1 lds
    v_mfma_f32_16x16x32_bf16 v[16:19], a[44:47], v[52:55], v[16:19]
    s_add_u32 s35, s35, 36864
    v_fma_f32 v126, v34, v21, v90
    v_fma_f32 v127, v35, v21, v91
    v_mfma_f32_16x16x32_bf16 v[12:15], a[40:43], v[52:55], v[12:15]
    s_cmp_eq_u32 s35, 147456
    s_cselect_b32 s35, 0, s35
    v_mul_f32 v124, v124, |v124|
    v_mfma_f32_16x16x32_bf16 v[12:15], a[28:31], v[48:51], v[12:15]
    buffer_load_dwordx4 v1, s[8:11], s33 offen offset:2048 sc1 lds
    v_mfma_f32_16x16x32_bf16 v[8:11], a[24:27], v[48:51], v[8:11]
    ds_read_b128 v[48:51], v2 offset:6144
    v_mul_f32 v125, v125, |v125|
    v_mfma_f32_16x16x32_bf16 v[8:11], a[36:39], v[52:55], v[8:11]
    ds_read_b128 v[52:55], v2 offset:7168
    s_waitcnt lgkmcnt(2)
    v_mfma_f32_16x16x32_bf16 v[8:11], a[48:51], v[40:43], v[8:11]
    buffer_load_dwordx4 v1, s[8:11], s33 offen offset:3072 sc1 lds
    v_mfma_f32_16x16x32_bf16 v[8:11], a[60:63], v[44:47], v[8:11]
    s_add_u32 m0, s34, s3
    v_mul_f32 v126, v126, |v126|
    v_mul_f32 v127, v127, |v127|
    v_mfma_f32_16x16x32_bf16 v[12:15], a[64:67], v[44:47], v[12:15]
    s_add_u32 s37, s33, s3
    v_cvt_pk_bf16_f32 v124, v124, v125
    v_cvt_pk_bf16_f32 v126, v126, v127
    v_mfma_f32_16x16x32_bf16 v[12:15], a[52:55], v[40:43], v[12:15]
    buffer_load_dwordx4 v1, s[8:11], s37 offen offset:0 sc1 lds
    v_mfma_f32_16x16x32_bf16 v[16:19], a[56:59], v[40:43], v[16:19]
    ds_read_b128 v[40:43], v2 offset:8192
    v_pk_max_i16 v96, v124, 0
    v_mfma_f32_16x16x32_bf16 v[16:19], a[68:71], v[44:47], v[16:19]
    ds_read_b128 v[44:47], v2 offset:9216
    s_waitcnt lgkmcnt(2)
    v_mfma_f32_16x16x32_bf16 v[16:19], a[80:83], v[48:51], v[16:19]
    s_add_u32 s16, s16, 8192
    v_pk_max_i16 v97, v126, 0
    v_pk_max_i16 v98, v124, 0
    v_mfma_f32_16x16x32_bf16 v[16:19], a[92:95], v[52:55], v[16:19]
    s_add_u32 m0, s34, 16384
    v_pk_max_i16 v99, v126, 0
    v_fma_f32 v116, v24, v21, v80
    v_mfma_f32_16x16x32_bf16 v[12:15], a[88:91], v[52:55], v[12:15]
    s_add_u32 s37, s33, 16384
    v_permlane32_swap_b32 v96, v98
    v_mfma_f32_16x16x32_bf16 v[12:15], a[76:79], v[48:51], v[12:15]
    v_permlane32_swap_b32 v97, v99
    v_mfma_f32_16x16x32_bf16 v[8:11], a[72:75], v[48:51], v[8:11]
    ds_read_b128 v[48:51], v2 offset:10240
    v_fma_f32 v117, v25, v21, v81
    v_mfma_f32_16x16x32_bf16 v[8:11], a[84:87], v[52:55], v[8:11]
    ds_read_b128 v[52:55], v2 offset:11264
    s_waitcnt lgkmcnt(2)
    v_mfma_f32_16x16x32_bf16 v[8:11], a[96:99], v[40:43], v[8:11]
    buffer_store_dwordx4 v[96:99], v7, s[12:15], s36 offen sc1
    v_fma_f32 v118, v26, v21, v82
    v_mfma_f32_16x16x32_bf16 v[8:11], a[108:111], v[44:47], v[8:11]
    v_fma_f32 v119, v27, v21, v83
    v_fma_f32 v120, v28, v21, v84
    v_mfma_f32_16x16x32_bf16 v[12:15], a[112:115], v[44:47], v[12:15]
    v_fma_f32 v121, v29, v21, v85
    v_fma_f32 v122, v30, v21, v86
    v_mfma_f32_16x16x32_bf16 v[12:15], a[100:103], v[40:43], v[12:15]
    v_fma_f32 v123, v31, v21, v87
    v_mul_f32 v116, v116, |v116|
    v_mfma_f32_16x16x32_bf16 v[16:19], a[104:107], v[40:43], v[16:19]
    ds_read_b128 v[40:43], v2 offset:12288
    v_mul_f32 v117, v117, |v117|
    v_mfma_f32_16x16x32_bf16 v[16:19], a[116:119], v[44:47], v[16:19]
    ds_read_b128 v[44:47], v2 offset:13312
    s_waitcnt lgkmcnt(2)
    v_mfma_f32_16x16x32_bf16 v[16:19], a[128:131], v[48:51], v[16:19]
    v_sub_u32 v100, v2, v20
    v_mul_f32 v118, v118, |v118|
    v_mfma_f32_16x16x32_bf16 v[16:19], a[140:143], v[52:55], v[16:19]
    ds_read2st64_b64 v[112:115], v100 offset0:70 offset1:71
    v_mul_f32 v119, v119, |v119|
    v_mfma_f32_16x16x32_bf16 v[12:15], a[136:139], v[52:55], v[12:15]
    ds_read2st64_b64 v[108:111], v100 offset0:68 offset1:69
    v_mul_f32 v120, v120, |v120|
    v_mfma_f32_16x16x32_bf16 v[12:15], a[124:127], v[48:51], v[12:15]
    ds_read2st64_b64 v[104:107], v100 offset0:66 offset1:67
    v_mul_f32 v121, v121, |v121|
    v_mfma_f32_16x16x32_bf16 v[8:11], a[120:123], v[48:51], v[8:11]
    ds_read_b128 v[48:51], v2 offset:14336
    v_mul_f32 v122, v122, |v122|
    v_mfma_f32_16x16x32_bf16 v[8:11], a[132:135], v[52:55], v[8:11]
    ds_read_b128 v[52:55], v2 offset:15360
    s_waitcnt lgkmcnt(5)
    v_mfma_f32_16x16x32_bf16 v[8:11], a[144:147], v[40:43], v[8:11]
    s_waitcnt vmcnt(7)
    ds_read2st64_b64 v[100:103], v100 offset0:64 offset1:65
    v_mfma_f32_16x16x32_bf16 v[8:11], a[156:159], v[44:47], v[8:11]
    v_mul_f32 v123, v123, |v123|
    v_cvt_pk_bf16_f32 v116, v116, v117
    v_mfma_f32_16x16x32_bf16 v[12:15], a[160:163], v[44:47], v[12:15]
    v_cvt_pk_bf16_f32 v118, v118, v119
    v_cvt_pk_bf16_f32 v120, v120, v121
    v_mfma_f32_16x16x32_bf16 v[12:15], a[148:151], v[40:43], v[12:15]
    s_barrier
    v_mfma_f32_16x16x32_bf16 v[16:19], a[152:155], v[40:43], v[16:19]
    ds_read_b128 v[40:43], v2 offset:16384
    v_cvt_pk_bf16_f32 v122, v122, v123
    v_mfma_f32_16x16x32_bf16 v[16:19], a[164:167], v[44:47], v[16:19]
    ds_read_b128 v[44:47], v2 offset:17408
    s_waitcnt lgkmcnt(3)
    v_mfma_f32_16x16x32_bf16 v[16:19], a[176:179], v[48:51], v[16:19]
    v_pk_max_i16 v92, v116, 0
    v_pk_max_i16 v93, v118, 0
    v_mfma_f32_16x16x32_bf16 v[16:19], a[188:191], v[52:55], v[16:19]
    s_waitcnt lgkmcnt(2)
    v_pk_max_i16 v94, v120, 0
    v_pk_max_i16 v95, v122, 0
    v_mfma_f32_16x16x32_bf16 v[12:15], a[184:187], v[52:55], v[12:15]
    buffer_store_dwordx4 v[92:95], v1, s[12:15], s36 offen sc1
    v_add_u32 v3, s35, v1
    v_mfma_f32_16x16x32_bf16 v[12:15], a[172:175], v[48:51], v[12:15]
    s_add_u32 s36, s36, 116736
    v_add_f32 v100, v100, v108
    v_add_f32 v101, v101, v109
    v_mfma_f32_16x16x32_bf16 v[8:11], a[168:171], v[48:51], v[8:11]
    ds_read_b128 v[48:51], v2 offset:18432
    v_add_f32 v102, v102, v110
    v_mfma_f32_16x16x32_bf16 v[8:11], a[180:183], v[52:55], v[8:11]
    ds_read_b128 v[52:55], v2 offset:19456
    s_waitcnt lgkmcnt(2)
    v_mfma_f32_16x16x32_bf16 v[8:11], a[192:195], v[40:43], v[8:11]
    buffer_load_dword v5, v4, s[4:7], s16 offen sc1
    v_mfma_f32_16x16x32_bf16 v[8:11], a[204:207], v[44:47], v[8:11]
    v_add_f32 v103, v103, v111
    v_add_f32 v104, v104, v112
    v_mfma_f32_16x16x32_bf16 v[12:15], a[208:211], v[44:47], v[12:15]
    v_add_f32 v105, v105, v113
    v_add_f32 v106, v106, v114
    v_mfma_f32_16x16x32_bf16 v[12:15], a[196:199], v[40:43], v[12:15]
    buffer_load_dwordx4 v1, s[8:11], s37 offen offset:0 sc1 lds
    v_mfma_f32_16x16x32_bf16 v[16:19], a[200:203], v[40:43], v[16:19]
    ds_read_b128 v[40:43], v2 offset:20480
    v_add_f32 v107, v107, v115
    v_mfma_f32_16x16x32_bf16 v[16:19], a[212:215], v[44:47], v[16:19]
    ds_read_b128 v[44:47], v2 offset:21504
    s_waitcnt lgkmcnt(2)
    v_mfma_f32_16x16x32_bf16 v[16:19], a[224:227], v[48:51], v[16:19]
    buffer_load_dwordx4 v1, s[8:11], s37 offen offset:1024 sc1 lds
    v_mfma_f32_16x16x32_bf16 v[16:19], a[236:239], v[52:55], v[16:19]
    v_add_f32 v100, v100, v104
    v_add_f32 v101, v101, v105
    v_mfma_f32_16x16x32_bf16 v[12:15], a[232:235], v[52:55], v[12:15]
    v_add_f32 v102, v102, v106
    v_add_f32 v103, v103, v107
    v_mfma_f32_16x16x32_bf16 v[12:15], a[220:223], v[48:51], v[12:15]
    buffer_load_dwordx4 v1, s[8:11], s37 offen offset:2048 sc1 lds
    v_mfma_f32_16x16x32_bf16 v[8:11], a[216:219], v[48:51], v[8:11]
    ds_read_b128 v[48:51], v2 offset:22528
    v_add_f32 v100, v100, v102
    v_mfma_f32_16x16x32_bf16 v[8:11], a[228:231], v[52:55], v[8:11]
    ds_read_b128 v[52:55], v2 offset:23552
    s_waitcnt lgkmcnt(2)
    v_mfma_f32_16x16x32_bf16 v[8:11], a[240:243], v[40:43], v[8:11]
    buffer_load_dwordx4 v1, s[8:11], s37 offen offset:3072 sc1 lds
    v_mfma_f32_16x16x32_bf16 v[8:11], a[252:255], v[44:47], v[8:11]
    s_add_u32 s32, s32, 1
    v_add_f32 v101, v101, v103
    s_add_u32 s33, s33, 36864
    v_mfma_f32_16x16x32_bf16 v[12:15], v[128:131], v[44:47], v[12:15]
    s_add_u32 s34, s34, 36864
    v_permlane16_swap_b32 v100, v101
    v_mfma_f32_16x16x32_bf16 v[12:15], a[244:247], v[40:43], v[12:15]
    s_cmp_ge_u32 s34, 147456
    s_cselect_b32 s38, 147456, 0
    v_add_f32 v100, v100, v101
    v_mfma_f32_16x16x32_bf16 v[16:19], a[248:251], v[40:43], v[16:19]
    ds_read_b128 v[40:43], v2 offset:24576
    v_mov_b32 v101, v100
    v_mfma_f32_16x16x32_bf16 v[16:19], v[132:135], v[44:47], v[16:19]
    ds_read_b128 v[44:47], v2 offset:25600
    s_waitcnt lgkmcnt(2)
    v_mfma_f32_16x16x32_bf16 v[16:19], v[144:147], v[48:51], v[16:19]
    s_sub_u32 s34, s34, s38
    v_permlane32_swap_b32 v100, v101
    v_mfma_f32_16x16x32_bf16 v[16:19], v[156:159], v[52:55], v[16:19]
    v_add_f32 v100, v100, v101
    v_mul_f32 v100, 0x3a800000, v100
    v_mfma_f32_16x16x32_bf16 v[12:15], v[152:155], v[52:55], v[12:15]
    v_mov_b32 v101, v100
    v_mfma_f32_16x16x32_bf16 v[12:15], v[140:143], v[48:51], v[12:15]
    s_nop 0
    v_permlane16_swap_b32 v100, v101
    v_mfma_f32_16x16x32_bf16 v[8:11], v[136:139], v[48:51], v[8:11]
    ds_read_b128 v[48:51], v2 offset:26624
    v_fma_f32 v101, -v100, v100, v101
    v_mfma_f32_16x16x32_bf16 v[8:11], v[148:151], v[52:55], v[8:11]
    ds_read_b128 v[52:55], v2 offset:27648
    s_waitcnt lgkmcnt(2)
    v_mfma_f32_16x16x32_bf16 v[8:11], v[160:163], v[40:43], v[8:11]
    v_max_f32 v101, 0, v101
    v_add_f32 v101, 0x3727c5ac, v101
    v_mfma_f32_16x16x32_bf16 v[8:11], v[172:175], v[44:47], v[8:11]
    v_rsq_f32 v21, v101
    v_mfma_f32_16x16x32_bf16 v[12:15], v[176:179], v[44:47], v[12:15]
    v_mul_f32 v100, v100, v21
    v_fma_f32 v80, -v100, v56, v68
    v_mfma_f32_16x16x32_bf16 v[12:15], v[164:167], v[40:43], v[12:15]
    v_fma_f32 v81, -v100, v57, v69
    v_fma_f32 v82, -v100, v58, v70
    v_mfma_f32_16x16x32_bf16 v[16:19], v[168:171], v[40:43], v[16:19]
    ds_read_b128 v[40:43], v2 offset:28672
    v_fma_f32 v83, -v100, v59, v71
    v_mfma_f32_16x16x32_bf16 v[16:19], v[180:183], v[44:47], v[16:19]
    ds_read_b128 v[44:47], v2 offset:29696
    s_waitcnt lgkmcnt(2)
    v_mfma_f32_16x16x32_bf16 v[16:19], v[192:195], v[48:51], v[16:19]
    v_fma_f32 v84, -v100, v60, v72
    v_fma_f32 v85, -v100, v61, v73
    v_mfma_f32_16x16x32_bf16 v[16:19], v[204:207], v[52:55], v[16:19]
    v_fma_f32 v86, -v100, v62, v74
    v_fma_f32 v87, -v100, v63, v75
    v_mfma_f32_16x16x32_bf16 v[12:15], v[200:203], v[52:55], v[12:15]
    v_fma_f32 v88, -v100, v64, v76
    v_fma_f32 v89, -v100, v65, v77
    v_mfma_f32_16x16x32_bf16 v[12:15], v[188:191], v[48:51], v[12:15]
    v_fma_f32 v90, -v100, v66, v78
    v_fma_f32 v91, -v100, v67, v79
    v_mfma_f32_16x16x32_bf16 v[8:11], v[184:187], v[48:51], v[8:11]
    ds_read_b128 v[48:51], v2 offset:30720
    v_mfma_f32_16x16x32_bf16 v[8:11], v[196:199], v[52:55], v[8:11]
    ds_read_b128 v[52:55], v2 offset:31744
    s_waitcnt lgkmcnt(2)
    v_mfma_f32_16x16x32_bf16 v[8:11], v[208:211], v[40:43], v[8:11]
    s_waitcnt vmcnt(7)
    v_mfma_f32_16x16x32_bf16 v[8:11], v[220:223], v[44:47], v[8:11]
    v_mfma_f32_16x16x32_bf16 v[12:15], v[224:227], v[44:47], v[12:15]
    v_mfma_f32_16x16x32_bf16 v[12:15], v[212:215], v[40:43], v[12:15]
    s_barrier
    v_mfma_f32_16x16x32_bf16 v[16:19], v[216:219], v[40:43], v[16:19]
    ds_read_b128 v[40:43], v3 offset:0
    v_mfma_f32_16x16x32_bf16 v[16:19], v[228:231], v[44:47], v[16:19]
    ds_read_b128 v[44:47], v3 offset:1024
    s_waitcnt vmcnt(5) lgkmcnt(2)
    v_mfma_f32_16x16x32_bf16 v[16:19], v[240:243], v[48:51], v[16:19]
    buffer_store_dword v6, v22, s[12:15], s17 offen sc1
    s_mov_b32 s14, s6
    v_mfma_f32_16x16x32_bf16 v[16:19], v[252:255], v[52:55], v[16:19]
    s_add_u32 s17, s17, 8192
    v_mfma_f32_16x16x32_bf16 v[12:15], v[248:251], v[52:55], v[12:15]
    v_mfma_f32_16x16x32_bf16 v[12:15], v[236:239], v[48:51], v[12:15]
    v_mfma_f32_16x16x32_bf16 v[8:11], v[232:235], v[48:51], v[8:11]
    ds_read_b128 v[48:51], v3 offset:2048
    v_mfma_f32_16x16x32_bf16 v[8:11], v[244:247], v[52:55], v[8:11]
    ds_read_b128 v[52:55], v3 offset:3072
Lffa_body13:
    s_waitcnt lgkmcnt(2)
    v_mfma_f32_16x16x32_bf16 v[24:27], a[0:3], v[40:43], 0
    s_add_u32 m0, s34, 0
    s_waitcnt vmcnt(5)
    v_cmp_gt_i32 vcc, s32, v5
    v_mfma_f32_16x16x32_bf16 v[24:27], a[12:15], v[44:47], v[24:27]
    s_add_u32 s31, s31, 1
    v_mov_b32 v6, s31
    v_fma_f32 v124, v16, v21, v88
    v_mfma_f32_16x16x32_bf16 v[28:31], a[16:19], v[44:47], 0
    s_and_b64 vcc, vcc, s[18:19]
    s_cbranch_scc1 Lffa_v11
    v_mfma_f32_16x16x32_bf16 v[28:31], a[4:7], v[40:43], v[28:31]
    buffer_load_dwordx4 v1, s[8:11], s33 offen offset:0 sc1 lds
    v_mfma_f32_16x16x32_bf16 v[32:35], a[8:11], v[40:43], 0
    ds_read_b128 v[40:43], v3 offset:4096
    v_fma_f32 v125, v17, v21, v89
    v_mfma_f32_16x16x32_bf16 v[32:35], a[20:23], v[44:47], v[32:35]
    ds_read_b128 v[44:47], v3 offset:5120
    s_waitcnt lgkmcnt(2)
    v_mfma_f32_16x16x32_bf16 v[32:35], a[32:35], v[48:51], v[32:35]
    buffer_load_dwordx4 v1, s[8:11], s33 offen offset:1024 sc1 lds
    v_mfma_f32_16x16x32_bf16 v[32:35], a[44:47], v[52:55], v[32:35]
    s_add_u32 s35, s35, 36864
    v_fma_f32 v126, v18, v21, v90
    v_fma_f32 v127, v19, v21, v91
    v_mfma_f32_16x16x32_bf16 v[28:31], a[40:43], v[52:55], v[28:31]
    s_cmp_eq_u32 s35, 147456
    s_cselect_b32 s35, 0, s35
    v_mul_f32 v124, v124, |v124|
    v_mfma_f32_16x16x32_bf16 v[28:31], a[28:31], v[48:51], v[28:31]
    buffer_load_dwordx4 v1, s[8:11], s33 offen offset:2048 sc1 lds
    v_mfma_f32_16x16x32_bf16 v[24:27], a[24:27], v[48:51], v[24:27]
    ds_read_b128 v[48:51], v3 offset:6144
    v_mul_f32 v125, v125, |v125|
    v_mfma_f32_16x16x32_bf16 v[24:27], a[36:39], v[52:55], v[24:27]
    ds_read_b128 v[52:55], v3 offset:7168
    s_waitcnt lgkmcnt(2)
    v_mfma_f32_16x16x32_bf16 v[24:27], a[48:51], v[40:43], v[24:27]
    buffer_load_dwordx4 v1, s[8:11], s33 offen offset:3072 sc1 lds
    v_mfma_f32_16x16x32_bf16 v[24:27], a[60:63], v[44:47], v[24:27]
    s_add_u32 m0, s34, s3
    v_mul_f32 v126, v126, |v126|
    v_mul_f32 v127, v127, |v127|
    v_mfma_f32_16x16x32_bf16 v[28:31], a[64:67], v[44:47], v[28:31]
    s_add_u32 s37, s33, s3
    v_cvt_pk_bf16_f32 v124, v124, v125
    v_cvt_pk_bf16_f32 v126, v126, v127
    v_mfma_f32_16x16x32_bf16 v[28:31], a[52:55], v[40:43], v[28:31]
    buffer_load_dwordx4 v1, s[8:11], s37 offen offset:0 sc1 lds
    v_mfma_f32_16x16x32_bf16 v[32:35], a[56:59], v[40:43], v[32:35]
    ds_read_b128 v[40:43], v3 offset:8192
    v_pk_max_i16 v96, v124, 0
    v_mfma_f32_16x16x32_bf16 v[32:35], a[68:71], v[44:47], v[32:35]
    ds_read_b128 v[44:47], v3 offset:9216
    s_waitcnt lgkmcnt(2)
    v_mfma_f32_16x16x32_bf16 v[32:35], a[80:83], v[48:51], v[32:35]
    s_add_u32 s16, s16, 8192
    v_pk_max_i16 v97, v126, 0
    v_pk_max_i16 v98, v124, 0
    v_mfma_f32_16x16x32_bf16 v[32:35], a[92:95], v[52:55], v[32:35]
    s_add_u32 m0, s34, 16384
    v_pk_max_i16 v99, v126, 0
    v_fma_f32 v116, v8, v21, v80
    v_mfma_f32_16x16x32_bf16 v[28:31], a[88:91], v[52:55], v[28:31]
    s_add_u32 s37, s33, 16384
    v_permlane32_swap_b32 v96, v98
    v_mfma_f32_16x16x32_bf16 v[28:31], a[76:79], v[48:51], v[28:31]
    v_permlane32_swap_b32 v97, v99
    v_mfma_f32_16x16x32_bf16 v[24:27], a[72:75], v[48:51], v[24:27]
    ds_read_b128 v[48:51], v3 offset:10240
    v_fma_f32 v117, v9, v21, v81
    v_mfma_f32_16x16x32_bf16 v[24:27], a[84:87], v[52:55], v[24:27]
    ds_read_b128 v[52:55], v3 offset:11264
    s_waitcnt lgkmcnt(2)
    v_mfma_f32_16x16x32_bf16 v[24:27], a[96:99], v[40:43], v[24:27]
    buffer_store_dwordx4 v[96:99], v7, s[12:15], s36 offen sc1
    v_fma_f32 v118, v10, v21, v82
    v_mfma_f32_16x16x32_bf16 v[24:27], a[108:111], v[44:47], v[24:27]
    v_fma_f32 v119, v11, v21, v83
    v_fma_f32 v120, v12, v21, v84
    v_mfma_f32_16x16x32_bf16 v[28:31], a[112:115], v[44:47], v[28:31]
    v_fma_f32 v121, v13, v21, v85
    v_fma_f32 v122, v14, v21, v86
    v_mfma_f32_16x16x32_bf16 v[28:31], a[100:103], v[40:43], v[28:31]
    v_fma_f32 v123, v15, v21, v87
    v_mul_f32 v116, v116, |v116|
    v_mfma_f32_16x16x32_bf16 v[32:35], a[104:107], v[40:43], v[32:35]
    ds_read_b128 v[40:43], v3 offset:12288
    v_mul_f32 v117, v117, |v117|
    v_mfma_f32_16x16x32_bf16 v[32:35], a[116:119], v[44:47], v[32:35]
    ds_read_b128 v[44:47], v3 offset:13312
    s_waitcnt lgkmcnt(2)
    v_mfma_f32_16x16x32_bf16 v[32:35], a[128:131], v[48:51], v[32:35]
    v_sub_u32 v100, v3, v20
    v_mul_f32 v118, v118, |v118|
    v_mfma_f32_16x16x32_bf16 v[32:35], a[140:143], v[52:55], v[32:35]
    ds_read2st64_b64 v[112:115], v100 offset0:70 offset1:71
    v_mul_f32 v119, v119, |v119|
    v_mfma_f32_16x16x32_bf16 v[28:31], a[136:139], v[52:55], v[28:31]
    ds_read2st64_b64 v[108:111], v100 offset0:68 offset1:69
    v_mul_f32 v120, v120, |v120|
    v_mfma_f32_16x16x32_bf16 v[28:31], a[124:127], v[48:51], v[28:31]
    ds_read2st64_b64 v[104:107], v100 offset0:66 offset1:67
    v_mul_f32 v121, v121, |v121|
    v_mfma_f32_16x16x32_bf16 v[24:27], a[120:123], v[48:51], v[24:27]
    ds_read_b128 v[48:51], v3 offset:14336
    v_mul_f32 v122, v122, |v122|
    v_mfma_f32_16x16x32_bf16 v[24:27], a[132:135], v[52:55], v[24:27]
    ds_read_b128 v[52:55], v3 offset:15360
    s_waitcnt lgkmcnt(5)
    v_mfma_f32_16x16x32_bf16 v[24:27], a[144:147], v[40:43], v[24:27]
    s_waitcnt vmcnt(7)
    ds_read2st64_b64 v[100:103], v100 offset0:64 offset1:65
    v_mfma_f32_16x16x32_bf16 v[24:27], a[156:159], v[44:47], v[24:27]
    v_mul_f32 v123, v123, |v123|
    v_cvt_pk_bf16_f32 v116, v116, v117
    v_mfma_f32_16x16x32_bf16 v[28:31], a[160:163], v[44:47], v[28:31]
    v_cvt_pk_bf16_f32 v118, v118, v119
    v_cvt_pk_bf16_f32 v120, v120, v121
    v_mfma_f32_16x16x32_bf16 v[28:31], a[148:151], v[40:43], v[28:31]
    s_barrier
    v_mfma_f32_16x16x32_bf16 v[32:35], a[152:155], v[40:43], v[32:35]
    ds_read_b128 v[40:43], v3 offset:16384
    v_cvt_pk_bf16_f32 v122, v122, v123
    v_mfma_f32_16x16x32_bf16 v[32:35], a[164:167], v[44:47], v[32:35]
    ds_read_b128 v[44:47], v3 offset:17408
    s_waitcnt lgkmcnt(3)
    v_mfma_f32_16x16x32_bf16 v[32:35], a[176:179], v[48:51], v[32:35]
    v_pk_max_i16 v92, v116, 0
    v_pk_max_i16 v93, v118, 0
    v_mfma_f32_16x16x32_bf16 v[32:35], a[188:191], v[52:55], v[32:35]
    s_waitcnt lgkmcnt(2)
    v_pk_max_i16 v94, v120, 0
    v_pk_max_i16 v95, v122, 0
    v_mfma_f32_16x16x32_bf16 v[28:31], a[184:187], v[52:55], v[28:31]
    buffer_store_dwordx4 v[92:95], v1, s[12:15], s36 offen sc1
    v_add_u32 v2, s35, v1
    v_mfma_f32_16x16x32_bf16 v[28:31], a[172:175], v[48:51], v[28:31]
    s_add_u32 s36, s36, 116736
    v_add_f32 v100, v100, v108
    v_add_f32 v101, v101, v109
    v_mfma_f32_16x16x32_bf16 v[24:27], a[168:171], v[48:51], v[24:27]
    ds_read_b128 v[48:51], v3 offset:18432
    v_add_f32 v102, v102, v110
    v_mfma_f32_16x16x32_bf16 v[24:27], a[180:183], v[52:55], v[24:27]
    ds_read_b128 v[52:55], v3 offset:19456
    s_waitcnt lgkmcnt(2)
    v_mfma_f32_16x16x32_bf16 v[24:27], a[192:195], v[40:43], v[24:27]
    buffer_load_dword v5, v4, s[4:7], s16 offen sc1
    v_mfma_f32_16x16x32_bf16 v[24:27], a[204:207], v[44:47], v[24:27]
    v_add_f32 v103, v103, v111
    v_add_f32 v104, v104, v112
    v_mfma_f32_16x16x32_bf16 v[28:31], a[208:211], v[44:47], v[28:31]
    v_add_f32 v105, v105, v113
    v_add_f32 v106, v106, v114
    v_mfma_f32_16x16x32_bf16 v[28:31], a[196:199], v[40:43], v[28:31]
    buffer_load_dwordx4 v1, s[8:11], s37 offen offset:0 sc1 lds
    v_mfma_f32_16x16x32_bf16 v[32:35], a[200:203], v[40:43], v[32:35]
    ds_read_b128 v[40:43], v3 offset:20480
    v_add_f32 v107, v107, v115
    v_mfma_f32_16x16x32_bf16 v[32:35], a[212:215], v[44:47], v[32:35]
    ds_read_b128 v[44:47], v3 offset:21504
    s_waitcnt lgkmcnt(2)
    v_mfma_f32_16x16x32_bf16 v[32:35], a[224:227], v[48:51], v[32:35]
    buffer_load_dwordx4 v1, s[8:11], s37 offen offset:1024 sc1 lds
    v_mfma_f32_16x16x32_bf16 v[32:35], a[236:239], v[52:55], v[32:35]
    v_add_f32 v100, v100, v104
    v_add_f32 v101, v101, v105
    v_mfma_f32_16x16x32_bf16 v[28:31], a[232:235], v[52:55], v[28:31]
    v_add_f32 v102, v102, v106
    v_add_f32 v103, v103, v107
    v_mfma_f32_16x16x32_bf16 v[28:31], a[220:223], v[48:51], v[28:31]
    buffer_load_dwordx4 v1, s[8:11], s37 offen offset:2048 sc1 lds
    v_mfma_f32_16x16x32_bf16 v[24:27], a[216:219], v[48:51], v[24:27]
    ds_read_b128 v[48:51], v3 offset:22528
    v_add_f32 v100, v100, v102
    v_mfma_f32_16x16x32_bf16 v[24:27], a[228:231], v[52:55], v[24:27]
    ds_read_b128 v[52:55], v3 offset:23552
    s_waitcnt lgkmcnt(2)
    v_mfma_f32_16x16x32_bf16 v[24:27], a[240:243], v[40:43], v[24:27]
    buffer_load_dwordx4 v1, s[8:11], s37 offen offset:3072 sc1 lds
    v_mfma_f32_16x16x32_bf16 v[24:27], a[252:255], v[44:47], v[24:27]
    s_add_u32 s32, s32, 1
    v_add_f32 v101, v101, v103
    s_add_u32 s33, s33, 36864
    v_mfma_f32_16x16x32_bf16 v[28:31], v[128:131], v[44:47], v[28:31]
    s_add_u32 s34, s34, 36864
    v_permlane16_swap_b32 v100, v101
    v_mfma_f32_16x16x32_bf16 v[28:31], a[244:247], v[40:43], v[28:31]
    s_cmp_ge_u32 s34, 147456
    s_cselect_b32 s38, 147456, 0
    v_add_f32 v100, v100, v101
    v_mfma_f32_16x16x32_bf16 v[32:35], a[248:251], v[40:43], v[32:35]
    ds_read_b128 v[40:43], v3 offset:24576
    v_mov_b32 v101, v100
    v_mfma_f32_16x16x32_bf16 v[32:35], v[132:135], v[44:47], v[32:35]
    ds_read_b128 v[44:47], v3 offset:25600
    s_waitcnt lgkmcnt(2)
    v_mfma_f32_16x16x32_bf16 v[32:35], v[144:147], v[48:51], v[32:35]
    s_sub_u32 s34, s34, s38
    v_permlane32_swap_b32 v100, v101
    v_mfma_f32_16x16x32_bf16 v[32:35], v[156:159], v[52:55], v[32:35]
    v_add_f32 v100, v100, v101
    v_mul_f32 v100, 0x3a800000, v100
    v_mfma_f32_16x16x32_bf16 v[28:31], v[152:155], v[52:55], v[28:31]
    v_mov_b32 v101, v100
    v_mfma_f32_16x16x32_bf16 v[28:31], v[140:143], v[48:51], v[28:31]
    s_nop 0
    v_permlane16_swap_b32 v100, v101
    v_mfma_f32_16x16x32_bf16 v[24:27], v[136:139], v[48:51], v[24:27]
    ds_read_b128 v[48:51], v3 offset:26624
    v_fma_f32 v101, -v100, v100, v101
    v_mfma_f32_16x16x32_bf16 v[24:27], v[148:151], v[52:55], v[24:27]
    ds_read_b128 v[52:55], v3 offset:27648
    s_waitcnt lgkmcnt(2)
    v_mfma_f32_16x16x32_bf16 v[24:27], v[160:163], v[40:43], v[24:27]
    v_max_f32 v101, 0, v101
    v_add_f32 v101, 0x3727c5ac, v101
    v_mfma_f32_16x16x32_bf16 v[24:27], v[172:175], v[44:47], v[24:27]
    v_rsq_f32 v21, v101
    v_mfma_f32_16x16x32_bf16 v[28:31], v[176:179], v[44:47], v[28:31]
    v_mul_f32 v100, v100, v21
    v_fma_f32 v80, -v100, v56, v68
    v_mfma_f32_16x16x32_bf16 v[28:31], v[164:167], v[40:43], v[28:31]
    v_fma_f32 v81, -v100, v57, v69
    v_fma_f32 v82, -v100, v58, v70
    v_mfma_f32_16x16x32_bf16 v[32:35], v[168:171], v[40:43], v[32:35]
    ds_read_b128 v[40:43], v3 offset:28672
    v_fma_f32 v83, -v100, v59, v71
    v_mfma_f32_16x16x32_bf16 v[32:35], v[180:183], v[44:47], v[32:35]
    ds_read_b128 v[44:47], v3 offset:29696
    s_waitcnt lgkmcnt(2)
    v_mfma_f32_16x16x32_bf16 v[32:35], v[192:195], v[48:51], v[32:35]
    v_fma_f32 v84, -v100, v60, v72
    v_fma_f32 v85, -v100, v61, v73
    v_mfma_f32_16x16x32_bf16 v[32:35], v[204:207], v[52:55], v[32:35]
    v_fma_f32 v86, -v100, v62, v74
    v_fma_f32 v87, -v100, v63, v75
    v_mfma_f32_16x16x32_bf16 v[28:31], v[200:203], v[52:55], v[28:31]
    v_fma_f32 v88, -v100, v64, v76
    v_fma_f32 v89, -v100, v65, v77
    v_mfma_f32_16x16x32_bf16 v[28:31], v[188:191], v[48:51], v[28:31]
    v_fma_f32 v90, -v100, v66, v78
    v_fma_f32 v91, -v100, v67, v79
    v_mfma_f32_16x16x32_bf16 v[24:27], v[184:187], v[48:51], v[24:27]
    ds_read_b128 v[48:51], v3 offset:30720
    v_mfma_f32_16x16x32_bf16 v[24:27], v[196:199], v[52:55], v[24:27]
    ds_read_b128 v[52:55], v3 offset:31744
    s_waitcnt lgkmcnt(2)
    v_mfma_f32_16x16x32_bf16 v[24:27], v[208:211], v[40:43], v[24:27]
    s_waitcnt vmcnt(7)
    v_mfma_f32_16x16x32_bf16 v[24:27], v[220:223], v[44:47], v[24:27]
    v_mfma_f32_16x16x32_bf16 v[28:31], v[224:227], v[44:47], v[28:31]
    v_mfma_f32_16x16x32_bf16 v[28:31], v[212:215], v[40:43], v[28:31]
    s_barrier
    v_mfma_f32_16x16x32_bf16 v[32:35], v[216:219], v[40:43], v[32:35]
    ds_read_b128 v[40:43], v2 offset:0
    v_mfma_f32_16x16x32_bf16 v[32:35], v[228:231], v[44:47], v[32:35]
    ds_read_b128 v[44:47], v2 offset:1024
    s_waitcnt vmcnt(5) lgkmcnt(2)
    v_mfma_f32_16x16x32_bf16 v[32:35], v[240:243], v[48:51], v[32:35]
    buffer_store_dword v6, v22, s[12:15], s17 offen sc1
    s_mov_b32 s14, s6
    v_mfma_f32_16x16x32_bf16 v[32:35], v[252:255], v[52:55], v[32:35]
    s_add_u32 s17, s17, 8192
    v_mfma_f32_16x16x32_bf16 v[28:31], v[248:251], v[52:55], v[28:31]
    v_mfma_f32_16x16x32_bf16 v[28:31], v[236:239], v[48:51], v[28:31]
    v_mfma_f32_16x16x32_bf16 v[24:27], v[232:235], v[48:51], v[24:27]
    ds_read_b128 v[48:51], v2 offset:2048
    v_mfma_f32_16x16x32_bf16 v[24:27], v[244:247], v[52:55], v[24:27]
    ds_read_b128 v[52:55], v2 offset:3072
    s_cmp_lt_i32 s31, 63
    s_cbranch_scc1 Lffa_body03
    s_branch L_exit
Lffa_v01:
    v_mfma_f32_16x16x32_bf16 v[12:15], a[4:7], v[40:43], v[12:15]
    buffer_load_dword v5, v4, s[4:7], s16 offen sc1
    v_mfma_f32_16x16x32_bf16 v[16:19], a[8:11], v[40:43], 0
    ds_read_b128 v[40:43], v2 offset:4096
    v_fma_f32 v125, v33, v21, v89
    v_mfma_f32_16x16x32_bf16 v[16:19], a[20:23], v[44:47], v[16:19]
    ds_read_b128 v[44:47], v2 offset:5120
    s_waitcnt lgkmcnt(2)
    v_mfma_f32_16x16x32_bf16 v[16:19], a[32:35], v[48:51], v[16:19]
    s_add_u32 s35, s35, 36864
    v_fma_f32 v126, v34, v21, v90
    v_fma_f32 v127, v35, v21, v91
    v_mfma_f32_16x16x32_bf16 v[16:19], a[44:47], v[52:55], v[16:19]
    s_cmp_eq_u32 s35, 147456
    s_cselect_b32 s35, 0, s35
    v_mul_f32 v124, v124, |v124|
    v_mfma_f32_16x16x32_bf16 v[12:15], a[40:43], v[52:55], v[12:15]
    v_mul_f32 v125, v125, |v125|
    v_mul_f32 v126, v126, |v126|
    v_mfma_f32_16x16x32_bf16 v[12:15], a[28:31], v[48:51], v[12:15]
    v_mul_f32 v127, v127, |v127|
    v_cvt_pk_bf16_f32 v124, v124, v125
    v_mfma_f32_16x16x32_bf16 v[8:11], a[24:27], v[48:51], v[8:11]
    ds_read_b128 v[48:51], v2 offset:6144
    v_cvt_pk_bf16_f32 v126, v126, v127
    v_mfma_f32_16x16x32_bf16 v[8:11], a[36:39], v[52:55], v[8:11]
    ds_read_b128 v[52:55], v2 offset:7168
    s_waitcnt lgkmcnt(2)
    v_mfma_f32_16x16x32_bf16 v[8:11], a[48:51], v[40:43], v[8:11]
    v_pk_max_i16 v96, v124, 0
    v_pk_max_i16 v97, v126, 0
    v_mfma_f32_16x16x32_bf16 v[8:11], a[60:63], v[44:47], v[8:11]
    v_pk_max_i16 v98, v124, 0
    v_pk_max_i16 v99, v126, 0
    v_mfma_f32_16x16x32_bf16 v[12:15], a[64:67], v[44:47], v[12:15]
    v_permlane32_swap_b32 v96, v98
    v_mfma_f32_16x16x32_bf16 v[12:15], a[52:55], v[40:43], v[12:15]
    v_permlane32_swap_b32 v97, v99
    v_mfma_f32_16x16x32_bf16 v[16:19], a[56:59], v[40:43], v[16:19]
    ds_read_b128 v[40:43], v2 offset:8192
    v_fma_f32 v116, v24, v21, v80
    v_mfma_f32_16x16x32_bf16 v[16:19], a[68:71], v[44:47], v[16:19]
    ds_read_b128 v[44:47], v2 offset:9216
    s_waitcnt lgkmcnt(2)
    v_mfma_f32_16x16x32_bf16 v[16:19], a[80:83], v[48:51], v[16:19]
    buffer_store_dwordx4 v[96:99], v7, s[12:15], s36 offen sc1
    v_fma_f32 v117, v25, v21, v81
    v_mfma_f32_16x16x32_bf16 v[16:19], a[92:95], v[52:55], v[16:19]
    v_fma_f32 v118, v26, v21, v82
    v_fma_f32 v119, v27, v21, v83
    v_mfma_f32_16x16x32_bf16 v[12:15], a[88:91], v[52:55], v[12:15]
    v_fma_f32 v120, v28, v21, v84
    v_fma_f32 v121, v29, v21, v85
    v_mfma_f32_16x16x32_bf16 v[12:15], a[76:79], v[48:51], v[12:15]
    v_fma_f32 v122, v30, v21, v86
    v_fma_f32 v123, v31, v21, v87
    v_mfma_f32_16x16x32_bf16 v[8:11], a[72:75], v[48:51], v[8:11]
    ds_read_b128 v[48:51], v2 offset:10240
    v_mul_f32 v116, v116, |v116|
    v_mfma_f32_16x16x32_bf16 v[8:11], a[84:87], v[52:55], v[8:11]
    ds_read_b128 v[52:55], v2 offset:11264
    s_waitcnt lgkmcnt(2)
    v_mfma_f32_16x16x32_bf16 v[8:11], a[96:99], v[40:43], v[8:11]
    v_mul_f32 v117, v117, |v117|
    v_mul_f32 v118, v118, |v118|
    v_mfma_f32_16x16x32_bf16 v[8:11], a[108:111], v[44:47], v[8:11]
    v_mul_f32 v119, v119, |v119|
    v_mul_f32 v120, v120, |v120|
    v_mfma_f32_16x16x32_bf16 v[12:15], a[112:115], v[44:47], v[12:15]
    v_mul_f32 v121, v121, |v121|
    v_mul_f32 v122, v122, |v122|
    v_mfma_f32_16x16x32_bf16 v[12:15], a[100:103], v[40:43], v[12:15]
    v_mul_f32 v123, v123, |v123|
    v_cvt_pk_bf16_f32 v116, v116, v117
    v_mfma_f32_16x16x32_bf16 v[16:19], a[104:107], v[40:43], v[16:19]
    ds_read_b128 v[40:43], v2 offset:12288
    v_cvt_pk_bf16_f32 v118, v118, v119
    v_mfma_f32_16x16x32_bf16 v[16:19], a[116:119], v[44:47], v[16:19]
    ds_read_b128 v[44:47], v2 offset:13312
    s_waitcnt lgkmcnt(2)
    v_mfma_f32_16x16x32_bf16 v[16:19], a[128:131], v[48:51], v[16:19]
    v_sub_u32 v100, v2, v20
    v_cvt_pk_bf16_f32 v120, v120, v121
    v_mfma_f32_16x16x32_bf16 v[16:19], a[140:143], v[52:55], v[16:19]
    ds_read2st64_b64 v[112:115], v100 offset0:70 offset1:71
    v_cvt_pk_bf16_f32 v122, v122, v123
    v_mfma_f32_16x16x32_bf16 v[12:15], a[136:139], v[52:55], v[12:15]
    ds_read2st64_b64 v[108:111], v100 offset0:68 offset1:69
    v_pk_max_i16 v92, v116, 0
    v_mfma_f32_16x16x32_bf16 v[12:15], a[124:127], v[48:51], v[12:15]
    s_waitcnt vmcnt(1)
    v_cmp_gt_i32 vcc, s32, v5
    v_pk_max_i16 v93, v118, 0
    v_mfma_f32_16x16x32_bf16 v[8:11], a[120:123], v[48:51], v[8:11]
    ds_read_b128 v[48:51], v2 offset:14336
    v_pk_max_i16 v94, v120, 0
    v_mfma_f32_16x16x32_bf16 v[8:11], a[132:135], v[52:55], v[8:11]
    ds_read_b128 v[52:55], v2 offset:15360
    s_waitcnt lgkmcnt(4)
    v_mfma_f32_16x16x32_bf16 v[8:11], a[144:147], v[40:43], v[8:11]
    s_and_b64 vcc, vcc, s[18:19]
    s_cbranch_scc1 Lffa_v02
    v_mfma_f32_16x16x32_bf16 v[8:11], a[156:159], v[44:47], v[8:11]
    buffer_load_dwordx4 v1, s[8:11], s33 offen offset:0 sc1 lds
    v_mfma_f32_16x16x32_bf16 v[12:15], a[160:163], v[44:47], v[12:15]
    s_barrier
    v_mfma_f32_16x16x32_bf16 v[12:15], a[148:151], v[40:43], v[12:15]
    ds_read2st64_b64 v[104:107], v100 offset0:66 offset1:67
    v_pk_max_i16 v95, v122, 0
    v_mfma_f32_16x16x32_bf16 v[16:19], a[152:155], v[40:43], v[16:19]
    ds_read_b128 v[40:43], v2 offset:16384
    v_add_u32 v3, s35, v1
    v_mfma_f32_16x16x32_bf16 v[16:19], a[164:167], v[44:47], v[16:19]
    ds_read_b128 v[44:47], v2 offset:17408
    s_waitcnt lgkmcnt(3)
    v_mfma_f32_16x16x32_bf16 v[16:19], a[176:179], v[48:51], v[16:19]
    ds_read2st64_b64 v[100:103], v100 offset0:64 offset1:65
    v_mfma_f32_16x16x32_bf16 v[16:19], a[188:191], v[52:55], v[16:19]
    buffer_store_dwordx4 v[92:95], v1, s[12:15], s36 offen sc1
    s_add_u32 s36, s36, 116736
    v_mfma_f32_16x16x32_bf16 v[12:15], a[184:187], v[52:55], v[12:15]
    v_mfma_f32_16x16x32_bf16 v[12:15], a[172:175], v[48:51], v[12:15]
    v_mfma_f32_16x16x32_bf16 v[8:11], a[168:171], v[48:51], v[8:11]
    ds_read_b128 v[48:51], v2 offset:18432
    v_mfma_f32_16x16x32_bf16 v[8:11], a[180:183], v[52:55], v[8:11]
    ds_read_b128 v[52:55], v2 offset:19456
    s_waitcnt lgkmcnt(3)
    v_mfma_f32_16x16x32_bf16 v[8:11], a[192:195], v[40:43], v[8:11]
    buffer_load_dwordx4 v1, s[8:11], s33 offen offset:1024 sc1 lds
    v_mfma_f32_16x16x32_bf16 v[8:11], a[204:207], v[44:47], v[8:11]
    s_waitcnt lgkmcnt(2)
    v_add_f32 v100, v100, v108
    v_add_f32 v101, v101, v109
    v_mfma_f32_16x16x32_bf16 v[12:15], a[208:211], v[44:47], v[12:15]
    v_add_f32 v102, v102, v110
    v_add_f32 v103, v103, v111
    v_mfma_f32_16x16x32_bf16 v[12:15], a[196:199], v[40:43], v[12:15]
    buffer_load_dwordx4 v1, s[8:11], s33 offen offset:2048 sc1 lds
    v_mfma_f32_16x16x32_bf16 v[16:19], a[200:203], v[40:43], v[16:19]
    ds_read_b128 v[40:43], v2 offset:20480
    v_add_f32 v104, v104, v112
    v_mfma_f32_16x16x32_bf16 v[16:19], a[212:215], v[44:47], v[16:19]
    ds_read_b128 v[44:47], v2 offset:21504
    s_waitcnt lgkmcnt(2)
    v_mfma_f32_16x16x32_bf16 v[16:19], a[224:227], v[48:51], v[16:19]
    buffer_load_dwordx4 v1, s[8:11], s33 offen offset:3072 sc1 lds
    v_mfma_f32_16x16x32_bf16 v[16:19], a[236:239], v[52:55], v[16:19]
    s_add_u32 m0, s34, s3
    v_add_f32 v105, v105, v113
    v_add_f32 v106, v106, v114
    v_mfma_f32_16x16x32_bf16 v[12:15], a[232:235], v[52:55], v[12:15]
    s_add_u32 s37, s33, s3
    v_add_f32 v107, v107, v115
    v_add_f32 v100, v100, v104
    v_mfma_f32_16x16x32_bf16 v[12:15], a[220:223], v[48:51], v[12:15]
    buffer_load_dwordx4 v1, s[8:11], s37 offen offset:0 sc1 lds
    v_mfma_f32_16x16x32_bf16 v[8:11], a[216:219], v[48:51], v[8:11]
    ds_read_b128 v[48:51], v2 offset:22528
    v_add_f32 v101, v101, v105
    v_mfma_f32_16x16x32_bf16 v[8:11], a[228:231], v[52:55], v[8:11]
    ds_read_b128 v[52:55], v2 offset:23552
    s_waitcnt lgkmcnt(2)
    v_mfma_f32_16x16x32_bf16 v[8:11], a[240:243], v[40:43], v[8:11]
    s_add_u32 s16, s16, 8192
    v_add_f32 v102, v102, v106
    v_add_f32 v103, v103, v107
    v_mfma_f32_16x16x32_bf16 v[8:11], a[252:255], v[44:47], v[8:11]
    buffer_load_dword v5, v4, s[4:7], s16 offen sc1
    v_mfma_f32_16x16x32_bf16 v[12:15], v[128:131], v[44:47], v[12:15]
    s_add_u32 m0, s34, 16384
    v_add_f32 v100, v100, v102
    v_add_f32 v101, v101, v103
    v_mfma_f32_16x16x32_bf16 v[12:15], a[244:247], v[40:43], v[12:15]
    s_add_u32 s37, s33, 16384
    v_permlane16_swap_b32 v100, v101
    v_mfma_f32_16x16x32_bf16 v[16:19], a[248:251], v[40:43], v[16:19]
    ds_read_b128 v[40:43], v2 offset:24576
    v_add_f32 v100, v100, v101
    v_mfma_f32_16x16x32_bf16 v[16:19], v[132:135], v[44:47], v[16:19]
    ds_read_b128 v[44:47], v2 offset:25600
    s_waitcnt lgkmcnt(2)
    v_mfma_f32_16x16x32_bf16 v[16:19], v[144:147], v[48:51], v[16:19]
    buffer_load_dwordx4 v1, s[8:11], s37 offen offset:0 sc1 lds
    v_mfma_f32_16x16x32_bf16 v[16:19], v[156:159], v[52:55], v[16:19]
    v_mov_b32 v101, v100
    v_mfma_f32_16x16x32_bf16 v[12:15], v[152:155], v[52:55], v[12:15]
    s_nop 0
    v_permlane32_swap_b32 v100, v101
    v_mfma_f32_16x16x32_bf16 v[12:15], v[140:143], v[48:51], v[12:15]
    buffer_load_dwordx4 v1, s[8:11], s37 offen offset:1024 sc1 lds
    v_mfma_f32_16x16x32_bf16 v[8:11], v[136:139], v[48:51], v[8:11]
    ds_read_b128 v[48:51], v2 offset:26624
    v_add_f32 v100, v100, v101
    v_mfma_f32_16x16x32_bf16 v[8:11], v[148:151], v[52:55], v[8:11]
    ds_read_b128 v[52:55], v2 offset:27648
    s_waitcnt lgkmcnt(2)
    v_mfma_f32_16x16x32_bf16 v[8:11], v[160:163], v[40:43], v[8:11]
    buffer_load_dwordx4 v1, s[8:11], s37 offen offset:2048 sc1 lds
    v_mfma_f32_16x16x32_bf16 v[8:11], v[172:175], v[44:47], v[8:11]
    v_mul_f32 v100, 0x3a800000, v100
    v_mov_b32 v101, v100
    v_mfma_f32_16x16x32_bf16 v[12:15], v[176:179], v[44:47], v[12:15]
    s_nop 0
    v_permlane16_swap_b32 v100, v101
    v_mfma_f32_16x16x32_bf16 v[12:15], v[164:167], v[40:43], v[12:15]
    buffer_load_dwordx4 v1, s[8:11], s37 offen offset:3072 sc1 lds
    v_mfma_f32_16x16x32_bf16 v[16:19], v[168:171], v[40:43], v[16:19]
    ds_read_b128 v[40:43], v2 offset:28672
    v_fma_f32 v101, -v100, v100, v101
    v_mfma_f32_16x16x32_bf16 v[16:19], v[180:183], v[44:47], v[16:19]
    ds_read_b128 v[44:47], v2 offset:29696
    s_waitcnt lgkmcnt(2)
    v_mfma_f32_16x16x32_bf16 v[16:19], v[192:195], v[48:51], v[16:19]
    s_add_u32 s32, s32, 1
    v_max_f32 v101, 0, v101
    v_add_f32 v101, 0x3727c5ac, v101
    v_mfma_f32_16x16x32_bf16 v[16:19], v[204:207], v[52:55], v[16:19]
    s_add_u32 s33, s33, 36864
    v_rsq_f32 v21, v101
    v_mfma_f32_16x16x32_bf16 v[12:15], v[200:203], v[52:55], v[12:15]
    s_add_u32 s34, s34, 36864
    v_mul_f32 v100, v100, v21
    v_fma_f32 v80, -v100, v56, v68
    v_mfma_f32_16x16x32_bf16 v[12:15], v[188:191], v[48:51], v[12:15]
    s_cmp_ge_u32 s34, 147456
    s_cselect_b32 s38, 147456, 0
    v_fma_f32 v81, -v100, v57, v69
    v_mfma_f32_16x16x32_bf16 v[8:11], v[184:187], v[48:51], v[8:11]
    ds_read_b128 v[48:51], v2 offset:30720
    v_fma_f32 v82, -v100, v58, v70
    v_mfma_f32_16x16x32_bf16 v[8:11], v[196:199], v[52:55], v[8:11]
    ds_read_b128 v[52:55], v2 offset:31744
    s_waitcnt lgkmcnt(2)
    v_mfma_f32_16x16x32_bf16 v[8:11], v[208:211], v[40:43], v[8:11]
    s_sub_u32 s34, s34, s38
    v_fma_f32 v83, -v100, v59, v71
    v_fma_f32 v84, -v100, v60, v72
    v_mfma_f32_16x16x32_bf16 v[8:11], v[220:223], v[44:47], v[8:11]
    v_fma_f32 v85, -v100, v61, v73
    v_fma_f32 v86, -v100, v62, v74
    v_mfma_f32_16x16x32_bf16 v[12:15], v[224:227], v[44:47], v[12:15]
    v_fma_f32 v87, -v100, v63, v75
    v_fma_f32 v88, -v100, v64, v76
    v_mfma_f32_16x16x32_bf16 v[12:15], v[212:215], v[40:43], v[12:15]
    v_fma_f32 v89, -v100, v65, v77
    v_fma_f32 v90, -v100, v66, v78
    v_fma_f32 v91, -v100, v67, v79
    s_waitcnt vmcnt(9)
    buffer_store_dword v6, v22, s[12:15], s17 offen sc1
    s_mov_b32 s14, s6
    s_add_u32 s17, s17, 8192
    s_waitcnt vmcnt(6)
    s_barrier
    v_mfma_f32_16x16x32_bf16 v[16:19], v[216:219], v[40:43], v[16:19]
    ds_read_b128 v[40:43], v3 offset:0
    v_mfma_f32_16x16x32_bf16 v[16:19], v[228:231], v[44:47], v[16:19]
    ds_read_b128 v[44:47], v3 offset:1024
    s_waitcnt lgkmcnt(2)
    v_mfma_f32_16x16x32_bf16 v[16:19], v[240:243], v[48:51], v[16:19]
    v_mfma_f32_16x16x32_bf16 v[16:19], v[252:255], v[52:55], v[16:19]
    v_mfma_f32_16x16x32_bf16 v[12:15], v[248:251], v[52:55], v[12:15]
    v_mfma_f32_16x16x32_bf16 v[12:15], v[236:239], v[48:51], v[12:15]
    v_mfma_f32_16x16x32_bf16 v[8:11], v[232:235], v[48:51], v[8:11]
    ds_read_b128 v[48:51], v3 offset:2048
    v_mfma_f32_16x16x32_bf16 v[8:11], v[244:247], v[52:55], v[8:11]
    ds_read_b128 v[52:55], v3 offset:3072
    s_cmp_ge_i32 s31, 63
    s_cbranch_scc1 L_exit
    s_cmp_eq_u32 s30, 1
    s_cbranch_scc1 Lffa_body11
    s_cmp_eq_u32 s30, 2
    s_cbranch_scc1 Lffa_body12
    s_cmp_eq_u32 s30, 3
    s_cbranch_scc1 Lffa_body13
    s_branch Lffa_body10
Lffa_v02:
    v_mfma_f32_16x16x32_bf16 v[8:11], a[156:159], v[44:47], v[8:11]
    ds_read2st64_b64 v[104:107], v100 offset0:66 offset1:67
    v_pk_max_i16 v95, v122, 0
    v_mfma_f32_16x16x32_bf16 v[12:15], a[160:163], v[44:47], v[12:15]
    s_barrier
    v_mfma_f32_16x16x32_bf16 v[12:15], a[148:151], v[40:43], v[12:15]
    ds_read2st64_b64 v[100:103], v100 offset0:64 offset1:65
    v_add_u32 v3, s35, v1
    v_mfma_f32_16x16x32_bf16 v[16:19], a[152:155], v[40:43], v[16:19]
    ds_read_b128 v[40:43], v2 offset:16384
    v_mfma_f32_16x16x32_bf16 v[16:19], a[164:167], v[44:47], v[16:19]
    ds_read_b128 v[44:47], v2 offset:17408
    s_waitcnt lgkmcnt(4)
    v_mfma_f32_16x16x32_bf16 v[16:19], a[176:179], v[48:51], v[16:19]
    buffer_store_dwordx4 v[92:95], v1, s[12:15], s36 offen sc1
    s_add_u32 s36, s36, 116736
    v_mfma_f32_16x16x32_bf16 v[16:19], a[188:191], v[52:55], v[16:19]
    v_mfma_f32_16x16x32_bf16 v[12:15], a[184:187], v[52:55], v[12:15]
    v_mfma_f32_16x16x32_bf16 v[12:15], a[172:175], v[48:51], v[12:15]
    v_mfma_f32_16x16x32_bf16 v[8:11], a[168:171], v[48:51], v[8:11]
    ds_read_b128 v[48:51], v2 offset:18432
    s_waitcnt lgkmcnt(3)
    v_mfma_f32_16x16x32_bf16 v[8:11], a[180:183], v[52:55], v[8:11]
    ds_read_b128 v[52:55], v2 offset:19456
    s_waitcnt lgkmcnt(2)
    v_mfma_f32_16x16x32_bf16 v[8:11], a[192:195], v[40:43], v[8:11]
    v_add_f32 v100, v100, v108
    v_add_f32 v101, v101, v109
    v_mfma_f32_16x16x32_bf16 v[8:11], a[204:207], v[44:47], v[8:11]
    v_add_f32 v102, v102, v110
    v_add_f32 v103, v103, v111
    v_mfma_f32_16x16x32_bf16 v[12:15], a[208:211], v[44:47], v[12:15]
    v_add_f32 v104, v104, v112
    v_add_f32 v105, v105, v113
    v_mfma_f32_16x16x32_bf16 v[12:15], a[196:199], v[40:43], v[12:15]
    v_add_f32 v106, v106, v114
    v_add_f32 v107, v107, v115
    v_mfma_f32_16x16x32_bf16 v[16:19], a[200:203], v[40:43], v[16:19]
    ds_read_b128 v[40:43], v2 offset:20480
    v_add_f32 v100, v100, v104
    v_mfma_f32_16x16x32_bf16 v[16:19], a[212:215], v[44:47], v[16:19]
    ds_read_b128 v[44:47], v2 offset:21504
    s_waitcnt lgkmcnt(2)
    v_mfma_f32_16x16x32_bf16 v[16:19], a[224:227], v[48:51], v[16:19]
    v_add_f32 v101, v101, v105
    v_add_f32 v102, v102, v106
    v_mfma_f32_16x16x32_bf16 v[16:19], a[236:239], v[52:55], v[16:19]
    v_add_f32 v103, v103, v107
    v_add_f32 v100, v100, v102
    v_mfma_f32_16x16x32_bf16 v[12:15], a[232:235], v[52:55], v[12:15]
    v_add_f32 v101, v101, v103
    v_mfma_f32_16x16x32_bf16 v[12:15], a[220:223], v[48:51], v[12:15]
    s_nop 0
    v_permlane16_swap_b32 v100, v101
    v_mfma_f32_16x16x32_bf16 v[8:11], a[216:219], v[48:51], v[8:11]
    ds_read_b128 v[48:51], v2 offset:22528
    v_add_f32 v100, v100, v101
    v_mfma_f32_16x16x32_bf16 v[8:11], a[228:231], v[52:55], v[8:11]
    ds_read_b128 v[52:55], v2 offset:23552
    s_waitcnt lgkmcnt(2)
    v_mfma_f32_16x16x32_bf16 v[8:11], a[240:243], v[40:43], v[8:11]
    v_mov_b32 v101, v100
    v_mfma_f32_16x16x32_bf16 v[8:11], a[252:255], v[44:47], v[8:11]
    s_nop 0
    v_permlane32_swap_b32 v100, v101
    v_mfma_f32_16x16x32_bf16 v[12:15], v[128:131], v[44:47], v[12:15]
    v_add_f32 v100, v100, v101
    v_mul_f32 v100, 0x3a800000, v100
    v_mfma_f32_16x16x32_bf16 v[12:15], a[244:247], v[40:43], v[12:15]
    v_mov_b32 v101, v100
    v_mfma_f32_16x16x32_bf16 v[16:19], a[248:251], v[40:43], v[16:19]
    ds_read_b128 v[40:43], v2 offset:24576
    v_mfma_f32_16x16x32_bf16 v[16:19], v[132:135], v[44:47], v[16:19]
    ds_read_b128 v[44:47], v2 offset:25600
    s_waitcnt lgkmcnt(2)
    v_mfma_f32_16x16x32_bf16 v[16:19], v[144:147], v[48:51], v[16:19]
    v_permlane16_swap_b32 v100, v101
    v_mfma_f32_16x16x32_bf16 v[16:19], v[156:159], v[52:55], v[16:19]
    v_fma_f32 v101, -v100, v100, v101
    v_max_f32 v101, 0, v101
    v_mfma_f32_16x16x32_bf16 v[12:15], v[152:155], v[52:55], v[12:15]
    v_add_f32 v101, 0x3727c5ac, v101
    v_mfma_f32_16x16x32_bf16 v[12:15], v[140:143], v[48:51], v[12:15]
    v_rsq_f32 v21, v101
    v_mfma_f32_16x16x32_bf16 v[8:11], v[136:139], v[48:51], v[8:11]
    ds_read_b128 v[48:51], v2 offset:26624
    v_mul_f32 v100, v100, v21
    v_mfma_f32_16x16x32_bf16 v[8:11], v[148:151], v[52:55], v[8:11]
    ds_read_b128 v[52:55], v2 offset:27648
    s_waitcnt lgkmcnt(2)
    v_mfma_f32_16x16x32_bf16 v[8:11], v[160:163], v[40:43], v[8:11]
    v_fma_f32 v80, -v100, v56, v68
    v_fma_f32 v81, -v100, v57, v69
    v_mfma_f32_16x16x32_bf16 v[8:11], v[172:175], v[44:47], v[8:11]
    v_fma_f32 v82, -v100, v58, v70
    v_fma_f32 v83, -v100, v59, v71
    v_mfma_f32_16x16x32_bf16 v[12:15], v[176:179], v[44:47], v[12:15]
    v_fma_f32 v84, -v100, v60, v72
    v_fma_f32 v85, -v100, v61, v73
    v_mfma_f32_16x16x32_bf16 v[12:15], v[164:167], v[40:43], v[12:15]
    v_fma_f32 v86, -v100, v62, v74
    v_fma_f32 v87, -v100, v63, v75
    v_mfma_f32_16x16x32_bf16 v[16:19], v[168:171], v[40:43], v[16:19]
    ds_read_b128 v[40:43], v2 offset:28672
    v_fma_f32 v88, -v100, v64, v76
    v_mfma_f32_16x16x32_bf16 v[16:19], v[180:183], v[44:47], v[16:19]
    ds_read_b128 v[44:47], v2 offset:29696
    s_waitcnt lgkmcnt(2)
    v_mfma_f32_16x16x32_bf16 v[16:19], v[192:195], v[48:51], v[16:19]
    v_fma_f32 v89, -v100, v65, v77
    v_fma_f32 v90, -v100, v66, v78
    v_mfma_f32_16x16x32_bf16 v[16:19], v[204:207], v[52:55], v[16:19]
    v_fma_f32 v91, -v100, v67, v79
    v_mfma_f32_16x16x32_bf16 v[12:15], v[200:203], v[52:55], v[12:15]
    v_mfma_f32_16x16x32_bf16 v[12:15], v[188:191], v[48:51], v[12:15]
    v_mfma_f32_16x16x32_bf16 v[8:11], v[184:187], v[48:51], v[8:11]
    ds_read_b128 v[48:51], v2 offset:30720
    v_mfma_f32_16x16x32_bf16 v[8:11], v[196:199], v[52:55], v[8:11]
    ds_read_b128 v[52:55], v2 offset:31744
    s_waitcnt lgkmcnt(2)
    v_mfma_f32_16x16x32_bf16 v[8:11], v[208:211], v[40:43], v[8:11]
    buffer_load_dword v5, v4, s[4:7], s16 offen sc1
    v_mfma_f32_16x16x32_bf16 v[8:11], v[220:223], v[44:47], v[8:11]
    v_mfma_f32_16x16x32_bf16 v[12:15], v[224:227], v[44:47], v[12:15]
    v_mfma_f32_16x16x32_bf16 v[12:15], v[212:215], v[40:43], v[12:15]
    s_waitcnt vmcnt(1)
    buffer_store_dword v6, v22, s[12:15], s17 offen sc1
    v_mfma_f32_16x16x32_bf16 v[16:19], v[216:219], v[40:43], v[16:19]
    s_mov_b32 s14, s6
    s_add_u32 s17, s17, 8192
    v_mfma_f32_16x16x32_bf16 v[16:19], v[228:231], v[44:47], v[16:19]
    s_waitcnt lgkmcnt(0)
    v_mfma_f32_16x16x32_bf16 v[16:19], v[240:243], v[48:51], v[16:19]
    v_mfma_f32_16x16x32_bf16 v[16:19], v[252:255], v[52:55], v[16:19]
    v_mfma_f32_16x16x32_bf16 v[12:15], v[248:251], v[52:55], v[12:15]
    v_mfma_f32_16x16x32_bf16 v[12:15], v[236:239], v[48:51], v[12:15]
    v_mfma_f32_16x16x32_bf16 v[8:11], v[232:235], v[48:51], v[8:11]
    v_mfma_f32_16x16x32_bf16 v[8:11], v[244:247], v[52:55], v[8:11]
    s_nop 3
    v_fma_f32 v124, v16, v21, v88
    v_fma_f32 v125, v17, v21, v89
    v_fma_f32 v126, v18, v21, v90
    v_fma_f32 v127, v19, v21, v91
    v_mul_f32 v124, v124, |v124|
    v_mul_f32 v125, v125, |v125|
    v_mul_f32 v126, v126, |v126|
    v_mul_f32 v127, v127, |v127|
    v_cvt_pk_bf16_f32 v124, v124, v125
    v_cvt_pk_bf16_f32 v126, v126, v127
    v_pk_max_i16 v96, v124, 0
    v_pk_max_i16 v97, v126, 0
    v_pk_max_i16 v98, v124, 0
    v_pk_max_i16 v99, v126, 0
    v_fma_f32 v116, v8, v21, v80
    v_permlane32_swap_b32 v96, v98
    v_permlane32_swap_b32 v97, v99
    buffer_store_dwordx4 v[96:99], v7, s[12:15], s36 offen sc1
    v_fma_f32 v117, v9, v21, v81
    v_fma_f32 v118, v10, v21, v82
    v_fma_f32 v119, v11, v21, v83
    v_fma_f32 v120, v12, v21, v84
    v_fma_f32 v121, v13, v21, v85
    v_fma_f32 v122, v14, v21, v86
    v_fma_f32 v123, v15, v21, v87
    v_mul_f32 v116, v116, |v116|
    v_mul_f32 v117, v117, |v117|
    v_mul_f32 v118, v118, |v118|
    v_mul_f32 v119, v119, |v119|
    v_mul_f32 v120, v120, |v120|
    v_mul_f32 v121, v121, |v121|
    v_mul_f32 v122, v122, |v122|
    v_mul_f32 v123, v123, |v123|
    v_cvt_pk_bf16_f32 v116, v116, v117
    v_cvt_pk_bf16_f32 v118, v118, v119
    v_cvt_pk_bf16_f32 v120, v120, v121
    v_cvt_pk_bf16_f32 v122, v122, v123
    v_pk_max_i16 v92, v116, 0
    v_pk_max_i16 v93, v118, 0
    v_pk_max_i16 v94, v120, 0
    v_pk_max_i16 v95, v122, 0
    buffer_store_dwordx4 v[92:95], v1, s[12:15], s36 offen sc1
    s_add_u32 s54, s31, 1
    v_mov_b32 v6, s54
    s_waitcnt vmcnt(3)
    s_cmp_ge_i32 s31, 63
    s_cbranch_scc1 Lffa_late0
    v_cmp_gt_i32 vcc, s32, v5
    s_sub_u32 s43, s43, 1
    s_cmp_lt_i32 s43, 0
    s_cbranch_scc1 Lffa_rdy0
    s_and_b64 vcc, vcc, s[18:19]
    s_cbranch_scc0 Lffa_rdy0
Lffa_late0:
    buffer_load_dword v5, v4, s[4:7], s16 offen sc1
    s_waitcnt vmcnt(1)
    buffer_store_dword v6, v22, s[12:15], s17 offen sc1
    s_mov_b32 s14, 0
    s_cmp_ge_i32 s31, 63
    s_cbranch_scc1 L_exit
    s_waitcnt vmcnt(1)
    v_cmp_gt_i32 vcc, s32, v5
    s_sub_u32 s43, s43, 1
    s_cmp_lt_i32 s43, 0
    s_cbranch_scc1 Lffa_rdy0
    s_and_b64 vcc, vcc, s[18:19]
    s_cbranch_scc0 Lffa_rdy0
Lffa_spin0:
    buffer_load_dword v5, v4, s[4:7], s16 offen sc1
    s_waitcnt vmcnt(0)
    v_cmp_gt_i32 vcc, s32, v5
    s_sub_u32 s43, s43, 1
    s_cmp_lt_i32 s43, 0
    s_cbranch_scc1 Lffa_rdy0
    s_and_b64 vcc, vcc, s[18:19]
    s_cbranch_scc0 Lffa_rdy0
    s_sleep 8
    s_branch Lffa_spin0
Lffa_rdy0:
    s_add_u32 m0, s34, 0
    s_nop 0
    buffer_load_dwordx4 v1, s[8:11], s33 offen offset:0 sc1 lds
    buffer_load_dwordx4 v1, s[8:11], s33 offen offset:1024 sc1 lds
    buffer_load_dwordx4 v1, s[8:11], s33 offen offset:2048 sc1 lds
    buffer_load_dwordx4 v1, s[8:11], s33 offen offset:3072 sc1 lds
    s_add_u32 m0, s34, s3
    s_add_u32 s37, s33, s3
    buffer_load_dwordx4 v1, s[8:11], s37 offen offset:0 sc1 lds
    s_add_u32 s16, s16, 8192
    buffer_load_dword v5, v4, s[4:7], s16 offen sc1
    s_add_u32 m0, s34, 16384
    s_add_u32 s37, s33, 16384
    buffer_load_dwordx4 v1, s[8:11], s37 offen offset:0 sc1 lds
    buffer_load_dwordx4 v1, s[8:11], s37 offen offset:1024 sc1 lds
    buffer_load_dwordx4 v1, s[8:11], s37 offen offset:2048 sc1 lds
    buffer_load_dwordx4 v1, s[8:11], s37 offen offset:3072 sc1 lds
    s_add_u32 s32, s32, 1
    s_add_u32 s33, s33, 36864
    s_add_u32 s34, s34, 36864
    s_cmp_ge_u32 s34, 147456
    s_cselect_b32 s38, 147456, 0
    s_sub_u32 s34, s34, s38
    s_waitcnt vmcnt(5)
    buffer_store_dword v6, v22, s[12:15], s17 offen sc1
Lffa_go0:
    s_mov_b32 s14, 0
    s_barrier
    ds_read_b128 v[40:43], v3 offset:0
    ds_read_b128 v[44:47], v3 offset:1024
    ds_read_b128 v[48:51], v3 offset:2048
    ds_read_b128 v[52:55], v3 offset:3072
    s_cmp_eq_u32 s30, 1
    s_cbranch_scc1 Lffa_body11
    s_cmp_eq_u32 s30, 2
    s_cbranch_scc1 Lffa_body12
    s_cmp_eq_u32 s30, 3
    s_cbranch_scc1 Lffa_body13
    s_branch Lffa_body10
Lffa_v11:
    v_mfma_f32_16x16x32_bf16 v[28:31], a[4:7], v[40:43], v[28:31]
    buffer_load_dword v5, v4, s[4:7], s16 offen sc1
    v_mfma_f32_16x16x32_bf16 v[32:35], a[8:11], v[40:43], 0
    ds_read_b128 v[40:43], v3 offset:4096
    v_fma_f32 v125, v17, v21, v89
    v_mfma_f32_16x16x32_bf16 v[32:35], a[20:23], v[44:47], v[32:35]
    ds_read_b128 v[44:47], v3 offset:5120
    s_waitcnt lgkmcnt(2)
    v_mfma_f32_16x16x32_bf16 v[32:35], a[32:35], v[48:51], v[32:35]
    s_add_u32 s35, s35, 36864
    v_fma_f32 v126, v18, v21, v90
    v_fma_f32 v127, v19, v21, v91
    v_mfma_f32_16x16x32_bf16 v[32:35], a[44:47], v[52:55], v[32:35]
    s_cmp_eq_u32 s35, 147456
    s_cselect_b32 s35, 0, s35
    v_mul_f32 v124, v124, |v124|
    v_mfma_f32_16x16x32_bf16 v[28:31], a[40:43], v[52:55], v[28:31]
    v_mul_f32 v125, v125, |v125|
    v_mul_f32 v126, v126, |v126|
    v_mfma_f32_16x16x32_bf16 v[28:31], a[28:31], v[48:51], v[28:31]
    v_mul_f32 v127, v127, |v127|
    v_cvt_pk_bf16_f32 v124, v124, v125
    v_mfma_f32_16x16x32_bf16 v[24:27], a[24:27], v[48:51], v[24:27]
    ds_read_b128 v[48:51], v3 offset:6144
    v_cvt_pk_bf16_f32 v126, v126, v127
    v_mfma_f32_16x16x32_bf16 v[24:27], a[36:39], v[52:55], v[24:27]
    ds_read_b128 v[52:55], v3 offset:7168
    s_waitcnt lgkmcnt(2)
    v_mfma_f32_16x16x32_bf16 v[24:27], a[48:51], v[40:43], v[24:27]
    v_pk_max_i16 v96, v124, 0
    v_pk_max_i16 v97, v126, 0
    v_mfma_f32_16x16x32_bf16 v[24:27], a[60:63], v[44:47], v[24:27]
    v_pk_max_i16 v98, v124, 0
    v_pk_max_i16 v99, v126, 0
    v_mfma_f32_16x16x32_bf16 v[28:31], a[64:67], v[44:47], v[28:31]
    v_permlane32_swap_b32 v96, v98
    v_mfma_f32_16x16x32_bf16 v[28:31], a[52:55], v[40:43], v[28:31]
    v_permlane32_swap_b32 v97, v99
    v_mfma_f32_16x16x32_bf16 v[32:35], a[56:59], v[40:43], v[32:35]
    ds_read_b128 v[40:43], v3 offset:8192
    v_fma_f32 v116, v8, v21, v80
    v_mfma_f32_16x16x32_bf16 v[32:35], a[68:71], v[44:47], v[32:35]
    ds_read_b128 v[44:47], v3 offset:9216
    s_waitcnt lgkmcnt(2)
    v_mfma_f32_16x16x32_bf16 v[32:35], a[80:83], v[48:51], v[32:35]
    buffer_store_dwordx4 v[96:99], v7, s[12:15], s36 offen sc1
    v_fma_f32 v117, v9, v21, v81
    v_mfma_f32_16x16x32_bf16 v[32:35], a[92:95], v[52:55], v[32:35]
    v_fma_f32 v118, v10, v21, v82
    v_fma_f32 v119, v11, v21, v83
    v_mfma_f32_16x16x32_bf16 v[28:31], a[88:91], v[52:55], v[28:31]
    v_fma_f32 v120, v12, v21, v84
    v_fma_f32 v121, v13, v21, v85
    v_mfma_f32_16x16x32_bf16 v[28:31], a[76:79], v[48:51], v[28:31]
    v_fma_f32 v122, v14, v21, v86
    v_fma_f32 v123, v15, v21, v87
    v_mfma_f32_16x16x32_bf16 v[24:27], a[72:75], v[48:51], v[24:27]
    ds_read_b128 v[48:51], v3 offset:10240
    v_mul_f32 v116, v116, |v116|
    v_mfma_f32_16x16x32_bf16 v[24:27], a[84:87], v[52:55], v[24:27]
    ds_read_b128 v[52:55], v3 offset:11264
    s_waitcnt lgkmcnt(2)
    v_mfma_f32_16x16x32_bf16 v[24:27], a[96:99], v[40:43], v[24:27]
    v_mul_f32 v117, v117, |v117|
    v_mul_f32 v118, v118, |v118|
    v_mfma_f32_16x16x32_bf16 v[24:27], a[108:111], v[44:47], v[24:27]
    v_mul_f32 v119, v119, |v119|
    v_mul_f32 v120, v120, |v120|
    v_mfma_f32_16x16x32_bf16 v[28:31], a[112:115], v[44:47], v[28:31]
    v_mul_f32 v121, v121, |v121|
    v_mul_f32 v122, v122, |v122|
    v_mfma_f32_16x16x32_bf16 v[28:31], a[100:103], v[40:43], v[28:31]
    v_mul_f32 v123, v123, |v123|
    v_cvt_pk_bf16_f32 v116, v116, v117
    v_mfma_f32_16x16x32_bf16 v[32:35], a[104:107], v[40:43], v[32:35]
    ds_read_b128 v[40:43], v3 offset:12288
    v_cvt_pk_bf16_f32 v118, v118, v119
    v_mfma_f32_16x16x32_bf16 v[32:35], a[116:119], v[44:47], v[32:35]
    ds_read_b128 v[44:47], v3 offset:13312
    s_waitcnt lgkmcnt(2)
    v_mfma_f32_16x16x32_bf16 v[32:35], a[128:131], v[48:51], v[32:35]
    v_sub_u32 v100, v3, v20
    v_cvt_pk_bf16_f32 v120, v120, v121
    v_mfma_f32_16x16x32_bf16 v[32:35], a[140:143], v[52:55], v[32:35]
    ds_read2st64_b64 v[112:115], v100 offset0:70 offset1:71
    v_cvt_pk_bf16_f32 v122, v122, v123
    v_mfma_f32_16x16x32_bf16 v[28:31], a[136:139], v[52:55], v[28:31]
    ds_read2st64_b64 v[108:111], v100 offset0:68 offset1:69
    v_pk_max_i16 v92, v116, 0
    v_mfma_f32_16x16x32_bf16 v[28:31], a[124:127], v[48:51], v[28:31]
    s_waitcnt vmcnt(1)
    v_cmp_gt_i32 vcc, s32, v5
    v_pk_max_i16 v93, v118, 0
    v_mfma_f32_16x16x32_bf16 v[24:27], a[120:123], v[48:51], v[24:27]
    ds_read_b128 v[48:51], v3 offset:14336
    v_pk_max_i16 v94, v120, 0
    v_mfma_f32_16x16x32_bf16 v[24:27], a[132:135], v[52:55], v[24:27]
    ds_read_b128 v[52:55], v3 offset:15360
    s_waitcnt lgkmcnt(4)
    v_mfma_f32_16x16x32_bf16 v[24:27], a[144:147], v[40:43], v[24:27]
    s_and_b64 vcc, vcc, s[18:19]
    s_cbranch_scc1 Lffa_v12
    v_mfma_f32_16x16x32_bf16 v[24:27], a[156:159], v[44:47], v[24:27]
    buffer_load_dwordx4 v1, s[8:11], s33 offen offset:0 sc1 lds
    v_mfma_f32_16x16x32_bf16 v[28:31], a[160:163], v[44:47], v[28:31]
    s_barrier
    v_mfma_f32_16x16x32_bf16 v[28:31], a[148:151], v[40:43], v[28:31]
    ds_read2st64_b64 v[104:107], v100 offset0:66 offset1:67
    v_pk_max_i16 v95, v122, 0
    v_mfma_f32_16x16x32_bf16 v[32:35], a[152:155], v[40:43], v[32:35]
    ds_read_b128 v[40:43], v3 offset:16384
    v_add_u32 v2, s35, v1
    v_mfma_f32_16x16x32_bf16 v[32:35], a[164:167], v[44:47], v[32:35]
    ds_read_b128 v[44:47], v3 offset:17408
    s_waitcnt lgkmcnt(3)
    v_mfma_f32_16x16x32_bf16 v[32:35], a[176:179], v[48:51], v[32:35]
    ds_read2st64_b64 v[100:103], v100 offset0:64 offset1:65
    v_mfma_f32_16x16x32_bf16 v[32:35], a[188:191], v[52:55], v[32:35]
    buffer_store_dwordx4 v[92:95], v1, s[12:15], s36 offen sc1
    s_add_u32 s36, s36, 116736
    v_mfma_f32_16x16x32_bf16 v[28:31], a[184:187], v[52:55], v[28:31]
    v_mfma_f32_16x16x32_bf16 v[28:31], a[172:175], v[48:51], v[28:31]
    v_mfma_f32_16x16x32_bf16 v[24:27], a[168:171], v[48:51], v[24:27]
    ds_read_b128 v[48:51], v3 offset:18432
    v_mfma_f32_16x16x32_bf16 v[24:27], a[180:183], v[52:55], v[24:27]
    ds_read_b128 v[52:55], v3 offset:19456
    s_waitcnt lgkmcnt(3)
    v_mfma_f32_16x16x32_bf16 v[24:27], a[192:195], v[40:43], v[24:27]
    buffer_load_dwordx4 v1, s[8:11], s33 offen offset:1024 sc1 lds
    v_mfma_f32_16x16x32_bf16 v[24:27], a[204:207], v[44:47], v[24:27]
    s_waitcnt lgkmcnt(2)
    v_add_f32 v100, v100, v108
    v_add_f32 v101, v101, v109
    v_mfma_f32_16x16x32_bf16 v[28:31], a[208:211], v[44:47], v[28:31]
    v_add_f32 v102, v102, v110
    v_add_f32 v103, v103, v111
    v_mfma_f32_16x16x32_bf16 v[28:31], a[196:199], v[40:43], v[28:31]
    buffer_load_dwordx4 v1, s[8:11], s33 offen offset:2048 sc1 lds
    v_mfma_f32_16x16x32_bf16 v[32:35], a[200:203], v[40:43], v[32:35]
    ds_read_b128 v[40:43], v3 offset:20480
    v_add_f32 v104, v104, v112
    v_mfma_f32_16x16x32_bf16 v[32:35], a[212:215], v[44:47], v[32:35]
    ds_read_b128 v[44:47], v3 offset:21504
    s_waitcnt lgkmcnt(2)
    v_mfma_f32_16x16x32_bf16 v[32:35], a[224:227], v[48:51], v[32:35]
    buffer_load_dwordx4 v1, s[8:11], s33 offen offset:3072 sc1 lds
    v_mfma_f32_16x16x32_bf16 v[32:35], a[236:239], v[52:55], v[32:35]
    s_add_u32 m0, s34, s3
    v_add_f32 v105, v105, v113
    v_add_f32 v106, v106, v114
    v_mfma_f32_16x16x32_bf16 v[28:31], a[232:235], v[52:55], v[28:31]
    s_add_u32 s37, s33, s3
    v_add_f32 v107, v107, v115
    v_add_f32 v100, v100, v104
    v_mfma_f32_16x16x32_bf16 v[28:31], a[220:223], v[48:51], v[28:31]
    buffer_load_dwordx4 v1, s[8:11], s37 offen offset:0 sc1 lds
    v_mfma_f32_16x16x32_bf16 v[24:27], a[216:219], v[48:51], v[24:27]
    ds_read_b128 v[48:51], v3 offset:22528
    v_add_f32 v101, v101, v105
    v_mfma_f32_16x16x32_bf16 v[24:27], a[228:231], v[52:55], v[24:27]
    ds_read_b128 v[52:55], v3 offset:23552
    s_waitcnt lgkmcnt(2)
    v_mfma_f32_16x16x32_bf16 v[24:27], a[240:243], v[40:43], v[24:27]
    s_add_u32 s16, s16, 8192
    v_add_f32 v102, v102, v106
    v_add_f32 v103, v103, v107
    v_mfma_f32_16x16x32_bf16 v[24:27], a[252:255], v[44:47], v[24:27]
    buffer_load_dword v5, v4, s[4:7], s16 offen sc1
    v_mfma_f32_16x16x32_bf16 v[28:31], v[128:131], v[44:47], v[28:31]
    s_add_u32 m0, s34, 16384
    v_add_f32 v100, v100, v102
    v_add_f32 v101, v101, v103
    v_mfma_f32_16x16x32_bf16 v[28:31], a[244:247], v[40:43], v[28:31]
    s_add_u32 s37, s33, 16384
    v_permlane16_swap_b32 v100, v101
    v_mfma_f32_16x16x32_bf16 v[32:35], a[248:251], v[40:43], v[32:35]
    ds_read_b128 v[40:43], v3 offset:24576
    v_add_f32 v100, v100, v101
    v_mfma_f32_16x16x32_bf16 v[32:35], v[132:135], v[44:47], v[32:35]
    ds_read_b128 v[44:47], v3 offset:25600
    s_waitcnt lgkmcnt(2)
    v_mfma_f32_16x16x32_bf16 v[32:35], v[144:147], v[48:51], v[32:35]
    buffer_load_dwordx4 v1, s[8:11], s37 offen offset:0 sc1 lds
    v_mfma_f32_16x16x32_bf16 v[32:35], v[156:159], v[52:55], v[32:35]
    v_mov_b32 v101, v100
    v_mfma_f32_16x16x32_bf16 v[28:31], v[152:155], v[52:55], v[28:31]
    s_nop 0
    v_permlane32_swap_b32 v100, v101
    v_mfma_f32_16x16x32_bf16 v[28:31], v[140:143], v[48:51], v[28:31]
    buffer_load_dwordx4 v1, s[8:11], s37 offen offset:1024 sc1 lds
    v_mfma_f32_16x16x32_bf16 v[24:27], v[136:139], v[48:51], v[24:27]
    ds_read_b128 v[48:51], v3 offset:26624
    v_add_f32 v100, v100, v101
    v_mfma_f32_16x16x32_bf16 v[24:27], v[148:151], v[52:55], v[24:27]
    ds_read_b128 v[52:55], v3 offset:27648
    s_waitcnt lgkmcnt(2)
    v_mfma_f32_16x16x32_bf16 v[24:27], v[160:163], v[40:43], v[24:27]
    buffer_load_dwordx4 v1, s[8:11], s37 offen offset:2048 sc1 lds
    v_mfma_f32_16x16x32_bf16 v[24:27], v[172:175], v[44:47], v[24:27]
    v_mul_f32 v100, 0x3a800000, v100
    v_mov_b32 v101, v100
    v_mfma_f32_16x16x32_bf16 v[28:31], v[176:179], v[44:47], v[28:31]
    s_nop 0
    v_permlane16_swap_b32 v100, v101
    v_mfma_f32_16x16x32_bf16 v[28:31], v[164:167], v[40:43], v[28:31]
    buffer_load_dwordx4 v1, s[8:11], s37 offen offset:3072 sc1 lds
    v_mfma_f32_16x16x32_bf16 v[32:35], v[168:171], v[40:43], v[32:35]
    ds_read_b128 v[40:43], v3 offset:28672
    v_fma_f32 v101, -v100, v100, v101
    v_mfma_f32_16x16x32_bf16 v[32:35], v[180:183], v[44:47], v[32:35]
    ds_read_b128 v[44:47], v3 offset:29696
    s_waitcnt lgkmcnt(2)
    v_mfma_f32_16x16x32_bf16 v[32:35], v[192:195], v[48:51], v[32:35]
    s_add_u32 s32, s32, 1
    v_max_f32 v101, 0, v101
    v_add_f32 v101, 0x3727c5ac, v101
    v_mfma_f32_16x16x32_bf16 v[32:35], v[204:207], v[52:55], v[32:35]
    s_add_u32 s33, s33, 36864
    v_rsq_f32 v21, v101
    v_mfma_f32_16x16x32_bf16 v[28:31], v[200:203], v[52:55], v[28:31]
    s_add_u32 s34, s34, 36864
    v_mul_f32 v100, v100, v21
    v_fma_f32 v80, -v100, v56, v68
    v_mfma_f32_16x16x32_bf16 v[28:31], v[188:191], v[48:51], v[28:31]
    s_cmp_ge_u32 s34, 147456
    s_cselect_b32 s38, 147456, 0
    v_fma_f32 v81, -v100, v57, v69
    v_mfma_f32_16x16x32_bf16 v[24:27], v[184:187], v[48:51], v[24:27]
    ds_read_b128 v[48:51], v3 offset:30720
    v_fma_f32 v82, -v100, v58, v70
    v_mfma_f32_16x16x32_bf16 v[24:27], v[196:199], v[52:55], v[24:27]
    ds_read_b128 v[52:55], v3 offset:31744
    s_waitcnt lgkmcnt(2)
    v_mfma_f32_16x16x32_bf16 v[24:27], v[208:211], v[40:43], v[24:27]
    s_sub_u32 s34, s34, s38
    v_fma_f32 v83, -v100, v59, v71
    v_fma_f32 v84, -v100, v60, v72
    v_mfma_f32_16x16x32_bf16 v[24:27], v[220:223], v[44:47], v[24:27]
    v_fma_f32 v85, -v100, v61, v73
    v_fma_f32 v86, -v100, v62, v74
    v_mfma_f32_16x16x32_bf16 v[28:31], v[224:227], v[44:47], v[28:31]
    v_fma_f32 v87, -v100, v63, v75
    v_fma_f32 v88, -v100, v64, v76
    v_mfma_f32_16x16x32_bf16 v[28:31], v[212:215], v[40:43], v[28:31]
    v_fma_f32 v89, -v100, v65, v77
    v_fma_f32 v90, -v100, v66, v78
    v_fma_f32 v91, -v100, v67, v79
    s_waitcnt vmcnt(9)
    buffer_store_dword v6, v22, s[12:15], s17 offen sc1
    s_mov_b32 s14, s6
    s_add_u32 s17, s17, 8192
    s_waitcnt vmcnt(6)
    s_barrier
    v_mfma_f32_16x16x32_bf16 v[32:35], v[216:219], v[40:43], v[32:35]
    ds_read_b128 v[40:43], v2 offset:0
    v_mfma_f32_16x16x32_bf16 v[32:35], v[228:231], v[44:47], v[32:35]
    ds_read_b128 v[44:47], v2 offset:1024
    s_waitcnt lgkmcnt(2)
    v_mfma_f32_16x16x32_bf16 v[32:35], v[240:243], v[48:51], v[32:35]
    v_mfma_f32_16x16x32_bf16 v[32:35], v[252:255], v[52:55], v[32:35]
    v_mfma_f32_16x16x32_bf16 v[28:31], v[248:251], v[52:55], v[28:31]
    v_mfma_f32_16x16x32_bf16 v[28:31], v[236:239], v[48:51], v[28:31]
    v_mfma_f32_16x16x32_bf16 v[24:27], v[232:235], v[48:51], v[24:27]
    ds_read_b128 v[48:51], v2 offset:2048
    v_mfma_f32_16x16x32_bf16 v[24:27], v[244:247], v[52:55], v[24:27]
    ds_read_b128 v[52:55], v2 offset:3072
    s_cmp_ge_i32 s31, 63
    s_cbranch_scc1 L_exit
    s_cmp_eq_u32 s30, 1
    s_cbranch_scc1 Lffa_body01
    s_cmp_eq_u32 s30, 2
    s_cbranch_scc1 Lffa_body02
    s_cmp_eq_u32 s30, 3
    s_cbranch_scc1 Lffa_body03
    s_branch Lffa_body00
Lffa_v12:
    v_mfma_f32_16x16x32_bf16 v[24:27], a[156:159], v[44:47], v[24:27]
    ds_read2st64_b64 v[104:107], v100 offset0:66 offset1:67
    v_pk_max_i16 v95, v122, 0
    v_mfma_f32_16x16x32_bf16 v[28:31], a[160:163], v[44:47], v[28:31]
    s_barrier
    v_mfma_f32_16x16x32_bf16 v[28:31], a[148:151], v[40:43], v[28:31]
    ds_read2st64_b64 v[100:103], v100 offset0:64 offset1:65
    v_add_u32 v2, s35, v1
    v_mfma_f32_16x16x32_bf16 v[32:35], a[152:155], v[40:43], v[32:35]
    ds_read_b128 v[40:43], v3 offset:16384
    v_mfma_f32_16x16x32_bf16 v[32:35], a[164:167], v[44:47], v[32:35]
    ds_read_b128 v[44:47], v3 offset:17408
    s_waitcnt lgkmcnt(4)
    v_mfma_f32_16x16x32_bf16 v[32:35], a[176:179], v[48:51], v[32:35]
    buffer_store_dwordx4 v[92:95], v1, s[12:15], s36 offen sc1
    s_add_u32 s36, s36, 116736
    v_mfma_f32_16x16x32_bf16 v[32:35], a[188:191], v[52:55], v[32:35]
    v_mfma_f32_16x16x32_bf16 v[28:31], a[184:187], v[52:55], v[28:31]
    v_mfma_f32_16x16x32_bf16 v[28:31], a[172:175], v[48:51], v[28:31]
    v_mfma_f32_16x16x32_bf16 v[24:27], a[168:171], v[48:51], v[24:27]
    ds_read_b128 v[48:51], v3 offset:18432
    s_waitcnt lgkmcnt(3)
    v_mfma_f32_16x16x32_bf16 v[24:27], a[180:183], v[52:55], v[24:27]
    ds_read_b128 v[52:55], v3 offset:19456
    s_waitcnt lgkmcnt(2)
    v_mfma_f32_16x16x32_bf16 v[24:27], a[192:195], v[40:43], v[24:27]
    v_add_f32 v100, v100, v108
    v_add_f32 v101, v101, v109
    v_mfma_f32_16x16x32_bf16 v[24:27], a[204:207], v[44:47], v[24:27]
    v_add_f32 v102, v102, v110
    v_add_f32 v103, v103, v111
    v_mfma_f32_16x16x32_bf16 v[28:31], a[208:211], v[44:47], v[28:31]
    v_add_f32 v104, v104, v112
    v_add_f32 v105, v105, v113
    v_mfma_f32_16x16x32_bf16 v[28:31], a[196:199], v[40:43], v[28:31]
    v_add_f32 v106, v106, v114
    v_add_f32 v107, v107, v115
    v_mfma_f32_16x16x32_bf16 v[32:35], a[200:203], v[40:43], v[32:35]
    ds_read_b128 v[40:43], v3 offset:20480
    v_add_f32 v100, v100, v104
    v_mfma_f32_16x16x32_bf16 v[32:35], a[212:215], v[44:47], v[32:35]
    ds_read_b128 v[44:47], v3 offset:21504
    s_waitcnt lgkmcnt(2)
    v_mfma_f32_16x16x32_bf16 v[32:35], a[224:227], v[48:51], v[32:35]
    v_add_f32 v101, v101, v105
    v_add_f32 v102, v102, v106
    v_mfma_f32_16x16x32_bf16 v[32:35], a[236:239], v[52:55], v[32:35]
    v_add_f32 v103, v103, v107
    v_add_f32 v100, v100, v102
    v_mfma_f32_16x16x32_bf16 v[28:31], a[232:235], v[52:55], v[28:31]
    v_add_f32 v101, v101, v103
    v_mfma_f32_16x16x32_bf16 v[28:31], a[220:223], v[48:51], v[28:31]
    s_nop 0
    v_permlane16_swap_b32 v100, v101
    v_mfma_f32_16x16x32_bf16 v[24:27], a[216:219], v[48:51], v[24:27]
    ds_read_b128 v[48:51], v3 offset:22528
    v_add_f32 v100, v100, v101
    v_mfma_f32_16x16x32_bf16 v[24:27], a[228:231], v[52:55], v[24:27]
    ds_read_b128 v[52:55], v3 offset:23552
    s_waitcnt lgkmcnt(2)
    v_mfma_f32_16x16x32_bf16 v[24:27], a[240:243], v[40:43], v[24:27]
    v_mov_b32 v101, v100
    v_mfma_f32_16x16x32_bf16 v[24:27], a[252:255], v[44:47], v[24:27]
    s_nop 0
    v_permlane32_swap_b32 v100, v101
    v_mfma_f32_16x16x32_bf16 v[28:31], v[128:131], v[44:47], v[28:31]
    v_add_f32 v100, v100, v101
    v_mul_f32 v100, 0x3a800000, v100
    v_mfma_f32_16x16x32_bf16 v[28:31], a[244:247], v[40:43], v[28:31]
    v_mov_b32 v101, v100
    v_mfma_f32_16x16x32_bf16 v[32:35], a[248:251], v[40:43], v[32:35]
    ds_read_b128 v[40:43], v3 offset:24576
    v_mfma_f32_16x16x32_bf16 v[32:35], v[132:135], v[44:47], v[32:35]
    ds_read_b128 v[44:47], v3 offset:25600
    s_waitcnt lgkmcnt(2)
    v_mfma_f32_16x16x32_bf16 v[32:35], v[144:147], v[48:51], v[32:35]
    v_permlane16_swap_b32 v100, v101
    v_mfma_f32_16x16x32_bf16 v[32:35], v[156:159], v[52:55], v[32:35]
    v_fma_f32 v101, -v100, v100, v101
    v_max_f32 v101, 0, v101
    v_mfma_f32_16x16x32_bf16 v[28:31], v[152:155], v[52:55], v[28:31]
    v_add_f32 v101, 0x3727c5ac, v101
    v_mfma_f32_16x16x32_bf16 v[28:31], v[140:143], v[48:51], v[28:31]
    v_rsq_f32 v21, v101
    v_mfma_f32_16x16x32_bf16 v[24:27], v[136:139], v[48:51], v[24:27]
    ds_read_b128 v[48:51], v3 offset:26624
    v_mul_f32 v100, v100, v21
    v_mfma_f32_16x16x32_bf16 v[24:27], v[148:151], v[52:55], v[24:27]
    ds_read_b128 v[52:55], v3 offset:27648
    s_waitcnt lgkmcnt(2)
    v_mfma_f32_16x16x32_bf16 v[24:27], v[160:163], v[40:43], v[24:27]
    v_fma_f32 v80, -v100, v56, v68
    v_fma_f32 v81, -v100, v57, v69
    v_mfma_f32_16x16x32_bf16 v[24:27], v[172:175], v[44:47], v[24:27]
    v_fma_f32 v82, -v100, v58, v70
    v_fma_f32 v83, -v100, v59, v71
    v_mfma_f32_16x16x32_bf16 v[28:31], v[176:179], v[44:47], v[28:31]
    v_fma_f32 v84, -v100, v60, v72
    v_fma_f32 v85, -v100, v61, v73
    v_mfma_f32_16x16x32_bf16 v[28:31], v[164:167], v[40:43], v[28:31]
    v_fma_f32 v86, -v100, v62, v74
    v_fma_f32 v87, -v100, v63, v75
    v_mfma_f32_16x16x32_bf16 v[32:35], v[168:171], v[40:43], v[32:35]
    ds_read_b128 v[40:43], v3 offset:28672
    v_fma_f32 v88, -v100, v64, v76
    v_mfma_f32_16x16x32_bf16 v[32:35], v[180:183], v[44:47], v[32:35]
    ds_read_b128 v[44:47], v3 offset:29696
    s_waitcnt lgkmcnt(2)
    v_mfma_f32_16x16x32_bf16 v[32:35], v[192:195], v[48:51], v[32:35]
    v_fma_f32 v89, -v100, v65, v77
    v_fma_f32 v90, -v100, v66, v78
    v_mfma_f32_16x16x32_bf16 v[32:35], v[204:207], v[52:55], v[32:35]
    v_fma_f32 v91, -v100, v67, v79
    v_mfma_f32_16x16x32_bf16 v[28:31], v[200:203], v[52:55], v[28:31]
    v_mfma_f32_16x16x32_bf16 v[28:31], v[188:191], v[48:51], v[28:31]
    v_mfma_f32_16x16x32_bf16 v[24:27], v[184:187], v[48:51], v[24:27]
    ds_read_b128 v[48:51], v3 offset:30720
    v_mfma_f32_16x16x32_bf16 v[24:27], v[196:199], v[52:55], v[24:27]
    ds_read_b128 v[52:55], v3 offset:31744
    s_waitcnt lgkmcnt(2)
    v_mfma_f32_16x16x32_bf16 v[24:27], v[208:211], v[40:43], v[24:27]
    buffer_load_dword v5, v4, s[4:7], s16 offen sc1
    v_mfma_f32_16x16x32_bf16 v[24:27], v[220:223], v[44:47], v[24:27]
    v_mfma_f32_16x16x32_bf16 v[28:31], v[224:227], v[44:47], v[28:31]
    v_mfma_f32_16x16x32_bf16 v[28:31], v[212:215], v[40:43], v[28:31]
    s_waitcnt vmcnt(1)
    buffer_store_dword v6, v22, s[12:15], s17 offen sc1
    v_mfma_f32_16x16x32_bf16 v[32:35], v[216:219], v[40:43], v[32:35]
    s_mov_b32 s14, s6
    s_add_u32 s17, s17, 8192
    v_mfma_f32_16x16x32_bf16 v[32:35], v[228:231], v[44:47], v[32:35]
    s_waitcnt lgkmcnt(0)
    v_mfma_f32_16x16x32_bf16 v[32:35], v[240:243], v[48:51], v[32:35]
    v_mfma_f32_16x16x32_bf16 v[32:35], v[252:255], v[52:55], v[32:35]
    v_mfma_f32_16x16x32_bf16 v[28:31], v[248:251], v[52:55], v[28:31]
    v_mfma_f32_16x16x32_bf16 v[28:31], v[236:239], v[48:51], v[28:31]
    v_mfma_f32_16x16x32_bf16 v[24:27], v[232:235], v[48:51], v[24:27]
    v_mfma_f32_16x16x32_bf16 v[24:27], v[244:247], v[52:55], v[24:27]
    s_nop 3
    v_fma_f32 v124, v32, v21, v88
    v_fma_f32 v125, v33, v21, v89
    v_fma_f32 v126, v34, v21, v90
    v_fma_f32 v127, v35, v21, v91
    v_mul_f32 v124, v124, |v124|
    v_mul_f32 v125, v125, |v125|
    v_mul_f32 v126, v126, |v126|
    v_mul_f32 v127, v127, |v127|
    v_cvt_pk_bf16_f32 v124, v124, v125
    v_cvt_pk_bf16_f32 v126, v126, v127
    v_pk_max_i16 v96, v124, 0
    v_pk_max_i16 v97, v126, 0
    v_pk_max_i16 v98, v124, 0
    v_pk_max_i16 v99, v126, 0
    v_fma_f32 v116, v24, v21, v80
    v_permlane32_swap_b32 v96, v98
    v_permlane32_swap_b32 v97, v99
    buffer_store_dwordx4 v[96:99], v7, s[12:15], s36 offen sc1
    v_fma_f32 v117, v25, v21, v81
    v_fma_f32 v118, v26, v21, v82
    v_fma_f32 v119, v27, v21, v83
    v_fma_f32 v120, v28, v21, v84
    v_fma_f32 v121, v29, v21, v85
    v_fma_f32 v122, v30, v21, v86
    v_fma_f32 v123, v31, v21, v87
    v_mul_f32 v116, v116, |v116|
    v_mul_f32 v117, v117, |v117|
    v_mul_f32 v118, v118, |v118|
    v_mul_f32 v119, v119, |v119|
    v_mul_f32 v120, v120, |v120|
    v_mul_f32 v121, v121, |v121|
    v_mul_f32 v122, v122, |v122|
    v_mul_f32 v123, v123, |v123|
    v_cvt_pk_bf16_f32 v116, v116, v117
    v_cvt_pk_bf16_f32 v118, v118, v119
    v_cvt_pk_bf16_f32 v120, v120, v121
    v_cvt_pk_bf16_f32 v122, v122, v123
    v_pk_max_i16 v92, v116, 0
    v_pk_max_i16 v93, v118, 0
    v_pk_max_i16 v94, v120, 0
    v_pk_max_i16 v95, v122, 0
    buffer_store_dwordx4 v[92:95], v1, s[12:15], s36 offen sc1
    s_add_u32 s54, s31, 1
    v_mov_b32 v6, s54
    s_waitcnt vmcnt(3)
    s_cmp_ge_i32 s31, 63
    s_cbranch_scc1 Lffa_late1
    v_cmp_gt_i32 vcc, s32, v5
    s_sub_u32 s43, s43, 1
    s_cmp_lt_i32 s43, 0
    s_cbranch_scc1 Lffa_rdy1
    s_and_b64 vcc, vcc, s[18:19]
    s_cbranch_scc0 Lffa_rdy1
Lffa_late1:
    buffer_load_dword v5, v4, s[4:7], s16 offen sc1
    s_waitcnt vmcnt(1)
    buffer_store_dword v6, v22, s[12:15], s17 offen sc1
    s_mov_b32 s14, 0
    s_cmp_ge_i32 s31, 63
    s_cbranch_scc1 L_exit
    s_waitcnt vmcnt(1)
    v_cmp_gt_i32 vcc, s32, v5
    s_sub_u32 s43, s43, 1
    s_cmp_lt_i32 s43, 0
    s_cbranch_scc1 Lffa_rdy1
    s_and_b64 vcc, vcc, s[18:19]
    s_cbranch_scc0 Lffa_rdy1
Lffa_spin1:
    buffer_load_dword v5, v4, s[4:7], s16 offen sc1
    s_waitcnt vmcnt(0)
    v_cmp_gt_i32 vcc, s32, v5
    s_sub_u32 s43, s43, 1
    s_cmp_lt_i32 s43, 0
    s_cbranch_scc1 Lffa_rdy1
    s_and_b64 vcc, vcc, s[18:19]
    s_cbranch_scc0 Lffa_rdy1
    s_sleep 8
    s_branch Lffa_spin1
Lffa_rdy1:
    s_add_u32 m0, s34, 0
    s_nop 0
    buffer_load_dwordx4 v1, s[8:11], s33 offen offset:0 sc1 lds
    buffer_load_dwordx4 v1, s[8:11], s33 offen offset:1024 sc1 lds
    buffer_load_dwordx4 v1, s[8:11], s33 offen offset:2048 sc1 lds
    buffer_load_dwordx4 v1, s[8:11], s33 offen offset:3072 sc1 lds
    s_add_u32 m0, s34, s3
    s_add_u32 s37, s33, s3
    buffer_load_dwordx4 v1, s[8:11], s37 offen offset:0 sc1 lds
    s_add_u32 s16, s16, 8192
    buffer_load_dword v5, v4, s[4:7], s16 offen sc1
    s_add_u32 m0, s34, 16384
    s_add_u32 s37, s33, 16384
    buffer_load_dwordx4 v1, s[8:11], s37 offen offset:0 sc1 lds
    buffer_load_dwordx4 v1, s[8:11], s37 offen offset:1024 sc1 lds
    buffer_load_dwordx4 v1, s[8:11], s37 offen offset:2048 sc1 lds
    buffer_load_dwordx4 v1, s[8:11], s37 offen offset:3072 sc1 lds
    s_add_u32 s32, s32, 1
    s_add_u32 s33, s33, 36864
    s_add_u32 s34, s34, 36864
    s_cmp_ge_u32 s34, 147456
    s_cselect_b32 s38, 147456, 0
    s_sub_u32 s34, s34, s38
    s_waitcnt vmcnt(5)
    buffer_store_dword v6, v22, s[12:15], s17 offen sc1
Lffa_go1:
    s_mov_b32 s14, 0
    s_barrier
    ds_read_b128 v[40:43], v2 offset:0
    ds_read_b128 v[44:47], v2 offset:1024
    ds_read_b128 v[48:51], v2 offset:2048
    ds_read_b128 v[52:55], v2 offset:3072
    s_cmp_eq_u32 s30, 1
    s_cbranch_scc1 Lffa_body01
    s_cmp_eq_u32 s30, 2
    s_cbranch_scc1 Lffa_body02
    s_cmp_eq_u32 s30, 3
    s_cbranch_scc1 Lffa_body03
    s_branch Lffa_body00
Lffb_start:
    s_mov_b32 s12, s76
    s_mov_b32 s13, s77
    s_mov_b32 s14, 0x700000
    s_mov_b32 s15, 0x00020000
    v_lshrrev_b32 v24, 3, v0
    v_mul_u32_u24 v24, 2048, v24
    v_bfe_u32 v25, v0, 4, 2
    v_lshlrev_b32 v25, 1, v25
    v_and_b32 v26, 7, v0
    v_xor_b32 v25, v25, v26
    v_lshl_add_u32 v40, v25, 4, v24
    v_add_u32 v41, 15360, v40
    s_sub_u32 s38, s29, 44
    s_and_b32 s39, s38, 3
    s_lshr_b32 s38, s38, 2
    s_mul_i32 s86, s38, 0x180000
    s_mul_i32 s53, s39, 0x200
    s_add_u32 s86, s86, s53
    s_mul_i32 s37, s30, 32768
    s_add_u32 s86, s86, s37
    s_lshl_b32 s87, s30, 11
    s_add_u32 m0, s87, 0
    s_add_u32 s37, s86, 0
    buffer_load_dwordx4 v40, s[12:15], s37 offen offset:0 lds
    buffer_load_dwordx4 v41, s[12:15], s37 offen offset:1024 lds
    s_add_u32 m0, s87, 8192
    s_add_u32 s37, s86, 128
    buffer_load_dwordx4 v40, s[12:15], s37 offen offset:0 lds
    buffer_load_dwordx4 v41, s[12:15], s37 offen offset:1024 lds
    s_add_u32 m0, s87, 16384
    s_add_u32 s37, s86, 256
    buffer_load_dwordx4 v40, s[12:15], s37 offen offset:0 lds
    buffer_load_dwordx4 v41, s[12:15], s37 offen offset:1024 lds
    s_add_u32 m0, s87, 24576
    s_add_u32 s37, s86, 384
    buffer_load_dwordx4 v40, s[12:15], s37 offen offset:0 lds
    buffer_load_dwordx4 v41, s[12:15], s37 offen offset:1024 lds
    s_add_u32 m0, s87, 32768
    s_add_u32 s37, s86, 131072
    buffer_load_dwordx4 v40, s[12:15], s37 offen offset:0 lds
    buffer_load_dwordx4 v41, s[12:15], s37 offen offset:1024 lds
    s_add_u32 m0, s87, 40960
    s_add_u32 s37, s86, 131200
    buffer_load_dwordx4 v40, s[12:15], s37 offen offset:0 lds
    buffer_load_dwordx4 v41, s[12:15], s37 offen offset:1024 lds
    s_add_u32 m0, s87, 49152
    s_add_u32 s37, s86, 131328
    buffer_load_dwordx4 v40, s[12:15], s37 offen offset:0 lds
    buffer_load_dwordx4 v41, s[12:15], s37 offen offset:1024 lds
    s_add_u32 m0, s87, 57344
    s_add_u32 s37, s86, 131456
    buffer_load_dwordx4 v40, s[12:15], s37 offen offset:0 lds
    buffer_load_dwordx4 v41, s[12:15], s37 offen offset:1024 lds
    s_add_u32 m0, s87, 65536
    s_add_u32 s37, s86, 262144
    buffer_load_dwordx4 v40, s[12:15], s37 offen offset:0 lds
    buffer_load_dwordx4 v41, s[12:15], s37 offen offset:1024 lds
    s_add_u32 m0, s87, 73728
    s_add_u32 s37, s86, 262272
    buffer_load_dwordx4 v40, s[12:15], s37 offen offset:0 lds
    buffer_load_dwordx4 v41, s[12:15], s37 offen offset:1024 lds
    s_add_u32 m0, s87, 81920
    s_add_u32 s37, s86, 262400
    buffer_load_dwordx4 v40, s[12:15], s37 offen offset:0 lds
    buffer_load_dwordx4 v41, s[12:15], s37 offen offset:1024 lds
    s_add_u32 m0, s87, 90112
    s_add_u32 s37, s86, 262528
    buffer_load_dwordx4 v40, s[12:15], s37 offen offset:0 lds
    buffer_load_dwordx4 v41, s[12:15], s37 offen offset:1024 lds
    s_add_u32 m0, s87, 98304
    s_add_u32 s37, s86, 393216
    buffer_load_dwordx4 v40, s[12:15], s37 offen offset:0 lds
    buffer_load_dwordx4 v41, s[12:15], s37 offen offset:1024 lds
    s_add_u32 m0, s87, 106496
    s_add_u32 s37, s86, 393344
    buffer_load_dwordx4 v40, s[12:15], s37 offen offset:0 lds
    buffer_load_dwordx4 v41, s[12:15], s37 offen offset:1024 lds
    s_add_u32 m0, s87, 114688
    s_add_u32 s37, s86, 393472
    buffer_load_dwordx4 v40, s[12:15], s37 offen offset:0 lds
    buffer_load_dwordx4 v41, s[12:15], s37 offen offset:1024 lds
    s_add_u32 m0, s87, 122880
    s_add_u32 s37, s86, 393600
    buffer_load_dwordx4 v40, s[12:15], s37 offen offset:0 lds
    buffer_load_dwordx4 v41, s[12:15], s37 offen offset:1024 lds
    v_bfe_u32 v24, v0, 3, 2
    v_and_b32 v25, 3, v0
    v_lshlrev_b32 v25, 3, v25
    v_lshrrev_b32 v26, 2, v0
    v_lshl_add_u32 v26, v26, 7, v25
    v_lshrrev_b32 v27, 5, v0
    v_lshl_add_u32 v27, v27, 10, v26
    s_mov_b32 s37, s30
    s_mov_b32 s38, 0
    s_lshl_b32 s37, s37, 13
    v_xor_b32 v28, s38, v24
    v_lshl_add_u32 v28, v28, 5, s37
    v_add_u32 v42, v28, v26
    v_add_u32 v46, v28, v27
    s_mov_b32 s37, s30
    s_mov_b32 s38, 1
    s_lshl_b32 s37, s37, 13
    v_xor_b32 v28, s38, v24
    v_lshl_add_u32 v28, v28, 5, s37
    v_add_u32 v43, v28, v26
    v_add_u32 v47, v28, v27
    s_mov_b32 s37, s30
    s_mov_b32 s38, 2
    s_lshl_b32 s37, s37, 13
    v_xor_b32 v28, s38, v24
    v_lshl_add_u32 v28, v28, 5, s37
    v_add_u32 v44, v28, v26
    v_add_u32 v48, v28, v27
    s_mov_b32 s37, s30
    s_mov_b32 s38, 3
    s_lshl_b32 s37, s37, 13
    v_xor_b32 v28, s38, v24
    v_lshl_add_u32 v28, v28, 5, s37
    v_add_u32 v45, v28, v26
    v_add_u32 v49, v28, v27
    s_sub_u32 s38, s29, 44
    s_and_b32 s39, s38, 3
    s_lshr_b32 s38, s38, 2
    s_mul_i32 s37, s28, 0x80000
    s_mul_i32 s53, s38, 0x200
    s_add_u32 s37, s37, s53
    s_add_u32 s37, s37, 0x6000c00
    v_min_u32 v4, 15, v0
    v_lshl_add_u32 v4, v4, 5, s37
    s_mov_b32 s32, 1
    s_mul_i32 s33, s28, 0x720000
    s_mul_i32 s53, s38, 0x6000
    s_add_u32 s33, s33, s53
    s_add_u32 s33, s33, 0x2000000
    s_mul_i32 s36, s28, 0x800000
    s_mul_i32 s53, s38, 0x8000
    s_add_u32 s36, s36, s53
    s_mul_i32 s53, s39, 0x2000
    s_add_u32 s36, s36, s53
    s_mul_i32 s53, s30, 0x800
    s_add_u32 s36, s36, s53
    s_add_u32 s36, s36, 0x3fe0000
    s_mov_b32 s31, -1
    s_mov_b32 s35, 0
    s_mov_b32 s16, 0
    v_mov_b32 v5, 0
    s_mul_i32 s17, s28, 0x80000
    s_mul_i32 s53, s29, 0x80
    s_add_u32 s17, s17, s53
    s_mul_i32 s53, s30, 0x20
    s_add_u32 s17, s17, s53
    s_add_u32 s17, s17, 0x5ffe000
    v_cmp_eq_u32 vcc, 0, v0
    v_mov_b32 v80, 0x40000000
    s_nop 0
    v_cndmask_b32 v80, v80, v0, vcc
    v_mov_b32 v2, v1
    s_mul_i32 s34, s30, 3072
    s_mul_i32 s3, s30, 0x0
    s_add_u32 s3, s3, 0x3000
    s_add_u32 s41, s3, 4096
    s_add_u32 s33, s33, s34
    s_mov_b64 s[18:19], 0xffff
    v_mov_b32 v8, 0x40000000
    v_cndmask_b32 v4, v8, v4, s[18:19]
    v_add_u32 v12, 0, v42
    v_add_u32 v13, 0, v43
    v_add_u32 v14, 0, v44
    v_add_u32 v15, 0, v45
    s_waitcnt vmcnt(24) lgkmcnt(0)
    s_barrier
    s_add_u32 m0, s87, 131072
    s_add_u32 s37, s86, 524288
    buffer_load_dwordx4 v40, s[12:15], s37 offen offset:0 lds
    ds_read_b64_tr_b16 a[0:1], v12 offset:0
    ds_read_b64_tr_b16 a[2:3], v12 offset:2048
    ds_read_b64_tr_b16 a[4:5], v13 offset:0
    buffer_load_dwordx4 v41, s[12:15], s37 offen offset:1024 lds
    ds_read_b64_tr_b16 a[6:7], v13 offset:2048
    ds_read_b64_tr_b16 a[8:9], v14 offset:0
    ds_read_b64_tr_b16 a[10:11], v14 offset:2048
    s_add_u32 m0, s87, 139264
    s_add_u32 s37, s86, 524416
    buffer_load_dwordx4 v40, s[12:15], s37 offen offset:0 lds
    ds_read_b64_tr_b16 a[12:13], v15 offset:0
    ds_read_b64_tr_b16 a[14:15], v15 offset:2048
    ds_read_b64_tr_b16 a[16:17], v12 offset:4096
    buffer_load_dwordx4 v41, s[12:15], s37 offen offset:1024 lds
    ds_read_b64_tr_b16 a[18:19], v12 offset:6144
    ds_read_b64_tr_b16 a[20:21], v13 offset:4096
    ds_read_b64_tr_b16 a[22:23], v13 offset:6144
    s_add_u32 m0, s87, 147456
    s_add_u32 s37, s86, 524544
    buffer_load_dwordx4 v40, s[12:15], s37 offen offset:0 lds
    ds_read_b64_tr_b16 a[24:25], v14 offset:4096
    ds_read_b64_tr_b16 a[26:27], v14 offset:6144
    ds_read_b64_tr_b16 a[28:29], v15 offset:4096
    buffer_load_dwordx4 v41, s[12:15], s37 offen offset:1024 lds
    ds_read_b64_tr_b16 a[30:31], v15 offset:6144
    v_add_u32 v16, 32768, v42
    v_add_u32 v17, 32768, v43
    s_add_u32 m0, s87, 155648
    s_add_u32 s37, s86, 524672
    buffer_load_dwordx4 v40, s[12:15], s37 offen offset:0 lds
    v_add_u32 v18, 32768, v44
    v_add_u32 v19, 32768, v45
    buffer_load_dwordx4 v41, s[12:15], s37 offen offset:1024 lds
    s_waitcnt vmcnt(24) lgkmcnt(0)
    s_barrier
    s_add_u32 m0, s87, 0
    s_add_u32 s37, s86, 655360
    buffer_load_dwordx4 v40, s[12:15], s37 offen offset:0 lds
    ds_read_b64_tr_b16 a[32:33], v16 offset:0
    ds_read_b64_tr_b16 a[34:35], v16 offset:2048
    ds_read_b64_tr_b16 a[36:37], v17 offset:0
    buffer_load_dwordx4 v41, s[12:15], s37 offen offset:1024 lds
    ds_read_b64_tr_b16 a[38:39], v17 offset:2048
    ds_read_b64_tr_b16 a[40:41], v18 offset:0
    ds_read_b64_tr_b16 a[42:43], v18 offset:2048
    s_add_u32 m0, s87, 8192
    s_add_u32 s37, s86, 655488
    buffer_load_dwordx4 v40, s[12:15], s37 offen offset:0 lds
    ds_read_b64_tr_b16 a[44:45], v19 offset:0
    ds_read_b64_tr_b16 a[46:47], v19 offset:2048
    ds_read_b64_tr_b16 a[48:49], v16 offset:4096
    buffer_load_dwordx4 v41, s[12:15], s37 offen offset:1024 lds
    ds_read_b64_tr_b16 a[50:51], v16 offset:6144
    ds_read_b64_tr_b16 a[52:53], v17 offset:4096
    ds_read_b64_tr_b16 a[54:55], v17 offset:6144
    s_add_u32 m0, s87, 16384
    s_add_u32 s37, s86, 655616
    buffer_load_dwordx4 v40, s[12:15], s37 offen offset:0 lds
    ds_read_b64_tr_b16 a[56:57], v18 offset:4096
    ds_read_b64_tr_b16 a[58:59], v18 offset:6144
    ds_read_b64_tr_b16 a[60:61], v19 offset:4096
    buffer_load_dwordx4 v41, s[12:15], s37 offen offset:1024 lds
    ds_read_b64_tr_b16 a[62:63], v19 offset:6144
    v_add_u32 v12, 65536, v46
    v_add_u32 v13, 65536, v47
    s_add_u32 m0, s87, 24576
    s_add_u32 s37, s86, 655744
    buffer_load_dwordx4 v40, s[12:15], s37 offen offset:0 lds
    v_add_u32 v14, 65536, v48
    v_add_u32 v15, 65536, v49
    buffer_load_dwordx4 v41, s[12:15], s37 offen offset:1024 lds
    s_waitcnt vmcnt(24) lgkmcnt(0)
    s_barrier
    s_add_u32 m0, s87, 32768
    s_add_u32 s37, s86, 786432
    buffer_load_dwordx4 v40, s[12:15], s37 offen offset:0 lds
    ds_read_b64_tr_b16 a[64:65], v12 offset:0
    ds_read_b64_tr_b16 a[66:67], v12 offset:1024
    ds_read_b64_tr_b16 a[68:69], v13 offset:0
    buffer_load_dwordx4 v41, s[12:15], s37 offen offset:1024 lds
    ds_read_b64_tr_b16 a[70:71], v13 offset:1024
    ds_read_b64_tr_b16 a[72:73], v14 offset:0
    ds_read_b64_tr_b16 a[74:75], v14 offset:1024
    s_add_u32 m0, s87, 40960
    s_add_u32 s37, s86, 786560
    buffer_load_dwordx4 v40, s[12:15], s37 offen offset:0 lds
    ds_read_b64_tr_b16 a[76:77], v15 offset:0
    ds_read_b64_tr_b16 a[78:79], v15 offset:1024
    ds_read_b64_tr_b16 a[80:81], v12 offset:4096
    buffer_load_dwordx4 v41, s[12:15], s37 offen offset:1024 lds
    ds_read_b64_tr_b16 a[82:83], v12 offset:5120
    ds_read_b64_tr_b16 a[84:85], v13 offset:4096
    ds_read_b64_tr_b16 a[86:87], v13 offset:5120
    s_add_u32 m0, s87, 49152
    s_add_u32 s37, s86, 786688
    buffer_load_dwordx4 v40, s[12:15], s37 offen offset:0 lds
    ds_read_b64_tr_b16 a[88:89], v14 offset:4096
    ds_read_b64_tr_b16 a[90:91], v14 offset:5120
    ds_read_b64_tr_b16 a[92:93], v15 offset:4096
    buffer_load_dwordx4 v41, s[12:15], s37 offen offset:1024 lds
    ds_read_b64_tr_b16 a[94:95], v15 offset:5120
    v_add_u32 v16, 98304, v42
    v_add_u32 v17, 98304, v43
    s_add_u32 m0, s87, 57344
    s_add_u32 s37, s86, 786816
    buffer_load_dwordx4 v40, s[12:15], s37 offen offset:0 lds
    v_add_u32 v18, 98304, v44
    v_add_u32 v19, 98304, v45
    buffer_load_dwordx4 v41, s[12:15], s37 offen offset:1024 lds
    s_waitcnt vmcnt(24) lgkmcnt(0)
    s_barrier
    s_add_u32 m0, s87, 65536
    s_add_u32 s37, s86, 917504
    buffer_load_dwordx4 v40, s[12:15], s37 offen offset:0 lds
    ds_read_b64_tr_b16 a[96:97], v16 offset:0
    ds_read_b64_tr_b16 a[98:99], v16 offset:2048
    ds_read_b64_tr_b16 a[100:101], v17 offset:0
    buffer_load_dwordx4 v41, s[12:15], s37 offen offset:1024 lds
    ds_read_b64_tr_b16 a[102:103], v17 offset:2048
    ds_read_b64_tr_b16 a[104:105], v18 offset:0
    ds_read_b64_tr_b16 a[106:107], v18 offset:2048
    s_add_u32 m0, s87, 73728
    s_add_u32 s37, s86, 917632
    buffer_load_dwordx4 v40, s[12:15], s37 offen offset:0 lds
    ds_read_b64_tr_b16 a[108:109], v19 offset:0
    ds_read_b64_tr_b16 a[110:111], v19 offset:2048
    ds_read_b64_tr_b16 a[112:113], v16 offset:4096
    buffer_load_dwordx4 v41, s[12:15], s37 offen offset:1024 lds
    ds_read_b64_tr_b16 a[114:115], v16 offset:6144
    ds_read_b64_tr_b16 a[116:117], v17 offset:4096
    ds_read_b64_tr_b16 a[118:119], v17 offset:6144
    s_add_u32 m0, s87, 81920
    s_add_u32 s37, s86, 917760
    buffer_load_dwordx4 v40, s[12:15], s37 offen offset:0 lds
    ds_read_b64_tr_b16 a[120:121], v18 offset:4096
    ds_read_b64_tr_b16 a[122:123], v18 offset:6144
    ds_read_b64_tr_b16 a[124:125], v19 offset:4096
    buffer_load_dwordx4 v41, s[12:15], s37 offen offset:1024 lds
    ds_read_b64_tr_b16 a[126:127], v19 offset:6144
    v_add_u32 v12, 131072, v42
    v_add_u32 v13, 131072, v43
    s_add_u32 m0, s87, 90112
    s_add_u32 s37, s86, 917888
    buffer_load_dwordx4 v40, s[12:15], s37 offen offset:0 lds
    v_add_u32 v14, 131072, v44
    v_add_u32 v15, 131072, v45
    buffer_load_dwordx4 v41, s[12:15], s37 offen offset:1024 lds
    s_waitcnt vmcnt(24) lgkmcnt(0)
    s_barrier
    s_add_u32 m0, s87, 98304
    s_add_u32 s37, s86, 1048576
    buffer_load_dwordx4 v40, s[12:15], s37 offen offset:0 lds
    ds_read_b64_tr_b16 a[128:129], v12 offset:0
    ds_read_b64_tr_b16 a[130:131], v12 offset:2048
    ds_read_b64_tr_b16 a[132:133], v13 offset:0
    buffer_load_dwordx4 v41, s[12:15], s37 offen offset:1024 lds
    ds_read_b64_tr_b16 a[134:135], v13 offset:2048
    ds_read_b64_tr_b16 a[136:137], v14 offset:0
    ds_read_b64_tr_b16 a[138:139], v14 offset:2048
    s_add_u32 m0, s87, 106496
    s_add_u32 s37, s86, 1048704
    buffer_load_dwordx4 v40, s[12:15], s37 offen offset:0 lds
    ds_read_b64_tr_b16 a[140:141], v15 offset:0
    ds_read_b64_tr_b16 a[142:143], v15 offset:2048
    ds_read_b64_tr_b16 a[144:145], v12 offset:4096
    buffer_load_dwordx4 v41, s[12:15], s37 offen offset:1024 lds
    ds_read_b64_tr_b16 a[146:147], v12 offset:6144
    ds_read_b64_tr_b16 a[148:149], v13 offset:4096
    ds_read_b64_tr_b16 a[150:151], v13 offset:6144
    s_add_u32 m0, s87, 114688
    s_add_u32 s37, s86, 1048832
    buffer_load_dwordx4 v40, s[12:15], s37 offen offset:0 lds
    ds_read_b64_tr_b16 a[152:153], v14 offset:4096
    ds_read_b64_tr_b16 a[154:155], v14 offset:6144
    ds_read_b64_tr_b16 a[156:157], v15 offset:4096
    buffer_load_dwordx4 v41, s[12:15], s37 offen offset:1024 lds
    ds_read_b64_tr_b16 a[158:159], v15 offset:6144
    v_add_u32 v16, 0, v46
    v_add_u32 v17, 0, v47
    s_add_u32 m0, s87, 122880
    s_add_u32 s37, s86, 1048960
    buffer_load_dwordx4 v40, s[12:15], s37 offen offset:0 lds
    v_add_u32 v18, 0, v48
    v_add_u32 v19, 0, v49
    buffer_load_dwordx4 v41, s[12:15], s37 offen offset:1024 lds
    s_waitcnt vmcnt(24) lgkmcnt(0)
    s_barrier
    s_add_u32 m0, s87, 131072
    s_add_u32 s37, s86, 1179648
    buffer_load_dwordx4 v40, s[12:15], s37 offen offset:0 lds
    ds_read_b64_tr_b16 a[160:161], v16 offset:0
    ds_read_b64_tr_b16 a[162:163], v16 offset:1024
    ds_read_b64_tr_b16 a[164:165], v17 offset:0
    buffer_load_dwordx4 v41, s[12:15], s37 offen offset:1024 lds
    ds_read_b64_tr_b16 a[166:167], v17 offset:1024
    ds_read_b64_tr_b16 a[168:169], v18 offset:0
    ds_read_b64_tr_b16 a[170:171], v18 offset:1024
    s_add_u32 m0, s87, 139264
    s_add_u32 s37, s86, 1179776
    buffer_load_dwordx4 v40, s[12:15], s37 offen offset:0 lds
    ds_read_b64_tr_b16 a[172:173], v19 offset:0
    ds_read_b64_tr_b16 a[174:175], v19 offset:1024
    ds_read_b64_tr_b16 a[176:177], v16 offset:4096
    buffer_load_dwordx4 v41, s[12:15], s37 offen offset:1024 lds
    ds_read_b64_tr_b16 a[178:179], v16 offset:5120
    ds_read_b64_tr_b16 a[180:181], v17 offset:4096
    ds_read_b64_tr_b16 a[182:183], v17 offset:5120
    s_add_u32 m0, s87, 147456
    s_add_u32 s37, s86, 1179904
    buffer_load_dwordx4 v40, s[12:15], s37 offen offset:0 lds
    ds_read_b64_tr_b16 a[184:185], v18 offset:4096
    ds_read_b64_tr_b16 a[186:187], v18 offset:5120
    ds_read_b64_tr_b16 a[188:189], v19 offset:4096
    buffer_load_dwordx4 v41, s[12:15], s37 offen offset:1024 lds
    ds_read_b64_tr_b16 a[190:191], v19 offset:5120
    v_add_u32 v12, 32768, v42
    v_add_u32 v13, 32768, v43
    s_add_u32 m0, s87, 155648
    s_add_u32 s37, s86, 1180032
    buffer_load_dwordx4 v40, s[12:15], s37 offen offset:0 lds
    v_add_u32 v14, 32768, v44
    v_add_u32 v15, 32768, v45
    buffer_load_dwordx4 v41, s[12:15], s37 offen offset:1024 lds
    s_waitcnt vmcnt(24) lgkmcnt(0)
    s_barrier
    s_add_u32 m0, s87, 0
    s_add_u32 s37, s86, 1310720
    buffer_load_dwordx4 v40, s[12:15], s37 offen offset:0 lds
    ds_read_b64_tr_b16 a[192:193], v12 offset:0
    ds_read_b64_tr_b16 a[194:195], v12 offset:2048
    ds_read_b64_tr_b16 a[196:197], v13 offset:0
    buffer_load_dwordx4 v41, s[12:15], s37 offen offset:1024 lds
    ds_read_b64_tr_b16 a[198:199], v13 offset:2048
    ds_read_b64_tr_b16 a[200:201], v14 offset:0
    ds_read_b64_tr_b16 a[202:203], v14 offset:2048
    s_add_u32 m0, s87, 8192
    s_add_u32 s37, s86, 1310848
    buffer_load_dwordx4 v40, s[12:15], s37 offen offset:0 lds
    ds_read_b64_tr_b16 a[204:205], v15 offset:0
    ds_read_b64_tr_b16 a[206:207], v15 offset:2048
    ds_read_b64_tr_b16 a[208:209], v12 offset:4096
    buffer_load_dwordx4 v41, s[12:15], s37 offen offset:1024 lds
    ds_read_b64_tr_b16 a[210:211], v12 offset:6144
    ds_read_b64_tr_b16 a[212:213], v13 offset:4096
    ds_read_b64_tr_b16 a[214:215], v13 offset:6144
    s_add_u32 m0, s87, 16384
    s_add_u32 s37, s86, 1310976
    buffer_load_dwordx4 v40, s[12:15], s37 offen offset:0 lds
    ds_read_b64_tr_b16 a[216:217], v14 offset:4096
    ds_read_b64_tr_b16 a[218:219], v14 offset:6144
    ds_read_b64_tr_b16 a[220:221], v15 offset:4096
    buffer_load_dwordx4 v41, s[12:15], s37 offen offset:1024 lds
    ds_read_b64_tr_b16 a[222:223], v15 offset:6144
    v_add_u32 v16, 65536, v42
    v_add_u32 v17, 65536, v43
    s_add_u32 m0, s87, 24576
    s_add_u32 s37, s86, 1311104
    buffer_load_dwordx4 v40, s[12:15], s37 offen offset:0 lds
    v_add_u32 v18, 65536, v44
    v_add_u32 v19, 65536, v45
    buffer_load_dwordx4 v41, s[12:15], s37 offen offset:1024 lds
    s_waitcnt vmcnt(24) lgkmcnt(0)
    s_barrier
    s_add_u32 m0, s87, 32768
    s_add_u32 s37, s86, 1441792
    buffer_load_dwordx4 v40, s[12:15], s37 offen offset:0 lds
    ds_read_b64_tr_b16 a[224:225], v16 offset:0
    ds_read_b64_tr_b16 a[226:227], v16 offset:2048
    ds_read_b64_tr_b16 a[228:229], v17 offset:0
    buffer_load_dwordx4 v41, s[12:15], s37 offen offset:1024 lds
    ds_read_b64_tr_b16 a[230:231], v17 offset:2048
    ds_read_b64_tr_b16 a[232:233], v18 offset:0
    ds_read_b64_tr_b16 a[234:235], v18 offset:2048
    s_add_u32 m0, s87, 40960
    s_add_u32 s37, s86, 1441920
    buffer_load_dwordx4 v40, s[12:15], s37 offen offset:0 lds
    ds_read_b64_tr_b16 a[236:237], v19 offset:0
    ds_read_b64_tr_b16 a[238:239], v19 offset:2048
    ds_read_b64_tr_b16 a[240:241], v16 offset:4096
    buffer_load_dwordx4 v41, s[12:15], s37 offen offset:1024 lds
    ds_read_b64_tr_b16 a[242:243], v16 offset:6144
    ds_read_b64_tr_b16 a[244:245], v17 offset:4096
    ds_read_b64_tr_b16 a[246:247], v17 offset:6144
    s_add_u32 m0, s87, 49152
    s_add_u32 s37, s86, 1442048
    buffer_load_dwordx4 v40, s[12:15], s37 offen offset:0 lds
    ds_read_b64_tr_b16 a[248:249], v18 offset:4096
    ds_read_b64_tr_b16 a[250:251], v18 offset:6144
    ds_read_b64_tr_b16 a[252:253], v19 offset:4096
    buffer_load_dwordx4 v41, s[12:15], s37 offen offset:1024 lds
    ds_read_b64_tr_b16 a[254:255], v19 offset:6144
    v_add_u32 v12, 98304, v46
    v_add_u32 v13, 98304, v47
    s_add_u32 m0, s87, 57344
    s_add_u32 s37, s86, 1442176
    buffer_load_dwordx4 v40, s[12:15], s37 offen offset:0 lds
    v_add_u32 v14, 98304, v48
    v_add_u32 v15, 98304, v49
    buffer_load_dwordx4 v41, s[12:15], s37 offen offset:1024 lds
    s_waitcnt vmcnt(24) lgkmcnt(0)
    s_barrier
    ds_read_b64_tr_b16 v[128:129], v12 offset:0
    ds_read_b64_tr_b16 v[130:131], v12 offset:1024
    ds_read_b64_tr_b16 v[132:133], v13 offset:0
    ds_read_b64_tr_b16 v[134:135], v13 offset:1024
    ds_read_b64_tr_b16 v[136:137], v14 offset:0
    ds_read_b64_tr_b16 v[138:139], v14 offset:1024
    ds_read_b64_tr_b16 v[140:141], v15 offset:0
    ds_read_b64_tr_b16 v[142:143], v15 offset:1024
    ds_read_b64_tr_b16 v[144:145], v12 offset:4096
    ds_read_b64_tr_b16 v[146:147], v12 offset:5120
    ds_read_b64_tr_b16 v[148:149], v13 offset:4096
    ds_read_b64_tr_b16 v[150:151], v13 offset:5120
    ds_read_b64_tr_b16 v[152:153], v14 offset:4096
    ds_read_b64_tr_b16 v[154:155], v14 offset:5120
    ds_read_b64_tr_b16 v[156:157], v15 offset:4096
    ds_read_b64_tr_b16 v[158:159], v15 offset:5120
    v_add_u32 v16, 131072, v42
    v_add_u32 v17, 131072, v43
    v_add_u32 v18, 131072, v44
    v_add_u32 v19, 131072, v45
    s_waitcnt vmcnt(16) lgkmcnt(0)
    s_barrier
    ds_read_b64_tr_b16 v[160:161], v16 offset:0
    ds_read_b64_tr_b16 v[162:163], v16 offset:2048
    ds_read_b64_tr_b16 v[164:165], v17 offset:0
    ds_read_b64_tr_b16 v[166:167], v17 offset:2048
    ds_read_b64_tr_b16 v[168:169], v18 offset:0
    ds_read_b64_tr_b16 v[170:171], v18 offset:2048
    ds_read_b64_tr_b16 v[172:173], v19 offset:0
    ds_read_b64_tr_b16 v[174:175], v19 offset:2048
    ds_read_b64_tr_b16 v[176:177], v16 offset:4096
    ds_read_b64_tr_b16 v[178:179], v16 offset:6144
    ds_read_b64_tr_b16 v[180:181], v17 offset:4096
    ds_read_b64_tr_b16 v[182:183], v17 offset:6144
    ds_read_b64_tr_b16 v[184:185], v18 offset:4096
    ds_read_b64_tr_b16 v[186:187], v18 offset:6144
    ds_read_b64_tr_b16 v[188:189], v19 offset:4096
    ds_read_b64_tr_b16 v[190:191], v19 offset:6144
    v_add_u32 v12, 0, v42
    v_add_u32 v13, 0, v43
    v_add_u32 v14, 0, v44
    v_add_u32 v15, 0, v45
    s_waitcnt vmcnt(8) lgkmcnt(0)
    s_barrier
    ds_read_b64_tr_b16 v[192:193], v12 offset:0
    ds_read_b64_tr_b16 v[194:195], v12 offset:2048
    ds_read_b64_tr_b16 v[196:197], v13 offset:0
    ds_read_b64_tr_b16 v[198:199], v13 offset:2048
    ds_read_b64_tr_b16 v[200:201], v14 offset:0
    ds_read_b64_tr_b16 v[202:203], v14 offset:2048
    ds_read_b64_tr_b16 v[204:205], v15 offset:0
    ds_read_b64_tr_b16 v[206:207], v15 offset:2048
    ds_read_b64_tr_b16 v[208:209], v12 offset:4096
    ds_read_b64_tr_b16 v[210:211], v12 offset:6144
    ds_read_b64_tr_b16 v[212:213], v13 offset:4096
    ds_read_b64_tr_b16 v[214:215], v13 offset:6144
    ds_read_b64_tr_b16 v[216:217], v14 offset:4096
    ds_read_b64_tr_b16 v[218:219], v14 offset:6144
    ds_read_b64_tr_b16 v[220:221], v15 offset:4096
    ds_read_b64_tr_b16 v[222:223], v15 offset:6144
    v_add_u32 v16, 32768, v46
    v_add_u32 v17, 32768, v47
    v_add_u32 v18, 32768, v48
    v_add_u32 v19, 32768, v49
    s_waitcnt vmcnt(0) lgkmcnt(0)
    s_barrier
    ds_read_b64_tr_b16 v[224:225], v16 offset:0
    ds_read_b64_tr_b16 v[226:227], v16 offset:1024
    ds_read_b64_tr_b16 v[228:229], v17 offset:0
    ds_read_b64_tr_b16 v[230:231], v17 offset:1024
    ds_read_b64_tr_b16 v[232:233], v18 offset:0
    ds_read_b64_tr_b16 v[234:235], v18 offset:1024
    ds_read_b64_tr_b16 v[236:237], v19 offset:0
    ds_read_b64_tr_b16 v[238:239], v19 offset:1024
    ds_read_b64_tr_b16 v[240:241], v16 offset:4096
    ds_read_b64_tr_b16 v[242:243], v16 offset:5120
    ds_read_b64_tr_b16 v[244:245], v17 offset:4096
    ds_read_b64_tr_b16 v[246:247], v17 offset:5120
    ds_read_b64_tr_b16 v[248:249], v18 offset:4096
    ds_read_b64_tr_b16 v[250:251], v18 offset:5120
    ds_read_b64_tr_b16 v[252:253], v19 offset:4096
    ds_read_b64_tr_b16 v[254:255], v19 offset:5120
    s_waitcnt lgkmcnt(0)
    s_mov_b32 s12, s84
    s_mov_b32 s13, s85
    s_mov_b32 s14, 0x6200000
    s_mov_b32 s15, 0x00020000
    s_barrier
    s_mov_b32 s20, s82
    s_mov_b32 s21, s83
    s_mov_b32 s22, 0x100
    s_mov_b32 s23, 0x00020000
    v_and_b32 v8, 15, v0
    v_lshlrev_b32 v8, 4, v8
    v_mov_b32 v10, 8
    buffer_load_dword v9, v8, s[20:23], 0 offen sc1
    s_waitcnt vmcnt(0)
Lffb_wa:
    v_cmp_gt_u32 vcc, v10, v9
    s_sub_u32 s43, s43, 1
    s_cmp_lt_i32 s43, 0
    s_cbranch_scc1 Lffb_all
    s_cbranch_vccz Lffb_all
    s_sleep 2
    buffer_load_dword v9, v8, s[20:23], 0 offen sc1
    s_waitcnt vmcnt(0)
    s_branch Lffb_wa
Lffb_all:
    s_mov_b32 s14, 0
    s_cmp_lg_u32 s30, 0
    s_cbranch_scc1 Lffb_fok
Lffb_fspin:
    buffer_load_dword v5, v4, s[4:7], s16 offen sc1
    s_waitcnt vmcnt(0)
    v_cmp_gt_i32 vcc, s32, v5
    s_sub_u32 s43, s43, 1
    s_cmp_lt_i32 s43, 0
    s_cbranch_scc1 Lffb_fok
    s_and_b64 vcc, vcc, s[18:19]
    s_cbranch_scc0 Lffb_fok
    s_sleep 2
    s_branch Lffb_fspin
Lffb_fok:
    s_barrier
    s_branch Lffb_rdy1
    .p2align 6
Lffb_body00:
    s_waitcnt lgkmcnt(0)
    v_mfma_f32_16x16x32_bf16 v[8:11], a[0:3], v[40:43], 0
    ds_read_b128 v[48:51], v2 offset:2048
    s_add_u32 m0, s34, 0
    v_mfma_f32_16x16x32_bf16 v[8:11], a[16:19], v[44:47], v[8:11]
    s_add_u32 s31, s31, 1
    v_mov_b32 v6, s31
    s_add_u32 s35, s35, 36864
    v_mfma_f32_16x16x32_bf16 v[12:15], a[20:23], v[44:47], 0
    ds_read_b128 v[52:55], v2 offset:3072
    v_cvt_pk_bf16_f32 v72, v24, v25
    v_mfma_f32_16x16x32_bf16 v[12:15], a[4:7], v[40:43], v[12:15]
    s_cmp_eq_u32 s35, 147456
    s_cselect_b32 s35, 0, s35
    v_cvt_pk_bf16_f32 v73, v26, v27
    v_mfma_f32_16x16x32_bf16 v[16:19], a[8:11], v[40:43], 0
    v_cvt_pk_bf16_f32 v74, v28, v29
    v_cvt_pk_bf16_f32 v75, v30, v31
    v_mfma_f32_16x16x32_bf16 v[16:19], a[24:27], v[44:47], v[16:19]
    buffer_store_dwordx4 v[72:75], v1, s[12:15], s36 offen offset:0 sc1
    v_cvt_pk_bf16_f32 v76, v32, v33
    v_mfma_f32_16x16x32_bf16 v[20:23], a[28:31], v[44:47], 0
    v_cvt_pk_bf16_f32 v77, v34, v35
    v_cvt_pk_bf16_f32 v78, v36, v37
    v_mfma_f32_16x16x32_bf16 v[20:23], a[12:15], v[40:43], v[20:23]
    s_waitcnt lgkmcnt(0)
    v_cvt_pk_bf16_f32 v79, v38, v39
    v_add_u32 v3, s35, v1
    v_mfma_f32_16x16x32_bf16 v[20:23], a[44:47], v[48:51], v[20:23]
    ds_read_b128 v[56:59], v2 offset:4096
    v_mfma_f32_16x16x32_bf16 v[20:23], a[60:63], v[52:55], v[20:23]
    buffer_store_dwordx4 v[76:79], v1, s[12:15], s36 offen offset:1024 sc1
    s_add_u32 s36, s36, 131072
    v_mfma_f32_16x16x32_bf16 v[16:19], a[56:59], v[52:55], v[16:19]
    ds_read_b128 v[60:63], v2 offset:5120
    v_mfma_f32_16x16x32_bf16 v[16:19], a[40:43], v[48:51], v[16:19]
    v_mfma_f32_16x16x32_bf16 v[12:15], a[36:39], v[48:51], v[12:15]
    v_mfma_f32_16x16x32_bf16 v[12:15], a[52:55], v[52:55], v[12:15]
    v_mfma_f32_16x16x32_bf16 v[8:11], a[48:51], v[52:55], v[8:11]
    v_mfma_f32_16x16x32_bf16 v[8:11], a[32:35], v[48:51], v[8:11]
    s_waitcnt lgkmcnt(0)
    v_mfma_f32_16x16x32_bf16 v[8:11], a[64:67], v[56:59], v[8:11]
    ds_read_b128 v[64:67], v2 offset:6144
    v_mfma_f32_16x16x32_bf16 v[8:11], a[80:83], v[60:63], v[8:11]
    v_mfma_f32_16x16x32_bf16 v[12:15], a[84:87], v[60:63], v[12:15]
    ds_read_b128 v[68:71], v2 offset:7168
    v_mfma_f32_16x16x32_bf16 v[12:15], a[68:71], v[56:59], v[12:15]
    v_mfma_f32_16x16x32_bf16 v[16:19], a[72:75], v[56:59], v[16:19]
    v_mfma_f32_16x16x32_bf16 v[16:19], a[88:91], v[60:63], v[16:19]
    v_mfma_f32_16x16x32_bf16 v[20:23], a[92:95], v[60:63], v[20:23]
    v_mfma_f32_16x16x32_bf16 v[20:23], a[76:79], v[56:59], v[20:23]
    s_waitcnt lgkmcnt(0)
    v_mfma_f32_16x16x32_bf16 v[20:23], a[108:111], v[64:67], v[20:23]
    ds_read_b128 v[40:43], v2 offset:8192
    v_mfma_f32_16x16x32_bf16 v[20:23], a[124:127], v[68:71], v[20:23]
    v_mfma_f32_16x16x32_bf16 v[16:19], a[120:123], v[68:71], v[16:19]
    ds_read_b128 v[44:47], v2 offset:9216
    v_mfma_f32_16x16x32_bf16 v[16:19], a[104:107], v[64:67], v[16:19]
    v_mfma_f32_16x16x32_bf16 v[12:15], a[100:103], v[64:67], v[12:15]
    v_mfma_f32_16x16x32_bf16 v[12:15], a[116:119], v[68:71], v[12:15]
    v_mfma_f32_16x16x32_bf16 v[8:11], a[112:115], v[68:71], v[8:11]
    v_mfma_f32_16x16x32_bf16 v[8:11], a[96:99], v[64:67], v[8:11]
    s_waitcnt vmcnt(2) lgkmcnt(0)
    v_cmp_gt_i32 vcc, s32, v5
    v_mfma_f32_16x16x32_bf16 v[8:11], a[128:131], v[40:43], v[8:11]
    ds_read_b128 v[48:51], v2 offset:10240
    v_mfma_f32_16x16x32_bf16 v[8:11], a[144:147], v[44:47], v[8:11]
    s_and_b64 vcc, vcc, s[18:19]
    s_cbranch_scc1 Lffb_v01
    v_mfma_f32_16x16x32_bf16 v[12:15], a[148:151], v[44:47], v[12:15]
    ds_read_b128 v[52:55], v2 offset:11264
    v_mfma_f32_16x16x32_bf16 v[12:15], a[132:135], v[40:43], v[12:15]
    buffer_load_dwordx4 v1, s[8:11], s33 offen offset:0 sc1 lds
    v_mfma_f32_16x16x32_bf16 v[16:19], a[136:139], v[40:43], v[16:19]
    s_barrier
    v_mfma_f32_16x16x32_bf16 v[16:19], a[152:155], v[44:47], v[16:19]
    v_mfma_f32_16x16x32_bf16 v[20:23], a[156:159], v[44:47], v[20:23]
    v_mfma_f32_16x16x32_bf16 v[20:23], a[140:143], v[40:43], v[20:23]
    s_waitcnt lgkmcnt(0)
    buffer_load_dwordx4 v1, s[8:11], s33 offen offset:1024 sc1 lds
    v_mfma_f32_16x16x32_bf16 v[20:23], a[172:175], v[48:51], v[20:23]
    ds_read_b128 v[56:59], v2 offset:12288
    v_mfma_f32_16x16x32_bf16 v[20:23], a[188:191], v[52:55], v[20:23]
    v_mfma_f32_16x16x32_bf16 v[16:19], a[184:187], v[52:55], v[16:19]
    ds_read_b128 v[60:63], v2 offset:13312
    v_mfma_f32_16x16x32_bf16 v[16:19], a[168:171], v[48:51], v[16:19]
    buffer_load_dwordx4 v1, s[8:11], s33 offen offset:2048 sc1 lds
    v_mfma_f32_16x16x32_bf16 v[12:15], a[164:167], v[48:51], v[12:15]
    s_add_u32 s16, s16, 8192
    s_add_u32 m0, s34, s3
    s_add_u32 s37, s33, s3
    v_mfma_f32_16x16x32_bf16 v[12:15], a[180:183], v[52:55], v[12:15]
    v_mfma_f32_16x16x32_bf16 v[8:11], a[176:179], v[52:55], v[8:11]
    v_mfma_f32_16x16x32_bf16 v[8:11], a[160:163], v[48:51], v[8:11]
    s_waitcnt lgkmcnt(0)
    buffer_load_dwordx4 v1, s[8:11], s37 offen offset:0 sc1 lds
    v_mfma_f32_16x16x32_bf16 v[8:11], a[192:195], v[56:59], v[8:11]
    ds_read_b128 v[64:67], v2 offset:14336
    v_mfma_f32_16x16x32_bf16 v[8:11], a[208:211], v[60:63], v[8:11]
    v_mfma_f32_16x16x32_bf16 v[12:15], a[212:215], v[60:63], v[12:15]
    ds_read_b128 v[68:71], v2 offset:15360
    v_mfma_f32_16x16x32_bf16 v[12:15], a[196:199], v[56:59], v[12:15]
    s_waitcnt vmcnt(4)
    buffer_store_dword v6, v80, s[12:15], s17 offen sc1
    v_mfma_f32_16x16x32_bf16 v[16:19], a[200:203], v[56:59], v[16:19]
    buffer_load_dwordx4 v1, s[8:11], s37 offen offset:1024 sc1 lds
    v_mfma_f32_16x16x32_bf16 v[16:19], a[216:219], v[60:63], v[16:19]
    s_mov_b32 s14, s6
    s_add_u32 s17, s17, 8192
    v_mfma_f32_16x16x32_bf16 v[20:23], a[220:223], v[60:63], v[20:23]
    v_mfma_f32_16x16x32_bf16 v[20:23], a[204:207], v[56:59], v[20:23]
    s_waitcnt lgkmcnt(0)
    v_mfma_f32_16x16x32_bf16 v[20:23], a[236:239], v[64:67], v[20:23]
    ds_read_b128 v[40:43], v2 offset:16384
    v_mfma_f32_16x16x32_bf16 v[20:23], a[252:255], v[68:71], v[20:23]
    buffer_load_dwordx4 v1, s[8:11], s37 offen offset:2048 sc1 lds
    v_mfma_f32_16x16x32_bf16 v[16:19], a[248:251], v[68:71], v[16:19]
    ds_read_b128 v[44:47], v2 offset:17408
    s_add_u32 s32, s32, 1
    v_mfma_f32_16x16x32_bf16 v[16:19], a[232:235], v[64:67], v[16:19]
    s_add_u32 s33, s33, 116736
    s_add_u32 s34, s34, 36864
    v_mfma_f32_16x16x32_bf16 v[12:15], a[228:231], v[64:67], v[12:15]
    s_cmp_ge_u32 s34, 147456
    s_cselect_b32 s38, 147456, 0
    s_sub_u32 s34, s34, s38
    v_mfma_f32_16x16x32_bf16 v[12:15], a[244:247], v[68:71], v[12:15]
    v_mfma_f32_16x16x32_bf16 v[8:11], a[240:243], v[68:71], v[8:11]
    v_mfma_f32_16x16x32_bf16 v[8:11], a[224:227], v[64:67], v[8:11]
    s_waitcnt lgkmcnt(0)
    v_mfma_f32_16x16x32_bf16 v[8:11], v[128:131], v[40:43], v[8:11]
    ds_read_b128 v[48:51], v2 offset:18432
    v_mfma_f32_16x16x32_bf16 v[8:11], v[144:147], v[44:47], v[8:11]
    v_mfma_f32_16x16x32_bf16 v[12:15], v[148:151], v[44:47], v[12:15]
    ds_read_b128 v[52:55], v2 offset:19456
    v_mfma_f32_16x16x32_bf16 v[12:15], v[132:135], v[40:43], v[12:15]
    v_mfma_f32_16x16x32_bf16 v[16:19], v[136:139], v[40:43], v[16:19]
    v_mfma_f32_16x16x32_bf16 v[16:19], v[152:155], v[44:47], v[16:19]
    v_mfma_f32_16x16x32_bf16 v[20:23], v[156:159], v[44:47], v[20:23]
    v_mfma_f32_16x16x32_bf16 v[20:23], v[140:143], v[40:43], v[20:23]
    s_waitcnt lgkmcnt(0)
    v_mfma_f32_16x16x32_bf16 v[20:23], v[172:175], v[48:51], v[20:23]
    ds_read_b128 v[56:59], v2 offset:20480
    v_mfma_f32_16x16x32_bf16 v[20:23], v[188:191], v[52:55], v[20:23]
    v_mfma_f32_16x16x32_bf16 v[16:19], v[184:187], v[52:55], v[16:19]
    ds_read_b128 v[60:63], v2 offset:21504
    v_mfma_f32_16x16x32_bf16 v[16:19], v[168:171], v[48:51], v[16:19]
    v_mfma_f32_16x16x32_bf16 v[12:15], v[164:167], v[48:51], v[12:15]
    v_mfma_f32_16x16x32_bf16 v[12:15], v[180:183], v[52:55], v[12:15]
    v_mfma_f32_16x16x32_bf16 v[8:11], v[176:179], v[52:55], v[8:11]
    v_mfma_f32_16x16x32_bf16 v[8:11], v[160:163], v[48:51], v[8:11]
    s_waitcnt lgkmcnt(0)
    v_mfma_f32_16x16x32_bf16 v[8:11], v[192:195], v[56:59], v[8:11]
    ds_read_b128 v[64:67], v2 offset:22528
    v_mfma_f32_16x16x32_bf16 v[8:11], v[208:211], v[60:63], v[8:11]
    v_mfma_f32_16x16x32_bf16 v[12:15], v[212:215], v[60:63], v[12:15]
    ds_read_b128 v[68:71], v2 offset:23552
    v_mfma_f32_16x16x32_bf16 v[12:15], v[196:199], v[56:59], v[12:15]
    v_mfma_f32_16x16x32_bf16 v[16:19], v[200:203], v[56:59], v[16:19]
    s_waitcnt vmcnt(4)
    s_barrier
    v_mfma_f32_16x16x32_bf16 v[16:19], v[216:219], v[60:63], v[16:19]
    v_mfma_f32_16x16x32_bf16 v[20:23], v[220:223], v[60:63], v[20:23]
    v_mfma_f32_16x16x32_bf16 v[20:23], v[204:207], v[56:59], v[20:23]
    s_waitcnt lgkmcnt(0)
    v_mfma_f32_16x16x32_bf16 v[20:23], v[236:239], v[64:67], v[20:23]
    ds_read_b128 v[40:43], v3 offset:0
    v_mfma_f32_16x16x32_bf16 v[20:23], v[252:255], v[68:71], v[20:23]
    buffer_load_dword v5, v4, s[4:7], s16 offen sc1
    v_mfma_f32_16x16x32_bf16 v[16:19], v[248:251], v[68:71], v[16:19]
    ds_read_b128 v[44:47], v3 offset:1024
    v_mfma_f32_16x16x32_bf16 v[16:19], v[232:235], v[64:67], v[16:19]
    v_mfma_f32_16x16x32_bf16 v[12:15], v[228:231], v[64:67], v[12:15]
    v_mfma_f32_16x16x32_bf16 v[12:15], v[244:247], v[68:71], v[12:15]
    v_mfma_f32_16x16x32_bf16 v[8:11], v[240:243], v[68:71], v[8:11]
    v_mfma_f32_16x16x32_bf16 v[8:11], v[224:227], v[64:67], v[8:11]
Lffb_body10:
    s_waitcnt lgkmcnt(0)
    v_mfma_f32_16x16x32_bf16 v[24:27], a[0:3], v[40:43], 0
    ds_read_b128 v[48:51], v3 offset:2048
    s_add_u32 m0, s34, 0
    v_mfma_f32_16x16x32_bf16 v[24:27], a[16:19], v[44:47], v[24:27]
    s_add_u32 s31, s31, 1
    v_mov_b32 v6, s31
    s_add_u32 s35, s35, 36864
    v_mfma_f32_16x16x32_bf16 v[28:31], a[20:23], v[44:47], 0
    ds_read_b128 v[52:55], v3 offset:3072
    v_cvt_pk_bf16_f32 v72, v8, v9
    v_mfma_f32_16x16x32_bf16 v[28:31], a[4:7], v[40:43], v[28:31]
    s_cmp_eq_u32 s35, 147456
    s_cselect_b32 s35, 0, s35
    v_cvt_pk_bf16_f32 v73, v10, v11
    v_mfma_f32_16x16x32_bf16 v[32:35], a[8:11], v[40:43], 0
    v_cvt_pk_bf16_f32 v74, v12, v13
    v_cvt_pk_bf16_f32 v75, v14, v15
    v_mfma_f32_16x16x32_bf16 v[32:35], a[24:27], v[44:47], v[32:35]
    buffer_store_dwordx4 v[72:75], v1, s[12:15], s36 offen offset:0 sc1
    v_cvt_pk_bf16_f32 v76, v16, v17
    v_mfma_f32_16x16x32_bf16 v[36:39], a[28:31], v[44:47], 0
    v_cvt_pk_bf16_f32 v77, v18, v19
    v_cvt_pk_bf16_f32 v78, v20, v21
    v_mfma_f32_16x16x32_bf16 v[36:39], a[12:15], v[40:43], v[36:39]
    s_waitcnt lgkmcnt(0)
    v_cvt_pk_bf16_f32 v79, v22, v23
    v_add_u32 v2, s35, v1
    v_mfma_f32_16x16x32_bf16 v[36:39], a[44:47], v[48:51], v[36:39]
    ds_read_b128 v[56:59], v3 offset:4096
    v_mfma_f32_16x16x32_bf16 v[36:39], a[60:63], v[52:55], v[36:39]
    buffer_store_dwordx4 v[76:79], v1, s[12:15], s36 offen offset:1024 sc1
    s_add_u32 s36, s36, 131072
    v_mfma_f32_16x16x32_bf16 v[32:35], a[56:59], v[52:55], v[32:35]
    ds_read_b128 v[60:63], v3 offset:5120
    v_mfma_f32_16x16x32_bf16 v[32:35], a[40:43], v[48:51], v[32:35]
    v_mfma_f32_16x16x32_bf16 v[28:31], a[36:39], v[48:51], v[28:31]
    v_mfma_f32_16x16x32_bf16 v[28:31], a[52:55], v[52:55], v[28:31]
    v_mfma_f32_16x16x32_bf16 v[24:27], a[48:51], v[52:55], v[24:27]
    v_mfma_f32_16x16x32_bf16 v[24:27], a[32:35], v[48:51], v[24:27]
    s_waitcnt lgkmcnt(0)
    v_mfma_f32_16x16x32_bf16 v[24:27], a[64:67], v[56:59], v[24:27]
    ds_read_b128 v[64:67], v3 offset:6144
    v_mfma_f32_16x16x32_bf16 v[24:27], a[80:83], v[60:63], v[24:27]
    v_mfma_f32_16x16x32_bf16 v[28:31], a[84:87], v[60:63], v[28:31]
    ds_read_b128 v[68:71], v3 offset:7168
    v_mfma_f32_16x16x32_bf16 v[28:31], a[68:71], v[56:59], v[28:31]
    v_mfma_f32_16x16x32_bf16 v[32:35], a[72:75], v[56:59], v[32:35]
    v_mfma_f32_16x16x32_bf16 v[32:35], a[88:91], v[60:63], v[32:35]
    v_mfma_f32_16x16x32_bf16 v[36:39], a[92:95], v[60:63], v[36:39]
    v_mfma_f32_16x16x32_bf16 v[36:39], a[76:79], v[56:59], v[36:39]
    s_waitcnt lgkmcnt(0)
    v_mfma_f32_16x16x32_bf16 v[36:39], a[108:111], v[64:67], v[36:39]
    ds_read_b128 v[40:43], v3 offset:8192
    v_mfma_f32_16x16x32_bf16 v[36:39], a[124:127], v[68:71], v[36:39]
    v_mfma_f32_16x16x32_bf16 v[32:35], a[120:123], v[68:71], v[32:35]
    ds_read_b128 v[44:47], v3 offset:9216
    v_mfma_f32_16x16x32_bf16 v[32:35], a[104:107], v[64:67], v[32:35]
    v_mfma_f32_16x16x32_bf16 v[28:31], a[100:103], v[64:67], v[28:31]
    v_mfma_f32_16x16x32_bf16 v[28:31], a[116:119], v[68:71], v[28:31]
    v_mfma_f32_16x16x32_bf16 v[24:27], a[112:115], v[68:71], v[24:27]
    v_mfma_f32_16x16x32_bf16 v[24:27], a[96:99], v[64:67], v[24:27]
    s_waitcnt vmcnt(2) lgkmcnt(0)
    v_cmp_gt_i32 vcc, s32, v5
    v_mfma_f32_16x16x32_bf16 v[24:27], a[128:131], v[40:43], v[24:27]
    ds_read_b128 v[48:51], v3 offset:10240
    v_mfma_f32_16x16x32_bf16 v[24:27], a[144:147], v[44:47], v[24:27]
    s_and_b64 vcc, vcc, s[18:19]
    s_cbranch_scc1 Lffb_v11
    v_mfma_f32_16x16x32_bf16 v[28:31], a[148:151], v[44:47], v[28:31]
    ds_read_b128 v[52:55], v3 offset:11264
    v_mfma_f32_16x16x32_bf16 v[28:31], a[132:135], v[40:43], v[28:31]
    buffer_load_dwordx4 v1, s[8:11], s33 offen offset:0 sc1 lds
    v_mfma_f32_16x16x32_bf16 v[32:35], a[136:139], v[40:43], v[32:35]
    s_barrier
    v_mfma_f32_16x16x32_bf16 v[32:35], a[152:155], v[44:47], v[32:35]
    v_mfma_f32_16x16x32_bf16 v[36:39], a[156:159], v[44:47], v[36:39]
    v_mfma_f32_16x16x32_bf16 v[36:39], a[140:143], v[40:43], v[36:39]
    s_waitcnt lgkmcnt(0)
    buffer_load_dwordx4 v1, s[8:11], s33 offen offset:1024 sc1 lds
    v_mfma_f32_16x16x32_bf16 v[36:39], a[172:175], v[48:51], v[36:39]
    ds_read_b128 v[56:59], v3 offset:12288
    v_mfma_f32_16x16x32_bf16 v[36:39], a[188:191], v[52:55], v[36:39]
    v_mfma_f32_16x16x32_bf16 v[32:35], a[184:187], v[52:55], v[32:35]
    ds_read_b128 v[60:63], v3 offset:13312
    v_mfma_f32_16x16x32_bf16 v[32:35], a[168:171], v[48:51], v[32:35]
    buffer_load_dwordx4 v1, s[8:11], s33 offen offset:2048 sc1 lds
    v_mfma_f32_16x16x32_bf16 v[28:31], a[164:167], v[48:51], v[28:31]
    s_add_u32 s16, s16, 8192
    s_add_u32 m0, s34, s3
    s_add_u32 s37, s33, s3
    v_mfma_f32_16x16x32_bf16 v[28:31], a[180:183], v[52:55], v[28:31]
    v_mfma_f32_16x16x32_bf16 v[24:27], a[176:179], v[52:55], v[24:27]
    v_mfma_f32_16x16x32_bf16 v[24:27], a[160:163], v[48:51], v[24:27]
    s_waitcnt lgkmcnt(0)
    buffer_load_dwordx4 v1, s[8:11], s37 offen offset:0 sc1 lds
    v_mfma_f32_16x16x32_bf16 v[24:27], a[192:195], v[56:59], v[24:27]
    ds_read_b128 v[64:67], v3 offset:14336
    v_mfma_f32_16x16x32_bf16 v[24:27], a[208:211], v[60:63], v[24:27]
    v_mfma_f32_16x16x32_bf16 v[28:31], a[212:215], v[60:63], v[28:31]
    ds_read_b128 v[68:71], v3 offset:15360
    v_mfma_f32_16x16x32_bf16 v[28:31], a[196:199], v[56:59], v[28:31]
    s_waitcnt vmcnt(4)
    buffer_store_dword v6, v80, s[12:15], s17 offen sc1
    v_mfma_f32_16x16x32_bf16 v[32:35], a[200:203], v[56:59], v[32:35]
    buffer_load_dwordx4 v1, s[8:11], s37 offen offset:1024 sc1 lds
    v_mfma_f32_16x16x32_bf16 v[32:35], a[216:219], v[60:63], v[32:35]
    s_mov_b32 s14, s6
    s_add_u32 s17, s17, 8192
    v_mfma_f32_16x16x32_bf16 v[36:39], a[220:223], v[60:63], v[36:39]
    v_mfma_f32_16x16x32_bf16 v[36:39], a[204:207], v[56:59], v[36:39]
    s_waitcnt lgkmcnt(0)
    v_mfma_f32_16x16x32_bf16 v[36:39], a[236:239], v[64:67], v[36:39]
    ds_read_b128 v[40:43], v3 offset:16384
    v_mfma_f32_16x16x32_bf16 v[36:39], a[252:255], v[68:71], v[36:39]
    buffer_load_dwordx4 v1, s[8:11], s37 offen offset:2048 sc1 lds
    v_mfma_f32_16x16x32_bf16 v[32:35], a[248:251], v[68:71], v[32:35]
    ds_read_b128 v[44:47], v3 offset:17408
    s_add_u32 s32, s32, 1
    v_mfma_f32_16x16x32_bf16 v[32:35], a[232:235], v[64:67], v[32:35]
    s_add_u32 s33, s33, 116736
    s_add_u32 s34, s34, 36864
    v_mfma_f32_16x16x32_bf16 v[28:31], a[228:231], v[64:67], v[28:31]
    s_cmp_ge_u32 s34, 147456
    s_cselect_b32 s38, 147456, 0
    s_sub_u32 s34, s34, s38
    v_mfma_f32_16x16x32_bf16 v[28:31], a[244:247], v[68:71], v[28:31]
    v_mfma_f32_16x16x32_bf16 v[24:27], a[240:243], v[68:71], v[24:27]
    v_mfma_f32_16x16x32_bf16 v[24:27], a[224:227], v[64:67], v[24:27]
    s_waitcnt lgkmcnt(0)
    v_mfma_f32_16x16x32_bf16 v[24:27], v[128:131], v[40:43], v[24:27]
    ds_read_b128 v[48:51], v3 offset:18432
    v_mfma_f32_16x16x32_bf16 v[24:27], v[144:147], v[44:47], v[24:27]
    v_mfma_f32_16x16x32_bf16 v[28:31], v[148:151], v[44:47], v[28:31]
    ds_read_b128 v[52:55], v3 offset:19456
    v_mfma_f32_16x16x32_bf16 v[28:31], v[132:135], v[40:43], v[28:31]
    v_mfma_f32_16x16x32_bf16 v[32:35], v[136:139], v[40:43], v[32:35]
    v_mfma_f32_16x16x32_bf16 v[32:35], v[152:155], v[44:47], v[32:35]
    v_mfma_f32_16x16x32_bf16 v[36:39], v[156:159], v[44:47], v[36:39]
    v_mfma_f32_16x16x32_bf16 v[36:39], v[140:143], v[40:43], v[36:39]
    s_waitcnt lgkmcnt(0)
    v_mfma_f32_16x16x32_bf16 v[36:39], v[172:175], v[48:51], v[36:39]
    ds_read_b128 v[56:59], v3 offset:20480
    v_mfma_f32_16x16x32_bf16 v[36:39], v[188:191], v[52:55], v[36:39]
    v_mfma_f32_16x16x32_bf16 v[32:35], v[184:187], v[52:55], v[32:35]
    ds_read_b128 v[60:63], v3 offset:21504
    v_mfma_f32_16x16x32_bf16 v[32:35], v[168:171], v[48:51], v[32:35]
    v_mfma_f32_16x16x32_bf16 v[28:31], v[164:167], v[48:51], v[28:31]
    v_mfma_f32_16x16x32_bf16 v[28:31], v[180:183], v[52:55], v[28:31]
    v_mfma_f32_16x16x32_bf16 v[24:27], v[176:179], v[52:55], v[24:27]
    v_mfma_f32_16x16x32_bf16 v[24:27], v[160:163], v[48:51], v[24:27]
    s_waitcnt lgkmcnt(0)
    v_mfma_f32_16x16x32_bf16 v[24:27], v[192:195], v[56:59], v[24:27]
    ds_read_b128 v[64:67], v3 offset:22528
    v_mfma_f32_16x16x32_bf16 v[24:27], v[208:211], v[60:63], v[24:27]
    v_mfma_f32_16x16x32_bf16 v[28:31], v[212:215], v[60:63], v[28:31]
    ds_read_b128 v[68:71], v3 offset:23552
    v_mfma_f32_16x16x32_bf16 v[28:31], v[196:199], v[56:59], v[28:31]
    v_mfma_f32_16x16x32_bf16 v[32:35], v[200:203], v[56:59], v[32:35]
    s_waitcnt vmcnt(4)
    s_barrier
    v_mfma_f32_16x16x32_bf16 v[32:35], v[216:219], v[60:63], v[32:35]
    v_mfma_f32_16x16x32_bf16 v[36:39], v[220:223], v[60:63], v[36:39]
    v_mfma_f32_16x16x32_bf16 v[36:39], v[204:207], v[56:59], v[36:39]
    s_waitcnt lgkmcnt(0)
    v_mfma_f32_16x16x32_bf16 v[36:39], v[236:239], v[64:67], v[36:39]
    ds_read_b128 v[40:43], v2 offset:0
    v_mfma_f32_16x16x32_bf16 v[36:39], v[252:255], v[68:71], v[36:39]
    buffer_load_dword v5, v4, s[4:7], s16 offen sc1
    v_mfma_f32_16x16x32_bf16 v[32:35], v[248:251], v[68:71], v[32:35]
    ds_read_b128 v[44:47], v2 offset:1024
    v_mfma_f32_16x16x32_bf16 v[32:35], v[232:235], v[64:67], v[32:35]
    v_mfma_f32_16x16x32_bf16 v[28:31], v[228:231], v[64:67], v[28:31]
    v_mfma_f32_16x16x32_bf16 v[28:31], v[244:247], v[68:71], v[28:31]
    v_mfma_f32_16x16x32_bf16 v[24:27], v[240:243], v[68:71], v[24:27]
    v_mfma_f32_16x16x32_bf16 v[24:27], v[224:227], v[64:67], v[24:27]
    s_cmp_lt_i32 s31, 63
    s_cbranch_scc1 Lffb_body00
    s_branch L_exit
    .p2align 6
Lffb_body01:
    s_waitcnt lgkmcnt(0)
    v_mfma_f32_16x16x32_bf16 v[8:11], a[0:3], v[40:43], 0
    ds_read_b128 v[48:51], v2 offset:2048
    s_add_u32 m0, s34, 0
    v_mfma_f32_16x16x32_bf16 v[8:11], a[16:19], v[44:47], v[8:11]
    s_add_u32 s31, s31, 1
    v_mov_b32 v6, s31
    s_add_u32 s35, s35, 36864
    v_mfma_f32_16x16x32_bf16 v[12:15], a[20:23], v[44:47], 0
    ds_read_b128 v[52:55], v2 offset:3072
    v_cvt_pk_bf16_f32 v72, v24, v25
    v_mfma_f32_16x16x32_bf16 v[12:15], a[4:7], v[40:43], v[12:15]
    s_cmp_eq_u32 s35, 147456
    s_cselect_b32 s35, 0, s35
    v_cvt_pk_bf16_f32 v73, v26, v27
    v_mfma_f32_16x16x32_bf16 v[16:19], a[8:11], v[40:43], 0
    v_cvt_pk_bf16_f32 v74, v28, v29
    v_cvt_pk_bf16_f32 v75, v30, v31
    v_mfma_f32_16x16x32_bf16 v[16:19], a[24:27], v[44:47], v[16:19]
    buffer_store_dwordx4 v[72:75], v1, s[12:15], s36 offen offset:0 sc1
    v_cvt_pk_bf16_f32 v76, v32, v33
    v_mfma_f32_16x16x32_bf16 v[20:23], a[28:31], v[44:47], 0
    v_cvt_pk_bf16_f32 v77, v34, v35
    v_cvt_pk_bf16_f32 v78, v36, v37
    v_mfma_f32_16x16x32_bf16 v[20:23], a[12:15], v[40:43], v[20:23]
    s_waitcnt lgkmcnt(0)
    v_cvt_pk_bf16_f32 v79, v38, v39
    v_add_u32 v3, s35, v1
    v_mfma_f32_16x16x32_bf16 v[20:23], a[44:47], v[48:51], v[20:23]
    ds_read_b128 v[56:59], v2 offset:4096
    v_mfma_f32_16x16x32_bf16 v[20:23], a[60:63], v[52:55], v[20:23]
    buffer_store_dwordx4 v[76:79], v1, s[12:15], s36 offen offset:1024 sc1
    s_add_u32 s36, s36, 131072
    v_mfma_f32_16x16x32_bf16 v[16:19], a[56:59], v[52:55], v[16:19]
    ds_read_b128 v[60:63], v2 offset:5120
    v_mfma_f32_16x16x32_bf16 v[16:19], a[40:43], v[48:51], v[16:19]
    v_mfma_f32_16x16x32_bf16 v[12:15], a[36:39], v[48:51], v[12:15]
    v_mfma_f32_16x16x32_bf16 v[12:15], a[52:55], v[52:55], v[12:15]
    v_mfma_f32_16x16x32_bf16 v[8:11], a[48:51], v[52:55], v[8:11]
    v_mfma_f32_16x16x32_bf16 v[8:11], a[32:35], v[48:51], v[8:11]
    s_waitcnt lgkmcnt(0)
    v_mfma_f32_16x16x32_bf16 v[8:11], a[64:67], v[56:59], v[8:11]
    ds_read_b128 v[64:67], v2 offset:6144
    v_mfma_f32_16x16x32_bf16 v[8:11], a[80:83], v[60:63], v[8:11]
    v_mfma_f32_16x16x32_bf16 v[12:15], a[84:87], v[60:63], v[12:15]
    ds_read_b128 v[68:71], v2 offset:7168
    v_mfma_f32_16x16x32_bf16 v[12:15], a[68:71], v[56:59], v[12:15]
    v_mfma_f32_16x16x32_bf16 v[16:19], a[72:75], v[56:59], v[16:19]
    v_mfma_f32_16x16x32_bf16 v[16:19], a[88:91], v[60:63], v[16:19]
    v_mfma_f32_16x16x32_bf16 v[20:23], a[92:95], v[60:63], v[20:23]
    v_mfma_f32_16x16x32_bf16 v[20:23], a[76:79], v[56:59], v[20:23]
    s_waitcnt lgkmcnt(0)
    v_mfma_f32_16x16x32_bf16 v[20:23], a[108:111], v[64:67], v[20:23]
    ds_read_b128 v[40:43], v2 offset:8192
    v_mfma_f32_16x16x32_bf16 v[20:23], a[124:127], v[68:71], v[20:23]
    v_mfma_f32_16x16x32_bf16 v[16:19], a[120:123], v[68:71], v[16:19]
    ds_read_b128 v[44:47], v2 offset:9216
    v_mfma_f32_16x16x32_bf16 v[16:19], a[104:107], v[64:67], v[16:19]
    v_mfma_f32_16x16x32_bf16 v[12:15], a[100:103], v[64:67], v[12:15]
    v_mfma_f32_16x16x32_bf16 v[12:15], a[116:119], v[68:71], v[12:15]
    v_mfma_f32_16x16x32_bf16 v[8:11], a[112:115], v[68:71], v[8:11]
    v_mfma_f32_16x16x32_bf16 v[8:11], a[96:99], v[64:67], v[8:11]
    s_waitcnt vmcnt(2) lgkmcnt(0)
    v_cmp_gt_i32 vcc, s32, v5
    v_mfma_f32_16x16x32_bf16 v[8:11], a[128:131], v[40:43], v[8:11]
    ds_read_b128 v[48:51], v2 offset:10240
    v_mfma_f32_16x16x32_bf16 v[8:11], a[144:147], v[44:47], v[8:11]
    s_and_b64 vcc, vcc, s[18:19]
    s_cbranch_scc1 Lffb_v01
    v_mfma_f32_16x16x32_bf16 v[12:15], a[148:151], v[44:47], v[12:15]
    ds_read_b128 v[52:55], v2 offset:11264
    v_mfma_f32_16x16x32_bf16 v[12:15], a[132:135], v[40:43], v[12:15]
    buffer_load_dwordx4 v1, s[8:11], s33 offen offset:0 sc1 lds
    v_mfma_f32_16x16x32_bf16 v[16:19], a[136:139], v[40:43], v[16:19]
    v_mfma_f32_16x16x32_bf16 v[16:19], a[152:155], v[44:47], v[16:19]
    s_barrier
    v_mfma_f32_16x16x32_bf16 v[20:23], a[156:159], v[44:47], v[20:23]
    v_mfma_f32_16x16x32_bf16 v[20:23], a[140:143], v[40:43], v[20:23]
    s_waitcnt lgkmcnt(0)
    buffer_load_dwordx4 v1, s[8:11], s33 offen offset:1024 sc1 lds
    v_mfma_f32_16x16x32_bf16 v[20:23], a[172:175], v[48:51], v[20:23]
    ds_read_b128 v[56:59], v2 offset:12288
    v_mfma_f32_16x16x32_bf16 v[20:23], a[188:191], v[52:55], v[20:23]
    v_mfma_f32_16x16x32_bf16 v[16:19], a[184:187], v[52:55], v[16:19]
    ds_read_b128 v[60:63], v2 offset:13312
    v_mfma_f32_16x16x32_bf16 v[16:19], a[168:171], v[48:51], v[16:19]
    buffer_load_dwordx4 v1, s[8:11], s33 offen offset:2048 sc1 lds
    v_mfma_f32_16x16x32_bf16 v[12:15], a[164:167], v[48:51], v[12:15]
    s_add_u32 s16, s16, 8192
    s_add_u32 m0, s34, s3
    s_add_u32 s37, s33, s3
    v_mfma_f32_16x16x32_bf16 v[12:15], a[180:183], v[52:55], v[12:15]
    v_mfma_f32_16x16x32_bf16 v[8:11], a[176:179], v[52:55], v[8:11]
    v_mfma_f32_16x16x32_bf16 v[8:11], a[160:163], v[48:51], v[8:11]
    s_waitcnt lgkmcnt(0)
    buffer_load_dwordx4 v1, s[8:11], s37 offen offset:0 sc1 lds
    v_mfma_f32_16x16x32_bf16 v[8:11], a[192:195], v[56:59], v[8:11]
    ds_read_b128 v[64:67], v2 offset:14336
    v_mfma_f32_16x16x32_bf16 v[8:11], a[208:211], v[60:63], v[8:11]
    v_mfma_f32_16x16x32_bf16 v[12:15], a[212:215], v[60:63], v[12:15]
    ds_read_b128 v[68:71], v2 offset:15360
    v_mfma_f32_16x16x32_bf16 v[12:15], a[196:199], v[56:59], v[12:15]
    s_waitcnt vmcnt(4)
    buffer_store_dword v6, v80, s[12:15], s17 offen sc1
    v_mfma_f32_16x16x32_bf16 v[16:19], a[200:203], v[56:59], v[16:19]
    buffer_load_dwordx4 v1, s[8:11], s37 offen offset:1024 sc1 lds
    v_mfma_f32_16x16x32_bf16 v[16:19], a[216:219], v[60:63], v[16:19]
    s_mov_b32 s14, s6
    s_add_u32 s17, s17, 8192
    v_mfma_f32_16x16x32_bf16 v[20:23], a[220:223], v[60:63], v[20:23]
    v_mfma_f32_16x16x32_bf16 v[20:23], a[204:207], v[56:59], v[20:23]
    s_waitcnt lgkmcnt(0)
    v_mfma_f32_16x16x32_bf16 v[20:23], a[236:239], v[64:67], v[20:23]
    ds_read_b128 v[40:43], v2 offset:16384
    v_mfma_f32_16x16x32_bf16 v[20:23], a[252:255], v[68:71], v[20:23]
    buffer_load_dwordx4 v1, s[8:11], s37 offen offset:2048 sc1 lds
    v_mfma_f32_16x16x32_bf16 v[16:19], a[248:251], v[68:71], v[16:19]
    ds_read_b128 v[44:47], v2 offset:17408
    s_add_u32 s32, s32, 1
    v_mfma_f32_16x16x32_bf16 v[16:19], a[232:235], v[64:67], v[16:19]
    s_add_u32 s33, s33, 116736
    s_add_u32 s34, s34, 36864
    v_mfma_f32_16x16x32_bf16 v[12:15], a[228:231], v[64:67], v[12:15]
    s_cmp_ge_u32 s34, 147456
    s_cselect_b32 s38, 147456, 0
    s_sub_u32 s34, s34, s38
    v_mfma_f32_16x16x32_bf16 v[12:15], a[244:247], v[68:71], v[12:15]
    v_mfma_f32_16x16x32_bf16 v[8:11], a[240:243], v[68:71], v[8:11]
    v_mfma_f32_16x16x32_bf16 v[8:11], a[224:227], v[64:67], v[8:11]
    s_waitcnt lgkmcnt(0)
    v_mfma_f32_16x16x32_bf16 v[8:11], v[128:131], v[40:43], v[8:11]
    ds_read_b128 v[48:51], v2 offset:18432
    v_mfma_f32_16x16x32_bf16 v[8:11], v[144:147], v[44:47], v[8:11]
    v_mfma_f32_16x16x32_bf16 v[12:15], v[148:151], v[44:47], v[12:15]
    ds_read_b128 v[52:55], v2 offset:19456
    v_mfma_f32_16x16x32_bf16 v[12:15], v[132:135], v[40:43], v[12:15]
    v_mfma_f32_16x16x32_bf16 v[16:19], v[136:139], v[40:43], v[16:19]
    v_mfma_f32_16x16x32_bf16 v[16:19], v[152:155], v[44:47], v[16:19]
    v_mfma_f32_16x16x32_bf16 v[20:23], v[156:159], v[44:47], v[20:23]
    v_mfma_f32_16x16x32_bf16 v[20:23], v[140:143], v[40:43], v[20:23]
    s_waitcnt lgkmcnt(0)
    v_mfma_f32_16x16x32_bf16 v[20:23], v[172:175], v[48:51], v[20:23]
    ds_read_b128 v[56:59], v2 offset:20480
    v_mfma_f32_16x16x32_bf16 v[20:23], v[188:191], v[52:55], v[20:23]
    v_mfma_f32_16x16x32_bf16 v[16:19], v[184:187], v[52:55], v[16:19]
    ds_read_b128 v[60:63], v2 offset:21504
    v_mfma_f32_16x16x32_bf16 v[16:19], v[168:171], v[48:51], v[16:19]
    v_mfma_f32_16x16x32_bf16 v[12:15], v[164:167], v[48:51], v[12:15]
    v_mfma_f32_16x16x32_bf16 v[12:15], v[180:183], v[52:55], v[12:15]
    v_mfma_f32_16x16x32_bf16 v[8:11], v[176:179], v[52:55], v[8:11]
    v_mfma_f32_16x16x32_bf16 v[8:11], v[160:163], v[48:51], v[8:11]
    s_waitcnt lgkmcnt(0)
    v_mfma_f32_16x16x32_bf16 v[8:11], v[192:195], v[56:59], v[8:11]
    ds_read_b128 v[64:67], v2 offset:22528
    v_mfma_f32_16x16x32_bf16 v[8:11], v[208:211], v[60:63], v[8:11]
    v_mfma_f32_16x16x32_bf16 v[12:15], v[212:215], v[60:63], v[12:15]
    ds_read_b128 v[68:71], v2 offset:23552
    v_mfma_f32_16x16x32_bf16 v[12:15], v[196:199], v[56:59], v[12:15]
    v_mfma_f32_16x16x32_bf16 v[16:19], v[200:203], v[56:59], v[16:19]
    s_waitcnt vmcnt(4)
    v_mfma_f32_16x16x32_bf16 v[16:19], v[216:219], v[60:63], v[16:19]
    s_barrier
    v_mfma_f32_16x16x32_bf16 v[20:23], v[220:223], v[60:63], v[20:23]
    v_mfma_f32_16x16x32_bf16 v[20:23], v[204:207], v[56:59], v[20:23]
    s_waitcnt lgkmcnt(0)
    v_mfma_f32_16x16x32_bf16 v[20:23], v[236:239], v[64:67], v[20:23]
    ds_read_b128 v[40:43], v3 offset:0
    v_mfma_f32_16x16x32_bf16 v[20:23], v[252:255], v[68:71], v[20:23]
    buffer_load_dword v5, v4, s[4:7], s16 offen sc1
    v_mfma_f32_16x16x32_bf16 v[16:19], v[248:251], v[68:71], v[16:19]
    ds_read_b128 v[44:47], v3 offset:1024
    v_mfma_f32_16x16x32_bf16 v[16:19], v[232:235], v[64:67], v[16:19]
    v_mfma_f32_16x16x32_bf16 v[12:15], v[228:231], v[64:67], v[12:15]
    v_mfma_f32_16x16x32_bf16 v[12:15], v[244:247], v[68:71], v[12:15]
    v_mfma_f32_16x16x32_bf16 v[8:11], v[240:243], v[68:71], v[8:11]
    v_mfma_f32_16x16x32_bf16 v[8:11], v[224:227], v[64:67], v[8:11]
Lffb_body11:
    s_waitcnt lgkmcnt(0)
    v_mfma_f32_16x16x32_bf16 v[24:27], a[0:3], v[40:43], 0
    ds_read_b128 v[48:51], v3 offset:2048
    s_add_u32 m0, s34, 0
    v_mfma_f32_16x16x32_bf16 v[24:27], a[16:19], v[44:47], v[24:27]
    s_add_u32 s31, s31, 1
    v_mov_b32 v6, s31
    s_add_u32 s35, s35, 36864
    v_mfma_f32_16x16x32_bf16 v[28:31], a[20:23], v[44:47], 0
    ds_read_b128 v[52:55], v3 offset:3072
    v_cvt_pk_bf16_f32 v72, v8, v9
    v_mfma_f32_16x16x32_bf16 v[28:31], a[4:7], v[40:43], v[28:31]
    s_cmp_eq_u32 s35, 147456
    s_cselect_b32 s35, 0, s35
    v_cvt_pk_bf16_f32 v73, v10, v11
    v_mfma_f32_16x16x32_bf16 v[32:35], a[8:11], v[40:43], 0
    v_cvt_pk_bf16_f32 v74, v12, v13
    v_cvt_pk_bf16_f32 v75, v14, v15
    v_mfma_f32_16x16x32_bf16 v[32:35], a[24:27], v[44:47], v[32:35]
    buffer_store_dwordx4 v[72:75], v1, s[12:15], s36 offen offset:0 sc1
    v_cvt_pk_bf16_f32 v76, v16, v17
    v_mfma_f32_16x16x32_bf16 v[36:39], a[28:31], v[44:47], 0
    v_cvt_pk_bf16_f32 v77, v18, v19
    v_cvt_pk_bf16_f32 v78, v20, v21
    v_mfma_f32_16x16x32_bf16 v[36:39], a[12:15], v[40:43], v[36:39]
    s_waitcnt lgkmcnt(0)
    v_cvt_pk_bf16_f32 v79, v22, v23
    v_add_u32 v2, s35, v1
    v_mfma_f32_16x16x32_bf16 v[36:39], a[44:47], v[48:51], v[36:39]
    ds_read_b128 v[56:59], v3 offset:4096
    v_mfma_f32_16x16x32_bf16 v[36:39], a[60:63], v[52:55], v[36:39]
    buffer_store_dwordx4 v[76:79], v1, s[12:15], s36 offen offset:1024 sc1
    s_add_u32 s36, s36, 131072
    v_mfma_f32_16x16x32_bf16 v[32:35], a[56:59], v[52:55], v[32:35]
    ds_read_b128 v[60:63], v3 offset:5120
    v_mfma_f32_16x16x32_bf16 v[32:35], a[40:43], v[48:51], v[32:35]
    v_mfma_f32_16x16x32_bf16 v[28:31], a[36:39], v[48:51], v[28:31]
    v_mfma_f32_16x16x32_bf16 v[28:31], a[52:55], v[52:55], v[28:31]
    v_mfma_f32_16x16x32_bf16 v[24:27], a[48:51], v[52:55], v[24:27]
    v_mfma_f32_16x16x32_bf16 v[24:27], a[32:35], v[48:51], v[24:27]
    s_waitcnt lgkmcnt(0)
    v_mfma_f32_16x16x32_bf16 v[24:27], a[64:67], v[56:59], v[24:27]
    ds_read_b128 v[64:67], v3 offset:6144
    v_mfma_f32_16x16x32_bf16 v[24:27], a[80:83], v[60:63], v[24:27]
    v_mfma_f32_16x16x32_bf16 v[28:31], a[84:87], v[60:63], v[28:31]
    ds_read_b128 v[68:71], v3 offset:7168
    v_mfma_f32_16x16x32_bf16 v[28:31], a[68:71], v[56:59], v[28:31]
    v_mfma_f32_16x16x32_bf16 v[32:35], a[72:75], v[56:59], v[32:35]
    v_mfma_f32_16x16x32_bf16 v[32:35], a[88:91], v[60:63], v[32:35]
    v_mfma_f32_16x16x32_bf16 v[36:39], a[92:95], v[60:63], v[36:39]
    v_mfma_f32_16x16x32_bf16 v[36:39], a[76:79], v[56:59], v[36:39]
    s_waitcnt lgkmcnt(0)
    v_mfma_f32_16x16x32_bf16 v[36:39], a[108:111], v[64:67], v[36:39]
    ds_read_b128 v[40:43], v3 offset:8192
    v_mfma_f32_16x16x32_bf16 v[36:39], a[124:127], v[68:71], v[36:39]
    v_mfma_f32_16x16x32_bf16 v[32:35], a[120:123], v[68:71], v[32:35]
    ds_read_b128 v[44:47], v3 offset:9216
    v_mfma_f32_16x16x32_bf16 v[32:35], a[104:107], v[64:67], v[32:35]
    v_mfma_f32_16x16x32_bf16 v[28:31], a[100:103], v[64:67], v[28:31]
    v_mfma_f32_16x16x32_bf16 v[28:31], a[116:119], v[68:71], v[28:31]
    v_mfma_f32_16x16x32_bf16 v[24:27], a[112:115], v[68:71], v[24:27]
    v_mfma_f32_16x16x32_bf16 v[24:27], a[96:99], v[64:67], v[24:27]
    s_waitcnt vmcnt(2) lgkmcnt(0)
    v_cmp_gt_i32 vcc, s32, v5
    v_mfma_f32_16x16x32_bf16 v[24:27], a[128:131], v[40:43], v[24:27]
    ds_read_b128 v[48:51], v3 offset:10240
    v_mfma_f32_16x16x32_bf16 v[24:27], a[144:147], v[44:47], v[24:27]
    s_and_b64 vcc, vcc, s[18:19]
    s_cbranch_scc1 Lffb_v11
    v_mfma_f32_16x16x32_bf16 v[28:31], a[148:151], v[44:47], v[28:31]
    ds_read_b128 v[52:55], v3 offset:11264
    v_mfma_f32_16x16x32_bf16 v[28:31], a[132:135], v[40:43], v[28:31]
    buffer_load_dwordx4 v1, s[8:11], s33 offen offset:0 sc1 lds
    v_mfma_f32_16x16x32_bf16 v[32:35], a[136:139], v[40:43], v[32:35]
    v_mfma_f32_16x16x32_bf16 v[32:35], a[152:155], v[44:47], v[32:35]
    s_barrier
    v_mfma_f32_16x16x32_bf16 v[36:39], a[156:159], v[44:47], v[36:39]
    v_mfma_f32_16x16x32_bf16 v[36:39], a[140:143], v[40:43], v[36:39]
    s_waitcnt lgkmcnt(0)
    buffer_load_dwordx4 v1, s[8:11], s33 offen offset:1024 sc1 lds
    v_mfma_f32_16x16x32_bf16 v[36:39], a[172:175], v[48:51], v[36:39]
    ds_read_b128 v[56:59], v3 offset:12288
    v_mfma_f32_16x16x32_bf16 v[36:39], a[188:191], v[52:55], v[36:39]
    v_mfma_f32_16x16x32_bf16 v[32:35], a[184:187], v[52:55], v[32:35]
    ds_read_b128 v[60:63], v3 offset:13312
    v_mfma_f32_16x16x32_bf16 v[32:35], a[168:171], v[48:51], v[32:35]
    buffer_load_dwordx4 v1, s[8:11], s33 offen offset:2048 sc1 lds
    v_mfma_f32_16x16x32_bf16 v[28:31], a[164:167], v[48:51], v[28:31]
    s_add_u32 s16, s16, 8192
    s_add_u32 m0, s34, s3
    s_add_u32 s37, s33, s3
    v_mfma_f32_16x16x32_bf16 v[28:31], a[180:183], v[52:55], v[28:31]
    v_mfma_f32_16x16x32_bf16 v[24:27], a[176:179], v[52:55], v[24:27]
    v_mfma_f32_16x16x32_bf16 v[24:27], a[160:163], v[48:51], v[24:27]
    s_waitcnt lgkmcnt(0)
    buffer_load_dwordx4 v1, s[8:11], s37 offen offset:0 sc1 lds
    v_mfma_f32_16x16x32_bf16 v[24:27], a[192:195], v[56:59], v[24:27]
    ds_read_b128 v[64:67], v3 offset:14336
    v_mfma_f32_16x16x32_bf16 v[24:27], a[208:211], v[60:63], v[24:27]
    v_mfma_f32_16x16x32_bf16 v[28:31], a[212:215], v[60:63], v[28:31]
    ds_read_b128 v[68:71], v3 offset:15360
    v_mfma_f32_16x16x32_bf16 v[28:31], a[196:199], v[56:59], v[28:31]
    s_waitcnt vmcnt(4)
    buffer_store_dword v6, v80, s[12:15], s17 offen sc1
    v_mfma_f32_16x16x32_bf16 v[32:35], a[200:203], v[56:59], v[32:35]
    buffer_load_dwordx4 v1, s[8:11], s37 offen offset:1024 sc1 lds
    v_mfma_f32_16x16x32_bf16 v[32:35], a[216:219], v[60:63], v[32:35]
    s_mov_b32 s14, s6
    s_add_u32 s17, s17, 8192
    v_mfma_f32_16x16x32_bf16 v[36:39], a[220:223], v[60:63], v[36:39]
    v_mfma_f32_16x16x32_bf16 v[36:39], a[204:207], v[56:59], v[36:39]
    s_waitcnt lgkmcnt(0)
    v_mfma_f32_16x16x32_bf16 v[36:39], a[236:239], v[64:67], v[36:39]
    ds_read_b128 v[40:43], v3 offset:16384
    v_mfma_f32_16x16x32_bf16 v[36:39], a[252:255], v[68:71], v[36:39]
    buffer_load_dwordx4 v1, s[8:11], s37 offen offset:2048 sc1 lds
    v_mfma_f32_16x16x32_bf16 v[32:35], a[248:251], v[68:71], v[32:35]
    ds_read_b128 v[44:47], v3 offset:17408
    s_add_u32 s32, s32, 1
    v_mfma_f32_16x16x32_bf16 v[32:35], a[232:235], v[64:67], v[32:35]
    s_add_u32 s33, s33, 116736
    s_add_u32 s34, s34, 36864
    v_mfma_f32_16x16x32_bf16 v[28:31], a[228:231], v[64:67], v[28:31]
    s_cmp_ge_u32 s34, 147456
    s_cselect_b32 s38, 147456, 0
    s_sub_u32 s34, s34, s38
    v_mfma_f32_16x16x32_bf16 v[28:31], a[244:247], v[68:71], v[28:31]
    v_mfma_f32_16x16x32_bf16 v[24:27], a[240:243], v[68:71], v[24:27]
    v_mfma_f32_16x16x32_bf16 v[24:27], a[224:227], v[64:67], v[24:27]
    s_waitcnt lgkmcnt(0)
    v_mfma_f32_16x16x32_bf16 v[24:27], v[128:131], v[40:43], v[24:27]
    ds_read_b128 v[48:51], v3 offset:18432
    v_mfma_f32_16x16x32_bf16 v[24:27], v[144:147], v[44:47], v[24:27]
    v_mfma_f32_16x16x32_bf16 v[28:31], v[148:151], v[44:47], v[28:31]
    ds_read_b128 v[52:55], v3 offset:19456
    v_mfma_f32_16x16x32_bf16 v[28:31], v[132:135], v[40:43], v[28:31]
    v_mfma_f32_16x16x32_bf16 v[32:35], v[136:139], v[40:43], v[32:35]
    v_mfma_f32_16x16x32_bf16 v[32:35], v[152:155], v[44:47], v[32:35]
    v_mfma_f32_16x16x32_bf16 v[36:39], v[156:159], v[44:47], v[36:39]
    v_mfma_f32_16x16x32_bf16 v[36:39], v[140:143], v[40:43], v[36:39]
    s_waitcnt lgkmcnt(0)
    v_mfma_f32_16x16x32_bf16 v[36:39], v[172:175], v[48:51], v[36:39]
    ds_read_b128 v[56:59], v3 offset:20480
    v_mfma_f32_16x16x32_bf16 v[36:39], v[188:191], v[52:55], v[36:39]
    v_mfma_f32_16x16x32_bf16 v[32:35], v[184:187], v[52:55], v[32:35]
    ds_read_b128 v[60:63], v3 offset:21504
    v_mfma_f32_16x16x32_bf16 v[32:35], v[168:171], v[48:51], v[32:35]
    v_mfma_f32_16x16x32_bf16 v[28:31], v[164:167], v[48:51], v[28:31]
    v_mfma_f32_16x16x32_bf16 v[28:31], v[180:183], v[52:55], v[28:31]
    v_mfma_f32_16x16x32_bf16 v[24:27], v[176:179], v[52:55], v[24:27]
    v_mfma_f32_16x16x32_bf16 v[24:27], v[160:163], v[48:51], v[24:27]
    s_waitcnt lgkmcnt(0)
    v_mfma_f32_16x16x32_bf16 v[24:27], v[192:195], v[56:59], v[24:27]
    ds_read_b128 v[64:67], v3 offset:22528
    v_mfma_f32_16x16x32_bf16 v[24:27], v[208:211], v[60:63], v[24:27]
    v_mfma_f32_16x16x32_bf16 v[28:31], v[212:215], v[60:63], v[28:31]
    ds_read_b128 v[68:71], v3 offset:23552
    v_mfma_f32_16x16x32_bf16 v[28:31], v[196:199], v[56:59], v[28:31]
    v_mfma_f32_16x16x32_bf16 v[32:35], v[200:203], v[56:59], v[32:35]
    s_waitcnt vmcnt(4)
    v_mfma_f32_16x16x32_bf16 v[32:35], v[216:219], v[60:63], v[32:35]
    s_barrier
    v_mfma_f32_16x16x32_bf16 v[36:39], v[220:223], v[60:63], v[36:39]
    v_mfma_f32_16x16x32_bf16 v[36:39], v[204:207], v[56:59], v[36:39]
    s_waitcnt lgkmcnt(0)
    v_mfma_f32_16x16x32_bf16 v[36:39], v[236:239], v[64:67], v[36:39]
    ds_read_b128 v[40:43], v2 offset:0
    v_mfma_f32_16x16x32_bf16 v[36:39], v[252:255], v[68:71], v[36:39]
    buffer_load_dword v5, v4, s[4:7], s16 offen sc1
    v_mfma_f32_16x16x32_bf16 v[32:35], v[248:251], v[68:71], v[32:35]
    ds_read_b128 v[44:47], v2 offset:1024
    v_mfma_f32_16x16x32_bf16 v[32:35], v[232:235], v[64:67], v[32:35]
    v_mfma_f32_16x16x32_bf16 v[28:31], v[228:231], v[64:67], v[28:31]
    v_mfma_f32_16x16x32_bf16 v[28:31], v[244:247], v[68:71], v[28:31]
    v_mfma_f32_16x16x32_bf16 v[24:27], v[240:243], v[68:71], v[24:27]
    v_mfma_f32_16x16x32_bf16 v[24:27], v[224:227], v[64:67], v[24:27]
    s_cmp_lt_i32 s31, 63
    s_cbranch_scc1 Lffb_body01
    s_branch L_exit
    .p2align 6
Lffb_body02:
    s_waitcnt lgkmcnt(0)
    v_mfma_f32_16x16x32_bf16 v[8:11], a[0:3], v[40:43], 0
    ds_read_b128 v[48:51], v2 offset:2048
    s_add_u32 m0, s34, 0
    v_mfma_f32_16x16x32_bf16 v[8:11], a[16:19], v[44:47], v[8:11]
    s_add_u32 s31, s31, 1
    v_mov_b32 v6, s31
    s_add_u32 s35, s35, 36864
    v_mfma_f32_16x16x32_bf16 v[12:15], a[20:23], v[44:47], 0
    ds_read_b128 v[52:55], v2 offset:3072
    v_cvt_pk_bf16_f32 v72, v24, v25
    v_mfma_f32_16x16x32_bf16 v[12:15], a[4:7], v[40:43], v[12:15]
    s_cmp_eq_u32 s35, 147456
    s_cselect_b32 s35, 0, s35
    v_cvt_pk_bf16_f32 v73, v26, v27
    v_mfma_f32_16x16x32_bf16 v[16:19], a[8:11], v[40:43], 0
    v_cvt_pk_bf16_f32 v74, v28, v29
    v_cvt_pk_bf16_f32 v75, v30, v31
    v_mfma_f32_16x16x32_bf16 v[16:19], a[24:27], v[44:47], v[16:19]
    buffer_store_dwordx4 v[72:75], v1, s[12:15], s36 offen offset:0 sc1
    v_cvt_pk_bf16_f32 v76, v32, v33
    v_mfma_f32_16x16x32_bf16 v[20:23], a[28:31], v[44:47], 0
    v_cvt_pk_bf16_f32 v77, v34, v35
    v_cvt_pk_bf16_f32 v78, v36, v37
    v_mfma_f32_16x16x32_bf16 v[20:23], a[12:15], v[40:43], v[20:23]
    s_waitcnt lgkmcnt(0)
    v_cvt_pk_bf16_f32 v79, v38, v39
    v_add_u32 v3, s35, v1
    v_mfma_f32_16x16x32_bf16 v[20:23], a[44:47], v[48:51], v[20:23]
    ds_read_b128 v[56:59], v2 offset:4096
    v_mfma_f32_16x16x32_bf16 v[20:23], a[60:63], v[52:55], v[20:23]
    buffer_store_dwordx4 v[76:79], v1, s[12:15], s36 offen offset:1024 sc1
    s_add_u32 s36, s36, 131072
    v_mfma_f32_16x16x32_bf16 v[16:19], a[56:59], v[52:55], v[16:19]
    ds_read_b128 v[60:63], v2 offset:5120
    v_mfma_f32_16x16x32_bf16 v[16:19], a[40:43], v[48:51], v[16:19]
    v_mfma_f32_16x16x32_bf16 v[12:15], a[36:39], v[48:51], v[12:15]
    v_mfma_f32_16x16x32_bf16 v[12:15], a[52:55], v[52:55], v[12:15]
    v_mfma_f32_16x16x32_bf16 v[8:11], a[48:51], v[52:55], v[8:11]
    v_mfma_f32_16x16x32_bf16 v[8:11], a[32:35], v[48:51], v[8:11]
    s_waitcnt lgkmcnt(0)
    v_mfma_f32_16x16x32_bf16 v[8:11], a[64:67], v[56:59], v[8:11]
    ds_read_b128 v[64:67], v2 offset:6144
    v_mfma_f32_16x16x32_bf16 v[8:11], a[80:83], v[60:63], v[8:11]
    v_mfma_f32_16x16x32_bf16 v[12:15], a[84:87], v[60:63], v[12:15]
    ds_read_b128 v[68:71], v2 offset:7168
    v_mfma_f32_16x16x32_bf16 v[12:15], a[68:71], v[56:59], v[12:15]
    v_mfma_f32_16x16x32_bf16 v[16:19], a[72:75], v[56:59], v[16:19]
    v_mfma_f32_16x16x32_bf16 v[16:19], a[88:91], v[60:63], v[16:19]
    v_mfma_f32_16x16x32_bf16 v[20:23], a[92:95], v[60:63], v[20:23]
    v_mfma_f32_16x16x32_bf16 v[20:23], a[76:79], v[56:59], v[20:23]
    s_waitcnt lgkmcnt(0)
    v_mfma_f32_16x16x32_bf16 v[20:23], a[108:111], v[64:67], v[20:23]
    ds_read_b128 v[40:43], v2 offset:8192
    v_mfma_f32_16x16x32_bf16 v[20:23], a[124:127], v[68:71], v[20:23]
    v_mfma_f32_16x16x32_bf16 v[16:19], a[120:123], v[68:71], v[16:19]
    ds_read_b128 v[44:47], v2 offset:9216
    v_mfma_f32_16x16x32_bf16 v[16:19], a[104:107], v[64:67], v[16:19]
    v_mfma_f32_16x16x32_bf16 v[12:15], a[100:103], v[64:67], v[12:15]
    v_mfma_f32_16x16x32_bf16 v[12:15], a[116:119], v[68:71], v[12:15]
    v_mfma_f32_16x16x32_bf16 v[8:11], a[112:115], v[68:71], v[8:11]
    v_mfma_f32_16x16x32_bf16 v[8:11], a[96:99], v[64:67], v[8:11]
    s_waitcnt vmcnt(2) lgkmcnt(0)
    v_cmp_gt_i32 vcc, s32, v5
    v_mfma_f32_16x16x32_bf16 v[8:11], a[128:131], v[40:43], v[8:11]
    ds_read_b128 v[48:51], v2 offset:10240
    v_mfma_f32_16x16x32_bf16 v[8:11], a[144:147], v[44:47], v[8:11]
    s_and_b64 vcc, vcc, s[18:19]
    s_cbranch_scc1 Lffb_v01
    v_mfma_f32_16x16x32_bf16 v[12:15], a[148:151], v[44:47], v[12:15]
    ds_read_b128 v[52:55], v2 offset:11264
    v_mfma_f32_16x16x32_bf16 v[12:15], a[132:135], v[40:43], v[12:15]
    buffer_load_dwordx4 v1, s[8:11], s33 offen offset:0 sc1 lds
    v_mfma_f32_16x16x32_bf16 v[16:19], a[136:139], v[40:43], v[16:19]
    v_mfma_f32_16x16x32_bf16 v[16:19], a[152:155], v[44:47], v[16:19]
    v_mfma_f32_16x16x32_bf16 v[20:23], a[156:159], v[44:47], v[20:23]
    s_barrier
    v_mfma_f32_16x16x32_bf16 v[20:23], a[140:143], v[40:43], v[20:23]
    s_waitcnt lgkmcnt(0)
    buffer_load_dwordx4 v1, s[8:11], s33 offen offset:1024 sc1 lds
    v_mfma_f32_16x16x32_bf16 v[20:23], a[172:175], v[48:51], v[20:23]
    ds_read_b128 v[56:59], v2 offset:12288
    v_mfma_f32_16x16x32_bf16 v[20:23], a[188:191], v[52:55], v[20:23]
    v_mfma_f32_16x16x32_bf16 v[16:19], a[184:187], v[52:55], v[16:19]
    ds_read_b128 v[60:63], v2 offset:13312
    v_mfma_f32_16x16x32_bf16 v[16:19], a[168:171], v[48:51], v[16:19]
    buffer_load_dwordx4 v1, s[8:11], s33 offen offset:2048 sc1 lds
    v_mfma_f32_16x16x32_bf16 v[12:15], a[164:167], v[48:51], v[12:15]
    s_add_u32 s16, s16, 8192
    s_add_u32 m0, s34, s3
    s_add_u32 s37, s33, s3
    v_mfma_f32_16x16x32_bf16 v[12:15], a[180:183], v[52:55], v[12:15]
    v_mfma_f32_16x16x32_bf16 v[8:11], a[176:179], v[52:55], v[8:11]
    v_mfma_f32_16x16x32_bf16 v[8:11], a[160:163], v[48:51], v[8:11]
    s_waitcnt lgkmcnt(0)
    buffer_load_dwordx4 v1, s[8:11], s37 offen offset:0 sc1 lds
    v_mfma_f32_16x16x32_bf16 v[8:11], a[192:195], v[56:59], v[8:11]
    ds_read_b128 v[64:67], v2 offset:14336
    v_mfma_f32_16x16x32_bf16 v[8:11], a[208:211], v[60:63], v[8:11]
    v_mfma_f32_16x16x32_bf16 v[12:15], a[212:215], v[60:63], v[12:15]
    ds_read_b128 v[68:71], v2 offset:15360
    v_mfma_f32_16x16x32_bf16 v[12:15], a[196:199], v[56:59], v[12:15]
    s_waitcnt vmcnt(4)
    buffer_store_dword v6, v80, s[12:15], s17 offen sc1
    v_mfma_f32_16x16x32_bf16 v[16:19], a[200:203], v[56:59], v[16:19]
    buffer_load_dwordx4 v1, s[8:11], s37 offen offset:1024 sc1 lds
    v_mfma_f32_16x16x32_bf16 v[16:19], a[216:219], v[60:63], v[16:19]
    s_mov_b32 s14, s6
    s_add_u32 s17, s17, 8192
    v_mfma_f32_16x16x32_bf16 v[20:23], a[220:223], v[60:63], v[20:23]
    v_mfma_f32_16x16x32_bf16 v[20:23], a[204:207], v[56:59], v[20:23]
    s_waitcnt lgkmcnt(0)
    v_mfma_f32_16x16x32_bf16 v[20:23], a[236:239], v[64:67], v[20:23]
    ds_read_b128 v[40:43], v2 offset:16384
    v_mfma_f32_16x16x32_bf16 v[20:23], a[252:255], v[68:71], v[20:23]
    buffer_load_dwordx4 v1, s[8:11], s37 offen offset:2048 sc1 lds
    v_mfma_f32_16x16x32_bf16 v[16:19], a[248:251], v[68:71], v[16:19]
    ds_read_b128 v[44:47], v2 offset:17408
    s_add_u32 s32, s32, 1
    v_mfma_f32_16x16x32_bf16 v[16:19], a[232:235], v[64:67], v[16:19]
    s_add_u32 s33, s33, 116736
    s_add_u32 s34, s34, 36864
    v_mfma_f32_16x16x32_bf16 v[12:15], a[228:231], v[64:67], v[12:15]
    s_cmp_ge_u32 s34, 147456
    s_cselect_b32 s38, 147456, 0
    s_sub_u32 s34, s34, s38
    v_mfma_f32_16x16x32_bf16 v[12:15], a[244:247], v[68:71], v[12:15]
    v_mfma_f32_16x16x32_bf16 v[8:11], a[240:243], v[68:71], v[8:11]
    v_mfma_f32_16x16x32_bf16 v[8:11], a[224:227], v[64:67], v[8:11]
    s_waitcnt lgkmcnt(0)
    v_mfma_f32_16x16x32_bf16 v[8:11], v[128:131], v[40:43], v[8:11]
    ds_read_b128 v[48:51], v2 offset:18432
    v_mfma_f32_16x16x32_bf16 v[8:11], v[144:147], v[44:47], v[8:11]
    v_mfma_f32_16x16x32_bf16 v[12:15], v[148:151], v[44:47], v[12:15]
    ds_read_b128 v[52:55], v2 offset:19456
    v_mfma_f32_16x16x32_bf16 v[12:15], v[132:135], v[40:43], v[12:15]
    v_mfma_f32_16x16x32_bf16 v[16:19], v[136:139], v[40:43], v[16:19]
    v_mfma_f32_16x16x32_bf16 v[16:19], v[152:155], v[44:47], v[16:19]
    v_mfma_f32_16x16x32_bf16 v[20:23], v[156:159], v[44:47], v[20:23]
    v_mfma_f32_16x16x32_bf16 v[20:23], v[140:143], v[40:43], v[20:23]
    s_waitcnt lgkmcnt(0)
    v_mfma_f32_16x16x32_bf16 v[20:23], v[172:175], v[48:51], v[20:23]
    ds_read_b128 v[56:59], v2 offset:20480
    v_mfma_f32_16x16x32_bf16 v[20:23], v[188:191], v[52:55], v[20:23]
    v_mfma_f32_16x16x32_bf16 v[16:19], v[184:187], v[52:55], v[16:19]
    ds_read_b128 v[60:63], v2 offset:21504
    v_mfma_f32_16x16x32_bf16 v[16:19], v[168:171], v[48:51], v[16:19]
    v_mfma_f32_16x16x32_bf16 v[12:15], v[164:167], v[48:51], v[12:15]
    v_mfma_f32_16x16x32_bf16 v[12:15], v[180:183], v[52:55], v[12:15]
    v_mfma_f32_16x16x32_bf16 v[8:11], v[176:179], v[52:55], v[8:11]
    v_mfma_f32_16x16x32_bf16 v[8:11], v[160:163], v[48:51], v[8:11]
    s_waitcnt lgkmcnt(0)
    v_mfma_f32_16x16x32_bf16 v[8:11], v[192:195], v[56:59], v[8:11]
    ds_read_b128 v[64:67], v2 offset:22528
    v_mfma_f32_16x16x32_bf16 v[8:11], v[208:211], v[60:63], v[8:11]
    v_mfma_f32_16x16x32_bf16 v[12:15], v[212:215], v[60:63], v[12:15]
    ds_read_b128 v[68:71], v2 offset:23552
    v_mfma_f32_16x16x32_bf16 v[12:15], v[196:199], v[56:59], v[12:15]
    v_mfma_f32_16x16x32_bf16 v[16:19], v[200:203], v[56:59], v[16:19]
    s_waitcnt vmcnt(4)
    v_mfma_f32_16x16x32_bf16 v[16:19], v[216:219], v[60:63], v[16:19]
    v_mfma_f32_16x16x32_bf16 v[20:23], v[220:223], v[60:63], v[20:23]
    s_barrier
    v_mfma_f32_16x16x32_bf16 v[20:23], v[204:207], v[56:59], v[20:23]
    s_waitcnt lgkmcnt(0)
    v_mfma_f32_16x16x32_bf16 v[20:23], v[236:239], v[64:67], v[20:23]
    ds_read_b128 v[40:43], v3 offset:0
    v_mfma_f32_16x16x32_bf16 v[20:23], v[252:255], v[68:71], v[20:23]
    buffer_load_dword v5, v4, s[4:7], s16 offen sc1
    v_mfma_f32_16x16x32_bf16 v[16:19], v[248:251], v[68:71], v[16:19]
    ds_read_b128 v[44:47], v3 offset:1024
    v_mfma_f32_16x16x32_bf16 v[16:19], v[232:235], v[64:67], v[16:19]
    v_mfma_f32_16x16x32_bf16 v[12:15], v[228:231], v[64:67], v[12:15]
    v_mfma_f32_16x16x32_bf16 v[12:15], v[244:247], v[68:71], v[12:15]
    v_mfma_f32_16x16x32_bf16 v[8:11], v[240:243], v[68:71], v[8:11]
    v_mfma_f32_16x16x32_bf16 v[8:11], v[224:227], v[64:67], v[8:11]
Lffb_body12:
    s_waitcnt lgkmcnt(0)
    v_mfma_f32_16x16x32_bf16 v[24:27], a[0:3], v[40:43], 0
    ds_read_b128 v[48:51], v3 offset:2048
    s_add_u32 m0, s34, 0
    v_mfma_f32_16x16x32_bf16 v[24:27], a[16:19], v[44:47], v[24:27]
    s_add_u32 s31, s31, 1
    v_mov_b32 v6, s31
    s_add_u32 s35, s35, 36864
    v_mfma_f32_16x16x32_bf16 v[28:31], a[20:23], v[44:47], 0
    ds_read_b128 v[52:55], v3 offset:3072
    v_cvt_pk_bf16_f32 v72, v8, v9
    v_mfma_f32_16x16x32_bf16 v[28:31], a[4:7], v[40:43], v[28:31]
    s_cmp_eq_u32 s35, 147456
    s_cselect_b32 s35, 0, s35
    v_cvt_pk_bf16_f32 v73, v10, v11
    v_mfma_f32_16x16x32_bf16 v[32:35], a[8:11], v[40:43], 0
    v_cvt_pk_bf16_f32 v74, v12, v13
    v_cvt_pk_bf16_f32 v75, v14, v15
    v_mfma_f32_16x16x32_bf16 v[32:35], a[24:27], v[44:47], v[32:35]
    buffer_store_dwordx4 v[72:75], v1, s[12:15], s36 offen offset:0 sc1
    v_cvt_pk_bf16_f32 v76, v16, v17
    v_mfma_f32_16x16x32_bf16 v[36:39], a[28:31], v[44:47], 0
    v_cvt_pk_bf16_f32 v77, v18, v19
    v_cvt_pk_bf16_f32 v78, v20, v21
    v_mfma_f32_16x16x32_bf16 v[36:39], a[12:15], v[40:43], v[36:39]
    s_waitcnt lgkmcnt(0)
    v_cvt_pk_bf16_f32 v79, v22, v23
    v_add_u32 v2, s35, v1
    v_mfma_f32_16x16x32_bf16 v[36:39], a[44:47], v[48:51], v[36:39]
    ds_read_b128 v[56:59], v3 offset:4096
    v_mfma_f32_16x16x32_bf16 v[36:39], a[60:63], v[52:55], v[36:39]
    buffer_store_dwordx4 v[76:79], v1, s[12:15], s36 offen offset:1024 sc1
    s_add_u32 s36, s36, 131072
    v_mfma_f32_16x16x32_bf16 v[32:35], a[56:59], v[52:55], v[32:35]
    ds_read_b128 v[60:63], v3 offset:5120
    v_mfma_f32_16x16x32_bf16 v[32:35], a[40:43], v[48:51], v[32:35]
    v_mfma_f32_16x16x32_bf16 v[28:31], a[36:39], v[48:51], v[28:31]
    v_mfma_f32_16x16x32_bf16 v[28:31], a[52:55], v[52:55], v[28:31]
    v_mfma_f32_16x16x32_bf16 v[24:27], a[48:51], v[52:55], v[24:27]
    v_mfma_f32_16x16x32_bf16 v[24:27], a[32:35], v[48:51], v[24:27]
    s_waitcnt lgkmcnt(0)
    v_mfma_f32_16x16x32_bf16 v[24:27], a[64:67], v[56:59], v[24:27]
    ds_read_b128 v[64:67], v3 offset:6144
    v_mfma_f32_16x16x32_bf16 v[24:27], a[80:83], v[60:63], v[24:27]
    v_mfma_f32_16x16x32_bf16 v[28:31], a[84:87], v[60:63], v[28:31]
    ds_read_b128 v[68:71], v3 offset:7168
    v_mfma_f32_16x16x32_bf16 v[28:31], a[68:71], v[56:59], v[28:31]
    v_mfma_f32_16x16x32_bf16 v[32:35], a[72:75], v[56:59], v[32:35]
    v_mfma_f32_16x16x32_bf16 v[32:35], a[88:91], v[60:63], v[32:35]
    v_mfma_f32_16x16x32_bf16 v[36:39], a[92:95], v[60:63], v[36:39]
    v_mfma_f32_16x16x32_bf16 v[36:39], a[76:79], v[56:59], v[36:39]
    s_waitcnt lgkmcnt(0)
    v_mfma_f32_16x16x32_bf16 v[36:39], a[108:111], v[64:67], v[36:39]
    ds_read_b128 v[40:43], v3 offset:8192
    v_mfma_f32_16x16x32_bf16 v[36:39], a[124:127], v[68:71], v[36:39]
    v_mfma_f32_16x16x32_bf16 v[32:35], a[120:123], v[68:71], v[32:35]
    ds_read_b128 v[44:47], v3 offset:9216
    v_mfma_f32_16x16x32_bf16 v[32:35], a[104:107], v[64:67], v[32:35]
    v_mfma_f32_16x16x32_bf16 v[28:31], a[100:103], v[64:67], v[28:31]
    v_mfma_f32_16x16x32_bf16 v[28:31], a[116:119], v[68:71], v[28:31]
    v_mfma_f32_16x16x32_bf16 v[24:27], a[112:115], v[68:71], v[24:27]
    v_mfma_f32_16x16x32_bf16 v[24:27], a[96:99], v[64:67], v[24:27]
    s_waitcnt vmcnt(2) lgkmcnt(0)
    v_cmp_gt_i32 vcc, s32, v5
    v_mfma_f32_16x16x32_bf16 v[24:27], a[128:131], v[40:43], v[24:27]
    ds_read_b128 v[48:51], v3 offset:10240
    v_mfma_f32_16x16x32_bf16 v[24:27], a[144:147], v[44:47], v[24:27]
    s_and_b64 vcc, vcc, s[18:19]
    s_cbranch_scc1 Lffb_v11
    v_mfma_f32_16x16x32_bf16 v[28:31], a[148:151], v[44:47], v[28:31]
    ds_read_b128 v[52:55], v3 offset:11264
    v_mfma_f32_16x16x32_bf16 v[28:31], a[132:135], v[40:43], v[28:31]
    buffer_load_dwordx4 v1, s[8:11], s33 offen offset:0 sc1 lds
    v_mfma_f32_16x16x32_bf16 v[32:35], a[136:139], v[40:43], v[32:35]
    v_mfma_f32_16x16x32_bf16 v[32:35], a[152:155], v[44:47], v[32:35]
    v_mfma_f32_16x16x32_bf16 v[36:39], a[156:159], v[44:47], v[36:39]
    s_barrier
    v_mfma_f32_16x16x32_bf16 v[36:39], a[140:143], v[40:43], v[36:39]
    s_waitcnt lgkmcnt(0)
    buffer_load_dwordx4 v1, s[8:11], s33 offen offset:1024 sc1 lds
    v_mfma_f32_16x16x32_bf16 v[36:39], a[172:175], v[48:51], v[36:39]
    ds_read_b128 v[56:59], v3 offset:12288
    v_mfma_f32_16x16x32_bf16 v[36:39], a[188:191], v[52:55], v[36:39]
    v_mfma_f32_16x16x32_bf16 v[32:35], a[184:187], v[52:55], v[32:35]
    ds_read_b128 v[60:63], v3 offset:13312
    v_mfma_f32_16x16x32_bf16 v[32:35], a[168:171], v[48:51], v[32:35]
    buffer_load_dwordx4 v1, s[8:11], s33 offen offset:2048 sc1 lds
    v_mfma_f32_16x16x32_bf16 v[28:31], a[164:167], v[48:51], v[28:31]
    s_add_u32 s16, s16, 8192
    s_add_u32 m0, s34, s3
    s_add_u32 s37, s33, s3
    v_mfma_f32_16x16x32_bf16 v[28:31], a[180:183], v[52:55], v[28:31]
    v_mfma_f32_16x16x32_bf16 v[24:27], a[176:179], v[52:55], v[24:27]
    v_mfma_f32_16x16x32_bf16 v[24:27], a[160:163], v[48:51], v[24:27]
    s_waitcnt lgkmcnt(0)
    buffer_load_dwordx4 v1, s[8:11], s37 offen offset:0 sc1 lds
    v_mfma_f32_16x16x32_bf16 v[24:27], a[192:195], v[56:59], v[24:27]
    ds_read_b128 v[64:67], v3 offset:14336
    v_mfma_f32_16x16x32_bf16 v[24:27], a[208:211], v[60:63], v[24:27]
    v_mfma_f32_16x16x32_bf16 v[28:31], a[212:215], v[60:63], v[28:31]
    ds_read_b128 v[68:71], v3 offset:15360
    v_mfma_f32_16x16x32_bf16 v[28:31], a[196:199], v[56:59], v[28:31]
    s_waitcnt vmcnt(4)
    buffer_store_dword v6, v80, s[12:15], s17 offen sc1
    v_mfma_f32_16x16x32_bf16 v[32:35], a[200:203], v[56:59], v[32:35]
    buffer_load_dwordx4 v1, s[8:11], s37 offen offset:1024 sc1 lds
    v_mfma_f32_16x16x32_bf16 v[32:35], a[216:219], v[60:63], v[32:35]
    s_mov_b32 s14, s6
    s_add_u32 s17, s17, 8192
    v_mfma_f32_16x16x32_bf16 v[36:39], a[220:223], v[60:63], v[36:39]
    v_mfma_f32_16x16x32_bf16 v[36:39], a[204:207], v[56:59], v[36:39]
    s_waitcnt lgkmcnt(0)
    v_mfma_f32_16x16x32_bf16 v[36:39], a[236:239], v[64:67], v[36:39]
    ds_read_b128 v[40:43], v3 offset:16384
    v_mfma_f32_16x16x32_bf16 v[36:39], a[252:255], v[68:71], v[36:39]
    buffer_load_dwordx4 v1, s[8:11], s37 offen offset:2048 sc1 lds
    v_mfma_f32_16x16x32_bf16 v[32:35], a[248:251], v[68:71], v[32:35]
    ds_read_b128 v[44:47], v3 offset:17408
    s_add_u32 s32, s32, 1
    v_mfma_f32_16x16x32_bf16 v[32:35], a[232:235], v[64:67], v[32:35]
    s_add_u32 s33, s33, 116736
    s_add_u32 s34, s34, 36864
    v_mfma_f32_16x16x32_bf16 v[28:31], a[228:231], v[64:67], v[28:31]
    s_cmp_ge_u32 s34, 147456
    s_cselect_b32 s38, 147456, 0
    s_sub_u32 s34, s34, s38
    v_mfma_f32_16x16x32_bf16 v[28:31], a[244:247], v[68:71], v[28:31]
    v_mfma_f32_16x16x32_bf16 v[24:27], a[240:243], v[68:71], v[24:27]
    v_mfma_f32_16x16x32_bf16 v[24:27], a[224:227], v[64:67], v[24:27]
    s_waitcnt lgkmcnt(0)
    v_mfma_f32_16x16x32_bf16 v[24:27], v[128:131], v[40:43], v[24:27]
    ds_read_b128 v[48:51], v3 offset:18432
    v_mfma_f32_16x16x32_bf16 v[24:27], v[144:147], v[44:47], v[24:27]
    v_mfma_f32_16x16x32_bf16 v[28:31], v[148:151], v[44:47], v[28:31]
    ds_read_b128 v[52:55], v3 offset:19456
    v_mfma_f32_16x16x32_bf16 v[28:31], v[132:135], v[40:43], v[28:31]
    v_mfma_f32_16x16x32_bf16 v[32:35], v[136:139], v[40:43], v[32:35]
    v_mfma_f32_16x16x32_bf16 v[32:35], v[152:155], v[44:47], v[32:35]
    v_mfma_f32_16x16x32_bf16 v[36:39], v[156:159], v[44:47], v[36:39]
    v_mfma_f32_16x16x32_bf16 v[36:39], v[140:143], v[40:43], v[36:39]
    s_waitcnt lgkmcnt(0)
    v_mfma_f32_16x16x32_bf16 v[36:39], v[172:175], v[48:51], v[36:39]
    ds_read_b128 v[56:59], v3 offset:20480
    v_mfma_f32_16x16x32_bf16 v[36:39], v[188:191], v[52:55], v[36:39]
    v_mfma_f32_16x16x32_bf16 v[32:35], v[184:187], v[52:55], v[32:35]
    ds_read_b128 v[60:63], v3 offset:21504
    v_mfma_f32_16x16x32_bf16 v[32:35], v[168:171], v[48:51], v[32:35]
    v_mfma_f32_16x16x32_bf16 v[28:31], v[164:167], v[48:51], v[28:31]
    v_mfma_f32_16x16x32_bf16 v[28:31], v[180:183], v[52:55], v[28:31]
    v_mfma_f32_16x16x32_bf16 v[24:27], v[176:179], v[52:55], v[24:27]
    v_mfma_f32_16x16x32_bf16 v[24:27], v[160:163], v[48:51], v[24:27]
    s_waitcnt lgkmcnt(0)
    v_mfma_f32_16x16x32_bf16 v[24:27], v[192:195], v[56:59], v[24:27]
    ds_read_b128 v[64:67], v3 offset:22528
    v_mfma_f32_16x16x32_bf16 v[24:27], v[208:211], v[60:63], v[24:27]
    v_mfma_f32_16x16x32_bf16 v[28:31], v[212:215], v[60:63], v[28:31]
    ds_read_b128 v[68:71], v3 offset:23552
    v_mfma_f32_16x16x32_bf16 v[28:31], v[196:199], v[56:59], v[28:31]
    v_mfma_f32_16x16x32_bf16 v[32:35], v[200:203], v[56:59], v[32:35]
    s_waitcnt vmcnt(4)
    v_mfma_f32_16x16x32_bf16 v[32:35], v[216:219], v[60:63], v[32:35]
    v_mfma_f32_16x16x32_bf16 v[36:39], v[220:223], v[60:63], v[36:39]
    s_barrier
    v_mfma_f32_16x16x32_bf16 v[36:39], v[204:207], v[56:59], v[36:39]
    s_waitcnt lgkmcnt(0)
    v_mfma_f32_16x16x32_bf16 v[36:39], v[236:239], v[64:67], v[36:39]
    ds_read_b128 v[40:43], v2 offset:0
    v_mfma_f32_16x16x32_bf16 v[36:39], v[252:255], v[68:71], v[36:39]
    buffer_load_dword v5, v4, s[4:7], s16 offen sc1
    v_mfma_f32_16x16x32_bf16 v[32:35], v[248:251], v[68:71], v[32:35]
    ds_read_b128 v[44:47], v2 offset:1024
    v_mfma_f32_16x16x32_bf16 v[32:35], v[232:235], v[64:67], v[32:35]
    v_mfma_f32_16x16x32_bf16 v[28:31], v[228:231], v[64:67], v[28:31]
    v_mfma_f32_16x16x32_bf16 v[28:31], v[244:247], v[68:71], v[28:31]
    v_mfma_f32_16x16x32_bf16 v[24:27], v[240:243], v[68:71], v[24:27]
    v_mfma_f32_16x16x32_bf16 v[24:27], v[224:227], v[64:67], v[24:27]
    s_cmp_lt_i32 s31, 63
    s_cbranch_scc1 Lffb_body02
    s_branch L_exit
    .p2align 6
Lffb_body03:
    s_waitcnt lgkmcnt(0)
    v_mfma_f32_16x16x32_bf16 v[8:11], a[0:3], v[40:43], 0
    ds_read_b128 v[48:51], v2 offset:2048
    s_add_u32 m0, s34, 0
    v_mfma_f32_16x16x32_bf16 v[8:11], a[16:19], v[44:47], v[8:11]
    s_add_u32 s31, s31, 1
    v_mov_b32 v6, s31
    s_add_u32 s35, s35, 36864
    v_mfma_f32_16x16x32_bf16 v[12:15], a[20:23], v[44:47], 0
    ds_read_b128 v[52:55], v2 offset:3072
    v_cvt_pk_bf16_f32 v72, v24, v25
    v_mfma_f32_16x16x32_bf16 v[12:15], a[4:7], v[40:43], v[12:15]
    s_cmp_eq_u32 s35, 147456
    s_cselect_b32 s35, 0, s35
    v_cvt_pk_bf16_f32 v73, v26, v27
    v_mfma_f32_16x16x32_bf16 v[16:19], a[8:11], v[40:43], 0
    v_cvt_pk_bf16_f32 v74, v28, v29
    v_cvt_pk_bf16_f32 v75, v30, v31
    v_mfma_f32_16x16x32_bf16 v[16:19], a[24:27], v[44:47], v[16:19]
    buffer_store_dwordx4 v[72:75], v1, s[12:15], s36 offen offset:0 sc1
    v_cvt_pk_bf16_f32 v76, v32, v33
    v_mfma_f32_16x16x32_bf16 v[20:23], a[28:31], v[44:47], 0
    v_cvt_pk_bf16_f32 v77, v34, v35
    v_cvt_pk_bf16_f32 v78, v36, v37
    v_mfma_f32_16x16x32_bf16 v[20:23], a[12:15], v[40:43], v[20:23]
    s_waitcnt lgkmcnt(0)
    v_cvt_pk_bf16_f32 v79, v38, v39
    v_add_u32 v3, s35, v1
    v_mfma_f32_16x16x32_bf16 v[20:23], a[44:47], v[48:51], v[20:23]
    ds_read_b128 v[56:59], v2 offset:4096
    v_mfma_f32_16x16x32_bf16 v[20:23], a[60:63], v[52:55], v[20:23]
    buffer_store_dwordx4 v[76:79], v1, s[12:15], s36 offen offset:1024 sc1
    s_add_u32 s36, s36, 131072
    v_mfma_f32_16x16x32_bf16 v[16:19], a[56:59], v[52:55], v[16:19]
    ds_read_b128 v[60:63], v2 offset:5120
    v_mfma_f32_16x16x32_bf16 v[16:19], a[40:43], v[48:51], v[16:19]
    v_mfma_f32_16x16x32_bf16 v[12:15], a[36:39], v[48:51], v[12:15]
    v_mfma_f32_16x16x32_bf16 v[12:15], a[52:55], v[52:55], v[12:15]
    v_mfma_f32_16x16x32_bf16 v[8:11], a[48:51], v[52:55], v[8:11]
    v_mfma_f32_16x16x32_bf16 v[8:11], a[32:35], v[48:51], v[8:11]
    s_waitcnt lgkmcnt(0)
    v_mfma_f32_16x16x32_bf16 v[8:11], a[64:67], v[56:59], v[8:11]
    ds_read_b128 v[64:67], v2 offset:6144
    v_mfma_f32_16x16x32_bf16 v[8:11], a[80:83], v[60:63], v[8:11]
    v_mfma_f32_16x16x32_bf16 v[12:15], a[84:87], v[60:63], v[12:15]
    ds_read_b128 v[68:71], v2 offset:7168
    v_mfma_f32_16x16x32_bf16 v[12:15], a[68:71], v[56:59], v[12:15]
    v_mfma_f32_16x16x32_bf16 v[16:19], a[72:75], v[56:59], v[16:19]
    v_mfma_f32_16x16x32_bf16 v[16:19], a[88:91], v[60:63], v[16:19]
    v_mfma_f32_16x16x32_bf16 v[20:23], a[92:95], v[60:63], v[20:23]
    v_mfma_f32_16x16x32_bf16 v[20:23], a[76:79], v[56:59], v[20:23]
    s_waitcnt lgkmcnt(0)
    v_mfma_f32_16x16x32_bf16 v[20:23], a[108:111], v[64:67], v[20:23]
    ds_read_b128 v[40:43], v2 offset:8192
    v_mfma_f32_16x16x32_bf16 v[20:23], a[124:127], v[68:71], v[20:23]
    v_mfma_f32_16x16x32_bf16 v[16:19], a[120:123], v[68:71], v[16:19]
    ds_read_b128 v[44:47], v2 offset:9216
    v_mfma_f32_16x16x32_bf16 v[16:19], a[104:107], v[64:67], v[16:19]
    v_mfma_f32_16x16x32_bf16 v[12:15], a[100:103], v[64:67], v[12:15]
    v_mfma_f32_16x16x32_bf16 v[12:15], a[116:119], v[68:71], v[12:15]
    v_mfma_f32_16x16x32_bf16 v[8:11], a[112:115], v[68:71], v[8:11]
    v_mfma_f32_16x16x32_bf16 v[8:11], a[96:99], v[64:67], v[8:11]
    s_waitcnt vmcnt(2) lgkmcnt(0)
    v_cmp_gt_i32 vcc, s32, v5
    v_mfma_f32_16x16x32_bf16 v[8:11], a[128:131], v[40:43], v[8:11]
    ds_read_b128 v[48:51], v2 offset:10240
    v_mfma_f32_16x16x32_bf16 v[8:11], a[144:147], v[44:47], v[8:11]
    s_and_b64 vcc, vcc, s[18:19]
    s_cbranch_scc1 Lffb_v01
    v_mfma_f32_16x16x32_bf16 v[12:15], a[148:151], v[44:47], v[12:15]
    ds_read_b128 v[52:55], v2 offset:11264
    v_mfma_f32_16x16x32_bf16 v[12:15], a[132:135], v[40:43], v[12:15]
    buffer_load_dwordx4 v1, s[8:11], s33 offen offset:0 sc1 lds
    v_mfma_f32_16x16x32_bf16 v[16:19], a[136:139], v[40:43], v[16:19]
    v_mfma_f32_16x16x32_bf16 v[16:19], a[152:155], v[44:47], v[16:19]
    v_mfma_f32_16x16x32_bf16 v[20:23], a[156:159], v[44:47], v[20:23]
    v_mfma_f32_16x16x32_bf16 v[20:23], a[140:143], v[40:43], v[20:23]
    s_waitcnt lgkmcnt(0)
    s_barrier
    v_mfma_f32_16x16x32_bf16 v[20:23], a[172:175], v[48:51], v[20:23]
    ds_read_b128 v[56:59], v2 offset:12288
    v_mfma_f32_16x16x32_bf16 v[20:23], a[188:191], v[52:55], v[20:23]
    buffer_load_dwordx4 v1, s[8:11], s33 offen offset:1024 sc1 lds
    v_mfma_f32_16x16x32_bf16 v[16:19], a[184:187], v[52:55], v[16:19]
    ds_read_b128 v[60:63], v2 offset:13312
    v_mfma_f32_16x16x32_bf16 v[16:19], a[168:171], v[48:51], v[16:19]
    v_mfma_f32_16x16x32_bf16 v[12:15], a[164:167], v[48:51], v[12:15]
    v_mfma_f32_16x16x32_bf16 v[12:15], a[180:183], v[52:55], v[12:15]
    buffer_load_dwordx4 v1, s[8:11], s33 offen offset:2048 sc1 lds
    v_mfma_f32_16x16x32_bf16 v[8:11], a[176:179], v[52:55], v[8:11]
    s_add_u32 s16, s16, 8192
    s_add_u32 m0, s34, s3
    s_add_u32 s37, s33, s3
    v_mfma_f32_16x16x32_bf16 v[8:11], a[160:163], v[48:51], v[8:11]
    s_waitcnt lgkmcnt(0)
    v_mfma_f32_16x16x32_bf16 v[8:11], a[192:195], v[56:59], v[8:11]
    ds_read_b128 v[64:67], v2 offset:14336
    v_mfma_f32_16x16x32_bf16 v[8:11], a[208:211], v[60:63], v[8:11]
    buffer_load_dwordx4 v1, s[8:11], s37 offen offset:0 sc1 lds
    v_mfma_f32_16x16x32_bf16 v[12:15], a[212:215], v[60:63], v[12:15]
    ds_read_b128 v[68:71], v2 offset:15360
    v_mfma_f32_16x16x32_bf16 v[12:15], a[196:199], v[56:59], v[12:15]
    s_waitcnt vmcnt(4)
    buffer_store_dword v6, v80, s[12:15], s17 offen sc1
    v_mfma_f32_16x16x32_bf16 v[16:19], a[200:203], v[56:59], v[16:19]
    s_mov_b32 s14, s6
    s_add_u32 s17, s17, 8192
    v_mfma_f32_16x16x32_bf16 v[16:19], a[216:219], v[60:63], v[16:19]
    buffer_load_dwordx4 v1, s[8:11], s37 offen offset:1024 sc1 lds
    v_mfma_f32_16x16x32_bf16 v[20:23], a[220:223], v[60:63], v[20:23]
    v_mfma_f32_16x16x32_bf16 v[20:23], a[204:207], v[56:59], v[20:23]
    s_waitcnt lgkmcnt(0)
    v_mfma_f32_16x16x32_bf16 v[20:23], a[236:239], v[64:67], v[20:23]
    ds_read_b128 v[40:43], v2 offset:16384
    v_mfma_f32_16x16x32_bf16 v[20:23], a[252:255], v[68:71], v[20:23]
    buffer_load_dwordx4 v1, s[8:11], s37 offen offset:2048 sc1 lds
    v_mfma_f32_16x16x32_bf16 v[16:19], a[248:251], v[68:71], v[16:19]
    ds_read_b128 v[44:47], v2 offset:17408
    s_add_u32 s32, s32, 1
    v_mfma_f32_16x16x32_bf16 v[16:19], a[232:235], v[64:67], v[16:19]
    s_add_u32 s33, s33, 116736
    s_add_u32 s34, s34, 36864
    v_mfma_f32_16x16x32_bf16 v[12:15], a[228:231], v[64:67], v[12:15]
    s_cmp_ge_u32 s34, 147456
    s_cselect_b32 s38, 147456, 0
    s_sub_u32 s34, s34, s38
    v_mfma_f32_16x16x32_bf16 v[12:15], a[244:247], v[68:71], v[12:15]
    v_mfma_f32_16x16x32_bf16 v[8:11], a[240:243], v[68:71], v[8:11]
    v_mfma_f32_16x16x32_bf16 v[8:11], a[224:227], v[64:67], v[8:11]
    s_waitcnt lgkmcnt(0)
    v_mfma_f32_16x16x32_bf16 v[8:11], v[128:131], v[40:43], v[8:11]
    ds_read_b128 v[48:51], v2 offset:18432
    v_mfma_f32_16x16x32_bf16 v[8:11], v[144:147], v[44:47], v[8:11]
    v_mfma_f32_16x16x32_bf16 v[12:15], v[148:151], v[44:47], v[12:15]
    ds_read_b128 v[52:55], v2 offset:19456
    v_mfma_f32_16x16x32_bf16 v[12:15], v[132:135], v[40:43], v[12:15]
    v_mfma_f32_16x16x32_bf16 v[16:19], v[136:139], v[40:43], v[16:19]
    v_mfma_f32_16x16x32_bf16 v[16:19], v[152:155], v[44:47], v[16:19]
    v_mfma_f32_16x16x32_bf16 v[20:23], v[156:159], v[44:47], v[20:23]
    v_mfma_f32_16x16x32_bf16 v[20:23], v[140:143], v[40:43], v[20:23]
    s_waitcnt lgkmcnt(0)
    v_mfma_f32_16x16x32_bf16 v[20:23], v[172:175], v[48:51], v[20:23]
    ds_read_b128 v[56:59], v2 offset:20480
    v_mfma_f32_16x16x32_bf16 v[20:23], v[188:191], v[52:55], v[20:23]
    v_mfma_f32_16x16x32_bf16 v[16:19], v[184:187], v[52:55], v[16:19]
    ds_read_b128 v[60:63], v2 offset:21504
    v_mfma_f32_16x16x32_bf16 v[16:19], v[168:171], v[48:51], v[16:19]
    v_mfma_f32_16x16x32_bf16 v[12:15], v[164:167], v[48:51], v[12:15]
    v_mfma_f32_16x16x32_bf16 v[12:15], v[180:183], v[52:55], v[12:15]
    v_mfma_f32_16x16x32_bf16 v[8:11], v[176:179], v[52:55], v[8:11]
    v_mfma_f32_16x16x32_bf16 v[8:11], v[160:163], v[48:51], v[8:11]
    s_waitcnt lgkmcnt(0)
    v_mfma_f32_16x16x32_bf16 v[8:11], v[192:195], v[56:59], v[8:11]
    ds_read_b128 v[64:67], v2 offset:22528
    v_mfma_f32_16x16x32_bf16 v[8:11], v[208:211], v[60:63], v[8:11]
    v_mfma_f32_16x16x32_bf16 v[12:15], v[212:215], v[60:63], v[12:15]
    ds_read_b128 v[68:71], v2 offset:23552
    v_mfma_f32_16x16x32_bf16 v[12:15], v[196:199], v[56:59], v[12:15]
    v_mfma_f32_16x16x32_bf16 v[16:19], v[200:203], v[56:59], v[16:19]
    s_waitcnt vmcnt(4)
    v_mfma_f32_16x16x32_bf16 v[16:19], v[216:219], v[60:63], v[16:19]
    v_mfma_f32_16x16x32_bf16 v[20:23], v[220:223], v[60:63], v[20:23]
    v_mfma_f32_16x16x32_bf16 v[20:23], v[204:207], v[56:59], v[20:23]
    s_waitcnt lgkmcnt(0)
    s_barrier
    v_mfma_f32_16x16x32_bf16 v[20:23], v[236:239], v[64:67], v[20:23]
    ds_read_b128 v[40:43], v3 offset:0
    v_mfma_f32_16x16x32_bf16 v[20:23], v[252:255], v[68:71], v[20:23]
    buffer_load_dword v5, v4, s[4:7], s16 offen sc1
    v_mfma_f32_16x16x32_bf16 v[16:19], v[248:251], v[68:71], v[16:19]
    ds_read_b128 v[44:47], v3 offset:1024
    v_mfma_f32_16x16x32_bf16 v[16:19], v[232:235], v[64:67], v[16:19]
    v_mfma_f32_16x16x32_bf16 v[12:15], v[228:231], v[64:67], v[12:15]
    v_mfma_f32_16x16x32_bf16 v[12:15], v[244:247], v[68:71], v[12:15]
    v_mfma_f32_16x16x32_bf16 v[8:11], v[240:243], v[68:71], v[8:11]
    v_mfma_f32_16x16x32_bf16 v[8:11], v[224:227], v[64:67], v[8:11]
Lffb_body13:
    s_waitcnt lgkmcnt(0)
    v_mfma_f32_16x16x32_bf16 v[24:27], a[0:3], v[40:43], 0
    ds_read_b128 v[48:51], v3 offset:2048
    s_add_u32 m0, s34, 0
    v_mfma_f32_16x16x32_bf16 v[24:27], a[16:19], v[44:47], v[24:27]
    s_add_u32 s31, s31, 1
    v_mov_b32 v6, s31
    s_add_u32 s35, s35, 36864
    v_mfma_f32_16x16x32_bf16 v[28:31], a[20:23], v[44:47], 0
    ds_read_b128 v[52:55], v3 offset:3072
    v_cvt_pk_bf16_f32 v72, v8, v9
    v_mfma_f32_16x16x32_bf16 v[28:31], a[4:7], v[40:43], v[28:31]
    s_cmp_eq_u32 s35, 147456
    s_cselect_b32 s35, 0, s35
    v_cvt_pk_bf16_f32 v73, v10, v11
    v_mfma_f32_16x16x32_bf16 v[32:35], a[8:11], v[40:43], 0
    v_cvt_pk_bf16_f32 v74, v12, v13
    v_cvt_pk_bf16_f32 v75, v14, v15
    v_mfma_f32_16x16x32_bf16 v[32:35], a[24:27], v[44:47], v[32:35]
    buffer_store_dwordx4 v[72:75], v1, s[12:15], s36 offen offset:0 sc1
    v_cvt_pk_bf16_f32 v76, v16, v17
    v_mfma_f32_16x16x32_bf16 v[36:39], a[28:31], v[44:47], 0
    v_cvt_pk_bf16_f32 v77, v18, v19
    v_cvt_pk_bf16_f32 v78, v20, v21
    v_mfma_f32_16x16x32_bf16 v[36:39], a[12:15], v[40:43], v[36:39]
    s_waitcnt lgkmcnt(0)
    v_cvt_pk_bf16_f32 v79, v22, v23
    v_add_u32 v2, s35, v1
    v_mfma_f32_16x16x32_bf16 v[36:39], a[44:47], v[48:51], v[36:39]
    ds_read_b128 v[56:59], v3 offset:4096
    v_mfma_f32_16x16x32_bf16 v[36:39], a[60:63], v[52:55], v[36:39]
    buffer_store_dwordx4 v[76:79], v1, s[12:15], s36 offen offset:1024 sc1
    s_add_u32 s36, s36, 131072
    v_mfma_f32_16x16x32_bf16 v[32:35], a[56:59], v[52:55], v[32:35]
    ds_read_b128 v[60:63], v3 offset:5120
    v_mfma_f32_16x16x32_bf16 v[32:35], a[40:43], v[48:51], v[32:35]
    v_mfma_f32_16x16x32_bf16 v[28:31], a[36:39], v[48:51], v[28:31]
    v_mfma_f32_16x16x32_bf16 v[28:31], a[52:55], v[52:55], v[28:31]
    v_mfma_f32_16x16x32_bf16 v[24:27], a[48:51], v[52:55], v[24:27]
    v_mfma_f32_16x16x32_bf16 v[24:27], a[32:35], v[48:51], v[24:27]
    s_waitcnt lgkmcnt(0)
    v_mfma_f32_16x16x32_bf16 v[24:27], a[64:67], v[56:59], v[24:27]
    ds_read_b128 v[64:67], v3 offset:6144
    v_mfma_f32_16x16x32_bf16 v[24:27], a[80:83], v[60:63], v[24:27]
    v_mfma_f32_16x16x32_bf16 v[28:31], a[84:87], v[60:63], v[28:31]
    ds_read_b128 v[68:71], v3 offset:7168
    v_mfma_f32_16x16x32_bf16 v[28:31], a[68:71], v[56:59], v[28:31]
    v_mfma_f32_16x16x32_bf16 v[32:35], a[72:75], v[56:59], v[32:35]
    v_mfma_f32_16x16x32_bf16 v[32:35], a[88:91], v[60:63], v[32:35]
    v_mfma_f32_16x16x32_bf16 v[36:39], a[92:95], v[60:63], v[36:39]
    v_mfma_f32_16x16x32_bf16 v[36:39], a[76:79], v[56:59], v[36:39]
    s_waitcnt lgkmcnt(0)
    v_mfma_f32_16x16x32_bf16 v[36:39], a[108:111], v[64:67], v[36:39]
    ds_read_b128 v[40:43], v3 offset:8192
    v_mfma_f32_16x16x32_bf16 v[36:39], a[124:127], v[68:71], v[36:39]
    v_mfma_f32_16x16x32_bf16 v[32:35], a[120:123], v[68:71], v[32:35]
    ds_read_b128 v[44:47], v3 offset:9216
    v_mfma_f32_16x16x32_bf16 v[32:35], a[104:107], v[64:67], v[32:35]
    v_mfma_f32_16x16x32_bf16 v[28:31], a[100:103], v[64:67], v[28:31]
    v_mfma_f32_16x16x32_bf16 v[28:31], a[116:119], v[68:71], v[28:31]
    v_mfma_f32_16x16x32_bf16 v[24:27], a[112:115], v[68:71], v[24:27]
    v_mfma_f32_16x16x32_bf16 v[24:27], a[96:99], v[64:67], v[24:27]
    s_waitcnt vmcnt(2) lgkmcnt(0)
    v_cmp_gt_i32 vcc, s32, v5
    v_mfma_f32_16x16x32_bf16 v[24:27], a[128:131], v[40:43], v[24:27]
    ds_read_b128 v[48:51], v3 offset:10240
    v_mfma_f32_16x16x32_bf16 v[24:27], a[144:147], v[44:47], v[24:27]
    s_and_b64 vcc, vcc, s[18:19]
    s_cbranch_scc1 Lffb_v11
    v_mfma_f32_16x16x32_bf16 v[28:31], a[148:151], v[44:47], v[28:31]
    ds_read_b128 v[52:55], v3 offset:11264
    v_mfma_f32_16x16x32_bf16 v[28:31], a[132:135], v[40:43], v[28:31]
    buffer_load_dwordx4 v1, s[8:11], s33 offen offset:0 sc1 lds
    v_mfma_f32_16x16x32_bf16 v[32:35], a[136:139], v[40:43], v[32:35]
    v_mfma_f32_16x16x32_bf16 v[32:35], a[152:155], v[44:47], v[32:35]
    v_mfma_f32_16x16x32_bf16 v[36:39], a[156:159], v[44:47], v[36:39]
    v_mfma_f32_16x16x32_bf16 v[36:39], a[140:143], v[40:43], v[36:39]
    s_waitcnt lgkmcnt(0)
    s_barrier
    v_mfma_f32_16x16x32_bf16 v[36:39], a[172:175], v[48:51], v[36:39]
    ds_read_b128 v[56:59], v3 offset:12288
    v_mfma_f32_16x16x32_bf16 v[36:39], a[188:191], v[52:55], v[36:39]
    buffer_load_dwordx4 v1, s[8:11], s33 offen offset:1024 sc1 lds
    v_mfma_f32_16x16x32_bf16 v[32:35], a[184:187], v[52:55], v[32:35]
    ds_read_b128 v[60:63], v3 offset:13312
    v_mfma_f32_16x16x32_bf16 v[32:35], a[168:171], v[48:51], v[32:35]
    v_mfma_f32_16x16x32_bf16 v[28:31], a[164:167], v[48:51], v[28:31]
    v_mfma_f32_16x16x32_bf16 v[28:31], a[180:183], v[52:55], v[28:31]
    buffer_load_dwordx4 v1, s[8:11], s33 offen offset:2048 sc1 lds
    v_mfma_f32_16x16x32_bf16 v[24:27], a[176:179], v[52:55], v[24:27]
    s_add_u32 s16, s16, 8192
    s_add_u32 m0, s34, s3
    s_add_u32 s37, s33, s3
    v_mfma_f32_16x16x32_bf16 v[24:27], a[160:163], v[48:51], v[24:27]
    s_waitcnt lgkmcnt(0)
    v_mfma_f32_16x16x32_bf16 v[24:27], a[192:195], v[56:59], v[24:27]
    ds_read_b128 v[64:67], v3 offset:14336
    v_mfma_f32_16x16x32_bf16 v[24:27], a[208:211], v[60:63], v[24:27]
    buffer_load_dwordx4 v1, s[8:11], s37 offen offset:0 sc1 lds
    v_mfma_f32_16x16x32_bf16 v[28:31], a[212:215], v[60:63], v[28:31]
    ds_read_b128 v[68:71], v3 offset:15360
    v_mfma_f32_16x16x32_bf16 v[28:31], a[196:199], v[56:59], v[28:31]
    s_waitcnt vmcnt(4)
    buffer_store_dword v6, v80, s[12:15], s17 offen sc1
    v_mfma_f32_16x16x32_bf16 v[32:35], a[200:203], v[56:59], v[32:35]
    s_mov_b32 s14, s6
    s_add_u32 s17, s17, 8192
    v_mfma_f32_16x16x32_bf16 v[32:35], a[216:219], v[60:63], v[32:35]
    buffer_load_dwordx4 v1, s[8:11], s37 offen offset:1024 sc1 lds
    v_mfma_f32_16x16x32_bf16 v[36:39], a[220:223], v[60:63], v[36:39]
    v_mfma_f32_16x16x32_bf16 v[36:39], a[204:207], v[56:59], v[36:39]
    s_waitcnt lgkmcnt(0)
    v_mfma_f32_16x16x32_bf16 v[36:39], a[236:239], v[64:67], v[36:39]
    ds_read_b128 v[40:43], v3 offset:16384
    v_mfma_f32_16x16x32_bf16 v[36:39], a[252:255], v[68:71], v[36:39]
    buffer_load_dwordx4 v1, s[8:11], s37 offen offset:2048 sc1 lds
    v_mfma_f32_16x16x32_bf16 v[32:35], a[248:251], v[68:71], v[32:35]
    ds_read_b128 v[44:47], v3 offset:17408
    s_add_u32 s32, s32, 1
    v_mfma_f32_16x16x32_bf16 v[32:35], a[232:235], v[64:67], v[32:35]
    s_add_u32 s33, s33, 116736
    s_add_u32 s34, s34, 36864
    v_mfma_f32_16x16x32_bf16 v[28:31], a[228:231], v[64:67], v[28:31]
    s_cmp_ge_u32 s34, 147456
    s_cselect_b32 s38, 147456, 0
    s_sub_u32 s34, s34, s38
    v_mfma_f32_16x16x32_bf16 v[28:31], a[244:247], v[68:71], v[28:31]
    v_mfma_f32_16x16x32_bf16 v[24:27], a[240:243], v[68:71], v[24:27]
    v_mfma_f32_16x16x32_bf16 v[24:27], a[224:227], v[64:67], v[24:27]
    s_waitcnt lgkmcnt(0)
    v_mfma_f32_16x16x32_bf16 v[24:27], v[128:131], v[40:43], v[24:27]
    ds_read_b128 v[48:51], v3 offset:18432
    v_mfma_f32_16x16x32_bf16 v[24:27], v[144:147], v[44:47], v[24:27]
    v_mfma_f32_16x16x32_bf16 v[28:31], v[148:151], v[44:47], v[28:31]
    ds_read_b128 v[52:55], v3 offset:19456
    v_mfma_f32_16x16x32_bf16 v[28:31], v[132:135], v[40:43], v[28:31]
    v_mfma_f32_16x16x32_bf16 v[32:35], v[136:139], v[40:43], v[32:35]
    v_mfma_f32_16x16x32_bf16 v[32:35], v[152:155], v[44:47], v[32:35]
    v_mfma_f32_16x16x32_bf16 v[36:39], v[156:159], v[44:47], v[36:39]
    v_mfma_f32_16x16x32_bf16 v[36:39], v[140:143], v[40:43], v[36:39]
    s_waitcnt lgkmcnt(0)
    v_mfma_f32_16x16x32_bf16 v[36:39], v[172:175], v[48:51], v[36:39]
    ds_read_b128 v[56:59], v3 offset:20480
    v_mfma_f32_16x16x32_bf16 v[36:39], v[188:191], v[52:55], v[36:39]
    v_mfma_f32_16x16x32_bf16 v[32:35], v[184:187], v[52:55], v[32:35]
    ds_read_b128 v[60:63], v3 offset:21504
    v_mfma_f32_16x16x32_bf16 v[32:35], v[168:171], v[48:51], v[32:35]
    v_mfma_f32_16x16x32_bf16 v[28:31], v[164:167], v[48:51], v[28:31]
    v_mfma_f32_16x16x32_bf16 v[28:31], v[180:183], v[52:55], v[28:31]
    v_mfma_f32_16x16x32_bf16 v[24:27], v[176:179], v[52:55], v[24:27]
    v_mfma_f32_16x16x32_bf16 v[24:27], v[160:163], v[48:51], v[24:27]
    s_waitcnt lgkmcnt(0)
    v_mfma_f32_16x16x32_bf16 v[24:27], v[192:195], v[56:59], v[24:27]
    ds_read_b128 v[64:67], v3 offset:22528
    v_mfma_f32_16x16x32_bf16 v[24:27], v[208:211], v[60:63], v[24:27]
    v_mfma_f32_16x16x32_bf16 v[28:31], v[212:215], v[60:63], v[28:31]
    ds_read_b128 v[68:71], v3 offset:23552
    v_mfma_f32_16x16x32_bf16 v[28:31], v[196:199], v[56:59], v[28:31]
    v_mfma_f32_16x16x32_bf16 v[32:35], v[200:203], v[56:59], v[32:35]
    s_waitcnt vmcnt(4)
    v_mfma_f32_16x16x32_bf16 v[32:35], v[216:219], v[60:63], v[32:35]
    v_mfma_f32_16x16x32_bf16 v[36:39], v[220:223], v[60:63], v[36:39]
    v_mfma_f32_16x16x32_bf16 v[36:39], v[204:207], v[56:59], v[36:39]
    s_waitcnt lgkmcnt(0)
    s_barrier
    v_mfma_f32_16x16x32_bf16 v[36:39], v[236:239], v[64:67], v[36:39]
    ds_read_b128 v[40:43], v2 offset:0
    v_mfma_f32_16x16x32_bf16 v[36:39], v[252:255], v[68:71], v[36:39]
    buffer_load_dword v5, v4, s[4:7], s16 offen sc1
    v_mfma_f32_16x16x32_bf16 v[32:35], v[248:251], v[68:71], v[32:35]
    ds_read_b128 v[44:47], v2 offset:1024
    v_mfma_f32_16x16x32_bf16 v[32:35], v[232:235], v[64:67], v[32:35]
    v_mfma_f32_16x16x32_bf16 v[28:31], v[228:231], v[64:67], v[28:31]
    v_mfma_f32_16x16x32_bf16 v[28:31], v[244:247], v[68:71], v[28:31]
    v_mfma_f32_16x16x32_bf16 v[24:27], v[240:243], v[68:71], v[24:27]
    v_mfma_f32_16x16x32_bf16 v[24:27], v[224:227], v[64:67], v[24:27]
    s_cmp_lt_i32 s31, 63
    s_cbranch_scc1 Lffb_body03
    s_branch L_exit
Lffb_v01:
    v_mfma_f32_16x16x32_bf16 v[12:15], a[148:151], v[44:47], v[12:15]
    ds_read_b128 v[52:55], v2 offset:11264
    v_mfma_f32_16x16x32_bf16 v[12:15], a[132:135], v[40:43], v[12:15]
    buffer_load_dword v5, v4, s[4:7], s16 offen sc1
    v_mfma_f32_16x16x32_bf16 v[16:19], a[136:139], v[40:43], v[16:19]
    v_mfma_f32_16x16x32_bf16 v[16:19], a[152:155], v[44:47], v[16:19]
    v_mfma_f32_16x16x32_bf16 v[20:23], a[156:159], v[44:47], v[20:23]
    s_barrier
    v_mfma_f32_16x16x32_bf16 v[20:23], a[140:143], v[40:43], v[20:23]
    s_waitcnt lgkmcnt(0)
    v_mfma_f32_16x16x32_bf16 v[20:23], a[172:175], v[48:51], v[20:23]
    ds_read_b128 v[56:59], v2 offset:12288
    v_mfma_f32_16x16x32_bf16 v[20:23], a[188:191], v[52:55], v[20:23]
    v_mfma_f32_16x16x32_bf16 v[16:19], a[184:187], v[52:55], v[16:19]
    ds_read_b128 v[60:63], v2 offset:13312
    v_mfma_f32_16x16x32_bf16 v[16:19], a[168:171], v[48:51], v[16:19]
    v_mfma_f32_16x16x32_bf16 v[12:15], a[164:167], v[48:51], v[12:15]
    v_mfma_f32_16x16x32_bf16 v[12:15], a[180:183], v[52:55], v[12:15]
    v_mfma_f32_16x16x32_bf16 v[8:11], a[176:179], v[52:55], v[8:11]
    v_mfma_f32_16x16x32_bf16 v[8:11], a[160:163], v[48:51], v[8:11]
    s_waitcnt lgkmcnt(0)
    v_mfma_f32_16x16x32_bf16 v[8:11], a[192:195], v[56:59], v[8:11]
    ds_read_b128 v[64:67], v2 offset:14336
    v_mfma_f32_16x16x32_bf16 v[8:11], a[208:211], v[60:63], v[8:11]
    v_mfma_f32_16x16x32_bf16 v[12:15], a[212:215], v[60:63], v[12:15]
    ds_read_b128 v[68:71], v2 offset:15360
    v_mfma_f32_16x16x32_bf16 v[12:15], a[196:199], v[56:59], v[12:15]
    s_waitcnt vmcnt(1)
    buffer_store_dword v6, v80, s[12:15], s17 offen sc1
    v_mfma_f32_16x16x32_bf16 v[16:19], a[200:203], v[56:59], v[16:19]
    s_mov_b32 s14, s6
    s_add_u32 s17, s17, 8192
    v_mfma_f32_16x16x32_bf16 v[16:19], a[216:219], v[60:63], v[16:19]
    v_mfma_f32_16x16x32_bf16 v[20:23], a[220:223], v[60:63], v[20:23]
    v_mfma_f32_16x16x32_bf16 v[20:23], a[204:207], v[56:59], v[20:23]
    s_waitcnt lgkmcnt(0)
    v_mfma_f32_16x16x32_bf16 v[20:23], a[236:239], v[64:67], v[20:23]
    ds_read_b128 v[40:43], v2 offset:16384
    v_mfma_f32_16x16x32_bf16 v[20:23], a[252:255], v[68:71], v[20:23]
    v_mfma_f32_16x16x32_bf16 v[16:19], a[248:251], v[68:71], v[16:19]
    ds_read_b128 v[44:47], v2 offset:17408
    v_mfma_f32_16x16x32_bf16 v[16:19], a[232:235], v[64:67], v[16:19]
    v_mfma_f32_16x16x32_bf16 v[12:15], a[228:231], v[64:67], v[12:15]
    v_mfma_f32_16x16x32_bf16 v[12:15], a[244:247], v[68:71], v[12:15]
    v_mfma_f32_16x16x32_bf16 v[8:11], a[240:243], v[68:71], v[8:11]
    v_mfma_f32_16x16x32_bf16 v[8:11], a[224:227], v[64:67], v[8:11]
    s_waitcnt lgkmcnt(0)
    v_mfma_f32_16x16x32_bf16 v[8:11], v[128:131], v[40:43], v[8:11]
    ds_read_b128 v[48:51], v2 offset:18432
    v_mfma_f32_16x16x32_bf16 v[8:11], v[144:147], v[44:47], v[8:11]
    s_waitcnt vmcnt(1)
    v_cmp_gt_i32 vcc, s32, v5
    v_mfma_f32_16x16x32_bf16 v[12:15], v[148:151], v[44:47], v[12:15]
    ds_read_b128 v[52:55], v2 offset:19456
    v_mfma_f32_16x16x32_bf16 v[12:15], v[132:135], v[40:43], v[12:15]
    s_and_b64 vcc, vcc, s[18:19]
    s_cbranch_scc1 Lffb_v02
    v_mfma_f32_16x16x32_bf16 v[16:19], v[136:139], v[40:43], v[16:19]
    buffer_load_dwordx4 v1, s[8:11], s33 offen offset:0 sc1 lds
    v_mfma_f32_16x16x32_bf16 v[16:19], v[152:155], v[44:47], v[16:19]
    v_mfma_f32_16x16x32_bf16 v[20:23], v[156:159], v[44:47], v[20:23]
    v_mfma_f32_16x16x32_bf16 v[20:23], v[140:143], v[40:43], v[20:23]
    s_waitcnt lgkmcnt(0)
    v_mfma_f32_16x16x32_bf16 v[20:23], v[172:175], v[48:51], v[20:23]
    ds_read_b128 v[56:59], v2 offset:20480
    v_mfma_f32_16x16x32_bf16 v[20:23], v[188:191], v[52:55], v[20:23]
    buffer_load_dwordx4 v1, s[8:11], s33 offen offset:1024 sc1 lds
    v_mfma_f32_16x16x32_bf16 v[16:19], v[184:187], v[52:55], v[16:19]
    ds_read_b128 v[60:63], v2 offset:21504
    v_mfma_f32_16x16x32_bf16 v[16:19], v[168:171], v[48:51], v[16:19]
    v_mfma_f32_16x16x32_bf16 v[12:15], v[164:167], v[48:51], v[12:15]
    v_mfma_f32_16x16x32_bf16 v[12:15], v[180:183], v[52:55], v[12:15]
    buffer_load_dwordx4 v1, s[8:11], s33 offen offset:2048 sc1 lds
    v_mfma_f32_16x16x32_bf16 v[8:11], v[176:179], v[52:55], v[8:11]
    s_add_u32 s16, s16, 8192
    s_add_u32 m0, s34, s3
    s_add_u32 s37, s33, s3
    v_mfma_f32_16x16x32_bf16 v[8:11], v[160:163], v[48:51], v[8:11]
    s_waitcnt lgkmcnt(0)
    v_mfma_f32_16x16x32_bf16 v[8:11], v[192:195], v[56:59], v[8:11]
    ds_read_b128 v[64:67], v2 offset:22528
    v_mfma_f32_16x16x32_bf16 v[8:11], v[208:211], v[60:63], v[8:11]
    buffer_load_dwordx4 v1, s[8:11], s37 offen offset:0 sc1 lds
    v_mfma_f32_16x16x32_bf16 v[12:15], v[212:215], v[60:63], v[12:15]
    ds_read_b128 v[68:71], v2 offset:23552
    v_mfma_f32_16x16x32_bf16 v[12:15], v[196:199], v[56:59], v[12:15]
    v_mfma_f32_16x16x32_bf16 v[16:19], v[200:203], v[56:59], v[16:19]
    v_mfma_f32_16x16x32_bf16 v[16:19], v[216:219], v[60:63], v[16:19]
    buffer_load_dwordx4 v1, s[8:11], s37 offen offset:1024 sc1 lds
    v_mfma_f32_16x16x32_bf16 v[20:23], v[220:223], v[60:63], v[20:23]
    s_waitcnt vmcnt(2)
    s_barrier
    v_mfma_f32_16x16x32_bf16 v[20:23], v[204:207], v[56:59], v[20:23]
    s_waitcnt lgkmcnt(0)
    v_mfma_f32_16x16x32_bf16 v[20:23], v[236:239], v[64:67], v[20:23]
    ds_read_b128 v[40:43], v3 offset:0
    v_mfma_f32_16x16x32_bf16 v[20:23], v[252:255], v[68:71], v[20:23]
    buffer_load_dword v5, v4, s[4:7], s16 offen sc1
    v_mfma_f32_16x16x32_bf16 v[16:19], v[248:251], v[68:71], v[16:19]
    ds_read_b128 v[44:47], v3 offset:1024
    v_mfma_f32_16x16x32_bf16 v[16:19], v[232:235], v[64:67], v[16:19]
    v_mfma_f32_16x16x32_bf16 v[12:15], v[228:231], v[64:67], v[12:15]
    v_mfma_f32_16x16x32_bf16 v[12:15], v[244:247], v[68:71], v[12:15]
    buffer_load_dwordx4 v1, s[8:11], s37 offen offset:2048 sc1 lds
    v_mfma_f32_16x16x32_bf16 v[8:11], v[240:243], v[68:71], v[8:11]
    s_add_u32 s32, s32, 1
    s_add_u32 s33, s33, 116736
    s_add_u32 s34, s34, 36864
    v_mfma_f32_16x16x32_bf16 v[8:11], v[224:227], v[64:67], v[8:11]
    s_cmp_ge_u32 s34, 147456
    s_cselect_b32 s38, 147456, 0
    s_sub_u32 s34, s34, s38
    s_mov_b32 s39, 0x40000000
    buffer_store_dword v6, v1, s[4:7], s39 offen
    s_cmp_ge_i32 s31, 63
    s_cbranch_scc1 L_exit
    s_cmp_eq_u32 s30, 1
    s_cbranch_scc1 Lffb_body11
    s_cmp_eq_u32 s30, 2
    s_cbranch_scc1 Lffb_body12
    s_cmp_eq_u32 s30, 3
    s_cbranch_scc1 Lffb_body13
    s_branch Lffb_body10
Lffb_v02:
    v_mfma_f32_16x16x32_bf16 v[16:19], v[136:139], v[40:43], v[16:19]
    v_mfma_f32_16x16x32_bf16 v[16:19], v[152:155], v[44:47], v[16:19]
    v_mfma_f32_16x16x32_bf16 v[20:23], v[156:159], v[44:47], v[20:23]
    v_mfma_f32_16x16x32_bf16 v[20:23], v[140:143], v[40:43], v[20:23]
    s_waitcnt lgkmcnt(0)
    v_mfma_f32_16x16x32_bf16 v[20:23], v[172:175], v[48:51], v[20:23]
    ds_read_b128 v[56:59], v2 offset:20480
    v_mfma_f32_16x16x32_bf16 v[20:23], v[188:191], v[52:55], v[20:23]
    v_mfma_f32_16x16x32_bf16 v[16:19], v[184:187], v[52:55], v[16:19]
    ds_read_b128 v[60:63], v2 offset:21504
    v_mfma_f32_16x16x32_bf16 v[16:19], v[168:171], v[48:51], v[16:19]
    v_mfma_f32_16x16x32_bf16 v[12:15], v[164:167], v[48:51], v[12:15]
    v_mfma_f32_16x16x32_bf16 v[12:15], v[180:183], v[52:55], v[12:15]
    v_mfma_f32_16x16x32_bf16 v[8:11], v[176:179], v[52:55], v[8:11]
    v_mfma_f32_16x16x32_bf16 v[8:11], v[160:163], v[48:51], v[8:11]
    s_waitcnt lgkmcnt(0)
    v_mfma_f32_16x16x32_bf16 v[8:11], v[192:195], v[56:59], v[8:11]
    ds_read_b128 v[64:67], v2 offset:22528
    v_mfma_f32_16x16x32_bf16 v[8:11], v[208:211], v[60:63], v[8:11]
    v_mfma_f32_16x16x32_bf16 v[12:15], v[212:215], v[60:63], v[12:15]
    ds_read_b128 v[68:71], v2 offset:23552
    v_mfma_f32_16x16x32_bf16 v[12:15], v[196:199], v[56:59], v[12:15]
    buffer_load_dword v5, v4, s[4:7], s16 offen sc1
    v_mfma_f32_16x16x32_bf16 v[16:19], v[200:203], v[56:59], v[16:19]
    v_mfma_f32_16x16x32_bf16 v[16:19], v[216:219], v[60:63], v[16:19]
    v_mfma_f32_16x16x32_bf16 v[20:23], v[220:223], v[60:63], v[20:23]
    v_mfma_f32_16x16x32_bf16 v[20:23], v[204:207], v[56:59], v[20:23]
    s_waitcnt lgkmcnt(0)
    v_mfma_f32_16x16x32_bf16 v[20:23], v[236:239], v[64:67], v[20:23]
    v_mfma_f32_16x16x32_bf16 v[20:23], v[252:255], v[68:71], v[20:23]
    v_mfma_f32_16x16x32_bf16 v[16:19], v[248:251], v[68:71], v[16:19]
    v_mfma_f32_16x16x32_bf16 v[16:19], v[232:235], v[64:67], v[16:19]
    v_mfma_f32_16x16x32_bf16 v[12:15], v[228:231], v[64:67], v[12:15]
    v_mfma_f32_16x16x32_bf16 v[12:15], v[244:247], v[68:71], v[12:15]
    v_mfma_f32_16x16x32_bf16 v[8:11], v[240:243], v[68:71], v[8:11]
    v_mfma_f32_16x16x32_bf16 v[8:11], v[224:227], v[64:67], v[8:11]
    s_nop 7
    v_cvt_pk_bf16_f32 v72, v8, v9
    v_cvt_pk_bf16_f32 v73, v10, v11
    v_cvt_pk_bf16_f32 v74, v12, v13
    v_cvt_pk_bf16_f32 v75, v14, v15
    buffer_store_dwordx4 v[72:75], v1, s[12:15], s36 offen offset:0 sc1
    v_cvt_pk_bf16_f32 v76, v16, v17
    v_cvt_pk_bf16_f32 v77, v18, v19
    v_cvt_pk_bf16_f32 v78, v20, v21
    v_cvt_pk_bf16_f32 v79, v22, v23
    buffer_store_dwordx4 v[76:79], v1, s[12:15], s36 offen offset:1024 sc1
    s_add_u32 s54, s31, 1
    v_mov_b32 v6, s54
    s_waitcnt vmcnt(2)
    s_cmp_ge_i32 s31, 63
    s_cbranch_scc1 Lffb_late0
    v_cmp_gt_i32 vcc, s32, v5
    s_sub_u32 s43, s43, 1
    s_cmp_lt_i32 s43, 0
    s_cbranch_scc1 Lffb_rdy0
    s_and_b64 vcc, vcc, s[18:19]
    s_cbranch_scc0 Lffb_rdy0
Lffb_late0:
    buffer_load_dword v5, v4, s[4:7], s16 offen sc1
    s_waitcnt vmcnt(1)
    buffer_store_dword v6, v80, s[12:15], s17 offen sc1
    s_mov_b32 s14, 0
    s_cmp_ge_i32 s31, 63
    s_cbranch_scc1 L_exit
    s_waitcnt vmcnt(1)
    v_cmp_gt_i32 vcc, s32, v5
    s_sub_u32 s43, s43, 1
    s_cmp_lt_i32 s43, 0
    s_cbranch_scc1 Lffb_rdy0
    s_and_b64 vcc, vcc, s[18:19]
    s_cbranch_scc0 Lffb_rdy0
Lffb_spin0:
    buffer_load_dword v5, v4, s[4:7], s16 offen sc1
    s_waitcnt vmcnt(0)
    v_cmp_gt_i32 vcc, s32, v5
    s_sub_u32 s43, s43, 1
    s_cmp_lt_i32 s43, 0
    s_cbranch_scc1 Lffb_rdy0
    s_and_b64 vcc, vcc, s[18:19]
    s_cbranch_scc0 Lffb_rdy0
    s_sleep 8
    s_branch Lffb_spin0
Lffb_rdy0:
    s_add_u32 m0, s34, 0
    s_nop 0
    buffer_load_dwordx4 v1, s[8:11], s33 offen offset:0 sc1 lds
    buffer_load_dwordx4 v1, s[8:11], s33 offen offset:1024 sc1 lds
    buffer_load_dwordx4 v1, s[8:11], s33 offen offset:2048 sc1 lds
    s_add_u32 s16, s16, 8192
    buffer_load_dword v5, v4, s[4:7], s16 offen sc1
    s_add_u32 m0, s34, s3
    s_add_u32 s37, s33, s3
    buffer_load_dwordx4 v1, s[8:11], s37 offen offset:0 sc1 lds
    buffer_load_dwordx4 v1, s[8:11], s37 offen offset:1024 sc1 lds
    buffer_load_dwordx4 v1, s[8:11], s37 offen offset:2048 sc1 lds
    s_add_u32 s32, s32, 1
    s_add_u32 s33, s33, 116736
    s_add_u32 s34, s34, 36864
    s_cmp_ge_u32 s34, 147456
    s_cselect_b32 s38, 147456, 0
    s_sub_u32 s34, s34, s38
    s_waitcnt vmcnt(4)
    buffer_store_dword v6, v80, s[12:15], s17 offen sc1
Lffb_go0:
    s_mov_b32 s14, 0
    s_barrier
    ds_read_b128 v[40:43], v3 offset:0
    ds_read_b128 v[44:47], v3 offset:1024
    s_cmp_eq_u32 s30, 1
    s_cbranch_scc1 Lffb_body11
    s_cmp_eq_u32 s30, 2
    s_cbranch_scc1 Lffb_body12
    s_cmp_eq_u32 s30, 3
    s_cbranch_scc1 Lffb_body13
    s_branch Lffb_body10
Lffb_v11:
    v_mfma_f32_16x16x32_bf16 v[28:31], a[148:151], v[44:47], v[28:31]
    ds_read_b128 v[52:55], v3 offset:11264
    v_mfma_f32_16x16x32_bf16 v[28:31], a[132:135], v[40:43], v[28:31]
    buffer_load_dword v5, v4, s[4:7], s16 offen sc1
    v_mfma_f32_16x16x32_bf16 v[32:35], a[136:139], v[40:43], v[32:35]
    v_mfma_f32_16x16x32_bf16 v[32:35], a[152:155], v[44:47], v[32:35]
    v_mfma_f32_16x16x32_bf16 v[36:39], a[156:159], v[44:47], v[36:39]
    s_barrier
    v_mfma_f32_16x16x32_bf16 v[36:39], a[140:143], v[40:43], v[36:39]
    s_waitcnt lgkmcnt(0)
    v_mfma_f32_16x16x32_bf16 v[36:39], a[172:175], v[48:51], v[36:39]
    ds_read_b128 v[56:59], v3 offset:12288
    v_mfma_f32_16x16x32_bf16 v[36:39], a[188:191], v[52:55], v[36:39]
    v_mfma_f32_16x16x32_bf16 v[32:35], a[184:187], v[52:55], v[32:35]
    ds_read_b128 v[60:63], v3 offset:13312
    v_mfma_f32_16x16x32_bf16 v[32:35], a[168:171], v[48:51], v[32:35]
    v_mfma_f32_16x16x32_bf16 v[28:31], a[164:167], v[48:51], v[28:31]
    v_mfma_f32_16x16x32_bf16 v[28:31], a[180:183], v[52:55], v[28:31]
    v_mfma_f32_16x16x32_bf16 v[24:27], a[176:179], v[52:55], v[24:27]
    v_mfma_f32_16x16x32_bf16 v[24:27], a[160:163], v[48:51], v[24:27]
    s_waitcnt lgkmcnt(0)
    v_mfma_f32_16x16x32_bf16 v[24:27], a[192:195], v[56:59], v[24:27]
    ds_read_b128 v[64:67], v3 offset:14336
    v_mfma_f32_16x16x32_bf16 v[24:27], a[208:211], v[60:63], v[24:27]
    v_mfma_f32_16x16x32_bf16 v[28:31], a[212:215], v[60:63], v[28:31]
    ds_read_b128 v[68:71], v3 offset:15360
    v_mfma_f32_16x16x32_bf16 v[28:31], a[196:199], v[56:59], v[28:31]
    s_waitcnt vmcnt(1)
    buffer_store_dword v6, v80, s[12:15], s17 offen sc1
    v_mfma_f32_16x16x32_bf16 v[32:35], a[200:203], v[56:59], v[32:35]
    s_mov_b32 s14, s6
    s_add_u32 s17, s17, 8192
    v_mfma_f32_16x16x32_bf16 v[32:35], a[216:219], v[60:63], v[32:35]
    v_mfma_f32_16x16x32_bf16 v[36:39], a[220:223], v[60:63], v[36:39]
    v_mfma_f32_16x16x32_bf16 v[36:39], a[204:207], v[56:59], v[36:39]
    s_waitcnt lgkmcnt(0)
    v_mfma_f32_16x16x32_bf16 v[36:39], a[236:239], v[64:67], v[36:39]
    ds_read_b128 v[40:43], v3 offset:16384
    v_mfma_f32_16x16x32_bf16 v[36:39], a[252:255], v[68:71], v[36:39]
    v_mfma_f32_16x16x32_bf16 v[32:35], a[248:251], v[68:71], v[32:35]
    ds_read_b128 v[44:47], v3 offset:17408
    v_mfma_f32_16x16x32_bf16 v[32:35], a[232:235], v[64:67], v[32:35]
    v_mfma_f32_16x16x32_bf16 v[28:31], a[228:231], v[64:67], v[28:31]
    v_mfma_f32_16x16x32_bf16 v[28:31], a[244:247], v[68:71], v[28:31]
    v_mfma_f32_16x16x32_bf16 v[24:27], a[240:243], v[68:71], v[24:27]
    v_mfma_f32_16x16x32_bf16 v[24:27], a[224:227], v[64:67], v[24:27]
    s_waitcnt lgkmcnt(0)
    v_mfma_f32_16x16x32_bf16 v[24:27], v[128:131], v[40:43], v[24:27]
    ds_read_b128 v[48:51], v3 offset:18432
    v_mfma_f32_16x16x32_bf16 v[24:27], v[144:147], v[44:47], v[24:27]
    s_waitcnt vmcnt(1)
    v_cmp_gt_i32 vcc, s32, v5
    v_mfma_f32_16x16x32_bf16 v[28:31], v[148:151], v[44:47], v[28:31]
    ds_read_b128 v[52:55], v3 offset:19456
    v_mfma_f32_16x16x32_bf16 v[28:31], v[132:135], v[40:43], v[28:31]
    s_and_b64 vcc, vcc, s[18:19]
    s_cbranch_scc1 Lffb_v12
    v_mfma_f32_16x16x32_bf16 v[32:35], v[136:139], v[40:43], v[32:35]
    buffer_load_dwordx4 v1, s[8:11], s33 offen offset:0 sc1 lds
    v_mfma_f32_16x16x32_bf16 v[32:35], v[152:155], v[44:47], v[32:35]
    v_mfma_f32_16x16x32_bf16 v[36:39], v[156:159], v[44:47], v[36:39]
    v_mfma_f32_16x16x32_bf16 v[36:39], v[140:143], v[40:43], v[36:39]
    s_waitcnt lgkmcnt(0)
    v_mfma_f32_16x16x32_bf16 v[36:39], v[172:175], v[48:51], v[36:39]
    ds_read_b128 v[56:59], v3 offset:20480
    v_mfma_f32_16x16x32_bf16 v[36:39], v[188:191], v[52:55], v[36:39]
    buffer_load_dwordx4 v1, s[8:11], s33 offen offset:1024 sc1 lds
    v_mfma_f32_16x16x32_bf16 v[32:35], v[184:187], v[52:55], v[32:35]
    ds_read_b128 v[60:63], v3 offset:21504
    v_mfma_f32_16x16x32_bf16 v[32:35], v[168:171], v[48:51], v[32:35]
    v_mfma_f32_16x16x32_bf16 v[28:31], v[164:167], v[48:51], v[28:31]
    v_mfma_f32_16x16x32_bf16 v[28:31], v[180:183], v[52:55], v[28:31]
    buffer_load_dwordx4 v1, s[8:11], s33 offen offset:2048 sc1 lds
    v_mfma_f32_16x16x32_bf16 v[24:27], v[176:179], v[52:55], v[24:27]
    s_add_u32 s16, s16, 8192
    s_add_u32 m0, s34, s3
    s_add_u32 s37, s33, s3
    v_mfma_f32_16x16x32_bf16 v[24:27], v[160:163], v[48:51], v[24:27]
    s_waitcnt lgkmcnt(0)
    v_mfma_f32_16x16x32_bf16 v[24:27], v[192:195], v[56:59], v[24:27]
    ds_read_b128 v[64:67], v3 offset:22528
    v_mfma_f32_16x16x32_bf16 v[24:27], v[208:211], v[60:63], v[24:27]
    buffer_load_dwordx4 v1, s[8:11], s37 offen offset:0 sc1 lds
    v_mfma_f32_16x16x32_bf16 v[28:31], v[212:215], v[60:63], v[28:31]
    ds_read_b128 v[68:71], v3 offset:23552
    v_mfma_f32_16x16x32_bf16 v[28:31], v[196:199], v[56:59], v[28:31]
    v_mfma_f32_16x16x32_bf16 v[32:35], v[200:203], v[56:59], v[32:35]
    v_mfma_f32_16x16x32_bf16 v[32:35], v[216:219], v[60:63], v[32:35]
    buffer_load_dwordx4 v1, s[8:11], s37 offen offset:1024 sc1 lds
    v_mfma_f32_16x16x32_bf16 v[36:39], v[220:223], v[60:63], v[36:39]
    s_waitcnt vmcnt(2)
    s_barrier
    v_mfma_f32_16x16x32_bf16 v[36:39], v[204:207], v[56:59], v[36:39]
    s_waitcnt lgkmcnt(0)
    v_mfma_f32_16x16x32_bf16 v[36:39], v[236:239], v[64:67], v[36:39]
    ds_read_b128 v[40:43], v2 offset:0
    v_mfma_f32_16x16x32_bf16 v[36:39], v[252:255], v[68:71], v[36:39]
    buffer_load_dword v5, v4, s[4:7], s16 offen sc1
    v_mfma_f32_16x16x32_bf16 v[32:35], v[248:251], v[68:71], v[32:35]
    ds_read_b128 v[44:47], v2 offset:1024
    v_mfma_f32_16x16x32_bf16 v[32:35], v[232:235], v[64:67], v[32:35]
    v_mfma_f32_16x16x32_bf16 v[28:31], v[228:231], v[64:67], v[28:31]
    v_mfma_f32_16x16x32_bf16 v[28:31], v[244:247], v[68:71], v[28:31]
    buffer_load_dwordx4 v1, s[8:11], s37 offen offset:2048 sc1 lds
    v_mfma_f32_16x16x32_bf16 v[24:27], v[240:243], v[68:71], v[24:27]
    s_add_u32 s32, s32, 1
    s_add_u32 s33, s33, 116736
    s_add_u32 s34, s34, 36864
    v_mfma_f32_16x16x32_bf16 v[24:27], v[224:227], v[64:67], v[24:27]
    s_cmp_ge_u32 s34, 147456
    s_cselect_b32 s38, 147456, 0
    s_sub_u32 s34, s34, s38
    s_mov_b32 s39, 0x40000000
    buffer_store_dword v6, v1, s[4:7], s39 offen
    s_cmp_ge_i32 s31, 63
    s_cbranch_scc1 L_exit
    s_cmp_eq_u32 s30, 1
    s_cbranch_scc1 Lffb_body01
    s_cmp_eq_u32 s30, 2
    s_cbranch_scc1 Lffb_body02
    s_cmp_eq_u32 s30, 3
    s_cbranch_scc1 Lffb_body03
    s_branch Lffb_body00
Lffb_v12:
    v_mfma_f32_16x16x32_bf16 v[32:35], v[136:139], v[40:43], v[32:35]
    v_mfma_f32_16x16x32_bf16 v[32:35], v[152:155], v[44:47], v[32:35]
    v_mfma_f32_16x16x32_bf16 v[36:39], v[156:159], v[44:47], v[36:39]
    v_mfma_f32_16x16x32_bf16 v[36:39], v[140:143], v[40:43], v[36:39]
    s_waitcnt lgkmcnt(0)
    v_mfma_f32_16x16x32_bf16 v[36:39], v[172:175], v[48:51], v[36:39]
    ds_read_b128 v[56:59], v3 offset:20480
    v_mfma_f32_16x16x32_bf16 v[36:39], v[188:191], v[52:55], v[36:39]
    v_mfma_f32_16x16x32_bf16 v[32:35], v[184:187], v[52:55], v[32:35]
    ds_read_b128 v[60:63], v3 offset:21504
    v_mfma_f32_16x16x32_bf16 v[32:35], v[168:171], v[48:51], v[32:35]
    v_mfma_f32_16x16x32_bf16 v[28:31], v[164:167], v[48:51], v[28:31]
    v_mfma_f32_16x16x32_bf16 v[28:31], v[180:183], v[52:55], v[28:31]
    v_mfma_f32_16x16x32_bf16 v[24:27], v[176:179], v[52:55], v[24:27]
    v_mfma_f32_16x16x32_bf16 v[24:27], v[160:163], v[48:51], v[24:27]
    s_waitcnt lgkmcnt(0)
    v_mfma_f32_16x16x32_bf16 v[24:27], v[192:195], v[56:59], v[24:27]
    ds_read_b128 v[64:67], v3 offset:22528
    v_mfma_f32_16x16x32_bf16 v[24:27], v[208:211], v[60:63], v[24:27]
    v_mfma_f32_16x16x32_bf16 v[28:31], v[212:215], v[60:63], v[28:31]
    ds_read_b128 v[68:71], v3 offset:23552
    v_mfma_f32_16x16x32_bf16 v[28:31], v[196:199], v[56:59], v[28:31]
    buffer_load_dword v5, v4, s[4:7], s16 offen sc1
    v_mfma_f32_16x16x32_bf16 v[32:35], v[200:203], v[56:59], v[32:35]
    v_mfma_f32_16x16x32_bf16 v[32:35], v[216:219], v[60:63], v[32:35]
    v_mfma_f32_16x16x32_bf16 v[36:39], v[220:223], v[60:63], v[36:39]
    v_mfma_f32_16x16x32_bf16 v[36:39], v[204:207], v[56:59], v[36:39]
    s_waitcnt lgkmcnt(0)
    v_mfma_f32_16x16x32_bf16 v[36:39], v[236:239], v[64:67], v[36:39]
    v_mfma_f32_16x16x32_bf16 v[36:39], v[252:255], v[68:71], v[36:39]
    v_mfma_f32_16x16x32_bf16 v[32:35], v[248:251], v[68:71], v[32:35]
    v_mfma_f32_16x16x32_bf16 v[32:35], v[232:235], v[64:67], v[32:35]
    v_mfma_f32_16x16x32_bf16 v[28:31], v[228:231], v[64:67], v[28:31]
    v_mfma_f32_16x16x32_bf16 v[28:31], v[244:247], v[68:71], v[28:31]
    v_mfma_f32_16x16x32_bf16 v[24:27], v[240:243], v[68:71], v[24:27]
    v_mfma_f32_16x16x32_bf16 v[24:27], v[224:227], v[64:67], v[24:27]
    s_nop 7
    v_cvt_pk_bf16_f32 v72, v24, v25
    v_cvt_pk_bf16_f32 v73, v26, v27
    v_cvt_pk_bf16_f32 v74, v28, v29
    v_cvt_pk_bf16_f32 v75, v30, v31
    buffer_store_dwordx4 v[72:75], v1, s[12:15], s36 offen offset:0 sc1
    v_cvt_pk_bf16_f32 v76, v32, v33
    v_cvt_pk_bf16_f32 v77, v34, v35
    v_cvt_pk_bf16_f32 v78, v36, v37
    v_cvt_pk_bf16_f32 v79, v38, v39
    buffer_store_dwordx4 v[76:79], v1, s[12:15], s36 offen offset:1024 sc1
    s_add_u32 s54, s31, 1
    v_mov_b32 v6, s54
    s_waitcnt vmcnt(2)
    s_cmp_ge_i32 s31, 63
    s_cbranch_scc1 Lffb_late1
    v_cmp_gt_i32 vcc, s32, v5
    s_sub_u32 s43, s43, 1
    s_cmp_lt_i32 s43, 0
    s_cbranch_scc1 Lffb_rdy1
    s_and_b64 vcc, vcc, s[18:19]
    s_cbranch_scc0 Lffb_rdy1
Lffb_late1:
    buffer_load_dword v5, v4, s[4:7], s16 offen sc1
    s_waitcnt vmcnt(1)
    buffer_store_dword v6, v80, s[12:15], s17 offen sc1
    s_mov_b32 s14, 0
    s_cmp_ge_i32 s31, 63
    s_cbranch_scc1 L_exit
    s_waitcnt vmcnt(1)
    v_cmp_gt_i32 vcc, s32, v5
    s_sub_u32 s43, s43, 1
    s_cmp_lt_i32 s43, 0
    s_cbranch_scc1 Lffb_rdy1
    s_and_b64 vcc, vcc, s[18:19]
    s_cbranch_scc0 Lffb_rdy1
Lffb_spin1:
    buffer_load_dword v5, v4, s[4:7], s16 offen sc1
    s_waitcnt vmcnt(0)
    v_cmp_gt_i32 vcc, s32, v5
    s_sub_u32 s43, s43, 1
    s_cmp_lt_i32 s43, 0
    s_cbranch_scc1 Lffb_rdy1
    s_and_b64 vcc, vcc, s[18:19]
    s_cbranch_scc0 Lffb_rdy1
    s_sleep 8
    s_branch Lffb_spin1
Lffb_rdy1:
    s_add_u32 m0, s34, 0
    s_nop 0
    buffer_load_dwordx4 v1, s[8:11], s33 offen offset:0 sc1 lds
    buffer_load_dwordx4 v1, s[8:11], s33 offen offset:1024 sc1 lds
    buffer_load_dwordx4 v1, s[8:11], s33 offen offset:2048 sc1 lds
    s_add_u32 s16, s16, 8192
    buffer_load_dword v5, v4, s[4:7], s16 offen sc1
    s_add_u32 m0, s34, s3
    s_add_u32 s37, s33, s3
    buffer_load_dwordx4 v1, s[8:11], s37 offen offset:0 sc1 lds
    buffer_load_dwordx4 v1, s[8:11], s37 offen offset:1024 sc1 lds
    buffer_load_dwordx4 v1, s[8:11], s37 offen offset:2048 sc1 lds
    s_add_u32 s32, s32, 1
    s_add_u32 s33, s33, 116736
    s_add_u32 s34, s34, 36864
    s_cmp_ge_u32 s34, 147456
    s_cselect_b32 s38, 147456, 0
    s_sub_u32 s34, s34, s38
    s_waitcnt vmcnt(4)
    buffer_store_dword v6, v80, s[12:15], s17 offen sc1
Lffb_go1:
    s_mov_b32 s14, 0
    s_barrier
    ds_read_b128 v[40:43], v2 offset:0
    ds_read_b128 v[44:47], v2 offset:1024
    s_cmp_eq_u32 s30, 1
    s_cbranch_scc1 Lffb_body01
    s_cmp_eq_u32 s30, 2
    s_cbranch_scc1 Lffb_body02
    s_cmp_eq_u32 s30, 3
    s_cbranch_scc1 Lffb_body03
    s_branch Lffb_body00
Lred_start:
    s_mov_b32 s12, s76
    s_mov_b32 s13, s77
    s_mov_b32 s14, 0x700000
    s_mov_b32 s15, 0x00020000
    v_lshrrev_b32 v24, 3, v0
    v_mul_u32_u24 v24, 2048, v24
    v_bfe_u32 v25, v0, 4, 2
    v_lshlrev_b32 v25, 1, v25
    v_and_b32 v26, 7, v0
    v_xor_b32 v25, v25, v26
    v_lshl_add_u32 v40, v25, 4, v24
    v_add_u32 v41, 15360, v40
    s_sub_u32 s38, s29, 44
    s_and_b32 s39, s38, 3
    s_lshr_b32 s38, s38, 2
    s_mul_i32 s86, s38, 0x180000
    s_mul_i32 s53, s39, 0x200
    s_add_u32 s86, s86, s53
    s_mul_i32 s37, s30, 32768
    s_add_u32 s86, s86, s37
    s_lshl_b32 s87, s30, 11
    s_add_u32 m0, s87, 0
    s_add_u32 s37, s86, 0
    buffer_load_dwordx4 v40, s[12:15], s37 offen offset:0 lds
    buffer_load_dwordx4 v41, s[12:15], s37 offen offset:1024 lds
    s_add_u32 m0, s87, 8192
    s_add_u32 s37, s86, 128
    buffer_load_dwordx4 v40, s[12:15], s37 offen offset:0 lds
    buffer_load_dwordx4 v41, s[12:15], s37 offen offset:1024 lds
    s_add_u32 m0, s87, 16384
    s_add_u32 s37, s86, 256
    buffer_load_dwordx4 v40, s[12:15], s37 offen offset:0 lds
    buffer_load_dwordx4 v41, s[12:15], s37 offen offset:1024 lds
    s_add_u32 m0, s87, 24576
    s_add_u32 s37, s86, 384
    buffer_load_dwordx4 v40, s[12:15], s37 offen offset:0 lds
    buffer_load_dwordx4 v41, s[12:15], s37 offen offset:1024 lds
    s_add_u32 m0, s87, 32768
    s_add_u32 s37, s86, 131072
    buffer_load_dwordx4 v40, s[12:15], s37 offen offset:0 lds
    buffer_load_dwordx4 v41, s[12:15], s37 offen offset:1024 lds
    s_add_u32 m0, s87, 40960
    s_add_u32 s37, s86, 131200
    buffer_load_dwordx4 v40, s[12:15], s37 offen offset:0 lds
    buffer_load_dwordx4 v41, s[12:15], s37 offen offset:1024 lds
    s_add_u32 m0, s87, 49152
    s_add_u32 s37, s86, 131328
    buffer_load_dwordx4 v40, s[12:15], s37 offen offset:0 lds
    buffer_load_dwordx4 v41, s[12:15], s37 offen offset:1024 lds
    s_add_u32 m0, s87, 57344
    s_add_u32 s37, s86, 131456
    buffer_load_dwordx4 v40, s[12:15], s37 offen offset:0 lds
    buffer_load_dwordx4 v41, s[12:15], s37 offen offset:1024 lds
    s_add_u32 m0, s87, 65536
    s_add_u32 s37, s86, 262144
    buffer_load_dwordx4 v40, s[12:15], s37 offen offset:0 lds
    buffer_load_dwordx4 v41, s[12:15], s37 offen offset:1024 lds
    s_add_u32 m0, s87, 73728
    s_add_u32 s37, s86, 262272
    buffer_load_dwordx4 v40, s[12:15], s37 offen offset:0 lds
    buffer_load_dwordx4 v41, s[12:15], s37 offen offset:1024 lds
    s_add_u32 m0, s87, 81920
    s_add_u32 s37, s86, 262400
    buffer_load_dwordx4 v40, s[12:15], s37 offen offset:0 lds
    buffer_load_dwordx4 v41, s[12:15], s37 offen offset:1024 lds
    s_add_u32 m0, s87, 90112
    s_add_u32 s37, s86, 262528
    buffer_load_dwordx4 v40, s[12:15], s37 offen offset:0 lds
    buffer_load_dwordx4 v41, s[12:15], s37 offen offset:1024 lds
    s_add_u32 m0, s87, 98304
    s_add_u32 s37, s86, 393216
    buffer_load_dwordx4 v40, s[12:15], s37 offen offset:0 lds
    buffer_load_dwordx4 v41, s[12:15], s37 offen offset:1024 lds
    s_add_u32 m0, s87, 106496
    s_add_u32 s37, s86, 393344
    buffer_load_dwordx4 v40, s[12:15], s37 offen offset:0 lds
    buffer_load_dwordx4 v41, s[12:15], s37 offen offset:1024 lds
    s_add_u32 m0, s87, 114688
    s_add_u32 s37, s86, 393472
    buffer_load_dwordx4 v40, s[12:15], s37 offen offset:0 lds
    buffer_load_dwordx4 v41, s[12:15], s37 offen offset:1024 lds
    s_add_u32 m0, s87, 122880
    s_add_u32 s37, s86, 393600
    buffer_load_dwordx4 v40, s[12:15], s37 offen offset:0 lds
    buffer_load_dwordx4 v41, s[12:15], s37 offen offset:1024 lds
    v_bfe_u32 v24, v0, 3, 2
    v_and_b32 v25, 3, v0
    v_lshlrev_b32 v25, 3, v25
    v_lshrrev_b32 v26, 2, v0
    v_lshl_add_u32 v26, v26, 7, v25
    v_lshrrev_b32 v27, 5, v0
    v_lshl_add_u32 v27, v27, 10, v26
    s_mov_b32 s37, s30
    s_mov_b32 s38, 0
    s_lshl_b32 s37, s37, 13
    v_xor_b32 v28, s38, v24
    v_lshl_add_u32 v28, v28, 5, s37
    v_add_u32 v42, v28, v26
    v_add_u32 v46, v28, v27
    s_mov_b32 s37, s30
    s_mov_b32 s38, 1
    s_lshl_b32 s37, s37, 13
    v_xor_b32 v28, s38, v24
    v_lshl_add_u32 v28, v28, 5, s37
    v_add_u32 v43, v28, v26
    v_add_u32 v47, v28, v27
    s_mov_b32 s37, s30
    s_mov_b32 s38, 2
    s_lshl_b32 s37, s37, 13
    v_xor_b32 v28, s38, v24
    v_lshl_add_u32 v28, v28, 5, s37
    v_add_u32 v44, v28, v26
    v_add_u32 v48, v28, v27
    s_mov_b32 s37, s30
    s_mov_b32 s38, 3
    s_lshl_b32 s37, s37, 13
    v_xor_b32 v28, s38, v24
    v_lshl_add_u32 v28, v28, 5, s37
    v_add_u32 v45, v28, v26
    v_add_u32 v49, v28, v27
    s_mov_b32 s20, s78
    s_mov_b32 s21, s79
    s_mov_b32 s22, 0x800
    s_mov_b32 s23, 0x00020000
    v_lshrrev_b32 v8, 4, v0
    v_lshlrev_b32 v8, 3, v8
    s_mul_i32 s37, s29, 0x200
    s_mul_i32 s53, s30, 0x80
    s_add_u32 s37, s37, s53
    s_add_u32 s37, s37, 0xffff8800
    buffer_load_dwordx2 v[10:11], v8, s[20:23], s37 offen
    s_mul_i32 s37, s29, 0x200
    s_mul_i32 s53, s30, 0x80
    s_add_u32 s37, s37, s53
    s_add_u32 s37, s37, 0xffff8820
    buffer_load_dwordx2 v[12:13], v8, s[20:23], s37 offen
    s_mul_i32 s37, s29, 0x200
    s_mul_i32 s53, s30, 0x80
    s_add_u32 s37, s37, s53
    s_add_u32 s37, s37, 0xffff8840
    buffer_load_dwordx2 v[14:15], v8, s[20:23], s37 offen
    s_mul_i32 s37, s29, 0x200
    s_mul_i32 s53, s30, 0x80
    s_add_u32 s37, s37, s53
    s_add_u32 s37, s37, 0xffff8860
    buffer_load_dwordx2 v[16:17], v8, s[20:23], s37 offen
    s_waitcnt vmcnt(0)
    v_lshlrev_b32 v100, 16, v10
    v_and_b32 v101, 0xffff0000, v10
    v_lshlrev_b32 v102, 16, v11
    v_and_b32 v103, 0xffff0000, v11
    v_lshlrev_b32 v104, 16, v12
    v_and_b32 v105, 0xffff0000, v12
    v_lshlrev_b32 v106, 16, v13
    v_and_b32 v107, 0xffff0000, v13
    v_lshlrev_b32 v108, 16, v14
    v_and_b32 v109, 0xffff0000, v14
    v_lshlrev_b32 v110, 16, v15
    v_and_b32 v111, 0xffff0000, v15
    v_lshlrev_b32 v112, 16, v16
    v_and_b32 v113, 0xffff0000, v16
    v_lshlrev_b32 v114, 16, v17
    v_and_b32 v115, 0xffff0000, v17
    v_mov_b32 v90, 0x3f803f80
    v_mov_b32 v91, 0x3f803f80
    v_mov_b32 v92, 0x3f803f80
    v_mov_b32 v93, 0x3f803f80
    s_mov_b32 s44, 0xaaaaaaaa
    s_mov_b32 s45, 0xaaaaaaaa
    s_mov_b32 s46, 0xcccccccc
    s_mov_b32 s47, 0xcccccccc
    s_mov_b32 s38, 0xf0000f
    s_mov_b32 s39, 0xf0000f00
    v_and_b32 v8, 15, v0
    v_lshlrev_b32 v8, 3, v8
    v_mov_b32 v7, 0x40000000
    v_cndmask_b32 v7, v7, v8, s[38:39]
    s_mul_i32 s37, s29, 0xffffe200
    s_mul_i32 s53, s30, 0xfffff880
    s_add_u32 s37, s37, s53
    s_add_u32 s37, s37, 0x78800
    v_add_u32 v7, s37, v7
    v_mov_b32 v94, 0
    v_mov_b32 v95, 0
    v_mov_b32 v98, 0
    v_mov_b32 v99, 0
    v_mov_b32 v8, 0x3f80
    v_mov_b32 v9, 0x3f800000
    s_mov_b32 s38, 0x100001
    s_mov_b32 s39, 0x10000100
    v_cndmask_b32 v96, v94, v8, s[38:39]
    s_mov_b32 s38, 0x200002
    s_mov_b32 s39, 0x20000200
    v_cndmask_b32 v96, v96, v9, s[38:39]
    s_mov_b32 s38, 0x400004
    s_mov_b32 s39, 0x40000400
    v_cndmask_b32 v97, v94, v8, s[38:39]
    s_mov_b32 s38, 0x800008
    s_mov_b32 s39, 0x80000800
    v_cndmask_b32 v97, v97, v9, s[38:39]
    s_mul_i32 s37, s30, 0x800
    s_add_u32 s37, s37, 0x24000
    v_add_u32 v222, s37, v1
    v_and_b32 v8, 15, v0
    v_lshl_add_u32 v9, v8, 7, s37
    v_bfe_u32 v10, v0, 4, 1
    v_lshl_add_u32 v9, v10, 3, v9
    v_lshrrev_b32 v10, 5, v0
    v_and_b32 v8, 7, v0
    v_xor_b32 v10, v10, v8
    v_add_u32 v210, 0, v222
    v_xor_b32 v11, 0, v10
    v_lshl_add_u32 v216, v11, 4, v9
    v_add_u32 v211, 8, v222
    v_xor_b32 v11, 2, v10
    v_lshl_add_u32 v217, v11, 4, v9
    v_add_u32 v212, 1024, v222
    v_xor_b32 v11, 4, v10
    v_lshl_add_u32 v218, v11, 4, v9
    v_add_u32 v213, 1032, v222
    v_xor_b32 v11, 6, v10
    v_lshl_add_u32 v219, v11, 4, v9
    v_lshrrev_b32 v9, 3, v0
    v_xor_b32 v8, v8, v9
    v_lshlrev_b32 v8, 4, v8
    v_add_u32 v214, 0, v1
    v_add_u32 v215, 1024, v1
    v_lshl_add_u32 v220, v9, 11, v8
    v_add_u32 v221, 16384, v220
    v_mov_b32 v204, v210
    v_mov_b32 v205, v211
    v_mov_b32 v206, v212
    v_mov_b32 v207, v213
    v_mov_b32 v208, v214
    v_mov_b32 v209, v215
    s_mul_i32 s37, s28, 0x80000
    s_add_u32 s37, s37, 0x6005200
    v_min_u32 v4, 27, v0
    v_lshl_add_u32 v4, v4, 5, s37
    s_mul_i32 s37, s28, 0x80000
    s_mul_i32 s53, s29, 0x80
    s_add_u32 s37, s37, s53
    s_add_u32 s37, s37, 0x5fff800
    v_lshrrev_b32 v8, 2, v0
    v_lshl_add_u32 v8, v8, 9, s37
    v_and_b32 v9, 3, v0
    v_lshl_add_u32 v8, v9, 5, v8
    v_cmp_gt_u32 vcc, 16, v0
    s_nop 1
    v_cndmask_b32 v4, v4, v8, vcc
    v_subrev_u32 v4, 16384, v4
    s_mov_b32 s32, 1
    s_mul_i32 s33, s28, 0x720000
    s_add_u32 s33, s33, 0x2018000
    s_mul_i32 s40, s28, 0x800000
    s_mul_i32 s53, s29, 0x2000
    s_add_u32 s40, s40, s53
    s_mul_i32 s53, s30, 0x800
    s_add_u32 s40, s40, s53
    s_add_u32 s40, s40, 0x3f88000
    s_mul_i32 s41, s28, 0x240000
    s_mul_i32 s53, s29, 0x2000
    s_add_u32 s41, s41, s53
    s_mul_i32 s53, s30, 0x800
    s_add_u32 s41, s41, s53
    s_add_u32 s41, s41, 0x1188000
    s_mul_i32 s36, s28, 0x220000
    s_mul_i32 s53, s29, 0x2000
    s_add_u32 s36, s36, s53
    s_mul_i32 s53, s30, 0x800
    s_add_u32 s36, s36, s53
    s_add_u32 s36, s36, 0x8f800
    s_mul_i32 s42, s28, 0x100000
    s_mul_i32 s53, s29, 0x200
    s_add_u32 s42, s42, s53
    s_mul_i32 s53, s30, 0x80
    s_add_u32 s42, s42, s53
    s_add_u32 s42, s42, 0x1f8800
    s_mov_b32 s24, s84
    s_mov_b32 s25, s85
    s_mov_b32 s26, 0x0
    s_mov_b32 s27, 0x00020000
    s_mov_b32 s54, 0
    s_mov_b32 s31, -1
    s_mov_b32 s35, 0
    s_mov_b32 s16, 0
    v_mov_b32 v5, 0
    s_mul_i32 s17, s28, 0x80000
    s_mul_i32 s53, s29, 0x80
    s_add_u32 s17, s17, s53
    s_mul_i32 s53, s30, 0x20
    s_add_u32 s17, s17, s53
    s_add_u32 s17, s17, 0x5ffc000
    v_cmp_eq_u32 vcc, 0, v0
    v_mov_b32 v80, 0x40000000
    s_nop 0
    v_cndmask_b32 v80, v80, v0, vcc
    v_mov_b32 v2, v1
    s_mul_i32 s34, s30, 4096
    s_add_u32 s33, s33, s34
    s_mov_b64 s[18:19], 0xfffffff
    v_mov_b32 v8, 0x40000000
    v_cndmask_b32 v4, v8, v4, s[18:19]
    v_add_u32 v12, 0, v42
    v_add_u32 v13, 0, v43
    v_add_u32 v14, 0, v44
    v_add_u32 v15, 0, v45
    s_waitcnt vmcnt(24) lgkmcnt(0)
    s_barrier
    s_add_u32 m0, s87, 131072
    s_add_u32 s37, s86, 524288
    buffer_load_dwordx4 v40, s[12:15], s37 offen offset:0 lds
    ds_read_b64_tr_b16 a[0:1], v12 offset:0
    ds_read_b64_tr_b16 a[2:3], v12 offset:2048
    ds_read_b64_tr_b16 a[4:5], v13 offset:0
    buffer_load_dwordx4 v41, s[12:15], s37 offen offset:1024 lds
    ds_read_b64_tr_b16 a[6:7], v13 offset:2048
    ds_read_b64_tr_b16 a[8:9], v14 offset:0
    ds_read_b64_tr_b16 a[10:11], v14 offset:2048
    s_add_u32 m0, s87, 139264
    s_add_u32 s37, s86, 524416
    buffer_load_dwordx4 v40, s[12:15], s37 offen offset:0 lds
    ds_read_b64_tr_b16 a[12:13], v15 offset:0
    ds_read_b64_tr_b16 a[14:15], v15 offset:2048
    ds_read_b64_tr_b16 a[16:17], v12 offset:4096
    buffer_load_dwordx4 v41, s[12:15], s37 offen offset:1024 lds
    ds_read_b64_tr_b16 a[18:19], v12 offset:6144
    ds_read_b64_tr_b16 a[20:21], v13 offset:4096
    ds_read_b64_tr_b16 a[22:23], v13 offset:6144
    s_add_u32 m0, s87, 147456
    s_add_u32 s37, s86, 524544
    buffer_load_dwordx4 v40, s[12:15], s37 offen offset:0 lds
    ds_read_b64_tr_b16 a[24:25], v14 offset:4096
    ds_read_b64_tr_b16 a[26:27], v14 offset:6144
    ds_read_b64_tr_b16 a[28:29], v15 offset:4096
    buffer_load_dwordx4 v41, s[12:15], s37 offen offset:1024 lds
    ds_read_b64_tr_b16 a[30:31], v15 offset:6144
    v_add_u32 v16, 32768, v42
    v_add_u32 v17, 32768, v43
    s_add_u32 m0, s87, 155648
    s_add_u32 s37, s86, 524672
    buffer_load_dwordx4 v40, s[12:15], s37 offen offset:0 lds
    v_add_u32 v18, 32768, v44
    v_add_u32 v19, 32768, v45
    buffer_load_dwordx4 v41, s[12:15], s37 offen offset:1024 lds
    s_waitcnt vmcnt(24) lgkmcnt(0)
    s_barrier
    s_add_u32 m0, s87, 0
    s_add_u32 s37, s86, 655360
    buffer_load_dwordx4 v40, s[12:15], s37 offen offset:0 lds
    ds_read_b64_tr_b16 a[32:33], v16 offset:0
    ds_read_b64_tr_b16 a[34:35], v16 offset:2048
    ds_read_b64_tr_b16 a[36:37], v17 offset:0
    buffer_load_dwordx4 v41, s[12:15], s37 offen offset:1024 lds
    ds_read_b64_tr_b16 a[38:39], v17 offset:2048
    ds_read_b64_tr_b16 a[40:41], v18 offset:0
    ds_read_b64_tr_b16 a[42:43], v18 offset:2048
    s_add_u32 m0, s87, 8192
    s_add_u32 s37, s86, 655488
    buffer_load_dwordx4 v40, s[12:15], s37 offen offset:0 lds
    ds_read_b64_tr_b16 a[44:45], v19 offset:0
    ds_read_b64_tr_b16 a[46:47], v19 offset:2048
    ds_read_b64_tr_b16 a[48:49], v16 offset:4096
    buffer_load_dwordx4 v41, s[12:15], s37 offen offset:1024 lds
    ds_read_b64_tr_b16 a[50:51], v16 offset:6144
    ds_read_b64_tr_b16 a[52:53], v17 offset:4096
    ds_read_b64_tr_b16 a[54:55], v17 offset:6144
    s_add_u32 m0, s87, 16384
    s_add_u32 s37, s86, 655616
    buffer_load_dwordx4 v40, s[12:15], s37 offen offset:0 lds
    ds_read_b64_tr_b16 a[56:57], v18 offset:4096
    ds_read_b64_tr_b16 a[58:59], v18 offset:6144
    ds_read_b64_tr_b16 a[60:61], v19 offset:4096
    buffer_load_dwordx4 v41, s[12:15], s37 offen offset:1024 lds
    ds_read_b64_tr_b16 a[62:63], v19 offset:6144
    v_add_u32 v12, 65536, v46
    v_add_u32 v13, 65536, v47
    s_add_u32 m0, s87, 24576
    s_add_u32 s37, s86, 655744
    buffer_load_dwordx4 v40, s[12:15], s37 offen offset:0 lds
    v_add_u32 v14, 65536, v48
    v_add_u32 v15, 65536, v49
    buffer_load_dwordx4 v41, s[12:15], s37 offen offset:1024 lds
    s_waitcnt vmcnt(24) lgkmcnt(0)
    s_barrier
    s_add_u32 m0, s87, 32768
    s_add_u32 s37, s86, 786432
    buffer_load_dwordx4 v40, s[12:15], s37 offen offset:0 lds
    ds_read_b64_tr_b16 a[64:65], v12 offset:0
    ds_read_b64_tr_b16 a[66:67], v12 offset:1024
    ds_read_b64_tr_b16 a[68:69], v13 offset:0
    buffer_load_dwordx4 v41, s[12:15], s37 offen offset:1024 lds
    ds_read_b64_tr_b16 a[70:71], v13 offset:1024
    ds_read_b64_tr_b16 a[72:73], v14 offset:0
    ds_read_b64_tr_b16 a[74:75], v14 offset:1024
    s_add_u32 m0, s87, 40960
    s_add_u32 s37, s86, 786560
    buffer_load_dwordx4 v40, s[12:15], s37 offen offset:0 lds
    ds_read_b64_tr_b16 a[76:77], v15 offset:0
    ds_read_b64_tr_b16 a[78:79], v15 offset:1024
    ds_read_b64_tr_b16 a[80:81], v12 offset:4096
    buffer_load_dwordx4 v41, s[12:15], s37 offen offset:1024 lds
    ds_read_b64_tr_b16 a[82:83], v12 offset:5120
    ds_read_b64_tr_b16 a[84:85], v13 offset:4096
    ds_read_b64_tr_b16 a[86:87], v13 offset:5120
    s_add_u32 m0, s87, 49152
    s_add_u32 s37, s86, 786688
    buffer_load_dwordx4 v40, s[12:15], s37 offen offset:0 lds
    ds_read_b64_tr_b16 a[88:89], v14 offset:4096
    ds_read_b64_tr_b16 a[90:91], v14 offset:5120
    ds_read_b64_tr_b16 a[92:93], v15 offset:4096
    buffer_load_dwordx4 v41, s[12:15], s37 offen offset:1024 lds
    ds_read_b64_tr_b16 a[94:95], v15 offset:5120
    v_add_u32 v16, 98304, v42
    v_add_u32 v17, 98304, v43
    s_add_u32 m0, s87, 57344
    s_add_u32 s37, s86, 786816
    buffer_load_dwordx4 v40, s[12:15], s37 offen offset:0 lds
    v_add_u32 v18, 98304, v44
    v_add_u32 v19, 98304, v45
    buffer_load_dwordx4 v41, s[12:15], s37 offen offset:1024 lds
    s_waitcnt vmcnt(24) lgkmcnt(0)
    s_barrier
    s_add_u32 m0, s87, 65536
    s_add_u32 s37, s86, 917504
    buffer_load_dwordx4 v40, s[12:15], s37 offen offset:0 lds
    ds_read_b64_tr_b16 a[96:97], v16 offset:0
    ds_read_b64_tr_b16 a[98:99], v16 offset:2048
    ds_read_b64_tr_b16 a[100:101], v17 offset:0
    buffer_load_dwordx4 v41, s[12:15], s37 offen offset:1024 lds
    ds_read_b64_tr_b16 a[102:103], v17 offset:2048
    ds_read_b64_tr_b16 a[104:105], v18 offset:0
    ds_read_b64_tr_b16 a[106:107], v18 offset:2048
    s_add_u32 m0, s87, 73728
    s_add_u32 s37, s86, 917632
    buffer_load_dwordx4 v40, s[12:15], s37 offen offset:0 lds
    ds_read_b64_tr_b16 a[108:109], v19 offset:0
    ds_read_b64_tr_b16 a[110:111], v19 offset:2048
    ds_read_b64_tr_b16 a[112:113], v16 offset:4096
    buffer_load_dwordx4 v41, s[12:15], s37 offen offset:1024 lds
    ds_read_b64_tr_b16 a[114:115], v16 offset:6144
    ds_read_b64_tr_b16 a[116:117], v17 offset:4096
    ds_read_b64_tr_b16 a[118:119], v17 offset:6144
    s_add_u32 m0, s87, 81920
    s_add_u32 s37, s86, 917760
    buffer_load_dwordx4 v40, s[12:15], s37 offen offset:0 lds
    ds_read_b64_tr_b16 a[120:121], v18 offset:4096
    ds_read_b64_tr_b16 a[122:123], v18 offset:6144
    ds_read_b64_tr_b16 a[124:125], v19 offset:4096
    buffer_load_dwordx4 v41, s[12:15], s37 offen offset:1024 lds
    ds_read_b64_tr_b16 a[126:127], v19 offset:6144
    v_add_u32 v12, 131072, v42
    v_add_u32 v13, 131072, v43
    s_add_u32 m0, s87, 90112
    s_add_u32 s37, s86, 917888
    buffer_load_dwordx4 v40, s[12:15], s37 offen offset:0 lds
    v_add_u32 v14, 131072, v44
    v_add_u32 v15, 131072, v45
    buffer_load_dwordx4 v41, s[12:15], s37 offen offset:1024 lds
    s_waitcnt vmcnt(24) lgkmcnt(0)
    s_barrier
    ds_read_b64_tr_b16 a[128:129], v12 offset:0
    ds_read_b64_tr_b16 a[130:131], v12 offset:2048
    ds_read_b64_tr_b16 a[132:133], v13 offset:0
    ds_read_b64_tr_b16 a[134:135], v13 offset:2048
    ds_read_b64_tr_b16 a[136:137], v14 offset:0
    ds_read_b64_tr_b16 a[138:139], v14 offset:2048
    ds_read_b64_tr_b16 a[140:141], v15 offset:0
    ds_read_b64_tr_b16 a[142:143], v15 offset:2048
    ds_read_b64_tr_b16 a[144:145], v12 offset:4096
    ds_read_b64_tr_b16 a[146:147], v12 offset:6144
    ds_read_b64_tr_b16 a[148:149], v13 offset:4096
    ds_read_b64_tr_b16 a[150:151], v13 offset:6144
    ds_read_b64_tr_b16 a[152:153], v14 offset:4096
    ds_read_b64_tr_b16 a[154:155], v14 offset:6144
    ds_read_b64_tr_b16 a[156:157], v15 offset:4096
    ds_read_b64_tr_b16 a[158:159], v15 offset:6144
    v_add_u32 v16, 0, v46
    v_add_u32 v17, 0, v47
    v_add_u32 v18, 0, v48
    v_add_u32 v19, 0, v49
    s_waitcnt vmcnt(16) lgkmcnt(0)
    s_barrier
    ds_read_b64_tr_b16 a[160:161], v16 offset:0
    ds_read_b64_tr_b16 a[162:163], v16 offset:1024
    ds_read_b64_tr_b16 a[164:165], v17 offset:0
    ds_read_b64_tr_b16 a[166:167], v17 offset:1024
    ds_read_b64_tr_b16 a[168:169], v18 offset:0
    ds_read_b64_tr_b16 a[170:171], v18 offset:1024
    ds_read_b64_tr_b16 a[172:173], v19 offset:0
    ds_read_b64_tr_b16 a[174:175], v19 offset:1024
    ds_read_b64_tr_b16 a[176:177], v16 offset:4096
    ds_read_b64_tr_b16 a[178:179], v16 offset:5120
    ds_read_b64_tr_b16 a[180:181], v17 offset:4096
    ds_read_b64_tr_b16 a[182:183], v17 offset:5120
    ds_read_b64_tr_b16 a[184:185], v18 offset:4096
    ds_read_b64_tr_b16 a[186:187], v18 offset:5120
    ds_read_b64_tr_b16 a[188:189], v19 offset:4096
    ds_read_b64_tr_b16 a[190:191], v19 offset:5120
    v_add_u32 v12, 32768, v42
    v_add_u32 v13, 32768, v43
    v_add_u32 v14, 32768, v44
    v_add_u32 v15, 32768, v45
    s_waitcnt vmcnt(8) lgkmcnt(0)
    s_barrier
    ds_read_b64_tr_b16 a[192:193], v12 offset:0
    ds_read_b64_tr_b16 a[194:195], v12 offset:2048
    ds_read_b64_tr_b16 a[196:197], v13 offset:0
    ds_read_b64_tr_b16 a[198:199], v13 offset:2048
    ds_read_b64_tr_b16 a[200:201], v14 offset:0
    ds_read_b64_tr_b16 a[202:203], v14 offset:2048
    ds_read_b64_tr_b16 a[204:205], v15 offset:0
    ds_read_b64_tr_b16 a[206:207], v15 offset:2048
    ds_read_b64_tr_b16 a[208:209], v12 offset:4096
    ds_read_b64_tr_b16 a[210:211], v12 offset:6144
    ds_read_b64_tr_b16 a[212:213], v13 offset:4096
    ds_read_b64_tr_b16 a[214:215], v13 offset:6144
    ds_read_b64_tr_b16 a[216:217], v14 offset:4096
    ds_read_b64_tr_b16 a[218:219], v14 offset:6144
    ds_read_b64_tr_b16 a[220:221], v15 offset:4096
    ds_read_b64_tr_b16 a[222:223], v15 offset:6144
    v_add_u32 v16, 65536, v42
    v_add_u32 v17, 65536, v43
    v_add_u32 v18, 65536, v44
    v_add_u32 v19, 65536, v45
    s_waitcnt vmcnt(0) lgkmcnt(0)
    s_barrier
    ds_read_b64_tr_b16 a[224:225], v16 offset:0
    ds_read_b64_tr_b16 a[226:227], v16 offset:2048
    ds_read_b64_tr_b16 a[228:229], v17 offset:0
    ds_read_b64_tr_b16 a[230:231], v17 offset:2048
    ds_read_b64_tr_b16 a[232:233], v18 offset:0
    ds_read_b64_tr_b16 a[234:235], v18 offset:2048
    ds_read_b64_tr_b16 a[236:237], v19 offset:0
    ds_read_b64_tr_b16 a[238:239], v19 offset:2048
    ds_read_b64_tr_b16 a[240:241], v16 offset:4096
    ds_read_b64_tr_b16 a[242:243], v16 offset:6144
    ds_read_b64_tr_b16 a[244:245], v17 offset:4096
    ds_read_b64_tr_b16 a[246:247], v17 offset:6144
    ds_read_b64_tr_b16 a[248:249], v18 offset:4096
    ds_read_b64_tr_b16 a[250:251], v18 offset:6144
    ds_read_b64_tr_b16 a[252:253], v19 offset:4096
    ds_read_b64_tr_b16 a[254:255], v19 offset:6144
    s_waitcnt lgkmcnt(0)
    s_mov_b32 s12, s84
    s_mov_b32 s13, s85
    s_mov_b32 s14, 0x6200000
    s_mov_b32 s15, 0x00020000
    s_barrier
    s_mov_b32 s20, s82
    s_mov_b32 s21, s83
    s_mov_b32 s22, 0x100
    s_mov_b32 s23, 0x00020000
    v_and_b32 v8, 15, v0
    v_lshlrev_b32 v8, 4, v8
    v_mov_b32 v10, 8
    buffer_load_dword v9, v8, s[20:23], 0 offen sc1
    s_waitcnt vmcnt(0)
Lred_wa:
    v_cmp_gt_u32 vcc, v10, v9
    s_sub_u32 s43, s43, 1
    s_cmp_lt_i32 s43, 0
    s_cbranch_scc1 Lred_all
    s_cbranch_vccz Lred_all
    s_sleep 2
    buffer_load_dword v9, v8, s[20:23], 0 offen sc1
    s_waitcnt vmcnt(0)
    s_branch Lred_wa
Lred_all:
    s_mov_b32 s18, 0xfff0000
    s_mov_b32 s14, 0
    s_mov_b32 s20, s84
    s_mov_b32 s21, s85
    s_mov_b32 s22, 0x0
    s_mov_b32 s23, 0x00020000
    s_cmp_lg_u32 s30, 0
    s_cbranch_scc1 Lred_f0ok
Lred_f0spin:
    buffer_load_dword v5, v4, s[4:7], s16 offen sc1
    s_waitcnt vmcnt(0)
    v_cmp_gt_i32 vcc, s32, v5
    s_sub_u32 s43, s43, 1
    s_cmp_lt_i32 s43, 0
    s_cbranch_scc1 Lred_f0ok
    s_and_b64 vcc, vcc, s[18:19]
    s_cbranch_scc0 Lred_f0ok
    s_sleep 2
    s_branch Lred_f0spin
Lred_f0ok:
    s_barrier
    s_mov_b32 s10, s6
    s_add_u32 m0, s34, 0
    s_nop 0
    buffer_load_dwordx4 v1, s[8:11], s33 offen offset:0 sc1 lds
    buffer_load_dwordx4 v1, s[8:11], s33 offen offset:1024 sc1 lds
    buffer_load_dwordx4 v1, s[8:11], s33 offen offset:2048 sc1 lds
    buffer_load_dwordx4 v1, s[8:11], s33 offen offset:3072 sc1 lds
    s_add_u32 s33, s33, 116736
    s_add_u32 s34, s34, 36864
    s_cmp_ge_u32 s34, 147456
    s_cselect_b32 s38, 147456, 0
    s_sub_u32 s34, s34, s38
    buffer_load_dwordx4 v[180:183], v1, s[4:7], s41 offen offset:0 sc1
    buffer_load_dwordx4 v[184:187], v1, s[4:7], s41 offen offset:1024 sc1
    s_add_u32 s41, s41, 36864
    s_add_u32 s16, s16, 8192
    s_cmp_lg_u32 s30, 0
    s_cbranch_scc1 Lred_f1ok
Lred_f1spin:
    buffer_load_dword v5, v4, s[4:7], s16 offen sc1
    s_waitcnt vmcnt(0)
    v_cmp_gt_i32 vcc, s32, v5
    s_sub_u32 s43, s43, 1
    s_cmp_lt_i32 s43, 0
    s_cbranch_scc1 Lred_f1ok
    s_and_b64 vcc, vcc, s[18:19]
    s_cbranch_scc0 Lred_f1ok
    s_sleep 2
    s_branch Lred_f1spin
Lred_f1ok:
    s_barrier
    s_mov_b32 s10, s6
    s_add_u32 m0, s34, 0
    s_nop 0
    buffer_load_dwordx4 v1, s[8:11], s33 offen offset:0 sc1 lds
    buffer_load_dwordx4 v1, s[8:11], s33 offen offset:1024 sc1 lds
    buffer_load_dwordx4 v1, s[8:11], s33 offen offset:2048 sc1 lds
    buffer_load_dwordx4 v1, s[8:11], s33 offen offset:3072 sc1 lds
    s_add_u32 s33, s33, 116736
    s_add_u32 s34, s34, 36864
    s_cmp_ge_u32 s34, 147456
    s_cselect_b32 s38, 147456, 0
    s_sub_u32 s34, s34, s38
    s_add_u32 s16, s16, 8192
    s_mov_b32 s18, 0xfffffff
    s_mov_b32 s31, -2
    v_mov_b32 v5, 0
    s_waitcnt vmcnt(0)
    s_branch Lred_top1
    .p2align 6
Lred_run0:
    s_waitcnt vmcnt(17)
    v_mfma_f32_16x16x32_bf16 v[20:23], v[94:97], v[120:123], v[20:23]
    s_barrier
    v_mfma_f32_16x16x32_bf16 v[16:19], v[96:99], v[120:123], v[16:19]
    s_waitcnt vmcnt(9)
    v_add_u32 v3, s35, v1
    v_cmp_gt_i32 vcc, s32, v5
    v_mfma_f32_16x16x32_bf16 v[12:15], v[94:97], v[116:119], v[12:15]
    v_mfma_f32_16x16x32_bf16 v[8:11], v[96:99], v[116:119], v[8:11]
    s_and_b64 vcc, vcc, s[18:19]
    s_cbranch_scc1 Lred_v01
    v_mfma_f32_16x16x32_bf16 v[8:11], v[96:99], v[124:127], v[8:11]
    s_add_u32 s16, s16, 8192
    v_mfma_f32_16x16x32_bf16 v[12:15], v[94:97], v[124:127], v[12:15]
    buffer_load_dwordx4 v[148:151], v1, s[4:7], s40 offen offset:0 sc1
    v_mfma_f32_16x16x32_bf16 v[16:19], v[96:99], v[128:131], v[16:19]
    ds_read_b128 v[40:43], v3 offset:0
    s_add_u32 s31, s31, 1
    v_mfma_f32_16x16x32_bf16 v[20:23], v[94:97], v[128:131], v[20:23]
    v_mov_b32 v6, s31
    v_mfma_f32_16x16x32_bf16 v[20:23], v[94:97], v[136:139], v[20:23]
    ds_read_b128 v[44:47], v3 offset:1024
    s_waitcnt vmcnt(7)
    v_mfma_f32_16x16x32_bf16 v[16:19], v[96:99], v[136:139], v[16:19]
    buffer_load_dwordx4 v[152:155], v1, s[4:7], s40 offen offset:1024 sc1
    v_mfma_f32_16x16x32_bf16 v[12:15], v[94:97], v[132:135], v[12:15]
    ds_read_b128 v[48:51], v3 offset:2048
    s_add_u32 s37, s40, 32768
    v_mfma_f32_16x16x32_bf16 v[8:11], v[96:99], v[132:135], v[8:11]
    buffer_store_dword v6, v80, s[20:23], s17 offen sc1
    s_add_u32 s17, s17, 8192
    v_mfma_f32_16x16x32_bf16 v[8:11], v[96:99], v[140:143], v[8:11]
    ds_read_b128 v[52:55], v3 offset:3072
    v_mfma_f32_16x16x32_bf16 v[12:15], v[94:97], v[140:143], v[12:15]
    buffer_load_dwordx4 v[156:159], v1, s[4:7], s37 offen offset:0 sc1
    v_mfma_f32_16x16x32_bf16 v[16:19], v[96:99], v[144:147], v[16:19]
    v_mfma_f32_16x16x32_bf16 v[20:23], v[94:97], v[144:147], v[20:23]
    s_waitcnt lgkmcnt(2)
    v_mfma_f32_16x16x32_bf16 v[24:27], a[0:3], v[40:43], v[100:103]
    ds_read_b128 v[56:59], v3 offset:4096
    v_cvt_pk_bf16_f32 v72, v8, v9
    v_mfma_f32_16x16x32_bf16 v[24:27], a[16:19], v[44:47], v[24:27]
    buffer_load_dwordx4 v[160:163], v1, s[4:7], s37 offen offset:1024 sc1
    v_mfma_f32_16x16x32_bf16 v[28:31], a[20:23], v[44:47], v[104:107]
    s_add_u32 s37, s40, 65536
    v_cvt_pk_bf16_f32 v73, v10, v11
    v_mfma_f32_16x16x32_bf16 v[28:31], a[4:7], v[40:43], v[28:31]
    ds_write_b64 v204, v[72:73]
    v_mfma_f32_16x16x32_bf16 v[32:35], a[8:11], v[40:43], v[108:111]
    ds_read_b128 v[60:63], v3 offset:5120
    v_cvt_pk_bf16_f32 v74, v12, v13
    v_mfma_f32_16x16x32_bf16 v[32:35], a[24:27], v[44:47], v[32:35]
    buffer_load_dwordx4 v[164:167], v1, s[4:7], s37 offen offset:0 sc1
    v_mfma_f32_16x16x32_bf16 v[36:39], a[28:31], v[44:47], v[112:115]
    v_cvt_pk_bf16_f32 v75, v14, v15
    v_mfma_f32_16x16x32_bf16 v[36:39], a[12:15], v[40:43], v[36:39]
    s_waitcnt lgkmcnt(3)
    ds_write_b64 v205, v[74:75]
    v_mfma_f32_16x16x32_bf16 v[36:39], a[44:47], v[48:51], v[36:39]
    ds_read_b128 v[64:67], v3 offset:6144
    v_cvt_pk_bf16_f32 v76, v16, v17
    v_mfma_f32_16x16x32_bf16 v[36:39], a[60:63], v[52:55], v[36:39]
    buffer_load_dwordx4 v[168:171], v1, s[4:7], s37 offen offset:1024 sc1
    v_mfma_f32_16x16x32_bf16 v[32:35], a[56:59], v[52:55], v[32:35]
    s_add_u32 s37, s40, 98304
    v_cvt_pk_bf16_f32 v77, v18, v19
    v_mfma_f32_16x16x32_bf16 v[32:35], a[40:43], v[48:51], v[32:35]
    ds_write_b64 v206, v[76:77]
    v_mfma_f32_16x16x32_bf16 v[28:31], a[36:39], v[48:51], v[28:31]
    ds_read_b128 v[68:71], v3 offset:7168
    v_cvt_pk_bf16_f32 v78, v20, v21
    v_mfma_f32_16x16x32_bf16 v[28:31], a[52:55], v[52:55], v[28:31]
    buffer_load_dwordx4 v[172:175], v1, s[4:7], s37 offen offset:0 sc1
    v_mfma_f32_16x16x32_bf16 v[24:27], a[48:51], v[52:55], v[24:27]
    v_cvt_pk_bf16_f32 v79, v22, v23
    v_mfma_f32_16x16x32_bf16 v[24:27], a[32:35], v[48:51], v[24:27]
    s_waitcnt lgkmcnt(4)
    ds_write_b64 v207, v[78:79]
    v_mfma_f32_16x16x32_bf16 v[24:27], a[64:67], v[56:59], v[24:27]
    ds_read_b128 v[40:43], v3 offset:8192
    v_mfma_f32_16x16x32_bf16 v[24:27], a[80:83], v[60:63], v[24:27]
    buffer_load_dwordx4 v[176:179], v1, s[4:7], s37 offen offset:1024 sc1
    v_mfma_f32_16x16x32_bf16 v[28:31], a[84:87], v[60:63], v[28:31]
    s_add_u32 m0, s34, 0
    ds_read_b128 v[196:199], v222 offset:0
    v_mfma_f32_16x16x32_bf16 v[28:31], a[68:71], v[56:59], v[28:31]
    ds_read_b128 v[200:203], v222 offset:1024
    v_mfma_f32_16x16x32_bf16 v[86:89], v[72:75], v[72:75], 0
    v_mfma_f32_16x16x32_bf16 v[82:85], v[90:93], v[72:75], 0
    buffer_load_dword v5, v4, s[4:7], s16 offen sc1
    v_mfma_f32_16x16x32_bf16 v[86:89], v[76:79], v[76:79], v[86:89]
    v_mfma_f32_16x16x32_bf16 v[82:85], v[90:93], v[76:79], v[82:85]
    s_waitcnt lgkmcnt(1)
    v_mfma_f32_16x16x32_bf16 v[32:35], a[72:75], v[56:59], v[32:35]
    ds_read_b128 v[44:47], v3 offset:9216
    v_mfma_f32_16x16x32_bf16 v[32:35], a[88:91], v[60:63], v[32:35]
    buffer_store_dwordx4 v[196:199], v208, s[24:27], s54 offen sc1
    s_waitcnt lgkmcnt(1)
    v_mfma_f32_16x16x32_bf16 v[36:39], a[92:95], v[60:63], v[36:39]
    v_mfma_f32_16x16x32_bf16 v[36:39], a[76:79], v[56:59], v[36:39]
    v_mfma_f32_16x16x32_bf16 v[36:39], a[108:111], v[64:67], v[36:39]
    ds_read_b128 v[48:51], v3 offset:10240
    v_mfma_f32_16x16x32_bf16 v[36:39], a[124:127], v[68:71], v[36:39]
    buffer_store_dwordx4 v[200:203], v209, s[24:27], s54 offen sc1
    v_cndmask_b32 v86, v86, v87, s[44:45]
    v_mfma_f32_16x16x32_bf16 v[32:35], a[120:123], v[68:71], v[32:35]
    v_cndmask_b32 v88, v88, v89, s[44:45]
    v_cndmask_b32 v83, v86, v88, s[46:47]
    v_mfma_f32_16x16x32_bf16 v[32:35], a[104:107], v[64:67], v[32:35]
    buffer_store_dwordx2 v[82:83], v7, s[12:15], s36 offen offset:0 sc1
    s_mov_b32 s22, s14
    v_mfma_f32_16x16x32_bf16 v[28:31], a[100:103], v[64:67], v[28:31]
    ds_read_b128 v[52:55], v3 offset:11264
    s_add_u32 s36, s36, 34816
    v_mfma_f32_16x16x32_bf16 v[28:31], a[116:119], v[68:71], v[28:31]
    buffer_load_dwordx4 v1, s[8:11], s33 offen offset:0 sc1 lds
    v_mfma_f32_16x16x32_bf16 v[24:27], a[112:115], v[68:71], v[24:27]
    s_sub_u32 s42, s42, 32768
    v_mfma_f32_16x16x32_bf16 v[24:27], a[96:99], v[64:67], v[24:27]
    s_waitcnt lgkmcnt(2)
    v_mfma_f32_16x16x32_bf16 v[24:27], a[128:131], v[40:43], v[24:27]
    ds_read_b128 v[56:59], v3 offset:12288
    v_mfma_f32_16x16x32_bf16 v[24:27], a[144:147], v[44:47], v[24:27]
    buffer_load_dwordx4 v1, s[8:11], s33 offen offset:1024 sc1 lds
    v_mfma_f32_16x16x32_bf16 v[28:31], a[148:151], v[44:47], v[28:31]
    s_cmp_lt_i32 s31, 31
    s_cselect_b32 s14, s6, 0
    s_cselect_b32 s54, s36, s42
    v_mfma_f32_16x16x32_bf16 v[28:31], a[132:135], v[40:43], v[28:31]
    s_cmp_lt_i32 s31, 31
    s_cselect_b64 s[24:25], s[4:5], s[80:81]
    s_cselect_b32 s26, s6, 0x400000
    v_mfma_f32_16x16x32_bf16 v[32:35], a[136:139], v[40:43], v[32:35]
    ds_read_b128 v[60:63], v3 offset:13312
    v_mfma_f32_16x16x32_bf16 v[32:35], a[152:155], v[44:47], v[32:35]
    buffer_load_dwordx4 v1, s[8:11], s33 offen offset:2048 sc1 lds
    v_mfma_f32_16x16x32_bf16 v[36:39], a[156:159], v[44:47], v[36:39]
    s_cmp_lt_i32 s31, 31
    s_cselect_b64 s[48:49], 0, -1
    v_cndmask_b32 v204, v210, v216, s[48:49]
    v_mfma_f32_16x16x32_bf16 v[36:39], a[140:143], v[40:43], v[36:39]
    s_waitcnt lgkmcnt(2)
    v_cndmask_b32 v205, v211, v217, s[48:49]
    v_cndmask_b32 v206, v212, v218, s[48:49]
    v_mfma_f32_16x16x32_bf16 v[36:39], a[172:175], v[48:51], v[36:39]
    ds_read_b128 v[64:67], v3 offset:14336
    v_cndmask_b32 v207, v213, v219, s[48:49]
    v_mfma_f32_16x16x32_bf16 v[36:39], a[188:191], v[52:55], v[36:39]
    buffer_load_dwordx4 v1, s[8:11], s33 offen offset:3072 sc1 lds
    v_mfma_f32_16x16x32_bf16 v[32:35], a[184:187], v[52:55], v[32:35]
    s_add_u32 s32, s32, 1
    s_add_u32 s40, s40, 131072
    s_add_u32 s33, s33, 116736
    v_mfma_f32_16x16x32_bf16 v[32:35], a[168:171], v[48:51], v[32:35]
    s_add_u32 s34, s34, 36864
    s_cmp_ge_u32 s34, 147456
    s_cselect_b32 s38, 147456, 0
    v_mfma_f32_16x16x32_bf16 v[28:31], a[164:167], v[48:51], v[28:31]
    ds_read_b128 v[68:71], v3 offset:15360
    s_sub_u32 s34, s34, s38
    v_mfma_f32_16x16x32_bf16 v[28:31], a[180:183], v[52:55], v[28:31]
    s_cmp_ge_i32 s32, 63
    s_cselect_b32 s18, 0xffff, s18
    v_cndmask_b32 v208, v214, v220, s[48:49]
    v_mfma_f32_16x16x32_bf16 v[24:27], a[176:179], v[52:55], v[24:27]
    buffer_load_dwordx4 v[180:183], v1, s[4:7], s41 offen offset:0 sc1
    v_mfma_f32_16x16x32_bf16 v[24:27], a[160:163], v[48:51], v[24:27]
    s_waitcnt lgkmcnt(2)
    v_cndmask_b32 v209, v215, v221, s[48:49]
    s_add_u32 s35, s35, 36864
    v_mfma_f32_16x16x32_bf16 v[24:27], a[192:195], v[56:59], v[24:27]
    s_cmp_eq_u32 s35, 147456
    s_cselect_b32 s35, 0, s35
    v_mfma_f32_16x16x32_bf16 v[24:27], a[208:211], v[60:63], v[24:27]
    v_mfma_f32_16x16x32_bf16 v[28:31], a[212:215], v[60:63], v[28:31]
    buffer_load_dwordx4 v[184:187], v1, s[4:7], s41 offen offset:1024 sc1
    v_mfma_f32_16x16x32_bf16 v[28:31], a[196:199], v[56:59], v[28:31]
    s_add_u32 s41, s41, 36864
    v_mfma_f32_16x16x32_bf16 v[32:35], a[200:203], v[56:59], v[32:35]
    v_mfma_f32_16x16x32_bf16 v[32:35], a[216:219], v[60:63], v[32:35]
    v_mfma_f32_16x16x32_bf16 v[36:39], a[220:223], v[60:63], v[36:39]
    v_mfma_f32_16x16x32_bf16 v[36:39], a[204:207], v[56:59], v[36:39]
    s_waitcnt lgkmcnt(0)
    v_mfma_f32_16x16x32_bf16 v[36:39], a[236:239], v[64:67], v[36:39]
    v_mfma_f32_16x16x32_bf16 v[36:39], a[252:255], v[68:71], v[36:39]
    v_mfma_f32_16x16x32_bf16 v[32:35], a[248:251], v[68:71], v[32:35]
    v_mfma_f32_16x16x32_bf16 v[32:35], a[232:235], v[64:67], v[32:35]
    v_mfma_f32_16x16x32_bf16 v[28:31], a[228:231], v[64:67], v[28:31]
    v_mfma_f32_16x16x32_bf16 v[28:31], a[244:247], v[68:71], v[28:31]
    v_mfma_f32_16x16x32_bf16 v[24:27], a[240:243], v[68:71], v[24:27]
    v_mfma_f32_16x16x32_bf16 v[24:27], a[224:227], v[64:67], v[24:27]
    s_waitcnt vmcnt(19)
    v_mfma_f32_16x16x32_bf16 v[24:27], v[96:99], v[188:191], v[24:27]
    v_mfma_f32_16x16x32_bf16 v[28:31], v[94:97], v[188:191], v[28:31]
    v_mfma_f32_16x16x32_bf16 v[32:35], v[96:99], v[192:195], v[32:35]
    v_mfma_f32_16x16x32_bf16 v[36:39], v[94:97], v[192:195], v[36:39]
    s_cmp_lt_i32 s31, 63
    s_cbranch_scc1 Lred_run1
    s_branch L_exit
Lred_run1:
    s_waitcnt vmcnt(17)
    v_mfma_f32_16x16x32_bf16 v[36:39], v[94:97], v[152:155], v[36:39]
    s_barrier
    v_mfma_f32_16x16x32_bf16 v[32:35], v[96:99], v[152:155], v[32:35]
    s_waitcnt vmcnt(9)
    v_add_u32 v2, s35, v1
    v_cmp_gt_i32 vcc, s32, v5
    v_mfma_f32_16x16x32_bf16 v[28:31], v[94:97], v[148:151], v[28:31]
    v_mfma_f32_16x16x32_bf16 v[24:27], v[96:99], v[148:151], v[24:27]
    s_and_b64 vcc, vcc, s[18:19]
    s_cbranch_scc1 Lred_v11
    v_mfma_f32_16x16x32_bf16 v[24:27], v[96:99], v[156:159], v[24:27]
    s_add_u32 s16, s16, 8192
    v_mfma_f32_16x16x32_bf16 v[28:31], v[94:97], v[156:159], v[28:31]
    buffer_load_dwordx4 v[116:119], v1, s[4:7], s40 offen offset:0 sc1
    v_mfma_f32_16x16x32_bf16 v[32:35], v[96:99], v[160:163], v[32:35]
    ds_read_b128 v[40:43], v2 offset:0
    s_add_u32 s31, s31, 1
    v_mfma_f32_16x16x32_bf16 v[36:39], v[94:97], v[160:163], v[36:39]
    v_mov_b32 v6, s31
    v_mfma_f32_16x16x32_bf16 v[36:39], v[94:97], v[168:171], v[36:39]
    ds_read_b128 v[44:47], v2 offset:1024
    s_waitcnt vmcnt(7)
    v_mfma_f32_16x16x32_bf16 v[32:35], v[96:99], v[168:171], v[32:35]
    buffer_load_dwordx4 v[120:123], v1, s[4:7], s40 offen offset:1024 sc1
    v_mfma_f32_16x16x32_bf16 v[28:31], v[94:97], v[164:167], v[28:31]
    ds_read_b128 v[48:51], v2 offset:2048
    s_add_u32 s37, s40, 32768
    v_mfma_f32_16x16x32_bf16 v[24:27], v[96:99], v[164:167], v[24:27]
    buffer_store_dword v6, v80, s[20:23], s17 offen sc1
    s_add_u32 s17, s17, 8192
    v_mfma_f32_16x16x32_bf16 v[24:27], v[96:99], v[172:175], v[24:27]
    ds_read_b128 v[52:55], v2 offset:3072
    v_mfma_f32_16x16x32_bf16 v[28:31], v[94:97], v[172:175], v[28:31]
    buffer_load_dwordx4 v[124:127], v1, s[4:7], s37 offen offset:0 sc1
    v_mfma_f32_16x16x32_bf16 v[32:35], v[96:99], v[176:179], v[32:35]
    v_mfma_f32_16x16x32_bf16 v[36:39], v[94:97], v[176:179], v[36:39]
    s_waitcnt lgkmcnt(2)
    v_mfma_f32_16x16x32_bf16 v[8:11], a[0:3], v[40:43], v[100:103]
    ds_read_b128 v[56:59], v2 offset:4096
    v_cvt_pk_bf16_f32 v72, v24, v25
    v_mfma_f32_16x16x32_bf16 v[8:11], a[16:19], v[44:47], v[8:11]
    buffer_load_dwordx4 v[128:131], v1, s[4:7], s37 offen offset:1024 sc1
    v_mfma_f32_16x16x32_bf16 v[12:15], a[20:23], v[44:47], v[104:107]
    s_add_u32 s37, s40, 65536
    v_cvt_pk_bf16_f32 v73, v26, v27
    v_mfma_f32_16x16x32_bf16 v[12:15], a[4:7], v[40:43], v[12:15]
    ds_write_b64 v204, v[72:73]
    v_mfma_f32_16x16x32_bf16 v[16:19], a[8:11], v[40:43], v[108:111]
    ds_read_b128 v[60:63], v2 offset:5120
    v_cvt_pk_bf16_f32 v74, v28, v29
    v_mfma_f32_16x16x32_bf16 v[16:19], a[24:27], v[44:47], v[16:19]
    buffer_load_dwordx4 v[132:135], v1, s[4:7], s37 offen offset:0 sc1
    v_mfma_f32_16x16x32_bf16 v[20:23], a[28:31], v[44:47], v[112:115]
    v_cvt_pk_bf16_f32 v75, v30, v31
    v_mfma_f32_16x16x32_bf16 v[20:23], a[12:15], v[40:43], v[20:23]
    s_waitcnt lgkmcnt(3)
    ds_write_b64 v205, v[74:75]
    v_mfma_f32_16x16x32_bf16 v[20:23], a[44:47], v[48:51], v[20:23]
    ds_read_b128 v[64:67], v2 offset:6144
    v_cvt_pk_bf16_f32 v76, v32, v33
    v_mfma_f32_16x16x32_bf16 v[20:23], a[60:63], v[52:55], v[20:23]
    buffer_load_dwordx4 v[136:139], v1, s[4:7], s37 offen offset:1024 sc1
    v_mfma_f32_16x16x32_bf16 v[16:19], a[56:59], v[52:55], v[16:19]
    s_add_u32 s37, s40, 98304
    v_cvt_pk_bf16_f32 v77, v34, v35
    v_mfma_f32_16x16x32_bf16 v[16:19], a[40:43], v[48:51], v[16:19]
    ds_write_b64 v206, v[76:77]
    v_mfma_f32_16x16x32_bf16 v[12:15], a[36:39], v[48:51], v[12:15]
    ds_read_b128 v[68:71], v2 offset:7168
    v_cvt_pk_bf16_f32 v78, v36, v37
    v_mfma_f32_16x16x32_bf16 v[12:15], a[52:55], v[52:55], v[12:15]
    buffer_load_dwordx4 v[140:143], v1, s[4:7], s37 offen offset:0 sc1
    v_mfma_f32_16x16x32_bf16 v[8:11], a[48:51], v[52:55], v[8:11]
    v_cvt_pk_bf16_f32 v79, v38, v39
    v_mfma_f32_16x16x32_bf16 v[8:11], a[32:35], v[48:51], v[8:11]
    s_waitcnt lgkmcnt(4)
    ds_write_b64 v207, v[78:79]
    v_mfma_f32_16x16x32_bf16 v[8:11], a[64:67], v[56:59], v[8:11]
    ds_read_b128 v[40:43], v2 offset:8192
    v_mfma_f32_16x16x32_bf16 v[8:11], a[80:83], v[60:63], v[8:11]
    buffer_load_dwordx4 v[144:147], v1, s[4:7], s37 offen offset:1024 sc1
    v_mfma_f32_16x16x32_bf16 v[12:15], a[84:87], v[60:63], v[12:15]
    s_add_u32 m0, s34, 0
    ds_read_b128 v[196:199], v222 offset:0
    v_mfma_f32_16x16x32_bf16 v[12:15], a[68:71], v[56:59], v[12:15]
    ds_read_b128 v[200:203], v222 offset:1024
    v_mfma_f32_16x16x32_bf16 v[86:89], v[72:75], v[72:75], 0
    v_mfma_f32_16x16x32_bf16 v[82:85], v[90:93], v[72:75], 0
    buffer_load_dword v5, v4, s[4:7], s16 offen sc1
    v_mfma_f32_16x16x32_bf16 v[86:89], v[76:79], v[76:79], v[86:89]
    v_mfma_f32_16x16x32_bf16 v[82:85], v[90:93], v[76:79], v[82:85]
    s_waitcnt lgkmcnt(1)
    v_mfma_f32_16x16x32_bf16 v[16:19], a[72:75], v[56:59], v[16:19]
    ds_read_b128 v[44:47], v2 offset:9216
    v_mfma_f32_16x16x32_bf16 v[16:19], a[88:91], v[60:63], v[16:19]
    buffer_store_dwordx4 v[196:199], v208, s[24:27], s54 offen sc1
    s_waitcnt lgkmcnt(1)
    v_mfma_f32_16x16x32_bf16 v[20:23], a[92:95], v[60:63], v[20:23]
    v_mfma_f32_16x16x32_bf16 v[20:23], a[76:79], v[56:59], v[20:23]
    v_mfma_f32_16x16x32_bf16 v[20:23], a[108:111], v[64:67], v[20:23]
    ds_read_b128 v[48:51], v2 offset:10240
    v_mfma_f32_16x16x32_bf16 v[20:23], a[124:127], v[68:71], v[20:23]
    buffer_store_dwordx4 v[200:203], v209, s[24:27], s54 offen sc1
    v_cndmask_b32 v86, v86, v87, s[44:45]
    v_mfma_f32_16x16x32_bf16 v[16:19], a[120:123], v[68:71], v[16:19]
    v_cndmask_b32 v88, v88, v89, s[44:45]
    v_cndmask_b32 v83, v86, v88, s[46:47]
    v_mfma_f32_16x16x32_bf16 v[16:19], a[104:107], v[64:67], v[16:19]
    buffer_store_dwordx2 v[82:83], v7, s[12:15], s36 offen offset:0 sc1
    s_mov_b32 s22, s14
    v_mfma_f32_16x16x32_bf16 v[12:15], a[100:103], v[64:67], v[12:15]
    ds_read_b128 v[52:55], v2 offset:11264
    s_add_u32 s36, s36, 34816
    v_mfma_f32_16x16x32_bf16 v[12:15], a[116:119], v[68:71], v[12:15]
    buffer_load_dwordx4 v1, s[8:11], s33 offen offset:0 sc1 lds
    v_mfma_f32_16x16x32_bf16 v[8:11], a[112:115], v[68:71], v[8:11]
    s_sub_u32 s42, s42, 32768
    v_mfma_f32_16x16x32_bf16 v[8:11], a[96:99], v[64:67], v[8:11]
    s_waitcnt lgkmcnt(2)
    v_mfma_f32_16x16x32_bf16 v[8:11], a[128:131], v[40:43], v[8:11]
    ds_read_b128 v[56:59], v2 offset:12288
    v_mfma_f32_16x16x32_bf16 v[8:11], a[144:147], v[44:47], v[8:11]
    buffer_load_dwordx4 v1, s[8:11], s33 offen offset:1024 sc1 lds
    v_mfma_f32_16x16x32_bf16 v[12:15], a[148:151], v[44:47], v[12:15]
    s_cmp_lt_i32 s31, 31
    s_cselect_b32 s14, s6, 0
    s_cselect_b32 s54, s36, s42
    v_mfma_f32_16x16x32_bf16 v[12:15], a[132:135], v[40:43], v[12:15]
    s_cmp_lt_i32 s31, 31
    s_cselect_b64 s[24:25], s[4:5], s[80:81]
    s_cselect_b32 s26, s6, 0x400000
    v_mfma_f32_16x16x32_bf16 v[16:19], a[136:139], v[40:43], v[16:19]
    ds_read_b128 v[60:63], v2 offset:13312
    v_mfma_f32_16x16x32_bf16 v[16:19], a[152:155], v[44:47], v[16:19]
    buffer_load_dwordx4 v1, s[8:11], s33 offen offset:2048 sc1 lds
    v_mfma_f32_16x16x32_bf16 v[20:23], a[156:159], v[44:47], v[20:23]
    s_cmp_lt_i32 s31, 31
    s_cselect_b64 s[48:49], 0, -1
    v_cndmask_b32 v204, v210, v216, s[48:49]
    v_mfma_f32_16x16x32_bf16 v[20:23], a[140:143], v[40:43], v[20:23]
    s_waitcnt lgkmcnt(2)
    v_cndmask_b32 v205, v211, v217, s[48:49]
    v_cndmask_b32 v206, v212, v218, s[48:49]
    v_mfma_f32_16x16x32_bf16 v[20:23], a[172:175], v[48:51], v[20:23]
    ds_read_b128 v[64:67], v2 offset:14336
    v_cndmask_b32 v207, v213, v219, s[48:49]
    v_mfma_f32_16x16x32_bf16 v[20:23], a[188:191], v[52:55], v[20:23]
    buffer_load_dwordx4 v1, s[8:11], s33 offen offset:3072 sc1 lds
    v_mfma_f32_16x16x32_bf16 v[16:19], a[184:187], v[52:55], v[16:19]
    s_add_u32 s32, s32, 1
    s_add_u32 s40, s40, 131072
    s_add_u32 s33, s33, 116736
    v_mfma_f32_16x16x32_bf16 v[16:19], a[168:171], v[48:51], v[16:19]
    s_add_u32 s34, s34, 36864
    s_cmp_ge_u32 s34, 147456
    s_cselect_b32 s38, 147456, 0
    v_mfma_f32_16x16x32_bf16 v[12:15], a[164:167], v[48:51], v[12:15]
    ds_read_b128 v[68:71], v2 offset:15360
    s_sub_u32 s34, s34, s38
    v_mfma_f32_16x16x32_bf16 v[12:15], a[180:183], v[52:55], v[12:15]
    s_cmp_ge_i32 s32, 63
    s_cselect_b32 s18, 0xffff, s18
    v_cndmask_b32 v208, v214, v220, s[48:49]
    v_mfma_f32_16x16x32_bf16 v[8:11], a[176:179], v[52:55], v[8:11]
    buffer_load_dwordx4 v[188:191], v1, s[4:7], s41 offen offset:0 sc1
    v_mfma_f32_16x16x32_bf16 v[8:11], a[160:163], v[48:51], v[8:11]
    s_waitcnt lgkmcnt(2)
    v_cndmask_b32 v209, v215, v221, s[48:49]
    s_add_u32 s35, s35, 36864
    v_mfma_f32_16x16x32_bf16 v[8:11], a[192:195], v[56:59], v[8:11]
    s_cmp_eq_u32 s35, 147456
    s_cselect_b32 s35, 0, s35
    v_mfma_f32_16x16x32_bf16 v[8:11], a[208:211], v[60:63], v[8:11]
    v_mfma_f32_16x16x32_bf16 v[12:15], a[212:215], v[60:63], v[12:15]
    buffer_load_dwordx4 v[192:195], v1, s[4:7], s41 offen offset:1024 sc1
    v_mfma_f32_16x16x32_bf16 v[12:15], a[196:199], v[56:59], v[12:15]
    s_add_u32 s41, s41, 36864
    v_mfma_f32_16x16x32_bf16 v[16:19], a[200:203], v[56:59], v[16:19]
    v_mfma_f32_16x16x32_bf16 v[16:19], a[216:219], v[60:63], v[16:19]
    v_mfma_f32_16x16x32_bf16 v[20:23], a[220:223], v[60:63], v[20:23]
    v_mfma_f32_16x16x32_bf16 v[20:23], a[204:207], v[56:59], v[20:23]
    s_waitcnt lgkmcnt(0)
    v_mfma_f32_16x16x32_bf16 v[20:23], a[236:239], v[64:67], v[20:23]
    v_mfma_f32_16x16x32_bf16 v[20:23], a[252:255], v[68:71], v[20:23]
    v_mfma_f32_16x16x32_bf16 v[16:19], a[248:251], v[68:71], v[16:19]
    v_mfma_f32_16x16x32_bf16 v[16:19], a[232:235], v[64:67], v[16:19]
    v_mfma_f32_16x16x32_bf16 v[12:15], a[228:231], v[64:67], v[12:15]
    v_mfma_f32_16x16x32_bf16 v[12:15], a[244:247], v[68:71], v[12:15]
    v_mfma_f32_16x16x32_bf16 v[8:11], a[240:243], v[68:71], v[8:11]
    v_mfma_f32_16x16x32_bf16 v[8:11], a[224:227], v[64:67], v[8:11]
    s_waitcnt vmcnt(19)
    v_mfma_f32_16x16x32_bf16 v[8:11], v[96:99], v[180:183], v[8:11]
    v_mfma_f32_16x16x32_bf16 v[12:15], v[94:97], v[180:183], v[12:15]
    v_mfma_f32_16x16x32_bf16 v[16:19], v[96:99], v[184:187], v[16:19]
    v_mfma_f32_16x16x32_bf16 v[20:23], v[94:97], v[184:187], v[20:23]
    s_cmp_lt_i32 s31, 63
    s_cbranch_scc1 Lred_run0
    s_branch L_exit
Lred_top0:
    s_waitcnt vmcnt(10)
    v_mfma_f32_16x16x32_bf16 v[20:23], v[94:97], v[120:123], v[20:23]
    s_barrier
    v_mfma_f32_16x16x32_bf16 v[16:19], v[96:99], v[120:123], v[16:19]
    s_waitcnt vmcnt(9)
    v_add_u32 v3, s35, v1
    v_cmp_gt_i32 vcc, s32, v5
    v_mfma_f32_16x16x32_bf16 v[12:15], v[94:97], v[116:119], v[12:15]
    v_mfma_f32_16x16x32_bf16 v[8:11], v[96:99], v[116:119], v[8:11]
    s_waitcnt vmcnt(8)
    s_and_b64 vcc, vcc, s[18:19]
    s_cbranch_scc1 Lred_v01
    v_mfma_f32_16x16x32_bf16 v[8:11], v[96:99], v[124:127], v[8:11]
    s_add_u32 s16, s16, 8192
    v_mfma_f32_16x16x32_bf16 v[12:15], v[94:97], v[124:127], v[12:15]
    buffer_load_dwordx4 v[148:151], v1, s[4:7], s40 offen offset:0 sc1
    v_mfma_f32_16x16x32_bf16 v[16:19], v[96:99], v[128:131], v[16:19]
    ds_read_b128 v[40:43], v3 offset:0
    s_add_u32 s31, s31, 1
    v_mfma_f32_16x16x32_bf16 v[20:23], v[94:97], v[128:131], v[20:23]
    s_waitcnt vmcnt(7)
    v_mov_b32 v6, s31
    v_mfma_f32_16x16x32_bf16 v[20:23], v[94:97], v[136:139], v[20:23]
    ds_read_b128 v[44:47], v3 offset:1024
    v_mfma_f32_16x16x32_bf16 v[16:19], v[96:99], v[136:139], v[16:19]
    buffer_load_dwordx4 v[152:155], v1, s[4:7], s40 offen offset:1024 sc1
    v_mfma_f32_16x16x32_bf16 v[12:15], v[94:97], v[132:135], v[12:15]
    ds_read_b128 v[48:51], v3 offset:2048
    s_add_u32 s37, s40, 32768
    v_mfma_f32_16x16x32_bf16 v[8:11], v[96:99], v[132:135], v[8:11]
    s_waitcnt vmcnt(6)
    buffer_store_dword v6, v80, s[20:23], s17 offen sc1
    v_mfma_f32_16x16x32_bf16 v[8:11], v[96:99], v[140:143], v[8:11]
    ds_read_b128 v[52:55], v3 offset:3072
    s_add_u32 s17, s17, 8192
    v_mfma_f32_16x16x32_bf16 v[12:15], v[94:97], v[140:143], v[12:15]
    buffer_load_dwordx4 v[156:159], v1, s[4:7], s37 offen offset:0 sc1
    v_mfma_f32_16x16x32_bf16 v[16:19], v[96:99], v[144:147], v[16:19]
    v_mfma_f32_16x16x32_bf16 v[20:23], v[94:97], v[144:147], v[20:23]
    s_waitcnt lgkmcnt(2)
    v_mfma_f32_16x16x32_bf16 v[24:27], a[0:3], v[40:43], v[100:103]
    ds_read_b128 v[56:59], v3 offset:4096
    v_cvt_pk_bf16_f32 v72, v8, v9
    v_mfma_f32_16x16x32_bf16 v[24:27], a[16:19], v[44:47], v[24:27]
    buffer_load_dwordx4 v[160:163], v1, s[4:7], s37 offen offset:1024 sc1
    v_mfma_f32_16x16x32_bf16 v[28:31], a[20:23], v[44:47], v[104:107]
    s_add_u32 s37, s40, 65536
    v_cvt_pk_bf16_f32 v73, v10, v11
    v_mfma_f32_16x16x32_bf16 v[28:31], a[4:7], v[40:43], v[28:31]
    ds_write_b64 v204, v[72:73]
    v_mfma_f32_16x16x32_bf16 v[32:35], a[8:11], v[40:43], v[108:111]
    ds_read_b128 v[60:63], v3 offset:5120
    v_cvt_pk_bf16_f32 v74, v12, v13
    v_mfma_f32_16x16x32_bf16 v[32:35], a[24:27], v[44:47], v[32:35]
    buffer_load_dwordx4 v[164:167], v1, s[4:7], s37 offen offset:0 sc1
    v_mfma_f32_16x16x32_bf16 v[36:39], a[28:31], v[44:47], v[112:115]
    v_cvt_pk_bf16_f32 v75, v14, v15
    v_mfma_f32_16x16x32_bf16 v[36:39], a[12:15], v[40:43], v[36:39]
    s_waitcnt lgkmcnt(3)
    ds_write_b64 v205, v[74:75]
    v_mfma_f32_16x16x32_bf16 v[36:39], a[44:47], v[48:51], v[36:39]
    ds_read_b128 v[64:67], v3 offset:6144
    v_cvt_pk_bf16_f32 v76, v16, v17
    v_mfma_f32_16x16x32_bf16 v[36:39], a[60:63], v[52:55], v[36:39]
    buffer_load_dwordx4 v[168:171], v1, s[4:7], s37 offen offset:1024 sc1
    v_mfma_f32_16x16x32_bf16 v[32:35], a[56:59], v[52:55], v[32:35]
    s_add_u32 s37, s40, 98304
    v_cvt_pk_bf16_f32 v77, v18, v19
    v_mfma_f32_16x16x32_bf16 v[32:35], a[40:43], v[48:51], v[32:35]
    ds_write_b64 v206, v[76:77]
    v_mfma_f32_16x16x32_bf16 v[28:31], a[36:39], v[48:51], v[28:31]
    ds_read_b128 v[68:71], v3 offset:7168
    v_cvt_pk_bf16_f32 v78, v20, v21
    v_mfma_f32_16x16x32_bf16 v[28:31], a[52:55], v[52:55], v[28:31]
    buffer_load_dwordx4 v[172:175], v1, s[4:7], s37 offen offset:0 sc1
    v_mfma_f32_16x16x32_bf16 v[24:27], a[48:51], v[52:55], v[24:27]
    v_cvt_pk_bf16_f32 v79, v22, v23
    v_mfma_f32_16x16x32_bf16 v[24:27], a[32:35], v[48:51], v[24:27]
    s_waitcnt lgkmcnt(4)
    ds_write_b64 v207, v[78:79]
    v_mfma_f32_16x16x32_bf16 v[24:27], a[64:67], v[56:59], v[24:27]
    ds_read_b128 v[40:43], v3 offset:8192
    v_mfma_f32_16x16x32_bf16 v[24:27], a[80:83], v[60:63], v[24:27]
    buffer_load_dwordx4 v[176:179], v1, s[4:7], s37 offen offset:1024 sc1
    v_mfma_f32_16x16x32_bf16 v[28:31], a[84:87], v[60:63], v[28:31]
    s_add_u32 m0, s34, 0
    ds_read_b128 v[196:199], v222 offset:0
    v_mfma_f32_16x16x32_bf16 v[28:31], a[68:71], v[56:59], v[28:31]
    ds_read_b128 v[200:203], v222 offset:1024
    v_mfma_f32_16x16x32_bf16 v[86:89], v[72:75], v[72:75], 0
    v_mfma_f32_16x16x32_bf16 v[82:85], v[90:93], v[72:75], 0
    buffer_load_dword v5, v4, s[4:7], s16 offen sc1
    v_mfma_f32_16x16x32_bf16 v[86:89], v[76:79], v[76:79], v[86:89]
    v_mfma_f32_16x16x32_bf16 v[82:85], v[90:93], v[76:79], v[82:85]
    s_waitcnt lgkmcnt(1)
    v_mfma_f32_16x16x32_bf16 v[32:35], a[72:75], v[56:59], v[32:35]
    ds_read_b128 v[44:47], v3 offset:9216
    v_mfma_f32_16x16x32_bf16 v[32:35], a[88:91], v[60:63], v[32:35]
    buffer_store_dwordx4 v[196:199], v208, s[24:27], s54 offen sc1
    s_waitcnt lgkmcnt(1)
    v_mfma_f32_16x16x32_bf16 v[36:39], a[92:95], v[60:63], v[36:39]
    v_mfma_f32_16x16x32_bf16 v[36:39], a[76:79], v[56:59], v[36:39]
    v_mfma_f32_16x16x32_bf16 v[36:39], a[108:111], v[64:67], v[36:39]
    ds_read_b128 v[48:51], v3 offset:10240
    v_mfma_f32_16x16x32_bf16 v[36:39], a[124:127], v[68:71], v[36:39]
    buffer_store_dwordx4 v[200:203], v209, s[24:27], s54 offen sc1
    v_cndmask_b32 v86, v86, v87, s[44:45]
    v_mfma_f32_16x16x32_bf16 v[32:35], a[120:123], v[68:71], v[32:35]
    v_cndmask_b32 v88, v88, v89, s[44:45]
    v_cndmask_b32 v83, v86, v88, s[46:47]
    v_mfma_f32_16x16x32_bf16 v[32:35], a[104:107], v[64:67], v[32:35]
    buffer_store_dwordx2 v[82:83], v7, s[12:15], s36 offen offset:0 sc1
    s_mov_b32 s22, s14
    v_mfma_f32_16x16x32_bf16 v[28:31], a[100:103], v[64:67], v[28:31]
    ds_read_b128 v[52:55], v3 offset:11264
    s_add_u32 s36, s36, 34816
    v_mfma_f32_16x16x32_bf16 v[28:31], a[116:119], v[68:71], v[28:31]
    buffer_load_dwordx4 v1, s[8:11], s33 offen offset:0 sc1 lds
    v_mfma_f32_16x16x32_bf16 v[24:27], a[112:115], v[68:71], v[24:27]
    s_sub_u32 s42, s42, 32768
    v_mfma_f32_16x16x32_bf16 v[24:27], a[96:99], v[64:67], v[24:27]
    s_waitcnt lgkmcnt(2)
    v_mfma_f32_16x16x32_bf16 v[24:27], a[128:131], v[40:43], v[24:27]
    ds_read_b128 v[56:59], v3 offset:12288
    v_mfma_f32_16x16x32_bf16 v[24:27], a[144:147], v[44:47], v[24:27]
    buffer_load_dwordx4 v1, s[8:11], s33 offen offset:1024 sc1 lds
    v_mfma_f32_16x16x32_bf16 v[28:31], a[148:151], v[44:47], v[28:31]
    s_cmp_lt_i32 s31, 31
    s_cselect_b32 s14, s6, 0
    s_cselect_b32 s54, s36, s42
    v_mfma_f32_16x16x32_bf16 v[28:31], a[132:135], v[40:43], v[28:31]
    s_cmp_lt_i32 s31, 31
    s_cselect_b64 s[24:25], s[4:5], s[80:81]
    s_cselect_b32 s26, s6, 0x400000
    v_mfma_f32_16x16x32_bf16 v[32:35], a[136:139], v[40:43], v[32:35]
    ds_read_b128 v[60:63], v3 offset:13312
    v_mfma_f32_16x16x32_bf16 v[32:35], a[152:155], v[44:47], v[32:35]
    buffer_load_dwordx4 v1, s[8:11], s33 offen offset:2048 sc1 lds
    v_mfma_f32_16x16x32_bf16 v[36:39], a[156:159], v[44:47], v[36:39]
    s_cmp_lt_i32 s31, 31
    s_cselect_b64 s[48:49], 0, -1
    v_cndmask_b32 v204, v210, v216, s[48:49]
    v_mfma_f32_16x16x32_bf16 v[36:39], a[140:143], v[40:43], v[36:39]
    s_waitcnt lgkmcnt(2)
    v_cndmask_b32 v205, v211, v217, s[48:49]
    v_cndmask_b32 v206, v212, v218, s[48:49]
    v_mfma_f32_16x16x32_bf16 v[36:39], a[172:175], v[48:51], v[36:39]
    ds_read_b128 v[64:67], v3 offset:14336
    v_cndmask_b32 v207, v213, v219, s[48:49]
    v_mfma_f32_16x16x32_bf16 v[36:39], a[188:191], v[52:55], v[36:39]
    buffer_load_dwordx4 v1, s[8:11], s33 offen offset:3072 sc1 lds
    v_mfma_f32_16x16x32_bf16 v[32:35], a[184:187], v[52:55], v[32:35]
    s_add_u32 s32, s32, 1
    s_add_u32 s40, s40, 131072
    s_add_u32 s33, s33, 116736
    v_mfma_f32_16x16x32_bf16 v[32:35], a[168:171], v[48:51], v[32:35]
    s_add_u32 s34, s34, 36864
    s_cmp_ge_u32 s34, 147456
    s_cselect_b32 s38, 147456, 0
    v_mfma_f32_16x16x32_bf16 v[28:31], a[164:167], v[48:51], v[28:31]
    ds_read_b128 v[68:71], v3 offset:15360
    s_sub_u32 s34, s34, s38
    v_mfma_f32_16x16x32_bf16 v[28:31], a[180:183], v[52:55], v[28:31]
    s_cmp_ge_i32 s32, 63
    s_cselect_b32 s18, 0xffff, s18
    v_cndmask_b32 v208, v214, v220, s[48:49]
    v_mfma_f32_16x16x32_bf16 v[24:27], a[176:179], v[52:55], v[24:27]
    buffer_load_dwordx4 v[180:183], v1, s[4:7], s41 offen offset:0 sc1
    v_mfma_f32_16x16x32_bf16 v[24:27], a[160:163], v[48:51], v[24:27]
    s_waitcnt lgkmcnt(2)
    v_cndmask_b32 v209, v215, v221, s[48:49]
    s_add_u32 s35, s35, 36864
    v_mfma_f32_16x16x32_bf16 v[24:27], a[192:195], v[56:59], v[24:27]
    s_cmp_eq_u32 s35, 147456
    s_cselect_b32 s35, 0, s35
    v_mfma_f32_16x16x32_bf16 v[24:27], a[208:211], v[60:63], v[24:27]
    v_mfma_f32_16x16x32_bf16 v[28:31], a[212:215], v[60:63], v[28:31]
    buffer_load_dwordx4 v[184:187], v1, s[4:7], s41 offen offset:1024 sc1
    v_mfma_f32_16x16x32_bf16 v[28:31], a[196:199], v[56:59], v[28:31]
    s_add_u32 s41, s41, 36864
    v_mfma_f32_16x16x32_bf16 v[32:35], a[200:203], v[56:59], v[32:35]
    v_mfma_f32_16x16x32_bf16 v[32:35], a[216:219], v[60:63], v[32:35]
    v_mfma_f32_16x16x32_bf16 v[36:39], a[220:223], v[60:63], v[36:39]
    v_mfma_f32_16x16x32_bf16 v[36:39], a[204:207], v[56:59], v[36:39]
    s_waitcnt lgkmcnt(0)
    v_mfma_f32_16x16x32_bf16 v[36:39], a[236:239], v[64:67], v[36:39]
    v_mfma_f32_16x16x32_bf16 v[36:39], a[252:255], v[68:71], v[36:39]
    v_mfma_f32_16x16x32_bf16 v[32:35], a[248:251], v[68:71], v[32:35]
    v_mfma_f32_16x16x32_bf16 v[32:35], a[232:235], v[64:67], v[32:35]
    v_mfma_f32_16x16x32_bf16 v[28:31], a[228:231], v[64:67], v[28:31]
    v_mfma_f32_16x16x32_bf16 v[28:31], a[244:247], v[68:71], v[28:31]
    v_mfma_f32_16x16x32_bf16 v[24:27], a[240:243], v[68:71], v[24:27]
    v_mfma_f32_16x16x32_bf16 v[24:27], a[224:227], v[64:67], v[24:27]
    s_waitcnt vmcnt(19)
    v_mfma_f32_16x16x32_bf16 v[24:27], v[96:99], v[188:191], v[24:27]
    v_mfma_f32_16x16x32_bf16 v[28:31], v[94:97], v[188:191], v[28:31]
    v_mfma_f32_16x16x32_bf16 v[32:35], v[96:99], v[192:195], v[32:35]
    v_mfma_f32_16x16x32_bf16 v[36:39], v[94:97], v[192:195], v[36:39]
    s_cmp_lt_i32 s31, 63
    s_cbranch_scc1 Lred_run1
    s_branch L_exit
Lred_v01:
    s_nop 1
    s_waitcnt vmcnt(8)
    v_mfma_f32_16x16x32_bf16 v[8:11], v[96:99], v[124:127], v[8:11]
    buffer_load_dword v5, v4, s[4:7], s16 offen sc1
    v_mfma_f32_16x16x32_bf16 v[12:15], v[94:97], v[124:127], v[12:15]
    s_add_u32 s31, s31, 1
    v_mov_b32 v6, s31
    v_mfma_f32_16x16x32_bf16 v[16:19], v[96:99], v[128:131], v[16:19]
    ds_read_b128 v[40:43], v3 offset:0
    v_mfma_f32_16x16x32_bf16 v[20:23], v[94:97], v[128:131], v[20:23]
    s_waitcnt vmcnt(7)
    v_mfma_f32_16x16x32_bf16 v[20:23], v[94:97], v[136:139], v[20:23]
    ds_read_b128 v[44:47], v3 offset:1024
    v_mfma_f32_16x16x32_bf16 v[16:19], v[96:99], v[136:139], v[16:19]
    buffer_store_dword v6, v80, s[20:23], s17 offen sc1
    s_add_u32 s17, s17, 8192
    v_mfma_f32_16x16x32_bf16 v[12:15], v[94:97], v[132:135], v[12:15]
    ds_read_b128 v[48:51], v3 offset:2048
    v_mfma_f32_16x16x32_bf16 v[8:11], v[96:99], v[132:135], v[8:11]
    s_waitcnt vmcnt(6)
    v_mfma_f32_16x16x32_bf16 v[8:11], v[96:99], v[140:143], v[8:11]
    ds_read_b128 v[52:55], v3 offset:3072
    v_mfma_f32_16x16x32_bf16 v[12:15], v[94:97], v[140:143], v[12:15]
    v_mfma_f32_16x16x32_bf16 v[16:19], v[96:99], v[144:147], v[16:19]
    v_mfma_f32_16x16x32_bf16 v[20:23], v[94:97], v[144:147], v[20:23]
    s_waitcnt lgkmcnt(2)
    v_mfma_f32_16x16x32_bf16 v[24:27], a[0:3], v[40:43], v[100:103]
    ds_read_b128 v[56:59], v3 offset:4096
    v_mfma_f32_16x16x32_bf16 v[24:27], a[16:19], v[44:47], v[24:27]
    v_cvt_pk_bf16_f32 v72, v8, v9
    v_cvt_pk_bf16_f32 v73, v10, v11
    v_mfma_f32_16x16x32_bf16 v[28:31], a[20:23], v[44:47], v[104:107]
    ds_write_b64 v204, v[72:73]
    v_mfma_f32_16x16x32_bf16 v[28:31], a[4:7], v[40:43], v[28:31]
    v_cvt_pk_bf16_f32 v74, v12, v13
    v_cvt_pk_bf16_f32 v75, v14, v15
    v_mfma_f32_16x16x32_bf16 v[32:35], a[8:11], v[40:43], v[108:111]
    ds_read_b128 v[60:63], v3 offset:5120
    v_mfma_f32_16x16x32_bf16 v[32:35], a[24:27], v[44:47], v[32:35]
    ds_write_b64 v205, v[74:75]
    v_mfma_f32_16x16x32_bf16 v[36:39], a[28:31], v[44:47], v[112:115]
    s_waitcnt vmcnt(1)
    v_cmp_gt_i32 vcc, s32, v5
    v_cvt_pk_bf16_f32 v76, v16, v17
    v_mfma_f32_16x16x32_bf16 v[36:39], a[12:15], v[40:43], v[36:39]
    s_waitcnt lgkmcnt(4)
    v_cvt_pk_bf16_f32 v77, v18, v19
    v_mfma_f32_16x16x32_bf16 v[36:39], a[44:47], v[48:51], v[36:39]
    ds_read_b128 v[64:67], v3 offset:6144
    v_mfma_f32_16x16x32_bf16 v[36:39], a[60:63], v[52:55], v[36:39]
    s_and_b64 vcc, vcc, s[18:19]
    s_cbranch_scc1 Lred_v02
    v_mfma_f32_16x16x32_bf16 v[32:35], a[56:59], v[52:55], v[32:35]
    s_add_u32 s16, s16, 8192
    v_mfma_f32_16x16x32_bf16 v[32:35], a[40:43], v[48:51], v[32:35]
    buffer_load_dwordx4 v[148:151], v1, s[4:7], s40 offen offset:0 sc1
    v_mfma_f32_16x16x32_bf16 v[28:31], a[36:39], v[48:51], v[28:31]
    ds_read_b128 v[68:71], v3 offset:7168
    v_mfma_f32_16x16x32_bf16 v[28:31], a[52:55], v[52:55], v[28:31]
    ds_write_b64 v206, v[76:77]
    v_mfma_f32_16x16x32_bf16 v[24:27], a[48:51], v[52:55], v[24:27]
    v_cvt_pk_bf16_f32 v78, v20, v21
    v_cvt_pk_bf16_f32 v79, v22, v23
    v_mfma_f32_16x16x32_bf16 v[24:27], a[32:35], v[48:51], v[24:27]
    s_waitcnt lgkmcnt(4)
    buffer_load_dwordx4 v[152:155], v1, s[4:7], s40 offen offset:1024 sc1
    v_mfma_f32_16x16x32_bf16 v[24:27], a[64:67], v[56:59], v[24:27]
    ds_read_b128 v[40:43], v3 offset:8192
    s_add_u32 s37, s40, 32768
    v_mfma_f32_16x16x32_bf16 v[24:27], a[80:83], v[60:63], v[24:27]
    ds_write_b64 v207, v[78:79]
    v_mfma_f32_16x16x32_bf16 v[28:31], a[84:87], v[60:63], v[28:31]
    ds_read_b128 v[196:199], v222 offset:0
    v_mfma_f32_16x16x32_bf16 v[28:31], a[68:71], v[56:59], v[28:31]
    buffer_load_dword v5, v4, s[4:7], s16 offen sc1
    v_mfma_f32_16x16x32_bf16 v[32:35], a[72:75], v[56:59], v[32:35]
    ds_read_b128 v[44:47], v3 offset:9216
    v_mfma_f32_16x16x32_bf16 v[32:35], a[88:91], v[60:63], v[32:35]
    ds_read_b128 v[200:203], v222 offset:1024
    v_mfma_f32_16x16x32_bf16 v[86:89], v[72:75], v[72:75], 0
    v_mfma_f32_16x16x32_bf16 v[82:85], v[90:93], v[72:75], 0
    buffer_load_dwordx4 v[156:159], v1, s[4:7], s37 offen offset:0 sc1
    v_mfma_f32_16x16x32_bf16 v[86:89], v[76:79], v[76:79], v[86:89]
    v_mfma_f32_16x16x32_bf16 v[82:85], v[90:93], v[76:79], v[82:85]
    s_waitcnt lgkmcnt(2)
    v_mfma_f32_16x16x32_bf16 v[36:39], a[92:95], v[60:63], v[36:39]
    v_mfma_f32_16x16x32_bf16 v[36:39], a[76:79], v[56:59], v[36:39]
    buffer_store_dwordx4 v[196:199], v208, s[24:27], s54 offen sc1
    s_waitcnt lgkmcnt(0)
    v_mfma_f32_16x16x32_bf16 v[36:39], a[108:111], v[64:67], v[36:39]
    ds_read_b128 v[48:51], v3 offset:10240
    v_mfma_f32_16x16x32_bf16 v[36:39], a[124:127], v[68:71], v[36:39]
    v_mfma_f32_16x16x32_bf16 v[32:35], a[120:123], v[68:71], v[32:35]
    v_mfma_f32_16x16x32_bf16 v[32:35], a[104:107], v[64:67], v[32:35]
    buffer_store_dwordx4 v[200:203], v209, s[24:27], s54 offen sc1
    v_cndmask_b32 v86, v86, v87, s[44:45]
    v_mfma_f32_16x16x32_bf16 v[28:31], a[100:103], v[64:67], v[28:31]
    ds_read_b128 v[52:55], v3 offset:11264
    v_cndmask_b32 v88, v88, v89, s[44:45]
    v_mfma_f32_16x16x32_bf16 v[28:31], a[116:119], v[68:71], v[28:31]
    v_cndmask_b32 v83, v86, v88, s[46:47]
    v_mfma_f32_16x16x32_bf16 v[24:27], a[112:115], v[68:71], v[24:27]
    buffer_store_dwordx2 v[82:83], v7, s[12:15], s36 offen offset:0 sc1
    s_mov_b32 s22, s14
    v_mfma_f32_16x16x32_bf16 v[24:27], a[96:99], v[64:67], v[24:27]
    buffer_load_dwordx4 v[160:163], v1, s[4:7], s37 offen offset:1024 sc1
    v_mfma_f32_16x16x32_bf16 v[24:27], a[128:131], v[40:43], v[24:27]
    ds_read_b128 v[56:59], v3 offset:12288
    s_add_u32 s37, s40, 65536
    v_mfma_f32_16x16x32_bf16 v[24:27], a[144:147], v[44:47], v[24:27]
    s_add_u32 s36, s36, 34816
    s_sub_u32 s42, s42, 32768
    v_mfma_f32_16x16x32_bf16 v[28:31], a[148:151], v[44:47], v[28:31]
    s_cmp_lt_i32 s31, 31
    s_cselect_b32 s14, s6, 0
    s_cselect_b32 s54, s36, s42
    v_mfma_f32_16x16x32_bf16 v[28:31], a[132:135], v[40:43], v[28:31]
    buffer_load_dwordx4 v[164:167], v1, s[4:7], s37 offen offset:0 sc1
    v_mfma_f32_16x16x32_bf16 v[32:35], a[136:139], v[40:43], v[32:35]
    ds_read_b128 v[60:63], v3 offset:13312
    v_mfma_f32_16x16x32_bf16 v[32:35], a[152:155], v[44:47], v[32:35]
    s_cmp_lt_i32 s31, 31
    s_cselect_b64 s[24:25], s[4:5], s[80:81]
    s_cselect_b32 s26, s6, 0x400000
    v_mfma_f32_16x16x32_bf16 v[36:39], a[156:159], v[44:47], v[36:39]
    s_cmp_lt_i32 s31, 31
    s_cselect_b64 s[48:49], 0, -1
    v_cndmask_b32 v204, v210, v216, s[48:49]
    v_mfma_f32_16x16x32_bf16 v[36:39], a[140:143], v[40:43], v[36:39]
    s_waitcnt lgkmcnt(2)
    buffer_load_dwordx4 v[168:171], v1, s[4:7], s37 offen offset:1024 sc1
    v_mfma_f32_16x16x32_bf16 v[36:39], a[172:175], v[48:51], v[36:39]
    ds_read_b128 v[64:67], v3 offset:14336
    s_add_u32 s37, s40, 98304
    v_mfma_f32_16x16x32_bf16 v[36:39], a[188:191], v[52:55], v[36:39]
    v_cndmask_b32 v205, v211, v217, s[48:49]
    v_cndmask_b32 v206, v212, v218, s[48:49]
    v_mfma_f32_16x16x32_bf16 v[32:35], a[184:187], v[52:55], v[32:35]
    v_cndmask_b32 v207, v213, v219, s[48:49]
    v_cndmask_b32 v208, v214, v220, s[48:49]
    v_mfma_f32_16x16x32_bf16 v[32:35], a[168:171], v[48:51], v[32:35]
    buffer_load_dwordx4 v[172:175], v1, s[4:7], s37 offen offset:0 sc1
    v_mfma_f32_16x16x32_bf16 v[28:31], a[164:167], v[48:51], v[28:31]
    ds_read_b128 v[68:71], v3 offset:15360
    v_cndmask_b32 v209, v215, v221, s[48:49]
    v_mfma_f32_16x16x32_bf16 v[28:31], a[180:183], v[52:55], v[28:31]
    s_add_u32 s35, s35, 36864
    s_cmp_eq_u32 s35, 147456
    s_cselect_b32 s35, 0, s35
    v_mfma_f32_16x16x32_bf16 v[24:27], a[176:179], v[52:55], v[24:27]
    v_mfma_f32_16x16x32_bf16 v[24:27], a[160:163], v[48:51], v[24:27]
    s_waitcnt lgkmcnt(2)
    buffer_load_dwordx4 v[176:179], v1, s[4:7], s37 offen offset:1024 sc1
    v_mfma_f32_16x16x32_bf16 v[24:27], a[192:195], v[56:59], v[24:27]
    s_add_u32 m0, s34, 0
    v_mfma_f32_16x16x32_bf16 v[24:27], a[208:211], v[60:63], v[24:27]
    v_mfma_f32_16x16x32_bf16 v[28:31], a[212:215], v[60:63], v[28:31]
    v_mfma_f32_16x16x32_bf16 v[28:31], a[196:199], v[56:59], v[28:31]
    buffer_load_dwordx4 v1, s[8:11], s33 offen offset:0 sc1 lds
    v_mfma_f32_16x16x32_bf16 v[32:35], a[200:203], v[56:59], v[32:35]
    v_mfma_f32_16x16x32_bf16 v[32:35], a[216:219], v[60:63], v[32:35]
    v_mfma_f32_16x16x32_bf16 v[36:39], a[220:223], v[60:63], v[36:39]
    v_mfma_f32_16x16x32_bf16 v[36:39], a[204:207], v[56:59], v[36:39]
    s_waitcnt lgkmcnt(0)
    buffer_load_dwordx4 v1, s[8:11], s33 offen offset:1024 sc1 lds
    v_mfma_f32_16x16x32_bf16 v[36:39], a[236:239], v[64:67], v[36:39]
    v_mfma_f32_16x16x32_bf16 v[36:39], a[252:255], v[68:71], v[36:39]
    v_mfma_f32_16x16x32_bf16 v[32:35], a[248:251], v[68:71], v[32:35]
    v_mfma_f32_16x16x32_bf16 v[32:35], a[232:235], v[64:67], v[32:35]
    buffer_load_dwordx4 v1, s[8:11], s33 offen offset:2048 sc1 lds
    v_mfma_f32_16x16x32_bf16 v[28:31], a[228:231], v[64:67], v[28:31]
    v_mfma_f32_16x16x32_bf16 v[28:31], a[244:247], v[68:71], v[28:31]
    v_mfma_f32_16x16x32_bf16 v[24:27], a[240:243], v[68:71], v[24:27]
    v_mfma_f32_16x16x32_bf16 v[24:27], a[224:227], v[64:67], v[24:27]
    buffer_load_dwordx4 v1, s[8:11], s33 offen offset:3072 sc1 lds
    v_mfma_f32_16x16x32_bf16 v[24:27], v[96:99], v[188:191], v[24:27]
    s_add_u32 s32, s32, 1
    s_add_u32 s40, s40, 131072
    s_add_u32 s33, s33, 116736
    v_mfma_f32_16x16x32_bf16 v[28:31], v[94:97], v[188:191], v[28:31]
    s_add_u32 s34, s34, 36864
    s_cmp_ge_u32 s34, 147456
    s_cselect_b32 s38, 147456, 0
    v_mfma_f32_16x16x32_bf16 v[32:35], v[96:99], v[192:195], v[32:35]
    s_sub_u32 s34, s34, s38
    s_cmp_ge_i32 s32, 63
    s_cselect_b32 s18, 0xffff, s18
    v_mfma_f32_16x16x32_bf16 v[36:39], v[94:97], v[192:195], v[36:39]
    buffer_load_dwordx4 v[180:183], v1, s[4:7], s41 offen offset:0 sc1
    buffer_load_dwordx4 v[184:187], v1, s[4:7], s41 offen offset:1024 sc1
    s_add_u32 s41, s41, 36864
    s_cmp_lt_i32 s31, 63
    s_cbranch_scc1 Lred_top1
    s_branch L_exit
Lred_v02:
    v_mfma_f32_16x16x32_bf16 v[32:35], a[56:59], v[52:55], v[32:35]
    buffer_load_dword v5, v4, s[4:7], s16 offen sc1
    v_mfma_f32_16x16x32_bf16 v[32:35], a[40:43], v[48:51], v[32:35]
    ds_write_b64 v206, v[76:77]
    v_mfma_f32_16x16x32_bf16 v[28:31], a[36:39], v[48:51], v[28:31]
    ds_read_b128 v[68:71], v3 offset:7168
    v_cvt_pk_bf16_f32 v78, v20, v21
    v_mfma_f32_16x16x32_bf16 v[28:31], a[52:55], v[52:55], v[28:31]
    v_cvt_pk_bf16_f32 v79, v22, v23
    v_mfma_f32_16x16x32_bf16 v[24:27], a[48:51], v[52:55], v[24:27]
    ds_write_b64 v207, v[78:79]
    v_mfma_f32_16x16x32_bf16 v[24:27], a[32:35], v[48:51], v[24:27]
    s_waitcnt lgkmcnt(5)
    ds_read_b128 v[196:199], v222 offset:0
    v_mfma_f32_16x16x32_bf16 v[24:27], a[64:67], v[56:59], v[24:27]
    ds_read_b128 v[40:43], v3 offset:8192
    v_mfma_f32_16x16x32_bf16 v[24:27], a[80:83], v[60:63], v[24:27]
    ds_read_b128 v[200:203], v222 offset:1024
    v_mfma_f32_16x16x32_bf16 v[86:89], v[72:75], v[72:75], 0
    buffer_load_dwordx4 v[180:183], v1, s[4:7], s41 offen offset:0 sc1
    v_mfma_f32_16x16x32_bf16 v[82:85], v[90:93], v[72:75], 0
    v_mfma_f32_16x16x32_bf16 v[86:89], v[76:79], v[76:79], v[86:89]
    v_mfma_f32_16x16x32_bf16 v[82:85], v[90:93], v[76:79], v[82:85]
    s_waitcnt lgkmcnt(2)
    v_mfma_f32_16x16x32_bf16 v[28:31], a[84:87], v[60:63], v[28:31]
    buffer_store_dwordx4 v[196:199], v208, s[24:27], s54 offen sc1
    s_waitcnt lgkmcnt(0)
    v_mfma_f32_16x16x32_bf16 v[28:31], a[68:71], v[56:59], v[28:31]
    v_mfma_f32_16x16x32_bf16 v[32:35], a[72:75], v[56:59], v[32:35]
    ds_read_b128 v[44:47], v3 offset:9216
    v_mfma_f32_16x16x32_bf16 v[32:35], a[88:91], v[60:63], v[32:35]
    v_mfma_f32_16x16x32_bf16 v[36:39], a[92:95], v[60:63], v[36:39]
    buffer_store_dwordx4 v[200:203], v209, s[24:27], s54 offen sc1
    v_cndmask_b32 v86, v86, v87, s[44:45]
    v_mfma_f32_16x16x32_bf16 v[36:39], a[76:79], v[56:59], v[36:39]
    v_cndmask_b32 v88, v88, v89, s[44:45]
    v_cndmask_b32 v83, v86, v88, s[46:47]
    v_mfma_f32_16x16x32_bf16 v[36:39], a[108:111], v[64:67], v[36:39]
    ds_read_b128 v[48:51], v3 offset:10240
    s_waitcnt vmcnt(3)
    v_mfma_f32_16x16x32_bf16 v[36:39], a[124:127], v[68:71], v[36:39]
    buffer_store_dwordx2 v[82:83], v7, s[12:15], s36 offen offset:0 sc1
    v_cmp_gt_i32 vcc, s32, v5
    v_mfma_f32_16x16x32_bf16 v[32:35], a[120:123], v[68:71], v[32:35]
    s_mov_b32 s22, s14
    s_add_u32 s36, s36, 34816
    s_sub_u32 s42, s42, 32768
    v_mfma_f32_16x16x32_bf16 v[32:35], a[104:107], v[64:67], v[32:35]
    s_and_b64 vcc, vcc, s[18:19]
    s_cbranch_scc1 Lred_v03
    v_mfma_f32_16x16x32_bf16 v[28:31], a[100:103], v[64:67], v[28:31]
    ds_read_b128 v[52:55], v3 offset:11264
    s_add_u32 s16, s16, 8192
    v_mfma_f32_16x16x32_bf16 v[28:31], a[116:119], v[68:71], v[28:31]
    buffer_load_dword v5, v4, s[4:7], s16 offen sc1
    v_mfma_f32_16x16x32_bf16 v[24:27], a[112:115], v[68:71], v[24:27]
    s_cmp_lt_i32 s31, 31
    s_cselect_b32 s14, s6, 0
    s_cselect_b32 s54, s36, s42
    v_mfma_f32_16x16x32_bf16 v[24:27], a[96:99], v[64:67], v[24:27]
    s_waitcnt lgkmcnt(2)
    v_mfma_f32_16x16x32_bf16 v[24:27], a[128:131], v[40:43], v[24:27]
    ds_read_b128 v[56:59], v3 offset:12288
    v_mfma_f32_16x16x32_bf16 v[24:27], a[144:147], v[44:47], v[24:27]
    buffer_load_dwordx4 v[148:151], v1, s[4:7], s40 offen offset:0 sc1
    v_mfma_f32_16x16x32_bf16 v[28:31], a[148:151], v[44:47], v[28:31]
    s_cmp_lt_i32 s31, 31
    s_cselect_b64 s[24:25], s[4:5], s[80:81]
    s_cselect_b32 s26, s6, 0x400000
    v_mfma_f32_16x16x32_bf16 v[28:31], a[132:135], v[40:43], v[28:31]
    s_cmp_lt_i32 s31, 31
    s_cselect_b64 s[48:49], 0, -1
    v_cndmask_b32 v204, v210, v216, s[48:49]
    v_mfma_f32_16x16x32_bf16 v[32:35], a[136:139], v[40:43], v[32:35]
    ds_read_b128 v[60:63], v3 offset:13312
    v_cndmask_b32 v205, v211, v217, s[48:49]
    v_mfma_f32_16x16x32_bf16 v[32:35], a[152:155], v[44:47], v[32:35]
    buffer_load_dwordx4 v[152:155], v1, s[4:7], s40 offen offset:1024 sc1
    v_mfma_f32_16x16x32_bf16 v[36:39], a[156:159], v[44:47], v[36:39]
    s_add_u32 s37, s40, 32768
    v_cndmask_b32 v206, v212, v218, s[48:49]
    v_cndmask_b32 v207, v213, v219, s[48:49]
    v_mfma_f32_16x16x32_bf16 v[36:39], a[140:143], v[40:43], v[36:39]
    s_waitcnt lgkmcnt(2)
    v_cndmask_b32 v208, v214, v220, s[48:49]
    v_cndmask_b32 v209, v215, v221, s[48:49]
    v_mfma_f32_16x16x32_bf16 v[36:39], a[172:175], v[48:51], v[36:39]
    ds_read_b128 v[64:67], v3 offset:14336
    s_add_u32 s35, s35, 36864
    v_mfma_f32_16x16x32_bf16 v[36:39], a[188:191], v[52:55], v[36:39]
    buffer_load_dwordx4 v[156:159], v1, s[4:7], s37 offen offset:0 sc1
    v_mfma_f32_16x16x32_bf16 v[32:35], a[184:187], v[52:55], v[32:35]
    s_cmp_eq_u32 s35, 147456
    s_cselect_b32 s35, 0, s35
    v_mfma_f32_16x16x32_bf16 v[32:35], a[168:171], v[48:51], v[32:35]
    v_mfma_f32_16x16x32_bf16 v[28:31], a[164:167], v[48:51], v[28:31]
    ds_read_b128 v[68:71], v3 offset:15360
    v_mfma_f32_16x16x32_bf16 v[28:31], a[180:183], v[52:55], v[28:31]
    buffer_load_dwordx4 v[160:163], v1, s[4:7], s37 offen offset:1024 sc1
    v_mfma_f32_16x16x32_bf16 v[24:27], a[176:179], v[52:55], v[24:27]
    s_add_u32 s37, s40, 65536
    v_mfma_f32_16x16x32_bf16 v[24:27], a[160:163], v[48:51], v[24:27]
    s_waitcnt lgkmcnt(2)
    v_mfma_f32_16x16x32_bf16 v[24:27], a[192:195], v[56:59], v[24:27]
    v_mfma_f32_16x16x32_bf16 v[24:27], a[208:211], v[60:63], v[24:27]
    buffer_load_dwordx4 v[164:167], v1, s[4:7], s37 offen offset:0 sc1
    v_mfma_f32_16x16x32_bf16 v[28:31], a[212:215], v[60:63], v[28:31]
    v_mfma_f32_16x16x32_bf16 v[28:31], a[196:199], v[56:59], v[28:31]
    v_mfma_f32_16x16x32_bf16 v[32:35], a[200:203], v[56:59], v[32:35]
    v_mfma_f32_16x16x32_bf16 v[32:35], a[216:219], v[60:63], v[32:35]
    buffer_load_dwordx4 v[168:171], v1, s[4:7], s37 offen offset:1024 sc1
    v_mfma_f32_16x16x32_bf16 v[36:39], a[220:223], v[60:63], v[36:39]
    s_add_u32 s37, s40, 98304
    v_mfma_f32_16x16x32_bf16 v[36:39], a[204:207], v[56:59], v[36:39]
    s_waitcnt lgkmcnt(0)
    v_mfma_f32_16x16x32_bf16 v[36:39], a[236:239], v[64:67], v[36:39]
    v_mfma_f32_16x16x32_bf16 v[36:39], a[252:255], v[68:71], v[36:39]
    buffer_load_dwordx4 v[172:175], v1, s[4:7], s37 offen offset:0 sc1
    v_mfma_f32_16x16x32_bf16 v[32:35], a[248:251], v[68:71], v[32:35]
    v_mfma_f32_16x16x32_bf16 v[32:35], a[232:235], v[64:67], v[32:35]
    v_mfma_f32_16x16x32_bf16 v[28:31], a[228:231], v[64:67], v[28:31]
    v_mfma_f32_16x16x32_bf16 v[28:31], a[244:247], v[68:71], v[28:31]
    buffer_load_dwordx4 v[176:179], v1, s[4:7], s37 offen offset:1024 sc1
    v_mfma_f32_16x16x32_bf16 v[24:27], a[240:243], v[68:71], v[24:27]
    s_add_u32 m0, s34, 0
    v_mfma_f32_16x16x32_bf16 v[24:27], a[224:227], v[64:67], v[24:27]
    v_mfma_f32_16x16x32_bf16 v[24:27], v[96:99], v[188:191], v[24:27]
    v_mfma_f32_16x16x32_bf16 v[28:31], v[94:97], v[188:191], v[28:31]
    buffer_load_dwordx4 v1, s[8:11], s33 offen offset:0 sc1 lds
    v_mfma_f32_16x16x32_bf16 v[32:35], v[96:99], v[192:195], v[32:35]
    v_mfma_f32_16x16x32_bf16 v[36:39], v[94:97], v[192:195], v[36:39]
    buffer_load_dwordx4 v1, s[8:11], s33 offen offset:1024 sc1 lds
    buffer_load_dwordx4 v1, s[8:11], s33 offen offset:2048 sc1 lds
    buffer_load_dwordx4 v1, s[8:11], s33 offen offset:3072 sc1 lds
    s_add_u32 s32, s32, 1
    s_add_u32 s40, s40, 131072
    s_add_u32 s33, s33, 116736
    s_add_u32 s34, s34, 36864
    s_cmp_ge_u32 s34, 147456
    s_cselect_b32 s38, 147456, 0
    s_sub_u32 s34, s34, s38
    s_cmp_ge_i32 s32, 63
    s_cselect_b32 s18, 0xffff, s18
    buffer_load_dwordx4 v[184:187], v1, s[4:7], s41 offen offset:1024 sc1
    s_add_u32 s41, s41, 36864
    s_cmp_lt_i32 s31, 63
    s_cbranch_scc1 Lred_top1
    s_branch L_exit
Lred_v03:
    v_mfma_f32_16x16x32_bf16 v[28:31], a[100:103], v[64:67], v[28:31]
    ds_read_b128 v[52:55], v3 offset:11264
    v_mfma_f32_16x16x32_bf16 v[28:31], a[116:119], v[68:71], v[28:31]
    buffer_load_dword v5, v4, s[4:7], s16 offen sc1
    v_mfma_f32_16x16x32_bf16 v[24:27], a[112:115], v[68:71], v[24:27]
    s_cmp_lt_i32 s31, 31
    s_cselect_b32 s14, s6, 0
    s_cselect_b32 s54, s36, s42
    v_mfma_f32_16x16x32_bf16 v[24:27], a[96:99], v[64:67], v[24:27]
    s_waitcnt lgkmcnt(2)
    v_mfma_f32_16x16x32_bf16 v[24:27], a[128:131], v[40:43], v[24:27]
    ds_read_b128 v[56:59], v3 offset:12288
    v_mfma_f32_16x16x32_bf16 v[24:27], a[144:147], v[44:47], v[24:27]
    s_cmp_lt_i32 s31, 31
    s_cselect_b64 s[24:25], s[4:5], s[80:81]
    s_cselect_b32 s26, s6, 0x400000
    v_mfma_f32_16x16x32_bf16 v[28:31], a[148:151], v[44:47], v[28:31]
    s_cmp_lt_i32 s31, 31
    s_cselect_b64 s[48:49], 0, -1
    v_cndmask_b32 v204, v210, v216, s[48:49]
    v_mfma_f32_16x16x32_bf16 v[28:31], a[132:135], v[40:43], v[28:31]
    buffer_load_dwordx4 v[184:187], v1, s[4:7], s41 offen offset:1024 sc1
    v_mfma_f32_16x16x32_bf16 v[32:35], a[136:139], v[40:43], v[32:35]
    ds_read_b128 v[60:63], v3 offset:13312
    v_cndmask_b32 v205, v211, v217, s[48:49]
    v_mfma_f32_16x16x32_bf16 v[32:35], a[152:155], v[44:47], v[32:35]
    s_add_u32 s41, s41, 36864
    v_cndmask_b32 v206, v212, v218, s[48:49]
    v_cndmask_b32 v207, v213, v219, s[48:49]
    v_mfma_f32_16x16x32_bf16 v[36:39], a[156:159], v[44:47], v[36:39]
    v_cndmask_b32 v208, v214, v220, s[48:49]
    v_cndmask_b32 v209, v215, v221, s[48:49]
    v_mfma_f32_16x16x32_bf16 v[36:39], a[140:143], v[40:43], v[36:39]
    s_waitcnt lgkmcnt(2)
    s_add_u32 s35, s35, 36864
    v_mfma_f32_16x16x32_bf16 v[36:39], a[172:175], v[48:51], v[36:39]
    ds_read_b128 v[64:67], v3 offset:14336
    v_mfma_f32_16x16x32_bf16 v[36:39], a[188:191], v[52:55], v[36:39]
    s_cmp_eq_u32 s35, 147456
    s_cselect_b32 s35, 0, s35
    v_mfma_f32_16x16x32_bf16 v[32:35], a[184:187], v[52:55], v[32:35]
    v_mfma_f32_16x16x32_bf16 v[32:35], a[168:171], v[48:51], v[32:35]
    v_mfma_f32_16x16x32_bf16 v[28:31], a[164:167], v[48:51], v[28:31]
    ds_read_b128 v[68:71], v3 offset:15360
    v_mfma_f32_16x16x32_bf16 v[28:31], a[180:183], v[52:55], v[28:31]
    v_mfma_f32_16x16x32_bf16 v[24:27], a[176:179], v[52:55], v[24:27]
    v_mfma_f32_16x16x32_bf16 v[24:27], a[160:163], v[48:51], v[24:27]
    s_waitcnt vmcnt(1) lgkmcnt(2)
    v_cmp_gt_i32 vcc, s32, v5
    v_mfma_f32_16x16x32_bf16 v[24:27], a[192:195], v[56:59], v[24:27]
    v_mfma_f32_16x16x32_bf16 v[24:27], a[208:211], v[60:63], v[24:27]
    s_and_b64 vcc, vcc, s[18:19]
    s_cbranch_scc1 Lred_v04
    v_mfma_f32_16x16x32_bf16 v[28:31], a[212:215], v[60:63], v[28:31]
    s_add_u32 s16, s16, 8192
    v_mfma_f32_16x16x32_bf16 v[28:31], a[196:199], v[56:59], v[28:31]
    buffer_load_dword v5, v4, s[4:7], s16 offen sc1
    v_mfma_f32_16x16x32_bf16 v[32:35], a[200:203], v[56:59], v[32:35]
    v_mfma_f32_16x16x32_bf16 v[32:35], a[216:219], v[60:63], v[32:35]
    v_mfma_f32_16x16x32_bf16 v[36:39], a[220:223], v[60:63], v[36:39]
    v_mfma_f32_16x16x32_bf16 v[36:39], a[204:207], v[56:59], v[36:39]
    s_waitcnt lgkmcnt(0)
    buffer_load_dwordx4 v[148:151], v1, s[4:7], s40 offen offset:0 sc1
    v_mfma_f32_16x16x32_bf16 v[36:39], a[236:239], v[64:67], v[36:39]
    v_mfma_f32_16x16x32_bf16 v[36:39], a[252:255], v[68:71], v[36:39]
    v_mfma_f32_16x16x32_bf16 v[32:35], a[248:251], v[68:71], v[32:35]
    v_mfma_f32_16x16x32_bf16 v[32:35], a[232:235], v[64:67], v[32:35]
    buffer_load_dwordx4 v[152:155], v1, s[4:7], s40 offen offset:1024 sc1
    v_mfma_f32_16x16x32_bf16 v[28:31], a[228:231], v[64:67], v[28:31]
    s_add_u32 s37, s40, 32768
    v_mfma_f32_16x16x32_bf16 v[28:31], a[244:247], v[68:71], v[28:31]
    v_mfma_f32_16x16x32_bf16 v[24:27], a[240:243], v[68:71], v[24:27]
    v_mfma_f32_16x16x32_bf16 v[24:27], a[224:227], v[64:67], v[24:27]
    buffer_load_dwordx4 v[156:159], v1, s[4:7], s37 offen offset:0 sc1
    v_mfma_f32_16x16x32_bf16 v[24:27], v[96:99], v[188:191], v[24:27]
    v_mfma_f32_16x16x32_bf16 v[28:31], v[94:97], v[188:191], v[28:31]
    v_mfma_f32_16x16x32_bf16 v[32:35], v[96:99], v[192:195], v[32:35]
    v_mfma_f32_16x16x32_bf16 v[36:39], v[94:97], v[192:195], v[36:39]
    buffer_load_dwordx4 v[160:163], v1, s[4:7], s37 offen offset:1024 sc1
    s_add_u32 s37, s40, 65536
    buffer_load_dwordx4 v[164:167], v1, s[4:7], s37 offen offset:0 sc1
    buffer_load_dwordx4 v[168:171], v1, s[4:7], s37 offen offset:1024 sc1
    s_add_u32 s37, s40, 98304
    buffer_load_dwordx4 v[172:175], v1, s[4:7], s37 offen offset:0 sc1
    buffer_load_dwordx4 v[176:179], v1, s[4:7], s37 offen offset:1024 sc1
    s_add_u32 m0, s34, 0
    s_nop 0
    buffer_load_dwordx4 v1, s[8:11], s33 offen offset:0 sc1 lds
    buffer_load_dwordx4 v1, s[8:11], s33 offen offset:1024 sc1 lds
    buffer_load_dwordx4 v1, s[8:11], s33 offen offset:2048 sc1 lds
    buffer_load_dwordx4 v1, s[8:11], s33 offen offset:3072 sc1 lds
    s_add_u32 s32, s32, 1
    s_add_u32 s40, s40, 131072
    s_add_u32 s33, s33, 116736
    s_add_u32 s34, s34, 36864
    s_cmp_ge_u32 s34, 147456
    s_cselect_b32 s38, 147456, 0
    s_sub_u32 s34, s34, s38
    s_cmp_ge_i32 s32, 63
    s_cselect_b32 s18, 0xffff, s18
    s_cmp_lt_i32 s31, 63
    s_cbranch_scc1 Lred_top1
    s_branch L_exit
Lred_v04:
    v_mfma_f32_16x16x32_bf16 v[28:31], a[212:215], v[60:63], v[28:31]
    buffer_load_dword v5, v4, s[4:7], s16 offen sc1
    v_mfma_f32_16x16x32_bf16 v[28:31], a[196:199], v[56:59], v[28:31]
    v_mfma_f32_16x16x32_bf16 v[32:35], a[200:203], v[56:59], v[32:35]
    v_mfma_f32_16x16x32_bf16 v[32:35], a[216:219], v[60:63], v[32:35]
    v_mfma_f32_16x16x32_bf16 v[36:39], a[220:223], v[60:63], v[36:39]
    v_mfma_f32_16x16x32_bf16 v[36:39], a[204:207], v[56:59], v[36:39]
    s_waitcnt lgkmcnt(0)
    v_mfma_f32_16x16x32_bf16 v[36:39], a[236:239], v[64:67], v[36:39]
    v_mfma_f32_16x16x32_bf16 v[36:39], a[252:255], v[68:71], v[36:39]
    v_mfma_f32_16x16x32_bf16 v[32:35], a[248:251], v[68:71], v[32:35]
    v_mfma_f32_16x16x32_bf16 v[32:35], a[232:235], v[64:67], v[32:35]
    v_mfma_f32_16x16x32_bf16 v[28:31], a[228:231], v[64:67], v[28:31]
    v_mfma_f32_16x16x32_bf16 v[28:31], a[244:247], v[68:71], v[28:31]
    v_mfma_f32_16x16x32_bf16 v[24:27], a[240:243], v[68:71], v[24:27]
    v_mfma_f32_16x16x32_bf16 v[24:27], a[224:227], v[64:67], v[24:27]
    v_mfma_f32_16x16x32_bf16 v[24:27], v[96:99], v[188:191], v[24:27]
    v_mfma_f32_16x16x32_bf16 v[28:31], v[94:97], v[188:191], v[28:31]
    v_mfma_f32_16x16x32_bf16 v[32:35], v[96:99], v[192:195], v[32:35]
    v_mfma_f32_16x16x32_bf16 v[36:39], v[94:97], v[192:195], v[36:39]
    s_waitcnt vmcnt(0)
    v_cmp_gt_i32 vcc, s32, v5
    s_sub_u32 s43, s43, 1
    s_cmp_lt_i32 s43, 0
    s_cbranch_scc1 Lred_rdy0x
    s_and_b64 vcc, vcc, s[18:19]
    s_cbranch_scc0 Lred_rdy0x
Lred_spin0x:
    buffer_load_dword v5, v4, s[4:7], s16 offen sc1
    s_waitcnt vmcnt(0)
    v_cmp_gt_i32 vcc, s32, v5
    s_sub_u32 s43, s43, 1
    s_cmp_lt_i32 s43, 0
    s_cbranch_scc1 Lred_rdy0x
    s_and_b64 vcc, vcc, s[18:19]
    s_cbranch_scc0 Lred_rdy0x
    s_sleep 8
    s_branch Lred_spin0x
Lred_rdy0x:
    s_add_u32 s16, s16, 8192
    buffer_load_dword v5, v4, s[4:7], s16 offen sc1
    buffer_load_dwordx4 v[148:151], v1, s[4:7], s40 offen offset:0 sc1
    buffer_load_dwordx4 v[152:155], v1, s[4:7], s40 offen offset:1024 sc1
    s_add_u32 s37, s40, 32768
    buffer_load_dwordx4 v[156:159], v1, s[4:7], s37 offen offset:0 sc1
    buffer_load_dwordx4 v[160:163], v1, s[4:7], s37 offen offset:1024 sc1
    s_add_u32 s37, s40, 65536
    buffer_load_dwordx4 v[164:167], v1, s[4:7], s37 offen offset:0 sc1
    buffer_load_dwordx4 v[168:171], v1, s[4:7], s37 offen offset:1024 sc1
    s_add_u32 s37, s40, 98304
    buffer_load_dwordx4 v[172:175], v1, s[4:7], s37 offen offset:0 sc1
    buffer_load_dwordx4 v[176:179], v1, s[4:7], s37 offen offset:1024 sc1
    s_add_u32 m0, s34, 0
    s_nop 0
    buffer_load_dwordx4 v1, s[8:11], s33 offen offset:0 sc1 lds
    buffer_load_dwordx4 v1, s[8:11], s33 offen offset:1024 sc1 lds
    buffer_load_dwordx4 v1, s[8:11], s33 offen offset:2048 sc1 lds
    buffer_load_dwordx4 v1, s[8:11], s33 offen offset:3072 sc1 lds
    s_add_u32 s32, s32, 1
    s_add_u32 s40, s40, 131072
    s_add_u32 s33, s33, 116736
    s_add_u32 s34, s34, 36864
    s_cmp_ge_u32 s34, 147456
    s_cselect_b32 s38, 147456, 0
    s_sub_u32 s34, s34, s38
    s_cmp_ge_i32 s32, 63
    s_cselect_b32 s18, 0xffff, s18
    s_branch Lred_top1
Lred_top1:
    s_waitcnt vmcnt(10)
    v_mfma_f32_16x16x32_bf16 v[36:39], v[94:97], v[152:155], v[36:39]
    s_barrier
    v_mfma_f32_16x16x32_bf16 v[32:35], v[96:99], v[152:155], v[32:35]
    s_waitcnt vmcnt(9)
    v_add_u32 v2, s35, v1
    v_cmp_gt_i32 vcc, s32, v5
    v_mfma_f32_16x16x32_bf16 v[28:31], v[94:97], v[148:151], v[28:31]
    v_mfma_f32_16x16x32_bf16 v[24:27], v[96:99], v[148:151], v[24:27]
    s_waitcnt vmcnt(8)
    s_and_b64 vcc, vcc, s[18:19]
    s_cbranch_scc1 Lred_v11
    v_mfma_f32_16x16x32_bf16 v[24:27], v[96:99], v[156:159], v[24:27]
    s_add_u32 s16, s16, 8192
    v_mfma_f32_16x16x32_bf16 v[28:31], v[94:97], v[156:159], v[28:31]
    buffer_load_dwordx4 v[116:119], v1, s[4:7], s40 offen offset:0 sc1
    v_mfma_f32_16x16x32_bf16 v[32:35], v[96:99], v[160:163], v[32:35]
    ds_read_b128 v[40:43], v2 offset:0
    s_add_u32 s31, s31, 1
    v_mfma_f32_16x16x32_bf16 v[36:39], v[94:97], v[160:163], v[36:39]
    s_waitcnt vmcnt(7)
    v_mov_b32 v6, s31
    v_mfma_f32_16x16x32_bf16 v[36:39], v[94:97], v[168:171], v[36:39]
    ds_read_b128 v[44:47], v2 offset:1024
    v_mfma_f32_16x16x32_bf16 v[32:35], v[96:99], v[168:171], v[32:35]
    buffer_load_dwordx4 v[120:123], v1, s[4:7], s40 offen offset:1024 sc1
    v_mfma_f32_16x16x32_bf16 v[28:31], v[94:97], v[164:167], v[28:31]
    ds_read_b128 v[48:51], v2 offset:2048
    s_add_u32 s37, s40, 32768
    v_mfma_f32_16x16x32_bf16 v[24:27], v[96:99], v[164:167], v[24:27]
    s_waitcnt vmcnt(6)
    buffer_store_dword v6, v80, s[20:23], s17 offen sc1
    v_mfma_f32_16x16x32_bf16 v[24:27], v[96:99], v[172:175], v[24:27]
    ds_read_b128 v[52:55], v2 offset:3072
    s_add_u32 s17, s17, 8192
    v_mfma_f32_16x16x32_bf16 v[28:31], v[94:97], v[172:175], v[28:31]
    buffer_load_dwordx4 v[124:127], v1, s[4:7], s37 offen offset:0 sc1
    v_mfma_f32_16x16x32_bf16 v[32:35], v[96:99], v[176:179], v[32:35]
    v_mfma_f32_16x16x32_bf16 v[36:39], v[94:97], v[176:179], v[36:39]
    s_waitcnt lgkmcnt(2)
    v_mfma_f32_16x16x32_bf16 v[8:11], a[0:3], v[40:43], v[100:103]
    ds_read_b128 v[56:59], v2 offset:4096
    v_cvt_pk_bf16_f32 v72, v24, v25
    v_mfma_f32_16x16x32_bf16 v[8:11], a[16:19], v[44:47], v[8:11]
    buffer_load_dwordx4 v[128:131], v1, s[4:7], s37 offen offset:1024 sc1
    v_mfma_f32_16x16x32_bf16 v[12:15], a[20:23], v[44:47], v[104:107]
    s_add_u32 s37, s40, 65536
    v_cvt_pk_bf16_f32 v73, v26, v27
    v_mfma_f32_16x16x32_bf16 v[12:15], a[4:7], v[40:43], v[12:15]
    ds_write_b64 v204, v[72:73]
    v_mfma_f32_16x16x32_bf16 v[16:19], a[8:11], v[40:43], v[108:111]
    ds_read_b128 v[60:63], v2 offset:5120
    v_cvt_pk_bf16_f32 v74, v28, v29
    v_mfma_f32_16x16x32_bf16 v[16:19], a[24:27], v[44:47], v[16:19]
    buffer_load_dwordx4 v[132:135], v1, s[4:7], s37 offen offset:0 sc1
    v_mfma_f32_16x16x32_bf16 v[20:23], a[28:31], v[44:47], v[112:115]
    v_cvt_pk_bf16_f32 v75, v30, v31
    v_mfma_f32_16x16x32_bf16 v[20:23], a[12:15], v[40:43], v[20:23]
    s_waitcnt lgkmcnt(3)
    ds_write_b64 v205, v[74:75]
    v_mfma_f32_16x16x32_bf16 v[20:23], a[44:47], v[48:51], v[20:23]
    ds_read_b128 v[64:67], v2 offset:6144
    v_cvt_pk_bf16_f32 v76, v32, v33
    v_mfma_f32_16x16x32_bf16 v[20:23], a[60:63], v[52:55], v[20:23]
    buffer_load_dwordx4 v[136:139], v1, s[4:7], s37 offen offset:1024 sc1
    v_mfma_f32_16x16x32_bf16 v[16:19], a[56:59], v[52:55], v[16:19]
    s_add_u32 s37, s40, 98304
    v_cvt_pk_bf16_f32 v77, v34, v35
    v_mfma_f32_16x16x32_bf16 v[16:19], a[40:43], v[48:51], v[16:19]
    ds_write_b64 v206, v[76:77]
    v_mfma_f32_16x16x32_bf16 v[12:15], a[36:39], v[48:51], v[12:15]
    ds_read_b128 v[68:71], v2 offset:7168
    v_cvt_pk_bf16_f32 v78, v36, v37
    v_mfma_f32_16x16x32_bf16 v[12:15], a[52:55], v[52:55], v[12:15]
    buffer_load_dwordx4 v[140:143], v1, s[4:7], s37 offen offset:0 sc1
    v_mfma_f32_16x16x32_bf16 v[8:11], a[48:51], v[52:55], v[8:11]
    v_cvt_pk_bf16_f32 v79, v38, v39
    v_mfma_f32_16x16x32_bf16 v[8:11], a[32:35], v[48:51], v[8:11]
    s_waitcnt lgkmcnt(4)
    ds_write_b64 v207, v[78:79]
    v_mfma_f32_16x16x32_bf16 v[8:11], a[64:67], v[56:59], v[8:11]
    ds_read_b128 v[40:43], v2 offset:8192
    v_mfma_f32_16x16x32_bf16 v[8:11], a[80:83], v[60:63], v[8:11]
    buffer_load_dwordx4 v[144:147], v1, s[4:7], s37 offen offset:1024 sc1
    v_mfma_f32_16x16x32_bf16 v[12:15], a[84:87], v[60:63], v[12:15]
    s_add_u32 m0, s34, 0
    ds_read_b128 v[196:199], v222 offset:0
    v_mfma_f32_16x16x32_bf16 v[12:15], a[68:71], v[56:59], v[12:15]
    ds_read_b128 v[200:203], v222 offset:1024
    v_mfma_f32_16x16x32_bf16 v[86:89], v[72:75], v[72:75], 0
    v_mfma_f32_16x16x32_bf16 v[82:85], v[90:93], v[72:75], 0
    buffer_load_dword v5, v4, s[4:7], s16 offen sc1
    v_mfma_f32_16x16x32_bf16 v[86:89], v[76:79], v[76:79], v[86:89]
    v_mfma_f32_16x16x32_bf16 v[82:85], v[90:93], v[76:79], v[82:85]
    s_waitcnt lgkmcnt(1)
    v_mfma_f32_16x16x32_bf16 v[16:19], a[72:75], v[56:59], v[16:19]
    ds_read_b128 v[44:47], v2 offset:9216
    v_mfma_f32_16x16x32_bf16 v[16:19], a[88:91], v[60:63], v[16:19]
    buffer_store_dwordx4 v[196:199], v208, s[24:27], s54 offen sc1
    s_waitcnt lgkmcnt(1)
    v_mfma_f32_16x16x32_bf16 v[20:23], a[92:95], v[60:63], v[20:23]
    v_mfma_f32_16x16x32_bf16 v[20:23], a[76:79], v[56:59], v[20:23]
    v_mfma_f32_16x16x32_bf16 v[20:23], a[108:111], v[64:67], v[20:23]
    ds_read_b128 v[48:51], v2 offset:10240
    v_mfma_f32_16x16x32_bf16 v[20:23], a[124:127], v[68:71], v[20:23]
    buffer_store_dwordx4 v[200:203], v209, s[24:27], s54 offen sc1
    v_cndmask_b32 v86, v86, v87, s[44:45]
    v_mfma_f32_16x16x32_bf16 v[16:19], a[120:123], v[68:71], v[16:19]
    v_cndmask_b32 v88, v88, v89, s[44:45]
    v_cndmask_b32 v83, v86, v88, s[46:47]
    v_mfma_f32_16x16x32_bf16 v[16:19], a[104:107], v[64:67], v[16:19]
    buffer_store_dwordx2 v[82:83], v7, s[12:15], s36 offen offset:0 sc1
    s_mov_b32 s22, s14
    v_mfma_f32_16x16x32_bf16 v[12:15], a[100:103], v[64:67], v[12:15]
    ds_read_b128 v[52:55], v2 offset:11264
    s_add_u32 s36, s36, 34816
    v_mfma_f32_16x16x32_bf16 v[12:15], a[116:119], v[68:71], v[12:15]
    buffer_load_dwordx4 v1, s[8:11], s33 offen offset:0 sc1 lds
    v_mfma_f32_16x16x32_bf16 v[8:11], a[112:115], v[68:71], v[8:11]
    s_sub_u32 s42, s42, 32768
    v_mfma_f32_16x16x32_bf16 v[8:11], a[96:99], v[64:67], v[8:11]
    s_waitcnt lgkmcnt(2)
    v_mfma_f32_16x16x32_bf16 v[8:11], a[128:131], v[40:43], v[8:11]
    ds_read_b128 v[56:59], v2 offset:12288
    v_mfma_f32_16x16x32_bf16 v[8:11], a[144:147], v[44:47], v[8:11]
    buffer_load_dwordx4 v1, s[8:11], s33 offen offset:1024 sc1 lds
    v_mfma_f32_16x16x32_bf16 v[12:15], a[148:151], v[44:47], v[12:15]
    s_cmp_lt_i32 s31, 31
    s_cselect_b32 s14, s6, 0
    s_cselect_b32 s54, s36, s42
    v_mfma_f32_16x16x32_bf16 v[12:15], a[132:135], v[40:43], v[12:15]
    s_cmp_lt_i32 s31, 31
    s_cselect_b64 s[24:25], s[4:5], s[80:81]
    s_cselect_b32 s26, s6, 0x400000
    v_mfma_f32_16x16x32_bf16 v[16:19], a[136:139], v[40:43], v[16:19]
    ds_read_b128 v[60:63], v2 offset:13312
    v_mfma_f32_16x16x32_bf16 v[16:19], a[152:155], v[44:47], v[16:19]
    buffer_load_dwordx4 v1, s[8:11], s33 offen offset:2048 sc1 lds
    v_mfma_f32_16x16x32_bf16 v[20:23], a[156:159], v[44:47], v[20:23]
    s_cmp_lt_i32 s31, 31
    s_cselect_b64 s[48:49], 0, -1
    v_cndmask_b32 v204, v210, v216, s[48:49]
    v_mfma_f32_16x16x32_bf16 v[20:23], a[140:143], v[40:43], v[20:23]
    s_waitcnt lgkmcnt(2)
    v_cndmask_b32 v205, v211, v217, s[48:49]
    v_cndmask_b32 v206, v212, v218, s[48:49]
    v_mfma_f32_16x16x32_bf16 v[20:23], a[172:175], v[48:51], v[20:23]
    ds_read_b128 v[64:67], v2 offset:14336
    v_cndmask_b32 v207, v213, v219, s[48:49]
    v_mfma_f32_16x16x32_bf16 v[20:23], a[188:191], v[52:55], v[20:23]
    buffer_load_dwordx4 v1, s[8:11], s33 offen offset:3072 sc1 lds
    v_mfma_f32_16x16x32_bf16 v[16:19], a[184:187], v[52:55], v[16:19]
    s_add_u32 s32, s32, 1
    s_add_u32 s40, s40, 131072
    s_add_u32 s33, s33, 116736
    v_mfma_f32_16x16x32_bf16 v[16:19], a[168:171], v[48:51], v[16:19]
    s_add_u32 s34, s34, 36864
    s_cmp_ge_u32 s34, 147456
    s_cselect_b32 s38, 147456, 0
    v_mfma_f32_16x16x32_bf16 v[12:15], a[164:167], v[48:51], v[12:15]
    ds_read_b128 v[68:71], v2 offset:15360
    s_sub_u32 s34, s34, s38
    v_mfma_f32_16x16x32_bf16 v[12:15], a[180:183], v[52:55], v[12:15]
    s_cmp_ge_i32 s32, 63
    s_cselect_b32 s18, 0xffff, s18
    v_cndmask_b32 v208, v214, v220, s[48:49]
    v_mfma_f32_16x16x32_bf16 v[8:11], a[176:179], v[52:55], v[8:11]
    buffer_load_dwordx4 v[188:191], v1, s[4:7], s41 offen offset:0 sc1
    v_mfma_f32_16x16x32_bf16 v[8:11], a[160:163], v[48:51], v[8:11]
    s_waitcnt lgkmcnt(2)
    v_cndmask_b32 v209, v215, v221, s[48:49]
    s_add_u32 s35, s35, 36864
    v_mfma_f32_16x16x32_bf16 v[8:11], a[192:195], v[56:59], v[8:11]
    s_cmp_eq_u32 s35, 147456
    s_cselect_b32 s35, 0, s35
    v_mfma_f32_16x16x32_bf16 v[8:11], a[208:211], v[60:63], v[8:11]
    v_mfma_f32_16x16x32_bf16 v[12:15], a[212:215], v[60:63], v[12:15]
    buffer_load_dwordx4 v[192:195], v1, s[4:7], s41 offen offset:1024 sc1
    v_mfma_f32_16x16x32_bf16 v[12:15], a[196:199], v[56:59], v[12:15]
    s_add_u32 s41, s41, 36864
    v_mfma_f32_16x16x32_bf16 v[16:19], a[200:203], v[56:59], v[16:19]
    v_mfma_f32_16x16x32_bf16 v[16:19], a[216:219], v[60:63], v[16:19]
    v_mfma_f32_16x16x32_bf16 v[20:23], a[220:223], v[60:63], v[20:23]
    v_mfma_f32_16x16x32_bf16 v[20:23], a[204:207], v[56:59], v[20:23]
    s_waitcnt lgkmcnt(0)
    v_mfma_f32_16x16x32_bf16 v[20:23], a[236:239], v[64:67], v[20:23]
    v_mfma_f32_16x16x32_bf16 v[20:23], a[252:255], v[68:71], v[20:23]
    v_mfma_f32_16x16x32_bf16 v[16:19], a[248:251], v[68:71], v[16:19]
    v_mfma_f32_16x16x32_bf16 v[16:19], a[232:235], v[64:67], v[16:19]
    v_mfma_f32_16x16x32_bf16 v[12:15], a[228:231], v[64:67], v[12:15]
    v_mfma_f32_16x16x32_bf16 v[12:15], a[244:247], v[68:71], v[12:15]
    v_mfma_f32_16x16x32_bf16 v[8:11], a[240:243], v[68:71], v[8:11]
    v_mfma_f32_16x16x32_bf16 v[8:11], a[224:227], v[64:67], v[8:11]
    s_waitcnt vmcnt(19)
    v_mfma_f32_16x16x32_bf16 v[8:11], v[96:99], v[180:183], v[8:11]
    v_mfma_f32_16x16x32_bf16 v[12:15], v[94:97], v[180:183], v[12:15]
    v_mfma_f32_16x16x32_bf16 v[16:19], v[96:99], v[184:187], v[16:19]
    v_mfma_f32_16x16x32_bf16 v[20:23], v[94:97], v[184:187], v[20:23]
    s_cmp_lt_i32 s31, 63
    s_cbranch_scc1 Lred_run0
    s_branch L_exit
Lred_v11:
    s_nop 1
    s_waitcnt vmcnt(8)
    v_mfma_f32_16x16x32_bf16 v[24:27], v[96:99], v[156:159], v[24:27]
    buffer_load_dword v5, v4, s[4:7], s16 offen sc1
    v_mfma_f32_16x16x32_bf16 v[28:31], v[94:97], v[156:159], v[28:31]
    s_add_u32 s31, s31, 1
    v_mov_b32 v6, s31
    v_mfma_f32_16x16x32_bf16 v[32:35], v[96:99], v[160:163], v[32:35]
    ds_read_b128 v[40:43], v2 offset:0
    v_mfma_f32_16x16x32_bf16 v[36:39], v[94:97], v[160:163], v[36:39]
    s_waitcnt vmcnt(7)
    v_mfma_f32_16x16x32_bf16 v[36:39], v[94:97], v[168:171], v[36:39]
    ds_read_b128 v[44:47], v2 offset:1024
    v_mfma_f32_16x16x32_bf16 v[32:35], v[96:99], v[168:171], v[32:35]
    buffer_store_dword v6, v80, s[20:23], s17 offen sc1
    s_add_u32 s17, s17, 8192
    v_mfma_f32_16x16x32_bf16 v[28:31], v[94:97], v[164:167], v[28:31]
    ds_read_b128 v[48:51], v2 offset:2048
    v_mfma_f32_16x16x32_bf16 v[24:27], v[96:99], v[164:167], v[24:27]
    s_waitcnt vmcnt(6)
    v_mfma_f32_16x16x32_bf16 v[24:27], v[96:99], v[172:175], v[24:27]
    ds_read_b128 v[52:55], v2 offset:3072
    v_mfma_f32_16x16x32_bf16 v[28:31], v[94:97], v[172:175], v[28:31]
    v_mfma_f32_16x16x32_bf16 v[32:35], v[96:99], v[176:179], v[32:35]
    v_mfma_f32_16x16x32_bf16 v[36:39], v[94:97], v[176:179], v[36:39]
    s_waitcnt lgkmcnt(2)
    v_mfma_f32_16x16x32_bf16 v[8:11], a[0:3], v[40:43], v[100:103]
    ds_read_b128 v[56:59], v2 offset:4096
    v_mfma_f32_16x16x32_bf16 v[8:11], a[16:19], v[44:47], v[8:11]
    v_cvt_pk_bf16_f32 v72, v24, v25
    v_cvt_pk_bf16_f32 v73, v26, v27
    v_mfma_f32_16x16x32_bf16 v[12:15], a[20:23], v[44:47], v[104:107]
    ds_write_b64 v204, v[72:73]
    v_mfma_f32_16x16x32_bf16 v[12:15], a[4:7], v[40:43], v[12:15]
    v_cvt_pk_bf16_f32 v74, v28, v29
    v_cvt_pk_bf16_f32 v75, v30, v31
    v_mfma_f32_16x16x32_bf16 v[16:19], a[8:11], v[40:43], v[108:111]
    ds_read_b128 v[60:63], v2 offset:5120
    v_mfma_f32_16x16x32_bf16 v[16:19], a[24:27], v[44:47], v[16:19]
    ds_write_b64 v205, v[74:75]
    v_mfma_f32_16x16x32_bf16 v[20:23], a[28:31], v[44:47], v[112:115]
    s_waitcnt vmcnt(1)
    v_cmp_gt_i32 vcc, s32, v5
    v_cvt_pk_bf16_f32 v76, v32, v33
    v_mfma_f32_16x16x32_bf16 v[20:23], a[12:15], v[40:43], v[20:23]
    s_waitcnt lgkmcnt(4)
    v_cvt_pk_bf16_f32 v77, v34, v35
    v_mfma_f32_16x16x32_bf16 v[20:23], a[44:47], v[48:51], v[20:23]
    ds_read_b128 v[64:67], v2 offset:6144
    v_mfma_f32_16x16x32_bf16 v[20:23], a[60:63], v[52:55], v[20:23]
    s_and_b64 vcc, vcc, s[18:19]
    s_cbranch_scc1 Lred_v12
    v_mfma_f32_16x16x32_bf16 v[16:19], a[56:59], v[52:55], v[16:19]
    s_add_u32 s16, s16, 8192
    v_mfma_f32_16x16x32_bf16 v[16:19], a[40:43], v[48:51], v[16:19]
    buffer_load_dwordx4 v[116:119], v1, s[4:7], s40 offen offset:0 sc1
    v_mfma_f32_16x16x32_bf16 v[12:15], a[36:39], v[48:51], v[12:15]
    ds_read_b128 v[68:71], v2 offset:7168
    v_mfma_f32_16x16x32_bf16 v[12:15], a[52:55], v[52:55], v[12:15]
    ds_write_b64 v206, v[76:77]
    v_mfma_f32_16x16x32_bf16 v[8:11], a[48:51], v[52:55], v[8:11]
    v_cvt_pk_bf16_f32 v78, v36, v37
    v_cvt_pk_bf16_f32 v79, v38, v39
    v_mfma_f32_16x16x32_bf16 v[8:11], a[32:35], v[48:51], v[8:11]
    s_waitcnt lgkmcnt(4)
    buffer_load_dwordx4 v[120:123], v1, s[4:7], s40 offen offset:1024 sc1
    v_mfma_f32_16x16x32_bf16 v[8:11], a[64:67], v[56:59], v[8:11]
    ds_read_b128 v[40:43], v2 offset:8192
    s_add_u32 s37, s40, 32768
    v_mfma_f32_16x16x32_bf16 v[8:11], a[80:83], v[60:63], v[8:11]
    ds_write_b64 v207, v[78:79]
    v_mfma_f32_16x16x32_bf16 v[12:15], a[84:87], v[60:63], v[12:15]
    ds_read_b128 v[196:199], v222 offset:0
    v_mfma_f32_16x16x32_bf16 v[12:15], a[68:71], v[56:59], v[12:15]
    buffer_load_dword v5, v4, s[4:7], s16 offen sc1
    v_mfma_f32_16x16x32_bf16 v[16:19], a[72:75], v[56:59], v[16:19]
    ds_read_b128 v[44:47], v2 offset:9216
    v_mfma_f32_16x16x32_bf16 v[16:19], a[88:91], v[60:63], v[16:19]
    ds_read_b128 v[200:203], v222 offset:1024
    v_mfma_f32_16x16x32_bf16 v[86:89], v[72:75], v[72:75], 0
    v_mfma_f32_16x16x32_bf16 v[82:85], v[90:93], v[72:75], 0
    buffer_load_dwordx4 v[124:127], v1, s[4:7], s37 offen offset:0 sc1
    v_mfma_f32_16x16x32_bf16 v[86:89], v[76:79], v[76:79], v[86:89]
    v_mfma_f32_16x16x32_bf16 v[82:85], v[90:93], v[76:79], v[82:85]
    s_waitcnt lgkmcnt(2)
    v_mfma_f32_16x16x32_bf16 v[20:23], a[92:95], v[60:63], v[20:23]
    v_mfma_f32_16x16x32_bf16 v[20:23], a[76:79], v[56:59], v[20:23]
    buffer_store_dwordx4 v[196:199], v208, s[24:27], s54 offen sc1
    s_waitcnt lgkmcnt(0)
    v_mfma_f32_16x16x32_bf16 v[20:23], a[108:111], v[64:67], v[20:23]
    ds_read_b128 v[48:51], v2 offset:10240
    v_mfma_f32_16x16x32_bf16 v[20:23], a[124:127], v[68:71], v[20:23]
    v_mfma_f32_16x16x32_bf16 v[16:19], a[120:123], v[68:71], v[16:19]
    v_mfma_f32_16x16x32_bf16 v[16:19], a[104:107], v[64:67], v[16:19]
    buffer_store_dwordx4 v[200:203], v209, s[24:27], s54 offen sc1
    v_cndmask_b32 v86, v86, v87, s[44:45]
    v_mfma_f32_16x16x32_bf16 v[12:15], a[100:103], v[64:67], v[12:15]
    ds_read_b128 v[52:55], v2 offset:11264
    v_cndmask_b32 v88, v88, v89, s[44:45]
    v_mfma_f32_16x16x32_bf16 v[12:15], a[116:119], v[68:71], v[12:15]
    v_cndmask_b32 v83, v86, v88, s[46:47]
    v_mfma_f32_16x16x32_bf16 v[8:11], a[112:115], v[68:71], v[8:11]
    buffer_store_dwordx2 v[82:83], v7, s[12:15], s36 offen offset:0 sc1
    s_mov_b32 s22, s14
    v_mfma_f32_16x16x32_bf16 v[8:11], a[96:99], v[64:67], v[8:11]
    buffer_load_dwordx4 v[128:131], v1, s[4:7], s37 offen offset:1024 sc1
    v_mfma_f32_16x16x32_bf16 v[8:11], a[128:131], v[40:43], v[8:11]
    ds_read_b128 v[56:59], v2 offset:12288
    s_add_u32 s37, s40, 65536
    v_mfma_f32_16x16x32_bf16 v[8:11], a[144:147], v[44:47], v[8:11]
    s_add_u32 s36, s36, 34816
    s_sub_u32 s42, s42, 32768
    v_mfma_f32_16x16x32_bf16 v[12:15], a[148:151], v[44:47], v[12:15]
    s_cmp_lt_i32 s31, 31
    s_cselect_b32 s14, s6, 0
    s_cselect_b32 s54, s36, s42
    v_mfma_f32_16x16x32_bf16 v[12:15], a[132:135], v[40:43], v[12:15]
    buffer_load_dwordx4 v[132:135], v1, s[4:7], s37 offen offset:0 sc1
    v_mfma_f32_16x16x32_bf16 v[16:19], a[136:139], v[40:43], v[16:19]
    ds_read_b128 v[60:63], v2 offset:13312
    v_mfma_f32_16x16x32_bf16 v[16:19], a[152:155], v[44:47], v[16:19]
    s_cmp_lt_i32 s31, 31
    s_cselect_b64 s[24:25], s[4:5], s[80:81]
    s_cselect_b32 s26, s6, 0x400000
    v_mfma_f32_16x16x32_bf16 v[20:23], a[156:159], v[44:47], v[20:23]
    s_cmp_lt_i32 s31, 31
    s_cselect_b64 s[48:49], 0, -1
    v_cndmask_b32 v204, v210, v216, s[48:49]
    v_mfma_f32_16x16x32_bf16 v[20:23], a[140:143], v[40:43], v[20:23]
    s_waitcnt lgkmcnt(2)
    buffer_load_dwordx4 v[136:139], v1, s[4:7], s37 offen offset:1024 sc1
    v_mfma_f32_16x16x32_bf16 v[20:23], a[172:175], v[48:51], v[20:23]
    ds_read_b128 v[64:67], v2 offset:14336
    s_add_u32 s37, s40, 98304
    v_mfma_f32_16x16x32_bf16 v[20:23], a[188:191], v[52:55], v[20:23]
    v_cndmask_b32 v205, v211, v217, s[48:49]
    v_cndmask_b32 v206, v212, v218, s[48:49]
    v_mfma_f32_16x16x32_bf16 v[16:19], a[184:187], v[52:55], v[16:19]
    v_cndmask_b32 v207, v213, v219, s[48:49]
    v_cndmask_b32 v208, v214, v220, s[48:49]
    v_mfma_f32_16x16x32_bf16 v[16:19], a[168:171], v[48:51], v[16:19]
    buffer_load_dwordx4 v[140:143], v1, s[4:7], s37 offen offset:0 sc1
    v_mfma_f32_16x16x32_bf16 v[12:15], a[164:167], v[48:51], v[12:15]
    ds_read_b128 v[68:71], v2 offset:15360
    v_cndmask_b32 v209, v215, v221, s[48:49]
    v_mfma_f32_16x16x32_bf16 v[12:15], a[180:183], v[52:55], v[12:15]
    s_add_u32 s35, s35, 36864
    s_cmp_eq_u32 s35, 147456
    s_cselect_b32 s35, 0, s35
    v_mfma_f32_16x16x32_bf16 v[8:11], a[176:179], v[52:55], v[8:11]
    v_mfma_f32_16x16x32_bf16 v[8:11], a[160:163], v[48:51], v[8:11]
    s_waitcnt lgkmcnt(2)
    buffer_load_dwordx4 v[144:147], v1, s[4:7], s37 offen offset:1024 sc1
    v_mfma_f32_16x16x32_bf16 v[8:11], a[192:195], v[56:59], v[8:11]
    s_add_u32 m0, s34, 0
    v_mfma_f32_16x16x32_bf16 v[8:11], a[208:211], v[60:63], v[8:11]
    v_mfma_f32_16x16x32_bf16 v[12:15], a[212:215], v[60:63], v[12:15]
    v_mfma_f32_16x16x32_bf16 v[12:15], a[196:199], v[56:59], v[12:15]
    buffer_load_dwordx4 v1, s[8:11], s33 offen offset:0 sc1 lds
    v_mfma_f32_16x16x32_bf16 v[16:19], a[200:203], v[56:59], v[16:19]
    v_mfma_f32_16x16x32_bf16 v[16:19], a[216:219], v[60:63], v[16:19]
    v_mfma_f32_16x16x32_bf16 v[20:23], a[220:223], v[60:63], v[20:23]
    v_mfma_f32_16x16x32_bf16 v[20:23], a[204:207], v[56:59], v[20:23]
    s_waitcnt lgkmcnt(0)
    buffer_load_dwordx4 v1, s[8:11], s33 offen offset:1024 sc1 lds
    v_mfma_f32_16x16x32_bf16 v[20:23], a[236:239], v[64:67], v[20:23]
    v_mfma_f32_16x16x32_bf16 v[20:23], a[252:255], v[68:71], v[20:23]
    v_mfma_f32_16x16x32_bf16 v[16:19], a[248:251], v[68:71], v[16:19]
    v_mfma_f32_16x16x32_bf16 v[16:19], a[232:235], v[64:67], v[16:19]
    buffer_load_dwordx4 v1, s[8:11], s33 offen offset:2048 sc1 lds
    v_mfma_f32_16x16x32_bf16 v[12:15], a[228:231], v[64:67], v[12:15]
    v_mfma_f32_16x16x32_bf16 v[12:15], a[244:247], v[68:71], v[12:15]
    v_mfma_f32_16x16x32_bf16 v[8:11], a[240:243], v[68:71], v[8:11]
    v_mfma_f32_16x16x32_bf16 v[8:11], a[224:227], v[64:67], v[8:11]
    buffer_load_dwordx4 v1, s[8:11], s33 offen offset:3072 sc1 lds
    v_mfma_f32_16x16x32_bf16 v[8:11], v[96:99], v[180:183], v[8:11]
    s_add_u32 s32, s32, 1
    s_add_u32 s40, s40, 131072
    s_add_u32 s33, s33, 116736
    v_mfma_f32_16x16x32_bf16 v[12:15], v[94:97], v[180:183], v[12:15]
    s_add_u32 s34, s34, 36864
    s_cmp_ge_u32 s34, 147456
    s_cselect_b32 s38, 147456, 0
    v_mfma_f32_16x16x32_bf16 v[16:19], v[96:99], v[184:187], v[16:19]
    s_sub_u32 s34, s34, s38
    s_cmp_ge_i32 s32, 63
    s_cselect_b32 s18, 0xffff, s18
    v_mfma_f32_16x16x32_bf16 v[20:23], v[94:97], v[184:187], v[20:23]
    buffer_load_dwordx4 v[188:191], v1, s[4:7], s41 offen offset:0 sc1
    buffer_load_dwordx4 v[192:195], v1, s[4:7], s41 offen offset:1024 sc1
    s_add_u32 s41, s41, 36864
    s_cmp_lt_i32 s31, 63
    s_cbranch_scc1 Lred_top0
    s_branch L_exit
Lred_v12:
    s_cmp_lt_i32 s31, 63
    s_cbranch_scc1 Lred_more
    ds_write_b64 v206, v[76:77]
    v_cvt_pk_bf16_f32 v78, v36, v37
    v_cvt_pk_bf16_f32 v79, v38, v39
    ds_write_b64 v207, v[78:79]
    ds_read_b128 v[196:199], v222 offset:0
    ds_read_b128 v[200:203], v222 offset:1024
    v_mfma_f32_16x16x32_bf16 v[86:89], v[72:75], v[72:75], 0
    v_mfma_f32_16x16x32_bf16 v[82:85], v[90:93], v[72:75], 0
    v_mfma_f32_16x16x32_bf16 v[86:89], v[76:79], v[76:79], v[86:89]
    v_mfma_f32_16x16x32_bf16 v[82:85], v[90:93], v[76:79], v[82:85]
    s_waitcnt lgkmcnt(1)
    buffer_store_dwordx4 v[196:199], v208, s[24:27], s54 offen sc1
    s_waitcnt lgkmcnt(0)
    buffer_store_dwordx4 v[200:203], v209, s[24:27], s54 offen sc1
    s_nop 2
    v_cndmask_b32 v86, v86, v87, s[44:45]
    v_cndmask_b32 v88, v88, v89, s[44:45]
    v_cndmask_b32 v83, v86, v88, s[46:47]
    buffer_store_dwordx2 v[82:83], v7, s[12:15], s36 offen offset:0 sc1
    s_mov_b32 s22, s14
    s_add_u32 s36, s36, 34816
    s_sub_u32 s42, s42, 32768
    s_cmp_lt_i32 s31, 31
    s_cselect_b32 s14, s6, 0
    s_cselect_b32 s54, s36, s42
    s_cmp_lt_i32 s31, 31
    s_cselect_b64 s[24:25], s[4:5], s[80:81]
    s_cselect_b32 s26, s6, 0x400000
    s_cmp_lt_i32 s31, 31
    s_cselect_b64 s[48:49], 0, -1
    v_cndmask_b32 v204, v210, v216, s[48:49]
    v_cndmask_b32 v205, v211, v217, s[48:49]
    v_cndmask_b32 v206, v212, v218, s[48:49]
    v_cndmask_b32 v207, v213, v219, s[48:49]
    v_cndmask_b32 v208, v214, v220, s[48:49]
    v_cndmask_b32 v209, v215, v221, s[48:49]
    s_add_u32 s35, s35, 36864
    s_cmp_eq_u32 s35, 147456
    s_cselect_b32 s35, 0, s35
    s_branch L_exit
Lred_more:
    v_mfma_f32_16x16x32_bf16 v[16:19], a[56:59], v[52:55], v[16:19]
    buffer_load_dword v5, v4, s[4:7], s16 offen sc1
    v_mfma_f32_16x16x32_bf16 v[16:19], a[40:43], v[48:51], v[16:19]
    ds_write_b64 v206, v[76:77]
    v_mfma_f32_16x16x32_bf16 v[12:15], a[36:39], v[48:51], v[12:15]
    ds_read_b128 v[68:71], v2 offset:7168
    v_cvt_pk_bf16_f32 v78, v36, v37
    v_mfma_f32_16x16x32_bf16 v[12:15], a[52:55], v[52:55], v[12:15]
    v_cvt_pk_bf16_f32 v79, v38, v39
    v_mfma_f32_16x16x32_bf16 v[8:11], a[48:51], v[52:55], v[8:11]
    ds_write_b64 v207, v[78:79]
    v_mfma_f32_16x16x32_bf16 v[8:11], a[32:35], v[48:51], v[8:11]
    s_waitcnt lgkmcnt(5)
    ds_read_b128 v[196:199], v222 offset:0
    v_mfma_f32_16x16x32_bf16 v[8:11], a[64:67], v[56:59], v[8:11]
    ds_read_b128 v[40:43], v2 offset:8192
    v_mfma_f32_16x16x32_bf16 v[8:11], a[80:83], v[60:63], v[8:11]
    ds_read_b128 v[200:203], v222 offset:1024
    v_mfma_f32_16x16x32_bf16 v[86:89], v[72:75], v[72:75], 0
    buffer_load_dwordx4 v[188:191], v1, s[4:7], s41 offen offset:0 sc1
    v_mfma_f32_16x16x32_bf16 v[82:85], v[90:93], v[72:75], 0
    v_mfma_f32_16x16x32_bf16 v[86:89], v[76:79], v[76:79], v[86:89]
    v_mfma_f32_16x16x32_bf16 v[82:85], v[90:93], v[76:79], v[82:85]
    s_waitcnt lgkmcnt(2)
    v_mfma_f32_16x16x32_bf16 v[12:15], a[84:87], v[60:63], v[12:15]
    buffer_store_dwordx4 v[196:199], v208, s[24:27], s54 offen sc1
    s_waitcnt lgkmcnt(0)
    v_mfma_f32_16x16x32_bf16 v[12:15], a[68:71], v[56:59], v[12:15]
    v_mfma_f32_16x16x32_bf16 v[16:19], a[72:75], v[56:59], v[16:19]
    ds_read_b128 v[44:47], v2 offset:9216
    v_mfma_f32_16x16x32_bf16 v[16:19], a[88:91], v[60:63], v[16:19]
    v_mfma_f32_16x16x32_bf16 v[20:23], a[92:95], v[60:63], v[20:23]
    buffer_store_dwordx4 v[200:203], v209, s[24:27], s54 offen sc1
    v_cndmask_b32 v86, v86, v87, s[44:45]
    v_mfma_f32_16x16x32_bf16 v[20:23], a[76:79], v[56:59], v[20:23]
    v_cndmask_b32 v88, v88, v89, s[44:45]
    v_cndmask_b32 v83, v86, v88, s[46:47]
    v_mfma_f32_16x16x32_bf16 v[20:23], a[108:111], v[64:67], v[20:23]
    ds_read_b128 v[48:51], v2 offset:10240
    s_waitcnt vmcnt(3)
    v_mfma_f32_16x16x32_bf16 v[20:23], a[124:127], v[68:71], v[20:23]
    buffer_store_dwordx2 v[82:83], v7, s[12:15], s36 offen offset:0 sc1
    v_cmp_gt_i32 vcc, s32, v5
    v_mfma_f32_16x16x32_bf16 v[16:19], a[120:123], v[68:71], v[16:19]
    s_mov_b32 s22, s14
    s_add_u32 s36, s36, 34816
    s_sub_u32 s42, s42, 32768
    v_mfma_f32_16x16x32_bf16 v[16:19], a[104:107], v[64:67], v[16:19]
    s_and_b64 vcc, vcc, s[18:19]
    s_cbranch_scc1 Lred_v13
    v_mfma_f32_16x16x32_bf16 v[12:15], a[100:103], v[64:67], v[12:15]
    ds_read_b128 v[52:55], v2 offset:11264
    s_add_u32 s16, s16, 8192
    v_mfma_f32_16x16x32_bf16 v[12:15], a[116:119], v[68:71], v[12:15]
    buffer_load_dword v5, v4, s[4:7], s16 offen sc1
    v_mfma_f32_16x16x32_bf16 v[8:11], a[112:115], v[68:71], v[8:11]
    s_cmp_lt_i32 s31, 31
    s_cselect_b32 s14, s6, 0
    s_cselect_b32 s54, s36, s42
    v_mfma_f32_16x16x32_bf16 v[8:11], a[96:99], v[64:67], v[8:11]
    s_waitcnt lgkmcnt(2)
    v_mfma_f32_16x16x32_bf16 v[8:11], a[128:131], v[40:43], v[8:11]
    ds_read_b128 v[56:59], v2 offset:12288
    v_mfma_f32_16x16x32_bf16 v[8:11], a[144:147], v[44:47], v[8:11]
    buffer_load_dwordx4 v[116:119], v1, s[4:7], s40 offen offset:0 sc1
    v_mfma_f32_16x16x32_bf16 v[12:15], a[148:151], v[44:47], v[12:15]
    s_cmp_lt_i32 s31, 31
    s_cselect_b64 s[24:25], s[4:5], s[80:81]
    s_cselect_b32 s26, s6, 0x400000
    v_mfma_f32_16x16x32_bf16 v[12:15], a[132:135], v[40:43], v[12:15]
    s_cmp_lt_i32 s31, 31
    s_cselect_b64 s[48:49], 0, -1
    v_cndmask_b32 v204, v210, v216, s[48:49]
    v_mfma_f32_16x16x32_bf16 v[16:19], a[136:139], v[40:43], v[16:19]
    ds_read_b128 v[60:63], v2 offset:13312
    v_cndmask_b32 v205, v211, v217, s[48:49]
    v_mfma_f32_16x16x32_bf16 v[16:19], a[152:155], v[44:47], v[16:19]
    buffer_load_dwordx4 v[120:123], v1, s[4:7], s40 offen offset:1024 sc1
    v_mfma_f32_16x16x32_bf16 v[20:23], a[156:159], v[44:47], v[20:23]
    s_add_u32 s37, s40, 32768
    v_cndmask_b32 v206, v212, v218, s[48:49]
    v_cndmask_b32 v207, v213, v219, s[48:49]
    v_mfma_f32_16x16x32_bf16 v[20:23], a[140:143], v[40:43], v[20:23]
    s_waitcnt lgkmcnt(2)
    v_cndmask_b32 v208, v214, v220, s[48:49]
    v_cndmask_b32 v209, v215, v221, s[48:49]
    v_mfma_f32_16x16x32_bf16 v[20:23], a[172:175], v[48:51], v[20:23]
    ds_read_b128 v[64:67], v2 offset:14336
    s_add_u32 s35, s35, 36864
    v_mfma_f32_16x16x32_bf16 v[20:23], a[188:191], v[52:55], v[20:23]
    buffer_load_dwordx4 v[124:127], v1, s[4:7], s37 offen offset:0 sc1
    v_mfma_f32_16x16x32_bf16 v[16:19], a[184:187], v[52:55], v[16:19]
    s_cmp_eq_u32 s35, 147456
    s_cselect_b32 s35, 0, s35
    v_mfma_f32_16x16x32_bf16 v[16:19], a[168:171], v[48:51], v[16:19]
    v_mfma_f32_16x16x32_bf16 v[12:15], a[164:167], v[48:51], v[12:15]
    ds_read_b128 v[68:71], v2 offset:15360
    v_mfma_f32_16x16x32_bf16 v[12:15], a[180:183], v[52:55], v[12:15]
    buffer_load_dwordx4 v[128:131], v1, s[4:7], s37 offen offset:1024 sc1
    v_mfma_f32_16x16x32_bf16 v[8:11], a[176:179], v[52:55], v[8:11]
    s_add_u32 s37, s40, 65536
    v_mfma_f32_16x16x32_bf16 v[8:11], a[160:163], v[48:51], v[8:11]
    s_waitcnt lgkmcnt(2)
    v_mfma_f32_16x16x32_bf16 v[8:11], a[192:195], v[56:59], v[8:11]
    v_mfma_f32_16x16x32_bf16 v[8:11], a[208:211], v[60:63], v[8:11]
    buffer_load_dwordx4 v[132:135], v1, s[4:7], s37 offen offset:0 sc1
    v_mfma_f32_16x16x32_bf16 v[12:15], a[212:215], v[60:63], v[12:15]
    v_mfma_f32_16x16x32_bf16 v[12:15], a[196:199], v[56:59], v[12:15]
    v_mfma_f32_16x16x32_bf16 v[16:19], a[200:203], v[56:59], v[16:19]
    v_mfma_f32_16x16x32_bf16 v[16:19], a[216:219], v[60:63], v[16:19]
    buffer_load_dwordx4 v[136:139], v1, s[4:7], s37 offen offset:1024 sc1
    v_mfma_f32_16x16x32_bf16 v[20:23], a[220:223], v[60:63], v[20:23]
    s_add_u32 s37, s40, 98304
    v_mfma_f32_16x16x32_bf16 v[20:23], a[204:207], v[56:59], v[20:23]
    s_waitcnt lgkmcnt(0)
    v_mfma_f32_16x16x32_bf16 v[20:23], a[236:239], v[64:67], v[20:23]
    v_mfma_f32_16x16x32_bf16 v[20:23], a[252:255], v[68:71], v[20:23]
    buffer_load_dwordx4 v[140:143], v1, s[4:7], s37 offen offset:0 sc1
    v_mfma_f32_16x16x32_bf16 v[16:19], a[248:251], v[68:71], v[16:19]
    v_mfma_f32_16x16x32_bf16 v[16:19], a[232:235], v[64:67], v[16:19]
    v_mfma_f32_16x16x32_bf16 v[12:15], a[228:231], v[64:67], v[12:15]
    v_mfma_f32_16x16x32_bf16 v[12:15], a[244:247], v[68:71], v[12:15]
    buffer_load_dwordx4 v[144:147], v1, s[4:7], s37 offen offset:1024 sc1
    v_mfma_f32_16x16x32_bf16 v[8:11], a[240:243], v[68:71], v[8:11]
    s_add_u32 m0, s34, 0
    v_mfma_f32_16x16x32_bf16 v[8:11], a[224:227], v[64:67], v[8:11]
    v_mfma_f32_16x16x32_bf16 v[8:11], v[96:99], v[180:183], v[8:11]
    v_mfma_f32_16x16x32_bf16 v[12:15], v[94:97], v[180:183], v[12:15]
    buffer_load_dwordx4 v1, s[8:11], s33 offen offset:0 sc1 lds
    v_mfma_f32_16x16x32_bf16 v[16:19], v[96:99], v[184:187], v[16:19]
    v_mfma_f32_16x16x32_bf16 v[20:23], v[94:97], v[184:187], v[20:23]
    buffer_load_dwordx4 v1, s[8:11], s33 offen offset:1024 sc1 lds
    buffer_load_dwordx4 v1, s[8:11], s33 offen offset:2048 sc1 lds
    buffer_load_dwordx4 v1, s[8:11], s33 offen offset:3072 sc1 lds
    s_add_u32 s32, s32, 1
    s_add_u32 s40, s40, 131072
    s_add_u32 s33, s33, 116736
    s_add_u32 s34, s34, 36864
    s_cmp_ge_u32 s34, 147456
    s_cselect_b32 s38, 147456, 0
    s_sub_u32 s34, s34, s38
    s_cmp_ge_i32 s32, 63
    s_cselect_b32 s18, 0xffff, s18
    buffer_load_dwordx4 v[192:195], v1, s[4:7], s41 offen offset:1024 sc1
    s_add_u32 s41, s41, 36864
    s_cmp_lt_i32 s31, 63
    s_cbranch_scc1 Lred_top0
    s_branch L_exit
Lred_v13:
    v_mfma_f32_16x16x32_bf16 v[12:15], a[100:103], v[64:67], v[12:15]
    ds_read_b128 v[52:55], v2 offset:11264
    v_mfma_f32_16x16x32_bf16 v[12:15], a[116:119], v[68:71], v[12:15]
    buffer_load_dword v5, v4, s[4:7], s16 offen sc1
    v_mfma_f32_16x16x32_bf16 v[8:11], a[112:115], v[68:71], v[8:11]
    s_cmp_lt_i32 s31, 31
    s_cselect_b32 s14, s6, 0
    s_cselect_b32 s54, s36, s42
    v_mfma_f32_16x16x32_bf16 v[8:11], a[96:99], v[64:67], v[8:11]
    s_waitcnt lgkmcnt(2)
    v_mfma_f32_16x16x32_bf16 v[8:11], a[128:131], v[40:43], v[8:11]
    ds_read_b128 v[56:59], v2 offset:12288
    v_mfma_f32_16x16x32_bf16 v[8:11], a[144:147], v[44:47], v[8:11]
    s_cmp_lt_i32 s31, 31
    s_cselect_b64 s[24:25], s[4:5], s[80:81]
    s_cselect_b32 s26, s6, 0x400000
    v_mfma_f32_16x16x32_bf16 v[12:15], a[148:151], v[44:47], v[12:15]
    s_cmp_lt_i32 s31, 31
    s_cselect_b64 s[48:49], 0, -1
    v_cndmask_b32 v204, v210, v216, s[48:49]
    v_mfma_f32_16x16x32_bf16 v[12:15], a[132:135], v[40:43], v[12:15]
    buffer_load_dwordx4 v[192:195], v1, s[4:7], s41 offen offset:1024 sc1
    v_mfma_f32_16x16x32_bf16 v[16:19], a[136:139], v[40:43], v[16:19]
    ds_read_b128 v[60:63], v2 offset:13312
    v_cndmask_b32 v205, v211, v217, s[48:49]
    v_mfma_f32_16x16x32_bf16 v[16:19], a[152:155], v[44:47], v[16:19]
    s_add_u32 s41, s41, 36864
    v_cndmask_b32 v206, v212, v218, s[48:49]
    v_cndmask_b32 v207, v213, v219, s[48:49]
    v_mfma_f32_16x16x32_bf16 v[20:23], a[156:159], v[44:47], v[20:23]
    v_cndmask_b32 v208, v214, v220, s[48:49]
    v_cndmask_b32 v209, v215, v221, s[48:49]
    v_mfma_f32_16x16x32_bf16 v[20:23], a[140:143], v[40:43], v[20:23]
    s_waitcnt lgkmcnt(2)
    s_add_u32 s35, s35, 36864
    v_mfma_f32_16x16x32_bf16 v[20:23], a[172:175], v[48:51], v[20:23]
    ds_read_b128 v[64:67], v2 offset:14336
    v_mfma_f32_16x16x32_bf16 v[20:23], a[188:191], v[52:55], v[20:23]
    s_cmp_eq_u32 s35, 147456
    s_cselect_b32 s35, 0, s35
    v_mfma_f32_16x16x32_bf16 v[16:19], a[184:187], v[52:55], v[16:19]
    v_mfma_f32_16x16x32_bf16 v[16:19], a[168:171], v[48:51], v[16:19]
    v_mfma_f32_16x16x32_bf16 v[12:15], a[164:167], v[48:51], v[12:15]
    ds_read_b128 v[68:71], v2 offset:15360
    v_mfma_f32_16x16x32_bf16 v[12:15], a[180:183], v[52:55], v[12:15]
    v_mfma_f32_16x16x32_bf16 v[8:11], a[176:179], v[52:55], v[8:11]
    v_mfma_f32_16x16x32_bf16 v[8:11], a[160:163], v[48:51], v[8:11]
    s_waitcnt vmcnt(1) lgkmcnt(2)
    v_cmp_gt_i32 vcc, s32, v5
    v_mfma_f32_16x16x32_bf16 v[8:11], a[192:195], v[56:59], v[8:11]
    v_mfma_f32_16x16x32_bf16 v[8:11], a[208:211], v[60:63], v[8:11]
    s_and_b64 vcc, vcc, s[18:19]
    s_cbranch_scc1 Lred_v14
    v_mfma_f32_16x16x32_bf16 v[12:15], a[212:215], v[60:63], v[12:15]
    s_add_u32 s16, s16, 8192
    v_mfma_f32_16x16x32_bf16 v[12:15], a[196:199], v[56:59], v[12:15]
    buffer_load_dword v5, v4, s[4:7], s16 offen sc1
    v_mfma_f32_16x16x32_bf16 v[16:19], a[200:203], v[56:59], v[16:19]
    v_mfma_f32_16x16x32_bf16 v[16:19], a[216:219], v[60:63], v[16:19]
    v_mfma_f32_16x16x32_bf16 v[20:23], a[220:223], v[60:63], v[20:23]
    v_mfma_f32_16x16x32_bf16 v[20:23], a[204:207], v[56:59], v[20:23]
    s_waitcnt lgkmcnt(0)
    buffer_load_dwordx4 v[116:119], v1, s[4:7], s40 offen offset:0 sc1
    v_mfma_f32_16x16x32_bf16 v[20:23], a[236:239], v[64:67], v[20:23]
    v_mfma_f32_16x16x32_bf16 v[20:23], a[252:255], v[68:71], v[20:23]
    v_mfma_f32_16x16x32_bf16 v[16:19], a[248:251], v[68:71], v[16:19]
    v_mfma_f32_16x16x32_bf16 v[16:19], a[232:235], v[64:67], v[16:19]
    buffer_load_dwordx4 v[120:123], v1, s[4:7], s40 offen offset:1024 sc1
    v_mfma_f32_16x16x32_bf16 v[12:15], a[228:231], v[64:67], v[12:15]
    s_add_u32 s37, s40, 32768
    v_mfma_f32_16x16x32_bf16 v[12:15], a[244:247], v[68:71], v[12:15]
    v_mfma_f32_16x16x32_bf16 v[8:11], a[240:243], v[68:71], v[8:11]
    v_mfma_f32_16x16x32_bf16 v[8:11], a[224:227], v[64:67], v[8:11]
    buffer_load_dwordx4 v[124:127], v1, s[4:7], s37 offen offset:0 sc1
    v_mfma_f32_16x16x32_bf16 v[8:11], v[96:99], v[180:183], v[8:11]
    v_mfma_f32_16x16x32_bf16 v[12:15], v[94:97], v[180:183], v[12:15]
    v_mfma_f32_16x16x32_bf16 v[16:19], v[96:99], v[184:187], v[16:19]
    v_mfma_f32_16x16x32_bf16 v[20:23], v[94:97], v[184:187], v[20:23]
    buffer_load_dwordx4 v[128:131], v1, s[4:7], s37 offen offset:1024 sc1
    s_add_u32 s37, s40, 65536
    buffer_load_dwordx4 v[132:135], v1, s[4:7], s37 offen offset:0 sc1
    buffer_load_dwordx4 v[136:139], v1, s[4:7], s37 offen offset:1024 sc1
    s_add_u32 s37, s40, 98304
    buffer_load_dwordx4 v[140:143], v1, s[4:7], s37 offen offset:0 sc1
    buffer_load_dwordx4 v[144:147], v1, s[4:7], s37 offen offset:1024 sc1
    s_add_u32 m0, s34, 0
    s_nop 0
    buffer_load_dwordx4 v1, s[8:11], s33 offen offset:0 sc1 lds
    buffer_load_dwordx4 v1, s[8:11], s33 offen offset:1024 sc1 lds
    buffer_load_dwordx4 v1, s[8:11], s33 offen offset:2048 sc1 lds
    buffer_load_dwordx4 v1, s[8:11], s33 offen offset:3072 sc1 lds
    s_add_u32 s32, s32, 1
    s_add_u32 s40, s40, 131072
    s_add_u32 s33, s33, 116736
    s_add_u32 s34, s34, 36864
    s_cmp_ge_u32 s34, 147456
    s_cselect_b32 s38, 147456, 0
    s_sub_u32 s34, s34, s38
    s_cmp_ge_i32 s32, 63
    s_cselect_b32 s18, 0xffff, s18
    s_cmp_lt_i32 s31, 63
    s_cbranch_scc1 Lred_top0
    s_branch L_exit
Lred_v14:
    v_mfma_f32_16x16x32_bf16 v[12:15], a[212:215], v[60:63], v[12:15]
    buffer_load_dword v5, v4, s[4:7], s16 offen sc1
    v_mfma_f32_16x16x32_bf16 v[12:15], a[196:199], v[56:59], v[12:15]
    v_mfma_f32_16x16x32_bf16 v[16:19], a[200:203], v[56:59], v[16:19]
    v_mfma_f32_16x16x32_bf16 v[16:19], a[216:219], v[60:63], v[16:19]
    v_mfma_f32_16x16x32_bf16 v[20:23], a[220:223], v[60:63], v[20:23]
    v_mfma_f32_16x16x32_bf16 v[20:23], a[204:207], v[56:59], v[20:23]
    s_waitcnt lgkmcnt(0)
    v_mfma_f32_16x16x32_bf16 v[20:23], a[236:239], v[64:67], v[20:23]
    v_mfma_f32_16x16x32_bf16 v[20:23], a[252:255], v[68:71], v[20:23]
    v_mfma_f32_16x16x32_bf16 v[16:19], a[248:251], v[68:71], v[16:19]
    v_mfma_f32_16x16x32_bf16 v[16:19], a[232:235], v[64:67], v[16:19]
    v_mfma_f32_16x16x32_bf16 v[12:15], a[228:231], v[64:67], v[12:15]
    v_mfma_f32_16x16x32_bf16 v[12:15], a[244:247], v[68:71], v[12:15]
    v_mfma_f32_16x16x32_bf16 v[8:11], a[240:243], v[68:71], v[8:11]
    v_mfma_f32_16x16x32_bf16 v[8:11], a[224:227], v[64:67], v[8:11]
    v_mfma_f32_16x16x32_bf16 v[8:11], v[96:99], v[180:183], v[8:11]
    v_mfma_f32_16x16x32_bf16 v[12:15], v[94:97], v[180:183], v[12:15]
    v_mfma_f32_16x16x32_bf16 v[16:19], v[96:99], v[184:187], v[16:19]
    v_mfma_f32_16x16x32_bf16 v[20:23], v[94:97], v[184:187], v[20:23]
    s_waitcnt vmcnt(0)
    v_cmp_gt_i32 vcc, s32, v5
    s_sub_u32 s43, s43, 1
    s_cmp_lt_i32 s43, 0
    s_cbranch_scc1 Lred_rdy1x
    s_and_b64 vcc, vcc, s[18:19]
    s_cbranch_scc0 Lred_rdy1x
Lred_spin1x:
    buffer_load_dword v5, v4, s[4:7], s16 offen sc1
    s_waitcnt vmcnt(0)
    v_cmp_gt_i32 vcc, s32, v5
    s_sub_u32 s43, s43, 1
    s_cmp_lt_i32 s43, 0
    s_cbranch_scc1 Lred_rdy1x
    s_and_b64 vcc, vcc, s[18:19]
    s_cbranch_scc0 Lred_rdy1x
    s_sleep 8
    s_branch Lred_spin1x
Lred_rdy1x:
    s_add_u32 s16, s16, 8192
    buffer_load_dword v5, v4, s[4:7], s16 offen sc1
    buffer_load_dwordx4 v[116:119], v1, s[4:7], s40 offen offset:0 sc1
    buffer_load_dwordx4 v[120:123], v1, s[4:7], s40 offen offset:1024 sc1
    s_add_u32 s37, s40, 32768
    buffer_load_dwordx4 v[124:127], v1, s[4:7], s37 offen offset:0 sc1
    buffer_load_dwordx4 v[128:131], v1, s[4:7], s37 offen offset:1024 sc1
    s_add_u32 s37, s40, 65536
    buffer_load_dwordx4 v[132:135], v1, s[4:7], s37 offen offset:0 sc1
    buffer_load_dwordx4 v[136:139], v1, s[4:7], s37 offen offset:1024 sc1
    s_add_u32 s37, s40, 98304
    buffer_load_dwordx4 v[140:143], v1, s[4:7], s37 offen offset:0 sc1
    buffer_load_dwordx4 v[144:147], v1, s[4:7], s37 offen offset:1024 sc1
    s_add_u32 m0, s34, 0
    s_nop 0
    buffer_load_dwordx4 v1, s[8:11], s33 offen offset:0 sc1 lds
    buffer_load_dwordx4 v1, s[8:11], s33 offen offset:1024 sc1 lds
    buffer_load_dwordx4 v1, s[8:11], s33 offen offset:2048 sc1 lds
    buffer_load_dwordx4 v1, s[8:11], s33 offen offset:3072 sc1 lds
    s_add_u32 s32, s32, 1
    s_add_u32 s40, s40, 131072
    s_add_u32 s33, s33, 116736
    s_add_u32 s34, s34, 36864
    s_cmp_ge_u32 s34, 147456
    s_cselect_b32 s38, 147456, 0
    s_sub_u32 s34, s34, s38
    s_cmp_ge_i32 s32, 63
    s_cselect_b32 s18, 0xffff, s18
    s_branch Lred_top0
L_exit:
L_end:
    s_endpgm
.section .rodata,"a"
.p2align 6
.amdhsa_kernel interleave_layers__sliding_local_dilated__dense_activation_squared_relu__prompt_kernel
  .amdhsa_next_free_vgpr 512
  .amdhsa_next_free_sgpr 102
  .amdhsa_accum_offset 256
  .amdhsa_group_segment_fixed_size 0
  .amdhsa_kernarg_size 88
  .amdhsa_user_sgpr_count 2
  .amdhsa_user_sgpr_kernarg_segment_ptr 1
  .amdhsa_system_sgpr_workgroup_id_x 1
.end_amdhsa_kernel
```
